```python
import torch

def _softmax(x, axis=-1):
    return torch.softmax(x, dim=axis)
def _gelu(x):
    return torch.nn.functional.gelu(x, approximate="tanh")
def _silu(x):
    return torch.nn.functional.silu(x)
def _sigmoid(x):
    return torch.sigmoid(x)
def _layernorm(x, axis=-1, eps=1e-5):
    m = x.mean(dim=axis, keepdim=True)
    v = x.var(dim=axis, keepdim=True, unbiased=False)
    return (x - m) / torch.sqrt(v + eps)
def _scatter_add(tgt, idx, src, axis=0):
    return tgt.clone().index_add_(axis, idx, src)
def _segment_sum(src, seg, n):
    out = torch.zeros((n,) + src.shape[1:], dtype=src.dtype)
    return out.index_add_(0, seg, src)
def _pad(x, pw):
    flat = tuple(v for pair in reversed(pw) for v in pair)
    return torch.nn.functional.pad(x, flat)

kernel_name = 'interleave_layers__linear_attn_block__dense_activation_gelu__prompt'

def setup_inputs():

    _w = (lambda a: (lambda t: t.to(torch.bfloat16) if t.is_floating_point() else t)(torch.as_tensor(a)))
    def _A_setup():
        B, S, D = 1, 2048, 640
        return {
            "x": _w((lambda *s: torch.randn(*s, dtype=torch.bfloat16) * 0.05)(B, S, D)),
            "wqkv": _w((lambda *s: torch.randn(*s, dtype=torch.bfloat16) * 0.05)(D, 3 * D)),
            "wo": _w((lambda *s: torch.randn(*s, dtype=torch.bfloat16) * 0.05)(D, D)),
        }
    _A_in = _A_setup()

    def _B_setup():
        B, S, D, F = 1, 2048, 640, 1728
        return {
            "x": _w((lambda *s: torch.randn(*s, dtype=torch.bfloat16) * 0.05)(B, S, D)),
            "w1": _w((lambda *s: torch.randn(*s, dtype=torch.bfloat16) * 0.8)(D, F) * (D ** -0.5)),
            "b1": _w((lambda *s: torch.randn(*s, dtype=torch.bfloat16) * 0.8)(F) * 0.01),
            "w2": _w((lambda *s: torch.randn(*s, dtype=torch.bfloat16) * 0.8)(F, D) * (F ** -0.5)),
            "b2": _w((lambda *s: torch.randn(*s, dtype=torch.bfloat16) * 0.8)(D) * 0.01),
        }
    _B_in = _B_setup()

    return {
        "A_x": _A_in["x"],
        "A_wqkv": _A_in["wqkv"],
        "A_wo": _A_in["wo"],
        "B_x": _B_in["x"],
        "B_w1": _B_in["w1"],
        "B_b1": _B_in["b1"],
        "B_w2": _B_in["w2"],
        "B_b2": _B_in["b2"],
    }

def reference(A_x, A_wqkv, A_wo, B_x, B_w1, B_b1, B_w2, B_b2):
    def _A_ref(x, wqkv, wo):
        B, S, D = x.shape
        H = 32; Dh = D // H
        qkv = (lambda x, *d: x.permute(*d))((x @ wqkv).reshape(B, S, 3, H, Dh), 2, 0, 3, 1, 4)
        q, k, v = qkv[0], qkv[1], qkv[2]
        phi = lambda t: torch.where(t > 0, t + 1, torch.exp(t)) + 1e-6
        pq, pk = phi(q), phi(k)
        kv = torch.einsum("bhsd,bhse->bhde", pk, v)
        z = torch.einsum("bhsd->bhd", pk)
        num = torch.einsum("bhqd,bhde->bhqe", pq, kv)
        den = torch.einsum("bhqd,bhd->bhq", pq, z)[..., None] + 1e-6
        o = num / den
        return (lambda x, *d: x.permute(*d))(o, 0, 2, 1, 3).reshape(B, S, D) @ wo

    def _B_ref(x, w1, b1, w2, b2):
        h = torch.einsum("bsd,df->bsf", x, w1) + b1
        h = _gelu(h)
        return torch.einsum("bsf,fd->bsd", h, w2) + b2

    x = A_x
    x = x + _A_ref(_layernorm(x, axis=-1), A_wqkv, A_wo)
    x = x + _B_ref(_layernorm(x, axis=-1), B_w1, B_b1, B_w2, B_b2)
    x = x + _A_ref(_layernorm(x, axis=-1), A_wqkv, A_wo)
    x = x + _B_ref(_layernorm(x, axis=-1), B_w1, B_b1, B_w2, B_b2)
    return x
```

```asm
; @launch kernel=prep_kernel grid=(1551,1,1) block=(256,1,1) lds=16384
; @launch kernel=k1p0_kernel grid=(208,1,1) block=(256,1,1) lds=148480
; @launch kernel=k2p0_kernel grid=(160,1,1) block=(256,1,1) lds=131072
; @launch kernel=k3p0_kernel grid=(224,1,1) block=(256,1,1) lds=99328
; @launch kernel=k4p0_kernel grid=(160,1,1) block=(256,1,1) lds=73728
; @launch kernel=k1p1_kernel grid=(208,1,1) block=(256,1,1) lds=148480
; @launch kernel=k2p1_kernel grid=(160,1,1) block=(256,1,1) lds=131072
; @launch kernel=k3p1_kernel grid=(224,1,1) block=(256,1,1) lds=99328
; @launch kernel=k4p1_kernel grid=(160,1,1) block=(256,1,1) lds=73728
.amdgcn_target "amdgcn-amd-amdhsa--gfx950"
.text
.globl prep_kernel
.p2align 8
.type prep_kernel,@function
prep_kernel:
    s_load_dwordx16 s[16:31], s[0:1], 0
    s_load_dwordx4 s[32:35], s[0:1], 64
    s_load_dwordx2 s[36:37], s[0:1], 80
    s_waitcnt lgkmcnt(0)
    s_cmp_ge_u32 s2, 1551
    s_cbranch_scc1 .k0_end
    s_cmp_ge_u32 s2, 1039
    s_cbranch_scc1 .k0_stats
    s_cmp_ge_u32 s2, 997
    s_cbranch_scc1 .k0_zero
    s_cmp_ge_u32 s2, 940
    s_cbranch_scc1 .k0_colsum
    s_cmp_ge_u32 s2, 300
    s_cbranch_scc1 .k0_t1
    s_sub_u32 s52, s2, 0
    s_mov_b32 s53, 429496730
    s_mul_hi_u32 s54, s52, s53
    s_mul_i32 s55, s54, 10
    s_sub_u32 s55, s52, s55
    s_lshl_b32 s50, s55, 6
    s_lshl_b32 s51, s54, 6
    s_mov_b32 s40, s18
    s_mov_b32 s41, s19
    s_and_b32 s41, s41, 0xffff
    s_mov_b32 s42, 2457600
    s_mov_b32 s43, 0x00020000
    s_mov_b32 s44, s36
    s_mov_b32 s45, s37
    s_and_b32 s45, s45, 0xffff
    s_mov_b32 s46, 2457600
    s_mov_b32 s47, 0x00020000
    s_mov_b32 s48, 3840
    s_mov_b32 s49, 1280
    s_branch .k0_tbody
.k0_t1:
    s_cmp_ge_u32 s2, 400
    s_cbranch_scc1 .k0_t2
    s_sub_u32 s52, s2, 300
    s_mov_b32 s53, 429496730
    s_mul_hi_u32 s54, s52, s53
    s_mul_i32 s55, s54, 10
    s_sub_u32 s55, s52, s55
    s_lshl_b32 s50, s55, 6
    s_lshl_b32 s51, s54, 6
    s_mov_b32 s40, s20
    s_mov_b32 s41, s21
    s_and_b32 s41, s41, 0xffff
    s_mov_b32 s42, 819200
    s_mov_b32 s43, 0x00020000
    s_add_u32 s44, s36, 2457600
    s_addc_u32 s45, s37, 0
    s_and_b32 s45, s45, 0xffff
    s_mov_b32 s46, 819200
    s_mov_b32 s47, 0x00020000
    s_mov_b32 s48, 1280
    s_mov_b32 s49, 1280
    s_branch .k0_tbody
.k0_t2:
    s_cmp_ge_u32 s2, 670
    s_cbranch_scc1 .k0_t3
    s_sub_u32 s52, s2, 400
    s_mov_b32 s53, 429496730
    s_mul_hi_u32 s54, s52, s53
    s_mul_i32 s55, s54, 10
    s_sub_u32 s55, s52, s55
    s_lshl_b32 s50, s55, 6
    s_lshl_b32 s51, s54, 6
    s_mov_b32 s40, s24
    s_mov_b32 s41, s25
    s_and_b32 s41, s41, 0xffff
    s_mov_b32 s42, 2211840
    s_mov_b32 s43, 0x00020000
    s_add_u32 s44, s36, 3276800
    s_addc_u32 s45, s37, 0
    s_and_b32 s45, s45, 0xffff
    s_mov_b32 s46, 2211840
    s_mov_b32 s47, 0x00020000
    s_mov_b32 s48, 3456
    s_mov_b32 s49, 1280
    s_branch .k0_tbody
.k0_t3:
    s_sub_u32 s52, s2, 670
    s_mov_b32 s53, 159072863
    s_mul_hi_u32 s54, s52, s53
    s_mul_i32 s55, s54, 27
    s_sub_u32 s55, s52, s55
    s_lshl_b32 s50, s55, 6
    s_lshl_b32 s51, s54, 6
    s_mov_b32 s40, s28
    s_mov_b32 s41, s29
    s_and_b32 s41, s41, 0xffff
    s_mov_b32 s42, 2211840
    s_mov_b32 s43, 0x00020000
    s_add_u32 s44, s36, 5488640
    s_addc_u32 s45, s37, 0
    s_and_b32 s45, s45, 0xffff
    s_mov_b32 s46, 2211840
    s_mov_b32 s47, 0x00020000
    s_mov_b32 s48, 1280
    s_mov_b32 s49, 3456
    s_branch .k0_tbody
.k0_tbody:
    v_lshrrev_b32 v1, 2, v0
    v_and_b32 v2, 3, v0
    v_add_u32 v3, s50, v1
    v_mul_lo_u32 v3, v3, s48
    v_lshlrev_b32 v4, 5, v2
    v_add_u32 v3, v3, v4
    s_lshl_b32 s56, s51, 1
    v_add_u32 v3, s56, v3
    buffer_load_dwordx4 v[8:11], v3, s[40:43], 0 offen
    buffer_load_dwordx4 v[12:15], v3, s[40:43], 0 offen offset:16
    v_mul_u32_u24 v5, 144, v1
    v_add_u32 v5, v5, v4
    s_waitcnt vmcnt(0)
    ds_write_b128 v5, v[8:11]
    ds_write_b128 v5, v[12:15] offset:16
    s_waitcnt lgkmcnt(0)
    s_barrier
    v_mul_u32_u24 v6, 2304, v2
    v_lshlrev_b32 v7, 1, v1
    v_add_u32 v6, v6, v7
    ds_read_u16 v24, v6 offset:0
    ds_read_u16 v25, v6 offset:144
    ds_read_u16 v26, v6 offset:288
    ds_read_u16 v27, v6 offset:432
    ds_read_u16 v28, v6 offset:576
    ds_read_u16 v29, v6 offset:720
    ds_read_u16 v30, v6 offset:864
    ds_read_u16 v31, v6 offset:1008
    ds_read_u16 v32, v6 offset:1152
    ds_read_u16 v33, v6 offset:1296
    ds_read_u16 v34, v6 offset:1440
    ds_read_u16 v35, v6 offset:1584
    ds_read_u16 v36, v6 offset:1728
    ds_read_u16 v37, v6 offset:1872
    ds_read_u16 v38, v6 offset:2016
    ds_read_u16 v39, v6 offset:2160
    v_add_u32 v3, s51, v1
    v_mul_lo_u32 v3, v3, s49
    v_add_u32 v3, v3, v4
    s_lshl_b32 s56, s50, 1
    v_add_u32 v3, s56, v3
    s_waitcnt lgkmcnt(0)
    v_lshl_or_b32 v16, v25, 16, v24
    v_lshl_or_b32 v17, v27, 16, v26
    v_lshl_or_b32 v18, v29, 16, v28
    v_lshl_or_b32 v19, v31, 16, v30
    v_lshl_or_b32 v20, v33, 16, v32
    v_lshl_or_b32 v21, v35, 16, v34
    v_lshl_or_b32 v22, v37, 16, v36
    v_lshl_or_b32 v23, v39, 16, v38
    buffer_store_dwordx4 v[16:19], v3, s[44:47], 0 offen
    buffer_store_dwordx4 v[20:23], v3, s[44:47], 0 offen offset:16
    s_endpgm
.k0_colsum:
    s_sub_u32 s52, s2, 940
    s_cmp_ge_u32 s52, 30
    s_cbranch_scc1 .k0_cs1
    s_mov_b32 s40, s18
    s_mov_b32 s41, s19
    s_and_b32 s41, s41, 0xffff
    s_mov_b32 s42, 2457600
    s_mov_b32 s43, 0x00020000
    s_add_u32 s44, s36, 7700480
    s_addc_u32 s45, s37, 0
    s_and_b32 s45, s45, 0xffff
    s_mov_b32 s46, 7680
    s_mov_b32 s47, 0x00020000
    s_mov_b32 s48, 3840
    s_branch .k0_csb
.k0_cs1:
    s_sub_u32 s52, s52, 30
    s_mov_b32 s40, s24
    s_mov_b32 s41, s25
    s_and_b32 s41, s41, 0xffff
    s_mov_b32 s42, 2211840
    s_mov_b32 s43, 0x00020000
    s_add_u32 s44, s36, 7708672
    s_addc_u32 s45, s37, 0
    s_and_b32 s45, s45, 0xffff
    s_mov_b32 s46, 6912
    s_mov_b32 s47, 0x00020000
    s_mov_b32 s48, 3456
.k0_csb:
    v_and_b32 v1, 31, v0
    v_lshrrev_b32 v2, 5, v0
    v_mul_u32_u24 v3, 80, v2
    v_mul_lo_u32 v3, v3, s48
    v_lshlrev_b32 v4, 2, v1
    v_add_u32 v3, v3, v4
    s_lshl_b32 s56, s52, 7
    v_add_u32 v3, s56, v3
    v_mov_b32 v10, 0
    v_mov_b32 v11, 0
    s_mov_b32 s57, 0
    buffer_load_dword v16, v3, s[40:43], s57 offen
    s_add_u32 s57, s57, s48
    buffer_load_dword v17, v3, s[40:43], s57 offen
    s_add_u32 s57, s57, s48
    buffer_load_dword v18, v3, s[40:43], s57 offen
    s_add_u32 s57, s57, s48
    buffer_load_dword v19, v3, s[40:43], s57 offen
    s_add_u32 s57, s57, s48
    buffer_load_dword v20, v3, s[40:43], s57 offen
    s_add_u32 s57, s57, s48
    buffer_load_dword v21, v3, s[40:43], s57 offen
    s_add_u32 s57, s57, s48
    buffer_load_dword v22, v3, s[40:43], s57 offen
    s_add_u32 s57, s57, s48
    buffer_load_dword v23, v3, s[40:43], s57 offen
    s_add_u32 s57, s57, s48
    buffer_load_dword v24, v3, s[40:43], s57 offen
    s_add_u32 s57, s57, s48
    buffer_load_dword v25, v3, s[40:43], s57 offen
    s_add_u32 s57, s57, s48
    buffer_load_dword v26, v3, s[40:43], s57 offen
    s_add_u32 s57, s57, s48
    buffer_load_dword v27, v3, s[40:43], s57 offen
    s_add_u32 s57, s57, s48
    buffer_load_dword v28, v3, s[40:43], s57 offen
    s_add_u32 s57, s57, s48
    buffer_load_dword v29, v3, s[40:43], s57 offen
    s_add_u32 s57, s57, s48
    buffer_load_dword v30, v3, s[40:43], s57 offen
    s_add_u32 s57, s57, s48
    buffer_load_dword v31, v3, s[40:43], s57 offen
    s_add_u32 s57, s57, s48
    buffer_load_dword v32, v3, s[40:43], s57 offen
    s_add_u32 s57, s57, s48
    buffer_load_dword v33, v3, s[40:43], s57 offen
    s_add_u32 s57, s57, s48
    buffer_load_dword v34, v3, s[40:43], s57 offen
    s_add_u32 s57, s57, s48
    buffer_load_dword v35, v3, s[40:43], s57 offen
    s_add_u32 s57, s57, s48
    buffer_load_dword v36, v3, s[40:43], s57 offen
    s_add_u32 s57, s57, s48
    buffer_load_dword v37, v3, s[40:43], s57 offen
    s_add_u32 s57, s57, s48
    buffer_load_dword v38, v3, s[40:43], s57 offen
    s_add_u32 s57, s57, s48
    buffer_load_dword v39, v3, s[40:43], s57 offen
    s_add_u32 s57, s57, s48
    buffer_load_dword v40, v3, s[40:43], s57 offen
    s_add_u32 s57, s57, s48
    buffer_load_dword v41, v3, s[40:43], s57 offen
    s_add_u32 s57, s57, s48
    buffer_load_dword v42, v3, s[40:43], s57 offen
    s_add_u32 s57, s57, s48
    buffer_load_dword v43, v3, s[40:43], s57 offen
    s_add_u32 s57, s57, s48
    buffer_load_dword v44, v3, s[40:43], s57 offen
    s_add_u32 s57, s57, s48
    buffer_load_dword v45, v3, s[40:43], s57 offen
    s_add_u32 s57, s57, s48
    buffer_load_dword v46, v3, s[40:43], s57 offen
    s_add_u32 s57, s57, s48
    buffer_load_dword v47, v3, s[40:43], s57 offen
    s_add_u32 s57, s57, s48
    buffer_load_dword v48, v3, s[40:43], s57 offen
    s_add_u32 s57, s57, s48
    buffer_load_dword v49, v3, s[40:43], s57 offen
    s_add_u32 s57, s57, s48
    buffer_load_dword v50, v3, s[40:43], s57 offen
    s_add_u32 s57, s57, s48
    buffer_load_dword v51, v3, s[40:43], s57 offen
    s_add_u32 s57, s57, s48
    buffer_load_dword v52, v3, s[40:43], s57 offen
    s_add_u32 s57, s57, s48
    buffer_load_dword v53, v3, s[40:43], s57 offen
    s_add_u32 s57, s57, s48
    buffer_load_dword v54, v3, s[40:43], s57 offen
    s_add_u32 s57, s57, s48
    buffer_load_dword v55, v3, s[40:43], s57 offen
    s_add_u32 s57, s57, s48
    s_waitcnt vmcnt(39)
    v_lshlrev_b32 v7, 16, v16
    v_and_b32 v8, 0xffff0000, v16
    v_add_f32 v10, v10, v7
    v_add_f32 v11, v11, v8
    s_waitcnt vmcnt(38)
    v_lshlrev_b32 v7, 16, v17
    v_and_b32 v8, 0xffff0000, v17
    v_add_f32 v10, v10, v7
    v_add_f32 v11, v11, v8
    s_waitcnt vmcnt(37)
    v_lshlrev_b32 v7, 16, v18
    v_and_b32 v8, 0xffff0000, v18
    v_add_f32 v10, v10, v7
    v_add_f32 v11, v11, v8
    s_waitcnt vmcnt(36)
    v_lshlrev_b32 v7, 16, v19
    v_and_b32 v8, 0xffff0000, v19
    v_add_f32 v10, v10, v7
    v_add_f32 v11, v11, v8
    s_waitcnt vmcnt(35)
    v_lshlrev_b32 v7, 16, v20
    v_and_b32 v8, 0xffff0000, v20
    v_add_f32 v10, v10, v7
    v_add_f32 v11, v11, v8
    s_waitcnt vmcnt(34)
    v_lshlrev_b32 v7, 16, v21
    v_and_b32 v8, 0xffff0000, v21
    v_add_f32 v10, v10, v7
    v_add_f32 v11, v11, v8
    s_waitcnt vmcnt(33)
    v_lshlrev_b32 v7, 16, v22
    v_and_b32 v8, 0xffff0000, v22
    v_add_f32 v10, v10, v7
    v_add_f32 v11, v11, v8
    s_waitcnt vmcnt(32)
    v_lshlrev_b32 v7, 16, v23
    v_and_b32 v8, 0xffff0000, v23
    v_add_f32 v10, v10, v7
    v_add_f32 v11, v11, v8
    s_waitcnt vmcnt(31)
    v_lshlrev_b32 v7, 16, v24
    v_and_b32 v8, 0xffff0000, v24
    v_add_f32 v10, v10, v7
    v_add_f32 v11, v11, v8
    s_waitcnt vmcnt(30)
    v_lshlrev_b32 v7, 16, v25
    v_and_b32 v8, 0xffff0000, v25
    v_add_f32 v10, v10, v7
    v_add_f32 v11, v11, v8
    s_waitcnt vmcnt(29)
    v_lshlrev_b32 v7, 16, v26
    v_and_b32 v8, 0xffff0000, v26
    v_add_f32 v10, v10, v7
    v_add_f32 v11, v11, v8
    s_waitcnt vmcnt(28)
    v_lshlrev_b32 v7, 16, v27
    v_and_b32 v8, 0xffff0000, v27
    v_add_f32 v10, v10, v7
    v_add_f32 v11, v11, v8
    s_waitcnt vmcnt(27)
    v_lshlrev_b32 v7, 16, v28
    v_and_b32 v8, 0xffff0000, v28
    v_add_f32 v10, v10, v7
    v_add_f32 v11, v11, v8
    s_waitcnt vmcnt(26)
    v_lshlrev_b32 v7, 16, v29
    v_and_b32 v8, 0xffff0000, v29
    v_add_f32 v10, v10, v7
    v_add_f32 v11, v11, v8
    s_waitcnt vmcnt(25)
    v_lshlrev_b32 v7, 16, v30
    v_and_b32 v8, 0xffff0000, v30
    v_add_f32 v10, v10, v7
    v_add_f32 v11, v11, v8
    s_waitcnt vmcnt(24)
    v_lshlrev_b32 v7, 16, v31
    v_and_b32 v8, 0xffff0000, v31
    v_add_f32 v10, v10, v7
    v_add_f32 v11, v11, v8
    s_waitcnt vmcnt(23)
    v_lshlrev_b32 v7, 16, v32
    v_and_b32 v8, 0xffff0000, v32
    v_add_f32 v10, v10, v7
    v_add_f32 v11, v11, v8
    s_waitcnt vmcnt(22)
    v_lshlrev_b32 v7, 16, v33
    v_and_b32 v8, 0xffff0000, v33
    v_add_f32 v10, v10, v7
    v_add_f32 v11, v11, v8
    s_waitcnt vmcnt(21)
    v_lshlrev_b32 v7, 16, v34
    v_and_b32 v8, 0xffff0000, v34
    v_add_f32 v10, v10, v7
    v_add_f32 v11, v11, v8
    s_waitcnt vmcnt(20)
    v_lshlrev_b32 v7, 16, v35
    v_and_b32 v8, 0xffff0000, v35
    v_add_f32 v10, v10, v7
    v_add_f32 v11, v11, v8
    s_waitcnt vmcnt(19)
    v_lshlrev_b32 v7, 16, v36
    v_and_b32 v8, 0xffff0000, v36
    v_add_f32 v10, v10, v7
    v_add_f32 v11, v11, v8
    s_waitcnt vmcnt(18)
    v_lshlrev_b32 v7, 16, v37
    v_and_b32 v8, 0xffff0000, v37
    v_add_f32 v10, v10, v7
    v_add_f32 v11, v11, v8
    s_waitcnt vmcnt(17)
    v_lshlrev_b32 v7, 16, v38
    v_and_b32 v8, 0xffff0000, v38
    v_add_f32 v10, v10, v7
    v_add_f32 v11, v11, v8
    s_waitcnt vmcnt(16)
    v_lshlrev_b32 v7, 16, v39
    v_and_b32 v8, 0xffff0000, v39
    v_add_f32 v10, v10, v7
    v_add_f32 v11, v11, v8
    s_waitcnt vmcnt(15)
    v_lshlrev_b32 v7, 16, v40
    v_and_b32 v8, 0xffff0000, v40
    v_add_f32 v10, v10, v7
    v_add_f32 v11, v11, v8
    s_waitcnt vmcnt(14)
    v_lshlrev_b32 v7, 16, v41
    v_and_b32 v8, 0xffff0000, v41
    v_add_f32 v10, v10, v7
    v_add_f32 v11, v11, v8
    s_waitcnt vmcnt(13)
    v_lshlrev_b32 v7, 16, v42
    v_and_b32 v8, 0xffff0000, v42
    v_add_f32 v10, v10, v7
    v_add_f32 v11, v11, v8
    s_waitcnt vmcnt(12)
    v_lshlrev_b32 v7, 16, v43
    v_and_b32 v8, 0xffff0000, v43
    v_add_f32 v10, v10, v7
    v_add_f32 v11, v11, v8
    s_waitcnt vmcnt(11)
    v_lshlrev_b32 v7, 16, v44
    v_and_b32 v8, 0xffff0000, v44
    v_add_f32 v10, v10, v7
    v_add_f32 v11, v11, v8
    s_waitcnt vmcnt(10)
    v_lshlrev_b32 v7, 16, v45
    v_and_b32 v8, 0xffff0000, v45
    v_add_f32 v10, v10, v7
    v_add_f32 v11, v11, v8
    s_waitcnt vmcnt(9)
    v_lshlrev_b32 v7, 16, v46
    v_and_b32 v8, 0xffff0000, v46
    v_add_f32 v10, v10, v7
    v_add_f32 v11, v11, v8
    s_waitcnt vmcnt(8)
    v_lshlrev_b32 v7, 16, v47
    v_and_b32 v8, 0xffff0000, v47
    v_add_f32 v10, v10, v7
    v_add_f32 v11, v11, v8
    s_waitcnt vmcnt(7)
    v_lshlrev_b32 v7, 16, v48
    v_and_b32 v8, 0xffff0000, v48
    v_add_f32 v10, v10, v7
    v_add_f32 v11, v11, v8
    s_waitcnt vmcnt(6)
    v_lshlrev_b32 v7, 16, v49
    v_and_b32 v8, 0xffff0000, v49
    v_add_f32 v10, v10, v7
    v_add_f32 v11, v11, v8
    s_waitcnt vmcnt(5)
    v_lshlrev_b32 v7, 16, v50
    v_and_b32 v8, 0xffff0000, v50
    v_add_f32 v10, v10, v7
    v_add_f32 v11, v11, v8
    s_waitcnt vmcnt(4)
    v_lshlrev_b32 v7, 16, v51
    v_and_b32 v8, 0xffff0000, v51
    v_add_f32 v10, v10, v7
    v_add_f32 v11, v11, v8
    s_waitcnt vmcnt(3)
    v_lshlrev_b32 v7, 16, v52
    v_and_b32 v8, 0xffff0000, v52
    v_add_f32 v10, v10, v7
    v_add_f32 v11, v11, v8
    s_waitcnt vmcnt(2)
    v_lshlrev_b32 v7, 16, v53
    v_and_b32 v8, 0xffff0000, v53
    v_add_f32 v10, v10, v7
    v_add_f32 v11, v11, v8
    s_waitcnt vmcnt(1)
    v_lshlrev_b32 v7, 16, v54
    v_and_b32 v8, 0xffff0000, v54
    v_add_f32 v10, v10, v7
    v_add_f32 v11, v11, v8
    s_waitcnt vmcnt(0)
    v_lshlrev_b32 v7, 16, v55
    v_and_b32 v8, 0xffff0000, v55
    v_add_f32 v10, v10, v7
    v_add_f32 v11, v11, v8
    buffer_load_dword v16, v3, s[40:43], s57 offen
    s_add_u32 s57, s57, s48
    buffer_load_dword v17, v3, s[40:43], s57 offen
    s_add_u32 s57, s57, s48
    buffer_load_dword v18, v3, s[40:43], s57 offen
    s_add_u32 s57, s57, s48
    buffer_load_dword v19, v3, s[40:43], s57 offen
    s_add_u32 s57, s57, s48
    buffer_load_dword v20, v3, s[40:43], s57 offen
    s_add_u32 s57, s57, s48
    buffer_load_dword v21, v3, s[40:43], s57 offen
    s_add_u32 s57, s57, s48
    buffer_load_dword v22, v3, s[40:43], s57 offen
    s_add_u32 s57, s57, s48
    buffer_load_dword v23, v3, s[40:43], s57 offen
    s_add_u32 s57, s57, s48
    buffer_load_dword v24, v3, s[40:43], s57 offen
    s_add_u32 s57, s57, s48
    buffer_load_dword v25, v3, s[40:43], s57 offen
    s_add_u32 s57, s57, s48
    buffer_load_dword v26, v3, s[40:43], s57 offen
    s_add_u32 s57, s57, s48
    buffer_load_dword v27, v3, s[40:43], s57 offen
    s_add_u32 s57, s57, s48
    buffer_load_dword v28, v3, s[40:43], s57 offen
    s_add_u32 s57, s57, s48
    buffer_load_dword v29, v3, s[40:43], s57 offen
    s_add_u32 s57, s57, s48
    buffer_load_dword v30, v3, s[40:43], s57 offen
    s_add_u32 s57, s57, s48
    buffer_load_dword v31, v3, s[40:43], s57 offen
    s_add_u32 s57, s57, s48
    buffer_load_dword v32, v3, s[40:43], s57 offen
    s_add_u32 s57, s57, s48
    buffer_load_dword v33, v3, s[40:43], s57 offen
    s_add_u32 s57, s57, s48
    buffer_load_dword v34, v3, s[40:43], s57 offen
    s_add_u32 s57, s57, s48
    buffer_load_dword v35, v3, s[40:43], s57 offen
    s_add_u32 s57, s57, s48
    buffer_load_dword v36, v3, s[40:43], s57 offen
    s_add_u32 s57, s57, s48
    buffer_load_dword v37, v3, s[40:43], s57 offen
    s_add_u32 s57, s57, s48
    buffer_load_dword v38, v3, s[40:43], s57 offen
    s_add_u32 s57, s57, s48
    buffer_load_dword v39, v3, s[40:43], s57 offen
    s_add_u32 s57, s57, s48
    buffer_load_dword v40, v3, s[40:43], s57 offen
    s_add_u32 s57, s57, s48
    buffer_load_dword v41, v3, s[40:43], s57 offen
    s_add_u32 s57, s57, s48
    buffer_load_dword v42, v3, s[40:43], s57 offen
    s_add_u32 s57, s57, s48
    buffer_load_dword v43, v3, s[40:43], s57 offen
    s_add_u32 s57, s57, s48
    buffer_load_dword v44, v3, s[40:43], s57 offen
    s_add_u32 s57, s57, s48
    buffer_load_dword v45, v3, s[40:43], s57 offen
    s_add_u32 s57, s57, s48
    buffer_load_dword v46, v3, s[40:43], s57 offen
    s_add_u32 s57, s57, s48
    buffer_load_dword v47, v3, s[40:43], s57 offen
    s_add_u32 s57, s57, s48
    buffer_load_dword v48, v3, s[40:43], s57 offen
    s_add_u32 s57, s57, s48
    buffer_load_dword v49, v3, s[40:43], s57 offen
    s_add_u32 s57, s57, s48
    buffer_load_dword v50, v3, s[40:43], s57 offen
    s_add_u32 s57, s57, s48
    buffer_load_dword v51, v3, s[40:43], s57 offen
    s_add_u32 s57, s57, s48
    buffer_load_dword v52, v3, s[40:43], s57 offen
    s_add_u32 s57, s57, s48
    buffer_load_dword v53, v3, s[40:43], s57 offen
    s_add_u32 s57, s57, s48
    buffer_load_dword v54, v3, s[40:43], s57 offen
    s_add_u32 s57, s57, s48
    buffer_load_dword v55, v3, s[40:43], s57 offen
    s_add_u32 s57, s57, s48
    s_waitcnt vmcnt(39)
    v_lshlrev_b32 v7, 16, v16
    v_and_b32 v8, 0xffff0000, v16
    v_add_f32 v10, v10, v7
    v_add_f32 v11, v11, v8
    s_waitcnt vmcnt(38)
    v_lshlrev_b32 v7, 16, v17
    v_and_b32 v8, 0xffff0000, v17
    v_add_f32 v10, v10, v7
    v_add_f32 v11, v11, v8
    s_waitcnt vmcnt(37)
    v_lshlrev_b32 v7, 16, v18
    v_and_b32 v8, 0xffff0000, v18
    v_add_f32 v10, v10, v7
    v_add_f32 v11, v11, v8
    s_waitcnt vmcnt(36)
    v_lshlrev_b32 v7, 16, v19
    v_and_b32 v8, 0xffff0000, v19
    v_add_f32 v10, v10, v7
    v_add_f32 v11, v11, v8
    s_waitcnt vmcnt(35)
    v_lshlrev_b32 v7, 16, v20
    v_and_b32 v8, 0xffff0000, v20
    v_add_f32 v10, v10, v7
    v_add_f32 v11, v11, v8
    s_waitcnt vmcnt(34)
    v_lshlrev_b32 v7, 16, v21
    v_and_b32 v8, 0xffff0000, v21
    v_add_f32 v10, v10, v7
    v_add_f32 v11, v11, v8
    s_waitcnt vmcnt(33)
    v_lshlrev_b32 v7, 16, v22
    v_and_b32 v8, 0xffff0000, v22
    v_add_f32 v10, v10, v7
    v_add_f32 v11, v11, v8
    s_waitcnt vmcnt(32)
    v_lshlrev_b32 v7, 16, v23
    v_and_b32 v8, 0xffff0000, v23
    v_add_f32 v10, v10, v7
    v_add_f32 v11, v11, v8
    s_waitcnt vmcnt(31)
    v_lshlrev_b32 v7, 16, v24
    v_and_b32 v8, 0xffff0000, v24
    v_add_f32 v10, v10, v7
    v_add_f32 v11, v11, v8
    s_waitcnt vmcnt(30)
    v_lshlrev_b32 v7, 16, v25
    v_and_b32 v8, 0xffff0000, v25
    v_add_f32 v10, v10, v7
    v_add_f32 v11, v11, v8
    s_waitcnt vmcnt(29)
    v_lshlrev_b32 v7, 16, v26
    v_and_b32 v8, 0xffff0000, v26
    v_add_f32 v10, v10, v7
    v_add_f32 v11, v11, v8
    s_waitcnt vmcnt(28)
    v_lshlrev_b32 v7, 16, v27
    v_and_b32 v8, 0xffff0000, v27
    v_add_f32 v10, v10, v7
    v_add_f32 v11, v11, v8
    s_waitcnt vmcnt(27)
    v_lshlrev_b32 v7, 16, v28
    v_and_b32 v8, 0xffff0000, v28
    v_add_f32 v10, v10, v7
    v_add_f32 v11, v11, v8
    s_waitcnt vmcnt(26)
    v_lshlrev_b32 v7, 16, v29
    v_and_b32 v8, 0xffff0000, v29
    v_add_f32 v10, v10, v7
    v_add_f32 v11, v11, v8
    s_waitcnt vmcnt(25)
    v_lshlrev_b32 v7, 16, v30
    v_and_b32 v8, 0xffff0000, v30
    v_add_f32 v10, v10, v7
    v_add_f32 v11, v11, v8
    s_waitcnt vmcnt(24)
    v_lshlrev_b32 v7, 16, v31
    v_and_b32 v8, 0xffff0000, v31
    v_add_f32 v10, v10, v7
    v_add_f32 v11, v11, v8
    s_waitcnt vmcnt(23)
    v_lshlrev_b32 v7, 16, v32
    v_and_b32 v8, 0xffff0000, v32
    v_add_f32 v10, v10, v7
    v_add_f32 v11, v11, v8
    s_waitcnt vmcnt(22)
    v_lshlrev_b32 v7, 16, v33
    v_and_b32 v8, 0xffff0000, v33
    v_add_f32 v10, v10, v7
    v_add_f32 v11, v11, v8
    s_waitcnt vmcnt(21)
    v_lshlrev_b32 v7, 16, v34
    v_and_b32 v8, 0xffff0000, v34
    v_add_f32 v10, v10, v7
    v_add_f32 v11, v11, v8
    s_waitcnt vmcnt(20)
    v_lshlrev_b32 v7, 16, v35
    v_and_b32 v8, 0xffff0000, v35
    v_add_f32 v10, v10, v7
    v_add_f32 v11, v11, v8
    s_waitcnt vmcnt(19)
    v_lshlrev_b32 v7, 16, v36
    v_and_b32 v8, 0xffff0000, v36
    v_add_f32 v10, v10, v7
    v_add_f32 v11, v11, v8
    s_waitcnt vmcnt(18)
    v_lshlrev_b32 v7, 16, v37
    v_and_b32 v8, 0xffff0000, v37
    v_add_f32 v10, v10, v7
    v_add_f32 v11, v11, v8
    s_waitcnt vmcnt(17)
    v_lshlrev_b32 v7, 16, v38
    v_and_b32 v8, 0xffff0000, v38
    v_add_f32 v10, v10, v7
    v_add_f32 v11, v11, v8
    s_waitcnt vmcnt(16)
    v_lshlrev_b32 v7, 16, v39
    v_and_b32 v8, 0xffff0000, v39
    v_add_f32 v10, v10, v7
    v_add_f32 v11, v11, v8
    s_waitcnt vmcnt(15)
    v_lshlrev_b32 v7, 16, v40
    v_and_b32 v8, 0xffff0000, v40
    v_add_f32 v10, v10, v7
    v_add_f32 v11, v11, v8
    s_waitcnt vmcnt(14)
    v_lshlrev_b32 v7, 16, v41
    v_and_b32 v8, 0xffff0000, v41
    v_add_f32 v10, v10, v7
    v_add_f32 v11, v11, v8
    s_waitcnt vmcnt(13)
    v_lshlrev_b32 v7, 16, v42
    v_and_b32 v8, 0xffff0000, v42
    v_add_f32 v10, v10, v7
    v_add_f32 v11, v11, v8
    s_waitcnt vmcnt(12)
    v_lshlrev_b32 v7, 16, v43
    v_and_b32 v8, 0xffff0000, v43
    v_add_f32 v10, v10, v7
    v_add_f32 v11, v11, v8
    s_waitcnt vmcnt(11)
    v_lshlrev_b32 v7, 16, v44
    v_and_b32 v8, 0xffff0000, v44
    v_add_f32 v10, v10, v7
    v_add_f32 v11, v11, v8
    s_waitcnt vmcnt(10)
    v_lshlrev_b32 v7, 16, v45
    v_and_b32 v8, 0xffff0000, v45
    v_add_f32 v10, v10, v7
    v_add_f32 v11, v11, v8
    s_waitcnt vmcnt(9)
    v_lshlrev_b32 v7, 16, v46
    v_and_b32 v8, 0xffff0000, v46
    v_add_f32 v10, v10, v7
    v_add_f32 v11, v11, v8
    s_waitcnt vmcnt(8)
    v_lshlrev_b32 v7, 16, v47
    v_and_b32 v8, 0xffff0000, v47
    v_add_f32 v10, v10, v7
    v_add_f32 v11, v11, v8
    s_waitcnt vmcnt(7)
    v_lshlrev_b32 v7, 16, v48
    v_and_b32 v8, 0xffff0000, v48
    v_add_f32 v10, v10, v7
    v_add_f32 v11, v11, v8
    s_waitcnt vmcnt(6)
    v_lshlrev_b32 v7, 16, v49
    v_and_b32 v8, 0xffff0000, v49
    v_add_f32 v10, v10, v7
    v_add_f32 v11, v11, v8
    s_waitcnt vmcnt(5)
    v_lshlrev_b32 v7, 16, v50
    v_and_b32 v8, 0xffff0000, v50
    v_add_f32 v10, v10, v7
    v_add_f32 v11, v11, v8
    s_waitcnt vmcnt(4)
    v_lshlrev_b32 v7, 16, v51
    v_and_b32 v8, 0xffff0000, v51
    v_add_f32 v10, v10, v7
    v_add_f32 v11, v11, v8
    s_waitcnt vmcnt(3)
    v_lshlrev_b32 v7, 16, v52
    v_and_b32 v8, 0xffff0000, v52
    v_add_f32 v10, v10, v7
    v_add_f32 v11, v11, v8
    s_waitcnt vmcnt(2)
    v_lshlrev_b32 v7, 16, v53
    v_and_b32 v8, 0xffff0000, v53
    v_add_f32 v10, v10, v7
    v_add_f32 v11, v11, v8
    s_waitcnt vmcnt(1)
    v_lshlrev_b32 v7, 16, v54
    v_and_b32 v8, 0xffff0000, v54
    v_add_f32 v10, v10, v7
    v_add_f32 v11, v11, v8
    s_waitcnt vmcnt(0)
    v_lshlrev_b32 v7, 16, v55
    v_and_b32 v8, 0xffff0000, v55
    v_add_f32 v10, v10, v7
    v_add_f32 v11, v11, v8
    v_lshlrev_b32 v7, 3, v0
    ds_write_b64 v7, v[10:11]
    s_waitcnt lgkmcnt(0)
    s_barrier
    v_cmp_gt_u32 vcc, 32, v0
    s_and_saveexec_b64 s[58:59], vcc
    s_cbranch_execz .k0_end
    v_lshlrev_b32 v7, 3, v0
    ds_read_b64 v[16:17], v7 offset:0
    ds_read_b64 v[18:19], v7 offset:256
    ds_read_b64 v[20:21], v7 offset:512
    ds_read_b64 v[22:23], v7 offset:768
    ds_read_b64 v[24:25], v7 offset:1024
    ds_read_b64 v[26:27], v7 offset:1280
    ds_read_b64 v[28:29], v7 offset:1536
    ds_read_b64 v[30:31], v7 offset:1792
    s_waitcnt lgkmcnt(0)
    v_add_f32 v16, v16, v18
    v_add_f32 v17, v17, v19
    v_add_f32 v16, v16, v20
    v_add_f32 v17, v17, v21
    v_add_f32 v16, v16, v22
    v_add_f32 v17, v17, v23
    v_add_f32 v16, v16, v24
    v_add_f32 v17, v17, v25
    v_add_f32 v16, v16, v26
    v_add_f32 v17, v17, v27
    v_add_f32 v16, v16, v28
    v_add_f32 v17, v17, v29
    v_add_f32 v16, v16, v30
    v_add_f32 v17, v17, v31
    v_lshlrev_b32 v4, 3, v0
    s_lshl_b32 s56, s52, 8
    v_add_u32 v4, s56, v4
    buffer_store_dwordx2 v[16:17], v4, s[44:47], 0 offen
    s_endpgm
.k0_zero:
    s_sub_u32 s52, s2, 997
    s_cmp_ge_u32 s52, 21
    s_cbranch_scc1 .k0_z1
    s_add_u32 s40, s36, 10993664
    s_addc_u32 s41, s37, 0
    s_and_b32 s41, s41, 0xffff
    s_mov_b32 s42, 166400
    s_mov_b32 s43, 0x00020000
    s_branch .k0_zb
.k0_z1:
    s_sub_u32 s52, s52, 21
    s_add_u32 s40, s36, 11161600
    s_addc_u32 s41, s37, 0
    s_and_b32 s41, s41, 0xffff
    s_mov_b32 s42, 166400
    s_mov_b32 s43, 0x00020000
.k0_zb:
    s_lshl_b32 s56, s52, 13
    v_lshlrev_b32 v1, 4, v0
    v_add_u32 v1, s56, v1
    v_mov_b32 v4, 0
    v_mov_b32 v5, 0
    v_mov_b32 v6, 0
    v_mov_b32 v7, 0
    v_add_u32 v2, 4096, v1
    buffer_store_dwordx4 v[4:7], v1, s[40:43], 0 offen
    buffer_store_dwordx4 v[4:7], v2, s[40:43], 0 offen
    s_endpgm
.k0_stats:
    s_sub_u32 s52, s2, 1039
    s_mov_b32 s40, s16
    s_mov_b32 s41, s17
    s_and_b32 s41, s41, 0xffff
    s_mov_b32 s42, 2621440
    s_mov_b32 s43, 0x00020000
    s_add_u32 s44, s36, 7716864
    s_addc_u32 s45, s37, 0
    s_and_b32 s45, s45, 0xffff
    s_mov_b32 s46, 163840
    s_mov_b32 s47, 0x00020000
    v_lshrrev_b32 v1, 6, v0
    v_and_b32 v2, 63, v0
    s_lshl_b32 s53, s52, 2
    v_add_u32 v3, s53, v1
    v_mul_u32_u24 v4, 1280, v3
    v_lshlrev_b32 v5, 2, v2
    v_add_u32 v4, v4, v5
    buffer_load_dword v16, v4, s[40:43], 0 offen offset:0
    buffer_load_dword v17, v4, s[40:43], 0 offen offset:256
    buffer_load_dword v18, v4, s[40:43], 0 offen offset:512
    buffer_load_dword v19, v4, s[40:43], 0 offen offset:768
    buffer_load_dword v20, v4, s[40:43], 0 offen offset:1024
    v_mov_b32 v6, 0
    v_mov_b32 v7, 0
    s_waitcnt vmcnt(0)
    v_lshlrev_b32 v8, 16, v16
    v_and_b32 v9, 0xffff0000, v16
    v_add_f32 v6, v6, v8
    v_fmac_f32 v7, v8, v8
    v_add_f32 v6, v6, v9
    v_fmac_f32 v7, v9, v9
    v_lshlrev_b32 v8, 16, v17
    v_and_b32 v9, 0xffff0000, v17
    v_add_f32 v6, v6, v8
    v_fmac_f32 v7, v8, v8
    v_add_f32 v6, v6, v9
    v_fmac_f32 v7, v9, v9
    v_lshlrev_b32 v8, 16, v18
    v_and_b32 v9, 0xffff0000, v18
    v_add_f32 v6, v6, v8
    v_fmac_f32 v7, v8, v8
    v_add_f32 v6, v6, v9
    v_fmac_f32 v7, v9, v9
    v_lshlrev_b32 v8, 16, v19
    v_and_b32 v9, 0xffff0000, v19
    v_add_f32 v6, v6, v8
    v_fmac_f32 v7, v8, v8
    v_add_f32 v6, v6, v9
    v_fmac_f32 v7, v9, v9
    v_lshlrev_b32 v8, 16, v20
    v_and_b32 v9, 0xffff0000, v20
    v_add_f32 v6, v6, v8
    v_fmac_f32 v7, v8, v8
    v_add_f32 v6, v6, v9
    v_fmac_f32 v7, v9, v9
    ds_swizzle_b32 v8, v6 offset:0x41f
    ds_swizzle_b32 v9, v7 offset:0x41f
    s_waitcnt lgkmcnt(0)
    v_add_f32 v6, v6, v8
    v_add_f32 v7, v7, v9
    ds_swizzle_b32 v8, v6 offset:0x81f
    ds_swizzle_b32 v9, v7 offset:0x81f
    s_waitcnt lgkmcnt(0)
    v_add_f32 v6, v6, v8
    v_add_f32 v7, v7, v9
    ds_swizzle_b32 v8, v6 offset:0x101f
    ds_swizzle_b32 v9, v7 offset:0x101f
    s_waitcnt lgkmcnt(0)
    v_add_f32 v6, v6, v8
    v_add_f32 v7, v7, v9
    ds_swizzle_b32 v8, v6 offset:0x201f
    ds_swizzle_b32 v9, v7 offset:0x201f
    s_waitcnt lgkmcnt(0)
    v_add_f32 v6, v6, v8
    v_add_f32 v7, v7, v9
    ds_swizzle_b32 v8, v6 offset:0x401f
    ds_swizzle_b32 v9, v7 offset:0x401f
    s_waitcnt lgkmcnt(0)
    v_add_f32 v6, v6, v8
    v_add_f32 v7, v7, v9
    s_nop 1
    v_readlane_b32 s60, v6, 32
    v_readlane_b32 s61, v7, 32
    s_nop 2
    v_add_f32 v6, s60, v6
    v_add_f32 v7, s61, v7
    v_cmp_eq_u32 vcc, 0, v2
    s_nop 1
    v_cndmask_b32 v6, 0, v6, vcc
    v_cndmask_b32 v7, 0, v7, vcc
    v_mul_u32_u24 v4, 80, v3
    v_lshlrev_b32 v5, 3, v2
    v_add_u32 v4, v4, v5
    v_cmp_gt_u32 vcc, 10, v2
    s_and_saveexec_b64 s[58:59], vcc
    buffer_store_dwordx2 v[6:7], v4, s[44:47], 0 offen
.k0_end:
    s_endpgm

.globl k1p0_kernel
.p2align 8
.type k1p0_kernel,@function
k1p0_kernel:
    s_cmp_ge_u32 s2, 208
    s_cbranch_scc1 .k1p0_kernel_end
    s_load_dwordx16 s[16:31], s[0:1], 0
    s_load_dwordx4 s[32:35], s[0:1], 64
    s_load_dwordx2 s[36:37], s[0:1], 80
    s_waitcnt lgkmcnt(0)
    s_cmp_ge_u32 s2, 128
    s_cbranch_scc1 .k1p0_kernel_q
    s_and_b32 s61, s2, 31
    s_lshl_b32 s61, s61, 6
    s_lshr_b32 s84, s2, 5
    s_mov_b32 s40, s16
    s_mov_b32 s41, s17
    s_and_b32 s41, s41, 0xffff
    s_mov_b32 s42, 2621440
    s_mov_b32 s43, 0x00020000
    s_mov_b32 s44, s36
    s_mov_b32 s45, s37
    s_and_b32 s45, s45, 0xffff
    s_mov_b32 s46, 2457600
    s_mov_b32 s47, 0x00020000
    s_mul_i32 s62, s84, 160
    s_add_u32 s62, s62, 640
    v_lshrrev_b32 v1, 6, v0
    s_nop 0
    v_readfirstlane_b32 s85, v1
    s_cmp_ge_u32 s85, 2
    s_cselect_b32 s86, 480, 0
    s_add_u32 s86, s86, s62
    v_and_b32 v160, 63, v0
    v_lshrrev_b32 v161, 6, v0
    s_nop 0
    v_readfirstlane_b32 s60, v161
    s_nop 1
    s_mul_i32 s63, s60, 2048
    s_mul_i32 s64, s60, 10240
    s_mul_i32 s65, s60, 16
    s_add_u32 s65, s65, 0
    v_lshrrev_b32 v161, 3, v160
    v_add_u32 v161, s65, v161
    v_lshrrev_b32 v162, 1, v161
    v_and_b32 v162, 7, v162
    v_and_b32 v132, 7, v160
    v_xor_b32 v162, v132, v162
    v_lshlrev_b32 v162, 4, v162
    v_add_u32 v161, s61, v161
    s_mov_b32 s66, 1280
    v_mul_lo_u32 v161, v161, s66
    v_add_u32 v132, v161, v162
    s_mul_i32 s65, s60, 16
    s_add_u32 s65, s65, 8
    v_lshrrev_b32 v161, 3, v160
    v_add_u32 v161, s65, v161
    v_lshrrev_b32 v162, 1, v161
    v_and_b32 v162, 7, v162
    v_and_b32 v133, 7, v160
    v_xor_b32 v162, v133, v162
    v_lshlrev_b32 v162, 4, v162
    v_add_u32 v161, s61, v161
    s_mov_b32 s66, 1280
    v_mul_lo_u32 v161, v161, s66
    v_add_u32 v133, v161, v162
    s_mul_i32 s65, s60, 80
    s_add_u32 s65, s65, 0
    v_lshrrev_b32 v161, 3, v160
    v_add_u32 v161, s65, v161
    v_lshrrev_b32 v162, 1, v161
    v_and_b32 v162, 7, v162
    v_and_b32 v134, 7, v160
    v_xor_b32 v162, v134, v162
    v_lshlrev_b32 v162, 4, v162
    v_add_u32 v161, s86, v161
    s_mov_b32 s66, 1280
    v_mul_lo_u32 v161, v161, s66
    v_add_u32 v134, v161, v162
    s_mul_i32 s65, s60, 80
    s_add_u32 s65, s65, 8
    v_lshrrev_b32 v161, 3, v160
    v_add_u32 v161, s65, v161
    v_lshrrev_b32 v162, 1, v161
    v_and_b32 v162, 7, v162
    v_and_b32 v135, 7, v160
    v_xor_b32 v162, v135, v162
    v_lshlrev_b32 v162, 4, v162
    v_add_u32 v161, s86, v161
    s_mov_b32 s66, 1280
    v_mul_lo_u32 v161, v161, s66
    v_add_u32 v135, v161, v162
    s_mul_i32 s65, s60, 80
    s_add_u32 s65, s65, 16
    v_lshrrev_b32 v161, 3, v160
    v_add_u32 v161, s65, v161
    v_lshrrev_b32 v162, 1, v161
    v_and_b32 v162, 7, v162
    v_and_b32 v136, 7, v160
    v_xor_b32 v162, v136, v162
    v_lshlrev_b32 v162, 4, v162
    v_add_u32 v161, s86, v161
    s_mov_b32 s66, 1280
    v_mul_lo_u32 v161, v161, s66
    v_add_u32 v136, v161, v162
    s_mul_i32 s65, s60, 80
    s_add_u32 s65, s65, 24
    v_lshrrev_b32 v161, 3, v160
    v_add_u32 v161, s65, v161
    v_lshrrev_b32 v162, 1, v161
    v_and_b32 v162, 7, v162
    v_and_b32 v137, 7, v160
    v_xor_b32 v162, v137, v162
    v_lshlrev_b32 v162, 4, v162
    v_add_u32 v161, s86, v161
    s_mov_b32 s66, 1280
    v_mul_lo_u32 v161, v161, s66
    v_add_u32 v137, v161, v162
    s_mul_i32 s65, s60, 80
    s_add_u32 s65, s65, 32
    v_lshrrev_b32 v161, 3, v160
    v_add_u32 v161, s65, v161
    v_lshrrev_b32 v162, 1, v161
    v_and_b32 v162, 7, v162
    v_and_b32 v138, 7, v160
    v_xor_b32 v162, v138, v162
    v_lshlrev_b32 v162, 4, v162
    v_add_u32 v161, s86, v161
    s_mov_b32 s66, 1280
    v_mul_lo_u32 v161, v161, s66
    v_add_u32 v138, v161, v162
    s_mul_i32 s65, s60, 80
    s_add_u32 s65, s65, 40
    v_lshrrev_b32 v161, 3, v160
    v_add_u32 v161, s65, v161
    v_lshrrev_b32 v162, 1, v161
    v_and_b32 v162, 7, v162
    v_and_b32 v139, 7, v160
    v_xor_b32 v162, v139, v162
    v_lshlrev_b32 v162, 4, v162
    v_add_u32 v161, s86, v161
    s_mov_b32 s66, 1280
    v_mul_lo_u32 v161, v161, s66
    v_add_u32 v139, v161, v162
    s_mul_i32 s65, s60, 80
    s_add_u32 s65, s65, 48
    v_lshrrev_b32 v161, 3, v160
    v_add_u32 v161, s65, v161
    v_lshrrev_b32 v162, 1, v161
    v_and_b32 v162, 7, v162
    v_and_b32 v140, 7, v160
    v_xor_b32 v162, v140, v162
    v_lshlrev_b32 v162, 4, v162
    v_add_u32 v161, s86, v161
    s_mov_b32 s66, 1280
    v_mul_lo_u32 v161, v161, s66
    v_add_u32 v140, v161, v162
    s_mul_i32 s65, s60, 80
    s_add_u32 s65, s65, 56
    v_lshrrev_b32 v161, 3, v160
    v_add_u32 v161, s65, v161
    v_lshrrev_b32 v162, 1, v161
    v_and_b32 v162, 7, v162
    v_and_b32 v141, 7, v160
    v_xor_b32 v162, v141, v162
    v_lshlrev_b32 v162, 4, v162
    v_add_u32 v161, s86, v161
    s_mov_b32 s66, 1280
    v_mul_lo_u32 v161, v161, s66
    v_add_u32 v141, v161, v162
    s_mul_i32 s65, s60, 80
    s_add_u32 s65, s65, 64
    v_lshrrev_b32 v161, 3, v160
    v_add_u32 v161, s65, v161
    v_lshrrev_b32 v162, 1, v161
    v_and_b32 v162, 7, v162
    v_and_b32 v142, 7, v160
    v_xor_b32 v162, v142, v162
    v_lshlrev_b32 v162, 4, v162
    v_add_u32 v161, s86, v161
    s_mov_b32 s66, 1280
    v_mul_lo_u32 v161, v161, s66
    v_add_u32 v142, v161, v162
    s_mul_i32 s65, s60, 80
    s_add_u32 s65, s65, 72
    v_lshrrev_b32 v161, 3, v160
    v_add_u32 v161, s65, v161
    v_lshrrev_b32 v162, 1, v161
    v_and_b32 v162, 7, v162
    v_and_b32 v143, 7, v160
    v_xor_b32 v162, v143, v162
    v_lshlrev_b32 v162, 4, v162
    v_add_u32 v161, s86, v161
    s_mov_b32 s66, 1280
    v_mul_lo_u32 v161, v161, s66
    v_add_u32 v143, v161, v162
    s_and_b32 s67, s60, 1
    s_lshr_b32 s68, s60, 1
    v_lshrrev_b32 v161, 5, v160
    v_add_u32 v161, 0, v161
    v_lshrrev_b32 v162, 1, v160
    v_and_b32 v162, 7, v162
    v_xor_b32 v161, v161, v162
    v_lshlrev_b32 v161, 4, v161
    v_and_b32 v162, 31, v160
    v_lshl_add_u32 v161, v162, 7, v161
    s_mul_i32 s65, s67, 4096
    v_add_u32 v144, s65, v161
    v_add_u32 v156, 0x10000, v144
    s_mul_i32 s65, s68, 20480
    v_add_u32 v148, s65, v161
    v_add_u32 v152, 0x10000, v148
    v_lshrrev_b32 v161, 5, v160
    v_add_u32 v161, 2, v161
    v_lshrrev_b32 v162, 1, v160
    v_and_b32 v162, 7, v162
    v_xor_b32 v161, v161, v162
    v_lshlrev_b32 v161, 4, v161
    v_and_b32 v162, 31, v160
    v_lshl_add_u32 v161, v162, 7, v161
    s_mul_i32 s65, s67, 4096
    v_add_u32 v145, s65, v161
    v_add_u32 v157, 0x10000, v145
    s_mul_i32 s65, s68, 20480
    v_add_u32 v149, s65, v161
    v_add_u32 v153, 0x10000, v149
    v_lshrrev_b32 v161, 5, v160
    v_add_u32 v161, 4, v161
    v_lshrrev_b32 v162, 1, v160
    v_and_b32 v162, 7, v162
    v_xor_b32 v161, v161, v162
    v_lshlrev_b32 v161, 4, v161
    v_and_b32 v162, 31, v160
    v_lshl_add_u32 v161, v162, 7, v161
    s_mul_i32 s65, s67, 4096
    v_add_u32 v146, s65, v161
    v_add_u32 v158, 0x10000, v146
    s_mul_i32 s65, s68, 20480
    v_add_u32 v150, s65, v161
    v_add_u32 v154, 0x10000, v150
    v_lshrrev_b32 v161, 5, v160
    v_add_u32 v161, 6, v161
    v_lshrrev_b32 v162, 1, v160
    v_and_b32 v162, 7, v162
    v_xor_b32 v161, v161, v162
    v_lshlrev_b32 v161, 4, v161
    v_and_b32 v162, 31, v160
    v_lshl_add_u32 v161, v162, 7, v161
    s_mul_i32 s65, s67, 4096
    v_add_u32 v147, s65, v161
    v_add_u32 v159, 0x10000, v147
    s_mul_i32 s65, s68, 20480
    v_add_u32 v151, s65, v161
    v_add_u32 v155, 0x10000, v151
    v_mov_b32 v4, 0
    v_mov_b32 v5, 0
    v_mov_b32 v6, 0
    v_mov_b32 v7, 0
    v_mov_b32 v8, 0
    v_mov_b32 v9, 0
    v_mov_b32 v10, 0
    v_mov_b32 v11, 0
    v_mov_b32 v12, 0
    v_mov_b32 v13, 0
    v_mov_b32 v14, 0
    v_mov_b32 v15, 0
    v_mov_b32 v16, 0
    v_mov_b32 v17, 0
    v_mov_b32 v18, 0
    v_mov_b32 v19, 0
    v_mov_b32 v20, 0
    v_mov_b32 v21, 0
    v_mov_b32 v22, 0
    v_mov_b32 v23, 0
    v_mov_b32 v24, 0
    v_mov_b32 v25, 0
    v_mov_b32 v26, 0
    v_mov_b32 v27, 0
    v_mov_b32 v28, 0
    v_mov_b32 v29, 0
    v_mov_b32 v30, 0
    v_mov_b32 v31, 0
    v_mov_b32 v32, 0
    v_mov_b32 v33, 0
    v_mov_b32 v34, 0
    v_mov_b32 v35, 0
    v_mov_b32 v36, 0
    v_mov_b32 v37, 0
    v_mov_b32 v38, 0
    v_mov_b32 v39, 0
    v_mov_b32 v40, 0
    v_mov_b32 v41, 0
    v_mov_b32 v42, 0
    v_mov_b32 v43, 0
    v_mov_b32 v44, 0
    v_mov_b32 v45, 0
    v_mov_b32 v46, 0
    v_mov_b32 v47, 0
    v_mov_b32 v48, 0
    v_mov_b32 v49, 0
    v_mov_b32 v50, 0
    v_mov_b32 v51, 0
    v_mov_b32 v52, 0
    v_mov_b32 v53, 0
    v_mov_b32 v54, 0
    v_mov_b32 v55, 0
    v_mov_b32 v56, 0
    v_mov_b32 v57, 0
    v_mov_b32 v58, 0
    v_mov_b32 v59, 0
    v_mov_b32 v60, 0
    v_mov_b32 v61, 0
    v_mov_b32 v62, 0
    v_mov_b32 v63, 0
    v_mov_b32 v64, 0
    v_mov_b32 v65, 0
    v_mov_b32 v66, 0
    v_mov_b32 v67, 0
    v_mov_b32 v68, 0
    v_mov_b32 v69, 0
    v_mov_b32 v70, 0
    v_mov_b32 v71, 0
    v_mov_b32 v72, 0
    v_mov_b32 v73, 0
    v_mov_b32 v74, 0
    v_mov_b32 v75, 0
    v_mov_b32 v76, 0
    v_mov_b32 v77, 0
    v_mov_b32 v78, 0
    v_mov_b32 v79, 0
    v_mov_b32 v80, 0
    v_mov_b32 v81, 0
    v_mov_b32 v82, 0
    v_mov_b32 v83, 0
    s_mov_b32 s69, 0
    s_add_u32 m0, s63, 1024
    buffer_load_dwordx4 v132, s[40:43], s69 offen lds
    s_add_u32 m0, s63, 2048
    buffer_load_dwordx4 v133, s[40:43], s69 offen lds
    s_add_u32 m0, s64, 9216
    buffer_load_dwordx4 v134, s[44:47], s69 offen lds
    s_add_u32 m0, s64, 10240
    buffer_load_dwordx4 v135, s[44:47], s69 offen lds
    s_add_u32 m0, s64, 11264
    buffer_load_dwordx4 v136, s[44:47], s69 offen lds
    s_add_u32 m0, s64, 12288
    buffer_load_dwordx4 v137, s[44:47], s69 offen lds
    s_add_u32 m0, s64, 13312
    buffer_load_dwordx4 v138, s[44:47], s69 offen lds
    s_add_u32 m0, s64, 14336
    buffer_load_dwordx4 v139, s[44:47], s69 offen lds
    s_add_u32 m0, s64, 15360
    buffer_load_dwordx4 v140, s[44:47], s69 offen lds
    s_add_u32 m0, s64, 16384
    buffer_load_dwordx4 v141, s[44:47], s69 offen lds
    s_add_u32 m0, s64, 17408
    buffer_load_dwordx4 v142, s[44:47], s69 offen lds
    s_add_u32 m0, s64, 18432
    buffer_load_dwordx4 v143, s[44:47], s69 offen lds
    s_mov_b32 s69, 128
    s_add_u32 m0, s63, 50176
    buffer_load_dwordx4 v132, s[40:43], s69 offen lds
    s_add_u32 m0, s63, 51200
    buffer_load_dwordx4 v133, s[40:43], s69 offen lds
    s_add_u32 m0, s64, 58368
    buffer_load_dwordx4 v134, s[44:47], s69 offen lds
    s_add_u32 m0, s64, 59392
    buffer_load_dwordx4 v135, s[44:47], s69 offen lds
    s_add_u32 m0, s64, 60416
    buffer_load_dwordx4 v136, s[44:47], s69 offen lds
    s_add_u32 m0, s64, 61440
    buffer_load_dwordx4 v137, s[44:47], s69 offen lds
    s_add_u32 m0, s64, 62464
    buffer_load_dwordx4 v138, s[44:47], s69 offen lds
    s_add_u32 m0, s64, 63488
    buffer_load_dwordx4 v139, s[44:47], s69 offen lds
    s_add_u32 m0, s64, 64512
    buffer_load_dwordx4 v140, s[44:47], s69 offen lds
    s_add_u32 m0, s64, 65536
    buffer_load_dwordx4 v141, s[44:47], s69 offen lds
    s_add_u32 m0, s64, 66560
    buffer_load_dwordx4 v142, s[44:47], s69 offen lds
    s_add_u32 m0, s64, 67584
    buffer_load_dwordx4 v143, s[44:47], s69 offen lds
    s_add_u32 s72, s36, 7716864
    s_addc_u32 s73, s37, 0
    s_and_b32 s73, s73, 0xffff
    s_mov_b32 s74, 163840
    s_mov_b32 s75, 0x00020000
    v_cmp_gt_u32 vcc, 64, v0
    s_and_saveexec_b64 s[76:77], vcc
    s_cbranch_execz .st_1
    v_add_u32 v104, s61, v0
    v_mul_u32_u24 v104, 80, v104
    buffer_load_dwordx4 v[84:87], v104, s[72:75], 0 offen offset:0
    buffer_load_dwordx4 v[88:91], v104, s[72:75], 0 offen offset:16
    buffer_load_dwordx4 v[92:95], v104, s[72:75], 0 offen offset:32
    buffer_load_dwordx4 v[96:99], v104, s[72:75], 0 offen offset:48
    buffer_load_dwordx4 v[100:103], v104, s[72:75], 0 offen offset:64
    s_waitcnt vmcnt(0)
    v_add_f32 v104, v84, v86
    v_add_f32 v105, v85, v87
    v_add_f32 v104, v104, v88
    v_add_f32 v105, v105, v89
    v_add_f32 v104, v104, v90
    v_add_f32 v105, v105, v91
    v_add_f32 v104, v104, v92
    v_add_f32 v105, v105, v93
    v_add_f32 v104, v104, v94
    v_add_f32 v105, v105, v95
    v_add_f32 v104, v104, v96
    v_add_f32 v105, v105, v97
    v_add_f32 v104, v104, v98
    v_add_f32 v105, v105, v99
    v_add_f32 v104, v104, v100
    v_add_f32 v105, v105, v101
    v_add_f32 v104, v104, v102
    v_add_f32 v105, v105, v103
    v_mul_f32 v104, 0x3acccccd, v104
    v_mul_f32 v105, 0x3acccccd, v105
    v_fma_f32 v105, -v104, v104, v105
    v_max_f32 v105, 0, v105
    v_cvt_pk_bf16_f32 v106, v104, v105
    v_lshlrev_b32 v104, 16, v106
    v_and_b32 v105, 0xffff0000, v106
    v_add_f32 v105, 0x3727c5ac, v105
    v_cvt_pk_bf16_f32 v106, v105, v105
    v_lshlrev_b32 v105, 16, v106
    v_sqrt_f32 v105, v105
    s_nop 0
    v_cvt_pk_bf16_f32 v106, v105, v105
    v_lshlrev_b32 v105, 16, v106
    v_rcp_f32 v105, v105
    v_lshlrev_b32 v106, 3, v0
    s_nop 0
    ds_write_b64 v106, v[104:105] offset:0
.st_1:
    s_or_b64 exec, exec, s[76:77]
    s_add_u32 s48, s36, 7700480
    s_addc_u32 s49, s37, 0
    s_and_b32 s49, s49, 0xffff
    s_mov_b32 s50, 7680
    s_mov_b32 s51, 0x00020000
    s_add_u32 s52, s36, 10993664
    s_addc_u32 s53, s37, 0
    s_and_b32 s53, s53, 0xffff
    s_mov_b32 s54, 166400
    s_mov_b32 s55, 0x00020000
    v_and_b32 v168, 31, v160
    v_lshlrev_b32 v168, 2, v168
    s_mul_i32 s65, s68, 160
    s_add_u32 s65, s65, s86
    s_lshl_b32 s65, s65, 2
    buffer_load_dword v163, v168, s[48:51], s65 offen offset:0
    buffer_load_dword v164, v168, s[48:51], s65 offen offset:128
    buffer_load_dword v165, v168, s[48:51], s65 offen offset:256
    buffer_load_dword v166, v168, s[48:51], s65 offen offset:384
    buffer_load_dword v167, v168, s[48:51], s65 offen offset:512
    s_waitcnt vmcnt(22)
    s_barrier
    s_mov_b32 s69, 256
    s_add_u32 m0, s63, 99328
    buffer_load_dwordx4 v132, s[40:43], s69 offen lds
    s_add_u32 m0, s63, 100352
    buffer_load_dwordx4 v133, s[40:43], s69 offen lds
    s_add_u32 m0, s64, 107520
    buffer_load_dwordx4 v134, s[44:47], s69 offen lds
    s_add_u32 m0, s64, 108544
    buffer_load_dwordx4 v135, s[44:47], s69 offen lds
    s_add_u32 m0, s64, 109568
    buffer_load_dwordx4 v136, s[44:47], s69 offen lds
    s_add_u32 m0, s64, 110592
    buffer_load_dwordx4 v137, s[44:47], s69 offen lds
    s_add_u32 m0, s64, 111616
    buffer_load_dwordx4 v138, s[44:47], s69 offen lds
    s_add_u32 m0, s64, 112640
    buffer_load_dwordx4 v139, s[44:47], s69 offen lds
    s_add_u32 m0, s64, 113664
    buffer_load_dwordx4 v140, s[44:47], s69 offen lds
    s_add_u32 m0, s64, 114688
    buffer_load_dwordx4 v141, s[44:47], s69 offen lds
    s_add_u32 m0, s64, 115712
    buffer_load_dwordx4 v142, s[44:47], s69 offen lds
    s_add_u32 m0, s64, 116736
    buffer_load_dwordx4 v143, s[44:47], s69 offen lds
    ds_read_b128 v[84:87], v144 offset:1024
    ds_read_b128 v[92:95], v148 offset:9216
    ds_read_b128 v[96:99], v148 offset:13312
    ds_read_b128 v[100:103], v148 offset:17408
    ds_read_b128 v[104:107], v148 offset:21504
    ds_read_b128 v[108:111], v148 offset:25600
    ds_read_b128 v[88:91], v145 offset:1024
    ds_read_b128 v[112:115], v149 offset:9216
    ds_read_b128 v[116:119], v149 offset:13312
    ds_read_b128 v[120:123], v149 offset:17408
    ds_read_b128 v[124:127], v149 offset:21504
    ds_read_b128 v[128:131], v149 offset:25600
    s_waitcnt lgkmcnt(6)
    v_mfma_f32_32x32x16_bf16 v[4:19], v[84:87], v[92:95], v[4:19]
    v_mfma_f32_32x32x16_bf16 v[20:35], v[84:87], v[96:99], v[20:35]
    v_mfma_f32_32x32x16_bf16 v[36:51], v[84:87], v[100:103], v[36:51]
    v_mfma_f32_32x32x16_bf16 v[52:67], v[84:87], v[104:107], v[52:67]
    v_mfma_f32_32x32x16_bf16 v[68:83], v[84:87], v[108:111], v[68:83]
    ds_read_b128 v[84:87], v146 offset:1024
    ds_read_b128 v[92:95], v150 offset:9216
    ds_read_b128 v[96:99], v150 offset:13312
    ds_read_b128 v[100:103], v150 offset:17408
    ds_read_b128 v[104:107], v150 offset:21504
    ds_read_b128 v[108:111], v150 offset:25600
    s_waitcnt lgkmcnt(6)
    v_mfma_f32_32x32x16_bf16 v[4:19], v[88:91], v[112:115], v[4:19]
    v_mfma_f32_32x32x16_bf16 v[20:35], v[88:91], v[116:119], v[20:35]
    v_mfma_f32_32x32x16_bf16 v[36:51], v[88:91], v[120:123], v[36:51]
    v_mfma_f32_32x32x16_bf16 v[52:67], v[88:91], v[124:127], v[52:67]
    v_mfma_f32_32x32x16_bf16 v[68:83], v[88:91], v[128:131], v[68:83]
    ds_read_b128 v[88:91], v147 offset:1024
    ds_read_b128 v[112:115], v151 offset:9216
    ds_read_b128 v[116:119], v151 offset:13312
    ds_read_b128 v[120:123], v151 offset:17408
    ds_read_b128 v[124:127], v151 offset:21504
    ds_read_b128 v[128:131], v151 offset:25600
    s_waitcnt lgkmcnt(6)
    v_mfma_f32_32x32x16_bf16 v[4:19], v[84:87], v[92:95], v[4:19]
    v_mfma_f32_32x32x16_bf16 v[20:35], v[84:87], v[96:99], v[20:35]
    v_mfma_f32_32x32x16_bf16 v[36:51], v[84:87], v[100:103], v[36:51]
    v_mfma_f32_32x32x16_bf16 v[52:67], v[84:87], v[104:107], v[52:67]
    v_mfma_f32_32x32x16_bf16 v[68:83], v[84:87], v[108:111], v[68:83]
    s_waitcnt vmcnt(22) lgkmcnt(0)
    s_barrier
    s_mov_b32 s69, 384
    s_add_u32 m0, s63, 1024
    buffer_load_dwordx4 v132, s[40:43], s69 offen lds
    s_add_u32 m0, s63, 2048
    buffer_load_dwordx4 v133, s[40:43], s69 offen lds
    s_add_u32 m0, s64, 9216
    buffer_load_dwordx4 v134, s[44:47], s69 offen lds
    s_add_u32 m0, s64, 10240
    buffer_load_dwordx4 v135, s[44:47], s69 offen lds
    s_add_u32 m0, s64, 11264
    buffer_load_dwordx4 v136, s[44:47], s69 offen lds
    s_add_u32 m0, s64, 12288
    buffer_load_dwordx4 v137, s[44:47], s69 offen lds
    s_add_u32 m0, s64, 13312
    buffer_load_dwordx4 v138, s[44:47], s69 offen lds
    s_add_u32 m0, s64, 14336
    buffer_load_dwordx4 v139, s[44:47], s69 offen lds
    s_add_u32 m0, s64, 15360
    buffer_load_dwordx4 v140, s[44:47], s69 offen lds
    s_add_u32 m0, s64, 16384
    buffer_load_dwordx4 v141, s[44:47], s69 offen lds
    s_add_u32 m0, s64, 17408
    buffer_load_dwordx4 v142, s[44:47], s69 offen lds
    s_add_u32 m0, s64, 18432
    buffer_load_dwordx4 v143, s[44:47], s69 offen lds
    ds_read_b128 v[84:87], v144 offset:50176
    ds_read_b128 v[92:95], v148 offset:58368
    ds_read_b128 v[96:99], v148 offset:62464
    ds_read_b128 v[100:103], v152 offset:1024
    ds_read_b128 v[104:107], v152 offset:5120
    ds_read_b128 v[108:111], v152 offset:9216
    v_mfma_f32_32x32x16_bf16 v[4:19], v[88:91], v[112:115], v[4:19]
    v_mfma_f32_32x32x16_bf16 v[20:35], v[88:91], v[116:119], v[20:35]
    v_mfma_f32_32x32x16_bf16 v[36:51], v[88:91], v[120:123], v[36:51]
    v_mfma_f32_32x32x16_bf16 v[52:67], v[88:91], v[124:127], v[52:67]
    v_mfma_f32_32x32x16_bf16 v[68:83], v[88:91], v[128:131], v[68:83]
    ds_read_b128 v[88:91], v145 offset:50176
    ds_read_b128 v[112:115], v149 offset:58368
    ds_read_b128 v[116:119], v149 offset:62464
    ds_read_b128 v[120:123], v153 offset:1024
    ds_read_b128 v[124:127], v153 offset:5120
    ds_read_b128 v[128:131], v153 offset:9216
    s_waitcnt lgkmcnt(6)
    v_mfma_f32_32x32x16_bf16 v[4:19], v[84:87], v[92:95], v[4:19]
    v_mfma_f32_32x32x16_bf16 v[20:35], v[84:87], v[96:99], v[20:35]
    v_mfma_f32_32x32x16_bf16 v[36:51], v[84:87], v[100:103], v[36:51]
    v_mfma_f32_32x32x16_bf16 v[52:67], v[84:87], v[104:107], v[52:67]
    v_mfma_f32_32x32x16_bf16 v[68:83], v[84:87], v[108:111], v[68:83]
    ds_read_b128 v[84:87], v146 offset:50176
    ds_read_b128 v[92:95], v150 offset:58368
    ds_read_b128 v[96:99], v150 offset:62464
    ds_read_b128 v[100:103], v154 offset:1024
    ds_read_b128 v[104:107], v154 offset:5120
    ds_read_b128 v[108:111], v154 offset:9216
    s_waitcnt lgkmcnt(6)
    v_mfma_f32_32x32x16_bf16 v[4:19], v[88:91], v[112:115], v[4:19]
    v_mfma_f32_32x32x16_bf16 v[20:35], v[88:91], v[116:119], v[20:35]
    v_mfma_f32_32x32x16_bf16 v[36:51], v[88:91], v[120:123], v[36:51]
    v_mfma_f32_32x32x16_bf16 v[52:67], v[88:91], v[124:127], v[52:67]
    v_mfma_f32_32x32x16_bf16 v[68:83], v[88:91], v[128:131], v[68:83]
    ds_read_b128 v[88:91], v147 offset:50176
    ds_read_b128 v[112:115], v151 offset:58368
    ds_read_b128 v[116:119], v151 offset:62464
    ds_read_b128 v[120:123], v155 offset:1024
    ds_read_b128 v[124:127], v155 offset:5120
    ds_read_b128 v[128:131], v155 offset:9216
    s_waitcnt lgkmcnt(6)
    v_mfma_f32_32x32x16_bf16 v[4:19], v[84:87], v[92:95], v[4:19]
    v_mfma_f32_32x32x16_bf16 v[20:35], v[84:87], v[96:99], v[20:35]
    v_mfma_f32_32x32x16_bf16 v[36:51], v[84:87], v[100:103], v[36:51]
    v_mfma_f32_32x32x16_bf16 v[52:67], v[84:87], v[104:107], v[52:67]
    v_mfma_f32_32x32x16_bf16 v[68:83], v[84:87], v[108:111], v[68:83]
    s_waitcnt vmcnt(12) lgkmcnt(0)
    s_barrier
    s_mov_b32 s69, 512
    s_add_u32 m0, s63, 50176
    buffer_load_dwordx4 v132, s[40:43], s69 offen lds
    s_add_u32 m0, s63, 51200
    buffer_load_dwordx4 v133, s[40:43], s69 offen lds
    s_add_u32 m0, s64, 58368
    buffer_load_dwordx4 v134, s[44:47], s69 offen lds
    s_add_u32 m0, s64, 59392
    buffer_load_dwordx4 v135, s[44:47], s69 offen lds
    s_add_u32 m0, s64, 60416
    buffer_load_dwordx4 v136, s[44:47], s69 offen lds
    s_add_u32 m0, s64, 61440
    buffer_load_dwordx4 v137, s[44:47], s69 offen lds
    s_add_u32 m0, s64, 62464
    buffer_load_dwordx4 v138, s[44:47], s69 offen lds
    s_add_u32 m0, s64, 63488
    buffer_load_dwordx4 v139, s[44:47], s69 offen lds
    s_add_u32 m0, s64, 64512
    buffer_load_dwordx4 v140, s[44:47], s69 offen lds
    s_add_u32 m0, s64, 65536
    buffer_load_dwordx4 v141, s[44:47], s69 offen lds
    s_add_u32 m0, s64, 66560
    buffer_load_dwordx4 v142, s[44:47], s69 offen lds
    s_add_u32 m0, s64, 67584
    buffer_load_dwordx4 v143, s[44:47], s69 offen lds
    ds_read_b128 v[84:87], v156 offset:33792
    ds_read_b128 v[92:95], v152 offset:41984
    ds_read_b128 v[96:99], v152 offset:46080
    ds_read_b128 v[100:103], v152 offset:50176
    ds_read_b128 v[104:107], v152 offset:54272
    ds_read_b128 v[108:111], v152 offset:58368
    v_mfma_f32_32x32x16_bf16 v[4:19], v[88:91], v[112:115], v[4:19]
    v_mfma_f32_32x32x16_bf16 v[20:35], v[88:91], v[116:119], v[20:35]
    v_mfma_f32_32x32x16_bf16 v[36:51], v[88:91], v[120:123], v[36:51]
    v_mfma_f32_32x32x16_bf16 v[52:67], v[88:91], v[124:127], v[52:67]
    v_mfma_f32_32x32x16_bf16 v[68:83], v[88:91], v[128:131], v[68:83]
    ds_read_b128 v[88:91], v157 offset:33792
    ds_read_b128 v[112:115], v153 offset:41984
    ds_read_b128 v[116:119], v153 offset:46080
    ds_read_b128 v[120:123], v153 offset:50176
    ds_read_b128 v[124:127], v153 offset:54272
    ds_read_b128 v[128:131], v153 offset:58368
    s_waitcnt lgkmcnt(6)
    v_mfma_f32_32x32x16_bf16 v[4:19], v[84:87], v[92:95], v[4:19]
    v_mfma_f32_32x32x16_bf16 v[20:35], v[84:87], v[96:99], v[20:35]
    v_mfma_f32_32x32x16_bf16 v[36:51], v[84:87], v[100:103], v[36:51]
    v_mfma_f32_32x32x16_bf16 v[52:67], v[84:87], v[104:107], v[52:67]
    v_mfma_f32_32x32x16_bf16 v[68:83], v[84:87], v[108:111], v[68:83]
    ds_read_b128 v[84:87], v158 offset:33792
    ds_read_b128 v[92:95], v154 offset:41984
    ds_read_b128 v[96:99], v154 offset:46080
    ds_read_b128 v[100:103], v154 offset:50176
    ds_read_b128 v[104:107], v154 offset:54272
    ds_read_b128 v[108:111], v154 offset:58368
    s_waitcnt lgkmcnt(6)
    v_mfma_f32_32x32x16_bf16 v[4:19], v[88:91], v[112:115], v[4:19]
    v_mfma_f32_32x32x16_bf16 v[20:35], v[88:91], v[116:119], v[20:35]
    v_mfma_f32_32x32x16_bf16 v[36:51], v[88:91], v[120:123], v[36:51]
    v_mfma_f32_32x32x16_bf16 v[52:67], v[88:91], v[124:127], v[52:67]
    v_mfma_f32_32x32x16_bf16 v[68:83], v[88:91], v[128:131], v[68:83]
    ds_read_b128 v[88:91], v159 offset:33792
    ds_read_b128 v[112:115], v155 offset:41984
    ds_read_b128 v[116:119], v155 offset:46080
    ds_read_b128 v[120:123], v155 offset:50176
    ds_read_b128 v[124:127], v155 offset:54272
    ds_read_b128 v[128:131], v155 offset:58368
    s_waitcnt lgkmcnt(6)
    v_mfma_f32_32x32x16_bf16 v[4:19], v[84:87], v[92:95], v[4:19]
    v_mfma_f32_32x32x16_bf16 v[20:35], v[84:87], v[96:99], v[20:35]
    v_mfma_f32_32x32x16_bf16 v[36:51], v[84:87], v[100:103], v[36:51]
    v_mfma_f32_32x32x16_bf16 v[52:67], v[84:87], v[104:107], v[52:67]
    v_mfma_f32_32x32x16_bf16 v[68:83], v[84:87], v[108:111], v[68:83]
    s_waitcnt vmcnt(12) lgkmcnt(0)
    s_barrier
    s_mov_b32 s69, 640
    s_add_u32 m0, s63, 99328
    buffer_load_dwordx4 v132, s[40:43], s69 offen lds
    s_add_u32 m0, s63, 100352
    buffer_load_dwordx4 v133, s[40:43], s69 offen lds
    s_add_u32 m0, s64, 107520
    buffer_load_dwordx4 v134, s[44:47], s69 offen lds
    s_add_u32 m0, s64, 108544
    buffer_load_dwordx4 v135, s[44:47], s69 offen lds
    s_add_u32 m0, s64, 109568
    buffer_load_dwordx4 v136, s[44:47], s69 offen lds
    s_add_u32 m0, s64, 110592
    buffer_load_dwordx4 v137, s[44:47], s69 offen lds
    s_add_u32 m0, s64, 111616
    buffer_load_dwordx4 v138, s[44:47], s69 offen lds
    s_add_u32 m0, s64, 112640
    buffer_load_dwordx4 v139, s[44:47], s69 offen lds
    s_add_u32 m0, s64, 113664
    buffer_load_dwordx4 v140, s[44:47], s69 offen lds
    s_add_u32 m0, s64, 114688
    buffer_load_dwordx4 v141, s[44:47], s69 offen lds
    s_add_u32 m0, s64, 115712
    buffer_load_dwordx4 v142, s[44:47], s69 offen lds
    s_add_u32 m0, s64, 116736
    buffer_load_dwordx4 v143, s[44:47], s69 offen lds
    ds_read_b128 v[84:87], v144 offset:1024
    ds_read_b128 v[92:95], v148 offset:9216
    ds_read_b128 v[96:99], v148 offset:13312
    ds_read_b128 v[100:103], v148 offset:17408
    ds_read_b128 v[104:107], v148 offset:21504
    ds_read_b128 v[108:111], v148 offset:25600
    v_mfma_f32_32x32x16_bf16 v[4:19], v[88:91], v[112:115], v[4:19]
    v_mfma_f32_32x32x16_bf16 v[20:35], v[88:91], v[116:119], v[20:35]
    v_mfma_f32_32x32x16_bf16 v[36:51], v[88:91], v[120:123], v[36:51]
    v_mfma_f32_32x32x16_bf16 v[52:67], v[88:91], v[124:127], v[52:67]
    v_mfma_f32_32x32x16_bf16 v[68:83], v[88:91], v[128:131], v[68:83]
    ds_read_b128 v[88:91], v145 offset:1024
    ds_read_b128 v[112:115], v149 offset:9216
    ds_read_b128 v[116:119], v149 offset:13312
    ds_read_b128 v[120:123], v149 offset:17408
    ds_read_b128 v[124:127], v149 offset:21504
    ds_read_b128 v[128:131], v149 offset:25600
    s_waitcnt lgkmcnt(6)
    v_mfma_f32_32x32x16_bf16 v[4:19], v[84:87], v[92:95], v[4:19]
    v_mfma_f32_32x32x16_bf16 v[20:35], v[84:87], v[96:99], v[20:35]
    v_mfma_f32_32x32x16_bf16 v[36:51], v[84:87], v[100:103], v[36:51]
    v_mfma_f32_32x32x16_bf16 v[52:67], v[84:87], v[104:107], v[52:67]
    v_mfma_f32_32x32x16_bf16 v[68:83], v[84:87], v[108:111], v[68:83]
    ds_read_b128 v[84:87], v146 offset:1024
    ds_read_b128 v[92:95], v150 offset:9216
    ds_read_b128 v[96:99], v150 offset:13312
    ds_read_b128 v[100:103], v150 offset:17408
    ds_read_b128 v[104:107], v150 offset:21504
    ds_read_b128 v[108:111], v150 offset:25600
    s_waitcnt lgkmcnt(6)
    v_mfma_f32_32x32x16_bf16 v[4:19], v[88:91], v[112:115], v[4:19]
    v_mfma_f32_32x32x16_bf16 v[20:35], v[88:91], v[116:119], v[20:35]
    v_mfma_f32_32x32x16_bf16 v[36:51], v[88:91], v[120:123], v[36:51]
    v_mfma_f32_32x32x16_bf16 v[52:67], v[88:91], v[124:127], v[52:67]
    v_mfma_f32_32x32x16_bf16 v[68:83], v[88:91], v[128:131], v[68:83]
    ds_read_b128 v[88:91], v147 offset:1024
    ds_read_b128 v[112:115], v151 offset:9216
    ds_read_b128 v[116:119], v151 offset:13312
    ds_read_b128 v[120:123], v151 offset:17408
    ds_read_b128 v[124:127], v151 offset:21504
    ds_read_b128 v[128:131], v151 offset:25600
    s_waitcnt lgkmcnt(6)
    v_mfma_f32_32x32x16_bf16 v[4:19], v[84:87], v[92:95], v[4:19]
    v_mfma_f32_32x32x16_bf16 v[20:35], v[84:87], v[96:99], v[20:35]
    v_mfma_f32_32x32x16_bf16 v[36:51], v[84:87], v[100:103], v[36:51]
    v_mfma_f32_32x32x16_bf16 v[52:67], v[84:87], v[104:107], v[52:67]
    v_mfma_f32_32x32x16_bf16 v[68:83], v[84:87], v[108:111], v[68:83]
    s_waitcnt vmcnt(12) lgkmcnt(0)
    s_barrier
    s_mov_b32 s69, 768
    s_add_u32 m0, s63, 1024
    buffer_load_dwordx4 v132, s[40:43], s69 offen lds
    s_add_u32 m0, s63, 2048
    buffer_load_dwordx4 v133, s[40:43], s69 offen lds
    s_add_u32 m0, s64, 9216
    buffer_load_dwordx4 v134, s[44:47], s69 offen lds
    s_add_u32 m0, s64, 10240
    buffer_load_dwordx4 v135, s[44:47], s69 offen lds
    s_add_u32 m0, s64, 11264
    buffer_load_dwordx4 v136, s[44:47], s69 offen lds
    s_add_u32 m0, s64, 12288
    buffer_load_dwordx4 v137, s[44:47], s69 offen lds
    s_add_u32 m0, s64, 13312
    buffer_load_dwordx4 v138, s[44:47], s69 offen lds
    s_add_u32 m0, s64, 14336
    buffer_load_dwordx4 v139, s[44:47], s69 offen lds
    s_add_u32 m0, s64, 15360
    buffer_load_dwordx4 v140, s[44:47], s69 offen lds
    s_add_u32 m0, s64, 16384
    buffer_load_dwordx4 v141, s[44:47], s69 offen lds
    s_add_u32 m0, s64, 17408
    buffer_load_dwordx4 v142, s[44:47], s69 offen lds
    s_add_u32 m0, s64, 18432
    buffer_load_dwordx4 v143, s[44:47], s69 offen lds
    ds_read_b128 v[84:87], v144 offset:50176
    ds_read_b128 v[92:95], v148 offset:58368
    ds_read_b128 v[96:99], v148 offset:62464
    ds_read_b128 v[100:103], v152 offset:1024
    ds_read_b128 v[104:107], v152 offset:5120
    ds_read_b128 v[108:111], v152 offset:9216
    v_mfma_f32_32x32x16_bf16 v[4:19], v[88:91], v[112:115], v[4:19]
    v_mfma_f32_32x32x16_bf16 v[20:35], v[88:91], v[116:119], v[20:35]
    v_mfma_f32_32x32x16_bf16 v[36:51], v[88:91], v[120:123], v[36:51]
    v_mfma_f32_32x32x16_bf16 v[52:67], v[88:91], v[124:127], v[52:67]
    v_mfma_f32_32x32x16_bf16 v[68:83], v[88:91], v[128:131], v[68:83]
    ds_read_b128 v[88:91], v145 offset:50176
    ds_read_b128 v[112:115], v149 offset:58368
    ds_read_b128 v[116:119], v149 offset:62464
    ds_read_b128 v[120:123], v153 offset:1024
    ds_read_b128 v[124:127], v153 offset:5120
    ds_read_b128 v[128:131], v153 offset:9216
    s_waitcnt lgkmcnt(6)
    v_mfma_f32_32x32x16_bf16 v[4:19], v[84:87], v[92:95], v[4:19]
    v_mfma_f32_32x32x16_bf16 v[20:35], v[84:87], v[96:99], v[20:35]
    v_mfma_f32_32x32x16_bf16 v[36:51], v[84:87], v[100:103], v[36:51]
    v_mfma_f32_32x32x16_bf16 v[52:67], v[84:87], v[104:107], v[52:67]
    v_mfma_f32_32x32x16_bf16 v[68:83], v[84:87], v[108:111], v[68:83]
    ds_read_b128 v[84:87], v146 offset:50176
    ds_read_b128 v[92:95], v150 offset:58368
    ds_read_b128 v[96:99], v150 offset:62464
    ds_read_b128 v[100:103], v154 offset:1024
    ds_read_b128 v[104:107], v154 offset:5120
    ds_read_b128 v[108:111], v154 offset:9216
    s_waitcnt lgkmcnt(6)
    v_mfma_f32_32x32x16_bf16 v[4:19], v[88:91], v[112:115], v[4:19]
    v_mfma_f32_32x32x16_bf16 v[20:35], v[88:91], v[116:119], v[20:35]
    v_mfma_f32_32x32x16_bf16 v[36:51], v[88:91], v[120:123], v[36:51]
    v_mfma_f32_32x32x16_bf16 v[52:67], v[88:91], v[124:127], v[52:67]
    v_mfma_f32_32x32x16_bf16 v[68:83], v[88:91], v[128:131], v[68:83]
    ds_read_b128 v[88:91], v147 offset:50176
    ds_read_b128 v[112:115], v151 offset:58368
    ds_read_b128 v[116:119], v151 offset:62464
    ds_read_b128 v[120:123], v155 offset:1024
    ds_read_b128 v[124:127], v155 offset:5120
    ds_read_b128 v[128:131], v155 offset:9216
    s_waitcnt lgkmcnt(6)
    v_mfma_f32_32x32x16_bf16 v[4:19], v[84:87], v[92:95], v[4:19]
    v_mfma_f32_32x32x16_bf16 v[20:35], v[84:87], v[96:99], v[20:35]
    v_mfma_f32_32x32x16_bf16 v[36:51], v[84:87], v[100:103], v[36:51]
    v_mfma_f32_32x32x16_bf16 v[52:67], v[84:87], v[104:107], v[52:67]
    v_mfma_f32_32x32x16_bf16 v[68:83], v[84:87], v[108:111], v[68:83]
    s_waitcnt vmcnt(12) lgkmcnt(0)
    s_barrier
    s_mov_b32 s69, 896
    s_add_u32 m0, s63, 50176
    buffer_load_dwordx4 v132, s[40:43], s69 offen lds
    s_add_u32 m0, s63, 51200
    buffer_load_dwordx4 v133, s[40:43], s69 offen lds
    s_add_u32 m0, s64, 58368
    buffer_load_dwordx4 v134, s[44:47], s69 offen lds
    s_add_u32 m0, s64, 59392
    buffer_load_dwordx4 v135, s[44:47], s69 offen lds
    s_add_u32 m0, s64, 60416
    buffer_load_dwordx4 v136, s[44:47], s69 offen lds
    s_add_u32 m0, s64, 61440
    buffer_load_dwordx4 v137, s[44:47], s69 offen lds
    s_add_u32 m0, s64, 62464
    buffer_load_dwordx4 v138, s[44:47], s69 offen lds
    s_add_u32 m0, s64, 63488
    buffer_load_dwordx4 v139, s[44:47], s69 offen lds
    s_add_u32 m0, s64, 64512
    buffer_load_dwordx4 v140, s[44:47], s69 offen lds
    s_add_u32 m0, s64, 65536
    buffer_load_dwordx4 v141, s[44:47], s69 offen lds
    s_add_u32 m0, s64, 66560
    buffer_load_dwordx4 v142, s[44:47], s69 offen lds
    s_add_u32 m0, s64, 67584
    buffer_load_dwordx4 v143, s[44:47], s69 offen lds
    ds_read_b128 v[84:87], v156 offset:33792
    ds_read_b128 v[92:95], v152 offset:41984
    ds_read_b128 v[96:99], v152 offset:46080
    ds_read_b128 v[100:103], v152 offset:50176
    ds_read_b128 v[104:107], v152 offset:54272
    ds_read_b128 v[108:111], v152 offset:58368
    v_mfma_f32_32x32x16_bf16 v[4:19], v[88:91], v[112:115], v[4:19]
    v_mfma_f32_32x32x16_bf16 v[20:35], v[88:91], v[116:119], v[20:35]
    v_mfma_f32_32x32x16_bf16 v[36:51], v[88:91], v[120:123], v[36:51]
    v_mfma_f32_32x32x16_bf16 v[52:67], v[88:91], v[124:127], v[52:67]
    v_mfma_f32_32x32x16_bf16 v[68:83], v[88:91], v[128:131], v[68:83]
    ds_read_b128 v[88:91], v157 offset:33792
    ds_read_b128 v[112:115], v153 offset:41984
    ds_read_b128 v[116:119], v153 offset:46080
    ds_read_b128 v[120:123], v153 offset:50176
    ds_read_b128 v[124:127], v153 offset:54272
    ds_read_b128 v[128:131], v153 offset:58368
    s_waitcnt lgkmcnt(6)
    v_mfma_f32_32x32x16_bf16 v[4:19], v[84:87], v[92:95], v[4:19]
    v_mfma_f32_32x32x16_bf16 v[20:35], v[84:87], v[96:99], v[20:35]
    v_mfma_f32_32x32x16_bf16 v[36:51], v[84:87], v[100:103], v[36:51]
    v_mfma_f32_32x32x16_bf16 v[52:67], v[84:87], v[104:107], v[52:67]
    v_mfma_f32_32x32x16_bf16 v[68:83], v[84:87], v[108:111], v[68:83]
    ds_read_b128 v[84:87], v158 offset:33792
    ds_read_b128 v[92:95], v154 offset:41984
    ds_read_b128 v[96:99], v154 offset:46080
    ds_read_b128 v[100:103], v154 offset:50176
    ds_read_b128 v[104:107], v154 offset:54272
    ds_read_b128 v[108:111], v154 offset:58368
    s_waitcnt lgkmcnt(6)
    v_mfma_f32_32x32x16_bf16 v[4:19], v[88:91], v[112:115], v[4:19]
    v_mfma_f32_32x32x16_bf16 v[20:35], v[88:91], v[116:119], v[20:35]
    v_mfma_f32_32x32x16_bf16 v[36:51], v[88:91], v[120:123], v[36:51]
    v_mfma_f32_32x32x16_bf16 v[52:67], v[88:91], v[124:127], v[52:67]
    v_mfma_f32_32x32x16_bf16 v[68:83], v[88:91], v[128:131], v[68:83]
    ds_read_b128 v[88:91], v159 offset:33792
    ds_read_b128 v[112:115], v155 offset:41984
    ds_read_b128 v[116:119], v155 offset:46080
    ds_read_b128 v[120:123], v155 offset:50176
    ds_read_b128 v[124:127], v155 offset:54272
    ds_read_b128 v[128:131], v155 offset:58368
    s_waitcnt lgkmcnt(6)
    v_mfma_f32_32x32x16_bf16 v[4:19], v[84:87], v[92:95], v[4:19]
    v_mfma_f32_32x32x16_bf16 v[20:35], v[84:87], v[96:99], v[20:35]
    v_mfma_f32_32x32x16_bf16 v[36:51], v[84:87], v[100:103], v[36:51]
    v_mfma_f32_32x32x16_bf16 v[52:67], v[84:87], v[104:107], v[52:67]
    v_mfma_f32_32x32x16_bf16 v[68:83], v[84:87], v[108:111], v[68:83]
    s_waitcnt vmcnt(12) lgkmcnt(0)
    s_barrier
    s_mov_b32 s69, 1024
    s_add_u32 m0, s63, 99328
    buffer_load_dwordx4 v132, s[40:43], s69 offen lds
    s_add_u32 m0, s63, 100352
    buffer_load_dwordx4 v133, s[40:43], s69 offen lds
    s_add_u32 m0, s64, 107520
    buffer_load_dwordx4 v134, s[44:47], s69 offen lds
    s_add_u32 m0, s64, 108544
    buffer_load_dwordx4 v135, s[44:47], s69 offen lds
    s_add_u32 m0, s64, 109568
    buffer_load_dwordx4 v136, s[44:47], s69 offen lds
    s_add_u32 m0, s64, 110592
    buffer_load_dwordx4 v137, s[44:47], s69 offen lds
    s_add_u32 m0, s64, 111616
    buffer_load_dwordx4 v138, s[44:47], s69 offen lds
    s_add_u32 m0, s64, 112640
    buffer_load_dwordx4 v139, s[44:47], s69 offen lds
    s_add_u32 m0, s64, 113664
    buffer_load_dwordx4 v140, s[44:47], s69 offen lds
    s_add_u32 m0, s64, 114688
    buffer_load_dwordx4 v141, s[44:47], s69 offen lds
    s_add_u32 m0, s64, 115712
    buffer_load_dwordx4 v142, s[44:47], s69 offen lds
    s_add_u32 m0, s64, 116736
    buffer_load_dwordx4 v143, s[44:47], s69 offen lds
    ds_read_b128 v[84:87], v144 offset:1024
    ds_read_b128 v[92:95], v148 offset:9216
    ds_read_b128 v[96:99], v148 offset:13312
    ds_read_b128 v[100:103], v148 offset:17408
    ds_read_b128 v[104:107], v148 offset:21504
    ds_read_b128 v[108:111], v148 offset:25600
    v_mfma_f32_32x32x16_bf16 v[4:19], v[88:91], v[112:115], v[4:19]
    v_mfma_f32_32x32x16_bf16 v[20:35], v[88:91], v[116:119], v[20:35]
    v_mfma_f32_32x32x16_bf16 v[36:51], v[88:91], v[120:123], v[36:51]
    v_mfma_f32_32x32x16_bf16 v[52:67], v[88:91], v[124:127], v[52:67]
    v_mfma_f32_32x32x16_bf16 v[68:83], v[88:91], v[128:131], v[68:83]
    ds_read_b128 v[88:91], v145 offset:1024
    ds_read_b128 v[112:115], v149 offset:9216
    ds_read_b128 v[116:119], v149 offset:13312
    ds_read_b128 v[120:123], v149 offset:17408
    ds_read_b128 v[124:127], v149 offset:21504
    ds_read_b128 v[128:131], v149 offset:25600
    s_waitcnt lgkmcnt(6)
    v_mfma_f32_32x32x16_bf16 v[4:19], v[84:87], v[92:95], v[4:19]
    v_mfma_f32_32x32x16_bf16 v[20:35], v[84:87], v[96:99], v[20:35]
    v_mfma_f32_32x32x16_bf16 v[36:51], v[84:87], v[100:103], v[36:51]
    v_mfma_f32_32x32x16_bf16 v[52:67], v[84:87], v[104:107], v[52:67]
    v_mfma_f32_32x32x16_bf16 v[68:83], v[84:87], v[108:111], v[68:83]
    ds_read_b128 v[84:87], v146 offset:1024
    ds_read_b128 v[92:95], v150 offset:9216
    ds_read_b128 v[96:99], v150 offset:13312
    ds_read_b128 v[100:103], v150 offset:17408
    ds_read_b128 v[104:107], v150 offset:21504
    ds_read_b128 v[108:111], v150 offset:25600
    s_waitcnt lgkmcnt(6)
    v_mfma_f32_32x32x16_bf16 v[4:19], v[88:91], v[112:115], v[4:19]
    v_mfma_f32_32x32x16_bf16 v[20:35], v[88:91], v[116:119], v[20:35]
    v_mfma_f32_32x32x16_bf16 v[36:51], v[88:91], v[120:123], v[36:51]
    v_mfma_f32_32x32x16_bf16 v[52:67], v[88:91], v[124:127], v[52:67]
    v_mfma_f32_32x32x16_bf16 v[68:83], v[88:91], v[128:131], v[68:83]
    ds_read_b128 v[88:91], v147 offset:1024
    ds_read_b128 v[112:115], v151 offset:9216
    ds_read_b128 v[116:119], v151 offset:13312
    ds_read_b128 v[120:123], v151 offset:17408
    ds_read_b128 v[124:127], v151 offset:21504
    ds_read_b128 v[128:131], v151 offset:25600
    s_waitcnt lgkmcnt(6)
    v_mfma_f32_32x32x16_bf16 v[4:19], v[84:87], v[92:95], v[4:19]
    v_mfma_f32_32x32x16_bf16 v[20:35], v[84:87], v[96:99], v[20:35]
    v_mfma_f32_32x32x16_bf16 v[36:51], v[84:87], v[100:103], v[36:51]
    v_mfma_f32_32x32x16_bf16 v[52:67], v[84:87], v[104:107], v[52:67]
    v_mfma_f32_32x32x16_bf16 v[68:83], v[84:87], v[108:111], v[68:83]
    s_waitcnt vmcnt(12) lgkmcnt(0)
    s_barrier
    s_mov_b32 s69, 1152
    s_add_u32 m0, s63, 1024
    buffer_load_dwordx4 v132, s[40:43], s69 offen lds
    s_add_u32 m0, s63, 2048
    buffer_load_dwordx4 v133, s[40:43], s69 offen lds
    s_add_u32 m0, s64, 9216
    buffer_load_dwordx4 v134, s[44:47], s69 offen lds
    s_add_u32 m0, s64, 10240
    buffer_load_dwordx4 v135, s[44:47], s69 offen lds
    s_add_u32 m0, s64, 11264
    buffer_load_dwordx4 v136, s[44:47], s69 offen lds
    s_add_u32 m0, s64, 12288
    buffer_load_dwordx4 v137, s[44:47], s69 offen lds
    s_add_u32 m0, s64, 13312
    buffer_load_dwordx4 v138, s[44:47], s69 offen lds
    s_add_u32 m0, s64, 14336
    buffer_load_dwordx4 v139, s[44:47], s69 offen lds
    s_add_u32 m0, s64, 15360
    buffer_load_dwordx4 v140, s[44:47], s69 offen lds
    s_add_u32 m0, s64, 16384
    buffer_load_dwordx4 v141, s[44:47], s69 offen lds
    s_add_u32 m0, s64, 17408
    buffer_load_dwordx4 v142, s[44:47], s69 offen lds
    s_add_u32 m0, s64, 18432
    buffer_load_dwordx4 v143, s[44:47], s69 offen lds
    ds_read_b128 v[84:87], v144 offset:50176
    ds_read_b128 v[92:95], v148 offset:58368
    ds_read_b128 v[96:99], v148 offset:62464
    ds_read_b128 v[100:103], v152 offset:1024
    ds_read_b128 v[104:107], v152 offset:5120
    ds_read_b128 v[108:111], v152 offset:9216
    v_mfma_f32_32x32x16_bf16 v[4:19], v[88:91], v[112:115], v[4:19]
    v_mfma_f32_32x32x16_bf16 v[20:35], v[88:91], v[116:119], v[20:35]
    v_mfma_f32_32x32x16_bf16 v[36:51], v[88:91], v[120:123], v[36:51]
    v_mfma_f32_32x32x16_bf16 v[52:67], v[88:91], v[124:127], v[52:67]
    v_mfma_f32_32x32x16_bf16 v[68:83], v[88:91], v[128:131], v[68:83]
    ds_read_b128 v[88:91], v145 offset:50176
    ds_read_b128 v[112:115], v149 offset:58368
    ds_read_b128 v[116:119], v149 offset:62464
    ds_read_b128 v[120:123], v153 offset:1024
    ds_read_b128 v[124:127], v153 offset:5120
    ds_read_b128 v[128:131], v153 offset:9216
    s_waitcnt lgkmcnt(6)
    v_mfma_f32_32x32x16_bf16 v[4:19], v[84:87], v[92:95], v[4:19]
    v_mfma_f32_32x32x16_bf16 v[20:35], v[84:87], v[96:99], v[20:35]
    v_mfma_f32_32x32x16_bf16 v[36:51], v[84:87], v[100:103], v[36:51]
    v_mfma_f32_32x32x16_bf16 v[52:67], v[84:87], v[104:107], v[52:67]
    v_mfma_f32_32x32x16_bf16 v[68:83], v[84:87], v[108:111], v[68:83]
    ds_read_b128 v[84:87], v146 offset:50176
    ds_read_b128 v[92:95], v150 offset:58368
    ds_read_b128 v[96:99], v150 offset:62464
    ds_read_b128 v[100:103], v154 offset:1024
    ds_read_b128 v[104:107], v154 offset:5120
    ds_read_b128 v[108:111], v154 offset:9216
    s_waitcnt lgkmcnt(6)
    v_mfma_f32_32x32x16_bf16 v[4:19], v[88:91], v[112:115], v[4:19]
    v_mfma_f32_32x32x16_bf16 v[20:35], v[88:91], v[116:119], v[20:35]
    v_mfma_f32_32x32x16_bf16 v[36:51], v[88:91], v[120:123], v[36:51]
    v_mfma_f32_32x32x16_bf16 v[52:67], v[88:91], v[124:127], v[52:67]
    v_mfma_f32_32x32x16_bf16 v[68:83], v[88:91], v[128:131], v[68:83]
    ds_read_b128 v[88:91], v147 offset:50176
    ds_read_b128 v[112:115], v151 offset:58368
    ds_read_b128 v[116:119], v151 offset:62464
    ds_read_b128 v[120:123], v155 offset:1024
    ds_read_b128 v[124:127], v155 offset:5120
    ds_read_b128 v[128:131], v155 offset:9216
    s_waitcnt lgkmcnt(6)
    v_mfma_f32_32x32x16_bf16 v[4:19], v[84:87], v[92:95], v[4:19]
    v_mfma_f32_32x32x16_bf16 v[20:35], v[84:87], v[96:99], v[20:35]
    v_mfma_f32_32x32x16_bf16 v[36:51], v[84:87], v[100:103], v[36:51]
    v_mfma_f32_32x32x16_bf16 v[52:67], v[84:87], v[104:107], v[52:67]
    v_mfma_f32_32x32x16_bf16 v[68:83], v[84:87], v[108:111], v[68:83]
    s_waitcnt vmcnt(12) lgkmcnt(0)
    s_barrier
    ds_read_b128 v[84:87], v156 offset:33792
    ds_read_b128 v[92:95], v152 offset:41984
    ds_read_b128 v[96:99], v152 offset:46080
    ds_read_b128 v[100:103], v152 offset:50176
    ds_read_b128 v[104:107], v152 offset:54272
    ds_read_b128 v[108:111], v152 offset:58368
    v_mfma_f32_32x32x16_bf16 v[4:19], v[88:91], v[112:115], v[4:19]
    v_mfma_f32_32x32x16_bf16 v[20:35], v[88:91], v[116:119], v[20:35]
    v_mfma_f32_32x32x16_bf16 v[36:51], v[88:91], v[120:123], v[36:51]
    v_mfma_f32_32x32x16_bf16 v[52:67], v[88:91], v[124:127], v[52:67]
    v_mfma_f32_32x32x16_bf16 v[68:83], v[88:91], v[128:131], v[68:83]
    ds_read_b128 v[88:91], v157 offset:33792
    ds_read_b128 v[112:115], v153 offset:41984
    ds_read_b128 v[116:119], v153 offset:46080
    ds_read_b128 v[120:123], v153 offset:50176
    ds_read_b128 v[124:127], v153 offset:54272
    ds_read_b128 v[128:131], v153 offset:58368
    s_waitcnt lgkmcnt(6)
    v_mfma_f32_32x32x16_bf16 v[4:19], v[84:87], v[92:95], v[4:19]
    v_mfma_f32_32x32x16_bf16 v[20:35], v[84:87], v[96:99], v[20:35]
    v_mfma_f32_32x32x16_bf16 v[36:51], v[84:87], v[100:103], v[36:51]
    v_mfma_f32_32x32x16_bf16 v[52:67], v[84:87], v[104:107], v[52:67]
    v_mfma_f32_32x32x16_bf16 v[68:83], v[84:87], v[108:111], v[68:83]
    ds_read_b128 v[84:87], v158 offset:33792
    ds_read_b128 v[92:95], v154 offset:41984
    ds_read_b128 v[96:99], v154 offset:46080
    ds_read_b128 v[100:103], v154 offset:50176
    ds_read_b128 v[104:107], v154 offset:54272
    ds_read_b128 v[108:111], v154 offset:58368
    s_waitcnt lgkmcnt(6)
    v_mfma_f32_32x32x16_bf16 v[4:19], v[88:91], v[112:115], v[4:19]
    v_mfma_f32_32x32x16_bf16 v[20:35], v[88:91], v[116:119], v[20:35]
    v_mfma_f32_32x32x16_bf16 v[36:51], v[88:91], v[120:123], v[36:51]
    v_mfma_f32_32x32x16_bf16 v[52:67], v[88:91], v[124:127], v[52:67]
    v_mfma_f32_32x32x16_bf16 v[68:83], v[88:91], v[128:131], v[68:83]
    ds_read_b128 v[88:91], v159 offset:33792
    ds_read_b128 v[112:115], v155 offset:41984
    ds_read_b128 v[116:119], v155 offset:46080
    ds_read_b128 v[120:123], v155 offset:50176
    ds_read_b128 v[124:127], v155 offset:54272
    ds_read_b128 v[128:131], v155 offset:58368
    s_waitcnt lgkmcnt(6)
    v_mfma_f32_32x32x16_bf16 v[4:19], v[84:87], v[92:95], v[4:19]
    v_mfma_f32_32x32x16_bf16 v[20:35], v[84:87], v[96:99], v[20:35]
    v_mfma_f32_32x32x16_bf16 v[36:51], v[84:87], v[100:103], v[36:51]
    v_mfma_f32_32x32x16_bf16 v[52:67], v[84:87], v[104:107], v[52:67]
    v_mfma_f32_32x32x16_bf16 v[68:83], v[84:87], v[108:111], v[68:83]
    s_waitcnt vmcnt(0) lgkmcnt(0)
    s_barrier
    ds_read_b128 v[84:87], v144 offset:1024
    ds_read_b128 v[92:95], v148 offset:9216
    ds_read_b128 v[96:99], v148 offset:13312
    ds_read_b128 v[100:103], v148 offset:17408
    ds_read_b128 v[104:107], v148 offset:21504
    ds_read_b128 v[108:111], v148 offset:25600
    v_mfma_f32_32x32x16_bf16 v[4:19], v[88:91], v[112:115], v[4:19]
    v_mfma_f32_32x32x16_bf16 v[20:35], v[88:91], v[116:119], v[20:35]
    v_mfma_f32_32x32x16_bf16 v[36:51], v[88:91], v[120:123], v[36:51]
    v_mfma_f32_32x32x16_bf16 v[52:67], v[88:91], v[124:127], v[52:67]
    v_mfma_f32_32x32x16_bf16 v[68:83], v[88:91], v[128:131], v[68:83]
    ds_read_b128 v[88:91], v145 offset:1024
    ds_read_b128 v[112:115], v149 offset:9216
    ds_read_b128 v[116:119], v149 offset:13312
    ds_read_b128 v[120:123], v149 offset:17408
    ds_read_b128 v[124:127], v149 offset:21504
    ds_read_b128 v[128:131], v149 offset:25600
    s_waitcnt lgkmcnt(6)
    v_mfma_f32_32x32x16_bf16 v[4:19], v[84:87], v[92:95], v[4:19]
    v_mfma_f32_32x32x16_bf16 v[20:35], v[84:87], v[96:99], v[20:35]
    v_mfma_f32_32x32x16_bf16 v[36:51], v[84:87], v[100:103], v[36:51]
    v_mfma_f32_32x32x16_bf16 v[52:67], v[84:87], v[104:107], v[52:67]
    v_mfma_f32_32x32x16_bf16 v[68:83], v[84:87], v[108:111], v[68:83]
    ds_read_b128 v[84:87], v146 offset:1024
    ds_read_b128 v[92:95], v150 offset:9216
    ds_read_b128 v[96:99], v150 offset:13312
    ds_read_b128 v[100:103], v150 offset:17408
    ds_read_b128 v[104:107], v150 offset:21504
    ds_read_b128 v[108:111], v150 offset:25600
    s_waitcnt lgkmcnt(6)
    v_mfma_f32_32x32x16_bf16 v[4:19], v[88:91], v[112:115], v[4:19]
    v_mfma_f32_32x32x16_bf16 v[20:35], v[88:91], v[116:119], v[20:35]
    v_mfma_f32_32x32x16_bf16 v[36:51], v[88:91], v[120:123], v[36:51]
    v_mfma_f32_32x32x16_bf16 v[52:67], v[88:91], v[124:127], v[52:67]
    v_mfma_f32_32x32x16_bf16 v[68:83], v[88:91], v[128:131], v[68:83]
    ds_read_b128 v[88:91], v147 offset:1024
    ds_read_b128 v[112:115], v151 offset:9216
    ds_read_b128 v[116:119], v151 offset:13312
    ds_read_b128 v[120:123], v151 offset:17408
    ds_read_b128 v[124:127], v151 offset:21504
    ds_read_b128 v[128:131], v151 offset:25600
    s_waitcnt lgkmcnt(6)
    v_mfma_f32_32x32x16_bf16 v[4:19], v[84:87], v[92:95], v[4:19]
    v_mfma_f32_32x32x16_bf16 v[20:35], v[84:87], v[96:99], v[20:35]
    v_mfma_f32_32x32x16_bf16 v[36:51], v[84:87], v[100:103], v[36:51]
    v_mfma_f32_32x32x16_bf16 v[52:67], v[84:87], v[104:107], v[52:67]
    v_mfma_f32_32x32x16_bf16 v[68:83], v[84:87], v[108:111], v[68:83]
    s_waitcnt lgkmcnt(0)
    v_mfma_f32_32x32x16_bf16 v[4:19], v[88:91], v[112:115], v[4:19]
    v_mfma_f32_32x32x16_bf16 v[20:35], v[88:91], v[116:119], v[20:35]
    v_mfma_f32_32x32x16_bf16 v[36:51], v[88:91], v[120:123], v[36:51]
    v_mfma_f32_32x32x16_bf16 v[52:67], v[88:91], v[124:127], v[52:67]
    v_mfma_f32_32x32x16_bf16 v[68:83], v[88:91], v[128:131], v[68:83]
    s_nop 7
    s_nop 7
    s_waitcnt vmcnt(0)
    v_lshrrev_b32 v168, 5, v160
    v_lshlrev_b32 v168, 5, v168
    s_lshl_b32 s65, s67, 8
    v_add_u32 v168, s65, v168
    ds_read_b128 v[172:175], v168 offset:0
    ds_read_b128 v[176:179], v168 offset:16
    ds_read_b128 v[180:183], v168 offset:64
    ds_read_b128 v[184:187], v168 offset:80
    ds_read_b128 v[188:191], v168 offset:128
    ds_read_b128 v[192:195], v168 offset:144
    ds_read_b128 v[196:199], v168 offset:192
    ds_read_b128 v[200:203], v168 offset:208
    s_waitcnt lgkmcnt(0)
    s_barrier
    v_lshlrev_b32 v228, 4, v160
    s_mul_i32 s87, s60, 10240
    v_add_u32 v228, s87, v228
    s_cmp_ge_u32 s68, 1
    s_cbranch_scc1 .kv_v_2
    v_mov_b32 v212, 0
    v_fma_f32 v4, -v172, v163, v4
    v_mul_f32 v4, v4, v173
    v_fma_f32 v5, -v174, v163, v5
    v_mul_f32 v5, v5, v175
    v_fma_f32 v6, -v176, v163, v6
    v_mul_f32 v6, v6, v177
    v_fma_f32 v7, -v178, v163, v7
    v_mul_f32 v7, v7, v179
    v_cvt_pk_bf16_f32 v204, v4, v5
    v_lshlrev_b32 v4, 16, v204
    v_and_b32 v5, 0xffff0000, v204
    v_cvt_pk_bf16_f32 v205, v6, v7
    v_lshlrev_b32 v6, 16, v205
    v_and_b32 v7, 0xffff0000, v205
    v_mul_f32 v208, 0x3fb8aa3b, v4
    v_exp_f32 v208, v208
    v_cmp_lt_f32 vcc, 0, v4
    v_add_f32 v4, 1.0, v4
    v_cndmask_b32 v4, v208, v4, vcc
    v_mul_f32 v209, 0x3fb8aa3b, v5
    v_exp_f32 v209, v209
    v_cmp_lt_f32 vcc, 0, v5
    v_add_f32 v5, 1.0, v5
    v_cndmask_b32 v5, v209, v5, vcc
    v_mul_f32 v210, 0x3fb8aa3b, v6
    v_exp_f32 v210, v210
    v_cmp_lt_f32 vcc, 0, v6
    v_add_f32 v6, 1.0, v6
    v_cndmask_b32 v6, v210, v6, vcc
    v_mul_f32 v211, 0x3fb8aa3b, v7
    v_exp_f32 v211, v211
    v_cmp_lt_f32 vcc, 0, v7
    v_add_f32 v7, 1.0, v7
    v_cndmask_b32 v7, v211, v7, vcc
    v_cvt_pk_bf16_f32 v204, v4, v5
    v_lshlrev_b32 v4, 16, v204
    v_and_b32 v5, 0xffff0000, v204
    v_cvt_pk_bf16_f32 v205, v6, v7
    v_lshlrev_b32 v6, 16, v205
    v_and_b32 v7, 0xffff0000, v205
    v_add_f32 v4, 0x358637bd, v4
    v_add_f32 v5, 0x358637bd, v5
    v_add_f32 v6, 0x358637bd, v6
    v_add_f32 v7, 0x358637bd, v7
    v_cvt_pk_bf16_f32 v204, v4, v5
    v_lshlrev_b32 v4, 16, v204
    v_and_b32 v5, 0xffff0000, v204
    v_cvt_pk_bf16_f32 v205, v6, v7
    v_lshlrev_b32 v6, 16, v205
    v_and_b32 v7, 0xffff0000, v205
    v_add_f32 v212, v212, v4
    v_add_f32 v212, v212, v5
    v_add_f32 v212, v212, v6
    v_add_f32 v212, v212, v7
    v_cvt_pk_bf16_f32 v220, v4, v5
    v_cvt_pk_bf16_f32 v221, v6, v7
    v_fma_f32 v8, -v180, v163, v8
    v_mul_f32 v8, v8, v181
    v_fma_f32 v9, -v182, v163, v9
    v_mul_f32 v9, v9, v183
    v_fma_f32 v10, -v184, v163, v10
    v_mul_f32 v10, v10, v185
    v_fma_f32 v11, -v186, v163, v11
    v_mul_f32 v11, v11, v187
    v_cvt_pk_bf16_f32 v204, v8, v9
    v_lshlrev_b32 v8, 16, v204
    v_and_b32 v9, 0xffff0000, v204
    v_cvt_pk_bf16_f32 v205, v10, v11
    v_lshlrev_b32 v10, 16, v205
    v_and_b32 v11, 0xffff0000, v205
    v_mul_f32 v208, 0x3fb8aa3b, v8
    v_exp_f32 v208, v208
    v_cmp_lt_f32 vcc, 0, v8
    v_add_f32 v8, 1.0, v8
    v_cndmask_b32 v8, v208, v8, vcc
    v_mul_f32 v209, 0x3fb8aa3b, v9
    v_exp_f32 v209, v209
    v_cmp_lt_f32 vcc, 0, v9
    v_add_f32 v9, 1.0, v9
    v_cndmask_b32 v9, v209, v9, vcc
    v_mul_f32 v210, 0x3fb8aa3b, v10
    v_exp_f32 v210, v210
    v_cmp_lt_f32 vcc, 0, v10
    v_add_f32 v10, 1.0, v10
    v_cndmask_b32 v10, v210, v10, vcc
    v_mul_f32 v211, 0x3fb8aa3b, v11
    v_exp_f32 v211, v211
    v_cmp_lt_f32 vcc, 0, v11
    v_add_f32 v11, 1.0, v11
    v_cndmask_b32 v11, v211, v11, vcc
    v_cvt_pk_bf16_f32 v204, v8, v9
    v_lshlrev_b32 v8, 16, v204
    v_and_b32 v9, 0xffff0000, v204
    v_cvt_pk_bf16_f32 v205, v10, v11
    v_lshlrev_b32 v10, 16, v205
    v_and_b32 v11, 0xffff0000, v205
    v_add_f32 v8, 0x358637bd, v8
    v_add_f32 v9, 0x358637bd, v9
    v_add_f32 v10, 0x358637bd, v10
    v_add_f32 v11, 0x358637bd, v11
    v_cvt_pk_bf16_f32 v204, v8, v9
    v_lshlrev_b32 v8, 16, v204
    v_and_b32 v9, 0xffff0000, v204
    v_cvt_pk_bf16_f32 v205, v10, v11
    v_lshlrev_b32 v10, 16, v205
    v_and_b32 v11, 0xffff0000, v205
    v_add_f32 v212, v212, v8
    v_add_f32 v212, v212, v9
    v_add_f32 v212, v212, v10
    v_add_f32 v212, v212, v11
    v_cvt_pk_bf16_f32 v222, v8, v9
    v_cvt_pk_bf16_f32 v223, v10, v11
    v_fma_f32 v12, -v188, v163, v12
    v_mul_f32 v12, v12, v189
    v_fma_f32 v13, -v190, v163, v13
    v_mul_f32 v13, v13, v191
    v_fma_f32 v14, -v192, v163, v14
    v_mul_f32 v14, v14, v193
    v_fma_f32 v15, -v194, v163, v15
    v_mul_f32 v15, v15, v195
    v_cvt_pk_bf16_f32 v204, v12, v13
    v_lshlrev_b32 v12, 16, v204
    v_and_b32 v13, 0xffff0000, v204
    v_cvt_pk_bf16_f32 v205, v14, v15
    v_lshlrev_b32 v14, 16, v205
    v_and_b32 v15, 0xffff0000, v205
    v_mul_f32 v208, 0x3fb8aa3b, v12
    v_exp_f32 v208, v208
    v_cmp_lt_f32 vcc, 0, v12
    v_add_f32 v12, 1.0, v12
    v_cndmask_b32 v12, v208, v12, vcc
    v_mul_f32 v209, 0x3fb8aa3b, v13
    v_exp_f32 v209, v209
    v_cmp_lt_f32 vcc, 0, v13
    v_add_f32 v13, 1.0, v13
    v_cndmask_b32 v13, v209, v13, vcc
    v_mul_f32 v210, 0x3fb8aa3b, v14
    v_exp_f32 v210, v210
    v_cmp_lt_f32 vcc, 0, v14
    v_add_f32 v14, 1.0, v14
    v_cndmask_b32 v14, v210, v14, vcc
    v_mul_f32 v211, 0x3fb8aa3b, v15
    v_exp_f32 v211, v211
    v_cmp_lt_f32 vcc, 0, v15
    v_add_f32 v15, 1.0, v15
    v_cndmask_b32 v15, v211, v15, vcc
    v_cvt_pk_bf16_f32 v204, v12, v13
    v_lshlrev_b32 v12, 16, v204
    v_and_b32 v13, 0xffff0000, v204
    v_cvt_pk_bf16_f32 v205, v14, v15
    v_lshlrev_b32 v14, 16, v205
    v_and_b32 v15, 0xffff0000, v205
    v_add_f32 v12, 0x358637bd, v12
    v_add_f32 v13, 0x358637bd, v13
    v_add_f32 v14, 0x358637bd, v14
    v_add_f32 v15, 0x358637bd, v15
    v_cvt_pk_bf16_f32 v204, v12, v13
    v_lshlrev_b32 v12, 16, v204
    v_and_b32 v13, 0xffff0000, v204
    v_cvt_pk_bf16_f32 v205, v14, v15
    v_lshlrev_b32 v14, 16, v205
    v_and_b32 v15, 0xffff0000, v205
    v_add_f32 v212, v212, v12
    v_add_f32 v212, v212, v13
    v_add_f32 v212, v212, v14
    v_add_f32 v212, v212, v15
    v_cvt_pk_bf16_f32 v224, v12, v13
    v_cvt_pk_bf16_f32 v225, v14, v15
    v_fma_f32 v16, -v196, v163, v16
    v_mul_f32 v16, v16, v197
    v_fma_f32 v17, -v198, v163, v17
    v_mul_f32 v17, v17, v199
    v_fma_f32 v18, -v200, v163, v18
    v_mul_f32 v18, v18, v201
    v_fma_f32 v19, -v202, v163, v19
    v_mul_f32 v19, v19, v203
    v_cvt_pk_bf16_f32 v204, v16, v17
    v_lshlrev_b32 v16, 16, v204
    v_and_b32 v17, 0xffff0000, v204
    v_cvt_pk_bf16_f32 v205, v18, v19
    v_lshlrev_b32 v18, 16, v205
    v_and_b32 v19, 0xffff0000, v205
    v_mul_f32 v208, 0x3fb8aa3b, v16
    v_exp_f32 v208, v208
    v_cmp_lt_f32 vcc, 0, v16
    v_add_f32 v16, 1.0, v16
    v_cndmask_b32 v16, v208, v16, vcc
    v_mul_f32 v209, 0x3fb8aa3b, v17
    v_exp_f32 v209, v209
    v_cmp_lt_f32 vcc, 0, v17
    v_add_f32 v17, 1.0, v17
    v_cndmask_b32 v17, v209, v17, vcc
    v_mul_f32 v210, 0x3fb8aa3b, v18
    v_exp_f32 v210, v210
    v_cmp_lt_f32 vcc, 0, v18
    v_add_f32 v18, 1.0, v18
    v_cndmask_b32 v18, v210, v18, vcc
    v_mul_f32 v211, 0x3fb8aa3b, v19
    v_exp_f32 v211, v211
    v_cmp_lt_f32 vcc, 0, v19
    v_add_f32 v19, 1.0, v19
    v_cndmask_b32 v19, v211, v19, vcc
    v_cvt_pk_bf16_f32 v204, v16, v17
    v_lshlrev_b32 v16, 16, v204
    v_and_b32 v17, 0xffff0000, v204
    v_cvt_pk_bf16_f32 v205, v18, v19
    v_lshlrev_b32 v18, 16, v205
    v_and_b32 v19, 0xffff0000, v205
    v_add_f32 v16, 0x358637bd, v16
    v_add_f32 v17, 0x358637bd, v17
    v_add_f32 v18, 0x358637bd, v18
    v_add_f32 v19, 0x358637bd, v19
    v_cvt_pk_bf16_f32 v204, v16, v17
    v_lshlrev_b32 v16, 16, v204
    v_and_b32 v17, 0xffff0000, v204
    v_cvt_pk_bf16_f32 v205, v18, v19
    v_lshlrev_b32 v18, 16, v205
    v_and_b32 v19, 0xffff0000, v205
    v_add_f32 v212, v212, v16
    v_add_f32 v212, v212, v17
    v_add_f32 v212, v212, v18
    v_add_f32 v212, v212, v19
    v_cvt_pk_bf16_f32 v226, v16, v17
    v_cvt_pk_bf16_f32 v227, v18, v19
    ds_write_b128 v228, v[220:223] offset:1024
    ds_write_b128 v228, v[224:227] offset:2048
    v_mov_b32 v213, v212
    s_nop 1
    v_permlane32_swap_b32 v212, v213
    s_nop 1
    v_add_f32 v212, v212, v213
    v_lshlrev_b32 v213, 2, v160
    s_mul_i32 s65, s84, 640
    s_add_u32 s65, s65, 163840
    v_cmp_gt_u32 vcc, 32, v160
    s_and_saveexec_b64 s[76:77], vcc
    buffer_atomic_add_f32 v212, v213, s[52:55], s65 offen
    s_or_b64 exec, exec, s[76:77]
    s_nop 1
    v_mov_b32 v212, 0
    v_fma_f32 v20, -v172, v164, v20
    v_mul_f32 v20, v20, v173
    v_fma_f32 v21, -v174, v164, v21
    v_mul_f32 v21, v21, v175
    v_fma_f32 v22, -v176, v164, v22
    v_mul_f32 v22, v22, v177
    v_fma_f32 v23, -v178, v164, v23
    v_mul_f32 v23, v23, v179
    v_cvt_pk_bf16_f32 v204, v20, v21
    v_lshlrev_b32 v20, 16, v204
    v_and_b32 v21, 0xffff0000, v204
    v_cvt_pk_bf16_f32 v205, v22, v23
    v_lshlrev_b32 v22, 16, v205
    v_and_b32 v23, 0xffff0000, v205
    v_mul_f32 v208, 0x3fb8aa3b, v20
    v_exp_f32 v208, v208
    v_cmp_lt_f32 vcc, 0, v20
    v_add_f32 v20, 1.0, v20
    v_cndmask_b32 v20, v208, v20, vcc
    v_mul_f32 v209, 0x3fb8aa3b, v21
    v_exp_f32 v209, v209
    v_cmp_lt_f32 vcc, 0, v21
    v_add_f32 v21, 1.0, v21
    v_cndmask_b32 v21, v209, v21, vcc
    v_mul_f32 v210, 0x3fb8aa3b, v22
    v_exp_f32 v210, v210
    v_cmp_lt_f32 vcc, 0, v22
    v_add_f32 v22, 1.0, v22
    v_cndmask_b32 v22, v210, v22, vcc
    v_mul_f32 v211, 0x3fb8aa3b, v23
    v_exp_f32 v211, v211
    v_cmp_lt_f32 vcc, 0, v23
    v_add_f32 v23, 1.0, v23
    v_cndmask_b32 v23, v211, v23, vcc
    v_cvt_pk_bf16_f32 v204, v20, v21
    v_lshlrev_b32 v20, 16, v204
    v_and_b32 v21, 0xffff0000, v204
    v_cvt_pk_bf16_f32 v205, v22, v23
    v_lshlrev_b32 v22, 16, v205
    v_and_b32 v23, 0xffff0000, v205
    v_add_f32 v20, 0x358637bd, v20
    v_add_f32 v21, 0x358637bd, v21
    v_add_f32 v22, 0x358637bd, v22
    v_add_f32 v23, 0x358637bd, v23
    v_cvt_pk_bf16_f32 v204, v20, v21
    v_lshlrev_b32 v20, 16, v204
    v_and_b32 v21, 0xffff0000, v204
    v_cvt_pk_bf16_f32 v205, v22, v23
    v_lshlrev_b32 v22, 16, v205
    v_and_b32 v23, 0xffff0000, v205
    v_add_f32 v212, v212, v20
    v_add_f32 v212, v212, v21
    v_add_f32 v212, v212, v22
    v_add_f32 v212, v212, v23
    v_cvt_pk_bf16_f32 v220, v20, v21
    v_cvt_pk_bf16_f32 v221, v22, v23
    v_fma_f32 v24, -v180, v164, v24
    v_mul_f32 v24, v24, v181
    v_fma_f32 v25, -v182, v164, v25
    v_mul_f32 v25, v25, v183
    v_fma_f32 v26, -v184, v164, v26
    v_mul_f32 v26, v26, v185
    v_fma_f32 v27, -v186, v164, v27
    v_mul_f32 v27, v27, v187
    v_cvt_pk_bf16_f32 v204, v24, v25
    v_lshlrev_b32 v24, 16, v204
    v_and_b32 v25, 0xffff0000, v204
    v_cvt_pk_bf16_f32 v205, v26, v27
    v_lshlrev_b32 v26, 16, v205
    v_and_b32 v27, 0xffff0000, v205
    v_mul_f32 v208, 0x3fb8aa3b, v24
    v_exp_f32 v208, v208
    v_cmp_lt_f32 vcc, 0, v24
    v_add_f32 v24, 1.0, v24
    v_cndmask_b32 v24, v208, v24, vcc
    v_mul_f32 v209, 0x3fb8aa3b, v25
    v_exp_f32 v209, v209
    v_cmp_lt_f32 vcc, 0, v25
    v_add_f32 v25, 1.0, v25
    v_cndmask_b32 v25, v209, v25, vcc
    v_mul_f32 v210, 0x3fb8aa3b, v26
    v_exp_f32 v210, v210
    v_cmp_lt_f32 vcc, 0, v26
    v_add_f32 v26, 1.0, v26
    v_cndmask_b32 v26, v210, v26, vcc
    v_mul_f32 v211, 0x3fb8aa3b, v27
    v_exp_f32 v211, v211
    v_cmp_lt_f32 vcc, 0, v27
    v_add_f32 v27, 1.0, v27
    v_cndmask_b32 v27, v211, v27, vcc
    v_cvt_pk_bf16_f32 v204, v24, v25
    v_lshlrev_b32 v24, 16, v204
    v_and_b32 v25, 0xffff0000, v204
    v_cvt_pk_bf16_f32 v205, v26, v27
    v_lshlrev_b32 v26, 16, v205
    v_and_b32 v27, 0xffff0000, v205
    v_add_f32 v24, 0x358637bd, v24
    v_add_f32 v25, 0x358637bd, v25
    v_add_f32 v26, 0x358637bd, v26
    v_add_f32 v27, 0x358637bd, v27
    v_cvt_pk_bf16_f32 v204, v24, v25
    v_lshlrev_b32 v24, 16, v204
    v_and_b32 v25, 0xffff0000, v204
    v_cvt_pk_bf16_f32 v205, v26, v27
    v_lshlrev_b32 v26, 16, v205
    v_and_b32 v27, 0xffff0000, v205
    v_add_f32 v212, v212, v24
    v_add_f32 v212, v212, v25
    v_add_f32 v212, v212, v26
    v_add_f32 v212, v212, v27
    v_cvt_pk_bf16_f32 v222, v24, v25
    v_cvt_pk_bf16_f32 v223, v26, v27
    v_fma_f32 v28, -v188, v164, v28
    v_mul_f32 v28, v28, v189
    v_fma_f32 v29, -v190, v164, v29
    v_mul_f32 v29, v29, v191
    v_fma_f32 v30, -v192, v164, v30
    v_mul_f32 v30, v30, v193
    v_fma_f32 v31, -v194, v164, v31
    v_mul_f32 v31, v31, v195
    v_cvt_pk_bf16_f32 v204, v28, v29
    v_lshlrev_b32 v28, 16, v204
    v_and_b32 v29, 0xffff0000, v204
    v_cvt_pk_bf16_f32 v205, v30, v31
    v_lshlrev_b32 v30, 16, v205
    v_and_b32 v31, 0xffff0000, v205
    v_mul_f32 v208, 0x3fb8aa3b, v28
    v_exp_f32 v208, v208
    v_cmp_lt_f32 vcc, 0, v28
    v_add_f32 v28, 1.0, v28
    v_cndmask_b32 v28, v208, v28, vcc
    v_mul_f32 v209, 0x3fb8aa3b, v29
    v_exp_f32 v209, v209
    v_cmp_lt_f32 vcc, 0, v29
    v_add_f32 v29, 1.0, v29
    v_cndmask_b32 v29, v209, v29, vcc
    v_mul_f32 v210, 0x3fb8aa3b, v30
    v_exp_f32 v210, v210
    v_cmp_lt_f32 vcc, 0, v30
    v_add_f32 v30, 1.0, v30
    v_cndmask_b32 v30, v210, v30, vcc
    v_mul_f32 v211, 0x3fb8aa3b, v31
    v_exp_f32 v211, v211
    v_cmp_lt_f32 vcc, 0, v31
    v_add_f32 v31, 1.0, v31
    v_cndmask_b32 v31, v211, v31, vcc
    v_cvt_pk_bf16_f32 v204, v28, v29
    v_lshlrev_b32 v28, 16, v204
    v_and_b32 v29, 0xffff0000, v204
    v_cvt_pk_bf16_f32 v205, v30, v31
    v_lshlrev_b32 v30, 16, v205
    v_and_b32 v31, 0xffff0000, v205
    v_add_f32 v28, 0x358637bd, v28
    v_add_f32 v29, 0x358637bd, v29
    v_add_f32 v30, 0x358637bd, v30
    v_add_f32 v31, 0x358637bd, v31
    v_cvt_pk_bf16_f32 v204, v28, v29
    v_lshlrev_b32 v28, 16, v204
    v_and_b32 v29, 0xffff0000, v204
    v_cvt_pk_bf16_f32 v205, v30, v31
    v_lshlrev_b32 v30, 16, v205
    v_and_b32 v31, 0xffff0000, v205
    v_add_f32 v212, v212, v28
    v_add_f32 v212, v212, v29
    v_add_f32 v212, v212, v30
    v_add_f32 v212, v212, v31
    v_cvt_pk_bf16_f32 v224, v28, v29
    v_cvt_pk_bf16_f32 v225, v30, v31
    v_fma_f32 v32, -v196, v164, v32
    v_mul_f32 v32, v32, v197
    v_fma_f32 v33, -v198, v164, v33
    v_mul_f32 v33, v33, v199
    v_fma_f32 v34, -v200, v164, v34
    v_mul_f32 v34, v34, v201
    v_fma_f32 v35, -v202, v164, v35
    v_mul_f32 v35, v35, v203
    v_cvt_pk_bf16_f32 v204, v32, v33
    v_lshlrev_b32 v32, 16, v204
    v_and_b32 v33, 0xffff0000, v204
    v_cvt_pk_bf16_f32 v205, v34, v35
    v_lshlrev_b32 v34, 16, v205
    v_and_b32 v35, 0xffff0000, v205
    v_mul_f32 v208, 0x3fb8aa3b, v32
    v_exp_f32 v208, v208
    v_cmp_lt_f32 vcc, 0, v32
    v_add_f32 v32, 1.0, v32
    v_cndmask_b32 v32, v208, v32, vcc
    v_mul_f32 v209, 0x3fb8aa3b, v33
    v_exp_f32 v209, v209
    v_cmp_lt_f32 vcc, 0, v33
    v_add_f32 v33, 1.0, v33
    v_cndmask_b32 v33, v209, v33, vcc
    v_mul_f32 v210, 0x3fb8aa3b, v34
    v_exp_f32 v210, v210
    v_cmp_lt_f32 vcc, 0, v34
    v_add_f32 v34, 1.0, v34
    v_cndmask_b32 v34, v210, v34, vcc
    v_mul_f32 v211, 0x3fb8aa3b, v35
    v_exp_f32 v211, v211
    v_cmp_lt_f32 vcc, 0, v35
    v_add_f32 v35, 1.0, v35
    v_cndmask_b32 v35, v211, v35, vcc
    v_cvt_pk_bf16_f32 v204, v32, v33
    v_lshlrev_b32 v32, 16, v204
    v_and_b32 v33, 0xffff0000, v204
    v_cvt_pk_bf16_f32 v205, v34, v35
    v_lshlrev_b32 v34, 16, v205
    v_and_b32 v35, 0xffff0000, v205
    v_add_f32 v32, 0x358637bd, v32
    v_add_f32 v33, 0x358637bd, v33
    v_add_f32 v34, 0x358637bd, v34
    v_add_f32 v35, 0x358637bd, v35
    v_cvt_pk_bf16_f32 v204, v32, v33
    v_lshlrev_b32 v32, 16, v204
    v_and_b32 v33, 0xffff0000, v204
    v_cvt_pk_bf16_f32 v205, v34, v35
    v_lshlrev_b32 v34, 16, v205
    v_and_b32 v35, 0xffff0000, v205
    v_add_f32 v212, v212, v32
    v_add_f32 v212, v212, v33
    v_add_f32 v212, v212, v34
    v_add_f32 v212, v212, v35
    v_cvt_pk_bf16_f32 v226, v32, v33
    v_cvt_pk_bf16_f32 v227, v34, v35
    ds_write_b128 v228, v[220:223] offset:3072
    ds_write_b128 v228, v[224:227] offset:4096
    v_mov_b32 v213, v212
    s_nop 1
    v_permlane32_swap_b32 v212, v213
    s_nop 1
    v_add_f32 v212, v212, v213
    v_lshlrev_b32 v213, 2, v160
    s_mul_i32 s65, s84, 640
    s_add_u32 s65, s65, 163968
    v_cmp_gt_u32 vcc, 32, v160
    s_and_saveexec_b64 s[76:77], vcc
    buffer_atomic_add_f32 v212, v213, s[52:55], s65 offen
    s_or_b64 exec, exec, s[76:77]
    s_nop 1
    v_mov_b32 v212, 0
    v_fma_f32 v36, -v172, v165, v36
    v_mul_f32 v36, v36, v173
    v_fma_f32 v37, -v174, v165, v37
    v_mul_f32 v37, v37, v175
    v_fma_f32 v38, -v176, v165, v38
    v_mul_f32 v38, v38, v177
    v_fma_f32 v39, -v178, v165, v39
    v_mul_f32 v39, v39, v179
    v_cvt_pk_bf16_f32 v204, v36, v37
    v_lshlrev_b32 v36, 16, v204
    v_and_b32 v37, 0xffff0000, v204
    v_cvt_pk_bf16_f32 v205, v38, v39
    v_lshlrev_b32 v38, 16, v205
    v_and_b32 v39, 0xffff0000, v205
    v_mul_f32 v208, 0x3fb8aa3b, v36
    v_exp_f32 v208, v208
    v_cmp_lt_f32 vcc, 0, v36
    v_add_f32 v36, 1.0, v36
    v_cndmask_b32 v36, v208, v36, vcc
    v_mul_f32 v209, 0x3fb8aa3b, v37
    v_exp_f32 v209, v209
    v_cmp_lt_f32 vcc, 0, v37
    v_add_f32 v37, 1.0, v37
    v_cndmask_b32 v37, v209, v37, vcc
    v_mul_f32 v210, 0x3fb8aa3b, v38
    v_exp_f32 v210, v210
    v_cmp_lt_f32 vcc, 0, v38
    v_add_f32 v38, 1.0, v38
    v_cndmask_b32 v38, v210, v38, vcc
    v_mul_f32 v211, 0x3fb8aa3b, v39
    v_exp_f32 v211, v211
    v_cmp_lt_f32 vcc, 0, v39
    v_add_f32 v39, 1.0, v39
    v_cndmask_b32 v39, v211, v39, vcc
    v_cvt_pk_bf16_f32 v204, v36, v37
    v_lshlrev_b32 v36, 16, v204
    v_and_b32 v37, 0xffff0000, v204
    v_cvt_pk_bf16_f32 v205, v38, v39
    v_lshlrev_b32 v38, 16, v205
    v_and_b32 v39, 0xffff0000, v205
    v_add_f32 v36, 0x358637bd, v36
    v_add_f32 v37, 0x358637bd, v37
    v_add_f32 v38, 0x358637bd, v38
    v_add_f32 v39, 0x358637bd, v39
    v_cvt_pk_bf16_f32 v204, v36, v37
    v_lshlrev_b32 v36, 16, v204
    v_and_b32 v37, 0xffff0000, v204
    v_cvt_pk_bf16_f32 v205, v38, v39
    v_lshlrev_b32 v38, 16, v205
    v_and_b32 v39, 0xffff0000, v205
    v_add_f32 v212, v212, v36
    v_add_f32 v212, v212, v37
    v_add_f32 v212, v212, v38
    v_add_f32 v212, v212, v39
    v_cvt_pk_bf16_f32 v220, v36, v37
    v_cvt_pk_bf16_f32 v221, v38, v39
    v_fma_f32 v40, -v180, v165, v40
    v_mul_f32 v40, v40, v181
    v_fma_f32 v41, -v182, v165, v41
    v_mul_f32 v41, v41, v183
    v_fma_f32 v42, -v184, v165, v42
    v_mul_f32 v42, v42, v185
    v_fma_f32 v43, -v186, v165, v43
    v_mul_f32 v43, v43, v187
    v_cvt_pk_bf16_f32 v204, v40, v41
    v_lshlrev_b32 v40, 16, v204
    v_and_b32 v41, 0xffff0000, v204
    v_cvt_pk_bf16_f32 v205, v42, v43
    v_lshlrev_b32 v42, 16, v205
    v_and_b32 v43, 0xffff0000, v205
    v_mul_f32 v208, 0x3fb8aa3b, v40
    v_exp_f32 v208, v208
    v_cmp_lt_f32 vcc, 0, v40
    v_add_f32 v40, 1.0, v40
    v_cndmask_b32 v40, v208, v40, vcc
    v_mul_f32 v209, 0x3fb8aa3b, v41
    v_exp_f32 v209, v209
    v_cmp_lt_f32 vcc, 0, v41
    v_add_f32 v41, 1.0, v41
    v_cndmask_b32 v41, v209, v41, vcc
    v_mul_f32 v210, 0x3fb8aa3b, v42
    v_exp_f32 v210, v210
    v_cmp_lt_f32 vcc, 0, v42
    v_add_f32 v42, 1.0, v42
    v_cndmask_b32 v42, v210, v42, vcc
    v_mul_f32 v211, 0x3fb8aa3b, v43
    v_exp_f32 v211, v211
    v_cmp_lt_f32 vcc, 0, v43
    v_add_f32 v43, 1.0, v43
    v_cndmask_b32 v43, v211, v43, vcc
    v_cvt_pk_bf16_f32 v204, v40, v41
    v_lshlrev_b32 v40, 16, v204
    v_and_b32 v41, 0xffff0000, v204
    v_cvt_pk_bf16_f32 v205, v42, v43
    v_lshlrev_b32 v42, 16, v205
    v_and_b32 v43, 0xffff0000, v205
    v_add_f32 v40, 0x358637bd, v40
    v_add_f32 v41, 0x358637bd, v41
    v_add_f32 v42, 0x358637bd, v42
    v_add_f32 v43, 0x358637bd, v43
    v_cvt_pk_bf16_f32 v204, v40, v41
    v_lshlrev_b32 v40, 16, v204
    v_and_b32 v41, 0xffff0000, v204
    v_cvt_pk_bf16_f32 v205, v42, v43
    v_lshlrev_b32 v42, 16, v205
    v_and_b32 v43, 0xffff0000, v205
    v_add_f32 v212, v212, v40
    v_add_f32 v212, v212, v41
    v_add_f32 v212, v212, v42
    v_add_f32 v212, v212, v43
    v_cvt_pk_bf16_f32 v222, v40, v41
    v_cvt_pk_bf16_f32 v223, v42, v43
    v_fma_f32 v44, -v188, v165, v44
    v_mul_f32 v44, v44, v189
    v_fma_f32 v45, -v190, v165, v45
    v_mul_f32 v45, v45, v191
    v_fma_f32 v46, -v192, v165, v46
    v_mul_f32 v46, v46, v193
    v_fma_f32 v47, -v194, v165, v47
    v_mul_f32 v47, v47, v195
    v_cvt_pk_bf16_f32 v204, v44, v45
    v_lshlrev_b32 v44, 16, v204
    v_and_b32 v45, 0xffff0000, v204
    v_cvt_pk_bf16_f32 v205, v46, v47
    v_lshlrev_b32 v46, 16, v205
    v_and_b32 v47, 0xffff0000, v205
    v_mul_f32 v208, 0x3fb8aa3b, v44
    v_exp_f32 v208, v208
    v_cmp_lt_f32 vcc, 0, v44
    v_add_f32 v44, 1.0, v44
    v_cndmask_b32 v44, v208, v44, vcc
    v_mul_f32 v209, 0x3fb8aa3b, v45
    v_exp_f32 v209, v209
    v_cmp_lt_f32 vcc, 0, v45
    v_add_f32 v45, 1.0, v45
    v_cndmask_b32 v45, v209, v45, vcc
    v_mul_f32 v210, 0x3fb8aa3b, v46
    v_exp_f32 v210, v210
    v_cmp_lt_f32 vcc, 0, v46
    v_add_f32 v46, 1.0, v46
    v_cndmask_b32 v46, v210, v46, vcc
    v_mul_f32 v211, 0x3fb8aa3b, v47
    v_exp_f32 v211, v211
    v_cmp_lt_f32 vcc, 0, v47
    v_add_f32 v47, 1.0, v47
    v_cndmask_b32 v47, v211, v47, vcc
    v_cvt_pk_bf16_f32 v204, v44, v45
    v_lshlrev_b32 v44, 16, v204
    v_and_b32 v45, 0xffff0000, v204
    v_cvt_pk_bf16_f32 v205, v46, v47
    v_lshlrev_b32 v46, 16, v205
    v_and_b32 v47, 0xffff0000, v205
    v_add_f32 v44, 0x358637bd, v44
    v_add_f32 v45, 0x358637bd, v45
    v_add_f32 v46, 0x358637bd, v46
    v_add_f32 v47, 0x358637bd, v47
    v_cvt_pk_bf16_f32 v204, v44, v45
    v_lshlrev_b32 v44, 16, v204
    v_and_b32 v45, 0xffff0000, v204
    v_cvt_pk_bf16_f32 v205, v46, v47
    v_lshlrev_b32 v46, 16, v205
    v_and_b32 v47, 0xffff0000, v205
    v_add_f32 v212, v212, v44
    v_add_f32 v212, v212, v45
    v_add_f32 v212, v212, v46
    v_add_f32 v212, v212, v47
    v_cvt_pk_bf16_f32 v224, v44, v45
    v_cvt_pk_bf16_f32 v225, v46, v47
    v_fma_f32 v48, -v196, v165, v48
    v_mul_f32 v48, v48, v197
    v_fma_f32 v49, -v198, v165, v49
    v_mul_f32 v49, v49, v199
    v_fma_f32 v50, -v200, v165, v50
    v_mul_f32 v50, v50, v201
    v_fma_f32 v51, -v202, v165, v51
    v_mul_f32 v51, v51, v203
    v_cvt_pk_bf16_f32 v204, v48, v49
    v_lshlrev_b32 v48, 16, v204
    v_and_b32 v49, 0xffff0000, v204
    v_cvt_pk_bf16_f32 v205, v50, v51
    v_lshlrev_b32 v50, 16, v205
    v_and_b32 v51, 0xffff0000, v205
    v_mul_f32 v208, 0x3fb8aa3b, v48
    v_exp_f32 v208, v208
    v_cmp_lt_f32 vcc, 0, v48
    v_add_f32 v48, 1.0, v48
    v_cndmask_b32 v48, v208, v48, vcc
    v_mul_f32 v209, 0x3fb8aa3b, v49
    v_exp_f32 v209, v209
    v_cmp_lt_f32 vcc, 0, v49
    v_add_f32 v49, 1.0, v49
    v_cndmask_b32 v49, v209, v49, vcc
    v_mul_f32 v210, 0x3fb8aa3b, v50
    v_exp_f32 v210, v210
    v_cmp_lt_f32 vcc, 0, v50
    v_add_f32 v50, 1.0, v50
    v_cndmask_b32 v50, v210, v50, vcc
    v_mul_f32 v211, 0x3fb8aa3b, v51
    v_exp_f32 v211, v211
    v_cmp_lt_f32 vcc, 0, v51
    v_add_f32 v51, 1.0, v51
    v_cndmask_b32 v51, v211, v51, vcc
    v_cvt_pk_bf16_f32 v204, v48, v49
    v_lshlrev_b32 v48, 16, v204
    v_and_b32 v49, 0xffff0000, v204
    v_cvt_pk_bf16_f32 v205, v50, v51
    v_lshlrev_b32 v50, 16, v205
    v_and_b32 v51, 0xffff0000, v205
    v_add_f32 v48, 0x358637bd, v48
    v_add_f32 v49, 0x358637bd, v49
    v_add_f32 v50, 0x358637bd, v50
    v_add_f32 v51, 0x358637bd, v51
    v_cvt_pk_bf16_f32 v204, v48, v49
    v_lshlrev_b32 v48, 16, v204
    v_and_b32 v49, 0xffff0000, v204
    v_cvt_pk_bf16_f32 v205, v50, v51
    v_lshlrev_b32 v50, 16, v205
    v_and_b32 v51, 0xffff0000, v205
    v_add_f32 v212, v212, v48
    v_add_f32 v212, v212, v49
    v_add_f32 v212, v212, v50
    v_add_f32 v212, v212, v51
    v_cvt_pk_bf16_f32 v226, v48, v49
    v_cvt_pk_bf16_f32 v227, v50, v51
    ds_write_b128 v228, v[220:223] offset:5120
    ds_write_b128 v228, v[224:227] offset:6144
    v_mov_b32 v213, v212
    s_nop 1
    v_permlane32_swap_b32 v212, v213
    s_nop 1
    v_add_f32 v212, v212, v213
    v_lshlrev_b32 v213, 2, v160
    s_mul_i32 s65, s84, 640
    s_add_u32 s65, s65, 164096
    v_cmp_gt_u32 vcc, 32, v160
    s_and_saveexec_b64 s[76:77], vcc
    buffer_atomic_add_f32 v212, v213, s[52:55], s65 offen
    s_or_b64 exec, exec, s[76:77]
    s_nop 1
    v_mov_b32 v212, 0
    v_fma_f32 v52, -v172, v166, v52
    v_mul_f32 v52, v52, v173
    v_fma_f32 v53, -v174, v166, v53
    v_mul_f32 v53, v53, v175
    v_fma_f32 v54, -v176, v166, v54
    v_mul_f32 v54, v54, v177
    v_fma_f32 v55, -v178, v166, v55
    v_mul_f32 v55, v55, v179
    v_cvt_pk_bf16_f32 v204, v52, v53
    v_lshlrev_b32 v52, 16, v204
    v_and_b32 v53, 0xffff0000, v204
    v_cvt_pk_bf16_f32 v205, v54, v55
    v_lshlrev_b32 v54, 16, v205
    v_and_b32 v55, 0xffff0000, v205
    v_mul_f32 v208, 0x3fb8aa3b, v52
    v_exp_f32 v208, v208
    v_cmp_lt_f32 vcc, 0, v52
    v_add_f32 v52, 1.0, v52
    v_cndmask_b32 v52, v208, v52, vcc
    v_mul_f32 v209, 0x3fb8aa3b, v53
    v_exp_f32 v209, v209
    v_cmp_lt_f32 vcc, 0, v53
    v_add_f32 v53, 1.0, v53
    v_cndmask_b32 v53, v209, v53, vcc
    v_mul_f32 v210, 0x3fb8aa3b, v54
    v_exp_f32 v210, v210
    v_cmp_lt_f32 vcc, 0, v54
    v_add_f32 v54, 1.0, v54
    v_cndmask_b32 v54, v210, v54, vcc
    v_mul_f32 v211, 0x3fb8aa3b, v55
    v_exp_f32 v211, v211
    v_cmp_lt_f32 vcc, 0, v55
    v_add_f32 v55, 1.0, v55
    v_cndmask_b32 v55, v211, v55, vcc
    v_cvt_pk_bf16_f32 v204, v52, v53
    v_lshlrev_b32 v52, 16, v204
    v_and_b32 v53, 0xffff0000, v204
    v_cvt_pk_bf16_f32 v205, v54, v55
    v_lshlrev_b32 v54, 16, v205
    v_and_b32 v55, 0xffff0000, v205
    v_add_f32 v52, 0x358637bd, v52
    v_add_f32 v53, 0x358637bd, v53
    v_add_f32 v54, 0x358637bd, v54
    v_add_f32 v55, 0x358637bd, v55
    v_cvt_pk_bf16_f32 v204, v52, v53
    v_lshlrev_b32 v52, 16, v204
    v_and_b32 v53, 0xffff0000, v204
    v_cvt_pk_bf16_f32 v205, v54, v55
    v_lshlrev_b32 v54, 16, v205
    v_and_b32 v55, 0xffff0000, v205
    v_add_f32 v212, v212, v52
    v_add_f32 v212, v212, v53
    v_add_f32 v212, v212, v54
    v_add_f32 v212, v212, v55
    v_cvt_pk_bf16_f32 v220, v52, v53
    v_cvt_pk_bf16_f32 v221, v54, v55
    v_fma_f32 v56, -v180, v166, v56
    v_mul_f32 v56, v56, v181
    v_fma_f32 v57, -v182, v166, v57
    v_mul_f32 v57, v57, v183
    v_fma_f32 v58, -v184, v166, v58
    v_mul_f32 v58, v58, v185
    v_fma_f32 v59, -v186, v166, v59
    v_mul_f32 v59, v59, v187
    v_cvt_pk_bf16_f32 v204, v56, v57
    v_lshlrev_b32 v56, 16, v204
    v_and_b32 v57, 0xffff0000, v204
    v_cvt_pk_bf16_f32 v205, v58, v59
    v_lshlrev_b32 v58, 16, v205
    v_and_b32 v59, 0xffff0000, v205
    v_mul_f32 v208, 0x3fb8aa3b, v56
    v_exp_f32 v208, v208
    v_cmp_lt_f32 vcc, 0, v56
    v_add_f32 v56, 1.0, v56
    v_cndmask_b32 v56, v208, v56, vcc
    v_mul_f32 v209, 0x3fb8aa3b, v57
    v_exp_f32 v209, v209
    v_cmp_lt_f32 vcc, 0, v57
    v_add_f32 v57, 1.0, v57
    v_cndmask_b32 v57, v209, v57, vcc
    v_mul_f32 v210, 0x3fb8aa3b, v58
    v_exp_f32 v210, v210
    v_cmp_lt_f32 vcc, 0, v58
    v_add_f32 v58, 1.0, v58
    v_cndmask_b32 v58, v210, v58, vcc
    v_mul_f32 v211, 0x3fb8aa3b, v59
    v_exp_f32 v211, v211
    v_cmp_lt_f32 vcc, 0, v59
    v_add_f32 v59, 1.0, v59
    v_cndmask_b32 v59, v211, v59, vcc
    v_cvt_pk_bf16_f32 v204, v56, v57
    v_lshlrev_b32 v56, 16, v204
    v_and_b32 v57, 0xffff0000, v204
    v_cvt_pk_bf16_f32 v205, v58, v59
    v_lshlrev_b32 v58, 16, v205
    v_and_b32 v59, 0xffff0000, v205
    v_add_f32 v56, 0x358637bd, v56
    v_add_f32 v57, 0x358637bd, v57
    v_add_f32 v58, 0x358637bd, v58
    v_add_f32 v59, 0x358637bd, v59
    v_cvt_pk_bf16_f32 v204, v56, v57
    v_lshlrev_b32 v56, 16, v204
    v_and_b32 v57, 0xffff0000, v204
    v_cvt_pk_bf16_f32 v205, v58, v59
    v_lshlrev_b32 v58, 16, v205
    v_and_b32 v59, 0xffff0000, v205
    v_add_f32 v212, v212, v56
    v_add_f32 v212, v212, v57
    v_add_f32 v212, v212, v58
    v_add_f32 v212, v212, v59
    v_cvt_pk_bf16_f32 v222, v56, v57
    v_cvt_pk_bf16_f32 v223, v58, v59
    v_fma_f32 v60, -v188, v166, v60
    v_mul_f32 v60, v60, v189
    v_fma_f32 v61, -v190, v166, v61
    v_mul_f32 v61, v61, v191
    v_fma_f32 v62, -v192, v166, v62
    v_mul_f32 v62, v62, v193
    v_fma_f32 v63, -v194, v166, v63
    v_mul_f32 v63, v63, v195
    v_cvt_pk_bf16_f32 v204, v60, v61
    v_lshlrev_b32 v60, 16, v204
    v_and_b32 v61, 0xffff0000, v204
    v_cvt_pk_bf16_f32 v205, v62, v63
    v_lshlrev_b32 v62, 16, v205
    v_and_b32 v63, 0xffff0000, v205
    v_mul_f32 v208, 0x3fb8aa3b, v60
    v_exp_f32 v208, v208
    v_cmp_lt_f32 vcc, 0, v60
    v_add_f32 v60, 1.0, v60
    v_cndmask_b32 v60, v208, v60, vcc
    v_mul_f32 v209, 0x3fb8aa3b, v61
    v_exp_f32 v209, v209
    v_cmp_lt_f32 vcc, 0, v61
    v_add_f32 v61, 1.0, v61
    v_cndmask_b32 v61, v209, v61, vcc
    v_mul_f32 v210, 0x3fb8aa3b, v62
    v_exp_f32 v210, v210
    v_cmp_lt_f32 vcc, 0, v62
    v_add_f32 v62, 1.0, v62
    v_cndmask_b32 v62, v210, v62, vcc
    v_mul_f32 v211, 0x3fb8aa3b, v63
    v_exp_f32 v211, v211
    v_cmp_lt_f32 vcc, 0, v63
    v_add_f32 v63, 1.0, v63
    v_cndmask_b32 v63, v211, v63, vcc
    v_cvt_pk_bf16_f32 v204, v60, v61
    v_lshlrev_b32 v60, 16, v204
    v_and_b32 v61, 0xffff0000, v204
    v_cvt_pk_bf16_f32 v205, v62, v63
    v_lshlrev_b32 v62, 16, v205
    v_and_b32 v63, 0xffff0000, v205
    v_add_f32 v60, 0x358637bd, v60
    v_add_f32 v61, 0x358637bd, v61
    v_add_f32 v62, 0x358637bd, v62
    v_add_f32 v63, 0x358637bd, v63
    v_cvt_pk_bf16_f32 v204, v60, v61
    v_lshlrev_b32 v60, 16, v204
    v_and_b32 v61, 0xffff0000, v204
    v_cvt_pk_bf16_f32 v205, v62, v63
    v_lshlrev_b32 v62, 16, v205
    v_and_b32 v63, 0xffff0000, v205
    v_add_f32 v212, v212, v60
    v_add_f32 v212, v212, v61
    v_add_f32 v212, v212, v62
    v_add_f32 v212, v212, v63
    v_cvt_pk_bf16_f32 v224, v60, v61
    v_cvt_pk_bf16_f32 v225, v62, v63
    v_fma_f32 v64, -v196, v166, v64
    v_mul_f32 v64, v64, v197
    v_fma_f32 v65, -v198, v166, v65
    v_mul_f32 v65, v65, v199
    v_fma_f32 v66, -v200, v166, v66
    v_mul_f32 v66, v66, v201
    v_fma_f32 v67, -v202, v166, v67
    v_mul_f32 v67, v67, v203
    v_cvt_pk_bf16_f32 v204, v64, v65
    v_lshlrev_b32 v64, 16, v204
    v_and_b32 v65, 0xffff0000, v204
    v_cvt_pk_bf16_f32 v205, v66, v67
    v_lshlrev_b32 v66, 16, v205
    v_and_b32 v67, 0xffff0000, v205
    v_mul_f32 v208, 0x3fb8aa3b, v64
    v_exp_f32 v208, v208
    v_cmp_lt_f32 vcc, 0, v64
    v_add_f32 v64, 1.0, v64
    v_cndmask_b32 v64, v208, v64, vcc
    v_mul_f32 v209, 0x3fb8aa3b, v65
    v_exp_f32 v209, v209
    v_cmp_lt_f32 vcc, 0, v65
    v_add_f32 v65, 1.0, v65
    v_cndmask_b32 v65, v209, v65, vcc
    v_mul_f32 v210, 0x3fb8aa3b, v66
    v_exp_f32 v210, v210
    v_cmp_lt_f32 vcc, 0, v66
    v_add_f32 v66, 1.0, v66
    v_cndmask_b32 v66, v210, v66, vcc
    v_mul_f32 v211, 0x3fb8aa3b, v67
    v_exp_f32 v211, v211
    v_cmp_lt_f32 vcc, 0, v67
    v_add_f32 v67, 1.0, v67
    v_cndmask_b32 v67, v211, v67, vcc
    v_cvt_pk_bf16_f32 v204, v64, v65
    v_lshlrev_b32 v64, 16, v204
    v_and_b32 v65, 0xffff0000, v204
    v_cvt_pk_bf16_f32 v205, v66, v67
    v_lshlrev_b32 v66, 16, v205
    v_and_b32 v67, 0xffff0000, v205
    v_add_f32 v64, 0x358637bd, v64
    v_add_f32 v65, 0x358637bd, v65
    v_add_f32 v66, 0x358637bd, v66
    v_add_f32 v67, 0x358637bd, v67
    v_cvt_pk_bf16_f32 v204, v64, v65
    v_lshlrev_b32 v64, 16, v204
    v_and_b32 v65, 0xffff0000, v204
    v_cvt_pk_bf16_f32 v205, v66, v67
    v_lshlrev_b32 v66, 16, v205
    v_and_b32 v67, 0xffff0000, v205
    v_add_f32 v212, v212, v64
    v_add_f32 v212, v212, v65
    v_add_f32 v212, v212, v66
    v_add_f32 v212, v212, v67
    v_cvt_pk_bf16_f32 v226, v64, v65
    v_cvt_pk_bf16_f32 v227, v66, v67
    ds_write_b128 v228, v[220:223] offset:7168
    ds_write_b128 v228, v[224:227] offset:8192
    v_mov_b32 v213, v212
    s_nop 1
    v_permlane32_swap_b32 v212, v213
    s_nop 1
    v_add_f32 v212, v212, v213
    v_lshlrev_b32 v213, 2, v160
    s_mul_i32 s65, s84, 640
    s_add_u32 s65, s65, 164224
    v_cmp_gt_u32 vcc, 32, v160
    s_and_saveexec_b64 s[76:77], vcc
    buffer_atomic_add_f32 v212, v213, s[52:55], s65 offen
    s_or_b64 exec, exec, s[76:77]
    s_nop 1
    v_mov_b32 v212, 0
    v_fma_f32 v68, -v172, v167, v68
    v_mul_f32 v68, v68, v173
    v_fma_f32 v69, -v174, v167, v69
    v_mul_f32 v69, v69, v175
    v_fma_f32 v70, -v176, v167, v70
    v_mul_f32 v70, v70, v177
    v_fma_f32 v71, -v178, v167, v71
    v_mul_f32 v71, v71, v179
    v_cvt_pk_bf16_f32 v204, v68, v69
    v_lshlrev_b32 v68, 16, v204
    v_and_b32 v69, 0xffff0000, v204
    v_cvt_pk_bf16_f32 v205, v70, v71
    v_lshlrev_b32 v70, 16, v205
    v_and_b32 v71, 0xffff0000, v205
    v_mul_f32 v208, 0x3fb8aa3b, v68
    v_exp_f32 v208, v208
    v_cmp_lt_f32 vcc, 0, v68
    v_add_f32 v68, 1.0, v68
    v_cndmask_b32 v68, v208, v68, vcc
    v_mul_f32 v209, 0x3fb8aa3b, v69
    v_exp_f32 v209, v209
    v_cmp_lt_f32 vcc, 0, v69
    v_add_f32 v69, 1.0, v69
    v_cndmask_b32 v69, v209, v69, vcc
    v_mul_f32 v210, 0x3fb8aa3b, v70
    v_exp_f32 v210, v210
    v_cmp_lt_f32 vcc, 0, v70
    v_add_f32 v70, 1.0, v70
    v_cndmask_b32 v70, v210, v70, vcc
    v_mul_f32 v211, 0x3fb8aa3b, v71
    v_exp_f32 v211, v211
    v_cmp_lt_f32 vcc, 0, v71
    v_add_f32 v71, 1.0, v71
    v_cndmask_b32 v71, v211, v71, vcc
    v_cvt_pk_bf16_f32 v204, v68, v69
    v_lshlrev_b32 v68, 16, v204
    v_and_b32 v69, 0xffff0000, v204
    v_cvt_pk_bf16_f32 v205, v70, v71
    v_lshlrev_b32 v70, 16, v205
    v_and_b32 v71, 0xffff0000, v205
    v_add_f32 v68, 0x358637bd, v68
    v_add_f32 v69, 0x358637bd, v69
    v_add_f32 v70, 0x358637bd, v70
    v_add_f32 v71, 0x358637bd, v71
    v_cvt_pk_bf16_f32 v204, v68, v69
    v_lshlrev_b32 v68, 16, v204
    v_and_b32 v69, 0xffff0000, v204
    v_cvt_pk_bf16_f32 v205, v70, v71
    v_lshlrev_b32 v70, 16, v205
    v_and_b32 v71, 0xffff0000, v205
    v_add_f32 v212, v212, v68
    v_add_f32 v212, v212, v69
    v_add_f32 v212, v212, v70
    v_add_f32 v212, v212, v71
    v_cvt_pk_bf16_f32 v220, v68, v69
    v_cvt_pk_bf16_f32 v221, v70, v71
    v_fma_f32 v72, -v180, v167, v72
    v_mul_f32 v72, v72, v181
    v_fma_f32 v73, -v182, v167, v73
    v_mul_f32 v73, v73, v183
    v_fma_f32 v74, -v184, v167, v74
    v_mul_f32 v74, v74, v185
    v_fma_f32 v75, -v186, v167, v75
    v_mul_f32 v75, v75, v187
    v_cvt_pk_bf16_f32 v204, v72, v73
    v_lshlrev_b32 v72, 16, v204
    v_and_b32 v73, 0xffff0000, v204
    v_cvt_pk_bf16_f32 v205, v74, v75
    v_lshlrev_b32 v74, 16, v205
    v_and_b32 v75, 0xffff0000, v205
    v_mul_f32 v208, 0x3fb8aa3b, v72
    v_exp_f32 v208, v208
    v_cmp_lt_f32 vcc, 0, v72
    v_add_f32 v72, 1.0, v72
    v_cndmask_b32 v72, v208, v72, vcc
    v_mul_f32 v209, 0x3fb8aa3b, v73
    v_exp_f32 v209, v209
    v_cmp_lt_f32 vcc, 0, v73
    v_add_f32 v73, 1.0, v73
    v_cndmask_b32 v73, v209, v73, vcc
    v_mul_f32 v210, 0x3fb8aa3b, v74
    v_exp_f32 v210, v210
    v_cmp_lt_f32 vcc, 0, v74
    v_add_f32 v74, 1.0, v74
    v_cndmask_b32 v74, v210, v74, vcc
    v_mul_f32 v211, 0x3fb8aa3b, v75
    v_exp_f32 v211, v211
    v_cmp_lt_f32 vcc, 0, v75
    v_add_f32 v75, 1.0, v75
    v_cndmask_b32 v75, v211, v75, vcc
    v_cvt_pk_bf16_f32 v204, v72, v73
    v_lshlrev_b32 v72, 16, v204
    v_and_b32 v73, 0xffff0000, v204
    v_cvt_pk_bf16_f32 v205, v74, v75
    v_lshlrev_b32 v74, 16, v205
    v_and_b32 v75, 0xffff0000, v205
    v_add_f32 v72, 0x358637bd, v72
    v_add_f32 v73, 0x358637bd, v73
    v_add_f32 v74, 0x358637bd, v74
    v_add_f32 v75, 0x358637bd, v75
    v_cvt_pk_bf16_f32 v204, v72, v73
    v_lshlrev_b32 v72, 16, v204
    v_and_b32 v73, 0xffff0000, v204
    v_cvt_pk_bf16_f32 v205, v74, v75
    v_lshlrev_b32 v74, 16, v205
    v_and_b32 v75, 0xffff0000, v205
    v_add_f32 v212, v212, v72
    v_add_f32 v212, v212, v73
    v_add_f32 v212, v212, v74
    v_add_f32 v212, v212, v75
    v_cvt_pk_bf16_f32 v222, v72, v73
    v_cvt_pk_bf16_f32 v223, v74, v75
    v_fma_f32 v76, -v188, v167, v76
    v_mul_f32 v76, v76, v189
    v_fma_f32 v77, -v190, v167, v77
    v_mul_f32 v77, v77, v191
    v_fma_f32 v78, -v192, v167, v78
    v_mul_f32 v78, v78, v193
    v_fma_f32 v79, -v194, v167, v79
    v_mul_f32 v79, v79, v195
    v_cvt_pk_bf16_f32 v204, v76, v77
    v_lshlrev_b32 v76, 16, v204
    v_and_b32 v77, 0xffff0000, v204
    v_cvt_pk_bf16_f32 v205, v78, v79
    v_lshlrev_b32 v78, 16, v205
    v_and_b32 v79, 0xffff0000, v205
    v_mul_f32 v208, 0x3fb8aa3b, v76
    v_exp_f32 v208, v208
    v_cmp_lt_f32 vcc, 0, v76
    v_add_f32 v76, 1.0, v76
    v_cndmask_b32 v76, v208, v76, vcc
    v_mul_f32 v209, 0x3fb8aa3b, v77
    v_exp_f32 v209, v209
    v_cmp_lt_f32 vcc, 0, v77
    v_add_f32 v77, 1.0, v77
    v_cndmask_b32 v77, v209, v77, vcc
    v_mul_f32 v210, 0x3fb8aa3b, v78
    v_exp_f32 v210, v210
    v_cmp_lt_f32 vcc, 0, v78
    v_add_f32 v78, 1.0, v78
    v_cndmask_b32 v78, v210, v78, vcc
    v_mul_f32 v211, 0x3fb8aa3b, v79
    v_exp_f32 v211, v211
    v_cmp_lt_f32 vcc, 0, v79
    v_add_f32 v79, 1.0, v79
    v_cndmask_b32 v79, v211, v79, vcc
    v_cvt_pk_bf16_f32 v204, v76, v77
    v_lshlrev_b32 v76, 16, v204
    v_and_b32 v77, 0xffff0000, v204
    v_cvt_pk_bf16_f32 v205, v78, v79
    v_lshlrev_b32 v78, 16, v205
    v_and_b32 v79, 0xffff0000, v205
    v_add_f32 v76, 0x358637bd, v76
    v_add_f32 v77, 0x358637bd, v77
    v_add_f32 v78, 0x358637bd, v78
    v_add_f32 v79, 0x358637bd, v79
    v_cvt_pk_bf16_f32 v204, v76, v77
    v_lshlrev_b32 v76, 16, v204
    v_and_b32 v77, 0xffff0000, v204
    v_cvt_pk_bf16_f32 v205, v78, v79
    v_lshlrev_b32 v78, 16, v205
    v_and_b32 v79, 0xffff0000, v205
    v_add_f32 v212, v212, v76
    v_add_f32 v212, v212, v77
    v_add_f32 v212, v212, v78
    v_add_f32 v212, v212, v79
    v_cvt_pk_bf16_f32 v224, v76, v77
    v_cvt_pk_bf16_f32 v225, v78, v79
    v_fma_f32 v80, -v196, v167, v80
    v_mul_f32 v80, v80, v197
    v_fma_f32 v81, -v198, v167, v81
    v_mul_f32 v81, v81, v199
    v_fma_f32 v82, -v200, v167, v82
    v_mul_f32 v82, v82, v201
    v_fma_f32 v83, -v202, v167, v83
    v_mul_f32 v83, v83, v203
    v_cvt_pk_bf16_f32 v204, v80, v81
    v_lshlrev_b32 v80, 16, v204
    v_and_b32 v81, 0xffff0000, v204
    v_cvt_pk_bf16_f32 v205, v82, v83
    v_lshlrev_b32 v82, 16, v205
    v_and_b32 v83, 0xffff0000, v205
    v_mul_f32 v208, 0x3fb8aa3b, v80
    v_exp_f32 v208, v208
    v_cmp_lt_f32 vcc, 0, v80
    v_add_f32 v80, 1.0, v80
    v_cndmask_b32 v80, v208, v80, vcc
    v_mul_f32 v209, 0x3fb8aa3b, v81
    v_exp_f32 v209, v209
    v_cmp_lt_f32 vcc, 0, v81
    v_add_f32 v81, 1.0, v81
    v_cndmask_b32 v81, v209, v81, vcc
    v_mul_f32 v210, 0x3fb8aa3b, v82
    v_exp_f32 v210, v210
    v_cmp_lt_f32 vcc, 0, v82
    v_add_f32 v82, 1.0, v82
    v_cndmask_b32 v82, v210, v82, vcc
    v_mul_f32 v211, 0x3fb8aa3b, v83
    v_exp_f32 v211, v211
    v_cmp_lt_f32 vcc, 0, v83
    v_add_f32 v83, 1.0, v83
    v_cndmask_b32 v83, v211, v83, vcc
    v_cvt_pk_bf16_f32 v204, v80, v81
    v_lshlrev_b32 v80, 16, v204
    v_and_b32 v81, 0xffff0000, v204
    v_cvt_pk_bf16_f32 v205, v82, v83
    v_lshlrev_b32 v82, 16, v205
    v_and_b32 v83, 0xffff0000, v205
    v_add_f32 v80, 0x358637bd, v80
    v_add_f32 v81, 0x358637bd, v81
    v_add_f32 v82, 0x358637bd, v82
    v_add_f32 v83, 0x358637bd, v83
    v_cvt_pk_bf16_f32 v204, v80, v81
    v_lshlrev_b32 v80, 16, v204
    v_and_b32 v81, 0xffff0000, v204
    v_cvt_pk_bf16_f32 v205, v82, v83
    v_lshlrev_b32 v82, 16, v205
    v_and_b32 v83, 0xffff0000, v205
    v_add_f32 v212, v212, v80
    v_add_f32 v212, v212, v81
    v_add_f32 v212, v212, v82
    v_add_f32 v212, v212, v83
    v_cvt_pk_bf16_f32 v226, v80, v81
    v_cvt_pk_bf16_f32 v227, v82, v83
    ds_write_b128 v228, v[220:223] offset:9216
    ds_write_b128 v228, v[224:227] offset:10240
    v_mov_b32 v213, v212
    s_nop 1
    v_permlane32_swap_b32 v212, v213
    s_nop 1
    v_add_f32 v212, v212, v213
    v_lshlrev_b32 v213, 2, v160
    s_mul_i32 s65, s84, 640
    s_add_u32 s65, s65, 164352
    v_cmp_gt_u32 vcc, 32, v160
    s_and_saveexec_b64 s[76:77], vcc
    buffer_atomic_add_f32 v212, v213, s[52:55], s65 offen
    s_or_b64 exec, exec, s[76:77]
    s_nop 1
    s_branch .kv_j_3
.kv_v_2:
    v_fma_f32 v4, -v172, v163, v4
    v_mul_f32 v4, v4, v173
    v_fma_f32 v5, -v174, v163, v5
    v_mul_f32 v5, v5, v175
    v_fma_f32 v6, -v176, v163, v6
    v_mul_f32 v6, v6, v177
    v_fma_f32 v7, -v178, v163, v7
    v_mul_f32 v7, v7, v179
    v_cvt_pk_bf16_f32 v204, v4, v5
    v_lshlrev_b32 v4, 16, v204
    v_and_b32 v5, 0xffff0000, v204
    v_cvt_pk_bf16_f32 v205, v6, v7
    v_lshlrev_b32 v6, 16, v205
    v_and_b32 v7, 0xffff0000, v205
    v_cvt_pk_bf16_f32 v220, v4, v5
    v_cvt_pk_bf16_f32 v221, v6, v7
    v_fma_f32 v8, -v180, v163, v8
    v_mul_f32 v8, v8, v181
    v_fma_f32 v9, -v182, v163, v9
    v_mul_f32 v9, v9, v183
    v_fma_f32 v10, -v184, v163, v10
    v_mul_f32 v10, v10, v185
    v_fma_f32 v11, -v186, v163, v11
    v_mul_f32 v11, v11, v187
    v_cvt_pk_bf16_f32 v204, v8, v9
    v_lshlrev_b32 v8, 16, v204
    v_and_b32 v9, 0xffff0000, v204
    v_cvt_pk_bf16_f32 v205, v10, v11
    v_lshlrev_b32 v10, 16, v205
    v_and_b32 v11, 0xffff0000, v205
    v_cvt_pk_bf16_f32 v222, v8, v9
    v_cvt_pk_bf16_f32 v223, v10, v11
    v_fma_f32 v12, -v188, v163, v12
    v_mul_f32 v12, v12, v189
    v_fma_f32 v13, -v190, v163, v13
    v_mul_f32 v13, v13, v191
    v_fma_f32 v14, -v192, v163, v14
    v_mul_f32 v14, v14, v193
    v_fma_f32 v15, -v194, v163, v15
    v_mul_f32 v15, v15, v195
    v_cvt_pk_bf16_f32 v204, v12, v13
    v_lshlrev_b32 v12, 16, v204
    v_and_b32 v13, 0xffff0000, v204
    v_cvt_pk_bf16_f32 v205, v14, v15
    v_lshlrev_b32 v14, 16, v205
    v_and_b32 v15, 0xffff0000, v205
    v_cvt_pk_bf16_f32 v224, v12, v13
    v_cvt_pk_bf16_f32 v225, v14, v15
    v_fma_f32 v16, -v196, v163, v16
    v_mul_f32 v16, v16, v197
    v_fma_f32 v17, -v198, v163, v17
    v_mul_f32 v17, v17, v199
    v_fma_f32 v18, -v200, v163, v18
    v_mul_f32 v18, v18, v201
    v_fma_f32 v19, -v202, v163, v19
    v_mul_f32 v19, v19, v203
    v_cvt_pk_bf16_f32 v204, v16, v17
    v_lshlrev_b32 v16, 16, v204
    v_and_b32 v17, 0xffff0000, v204
    v_cvt_pk_bf16_f32 v205, v18, v19
    v_lshlrev_b32 v18, 16, v205
    v_and_b32 v19, 0xffff0000, v205
    v_cvt_pk_bf16_f32 v226, v16, v17
    v_cvt_pk_bf16_f32 v227, v18, v19
    ds_write_b128 v228, v[220:223] offset:1024
    ds_write_b128 v228, v[224:227] offset:2048
    s_nop 1
    v_fma_f32 v20, -v172, v164, v20
    v_mul_f32 v20, v20, v173
    v_fma_f32 v21, -v174, v164, v21
    v_mul_f32 v21, v21, v175
    v_fma_f32 v22, -v176, v164, v22
    v_mul_f32 v22, v22, v177
    v_fma_f32 v23, -v178, v164, v23
    v_mul_f32 v23, v23, v179
    v_cvt_pk_bf16_f32 v204, v20, v21
    v_lshlrev_b32 v20, 16, v204
    v_and_b32 v21, 0xffff0000, v204
    v_cvt_pk_bf16_f32 v205, v22, v23
    v_lshlrev_b32 v22, 16, v205
    v_and_b32 v23, 0xffff0000, v205
    v_cvt_pk_bf16_f32 v220, v20, v21
    v_cvt_pk_bf16_f32 v221, v22, v23
    v_fma_f32 v24, -v180, v164, v24
    v_mul_f32 v24, v24, v181
    v_fma_f32 v25, -v182, v164, v25
    v_mul_f32 v25, v25, v183
    v_fma_f32 v26, -v184, v164, v26
    v_mul_f32 v26, v26, v185
    v_fma_f32 v27, -v186, v164, v27
    v_mul_f32 v27, v27, v187
    v_cvt_pk_bf16_f32 v204, v24, v25
    v_lshlrev_b32 v24, 16, v204
    v_and_b32 v25, 0xffff0000, v204
    v_cvt_pk_bf16_f32 v205, v26, v27
    v_lshlrev_b32 v26, 16, v205
    v_and_b32 v27, 0xffff0000, v205
    v_cvt_pk_bf16_f32 v222, v24, v25
    v_cvt_pk_bf16_f32 v223, v26, v27
    v_fma_f32 v28, -v188, v164, v28
    v_mul_f32 v28, v28, v189
    v_fma_f32 v29, -v190, v164, v29
    v_mul_f32 v29, v29, v191
    v_fma_f32 v30, -v192, v164, v30
    v_mul_f32 v30, v30, v193
    v_fma_f32 v31, -v194, v164, v31
    v_mul_f32 v31, v31, v195
    v_cvt_pk_bf16_f32 v204, v28, v29
    v_lshlrev_b32 v28, 16, v204
    v_and_b32 v29, 0xffff0000, v204
    v_cvt_pk_bf16_f32 v205, v30, v31
    v_lshlrev_b32 v30, 16, v205
    v_and_b32 v31, 0xffff0000, v205
    v_cvt_pk_bf16_f32 v224, v28, v29
    v_cvt_pk_bf16_f32 v225, v30, v31
    v_fma_f32 v32, -v196, v164, v32
    v_mul_f32 v32, v32, v197
    v_fma_f32 v33, -v198, v164, v33
    v_mul_f32 v33, v33, v199
    v_fma_f32 v34, -v200, v164, v34
    v_mul_f32 v34, v34, v201
    v_fma_f32 v35, -v202, v164, v35
    v_mul_f32 v35, v35, v203
    v_cvt_pk_bf16_f32 v204, v32, v33
    v_lshlrev_b32 v32, 16, v204
    v_and_b32 v33, 0xffff0000, v204
    v_cvt_pk_bf16_f32 v205, v34, v35
    v_lshlrev_b32 v34, 16, v205
    v_and_b32 v35, 0xffff0000, v205
    v_cvt_pk_bf16_f32 v226, v32, v33
    v_cvt_pk_bf16_f32 v227, v34, v35
    ds_write_b128 v228, v[220:223] offset:3072
    ds_write_b128 v228, v[224:227] offset:4096
    s_nop 1
    v_fma_f32 v36, -v172, v165, v36
    v_mul_f32 v36, v36, v173
    v_fma_f32 v37, -v174, v165, v37
    v_mul_f32 v37, v37, v175
    v_fma_f32 v38, -v176, v165, v38
    v_mul_f32 v38, v38, v177
    v_fma_f32 v39, -v178, v165, v39
    v_mul_f32 v39, v39, v179
    v_cvt_pk_bf16_f32 v204, v36, v37
    v_lshlrev_b32 v36, 16, v204
    v_and_b32 v37, 0xffff0000, v204
    v_cvt_pk_bf16_f32 v205, v38, v39
    v_lshlrev_b32 v38, 16, v205
    v_and_b32 v39, 0xffff0000, v205
    v_cvt_pk_bf16_f32 v220, v36, v37
    v_cvt_pk_bf16_f32 v221, v38, v39
    v_fma_f32 v40, -v180, v165, v40
    v_mul_f32 v40, v40, v181
    v_fma_f32 v41, -v182, v165, v41
    v_mul_f32 v41, v41, v183
    v_fma_f32 v42, -v184, v165, v42
    v_mul_f32 v42, v42, v185
    v_fma_f32 v43, -v186, v165, v43
    v_mul_f32 v43, v43, v187
    v_cvt_pk_bf16_f32 v204, v40, v41
    v_lshlrev_b32 v40, 16, v204
    v_and_b32 v41, 0xffff0000, v204
    v_cvt_pk_bf16_f32 v205, v42, v43
    v_lshlrev_b32 v42, 16, v205
    v_and_b32 v43, 0xffff0000, v205
    v_cvt_pk_bf16_f32 v222, v40, v41
    v_cvt_pk_bf16_f32 v223, v42, v43
    v_fma_f32 v44, -v188, v165, v44
    v_mul_f32 v44, v44, v189
    v_fma_f32 v45, -v190, v165, v45
    v_mul_f32 v45, v45, v191
    v_fma_f32 v46, -v192, v165, v46
    v_mul_f32 v46, v46, v193
    v_fma_f32 v47, -v194, v165, v47
    v_mul_f32 v47, v47, v195
    v_cvt_pk_bf16_f32 v204, v44, v45
    v_lshlrev_b32 v44, 16, v204
    v_and_b32 v45, 0xffff0000, v204
    v_cvt_pk_bf16_f32 v205, v46, v47
    v_lshlrev_b32 v46, 16, v205
    v_and_b32 v47, 0xffff0000, v205
    v_cvt_pk_bf16_f32 v224, v44, v45
    v_cvt_pk_bf16_f32 v225, v46, v47
    v_fma_f32 v48, -v196, v165, v48
    v_mul_f32 v48, v48, v197
    v_fma_f32 v49, -v198, v165, v49
    v_mul_f32 v49, v49, v199
    v_fma_f32 v50, -v200, v165, v50
    v_mul_f32 v50, v50, v201
    v_fma_f32 v51, -v202, v165, v51
    v_mul_f32 v51, v51, v203
    v_cvt_pk_bf16_f32 v204, v48, v49
    v_lshlrev_b32 v48, 16, v204
    v_and_b32 v49, 0xffff0000, v204
    v_cvt_pk_bf16_f32 v205, v50, v51
    v_lshlrev_b32 v50, 16, v205
    v_and_b32 v51, 0xffff0000, v205
    v_cvt_pk_bf16_f32 v226, v48, v49
    v_cvt_pk_bf16_f32 v227, v50, v51
    ds_write_b128 v228, v[220:223] offset:5120
    ds_write_b128 v228, v[224:227] offset:6144
    s_nop 1
    v_fma_f32 v52, -v172, v166, v52
    v_mul_f32 v52, v52, v173
    v_fma_f32 v53, -v174, v166, v53
    v_mul_f32 v53, v53, v175
    v_fma_f32 v54, -v176, v166, v54
    v_mul_f32 v54, v54, v177
    v_fma_f32 v55, -v178, v166, v55
    v_mul_f32 v55, v55, v179
    v_cvt_pk_bf16_f32 v204, v52, v53
    v_lshlrev_b32 v52, 16, v204
    v_and_b32 v53, 0xffff0000, v204
    v_cvt_pk_bf16_f32 v205, v54, v55
    v_lshlrev_b32 v54, 16, v205
    v_and_b32 v55, 0xffff0000, v205
    v_cvt_pk_bf16_f32 v220, v52, v53
    v_cvt_pk_bf16_f32 v221, v54, v55
    v_fma_f32 v56, -v180, v166, v56
    v_mul_f32 v56, v56, v181
    v_fma_f32 v57, -v182, v166, v57
    v_mul_f32 v57, v57, v183
    v_fma_f32 v58, -v184, v166, v58
    v_mul_f32 v58, v58, v185
    v_fma_f32 v59, -v186, v166, v59
    v_mul_f32 v59, v59, v187
    v_cvt_pk_bf16_f32 v204, v56, v57
    v_lshlrev_b32 v56, 16, v204
    v_and_b32 v57, 0xffff0000, v204
    v_cvt_pk_bf16_f32 v205, v58, v59
    v_lshlrev_b32 v58, 16, v205
    v_and_b32 v59, 0xffff0000, v205
    v_cvt_pk_bf16_f32 v222, v56, v57
    v_cvt_pk_bf16_f32 v223, v58, v59
    v_fma_f32 v60, -v188, v166, v60
    v_mul_f32 v60, v60, v189
    v_fma_f32 v61, -v190, v166, v61
    v_mul_f32 v61, v61, v191
    v_fma_f32 v62, -v192, v166, v62
    v_mul_f32 v62, v62, v193
    v_fma_f32 v63, -v194, v166, v63
    v_mul_f32 v63, v63, v195
    v_cvt_pk_bf16_f32 v204, v60, v61
    v_lshlrev_b32 v60, 16, v204
    v_and_b32 v61, 0xffff0000, v204
    v_cvt_pk_bf16_f32 v205, v62, v63
    v_lshlrev_b32 v62, 16, v205
    v_and_b32 v63, 0xffff0000, v205
    v_cvt_pk_bf16_f32 v224, v60, v61
    v_cvt_pk_bf16_f32 v225, v62, v63
    v_fma_f32 v64, -v196, v166, v64
    v_mul_f32 v64, v64, v197
    v_fma_f32 v65, -v198, v166, v65
    v_mul_f32 v65, v65, v199
    v_fma_f32 v66, -v200, v166, v66
    v_mul_f32 v66, v66, v201
    v_fma_f32 v67, -v202, v166, v67
    v_mul_f32 v67, v67, v203
    v_cvt_pk_bf16_f32 v204, v64, v65
    v_lshlrev_b32 v64, 16, v204
    v_and_b32 v65, 0xffff0000, v204
    v_cvt_pk_bf16_f32 v205, v66, v67
    v_lshlrev_b32 v66, 16, v205
    v_and_b32 v67, 0xffff0000, v205
    v_cvt_pk_bf16_f32 v226, v64, v65
    v_cvt_pk_bf16_f32 v227, v66, v67
    ds_write_b128 v228, v[220:223] offset:7168
    ds_write_b128 v228, v[224:227] offset:8192
    s_nop 1
    v_fma_f32 v68, -v172, v167, v68
    v_mul_f32 v68, v68, v173
    v_fma_f32 v69, -v174, v167, v69
    v_mul_f32 v69, v69, v175
    v_fma_f32 v70, -v176, v167, v70
    v_mul_f32 v70, v70, v177
    v_fma_f32 v71, -v178, v167, v71
    v_mul_f32 v71, v71, v179
    v_cvt_pk_bf16_f32 v204, v68, v69
    v_lshlrev_b32 v68, 16, v204
    v_and_b32 v69, 0xffff0000, v204
    v_cvt_pk_bf16_f32 v205, v70, v71
    v_lshlrev_b32 v70, 16, v205
    v_and_b32 v71, 0xffff0000, v205
    v_cvt_pk_bf16_f32 v220, v68, v69
    v_cvt_pk_bf16_f32 v221, v70, v71
    v_fma_f32 v72, -v180, v167, v72
    v_mul_f32 v72, v72, v181
    v_fma_f32 v73, -v182, v167, v73
    v_mul_f32 v73, v73, v183
    v_fma_f32 v74, -v184, v167, v74
    v_mul_f32 v74, v74, v185
    v_fma_f32 v75, -v186, v167, v75
    v_mul_f32 v75, v75, v187
    v_cvt_pk_bf16_f32 v204, v72, v73
    v_lshlrev_b32 v72, 16, v204
    v_and_b32 v73, 0xffff0000, v204
    v_cvt_pk_bf16_f32 v205, v74, v75
    v_lshlrev_b32 v74, 16, v205
    v_and_b32 v75, 0xffff0000, v205
    v_cvt_pk_bf16_f32 v222, v72, v73
    v_cvt_pk_bf16_f32 v223, v74, v75
    v_fma_f32 v76, -v188, v167, v76
    v_mul_f32 v76, v76, v189
    v_fma_f32 v77, -v190, v167, v77
    v_mul_f32 v77, v77, v191
    v_fma_f32 v78, -v192, v167, v78
    v_mul_f32 v78, v78, v193
    v_fma_f32 v79, -v194, v167, v79
    v_mul_f32 v79, v79, v195
    v_cvt_pk_bf16_f32 v204, v76, v77
    v_lshlrev_b32 v76, 16, v204
    v_and_b32 v77, 0xffff0000, v204
    v_cvt_pk_bf16_f32 v205, v78, v79
    v_lshlrev_b32 v78, 16, v205
    v_and_b32 v79, 0xffff0000, v205
    v_cvt_pk_bf16_f32 v224, v76, v77
    v_cvt_pk_bf16_f32 v225, v78, v79
    v_fma_f32 v80, -v196, v167, v80
    v_mul_f32 v80, v80, v197
    v_fma_f32 v81, -v198, v167, v81
    v_mul_f32 v81, v81, v199
    v_fma_f32 v82, -v200, v167, v82
    v_mul_f32 v82, v82, v201
    v_fma_f32 v83, -v202, v167, v83
    v_mul_f32 v83, v83, v203
    v_cvt_pk_bf16_f32 v204, v80, v81
    v_lshlrev_b32 v80, 16, v204
    v_and_b32 v81, 0xffff0000, v204
    v_cvt_pk_bf16_f32 v205, v82, v83
    v_lshlrev_b32 v82, 16, v205
    v_and_b32 v83, 0xffff0000, v205
    v_cvt_pk_bf16_f32 v226, v80, v81
    v_cvt_pk_bf16_f32 v227, v82, v83
    ds_write_b128 v228, v[220:223] offset:9216
    ds_write_b128 v228, v[224:227] offset:10240
    s_nop 1
.kv_j_3:
    s_waitcnt lgkmcnt(0)
    s_barrier
    v_and_b32 v229, 31, v160
    v_lshlrev_b32 v229, 2, v229
    v_lshrrev_b32 v230, 5, v160
    v_lshl_add_u32 v229, v230, 10, v229
    v_lshlrev_b32 v230, 4, v160
    s_mul_i32 s85, s84, 40960
    s_cmp_eq_u32 s60, 1
    s_cbranch_scc1 .kvw_5
    s_cmp_eq_u32 s60, 2
    s_cbranch_scc1 .kvw_6
    s_cmp_eq_u32 s60, 3
    s_cbranch_scc1 .kvw_7
.kvw_4:
    v_mov_b32 v4, 0
    v_mov_b32 v5, 0
    v_mov_b32 v6, 0
    v_mov_b32 v7, 0
    v_mov_b32 v8, 0
    v_mov_b32 v9, 0
    v_mov_b32 v10, 0
    v_mov_b32 v11, 0
    v_mov_b32 v12, 0
    v_mov_b32 v13, 0
    v_mov_b32 v14, 0
    v_mov_b32 v15, 0
    v_mov_b32 v16, 0
    v_mov_b32 v17, 0
    v_mov_b32 v18, 0
    v_mov_b32 v19, 0
    ds_read_b128 v[84:87], v230 offset:21504
    ds_read_b128 v[92:95], v230 offset:1024
    s_waitcnt lgkmcnt(0)
    v_mfma_f32_32x32x16_bf16 v[4:19], v[84:87], v[92:95], v[4:19]
    ds_read_b128 v[84:87], v230 offset:22528
    ds_read_b128 v[92:95], v230 offset:2048
    s_waitcnt lgkmcnt(0)
    v_mfma_f32_32x32x16_bf16 v[4:19], v[84:87], v[92:95], v[4:19]
    ds_read_b128 v[84:87], v230 offset:31744
    ds_read_b128 v[92:95], v230 offset:11264
    s_waitcnt lgkmcnt(0)
    v_mfma_f32_32x32x16_bf16 v[4:19], v[84:87], v[92:95], v[4:19]
    ds_read_b128 v[84:87], v230 offset:32768
    ds_read_b128 v[92:95], v230 offset:12288
    s_waitcnt lgkmcnt(0)
    v_mfma_f32_32x32x16_bf16 v[4:19], v[84:87], v[92:95], v[4:19]
    s_nop 7
    s_nop 7
    s_add_u32 s65, s85, 0
    s_mov_b32 exec_lo, 1048575
    s_mov_b32 exec_hi, 1048575
    buffer_atomic_add_f32 v4, v229, s[52:55], s65 offen
    s_add_u32 s65, s85, 256
    s_mov_b32 exec_lo, 1048575
    s_mov_b32 exec_hi, 1048575
    buffer_atomic_add_f32 v5, v229, s[52:55], s65 offen
    s_add_u32 s65, s85, 512
    s_mov_b32 exec_lo, 1048575
    s_mov_b32 exec_hi, 1048575
    buffer_atomic_add_f32 v6, v229, s[52:55], s65 offen
    s_add_u32 s65, s85, 768
    s_mov_b32 exec_lo, 1048575
    s_mov_b32 exec_hi, 1048575
    buffer_atomic_add_f32 v7, v229, s[52:55], s65 offen
    s_add_u32 s65, s85, 2048
    s_mov_b32 exec_lo, 1048575
    s_mov_b32 exec_hi, 1048575
    buffer_atomic_add_f32 v8, v229, s[52:55], s65 offen
    s_add_u32 s65, s85, 2304
    s_mov_b32 exec_lo, 1048575
    s_mov_b32 exec_hi, 1048575
    buffer_atomic_add_f32 v9, v229, s[52:55], s65 offen
    s_add_u32 s65, s85, 2560
    s_mov_b32 exec_lo, 1048575
    s_mov_b32 exec_hi, 1048575
    buffer_atomic_add_f32 v10, v229, s[52:55], s65 offen
    s_add_u32 s65, s85, 2816
    s_mov_b32 exec_lo, 1048575
    s_mov_b32 exec_hi, 1048575
    buffer_atomic_add_f32 v11, v229, s[52:55], s65 offen
    s_add_u32 s65, s85, 4096
    s_mov_b32 exec_lo, 1048575
    s_mov_b32 exec_hi, 4293918720
    buffer_atomic_add_f32 v12, v229, s[52:55], s65 offen
    s_add_u32 s65, s85, 4352
    s_mov_b32 exec_lo, 1048575
    s_mov_b32 exec_hi, 4293918720
    buffer_atomic_add_f32 v13, v229, s[52:55], s65 offen
    s_add_u32 s65, s85, 4608
    s_mov_b32 exec_lo, 1048575
    s_mov_b32 exec_hi, 4293918720
    buffer_atomic_add_f32 v14, v229, s[52:55], s65 offen
    s_add_u32 s65, s85, 4864
    s_mov_b32 exec_lo, 1048575
    s_mov_b32 exec_hi, 4293918720
    buffer_atomic_add_f32 v15, v229, s[52:55], s65 offen
    s_add_u32 s65, s85, 6144
    s_mov_b32 exec_lo, 4293918720
    s_mov_b32 exec_hi, 4293918720
    buffer_atomic_add_f32 v16, v229, s[52:55], s65 offen
    s_add_u32 s65, s85, 6400
    s_mov_b32 exec_lo, 4293918720
    s_mov_b32 exec_hi, 4293918720
    buffer_atomic_add_f32 v17, v229, s[52:55], s65 offen
    s_add_u32 s65, s85, 6656
    s_mov_b32 exec_lo, 4293918720
    s_mov_b32 exec_hi, 4293918720
    buffer_atomic_add_f32 v18, v229, s[52:55], s65 offen
    s_add_u32 s65, s85, 6912
    s_mov_b32 exec_lo, 4293918720
    s_mov_b32 exec_hi, 4293918720
    buffer_atomic_add_f32 v19, v229, s[52:55], s65 offen
    s_mov_b64 exec, -1
    v_mov_b32 v4, 0
    v_mov_b32 v5, 0
    v_mov_b32 v6, 0
    v_mov_b32 v7, 0
    v_mov_b32 v8, 0
    v_mov_b32 v9, 0
    v_mov_b32 v10, 0
    v_mov_b32 v11, 0
    v_mov_b32 v12, 0
    v_mov_b32 v13, 0
    v_mov_b32 v14, 0
    v_mov_b32 v15, 0
    v_mov_b32 v16, 0
    v_mov_b32 v17, 0
    v_mov_b32 v18, 0
    v_mov_b32 v19, 0
    ds_read_b128 v[84:87], v230 offset:25600
    ds_read_b128 v[92:95], v230 offset:3072
    s_waitcnt lgkmcnt(0)
    v_mfma_f32_32x32x16_bf16 v[4:19], v[84:87], v[92:95], v[4:19]
    ds_read_b128 v[84:87], v230 offset:26624
    ds_read_b128 v[92:95], v230 offset:4096
    s_waitcnt lgkmcnt(0)
    v_mfma_f32_32x32x16_bf16 v[4:19], v[84:87], v[92:95], v[4:19]
    ds_read_b128 v[84:87], v230 offset:35840
    ds_read_b128 v[92:95], v230 offset:13312
    s_waitcnt lgkmcnt(0)
    v_mfma_f32_32x32x16_bf16 v[4:19], v[84:87], v[92:95], v[4:19]
    ds_read_b128 v[84:87], v230 offset:36864
    ds_read_b128 v[92:95], v230 offset:14336
    s_waitcnt lgkmcnt(0)
    v_mfma_f32_32x32x16_bf16 v[4:19], v[84:87], v[92:95], v[4:19]
    s_nop 7
    s_nop 7
    s_add_u32 s65, s85, 16320
    s_mov_b32 exec_lo, 4026531840
    s_mov_b32 exec_hi, 4026531840
    buffer_atomic_add_f32 v4, v229, s[52:55], s65 offen
    s_add_u32 s65, s85, 16576
    s_mov_b32 exec_lo, 4026531840
    s_mov_b32 exec_hi, 4026531840
    buffer_atomic_add_f32 v5, v229, s[52:55], s65 offen
    s_add_u32 s65, s85, 16832
    s_mov_b32 exec_lo, 4026531840
    s_mov_b32 exec_hi, 4026531840
    buffer_atomic_add_f32 v6, v229, s[52:55], s65 offen
    s_add_u32 s65, s85, 17088
    s_mov_b32 exec_lo, 4026531840
    s_mov_b32 exec_hi, 4026531840
    buffer_atomic_add_f32 v7, v229, s[52:55], s65 offen
    s_add_u32 s65, s85, 18368
    s_mov_b32 exec_lo, 4026531840
    s_mov_b32 exec_hi, 4026531840
    buffer_atomic_add_f32 v8, v229, s[52:55], s65 offen
    s_add_u32 s65, s85, 18624
    s_mov_b32 exec_lo, 4026531840
    s_mov_b32 exec_hi, 4026531840
    buffer_atomic_add_f32 v9, v229, s[52:55], s65 offen
    s_add_u32 s65, s85, 18880
    s_mov_b32 exec_lo, 4026531840
    s_mov_b32 exec_hi, 4026531840
    buffer_atomic_add_f32 v10, v229, s[52:55], s65 offen
    s_add_u32 s65, s85, 19136
    s_mov_b32 exec_lo, 4026531840
    s_mov_b32 exec_hi, 4026531840
    buffer_atomic_add_f32 v11, v229, s[52:55], s65 offen
    s_mov_b64 exec, -1
    v_mov_b32 v4, 0
    v_mov_b32 v5, 0
    v_mov_b32 v6, 0
    v_mov_b32 v7, 0
    v_mov_b32 v8, 0
    v_mov_b32 v9, 0
    v_mov_b32 v10, 0
    v_mov_b32 v11, 0
    v_mov_b32 v12, 0
    v_mov_b32 v13, 0
    v_mov_b32 v14, 0
    v_mov_b32 v15, 0
    v_mov_b32 v16, 0
    v_mov_b32 v17, 0
    v_mov_b32 v18, 0
    v_mov_b32 v19, 0
    ds_read_b128 v[84:87], v230 offset:25600
    ds_read_b128 v[92:95], v230 offset:7168
    s_waitcnt lgkmcnt(0)
    v_mfma_f32_32x32x16_bf16 v[4:19], v[84:87], v[92:95], v[4:19]
    ds_read_b128 v[84:87], v230 offset:26624
    ds_read_b128 v[92:95], v230 offset:8192
    s_waitcnt lgkmcnt(0)
    v_mfma_f32_32x32x16_bf16 v[4:19], v[84:87], v[92:95], v[4:19]
    ds_read_b128 v[84:87], v230 offset:35840
    ds_read_b128 v[92:95], v230 offset:17408
    s_waitcnt lgkmcnt(0)
    v_mfma_f32_32x32x16_bf16 v[4:19], v[84:87], v[92:95], v[4:19]
    ds_read_b128 v[84:87], v230 offset:36864
    ds_read_b128 v[92:95], v230 offset:18432
    s_waitcnt lgkmcnt(0)
    v_mfma_f32_32x32x16_bf16 v[4:19], v[84:87], v[92:95], v[4:19]
    s_nop 7
    s_nop 7
    s_add_u32 s65, s85, 20672
    s_mov_b32 exec_lo, 15
    s_mov_b32 exec_hi, 15
    buffer_atomic_add_f32 v12, v229, s[52:55], s65 offen
    s_add_u32 s65, s85, 20928
    s_mov_b32 exec_lo, 15
    s_mov_b32 exec_hi, 15
    buffer_atomic_add_f32 v13, v229, s[52:55], s65 offen
    s_add_u32 s65, s85, 21184
    s_mov_b32 exec_lo, 15
    s_mov_b32 exec_hi, 15
    buffer_atomic_add_f32 v14, v229, s[52:55], s65 offen
    s_add_u32 s65, s85, 21440
    s_mov_b32 exec_lo, 15
    s_mov_b32 exec_hi, 15
    buffer_atomic_add_f32 v15, v229, s[52:55], s65 offen
    s_add_u32 s65, s85, 22720
    s_mov_b32 exec_lo, 15
    s_mov_b32 exec_hi, 15
    buffer_atomic_add_f32 v16, v229, s[52:55], s65 offen
    s_add_u32 s65, s85, 22976
    s_mov_b32 exec_lo, 15
    s_mov_b32 exec_hi, 15
    buffer_atomic_add_f32 v17, v229, s[52:55], s65 offen
    s_add_u32 s65, s85, 23232
    s_mov_b32 exec_lo, 15
    s_mov_b32 exec_hi, 15
    buffer_atomic_add_f32 v18, v229, s[52:55], s65 offen
    s_add_u32 s65, s85, 23488
    s_mov_b32 exec_lo, 15
    s_mov_b32 exec_hi, 15
    buffer_atomic_add_f32 v19, v229, s[52:55], s65 offen
    s_mov_b64 exec, -1
    v_mov_b32 v4, 0
    v_mov_b32 v5, 0
    v_mov_b32 v6, 0
    v_mov_b32 v7, 0
    v_mov_b32 v8, 0
    v_mov_b32 v9, 0
    v_mov_b32 v10, 0
    v_mov_b32 v11, 0
    v_mov_b32 v12, 0
    v_mov_b32 v13, 0
    v_mov_b32 v14, 0
    v_mov_b32 v15, 0
    v_mov_b32 v16, 0
    v_mov_b32 v17, 0
    v_mov_b32 v18, 0
    v_mov_b32 v19, 0
    ds_read_b128 v[84:87], v230 offset:29696
    ds_read_b128 v[92:95], v230 offset:9216
    s_waitcnt lgkmcnt(0)
    v_mfma_f32_32x32x16_bf16 v[4:19], v[84:87], v[92:95], v[4:19]
    ds_read_b128 v[84:87], v230 offset:30720
    ds_read_b128 v[92:95], v230 offset:10240
    s_waitcnt lgkmcnt(0)
    v_mfma_f32_32x32x16_bf16 v[4:19], v[84:87], v[92:95], v[4:19]
    ds_read_b128 v[84:87], v230 offset:39936
    ds_read_b128 v[92:95], v230 offset:19456
    s_waitcnt lgkmcnt(0)
    v_mfma_f32_32x32x16_bf16 v[4:19], v[84:87], v[92:95], v[4:19]
    ds_read_b128 v[84:87], v230 offset:40960
    ds_read_b128 v[92:95], v230 offset:20480
    s_waitcnt lgkmcnt(0)
    v_mfma_f32_32x32x16_bf16 v[4:19], v[84:87], v[92:95], v[4:19]
    s_nop 7
    s_nop 7
    s_add_u32 s65, s85, 32832
    s_mov_b32 exec_lo, 4095
    s_mov_b32 exec_hi, 4095
    buffer_atomic_add_f32 v4, v229, s[52:55], s65 offen
    s_add_u32 s65, s85, 33088
    s_mov_b32 exec_lo, 4095
    s_mov_b32 exec_hi, 4095
    buffer_atomic_add_f32 v5, v229, s[52:55], s65 offen
    s_add_u32 s65, s85, 33344
    s_mov_b32 exec_lo, 4095
    s_mov_b32 exec_hi, 4095
    buffer_atomic_add_f32 v6, v229, s[52:55], s65 offen
    s_add_u32 s65, s85, 33600
    s_mov_b32 exec_lo, 4095
    s_mov_b32 exec_hi, 4095
    buffer_atomic_add_f32 v7, v229, s[52:55], s65 offen
    s_add_u32 s65, s85, 34880
    s_mov_b32 exec_lo, 4095
    s_mov_b32 exec_hi, 4294963200
    buffer_atomic_add_f32 v8, v229, s[52:55], s65 offen
    s_add_u32 s65, s85, 35136
    s_mov_b32 exec_lo, 4095
    s_mov_b32 exec_hi, 4294963200
    buffer_atomic_add_f32 v9, v229, s[52:55], s65 offen
    s_add_u32 s65, s85, 35392
    s_mov_b32 exec_lo, 4095
    s_mov_b32 exec_hi, 4294963200
    buffer_atomic_add_f32 v10, v229, s[52:55], s65 offen
    s_add_u32 s65, s85, 35648
    s_mov_b32 exec_lo, 4095
    s_mov_b32 exec_hi, 4294963200
    buffer_atomic_add_f32 v11, v229, s[52:55], s65 offen
    s_add_u32 s65, s85, 36928
    s_mov_b32 exec_lo, 4294963200
    s_mov_b32 exec_hi, 4294963200
    buffer_atomic_add_f32 v12, v229, s[52:55], s65 offen
    s_add_u32 s65, s85, 37184
    s_mov_b32 exec_lo, 4294963200
    s_mov_b32 exec_hi, 4294963200
    buffer_atomic_add_f32 v13, v229, s[52:55], s65 offen
    s_add_u32 s65, s85, 37440
    s_mov_b32 exec_lo, 4294963200
    s_mov_b32 exec_hi, 4294963200
    buffer_atomic_add_f32 v14, v229, s[52:55], s65 offen
    s_add_u32 s65, s85, 37696
    s_mov_b32 exec_lo, 4294963200
    s_mov_b32 exec_hi, 4294963200
    buffer_atomic_add_f32 v15, v229, s[52:55], s65 offen
    s_add_u32 s65, s85, 38976
    s_mov_b32 exec_lo, 4294963200
    s_mov_b32 exec_hi, 4294963200
    buffer_atomic_add_f32 v16, v229, s[52:55], s65 offen
    s_add_u32 s65, s85, 39232
    s_mov_b32 exec_lo, 4294963200
    s_mov_b32 exec_hi, 4294963200
    buffer_atomic_add_f32 v17, v229, s[52:55], s65 offen
    s_add_u32 s65, s85, 39488
    s_mov_b32 exec_lo, 4294963200
    s_mov_b32 exec_hi, 4294963200
    buffer_atomic_add_f32 v18, v229, s[52:55], s65 offen
    s_add_u32 s65, s85, 39744
    s_mov_b32 exec_lo, 4294963200
    s_mov_b32 exec_hi, 4294963200
    buffer_atomic_add_f32 v19, v229, s[52:55], s65 offen
    s_mov_b64 exec, -1
    s_branch .kvend_8
.kvw_5:
    v_mov_b32 v4, 0
    v_mov_b32 v5, 0
    v_mov_b32 v6, 0
    v_mov_b32 v7, 0
    v_mov_b32 v8, 0
    v_mov_b32 v9, 0
    v_mov_b32 v10, 0
    v_mov_b32 v11, 0
    v_mov_b32 v12, 0
    v_mov_b32 v13, 0
    v_mov_b32 v14, 0
    v_mov_b32 v15, 0
    v_mov_b32 v16, 0
    v_mov_b32 v17, 0
    v_mov_b32 v18, 0
    v_mov_b32 v19, 0
    ds_read_b128 v[84:87], v230 offset:23552
    ds_read_b128 v[92:95], v230 offset:1024
    s_waitcnt lgkmcnt(0)
    v_mfma_f32_32x32x16_bf16 v[4:19], v[84:87], v[92:95], v[4:19]
    ds_read_b128 v[84:87], v230 offset:24576
    ds_read_b128 v[92:95], v230 offset:2048
    s_waitcnt lgkmcnt(0)
    v_mfma_f32_32x32x16_bf16 v[4:19], v[84:87], v[92:95], v[4:19]
    ds_read_b128 v[84:87], v230 offset:33792
    ds_read_b128 v[92:95], v230 offset:11264
    s_waitcnt lgkmcnt(0)
    v_mfma_f32_32x32x16_bf16 v[4:19], v[84:87], v[92:95], v[4:19]
    ds_read_b128 v[84:87], v230 offset:34816
    ds_read_b128 v[92:95], v230 offset:12288
    s_waitcnt lgkmcnt(0)
    v_mfma_f32_32x32x16_bf16 v[4:19], v[84:87], v[92:95], v[4:19]
    s_nop 7
    s_nop 7
    s_add_u32 s65, s85, 8128
    s_mov_b32 exec_lo, 4293918720
    s_mov_b32 exec_hi, 4293918720
    buffer_atomic_add_f32 v4, v229, s[52:55], s65 offen
    s_add_u32 s65, s85, 8384
    s_mov_b32 exec_lo, 4293918720
    s_mov_b32 exec_hi, 4293918720
    buffer_atomic_add_f32 v5, v229, s[52:55], s65 offen
    s_add_u32 s65, s85, 8640
    s_mov_b32 exec_lo, 4293918720
    s_mov_b32 exec_hi, 4293918720
    buffer_atomic_add_f32 v6, v229, s[52:55], s65 offen
    s_add_u32 s65, s85, 8896
    s_mov_b32 exec_lo, 4293918720
    s_mov_b32 exec_hi, 4293918720
    buffer_atomic_add_f32 v7, v229, s[52:55], s65 offen
    s_mov_b64 exec, -1
    v_mov_b32 v4, 0
    v_mov_b32 v5, 0
    v_mov_b32 v6, 0
    v_mov_b32 v7, 0
    v_mov_b32 v8, 0
    v_mov_b32 v9, 0
    v_mov_b32 v10, 0
    v_mov_b32 v11, 0
    v_mov_b32 v12, 0
    v_mov_b32 v13, 0
    v_mov_b32 v14, 0
    v_mov_b32 v15, 0
    v_mov_b32 v16, 0
    v_mov_b32 v17, 0
    v_mov_b32 v18, 0
    v_mov_b32 v19, 0
    ds_read_b128 v[84:87], v230 offset:23552
    ds_read_b128 v[92:95], v230 offset:5120
    s_waitcnt lgkmcnt(0)
    v_mfma_f32_32x32x16_bf16 v[4:19], v[84:87], v[92:95], v[4:19]
    ds_read_b128 v[84:87], v230 offset:24576
    ds_read_b128 v[92:95], v230 offset:6144
    s_waitcnt lgkmcnt(0)
    v_mfma_f32_32x32x16_bf16 v[4:19], v[84:87], v[92:95], v[4:19]
    ds_read_b128 v[84:87], v230 offset:33792
    ds_read_b128 v[92:95], v230 offset:15360
    s_waitcnt lgkmcnt(0)
    v_mfma_f32_32x32x16_bf16 v[4:19], v[84:87], v[92:95], v[4:19]
    ds_read_b128 v[84:87], v230 offset:34816
    ds_read_b128 v[92:95], v230 offset:16384
    s_waitcnt lgkmcnt(0)
    v_mfma_f32_32x32x16_bf16 v[4:19], v[84:87], v[92:95], v[4:19]
    s_nop 7
    s_nop 7
    s_add_u32 s65, s85, 14528
    s_mov_b32 exec_lo, 0
    s_mov_b32 exec_hi, 65535
    buffer_atomic_add_f32 v16, v229, s[52:55], s65 offen
    s_add_u32 s65, s85, 14784
    s_mov_b32 exec_lo, 0
    s_mov_b32 exec_hi, 65535
    buffer_atomic_add_f32 v17, v229, s[52:55], s65 offen
    s_add_u32 s65, s85, 15040
    s_mov_b32 exec_lo, 0
    s_mov_b32 exec_hi, 65535
    buffer_atomic_add_f32 v18, v229, s[52:55], s65 offen
    s_add_u32 s65, s85, 15296
    s_mov_b32 exec_lo, 0
    s_mov_b32 exec_hi, 65535
    buffer_atomic_add_f32 v19, v229, s[52:55], s65 offen
    s_mov_b64 exec, -1
    v_mov_b32 v4, 0
    v_mov_b32 v5, 0
    v_mov_b32 v6, 0
    v_mov_b32 v7, 0
    v_mov_b32 v8, 0
    v_mov_b32 v9, 0
    v_mov_b32 v10, 0
    v_mov_b32 v11, 0
    v_mov_b32 v12, 0
    v_mov_b32 v13, 0
    v_mov_b32 v14, 0
    v_mov_b32 v15, 0
    v_mov_b32 v16, 0
    v_mov_b32 v17, 0
    v_mov_b32 v18, 0
    v_mov_b32 v19, 0
    ds_read_b128 v[84:87], v230 offset:27648
    ds_read_b128 v[92:95], v230 offset:7168
    s_waitcnt lgkmcnt(0)
    v_mfma_f32_32x32x16_bf16 v[4:19], v[84:87], v[92:95], v[4:19]
    ds_read_b128 v[84:87], v230 offset:28672
    ds_read_b128 v[92:95], v230 offset:8192
    s_waitcnt lgkmcnt(0)
    v_mfma_f32_32x32x16_bf16 v[4:19], v[84:87], v[92:95], v[4:19]
    ds_read_b128 v[84:87], v230 offset:37888
    ds_read_b128 v[92:95], v230 offset:17408
    s_waitcnt lgkmcnt(0)
    v_mfma_f32_32x32x16_bf16 v[4:19], v[84:87], v[92:95], v[4:19]
    ds_read_b128 v[84:87], v230 offset:38912
    ds_read_b128 v[92:95], v230 offset:18432
    s_waitcnt lgkmcnt(0)
    v_mfma_f32_32x32x16_bf16 v[4:19], v[84:87], v[92:95], v[4:19]
    s_nop 7
    s_nop 7
    s_add_u32 s65, s85, 24640
    s_mov_b32 exec_lo, 15
    s_mov_b32 exec_hi, 16777200
    buffer_atomic_add_f32 v4, v229, s[52:55], s65 offen
    s_add_u32 s65, s85, 24896
    s_mov_b32 exec_lo, 15
    s_mov_b32 exec_hi, 16777200
    buffer_atomic_add_f32 v5, v229, s[52:55], s65 offen
    s_add_u32 s65, s85, 25152
    s_mov_b32 exec_lo, 15
    s_mov_b32 exec_hi, 16777200
    buffer_atomic_add_f32 v6, v229, s[52:55], s65 offen
    s_add_u32 s65, s85, 25408
    s_mov_b32 exec_lo, 15
    s_mov_b32 exec_hi, 16777200
    buffer_atomic_add_f32 v7, v229, s[52:55], s65 offen
    s_add_u32 s65, s85, 26688
    s_mov_b32 exec_lo, 16777200
    s_mov_b32 exec_hi, 16777200
    buffer_atomic_add_f32 v8, v229, s[52:55], s65 offen
    s_add_u32 s65, s85, 26944
    s_mov_b32 exec_lo, 16777200
    s_mov_b32 exec_hi, 16777200
    buffer_atomic_add_f32 v9, v229, s[52:55], s65 offen
    s_add_u32 s65, s85, 27200
    s_mov_b32 exec_lo, 16777200
    s_mov_b32 exec_hi, 16777200
    buffer_atomic_add_f32 v10, v229, s[52:55], s65 offen
    s_add_u32 s65, s85, 27456
    s_mov_b32 exec_lo, 16777200
    s_mov_b32 exec_hi, 16777200
    buffer_atomic_add_f32 v11, v229, s[52:55], s65 offen
    s_add_u32 s65, s85, 28736
    s_mov_b32 exec_lo, 16777200
    s_mov_b32 exec_hi, 16777200
    buffer_atomic_add_f32 v12, v229, s[52:55], s65 offen
    s_add_u32 s65, s85, 28992
    s_mov_b32 exec_lo, 16777200
    s_mov_b32 exec_hi, 16777200
    buffer_atomic_add_f32 v13, v229, s[52:55], s65 offen
    s_add_u32 s65, s85, 29248
    s_mov_b32 exec_lo, 16777200
    s_mov_b32 exec_hi, 16777200
    buffer_atomic_add_f32 v14, v229, s[52:55], s65 offen
    s_add_u32 s65, s85, 29504
    s_mov_b32 exec_lo, 16777200
    s_mov_b32 exec_hi, 16777200
    buffer_atomic_add_f32 v15, v229, s[52:55], s65 offen
    s_add_u32 s65, s85, 30784
    s_mov_b32 exec_lo, 4278190080
    s_mov_b32 exec_hi, 4278190080
    buffer_atomic_add_f32 v16, v229, s[52:55], s65 offen
    s_add_u32 s65, s85, 31040
    s_mov_b32 exec_lo, 4278190080
    s_mov_b32 exec_hi, 4278190080
    buffer_atomic_add_f32 v17, v229, s[52:55], s65 offen
    s_add_u32 s65, s85, 31296
    s_mov_b32 exec_lo, 4278190080
    s_mov_b32 exec_hi, 4278190080
    buffer_atomic_add_f32 v18, v229, s[52:55], s65 offen
    s_add_u32 s65, s85, 31552
    s_mov_b32 exec_lo, 4278190080
    s_mov_b32 exec_hi, 4278190080
    buffer_atomic_add_f32 v19, v229, s[52:55], s65 offen
    s_mov_b64 exec, -1
    s_branch .kvend_8
.kvw_6:
    v_mov_b32 v4, 0
    v_mov_b32 v5, 0
    v_mov_b32 v6, 0
    v_mov_b32 v7, 0
    v_mov_b32 v8, 0
    v_mov_b32 v9, 0
    v_mov_b32 v10, 0
    v_mov_b32 v11, 0
    v_mov_b32 v12, 0
    v_mov_b32 v13, 0
    v_mov_b32 v14, 0
    v_mov_b32 v15, 0
    v_mov_b32 v16, 0
    v_mov_b32 v17, 0
    v_mov_b32 v18, 0
    v_mov_b32 v19, 0
    ds_read_b128 v[84:87], v230 offset:21504
    ds_read_b128 v[92:95], v230 offset:3072
    s_waitcnt lgkmcnt(0)
    v_mfma_f32_32x32x16_bf16 v[4:19], v[84:87], v[92:95], v[4:19]
    ds_read_b128 v[84:87], v230 offset:22528
    ds_read_b128 v[92:95], v230 offset:4096
    s_waitcnt lgkmcnt(0)
    v_mfma_f32_32x32x16_bf16 v[4:19], v[84:87], v[92:95], v[4:19]
    ds_read_b128 v[84:87], v230 offset:31744
    ds_read_b128 v[92:95], v230 offset:13312
    s_waitcnt lgkmcnt(0)
    v_mfma_f32_32x32x16_bf16 v[4:19], v[84:87], v[92:95], v[4:19]
    ds_read_b128 v[84:87], v230 offset:32768
    ds_read_b128 v[92:95], v230 offset:14336
    s_waitcnt lgkmcnt(0)
    v_mfma_f32_32x32x16_bf16 v[4:19], v[84:87], v[92:95], v[4:19]
    s_nop 7
    s_nop 7
    s_add_u32 s65, s85, 4224
    s_mov_b32 exec_lo, 0
    s_mov_b32 exec_hi, 255
    buffer_atomic_add_f32 v12, v229, s[52:55], s65 offen
    s_add_u32 s65, s85, 4480
    s_mov_b32 exec_lo, 0
    s_mov_b32 exec_hi, 255
    buffer_atomic_add_f32 v13, v229, s[52:55], s65 offen
    s_add_u32 s65, s85, 4736
    s_mov_b32 exec_lo, 0
    s_mov_b32 exec_hi, 255
    buffer_atomic_add_f32 v14, v229, s[52:55], s65 offen
    s_add_u32 s65, s85, 4992
    s_mov_b32 exec_lo, 0
    s_mov_b32 exec_hi, 255
    buffer_atomic_add_f32 v15, v229, s[52:55], s65 offen
    s_add_u32 s65, s85, 6272
    s_mov_b32 exec_lo, 255
    s_mov_b32 exec_hi, 255
    buffer_atomic_add_f32 v16, v229, s[52:55], s65 offen
    s_add_u32 s65, s85, 6528
    s_mov_b32 exec_lo, 255
    s_mov_b32 exec_hi, 255
    buffer_atomic_add_f32 v17, v229, s[52:55], s65 offen
    s_add_u32 s65, s85, 6784
    s_mov_b32 exec_lo, 255
    s_mov_b32 exec_hi, 255
    buffer_atomic_add_f32 v18, v229, s[52:55], s65 offen
    s_add_u32 s65, s85, 7040
    s_mov_b32 exec_lo, 255
    s_mov_b32 exec_hi, 255
    buffer_atomic_add_f32 v19, v229, s[52:55], s65 offen
    s_mov_b64 exec, -1
    v_mov_b32 v4, 0
    v_mov_b32 v5, 0
    v_mov_b32 v6, 0
    v_mov_b32 v7, 0
    v_mov_b32 v8, 0
    v_mov_b32 v9, 0
    v_mov_b32 v10, 0
    v_mov_b32 v11, 0
    v_mov_b32 v12, 0
    v_mov_b32 v13, 0
    v_mov_b32 v14, 0
    v_mov_b32 v15, 0
    v_mov_b32 v16, 0
    v_mov_b32 v17, 0
    v_mov_b32 v18, 0
    v_mov_b32 v19, 0
    ds_read_b128 v[84:87], v230 offset:25600
    ds_read_b128 v[92:95], v230 offset:5120
    s_waitcnt lgkmcnt(0)
    v_mfma_f32_32x32x16_bf16 v[4:19], v[84:87], v[92:95], v[4:19]
    ds_read_b128 v[84:87], v230 offset:26624
    ds_read_b128 v[92:95], v230 offset:6144
    s_waitcnt lgkmcnt(0)
    v_mfma_f32_32x32x16_bf16 v[4:19], v[84:87], v[92:95], v[4:19]
    ds_read_b128 v[84:87], v230 offset:35840
    ds_read_b128 v[92:95], v230 offset:15360
    s_waitcnt lgkmcnt(0)
    v_mfma_f32_32x32x16_bf16 v[4:19], v[84:87], v[92:95], v[4:19]
    ds_read_b128 v[84:87], v230 offset:36864
    ds_read_b128 v[92:95], v230 offset:16384
    s_waitcnt lgkmcnt(0)
    v_mfma_f32_32x32x16_bf16 v[4:19], v[84:87], v[92:95], v[4:19]
    s_nop 7
    s_nop 7
    s_add_u32 s65, s85, 16448
    s_mov_b32 exec_lo, 65535
    s_mov_b32 exec_hi, 65535
    buffer_atomic_add_f32 v4, v229, s[52:55], s65 offen
    s_add_u32 s65, s85, 16704
    s_mov_b32 exec_lo, 65535
    s_mov_b32 exec_hi, 65535
    buffer_atomic_add_f32 v5, v229, s[52:55], s65 offen
    s_add_u32 s65, s85, 16960
    s_mov_b32 exec_lo, 65535
    s_mov_b32 exec_hi, 65535
    buffer_atomic_add_f32 v6, v229, s[52:55], s65 offen
    s_add_u32 s65, s85, 17216
    s_mov_b32 exec_lo, 65535
    s_mov_b32 exec_hi, 65535
    buffer_atomic_add_f32 v7, v229, s[52:55], s65 offen
    s_add_u32 s65, s85, 18496
    s_mov_b32 exec_lo, 65535
    s_mov_b32 exec_hi, 65535
    buffer_atomic_add_f32 v8, v229, s[52:55], s65 offen
    s_add_u32 s65, s85, 18752
    s_mov_b32 exec_lo, 65535
    s_mov_b32 exec_hi, 65535
    buffer_atomic_add_f32 v9, v229, s[52:55], s65 offen
    s_add_u32 s65, s85, 19008
    s_mov_b32 exec_lo, 65535
    s_mov_b32 exec_hi, 65535
    buffer_atomic_add_f32 v10, v229, s[52:55], s65 offen
    s_add_u32 s65, s85, 19264
    s_mov_b32 exec_lo, 65535
    s_mov_b32 exec_hi, 65535
    buffer_atomic_add_f32 v11, v229, s[52:55], s65 offen
    s_add_u32 s65, s85, 20544
    s_mov_b32 exec_lo, 4294901760
    s_mov_b32 exec_hi, 4294901760
    buffer_atomic_add_f32 v12, v229, s[52:55], s65 offen
    s_add_u32 s65, s85, 20800
    s_mov_b32 exec_lo, 4294901760
    s_mov_b32 exec_hi, 4294901760
    buffer_atomic_add_f32 v13, v229, s[52:55], s65 offen
    s_add_u32 s65, s85, 21056
    s_mov_b32 exec_lo, 4294901760
    s_mov_b32 exec_hi, 4294901760
    buffer_atomic_add_f32 v14, v229, s[52:55], s65 offen
    s_add_u32 s65, s85, 21312
    s_mov_b32 exec_lo, 4294901760
    s_mov_b32 exec_hi, 4294901760
    buffer_atomic_add_f32 v15, v229, s[52:55], s65 offen
    s_add_u32 s65, s85, 22592
    s_mov_b32 exec_lo, 4294901760
    s_mov_b32 exec_hi, 4294901760
    buffer_atomic_add_f32 v16, v229, s[52:55], s65 offen
    s_add_u32 s65, s85, 22848
    s_mov_b32 exec_lo, 4294901760
    s_mov_b32 exec_hi, 4294901760
    buffer_atomic_add_f32 v17, v229, s[52:55], s65 offen
    s_add_u32 s65, s85, 23104
    s_mov_b32 exec_lo, 4294901760
    s_mov_b32 exec_hi, 4294901760
    buffer_atomic_add_f32 v18, v229, s[52:55], s65 offen
    s_add_u32 s65, s85, 23360
    s_mov_b32 exec_lo, 4294901760
    s_mov_b32 exec_hi, 4294901760
    buffer_atomic_add_f32 v19, v229, s[52:55], s65 offen
    s_mov_b64 exec, -1
    v_mov_b32 v4, 0
    v_mov_b32 v5, 0
    v_mov_b32 v6, 0
    v_mov_b32 v7, 0
    v_mov_b32 v8, 0
    v_mov_b32 v9, 0
    v_mov_b32 v10, 0
    v_mov_b32 v11, 0
    v_mov_b32 v12, 0
    v_mov_b32 v13, 0
    v_mov_b32 v14, 0
    v_mov_b32 v15, 0
    v_mov_b32 v16, 0
    v_mov_b32 v17, 0
    v_mov_b32 v18, 0
    v_mov_b32 v19, 0
    ds_read_b128 v[84:87], v230 offset:29696
    ds_read_b128 v[92:95], v230 offset:7168
    s_waitcnt lgkmcnt(0)
    v_mfma_f32_32x32x16_bf16 v[4:19], v[84:87], v[92:95], v[4:19]
    ds_read_b128 v[84:87], v230 offset:30720
    ds_read_b128 v[92:95], v230 offset:8192
    s_waitcnt lgkmcnt(0)
    v_mfma_f32_32x32x16_bf16 v[4:19], v[84:87], v[92:95], v[4:19]
    ds_read_b128 v[84:87], v230 offset:39936
    ds_read_b128 v[92:95], v230 offset:17408
    s_waitcnt lgkmcnt(0)
    v_mfma_f32_32x32x16_bf16 v[4:19], v[84:87], v[92:95], v[4:19]
    ds_read_b128 v[84:87], v230 offset:40960
    ds_read_b128 v[92:95], v230 offset:18432
    s_waitcnt lgkmcnt(0)
    v_mfma_f32_32x32x16_bf16 v[4:19], v[84:87], v[92:95], v[4:19]
    s_nop 7
    s_nop 7
    s_add_u32 s65, s85, 32704
    s_mov_b32 exec_lo, 4278190080
    s_mov_b32 exec_hi, 4278190080
    buffer_atomic_add_f32 v4, v229, s[52:55], s65 offen
    s_add_u32 s65, s85, 32960
    s_mov_b32 exec_lo, 4278190080
    s_mov_b32 exec_hi, 4278190080
    buffer_atomic_add_f32 v5, v229, s[52:55], s65 offen
    s_add_u32 s65, s85, 33216
    s_mov_b32 exec_lo, 4278190080
    s_mov_b32 exec_hi, 4278190080
    buffer_atomic_add_f32 v6, v229, s[52:55], s65 offen
    s_add_u32 s65, s85, 33472
    s_mov_b32 exec_lo, 4278190080
    s_mov_b32 exec_hi, 4278190080
    buffer_atomic_add_f32 v7, v229, s[52:55], s65 offen
    s_add_u32 s65, s85, 34752
    s_mov_b32 exec_lo, 4278190080
    s_mov_b32 exec_hi, 0
    buffer_atomic_add_f32 v8, v229, s[52:55], s65 offen
    s_add_u32 s65, s85, 35008
    s_mov_b32 exec_lo, 4278190080
    s_mov_b32 exec_hi, 0
    buffer_atomic_add_f32 v9, v229, s[52:55], s65 offen
    s_add_u32 s65, s85, 35264
    s_mov_b32 exec_lo, 4278190080
    s_mov_b32 exec_hi, 0
    buffer_atomic_add_f32 v10, v229, s[52:55], s65 offen
    s_add_u32 s65, s85, 35520
    s_mov_b32 exec_lo, 4278190080
    s_mov_b32 exec_hi, 0
    buffer_atomic_add_f32 v11, v229, s[52:55], s65 offen
    s_mov_b64 exec, -1
    s_branch .kvend_8
.kvw_7:
    v_mov_b32 v4, 0
    v_mov_b32 v5, 0
    v_mov_b32 v6, 0
    v_mov_b32 v7, 0
    v_mov_b32 v8, 0
    v_mov_b32 v9, 0
    v_mov_b32 v10, 0
    v_mov_b32 v11, 0
    v_mov_b32 v12, 0
    v_mov_b32 v13, 0
    v_mov_b32 v14, 0
    v_mov_b32 v15, 0
    v_mov_b32 v16, 0
    v_mov_b32 v17, 0
    v_mov_b32 v18, 0
    v_mov_b32 v19, 0
    ds_read_b128 v[84:87], v230 offset:23552
    ds_read_b128 v[92:95], v230 offset:3072
    s_waitcnt lgkmcnt(0)
    v_mfma_f32_32x32x16_bf16 v[4:19], v[84:87], v[92:95], v[4:19]
    ds_read_b128 v[84:87], v230 offset:24576
    ds_read_b128 v[92:95], v230 offset:4096
    s_waitcnt lgkmcnt(0)
    v_mfma_f32_32x32x16_bf16 v[4:19], v[84:87], v[92:95], v[4:19]
    ds_read_b128 v[84:87], v230 offset:33792
    ds_read_b128 v[92:95], v230 offset:13312
    s_waitcnt lgkmcnt(0)
    v_mfma_f32_32x32x16_bf16 v[4:19], v[84:87], v[92:95], v[4:19]
    ds_read_b128 v[84:87], v230 offset:34816
    ds_read_b128 v[92:95], v230 offset:14336
    s_waitcnt lgkmcnt(0)
    v_mfma_f32_32x32x16_bf16 v[4:19], v[84:87], v[92:95], v[4:19]
    s_nop 7
    s_nop 7
    s_add_u32 s65, s85, 8256
    s_mov_b32 exec_lo, 255
    s_mov_b32 exec_hi, 255
    buffer_atomic_add_f32 v4, v229, s[52:55], s65 offen
    s_add_u32 s65, s85, 8512
    s_mov_b32 exec_lo, 255
    s_mov_b32 exec_hi, 255
    buffer_atomic_add_f32 v5, v229, s[52:55], s65 offen
    s_add_u32 s65, s85, 8768
    s_mov_b32 exec_lo, 255
    s_mov_b32 exec_hi, 255
    buffer_atomic_add_f32 v6, v229, s[52:55], s65 offen
    s_add_u32 s65, s85, 9024
    s_mov_b32 exec_lo, 255
    s_mov_b32 exec_hi, 255
    buffer_atomic_add_f32 v7, v229, s[52:55], s65 offen
    s_add_u32 s65, s85, 10304
    s_mov_b32 exec_lo, 268435200
    s_mov_b32 exec_hi, 268435200
    buffer_atomic_add_f32 v8, v229, s[52:55], s65 offen
    s_add_u32 s65, s85, 10560
    s_mov_b32 exec_lo, 268435200
    s_mov_b32 exec_hi, 268435200
    buffer_atomic_add_f32 v9, v229, s[52:55], s65 offen
    s_add_u32 s65, s85, 10816
    s_mov_b32 exec_lo, 268435200
    s_mov_b32 exec_hi, 268435200
    buffer_atomic_add_f32 v10, v229, s[52:55], s65 offen
    s_add_u32 s65, s85, 11072
    s_mov_b32 exec_lo, 268435200
    s_mov_b32 exec_hi, 268435200
    buffer_atomic_add_f32 v11, v229, s[52:55], s65 offen
    s_add_u32 s65, s85, 12352
    s_mov_b32 exec_lo, 268435200
    s_mov_b32 exec_hi, 268435200
    buffer_atomic_add_f32 v12, v229, s[52:55], s65 offen
    s_add_u32 s65, s85, 12608
    s_mov_b32 exec_lo, 268435200
    s_mov_b32 exec_hi, 268435200
    buffer_atomic_add_f32 v13, v229, s[52:55], s65 offen
    s_add_u32 s65, s85, 12864
    s_mov_b32 exec_lo, 268435200
    s_mov_b32 exec_hi, 268435200
    buffer_atomic_add_f32 v14, v229, s[52:55], s65 offen
    s_add_u32 s65, s85, 13120
    s_mov_b32 exec_lo, 268435200
    s_mov_b32 exec_hi, 268435200
    buffer_atomic_add_f32 v15, v229, s[52:55], s65 offen
    s_add_u32 s65, s85, 14400
    s_mov_b32 exec_lo, 268435200
    s_mov_b32 exec_hi, 4026531840
    buffer_atomic_add_f32 v16, v229, s[52:55], s65 offen
    s_add_u32 s65, s85, 14656
    s_mov_b32 exec_lo, 268435200
    s_mov_b32 exec_hi, 4026531840
    buffer_atomic_add_f32 v17, v229, s[52:55], s65 offen
    s_add_u32 s65, s85, 14912
    s_mov_b32 exec_lo, 268435200
    s_mov_b32 exec_hi, 4026531840
    buffer_atomic_add_f32 v18, v229, s[52:55], s65 offen
    s_add_u32 s65, s85, 15168
    s_mov_b32 exec_lo, 268435200
    s_mov_b32 exec_hi, 4026531840
    buffer_atomic_add_f32 v19, v229, s[52:55], s65 offen
    s_mov_b64 exec, -1
    v_mov_b32 v4, 0
    v_mov_b32 v5, 0
    v_mov_b32 v6, 0
    v_mov_b32 v7, 0
    v_mov_b32 v8, 0
    v_mov_b32 v9, 0
    v_mov_b32 v10, 0
    v_mov_b32 v11, 0
    v_mov_b32 v12, 0
    v_mov_b32 v13, 0
    v_mov_b32 v14, 0
    v_mov_b32 v15, 0
    v_mov_b32 v16, 0
    v_mov_b32 v17, 0
    v_mov_b32 v18, 0
    v_mov_b32 v19, 0
    ds_read_b128 v[84:87], v230 offset:27648
    ds_read_b128 v[92:95], v230 offset:5120
    s_waitcnt lgkmcnt(0)
    v_mfma_f32_32x32x16_bf16 v[4:19], v[84:87], v[92:95], v[4:19]
    ds_read_b128 v[84:87], v230 offset:28672
    ds_read_b128 v[92:95], v230 offset:6144
    s_waitcnt lgkmcnt(0)
    v_mfma_f32_32x32x16_bf16 v[4:19], v[84:87], v[92:95], v[4:19]
    ds_read_b128 v[84:87], v230 offset:37888
    ds_read_b128 v[92:95], v230 offset:15360
    s_waitcnt lgkmcnt(0)
    v_mfma_f32_32x32x16_bf16 v[4:19], v[84:87], v[92:95], v[4:19]
    ds_read_b128 v[84:87], v230 offset:38912
    ds_read_b128 v[92:95], v230 offset:16384
    s_waitcnt lgkmcnt(0)
    v_mfma_f32_32x32x16_bf16 v[4:19], v[84:87], v[92:95], v[4:19]
    s_nop 7
    s_nop 7
    s_add_u32 s65, s85, 24512
    s_mov_b32 exec_lo, 4294901760
    s_mov_b32 exec_hi, 0
    buffer_atomic_add_f32 v4, v229, s[52:55], s65 offen
    s_add_u32 s65, s85, 24768
    s_mov_b32 exec_lo, 4294901760
    s_mov_b32 exec_hi, 0
    buffer_atomic_add_f32 v5, v229, s[52:55], s65 offen
    s_add_u32 s65, s85, 25024
    s_mov_b32 exec_lo, 4294901760
    s_mov_b32 exec_hi, 0
    buffer_atomic_add_f32 v6, v229, s[52:55], s65 offen
    s_add_u32 s65, s85, 25280
    s_mov_b32 exec_lo, 4294901760
    s_mov_b32 exec_hi, 0
    buffer_atomic_add_f32 v7, v229, s[52:55], s65 offen
    s_mov_b64 exec, -1
    v_mov_b32 v4, 0
    v_mov_b32 v5, 0
    v_mov_b32 v6, 0
    v_mov_b32 v7, 0
    v_mov_b32 v8, 0
    v_mov_b32 v9, 0
    v_mov_b32 v10, 0
    v_mov_b32 v11, 0
    v_mov_b32 v12, 0
    v_mov_b32 v13, 0
    v_mov_b32 v14, 0
    v_mov_b32 v15, 0
    v_mov_b32 v16, 0
    v_mov_b32 v17, 0
    v_mov_b32 v18, 0
    v_mov_b32 v19, 0
    ds_read_b128 v[84:87], v230 offset:27648
    ds_read_b128 v[92:95], v230 offset:9216
    s_waitcnt lgkmcnt(0)
    v_mfma_f32_32x32x16_bf16 v[4:19], v[84:87], v[92:95], v[4:19]
    ds_read_b128 v[84:87], v230 offset:28672
    ds_read_b128 v[92:95], v230 offset:10240
    s_waitcnt lgkmcnt(0)
    v_mfma_f32_32x32x16_bf16 v[4:19], v[84:87], v[92:95], v[4:19]
    ds_read_b128 v[84:87], v230 offset:37888
    ds_read_b128 v[92:95], v230 offset:19456
    s_waitcnt lgkmcnt(0)
    v_mfma_f32_32x32x16_bf16 v[4:19], v[84:87], v[92:95], v[4:19]
    ds_read_b128 v[84:87], v230 offset:38912
    ds_read_b128 v[92:95], v230 offset:20480
    s_waitcnt lgkmcnt(0)
    v_mfma_f32_32x32x16_bf16 v[4:19], v[84:87], v[92:95], v[4:19]
    s_nop 7
    s_nop 7
    s_add_u32 s65, s85, 30912
    s_mov_b32 exec_lo, 4095
    s_mov_b32 exec_hi, 4095
    buffer_atomic_add_f32 v16, v229, s[52:55], s65 offen
    s_add_u32 s65, s85, 31168
    s_mov_b32 exec_lo, 4095
    s_mov_b32 exec_hi, 4095
    buffer_atomic_add_f32 v17, v229, s[52:55], s65 offen
    s_add_u32 s65, s85, 31424
    s_mov_b32 exec_lo, 4095
    s_mov_b32 exec_hi, 4095
    buffer_atomic_add_f32 v18, v229, s[52:55], s65 offen
    s_add_u32 s65, s85, 31680
    s_mov_b32 exec_lo, 4095
    s_mov_b32 exec_hi, 4095
    buffer_atomic_add_f32 v19, v229, s[52:55], s65 offen
    s_mov_b64 exec, -1
.kvend_8:
    s_endpgm
.k1p0_kernel_q:
    s_sub_u32 s65, s2, 128
    s_and_b32 s61, s65, 15
    s_lshl_b32 s61, s61, 7
    s_lshr_b32 s62, s65, 4
    s_lshl_b32 s62, s62, 7
    s_mov_b32 s40, s16
    s_mov_b32 s41, s17
    s_and_b32 s41, s41, 0xffff
    s_mov_b32 s42, 2621440
    s_mov_b32 s43, 0x00020000
    s_mov_b32 s44, s36
    s_mov_b32 s45, s37
    s_and_b32 s45, s45, 0xffff
    s_mov_b32 s46, 2457600
    s_mov_b32 s47, 0x00020000
    v_and_b32 v124, 63, v0
    v_lshrrev_b32 v125, 6, v0
    s_nop 0
    v_readfirstlane_b32 s60, v125
    s_nop 1
    s_mul_i32 s63, s60, 4096
    s_mul_i32 s64, s60, 4096
    s_mul_i32 s65, s60, 32
    s_add_u32 s65, s65, 0
    v_lshrrev_b32 v125, 3, v124
    v_add_u32 v125, s65, v125
    v_lshrrev_b32 v126, 1, v125
    v_and_b32 v126, 7, v126
    v_and_b32 v100, 7, v124
    v_xor_b32 v126, v100, v126
    v_lshlrev_b32 v126, 4, v126
    v_add_u32 v125, s61, v125
    s_mov_b32 s66, 1280
    v_mul_lo_u32 v125, v125, s66
    v_add_u32 v100, v125, v126
    s_mul_i32 s65, s60, 32
    s_add_u32 s65, s65, 8
    v_lshrrev_b32 v125, 3, v124
    v_add_u32 v125, s65, v125
    v_lshrrev_b32 v126, 1, v125
    v_and_b32 v126, 7, v126
    v_and_b32 v101, 7, v124
    v_xor_b32 v126, v101, v126
    v_lshlrev_b32 v126, 4, v126
    v_add_u32 v125, s61, v125
    s_mov_b32 s66, 1280
    v_mul_lo_u32 v125, v125, s66
    v_add_u32 v101, v125, v126
    s_mul_i32 s65, s60, 32
    s_add_u32 s65, s65, 16
    v_lshrrev_b32 v125, 3, v124
    v_add_u32 v125, s65, v125
    v_lshrrev_b32 v126, 1, v125
    v_and_b32 v126, 7, v126
    v_and_b32 v102, 7, v124
    v_xor_b32 v126, v102, v126
    v_lshlrev_b32 v126, 4, v126
    v_add_u32 v125, s61, v125
    s_mov_b32 s66, 1280
    v_mul_lo_u32 v125, v125, s66
    v_add_u32 v102, v125, v126
    s_mul_i32 s65, s60, 32
    s_add_u32 s65, s65, 24
    v_lshrrev_b32 v125, 3, v124
    v_add_u32 v125, s65, v125
    v_lshrrev_b32 v126, 1, v125
    v_and_b32 v126, 7, v126
    v_and_b32 v103, 7, v124
    v_xor_b32 v126, v103, v126
    v_lshlrev_b32 v126, 4, v126
    v_add_u32 v125, s61, v125
    s_mov_b32 s66, 1280
    v_mul_lo_u32 v125, v125, s66
    v_add_u32 v103, v125, v126
    s_mul_i32 s65, s60, 32
    s_add_u32 s65, s65, 0
    v_lshrrev_b32 v125, 3, v124
    v_add_u32 v125, s65, v125
    v_lshrrev_b32 v126, 1, v125
    v_and_b32 v126, 7, v126
    v_and_b32 v104, 7, v124
    v_xor_b32 v126, v104, v126
    v_lshlrev_b32 v126, 4, v126
    v_add_u32 v125, s62, v125
    s_mov_b32 s66, 1280
    v_mul_lo_u32 v125, v125, s66
    v_add_u32 v104, v125, v126
    s_mul_i32 s65, s60, 32
    s_add_u32 s65, s65, 8
    v_lshrrev_b32 v125, 3, v124
    v_add_u32 v125, s65, v125
    v_lshrrev_b32 v126, 1, v125
    v_and_b32 v126, 7, v126
    v_and_b32 v105, 7, v124
    v_xor_b32 v126, v105, v126
    v_lshlrev_b32 v126, 4, v126
    v_add_u32 v125, s62, v125
    s_mov_b32 s66, 1280
    v_mul_lo_u32 v125, v125, s66
    v_add_u32 v105, v125, v126
    s_mul_i32 s65, s60, 32
    s_add_u32 s65, s65, 16
    v_lshrrev_b32 v125, 3, v124
    v_add_u32 v125, s65, v125
    v_lshrrev_b32 v126, 1, v125
    v_and_b32 v126, 7, v126
    v_and_b32 v106, 7, v124
    v_xor_b32 v126, v106, v126
    v_lshlrev_b32 v126, 4, v126
    v_add_u32 v125, s62, v125
    s_mov_b32 s66, 1280
    v_mul_lo_u32 v125, v125, s66
    v_add_u32 v106, v125, v126
    s_mul_i32 s65, s60, 32
    s_add_u32 s65, s65, 24
    v_lshrrev_b32 v125, 3, v124
    v_add_u32 v125, s65, v125
    v_lshrrev_b32 v126, 1, v125
    v_and_b32 v126, 7, v126
    v_and_b32 v107, 7, v124
    v_xor_b32 v126, v107, v126
    v_lshlrev_b32 v126, 4, v126
    v_add_u32 v125, s62, v125
    s_mov_b32 s66, 1280
    v_mul_lo_u32 v125, v125, s66
    v_add_u32 v107, v125, v126
    s_and_b32 s67, s60, 1
    s_lshr_b32 s68, s60, 1
    v_lshrrev_b32 v125, 5, v124
    v_add_u32 v125, 0, v125
    v_lshrrev_b32 v126, 1, v124
    v_and_b32 v126, 7, v126
    v_xor_b32 v125, v125, v126
    v_lshlrev_b32 v125, 4, v125
    v_and_b32 v126, 31, v124
    v_lshl_add_u32 v125, v126, 7, v125
    s_mul_i32 s65, s67, 8192
    v_add_u32 v108, s65, v125
    v_add_u32 v120, 0x10000, v108
    s_mul_i32 s65, s68, 8192
    v_add_u32 v112, s65, v125
    v_add_u32 v116, 0x10000, v112
    v_lshrrev_b32 v125, 5, v124
    v_add_u32 v125, 2, v125
    v_lshrrev_b32 v126, 1, v124
    v_and_b32 v126, 7, v126
    v_xor_b32 v125, v125, v126
    v_lshlrev_b32 v125, 4, v125
    v_and_b32 v126, 31, v124
    v_lshl_add_u32 v125, v126, 7, v125
    s_mul_i32 s65, s67, 8192
    v_add_u32 v109, s65, v125
    v_add_u32 v121, 0x10000, v109
    s_mul_i32 s65, s68, 8192
    v_add_u32 v113, s65, v125
    v_add_u32 v117, 0x10000, v113
    v_lshrrev_b32 v125, 5, v124
    v_add_u32 v125, 4, v125
    v_lshrrev_b32 v126, 1, v124
    v_and_b32 v126, 7, v126
    v_xor_b32 v125, v125, v126
    v_lshlrev_b32 v125, 4, v125
    v_and_b32 v126, 31, v124
    v_lshl_add_u32 v125, v126, 7, v125
    s_mul_i32 s65, s67, 8192
    v_add_u32 v110, s65, v125
    v_add_u32 v122, 0x10000, v110
    s_mul_i32 s65, s68, 8192
    v_add_u32 v114, s65, v125
    v_add_u32 v118, 0x10000, v114
    v_lshrrev_b32 v125, 5, v124
    v_add_u32 v125, 6, v125
    v_lshrrev_b32 v126, 1, v124
    v_and_b32 v126, 7, v126
    v_xor_b32 v125, v125, v126
    v_lshlrev_b32 v125, 4, v125
    v_and_b32 v126, 31, v124
    v_lshl_add_u32 v125, v126, 7, v125
    s_mul_i32 s65, s67, 8192
    v_add_u32 v111, s65, v125
    v_add_u32 v123, 0x10000, v111
    s_mul_i32 s65, s68, 8192
    v_add_u32 v115, s65, v125
    v_add_u32 v119, 0x10000, v115
    v_mov_b32 v4, 0
    v_mov_b32 v5, 0
    v_mov_b32 v6, 0
    v_mov_b32 v7, 0
    v_mov_b32 v8, 0
    v_mov_b32 v9, 0
    v_mov_b32 v10, 0
    v_mov_b32 v11, 0
    v_mov_b32 v12, 0
    v_mov_b32 v13, 0
    v_mov_b32 v14, 0
    v_mov_b32 v15, 0
    v_mov_b32 v16, 0
    v_mov_b32 v17, 0
    v_mov_b32 v18, 0
    v_mov_b32 v19, 0
    v_mov_b32 v20, 0
    v_mov_b32 v21, 0
    v_mov_b32 v22, 0
    v_mov_b32 v23, 0
    v_mov_b32 v24, 0
    v_mov_b32 v25, 0
    v_mov_b32 v26, 0
    v_mov_b32 v27, 0
    v_mov_b32 v28, 0
    v_mov_b32 v29, 0
    v_mov_b32 v30, 0
    v_mov_b32 v31, 0
    v_mov_b32 v32, 0
    v_mov_b32 v33, 0
    v_mov_b32 v34, 0
    v_mov_b32 v35, 0
    v_mov_b32 v36, 0
    v_mov_b32 v37, 0
    v_mov_b32 v38, 0
    v_mov_b32 v39, 0
    v_mov_b32 v40, 0
    v_mov_b32 v41, 0
    v_mov_b32 v42, 0
    v_mov_b32 v43, 0
    v_mov_b32 v44, 0
    v_mov_b32 v45, 0
    v_mov_b32 v46, 0
    v_mov_b32 v47, 0
    v_mov_b32 v48, 0
    v_mov_b32 v49, 0
    v_mov_b32 v50, 0
    v_mov_b32 v51, 0
    v_mov_b32 v52, 0
    v_mov_b32 v53, 0
    v_mov_b32 v54, 0
    v_mov_b32 v55, 0
    v_mov_b32 v56, 0
    v_mov_b32 v57, 0
    v_mov_b32 v58, 0
    v_mov_b32 v59, 0
    v_mov_b32 v60, 0
    v_mov_b32 v61, 0
    v_mov_b32 v62, 0
    v_mov_b32 v63, 0
    v_mov_b32 v64, 0
    v_mov_b32 v65, 0
    v_mov_b32 v66, 0
    v_mov_b32 v67, 0
    s_mov_b32 s69, 0
    s_add_u32 m0, s63, 1024
    buffer_load_dwordx4 v100, s[40:43], s69 offen lds
    s_add_u32 m0, s63, 2048
    buffer_load_dwordx4 v101, s[40:43], s69 offen lds
    s_add_u32 m0, s63, 3072
    buffer_load_dwordx4 v102, s[40:43], s69 offen lds
    s_add_u32 m0, s63, 4096
    buffer_load_dwordx4 v103, s[40:43], s69 offen lds
    s_add_u32 m0, s64, 17408
    buffer_load_dwordx4 v104, s[44:47], s69 offen lds
    s_add_u32 m0, s64, 18432
    buffer_load_dwordx4 v105, s[44:47], s69 offen lds
    s_add_u32 m0, s64, 19456
    buffer_load_dwordx4 v106, s[44:47], s69 offen lds
    s_add_u32 m0, s64, 20480
    buffer_load_dwordx4 v107, s[44:47], s69 offen lds
    s_mov_b32 s69, 128
    s_add_u32 m0, s63, 33792
    buffer_load_dwordx4 v100, s[40:43], s69 offen lds
    s_add_u32 m0, s63, 34816
    buffer_load_dwordx4 v101, s[40:43], s69 offen lds
    s_add_u32 m0, s63, 35840
    buffer_load_dwordx4 v102, s[40:43], s69 offen lds
    s_add_u32 m0, s63, 36864
    buffer_load_dwordx4 v103, s[40:43], s69 offen lds
    s_add_u32 m0, s64, 50176
    buffer_load_dwordx4 v104, s[44:47], s69 offen lds
    s_add_u32 m0, s64, 51200
    buffer_load_dwordx4 v105, s[44:47], s69 offen lds
    s_add_u32 m0, s64, 52224
    buffer_load_dwordx4 v106, s[44:47], s69 offen lds
    s_add_u32 m0, s64, 53248
    buffer_load_dwordx4 v107, s[44:47], s69 offen lds
    s_add_u32 s72, s36, 7716864
    s_addc_u32 s73, s37, 0
    s_and_b32 s73, s73, 0xffff
    s_mov_b32 s74, 163840
    s_mov_b32 s75, 0x00020000
    v_cmp_gt_u32 vcc, 128, v0
    s_and_saveexec_b64 s[76:77], vcc
    s_cbranch_execz .st_9
    v_add_u32 v88, s61, v0
    v_mul_u32_u24 v88, 80, v88
    buffer_load_dwordx4 v[68:71], v88, s[72:75], 0 offen offset:0
    buffer_load_dwordx4 v[72:75], v88, s[72:75], 0 offen offset:16
    buffer_load_dwordx4 v[76:79], v88, s[72:75], 0 offen offset:32
    buffer_load_dwordx4 v[80:83], v88, s[72:75], 0 offen offset:48
    buffer_load_dwordx4 v[84:87], v88, s[72:75], 0 offen offset:64
    s_waitcnt vmcnt(0)
    v_add_f32 v88, v68, v70
    v_add_f32 v89, v69, v71
    v_add_f32 v88, v88, v72
    v_add_f32 v89, v89, v73
    v_add_f32 v88, v88, v74
    v_add_f32 v89, v89, v75
    v_add_f32 v88, v88, v76
    v_add_f32 v89, v89, v77
    v_add_f32 v88, v88, v78
    v_add_f32 v89, v89, v79
    v_add_f32 v88, v88, v80
    v_add_f32 v89, v89, v81
    v_add_f32 v88, v88, v82
    v_add_f32 v89, v89, v83
    v_add_f32 v88, v88, v84
    v_add_f32 v89, v89, v85
    v_add_f32 v88, v88, v86
    v_add_f32 v89, v89, v87
    v_mul_f32 v88, 0x3acccccd, v88
    v_mul_f32 v89, 0x3acccccd, v89
    v_fma_f32 v89, -v88, v88, v89
    v_max_f32 v89, 0, v89
    v_cvt_pk_bf16_f32 v90, v88, v89
    v_lshlrev_b32 v88, 16, v90
    v_and_b32 v89, 0xffff0000, v90
    v_add_f32 v89, 0x3727c5ac, v89
    v_cvt_pk_bf16_f32 v90, v89, v89
    v_lshlrev_b32 v89, 16, v90
    v_sqrt_f32 v89, v89
    s_nop 0
    v_cvt_pk_bf16_f32 v90, v89, v89
    v_lshlrev_b32 v89, 16, v90
    v_rcp_f32 v89, v89
    v_lshlrev_b32 v90, 3, v0
    s_nop 0
    ds_write_b64 v90, v[88:89] offset:0
.st_9:
    s_or_b64 exec, exec, s[76:77]
    s_add_u32 s48, s36, 7700480
    s_addc_u32 s49, s37, 0
    s_and_b32 s49, s49, 0xffff
    s_mov_b32 s50, 7680
    s_mov_b32 s51, 0x00020000
    s_add_u32 s56, s36, 8372224
    s_addc_u32 s57, s37, 0
    s_and_b32 s57, s57, 0xffff
    s_mov_b32 s58, 2621440
    s_mov_b32 s59, 0x00020000
    v_lshrrev_b32 v160, 5, v124
    v_lshlrev_b32 v160, 2, v160
    s_lshl_b32 s65, s68, 6
    v_add_u32 v160, s65, v160
    v_lshlrev_b32 v161, 2, v160
    s_lshl_b32 s65, s62, 2
    buffer_load_dwordx4 v[128:131], v161, s[48:51], s65 offen offset:0
    buffer_load_dwordx4 v[132:135], v161, s[48:51], s65 offen offset:32
    buffer_load_dwordx4 v[136:139], v161, s[48:51], s65 offen offset:64
    buffer_load_dwordx4 v[140:143], v161, s[48:51], s65 offen offset:96
    buffer_load_dwordx4 v[144:147], v161, s[48:51], s65 offen offset:128
    buffer_load_dwordx4 v[148:151], v161, s[48:51], s65 offen offset:160
    buffer_load_dwordx4 v[152:155], v161, s[48:51], s65 offen offset:192
    buffer_load_dwordx4 v[156:159], v161, s[48:51], s65 offen offset:224
    s_waitcnt vmcnt(21)
    s_barrier
    s_mov_b32 s69, 256
    s_add_u32 m0, s63, 66560
    buffer_load_dwordx4 v100, s[40:43], s69 offen lds
    s_add_u32 m0, s63, 67584
    buffer_load_dwordx4 v101, s[40:43], s69 offen lds
    s_add_u32 m0, s63, 68608
    buffer_load_dwordx4 v102, s[40:43], s69 offen lds
    s_add_u32 m0, s63, 69632
    buffer_load_dwordx4 v103, s[40:43], s69 offen lds
    s_add_u32 m0, s64, 82944
    buffer_load_dwordx4 v104, s[44:47], s69 offen lds
    s_add_u32 m0, s64, 83968
    buffer_load_dwordx4 v105, s[44:47], s69 offen lds
    s_add_u32 m0, s64, 84992
    buffer_load_dwordx4 v106, s[44:47], s69 offen lds
    s_add_u32 m0, s64, 86016
    buffer_load_dwordx4 v107, s[44:47], s69 offen lds
    ds_read_b128 v[68:71], v108 offset:1024
    ds_read_b128 v[72:75], v108 offset:5120
    ds_read_b128 v[84:87], v112 offset:17408
    ds_read_b128 v[88:91], v112 offset:21504
    ds_read_b128 v[76:79], v109 offset:1024
    ds_read_b128 v[80:83], v109 offset:5120
    ds_read_b128 v[92:95], v113 offset:17408
    ds_read_b128 v[96:99], v113 offset:21504
    s_waitcnt lgkmcnt(4)
    v_mfma_f32_32x32x16_bf16 v[4:19], v[84:87], v[68:71], v[4:19]
    v_mfma_f32_32x32x16_bf16 v[20:35], v[88:91], v[68:71], v[20:35]
    v_mfma_f32_32x32x16_bf16 v[36:51], v[84:87], v[72:75], v[36:51]
    v_mfma_f32_32x32x16_bf16 v[52:67], v[88:91], v[72:75], v[52:67]
    ds_read_b128 v[68:71], v110 offset:1024
    ds_read_b128 v[72:75], v110 offset:5120
    ds_read_b128 v[84:87], v114 offset:17408
    ds_read_b128 v[88:91], v114 offset:21504
    s_waitcnt lgkmcnt(4)
    v_mfma_f32_32x32x16_bf16 v[4:19], v[92:95], v[76:79], v[4:19]
    v_mfma_f32_32x32x16_bf16 v[20:35], v[96:99], v[76:79], v[20:35]
    v_mfma_f32_32x32x16_bf16 v[36:51], v[92:95], v[80:83], v[36:51]
    v_mfma_f32_32x32x16_bf16 v[52:67], v[96:99], v[80:83], v[52:67]
    ds_read_b128 v[76:79], v111 offset:1024
    ds_read_b128 v[80:83], v111 offset:5120
    ds_read_b128 v[92:95], v115 offset:17408
    ds_read_b128 v[96:99], v115 offset:21504
    s_waitcnt lgkmcnt(4)
    v_mfma_f32_32x32x16_bf16 v[4:19], v[84:87], v[68:71], v[4:19]
    v_mfma_f32_32x32x16_bf16 v[20:35], v[88:91], v[68:71], v[20:35]
    v_mfma_f32_32x32x16_bf16 v[36:51], v[84:87], v[72:75], v[36:51]
    v_mfma_f32_32x32x16_bf16 v[52:67], v[88:91], v[72:75], v[52:67]
    s_waitcnt vmcnt(21) lgkmcnt(0)
    s_barrier
    s_mov_b32 s69, 384
    s_add_u32 m0, s63, 1024
    buffer_load_dwordx4 v100, s[40:43], s69 offen lds
    s_add_u32 m0, s63, 2048
    buffer_load_dwordx4 v101, s[40:43], s69 offen lds
    s_add_u32 m0, s63, 3072
    buffer_load_dwordx4 v102, s[40:43], s69 offen lds
    s_add_u32 m0, s63, 4096
    buffer_load_dwordx4 v103, s[40:43], s69 offen lds
    s_add_u32 m0, s64, 17408
    buffer_load_dwordx4 v104, s[44:47], s69 offen lds
    s_add_u32 m0, s64, 18432
    buffer_load_dwordx4 v105, s[44:47], s69 offen lds
    s_add_u32 m0, s64, 19456
    buffer_load_dwordx4 v106, s[44:47], s69 offen lds
    s_add_u32 m0, s64, 20480
    buffer_load_dwordx4 v107, s[44:47], s69 offen lds
    ds_read_b128 v[68:71], v108 offset:33792
    ds_read_b128 v[72:75], v108 offset:37888
    ds_read_b128 v[84:87], v112 offset:50176
    ds_read_b128 v[88:91], v112 offset:54272
    v_mfma_f32_32x32x16_bf16 v[4:19], v[92:95], v[76:79], v[4:19]
    v_mfma_f32_32x32x16_bf16 v[20:35], v[96:99], v[76:79], v[20:35]
    v_mfma_f32_32x32x16_bf16 v[36:51], v[92:95], v[80:83], v[36:51]
    v_mfma_f32_32x32x16_bf16 v[52:67], v[96:99], v[80:83], v[52:67]
    ds_read_b128 v[76:79], v109 offset:33792
    ds_read_b128 v[80:83], v109 offset:37888
    ds_read_b128 v[92:95], v113 offset:50176
    ds_read_b128 v[96:99], v113 offset:54272
    s_waitcnt lgkmcnt(4)
    v_mfma_f32_32x32x16_bf16 v[4:19], v[84:87], v[68:71], v[4:19]
    v_mfma_f32_32x32x16_bf16 v[20:35], v[88:91], v[68:71], v[20:35]
    v_mfma_f32_32x32x16_bf16 v[36:51], v[84:87], v[72:75], v[36:51]
    v_mfma_f32_32x32x16_bf16 v[52:67], v[88:91], v[72:75], v[52:67]
    ds_read_b128 v[68:71], v110 offset:33792
    ds_read_b128 v[72:75], v110 offset:37888
    ds_read_b128 v[84:87], v114 offset:50176
    ds_read_b128 v[88:91], v114 offset:54272
    s_waitcnt lgkmcnt(4)
    v_mfma_f32_32x32x16_bf16 v[4:19], v[92:95], v[76:79], v[4:19]
    v_mfma_f32_32x32x16_bf16 v[20:35], v[96:99], v[76:79], v[20:35]
    v_mfma_f32_32x32x16_bf16 v[36:51], v[92:95], v[80:83], v[36:51]
    v_mfma_f32_32x32x16_bf16 v[52:67], v[96:99], v[80:83], v[52:67]
    ds_read_b128 v[76:79], v111 offset:33792
    ds_read_b128 v[80:83], v111 offset:37888
    ds_read_b128 v[92:95], v115 offset:50176
    ds_read_b128 v[96:99], v115 offset:54272
    s_waitcnt lgkmcnt(4)
    v_mfma_f32_32x32x16_bf16 v[4:19], v[84:87], v[68:71], v[4:19]
    v_mfma_f32_32x32x16_bf16 v[20:35], v[88:91], v[68:71], v[20:35]
    v_mfma_f32_32x32x16_bf16 v[36:51], v[84:87], v[72:75], v[36:51]
    v_mfma_f32_32x32x16_bf16 v[52:67], v[88:91], v[72:75], v[52:67]
    s_waitcnt vmcnt(8) lgkmcnt(0)
    s_barrier
    s_mov_b32 s69, 512
    s_add_u32 m0, s63, 33792
    buffer_load_dwordx4 v100, s[40:43], s69 offen lds
    s_add_u32 m0, s63, 34816
    buffer_load_dwordx4 v101, s[40:43], s69 offen lds
    s_add_u32 m0, s63, 35840
    buffer_load_dwordx4 v102, s[40:43], s69 offen lds
    s_add_u32 m0, s63, 36864
    buffer_load_dwordx4 v103, s[40:43], s69 offen lds
    s_add_u32 m0, s64, 50176
    buffer_load_dwordx4 v104, s[44:47], s69 offen lds
    s_add_u32 m0, s64, 51200
    buffer_load_dwordx4 v105, s[44:47], s69 offen lds
    s_add_u32 m0, s64, 52224
    buffer_load_dwordx4 v106, s[44:47], s69 offen lds
    s_add_u32 m0, s64, 53248
    buffer_load_dwordx4 v107, s[44:47], s69 offen lds
    ds_read_b128 v[68:71], v120 offset:1024
    ds_read_b128 v[72:75], v120 offset:5120
    ds_read_b128 v[84:87], v116 offset:17408
    ds_read_b128 v[88:91], v116 offset:21504
    v_mfma_f32_32x32x16_bf16 v[4:19], v[92:95], v[76:79], v[4:19]
    v_mfma_f32_32x32x16_bf16 v[20:35], v[96:99], v[76:79], v[20:35]
    v_mfma_f32_32x32x16_bf16 v[36:51], v[92:95], v[80:83], v[36:51]
    v_mfma_f32_32x32x16_bf16 v[52:67], v[96:99], v[80:83], v[52:67]
    ds_read_b128 v[76:79], v121 offset:1024
    ds_read_b128 v[80:83], v121 offset:5120
    ds_read_b128 v[92:95], v117 offset:17408
    ds_read_b128 v[96:99], v117 offset:21504
    s_waitcnt lgkmcnt(4)
    v_mfma_f32_32x32x16_bf16 v[4:19], v[84:87], v[68:71], v[4:19]
    v_mfma_f32_32x32x16_bf16 v[20:35], v[88:91], v[68:71], v[20:35]
    v_mfma_f32_32x32x16_bf16 v[36:51], v[84:87], v[72:75], v[36:51]
    v_mfma_f32_32x32x16_bf16 v[52:67], v[88:91], v[72:75], v[52:67]
    ds_read_b128 v[68:71], v122 offset:1024
    ds_read_b128 v[72:75], v122 offset:5120
    ds_read_b128 v[84:87], v118 offset:17408
    ds_read_b128 v[88:91], v118 offset:21504
    s_waitcnt lgkmcnt(4)
    v_mfma_f32_32x32x16_bf16 v[4:19], v[92:95], v[76:79], v[4:19]
    v_mfma_f32_32x32x16_bf16 v[20:35], v[96:99], v[76:79], v[20:35]
    v_mfma_f32_32x32x16_bf16 v[36:51], v[92:95], v[80:83], v[36:51]
    v_mfma_f32_32x32x16_bf16 v[52:67], v[96:99], v[80:83], v[52:67]
    ds_read_b128 v[76:79], v123 offset:1024
    ds_read_b128 v[80:83], v123 offset:5120
    ds_read_b128 v[92:95], v119 offset:17408
    ds_read_b128 v[96:99], v119 offset:21504
    s_waitcnt lgkmcnt(4)
    v_mfma_f32_32x32x16_bf16 v[4:19], v[84:87], v[68:71], v[4:19]
    v_mfma_f32_32x32x16_bf16 v[20:35], v[88:91], v[68:71], v[20:35]
    v_mfma_f32_32x32x16_bf16 v[36:51], v[84:87], v[72:75], v[36:51]
    v_mfma_f32_32x32x16_bf16 v[52:67], v[88:91], v[72:75], v[52:67]
    s_waitcnt vmcnt(8) lgkmcnt(0)
    s_barrier
    s_mov_b32 s69, 640
    s_add_u32 m0, s63, 66560
    buffer_load_dwordx4 v100, s[40:43], s69 offen lds
    s_add_u32 m0, s63, 67584
    buffer_load_dwordx4 v101, s[40:43], s69 offen lds
    s_add_u32 m0, s63, 68608
    buffer_load_dwordx4 v102, s[40:43], s69 offen lds
    s_add_u32 m0, s63, 69632
    buffer_load_dwordx4 v103, s[40:43], s69 offen lds
    s_add_u32 m0, s64, 82944
    buffer_load_dwordx4 v104, s[44:47], s69 offen lds
    s_add_u32 m0, s64, 83968
    buffer_load_dwordx4 v105, s[44:47], s69 offen lds
    s_add_u32 m0, s64, 84992
    buffer_load_dwordx4 v106, s[44:47], s69 offen lds
    s_add_u32 m0, s64, 86016
    buffer_load_dwordx4 v107, s[44:47], s69 offen lds
    ds_read_b128 v[68:71], v108 offset:1024
    ds_read_b128 v[72:75], v108 offset:5120
    ds_read_b128 v[84:87], v112 offset:17408
    ds_read_b128 v[88:91], v112 offset:21504
    v_mfma_f32_32x32x16_bf16 v[4:19], v[92:95], v[76:79], v[4:19]
    v_mfma_f32_32x32x16_bf16 v[20:35], v[96:99], v[76:79], v[20:35]
    v_mfma_f32_32x32x16_bf16 v[36:51], v[92:95], v[80:83], v[36:51]
    v_mfma_f32_32x32x16_bf16 v[52:67], v[96:99], v[80:83], v[52:67]
    ds_read_b128 v[76:79], v109 offset:1024
    ds_read_b128 v[80:83], v109 offset:5120
    ds_read_b128 v[92:95], v113 offset:17408
    ds_read_b128 v[96:99], v113 offset:21504
    s_waitcnt lgkmcnt(4)
    v_mfma_f32_32x32x16_bf16 v[4:19], v[84:87], v[68:71], v[4:19]
    v_mfma_f32_32x32x16_bf16 v[20:35], v[88:91], v[68:71], v[20:35]
    v_mfma_f32_32x32x16_bf16 v[36:51], v[84:87], v[72:75], v[36:51]
    v_mfma_f32_32x32x16_bf16 v[52:67], v[88:91], v[72:75], v[52:67]
    ds_read_b128 v[68:71], v110 offset:1024
    ds_read_b128 v[72:75], v110 offset:5120
    ds_read_b128 v[84:87], v114 offset:17408
    ds_read_b128 v[88:91], v114 offset:21504
    s_waitcnt lgkmcnt(4)
    v_mfma_f32_32x32x16_bf16 v[4:19], v[92:95], v[76:79], v[4:19]
    v_mfma_f32_32x32x16_bf16 v[20:35], v[96:99], v[76:79], v[20:35]
    v_mfma_f32_32x32x16_bf16 v[36:51], v[92:95], v[80:83], v[36:51]
    v_mfma_f32_32x32x16_bf16 v[52:67], v[96:99], v[80:83], v[52:67]
    ds_read_b128 v[76:79], v111 offset:1024
    ds_read_b128 v[80:83], v111 offset:5120
    ds_read_b128 v[92:95], v115 offset:17408
    ds_read_b128 v[96:99], v115 offset:21504
    s_waitcnt lgkmcnt(4)
    v_mfma_f32_32x32x16_bf16 v[4:19], v[84:87], v[68:71], v[4:19]
    v_mfma_f32_32x32x16_bf16 v[20:35], v[88:91], v[68:71], v[20:35]
    v_mfma_f32_32x32x16_bf16 v[36:51], v[84:87], v[72:75], v[36:51]
    v_mfma_f32_32x32x16_bf16 v[52:67], v[88:91], v[72:75], v[52:67]
    s_waitcnt vmcnt(8) lgkmcnt(0)
    s_barrier
    s_mov_b32 s69, 768
    s_add_u32 m0, s63, 1024
    buffer_load_dwordx4 v100, s[40:43], s69 offen lds
    s_add_u32 m0, s63, 2048
    buffer_load_dwordx4 v101, s[40:43], s69 offen lds
    s_add_u32 m0, s63, 3072
    buffer_load_dwordx4 v102, s[40:43], s69 offen lds
    s_add_u32 m0, s63, 4096
    buffer_load_dwordx4 v103, s[40:43], s69 offen lds
    s_add_u32 m0, s64, 17408
    buffer_load_dwordx4 v104, s[44:47], s69 offen lds
    s_add_u32 m0, s64, 18432
    buffer_load_dwordx4 v105, s[44:47], s69 offen lds
    s_add_u32 m0, s64, 19456
    buffer_load_dwordx4 v106, s[44:47], s69 offen lds
    s_add_u32 m0, s64, 20480
    buffer_load_dwordx4 v107, s[44:47], s69 offen lds
    ds_read_b128 v[68:71], v108 offset:33792
    ds_read_b128 v[72:75], v108 offset:37888
    ds_read_b128 v[84:87], v112 offset:50176
    ds_read_b128 v[88:91], v112 offset:54272
    v_mfma_f32_32x32x16_bf16 v[4:19], v[92:95], v[76:79], v[4:19]
    v_mfma_f32_32x32x16_bf16 v[20:35], v[96:99], v[76:79], v[20:35]
    v_mfma_f32_32x32x16_bf16 v[36:51], v[92:95], v[80:83], v[36:51]
    v_mfma_f32_32x32x16_bf16 v[52:67], v[96:99], v[80:83], v[52:67]
    ds_read_b128 v[76:79], v109 offset:33792
    ds_read_b128 v[80:83], v109 offset:37888
    ds_read_b128 v[92:95], v113 offset:50176
    ds_read_b128 v[96:99], v113 offset:54272
    s_waitcnt lgkmcnt(4)
    v_mfma_f32_32x32x16_bf16 v[4:19], v[84:87], v[68:71], v[4:19]
    v_mfma_f32_32x32x16_bf16 v[20:35], v[88:91], v[68:71], v[20:35]
    v_mfma_f32_32x32x16_bf16 v[36:51], v[84:87], v[72:75], v[36:51]
    v_mfma_f32_32x32x16_bf16 v[52:67], v[88:91], v[72:75], v[52:67]
    ds_read_b128 v[68:71], v110 offset:33792
    ds_read_b128 v[72:75], v110 offset:37888
    ds_read_b128 v[84:87], v114 offset:50176
    ds_read_b128 v[88:91], v114 offset:54272
    s_waitcnt lgkmcnt(4)
    v_mfma_f32_32x32x16_bf16 v[4:19], v[92:95], v[76:79], v[4:19]
    v_mfma_f32_32x32x16_bf16 v[20:35], v[96:99], v[76:79], v[20:35]
    v_mfma_f32_32x32x16_bf16 v[36:51], v[92:95], v[80:83], v[36:51]
    v_mfma_f32_32x32x16_bf16 v[52:67], v[96:99], v[80:83], v[52:67]
    ds_read_b128 v[76:79], v111 offset:33792
    ds_read_b128 v[80:83], v111 offset:37888
    ds_read_b128 v[92:95], v115 offset:50176
    ds_read_b128 v[96:99], v115 offset:54272
    s_waitcnt lgkmcnt(4)
    v_mfma_f32_32x32x16_bf16 v[4:19], v[84:87], v[68:71], v[4:19]
    v_mfma_f32_32x32x16_bf16 v[20:35], v[88:91], v[68:71], v[20:35]
    v_mfma_f32_32x32x16_bf16 v[36:51], v[84:87], v[72:75], v[36:51]
    v_mfma_f32_32x32x16_bf16 v[52:67], v[88:91], v[72:75], v[52:67]
    s_waitcnt vmcnt(8) lgkmcnt(0)
    s_barrier
    s_mov_b32 s69, 896
    s_add_u32 m0, s63, 33792
    buffer_load_dwordx4 v100, s[40:43], s69 offen lds
    s_add_u32 m0, s63, 34816
    buffer_load_dwordx4 v101, s[40:43], s69 offen lds
    s_add_u32 m0, s63, 35840
    buffer_load_dwordx4 v102, s[40:43], s69 offen lds
    s_add_u32 m0, s63, 36864
    buffer_load_dwordx4 v103, s[40:43], s69 offen lds
    s_add_u32 m0, s64, 50176
    buffer_load_dwordx4 v104, s[44:47], s69 offen lds
    s_add_u32 m0, s64, 51200
    buffer_load_dwordx4 v105, s[44:47], s69 offen lds
    s_add_u32 m0, s64, 52224
    buffer_load_dwordx4 v106, s[44:47], s69 offen lds
    s_add_u32 m0, s64, 53248
    buffer_load_dwordx4 v107, s[44:47], s69 offen lds
    ds_read_b128 v[68:71], v120 offset:1024
    ds_read_b128 v[72:75], v120 offset:5120
    ds_read_b128 v[84:87], v116 offset:17408
    ds_read_b128 v[88:91], v116 offset:21504
    v_mfma_f32_32x32x16_bf16 v[4:19], v[92:95], v[76:79], v[4:19]
    v_mfma_f32_32x32x16_bf16 v[20:35], v[96:99], v[76:79], v[20:35]
    v_mfma_f32_32x32x16_bf16 v[36:51], v[92:95], v[80:83], v[36:51]
    v_mfma_f32_32x32x16_bf16 v[52:67], v[96:99], v[80:83], v[52:67]
    ds_read_b128 v[76:79], v121 offset:1024
    ds_read_b128 v[80:83], v121 offset:5120
    ds_read_b128 v[92:95], v117 offset:17408
    ds_read_b128 v[96:99], v117 offset:21504
    s_waitcnt lgkmcnt(4)
    v_mfma_f32_32x32x16_bf16 v[4:19], v[84:87], v[68:71], v[4:19]
    v_mfma_f32_32x32x16_bf16 v[20:35], v[88:91], v[68:71], v[20:35]
    v_mfma_f32_32x32x16_bf16 v[36:51], v[84:87], v[72:75], v[36:51]
    v_mfma_f32_32x32x16_bf16 v[52:67], v[88:91], v[72:75], v[52:67]
    ds_read_b128 v[68:71], v122 offset:1024
    ds_read_b128 v[72:75], v122 offset:5120
    ds_read_b128 v[84:87], v118 offset:17408
    ds_read_b128 v[88:91], v118 offset:21504
    s_waitcnt lgkmcnt(4)
    v_mfma_f32_32x32x16_bf16 v[4:19], v[92:95], v[76:79], v[4:19]
    v_mfma_f32_32x32x16_bf16 v[20:35], v[96:99], v[76:79], v[20:35]
    v_mfma_f32_32x32x16_bf16 v[36:51], v[92:95], v[80:83], v[36:51]
    v_mfma_f32_32x32x16_bf16 v[52:67], v[96:99], v[80:83], v[52:67]
    ds_read_b128 v[76:79], v123 offset:1024
    ds_read_b128 v[80:83], v123 offset:5120
    ds_read_b128 v[92:95], v119 offset:17408
    ds_read_b128 v[96:99], v119 offset:21504
    s_waitcnt lgkmcnt(4)
    v_mfma_f32_32x32x16_bf16 v[4:19], v[84:87], v[68:71], v[4:19]
    v_mfma_f32_32x32x16_bf16 v[20:35], v[88:91], v[68:71], v[20:35]
    v_mfma_f32_32x32x16_bf16 v[36:51], v[84:87], v[72:75], v[36:51]
    v_mfma_f32_32x32x16_bf16 v[52:67], v[88:91], v[72:75], v[52:67]
    s_waitcnt vmcnt(8) lgkmcnt(0)
    s_barrier
    s_mov_b32 s69, 1024
    s_add_u32 m0, s63, 66560
    buffer_load_dwordx4 v100, s[40:43], s69 offen lds
    s_add_u32 m0, s63, 67584
    buffer_load_dwordx4 v101, s[40:43], s69 offen lds
    s_add_u32 m0, s63, 68608
    buffer_load_dwordx4 v102, s[40:43], s69 offen lds
    s_add_u32 m0, s63, 69632
    buffer_load_dwordx4 v103, s[40:43], s69 offen lds
    s_add_u32 m0, s64, 82944
    buffer_load_dwordx4 v104, s[44:47], s69 offen lds
    s_add_u32 m0, s64, 83968
    buffer_load_dwordx4 v105, s[44:47], s69 offen lds
    s_add_u32 m0, s64, 84992
    buffer_load_dwordx4 v106, s[44:47], s69 offen lds
    s_add_u32 m0, s64, 86016
    buffer_load_dwordx4 v107, s[44:47], s69 offen lds
    ds_read_b128 v[68:71], v108 offset:1024
    ds_read_b128 v[72:75], v108 offset:5120
    ds_read_b128 v[84:87], v112 offset:17408
    ds_read_b128 v[88:91], v112 offset:21504
    v_mfma_f32_32x32x16_bf16 v[4:19], v[92:95], v[76:79], v[4:19]
    v_mfma_f32_32x32x16_bf16 v[20:35], v[96:99], v[76:79], v[20:35]
    v_mfma_f32_32x32x16_bf16 v[36:51], v[92:95], v[80:83], v[36:51]
    v_mfma_f32_32x32x16_bf16 v[52:67], v[96:99], v[80:83], v[52:67]
    ds_read_b128 v[76:79], v109 offset:1024
    ds_read_b128 v[80:83], v109 offset:5120
    ds_read_b128 v[92:95], v113 offset:17408
    ds_read_b128 v[96:99], v113 offset:21504
    s_waitcnt lgkmcnt(4)
    v_mfma_f32_32x32x16_bf16 v[4:19], v[84:87], v[68:71], v[4:19]
    v_mfma_f32_32x32x16_bf16 v[20:35], v[88:91], v[68:71], v[20:35]
    v_mfma_f32_32x32x16_bf16 v[36:51], v[84:87], v[72:75], v[36:51]
    v_mfma_f32_32x32x16_bf16 v[52:67], v[88:91], v[72:75], v[52:67]
    ds_read_b128 v[68:71], v110 offset:1024
    ds_read_b128 v[72:75], v110 offset:5120
    ds_read_b128 v[84:87], v114 offset:17408
    ds_read_b128 v[88:91], v114 offset:21504
    s_waitcnt lgkmcnt(4)
    v_mfma_f32_32x32x16_bf16 v[4:19], v[92:95], v[76:79], v[4:19]
    v_mfma_f32_32x32x16_bf16 v[20:35], v[96:99], v[76:79], v[20:35]
    v_mfma_f32_32x32x16_bf16 v[36:51], v[92:95], v[80:83], v[36:51]
    v_mfma_f32_32x32x16_bf16 v[52:67], v[96:99], v[80:83], v[52:67]
    ds_read_b128 v[76:79], v111 offset:1024
    ds_read_b128 v[80:83], v111 offset:5120
    ds_read_b128 v[92:95], v115 offset:17408
    ds_read_b128 v[96:99], v115 offset:21504
    s_waitcnt lgkmcnt(4)
    v_mfma_f32_32x32x16_bf16 v[4:19], v[84:87], v[68:71], v[4:19]
    v_mfma_f32_32x32x16_bf16 v[20:35], v[88:91], v[68:71], v[20:35]
    v_mfma_f32_32x32x16_bf16 v[36:51], v[84:87], v[72:75], v[36:51]
    v_mfma_f32_32x32x16_bf16 v[52:67], v[88:91], v[72:75], v[52:67]
    s_waitcnt vmcnt(8) lgkmcnt(0)
    s_barrier
    s_mov_b32 s69, 1152
    s_add_u32 m0, s63, 1024
    buffer_load_dwordx4 v100, s[40:43], s69 offen lds
    s_add_u32 m0, s63, 2048
    buffer_load_dwordx4 v101, s[40:43], s69 offen lds
    s_add_u32 m0, s63, 3072
    buffer_load_dwordx4 v102, s[40:43], s69 offen lds
    s_add_u32 m0, s63, 4096
    buffer_load_dwordx4 v103, s[40:43], s69 offen lds
    s_add_u32 m0, s64, 17408
    buffer_load_dwordx4 v104, s[44:47], s69 offen lds
    s_add_u32 m0, s64, 18432
    buffer_load_dwordx4 v105, s[44:47], s69 offen lds
    s_add_u32 m0, s64, 19456
    buffer_load_dwordx4 v106, s[44:47], s69 offen lds
    s_add_u32 m0, s64, 20480
    buffer_load_dwordx4 v107, s[44:47], s69 offen lds
    ds_read_b128 v[68:71], v108 offset:33792
    ds_read_b128 v[72:75], v108 offset:37888
    ds_read_b128 v[84:87], v112 offset:50176
    ds_read_b128 v[88:91], v112 offset:54272
    v_mfma_f32_32x32x16_bf16 v[4:19], v[92:95], v[76:79], v[4:19]
    v_mfma_f32_32x32x16_bf16 v[20:35], v[96:99], v[76:79], v[20:35]
    v_mfma_f32_32x32x16_bf16 v[36:51], v[92:95], v[80:83], v[36:51]
    v_mfma_f32_32x32x16_bf16 v[52:67], v[96:99], v[80:83], v[52:67]
    ds_read_b128 v[76:79], v109 offset:33792
    ds_read_b128 v[80:83], v109 offset:37888
    ds_read_b128 v[92:95], v113 offset:50176
    ds_read_b128 v[96:99], v113 offset:54272
    s_waitcnt lgkmcnt(4)
    v_mfma_f32_32x32x16_bf16 v[4:19], v[84:87], v[68:71], v[4:19]
    v_mfma_f32_32x32x16_bf16 v[20:35], v[88:91], v[68:71], v[20:35]
    v_mfma_f32_32x32x16_bf16 v[36:51], v[84:87], v[72:75], v[36:51]
    v_mfma_f32_32x32x16_bf16 v[52:67], v[88:91], v[72:75], v[52:67]
    ds_read_b128 v[68:71], v110 offset:33792
    ds_read_b128 v[72:75], v110 offset:37888
    ds_read_b128 v[84:87], v114 offset:50176
    ds_read_b128 v[88:91], v114 offset:54272
    s_waitcnt lgkmcnt(4)
    v_mfma_f32_32x32x16_bf16 v[4:19], v[92:95], v[76:79], v[4:19]
    v_mfma_f32_32x32x16_bf16 v[20:35], v[96:99], v[76:79], v[20:35]
    v_mfma_f32_32x32x16_bf16 v[36:51], v[92:95], v[80:83], v[36:51]
    v_mfma_f32_32x32x16_bf16 v[52:67], v[96:99], v[80:83], v[52:67]
    ds_read_b128 v[76:79], v111 offset:33792
    ds_read_b128 v[80:83], v111 offset:37888
    ds_read_b128 v[92:95], v115 offset:50176
    ds_read_b128 v[96:99], v115 offset:54272
    s_waitcnt lgkmcnt(4)
    v_mfma_f32_32x32x16_bf16 v[4:19], v[84:87], v[68:71], v[4:19]
    v_mfma_f32_32x32x16_bf16 v[20:35], v[88:91], v[68:71], v[20:35]
    v_mfma_f32_32x32x16_bf16 v[36:51], v[84:87], v[72:75], v[36:51]
    v_mfma_f32_32x32x16_bf16 v[52:67], v[88:91], v[72:75], v[52:67]
    s_waitcnt vmcnt(8) lgkmcnt(0)
    s_barrier
    ds_read_b128 v[68:71], v120 offset:1024
    ds_read_b128 v[72:75], v120 offset:5120
    ds_read_b128 v[84:87], v116 offset:17408
    ds_read_b128 v[88:91], v116 offset:21504
    v_mfma_f32_32x32x16_bf16 v[4:19], v[92:95], v[76:79], v[4:19]
    v_mfma_f32_32x32x16_bf16 v[20:35], v[96:99], v[76:79], v[20:35]
    v_mfma_f32_32x32x16_bf16 v[36:51], v[92:95], v[80:83], v[36:51]
    v_mfma_f32_32x32x16_bf16 v[52:67], v[96:99], v[80:83], v[52:67]
    ds_read_b128 v[76:79], v121 offset:1024
    ds_read_b128 v[80:83], v121 offset:5120
    ds_read_b128 v[92:95], v117 offset:17408
    ds_read_b128 v[96:99], v117 offset:21504
    s_waitcnt lgkmcnt(4)
    v_mfma_f32_32x32x16_bf16 v[4:19], v[84:87], v[68:71], v[4:19]
    v_mfma_f32_32x32x16_bf16 v[20:35], v[88:91], v[68:71], v[20:35]
    v_mfma_f32_32x32x16_bf16 v[36:51], v[84:87], v[72:75], v[36:51]
    v_mfma_f32_32x32x16_bf16 v[52:67], v[88:91], v[72:75], v[52:67]
    ds_read_b128 v[68:71], v122 offset:1024
    ds_read_b128 v[72:75], v122 offset:5120
    ds_read_b128 v[84:87], v118 offset:17408
    ds_read_b128 v[88:91], v118 offset:21504
    s_waitcnt lgkmcnt(4)
    v_mfma_f32_32x32x16_bf16 v[4:19], v[92:95], v[76:79], v[4:19]
    v_mfma_f32_32x32x16_bf16 v[20:35], v[96:99], v[76:79], v[20:35]
    v_mfma_f32_32x32x16_bf16 v[36:51], v[92:95], v[80:83], v[36:51]
    v_mfma_f32_32x32x16_bf16 v[52:67], v[96:99], v[80:83], v[52:67]
    ds_read_b128 v[76:79], v123 offset:1024
    ds_read_b128 v[80:83], v123 offset:5120
    ds_read_b128 v[92:95], v119 offset:17408
    ds_read_b128 v[96:99], v119 offset:21504
    s_waitcnt lgkmcnt(4)
    v_mfma_f32_32x32x16_bf16 v[4:19], v[84:87], v[68:71], v[4:19]
    v_mfma_f32_32x32x16_bf16 v[20:35], v[88:91], v[68:71], v[20:35]
    v_mfma_f32_32x32x16_bf16 v[36:51], v[84:87], v[72:75], v[36:51]
    v_mfma_f32_32x32x16_bf16 v[52:67], v[88:91], v[72:75], v[52:67]
    s_waitcnt vmcnt(0) lgkmcnt(0)
    s_barrier
    ds_read_b128 v[68:71], v108 offset:1024
    ds_read_b128 v[72:75], v108 offset:5120
    ds_read_b128 v[84:87], v112 offset:17408
    ds_read_b128 v[88:91], v112 offset:21504
    v_mfma_f32_32x32x16_bf16 v[4:19], v[92:95], v[76:79], v[4:19]
    v_mfma_f32_32x32x16_bf16 v[20:35], v[96:99], v[76:79], v[20:35]
    v_mfma_f32_32x32x16_bf16 v[36:51], v[92:95], v[80:83], v[36:51]
    v_mfma_f32_32x32x16_bf16 v[52:67], v[96:99], v[80:83], v[52:67]
    ds_read_b128 v[76:79], v109 offset:1024
    ds_read_b128 v[80:83], v109 offset:5120
    ds_read_b128 v[92:95], v113 offset:17408
    ds_read_b128 v[96:99], v113 offset:21504
    s_waitcnt lgkmcnt(4)
    v_mfma_f32_32x32x16_bf16 v[4:19], v[84:87], v[68:71], v[4:19]
    v_mfma_f32_32x32x16_bf16 v[20:35], v[88:91], v[68:71], v[20:35]
    v_mfma_f32_32x32x16_bf16 v[36:51], v[84:87], v[72:75], v[36:51]
    v_mfma_f32_32x32x16_bf16 v[52:67], v[88:91], v[72:75], v[52:67]
    ds_read_b128 v[68:71], v110 offset:1024
    ds_read_b128 v[72:75], v110 offset:5120
    ds_read_b128 v[84:87], v114 offset:17408
    ds_read_b128 v[88:91], v114 offset:21504
    s_waitcnt lgkmcnt(4)
    v_mfma_f32_32x32x16_bf16 v[4:19], v[92:95], v[76:79], v[4:19]
    v_mfma_f32_32x32x16_bf16 v[20:35], v[96:99], v[76:79], v[20:35]
    v_mfma_f32_32x32x16_bf16 v[36:51], v[92:95], v[80:83], v[36:51]
    v_mfma_f32_32x32x16_bf16 v[52:67], v[96:99], v[80:83], v[52:67]
    ds_read_b128 v[76:79], v111 offset:1024
    ds_read_b128 v[80:83], v111 offset:5120
    ds_read_b128 v[92:95], v115 offset:17408
    ds_read_b128 v[96:99], v115 offset:21504
    s_waitcnt lgkmcnt(4)
    v_mfma_f32_32x32x16_bf16 v[4:19], v[84:87], v[68:71], v[4:19]
    v_mfma_f32_32x32x16_bf16 v[20:35], v[88:91], v[68:71], v[20:35]
    v_mfma_f32_32x32x16_bf16 v[36:51], v[84:87], v[72:75], v[36:51]
    v_mfma_f32_32x32x16_bf16 v[52:67], v[88:91], v[72:75], v[52:67]
    s_waitcnt lgkmcnt(0)
    v_mfma_f32_32x32x16_bf16 v[4:19], v[92:95], v[76:79], v[4:19]
    v_mfma_f32_32x32x16_bf16 v[20:35], v[96:99], v[76:79], v[20:35]
    v_mfma_f32_32x32x16_bf16 v[36:51], v[92:95], v[80:83], v[36:51]
    v_mfma_f32_32x32x16_bf16 v[52:67], v[96:99], v[80:83], v[52:67]
    s_nop 7
    s_nop 7
    s_waitcnt vmcnt(0)
    v_and_b32 v166, 31, v124
    s_lshl_b32 s65, s67, 6
    v_add_u32 v166, s65, v166
    v_lshlrev_b32 v167, 3, v166
    ds_read_b64 v[162:163], v167
    ds_read_b64 v[164:165], v167 offset:256
    v_add_u32 v166, s61, v166
    v_mul_u32_u24 v166, 1280, v166
    v_lshlrev_b32 v167, 1, v160
    v_add_u32 v166, v166, v167
    v_add_u32 v167, 40960, v166
    s_lshl_b32 s66, s62, 1
    s_waitcnt lgkmcnt(0)
    v_fma_f32 v4, -v162, v128, v4
    v_mul_f32 v4, v4, v163
    v_fma_f32 v5, -v162, v129, v5
    v_mul_f32 v5, v5, v163
    v_fma_f32 v6, -v162, v130, v6
    v_mul_f32 v6, v6, v163
    v_fma_f32 v7, -v162, v131, v7
    v_mul_f32 v7, v7, v163
    v_cvt_pk_bf16_f32 v168, v4, v5
    v_lshlrev_b32 v4, 16, v168
    v_and_b32 v5, 0xffff0000, v168
    v_cvt_pk_bf16_f32 v169, v6, v7
    v_lshlrev_b32 v6, 16, v169
    v_and_b32 v7, 0xffff0000, v169
    v_mul_f32 v170, 0x3fb8aa3b, v4
    v_exp_f32 v170, v170
    v_cmp_lt_f32 vcc, 0, v4
    v_add_f32 v4, 1.0, v4
    v_cndmask_b32 v4, v170, v4, vcc
    v_mul_f32 v171, 0x3fb8aa3b, v5
    v_exp_f32 v171, v171
    v_cmp_lt_f32 vcc, 0, v5
    v_add_f32 v5, 1.0, v5
    v_cndmask_b32 v5, v171, v5, vcc
    v_mul_f32 v172, 0x3fb8aa3b, v6
    v_exp_f32 v172, v172
    v_cmp_lt_f32 vcc, 0, v6
    v_add_f32 v6, 1.0, v6
    v_cndmask_b32 v6, v172, v6, vcc
    v_mul_f32 v173, 0x3fb8aa3b, v7
    v_exp_f32 v173, v173
    v_cmp_lt_f32 vcc, 0, v7
    v_add_f32 v7, 1.0, v7
    v_cndmask_b32 v7, v173, v7, vcc
    v_cvt_pk_bf16_f32 v168, v4, v5
    v_lshlrev_b32 v4, 16, v168
    v_and_b32 v5, 0xffff0000, v168
    v_cvt_pk_bf16_f32 v169, v6, v7
    v_lshlrev_b32 v6, 16, v169
    v_and_b32 v7, 0xffff0000, v169
    v_add_f32 v4, 0x358637bd, v4
    v_add_f32 v5, 0x358637bd, v5
    v_add_f32 v6, 0x358637bd, v6
    v_add_f32 v7, 0x358637bd, v7
    v_cvt_pk_bf16_f32 v174, v4, v5
    v_cvt_pk_bf16_f32 v175, v6, v7
    buffer_store_dwordx2 v[174:175], v166, s[56:59], s66 offen offset:0
    s_nop 1
    v_fma_f32 v8, -v162, v132, v8
    v_mul_f32 v8, v8, v163
    v_fma_f32 v9, -v162, v133, v9
    v_mul_f32 v9, v9, v163
    v_fma_f32 v10, -v162, v134, v10
    v_mul_f32 v10, v10, v163
    v_fma_f32 v11, -v162, v135, v11
    v_mul_f32 v11, v11, v163
    v_cvt_pk_bf16_f32 v168, v8, v9
    v_lshlrev_b32 v8, 16, v168
    v_and_b32 v9, 0xffff0000, v168
    v_cvt_pk_bf16_f32 v169, v10, v11
    v_lshlrev_b32 v10, 16, v169
    v_and_b32 v11, 0xffff0000, v169
    v_mul_f32 v170, 0x3fb8aa3b, v8
    v_exp_f32 v170, v170
    v_cmp_lt_f32 vcc, 0, v8
    v_add_f32 v8, 1.0, v8
    v_cndmask_b32 v8, v170, v8, vcc
    v_mul_f32 v171, 0x3fb8aa3b, v9
    v_exp_f32 v171, v171
    v_cmp_lt_f32 vcc, 0, v9
    v_add_f32 v9, 1.0, v9
    v_cndmask_b32 v9, v171, v9, vcc
    v_mul_f32 v172, 0x3fb8aa3b, v10
    v_exp_f32 v172, v172
    v_cmp_lt_f32 vcc, 0, v10
    v_add_f32 v10, 1.0, v10
    v_cndmask_b32 v10, v172, v10, vcc
    v_mul_f32 v173, 0x3fb8aa3b, v11
    v_exp_f32 v173, v173
    v_cmp_lt_f32 vcc, 0, v11
    v_add_f32 v11, 1.0, v11
    v_cndmask_b32 v11, v173, v11, vcc
    v_cvt_pk_bf16_f32 v168, v8, v9
    v_lshlrev_b32 v8, 16, v168
    v_and_b32 v9, 0xffff0000, v168
    v_cvt_pk_bf16_f32 v169, v10, v11
    v_lshlrev_b32 v10, 16, v169
    v_and_b32 v11, 0xffff0000, v169
    v_add_f32 v8, 0x358637bd, v8
    v_add_f32 v9, 0x358637bd, v9
    v_add_f32 v10, 0x358637bd, v10
    v_add_f32 v11, 0x358637bd, v11
    v_cvt_pk_bf16_f32 v174, v8, v9
    v_cvt_pk_bf16_f32 v175, v10, v11
    buffer_store_dwordx2 v[174:175], v166, s[56:59], s66 offen offset:16
    s_nop 1
    v_fma_f32 v12, -v162, v136, v12
    v_mul_f32 v12, v12, v163
    v_fma_f32 v13, -v162, v137, v13
    v_mul_f32 v13, v13, v163
    v_fma_f32 v14, -v162, v138, v14
    v_mul_f32 v14, v14, v163
    v_fma_f32 v15, -v162, v139, v15
    v_mul_f32 v15, v15, v163
    v_cvt_pk_bf16_f32 v168, v12, v13
    v_lshlrev_b32 v12, 16, v168
    v_and_b32 v13, 0xffff0000, v168
    v_cvt_pk_bf16_f32 v169, v14, v15
    v_lshlrev_b32 v14, 16, v169
    v_and_b32 v15, 0xffff0000, v169
    v_mul_f32 v170, 0x3fb8aa3b, v12
    v_exp_f32 v170, v170
    v_cmp_lt_f32 vcc, 0, v12
    v_add_f32 v12, 1.0, v12
    v_cndmask_b32 v12, v170, v12, vcc
    v_mul_f32 v171, 0x3fb8aa3b, v13
    v_exp_f32 v171, v171
    v_cmp_lt_f32 vcc, 0, v13
    v_add_f32 v13, 1.0, v13
    v_cndmask_b32 v13, v171, v13, vcc
    v_mul_f32 v172, 0x3fb8aa3b, v14
    v_exp_f32 v172, v172
    v_cmp_lt_f32 vcc, 0, v14
    v_add_f32 v14, 1.0, v14
    v_cndmask_b32 v14, v172, v14, vcc
    v_mul_f32 v173, 0x3fb8aa3b, v15
    v_exp_f32 v173, v173
    v_cmp_lt_f32 vcc, 0, v15
    v_add_f32 v15, 1.0, v15
    v_cndmask_b32 v15, v173, v15, vcc
    v_cvt_pk_bf16_f32 v168, v12, v13
    v_lshlrev_b32 v12, 16, v168
    v_and_b32 v13, 0xffff0000, v168
    v_cvt_pk_bf16_f32 v169, v14, v15
    v_lshlrev_b32 v14, 16, v169
    v_and_b32 v15, 0xffff0000, v169
    v_add_f32 v12, 0x358637bd, v12
    v_add_f32 v13, 0x358637bd, v13
    v_add_f32 v14, 0x358637bd, v14
    v_add_f32 v15, 0x358637bd, v15
    v_cvt_pk_bf16_f32 v174, v12, v13
    v_cvt_pk_bf16_f32 v175, v14, v15
    buffer_store_dwordx2 v[174:175], v166, s[56:59], s66 offen offset:32
    s_nop 1
    v_fma_f32 v16, -v162, v140, v16
    v_mul_f32 v16, v16, v163
    v_fma_f32 v17, -v162, v141, v17
    v_mul_f32 v17, v17, v163
    v_fma_f32 v18, -v162, v142, v18
    v_mul_f32 v18, v18, v163
    v_fma_f32 v19, -v162, v143, v19
    v_mul_f32 v19, v19, v163
    v_cvt_pk_bf16_f32 v168, v16, v17
    v_lshlrev_b32 v16, 16, v168
    v_and_b32 v17, 0xffff0000, v168
    v_cvt_pk_bf16_f32 v169, v18, v19
    v_lshlrev_b32 v18, 16, v169
    v_and_b32 v19, 0xffff0000, v169
    v_mul_f32 v170, 0x3fb8aa3b, v16
    v_exp_f32 v170, v170
    v_cmp_lt_f32 vcc, 0, v16
    v_add_f32 v16, 1.0, v16
    v_cndmask_b32 v16, v170, v16, vcc
    v_mul_f32 v171, 0x3fb8aa3b, v17
    v_exp_f32 v171, v171
    v_cmp_lt_f32 vcc, 0, v17
    v_add_f32 v17, 1.0, v17
    v_cndmask_b32 v17, v171, v17, vcc
    v_mul_f32 v172, 0x3fb8aa3b, v18
    v_exp_f32 v172, v172
    v_cmp_lt_f32 vcc, 0, v18
    v_add_f32 v18, 1.0, v18
    v_cndmask_b32 v18, v172, v18, vcc
    v_mul_f32 v173, 0x3fb8aa3b, v19
    v_exp_f32 v173, v173
    v_cmp_lt_f32 vcc, 0, v19
    v_add_f32 v19, 1.0, v19
    v_cndmask_b32 v19, v173, v19, vcc
    v_cvt_pk_bf16_f32 v168, v16, v17
    v_lshlrev_b32 v16, 16, v168
    v_and_b32 v17, 0xffff0000, v168
    v_cvt_pk_bf16_f32 v169, v18, v19
    v_lshlrev_b32 v18, 16, v169
    v_and_b32 v19, 0xffff0000, v169
    v_add_f32 v16, 0x358637bd, v16
    v_add_f32 v17, 0x358637bd, v17
    v_add_f32 v18, 0x358637bd, v18
    v_add_f32 v19, 0x358637bd, v19
    v_cvt_pk_bf16_f32 v174, v16, v17
    v_cvt_pk_bf16_f32 v175, v18, v19
    buffer_store_dwordx2 v[174:175], v166, s[56:59], s66 offen offset:48
    s_nop 1
    v_fma_f32 v20, -v162, v144, v20
    v_mul_f32 v20, v20, v163
    v_fma_f32 v21, -v162, v145, v21
    v_mul_f32 v21, v21, v163
    v_fma_f32 v22, -v162, v146, v22
    v_mul_f32 v22, v22, v163
    v_fma_f32 v23, -v162, v147, v23
    v_mul_f32 v23, v23, v163
    v_cvt_pk_bf16_f32 v168, v20, v21
    v_lshlrev_b32 v20, 16, v168
    v_and_b32 v21, 0xffff0000, v168
    v_cvt_pk_bf16_f32 v169, v22, v23
    v_lshlrev_b32 v22, 16, v169
    v_and_b32 v23, 0xffff0000, v169
    v_mul_f32 v170, 0x3fb8aa3b, v20
    v_exp_f32 v170, v170
    v_cmp_lt_f32 vcc, 0, v20
    v_add_f32 v20, 1.0, v20
    v_cndmask_b32 v20, v170, v20, vcc
    v_mul_f32 v171, 0x3fb8aa3b, v21
    v_exp_f32 v171, v171
    v_cmp_lt_f32 vcc, 0, v21
    v_add_f32 v21, 1.0, v21
    v_cndmask_b32 v21, v171, v21, vcc
    v_mul_f32 v172, 0x3fb8aa3b, v22
    v_exp_f32 v172, v172
    v_cmp_lt_f32 vcc, 0, v22
    v_add_f32 v22, 1.0, v22
    v_cndmask_b32 v22, v172, v22, vcc
    v_mul_f32 v173, 0x3fb8aa3b, v23
    v_exp_f32 v173, v173
    v_cmp_lt_f32 vcc, 0, v23
    v_add_f32 v23, 1.0, v23
    v_cndmask_b32 v23, v173, v23, vcc
    v_cvt_pk_bf16_f32 v168, v20, v21
    v_lshlrev_b32 v20, 16, v168
    v_and_b32 v21, 0xffff0000, v168
    v_cvt_pk_bf16_f32 v169, v22, v23
    v_lshlrev_b32 v22, 16, v169
    v_and_b32 v23, 0xffff0000, v169
    v_add_f32 v20, 0x358637bd, v20
    v_add_f32 v21, 0x358637bd, v21
    v_add_f32 v22, 0x358637bd, v22
    v_add_f32 v23, 0x358637bd, v23
    v_cvt_pk_bf16_f32 v174, v20, v21
    v_cvt_pk_bf16_f32 v175, v22, v23
    buffer_store_dwordx2 v[174:175], v166, s[56:59], s66 offen offset:64
    s_nop 1
    v_fma_f32 v24, -v162, v148, v24
    v_mul_f32 v24, v24, v163
    v_fma_f32 v25, -v162, v149, v25
    v_mul_f32 v25, v25, v163
    v_fma_f32 v26, -v162, v150, v26
    v_mul_f32 v26, v26, v163
    v_fma_f32 v27, -v162, v151, v27
    v_mul_f32 v27, v27, v163
    v_cvt_pk_bf16_f32 v168, v24, v25
    v_lshlrev_b32 v24, 16, v168
    v_and_b32 v25, 0xffff0000, v168
    v_cvt_pk_bf16_f32 v169, v26, v27
    v_lshlrev_b32 v26, 16, v169
    v_and_b32 v27, 0xffff0000, v169
    v_mul_f32 v170, 0x3fb8aa3b, v24
    v_exp_f32 v170, v170
    v_cmp_lt_f32 vcc, 0, v24
    v_add_f32 v24, 1.0, v24
    v_cndmask_b32 v24, v170, v24, vcc
    v_mul_f32 v171, 0x3fb8aa3b, v25
    v_exp_f32 v171, v171
    v_cmp_lt_f32 vcc, 0, v25
    v_add_f32 v25, 1.0, v25
    v_cndmask_b32 v25, v171, v25, vcc
    v_mul_f32 v172, 0x3fb8aa3b, v26
    v_exp_f32 v172, v172
    v_cmp_lt_f32 vcc, 0, v26
    v_add_f32 v26, 1.0, v26
    v_cndmask_b32 v26, v172, v26, vcc
    v_mul_f32 v173, 0x3fb8aa3b, v27
    v_exp_f32 v173, v173
    v_cmp_lt_f32 vcc, 0, v27
    v_add_f32 v27, 1.0, v27
    v_cndmask_b32 v27, v173, v27, vcc
    v_cvt_pk_bf16_f32 v168, v24, v25
    v_lshlrev_b32 v24, 16, v168
    v_and_b32 v25, 0xffff0000, v168
    v_cvt_pk_bf16_f32 v169, v26, v27
    v_lshlrev_b32 v26, 16, v169
    v_and_b32 v27, 0xffff0000, v169
    v_add_f32 v24, 0x358637bd, v24
    v_add_f32 v25, 0x358637bd, v25
    v_add_f32 v26, 0x358637bd, v26
    v_add_f32 v27, 0x358637bd, v27
    v_cvt_pk_bf16_f32 v174, v24, v25
    v_cvt_pk_bf16_f32 v175, v26, v27
    buffer_store_dwordx2 v[174:175], v166, s[56:59], s66 offen offset:80
    s_nop 1
    v_fma_f32 v28, -v162, v152, v28
    v_mul_f32 v28, v28, v163
    v_fma_f32 v29, -v162, v153, v29
    v_mul_f32 v29, v29, v163
    v_fma_f32 v30, -v162, v154, v30
    v_mul_f32 v30, v30, v163
    v_fma_f32 v31, -v162, v155, v31
    v_mul_f32 v31, v31, v163
    v_cvt_pk_bf16_f32 v168, v28, v29
    v_lshlrev_b32 v28, 16, v168
    v_and_b32 v29, 0xffff0000, v168
    v_cvt_pk_bf16_f32 v169, v30, v31
    v_lshlrev_b32 v30, 16, v169
    v_and_b32 v31, 0xffff0000, v169
    v_mul_f32 v170, 0x3fb8aa3b, v28
    v_exp_f32 v170, v170
    v_cmp_lt_f32 vcc, 0, v28
    v_add_f32 v28, 1.0, v28
    v_cndmask_b32 v28, v170, v28, vcc
    v_mul_f32 v171, 0x3fb8aa3b, v29
    v_exp_f32 v171, v171
    v_cmp_lt_f32 vcc, 0, v29
    v_add_f32 v29, 1.0, v29
    v_cndmask_b32 v29, v171, v29, vcc
    v_mul_f32 v172, 0x3fb8aa3b, v30
    v_exp_f32 v172, v172
    v_cmp_lt_f32 vcc, 0, v30
    v_add_f32 v30, 1.0, v30
    v_cndmask_b32 v30, v172, v30, vcc
    v_mul_f32 v173, 0x3fb8aa3b, v31
    v_exp_f32 v173, v173
    v_cmp_lt_f32 vcc, 0, v31
    v_add_f32 v31, 1.0, v31
    v_cndmask_b32 v31, v173, v31, vcc
    v_cvt_pk_bf16_f32 v168, v28, v29
    v_lshlrev_b32 v28, 16, v168
    v_and_b32 v29, 0xffff0000, v168
    v_cvt_pk_bf16_f32 v169, v30, v31
    v_lshlrev_b32 v30, 16, v169
    v_and_b32 v31, 0xffff0000, v169
    v_add_f32 v28, 0x358637bd, v28
    v_add_f32 v29, 0x358637bd, v29
    v_add_f32 v30, 0x358637bd, v30
    v_add_f32 v31, 0x358637bd, v31
    v_cvt_pk_bf16_f32 v174, v28, v29
    v_cvt_pk_bf16_f32 v175, v30, v31
    buffer_store_dwordx2 v[174:175], v166, s[56:59], s66 offen offset:96
    s_nop 1
    v_fma_f32 v32, -v162, v156, v32
    v_mul_f32 v32, v32, v163
    v_fma_f32 v33, -v162, v157, v33
    v_mul_f32 v33, v33, v163
    v_fma_f32 v34, -v162, v158, v34
    v_mul_f32 v34, v34, v163
    v_fma_f32 v35, -v162, v159, v35
    v_mul_f32 v35, v35, v163
    v_cvt_pk_bf16_f32 v168, v32, v33
    v_lshlrev_b32 v32, 16, v168
    v_and_b32 v33, 0xffff0000, v168
    v_cvt_pk_bf16_f32 v169, v34, v35
    v_lshlrev_b32 v34, 16, v169
    v_and_b32 v35, 0xffff0000, v169
    v_mul_f32 v170, 0x3fb8aa3b, v32
    v_exp_f32 v170, v170
    v_cmp_lt_f32 vcc, 0, v32
    v_add_f32 v32, 1.0, v32
    v_cndmask_b32 v32, v170, v32, vcc
    v_mul_f32 v171, 0x3fb8aa3b, v33
    v_exp_f32 v171, v171
    v_cmp_lt_f32 vcc, 0, v33
    v_add_f32 v33, 1.0, v33
    v_cndmask_b32 v33, v171, v33, vcc
    v_mul_f32 v172, 0x3fb8aa3b, v34
    v_exp_f32 v172, v172
    v_cmp_lt_f32 vcc, 0, v34
    v_add_f32 v34, 1.0, v34
    v_cndmask_b32 v34, v172, v34, vcc
    v_mul_f32 v173, 0x3fb8aa3b, v35
    v_exp_f32 v173, v173
    v_cmp_lt_f32 vcc, 0, v35
    v_add_f32 v35, 1.0, v35
    v_cndmask_b32 v35, v173, v35, vcc
    v_cvt_pk_bf16_f32 v168, v32, v33
    v_lshlrev_b32 v32, 16, v168
    v_and_b32 v33, 0xffff0000, v168
    v_cvt_pk_bf16_f32 v169, v34, v35
    v_lshlrev_b32 v34, 16, v169
    v_and_b32 v35, 0xffff0000, v169
    v_add_f32 v32, 0x358637bd, v32
    v_add_f32 v33, 0x358637bd, v33
    v_add_f32 v34, 0x358637bd, v34
    v_add_f32 v35, 0x358637bd, v35
    v_cvt_pk_bf16_f32 v174, v32, v33
    v_cvt_pk_bf16_f32 v175, v34, v35
    buffer_store_dwordx2 v[174:175], v166, s[56:59], s66 offen offset:112
    s_nop 1
    v_fma_f32 v36, -v164, v128, v36
    v_mul_f32 v36, v36, v165
    v_fma_f32 v37, -v164, v129, v37
    v_mul_f32 v37, v37, v165
    v_fma_f32 v38, -v164, v130, v38
    v_mul_f32 v38, v38, v165
    v_fma_f32 v39, -v164, v131, v39
    v_mul_f32 v39, v39, v165
    v_cvt_pk_bf16_f32 v168, v36, v37
    v_lshlrev_b32 v36, 16, v168
    v_and_b32 v37, 0xffff0000, v168
    v_cvt_pk_bf16_f32 v169, v38, v39
    v_lshlrev_b32 v38, 16, v169
    v_and_b32 v39, 0xffff0000, v169
    v_mul_f32 v170, 0x3fb8aa3b, v36
    v_exp_f32 v170, v170
    v_cmp_lt_f32 vcc, 0, v36
    v_add_f32 v36, 1.0, v36
    v_cndmask_b32 v36, v170, v36, vcc
    v_mul_f32 v171, 0x3fb8aa3b, v37
    v_exp_f32 v171, v171
    v_cmp_lt_f32 vcc, 0, v37
    v_add_f32 v37, 1.0, v37
    v_cndmask_b32 v37, v171, v37, vcc
    v_mul_f32 v172, 0x3fb8aa3b, v38
    v_exp_f32 v172, v172
    v_cmp_lt_f32 vcc, 0, v38
    v_add_f32 v38, 1.0, v38
    v_cndmask_b32 v38, v172, v38, vcc
    v_mul_f32 v173, 0x3fb8aa3b, v39
    v_exp_f32 v173, v173
    v_cmp_lt_f32 vcc, 0, v39
    v_add_f32 v39, 1.0, v39
    v_cndmask_b32 v39, v173, v39, vcc
    v_cvt_pk_bf16_f32 v168, v36, v37
    v_lshlrev_b32 v36, 16, v168
    v_and_b32 v37, 0xffff0000, v168
    v_cvt_pk_bf16_f32 v169, v38, v39
    v_lshlrev_b32 v38, 16, v169
    v_and_b32 v39, 0xffff0000, v169
    v_add_f32 v36, 0x358637bd, v36
    v_add_f32 v37, 0x358637bd, v37
    v_add_f32 v38, 0x358637bd, v38
    v_add_f32 v39, 0x358637bd, v39
    v_cvt_pk_bf16_f32 v174, v36, v37
    v_cvt_pk_bf16_f32 v175, v38, v39
    buffer_store_dwordx2 v[174:175], v167, s[56:59], s66 offen offset:0
    s_nop 1
    v_fma_f32 v40, -v164, v132, v40
    v_mul_f32 v40, v40, v165
    v_fma_f32 v41, -v164, v133, v41
    v_mul_f32 v41, v41, v165
    v_fma_f32 v42, -v164, v134, v42
    v_mul_f32 v42, v42, v165
    v_fma_f32 v43, -v164, v135, v43
    v_mul_f32 v43, v43, v165
    v_cvt_pk_bf16_f32 v168, v40, v41
    v_lshlrev_b32 v40, 16, v168
    v_and_b32 v41, 0xffff0000, v168
    v_cvt_pk_bf16_f32 v169, v42, v43
    v_lshlrev_b32 v42, 16, v169
    v_and_b32 v43, 0xffff0000, v169
    v_mul_f32 v170, 0x3fb8aa3b, v40
    v_exp_f32 v170, v170
    v_cmp_lt_f32 vcc, 0, v40
    v_add_f32 v40, 1.0, v40
    v_cndmask_b32 v40, v170, v40, vcc
    v_mul_f32 v171, 0x3fb8aa3b, v41
    v_exp_f32 v171, v171
    v_cmp_lt_f32 vcc, 0, v41
    v_add_f32 v41, 1.0, v41
    v_cndmask_b32 v41, v171, v41, vcc
    v_mul_f32 v172, 0x3fb8aa3b, v42
    v_exp_f32 v172, v172
    v_cmp_lt_f32 vcc, 0, v42
    v_add_f32 v42, 1.0, v42
    v_cndmask_b32 v42, v172, v42, vcc
    v_mul_f32 v173, 0x3fb8aa3b, v43
    v_exp_f32 v173, v173
    v_cmp_lt_f32 vcc, 0, v43
    v_add_f32 v43, 1.0, v43
    v_cndmask_b32 v43, v173, v43, vcc
    v_cvt_pk_bf16_f32 v168, v40, v41
    v_lshlrev_b32 v40, 16, v168
    v_and_b32 v41, 0xffff0000, v168
    v_cvt_pk_bf16_f32 v169, v42, v43
    v_lshlrev_b32 v42, 16, v169
    v_and_b32 v43, 0xffff0000, v169
    v_add_f32 v40, 0x358637bd, v40
    v_add_f32 v41, 0x358637bd, v41
    v_add_f32 v42, 0x358637bd, v42
    v_add_f32 v43, 0x358637bd, v43
    v_cvt_pk_bf16_f32 v174, v40, v41
    v_cvt_pk_bf16_f32 v175, v42, v43
    buffer_store_dwordx2 v[174:175], v167, s[56:59], s66 offen offset:16
    s_nop 1
    v_fma_f32 v44, -v164, v136, v44
    v_mul_f32 v44, v44, v165
    v_fma_f32 v45, -v164, v137, v45
    v_mul_f32 v45, v45, v165
    v_fma_f32 v46, -v164, v138, v46
    v_mul_f32 v46, v46, v165
    v_fma_f32 v47, -v164, v139, v47
    v_mul_f32 v47, v47, v165
    v_cvt_pk_bf16_f32 v168, v44, v45
    v_lshlrev_b32 v44, 16, v168
    v_and_b32 v45, 0xffff0000, v168
    v_cvt_pk_bf16_f32 v169, v46, v47
    v_lshlrev_b32 v46, 16, v169
    v_and_b32 v47, 0xffff0000, v169
    v_mul_f32 v170, 0x3fb8aa3b, v44
    v_exp_f32 v170, v170
    v_cmp_lt_f32 vcc, 0, v44
    v_add_f32 v44, 1.0, v44
    v_cndmask_b32 v44, v170, v44, vcc
    v_mul_f32 v171, 0x3fb8aa3b, v45
    v_exp_f32 v171, v171
    v_cmp_lt_f32 vcc, 0, v45
    v_add_f32 v45, 1.0, v45
    v_cndmask_b32 v45, v171, v45, vcc
    v_mul_f32 v172, 0x3fb8aa3b, v46
    v_exp_f32 v172, v172
    v_cmp_lt_f32 vcc, 0, v46
    v_add_f32 v46, 1.0, v46
    v_cndmask_b32 v46, v172, v46, vcc
    v_mul_f32 v173, 0x3fb8aa3b, v47
    v_exp_f32 v173, v173
    v_cmp_lt_f32 vcc, 0, v47
    v_add_f32 v47, 1.0, v47
    v_cndmask_b32 v47, v173, v47, vcc
    v_cvt_pk_bf16_f32 v168, v44, v45
    v_lshlrev_b32 v44, 16, v168
    v_and_b32 v45, 0xffff0000, v168
    v_cvt_pk_bf16_f32 v169, v46, v47
    v_lshlrev_b32 v46, 16, v169
    v_and_b32 v47, 0xffff0000, v169
    v_add_f32 v44, 0x358637bd, v44
    v_add_f32 v45, 0x358637bd, v45
    v_add_f32 v46, 0x358637bd, v46
    v_add_f32 v47, 0x358637bd, v47
    v_cvt_pk_bf16_f32 v174, v44, v45
    v_cvt_pk_bf16_f32 v175, v46, v47
    buffer_store_dwordx2 v[174:175], v167, s[56:59], s66 offen offset:32
    s_nop 1
    v_fma_f32 v48, -v164, v140, v48
    v_mul_f32 v48, v48, v165
    v_fma_f32 v49, -v164, v141, v49
    v_mul_f32 v49, v49, v165
    v_fma_f32 v50, -v164, v142, v50
    v_mul_f32 v50, v50, v165
    v_fma_f32 v51, -v164, v143, v51
    v_mul_f32 v51, v51, v165
    v_cvt_pk_bf16_f32 v168, v48, v49
    v_lshlrev_b32 v48, 16, v168
    v_and_b32 v49, 0xffff0000, v168
    v_cvt_pk_bf16_f32 v169, v50, v51
    v_lshlrev_b32 v50, 16, v169
    v_and_b32 v51, 0xffff0000, v169
    v_mul_f32 v170, 0x3fb8aa3b, v48
    v_exp_f32 v170, v170
    v_cmp_lt_f32 vcc, 0, v48
    v_add_f32 v48, 1.0, v48
    v_cndmask_b32 v48, v170, v48, vcc
    v_mul_f32 v171, 0x3fb8aa3b, v49
    v_exp_f32 v171, v171
    v_cmp_lt_f32 vcc, 0, v49
    v_add_f32 v49, 1.0, v49
    v_cndmask_b32 v49, v171, v49, vcc
    v_mul_f32 v172, 0x3fb8aa3b, v50
    v_exp_f32 v172, v172
    v_cmp_lt_f32 vcc, 0, v50
    v_add_f32 v50, 1.0, v50
    v_cndmask_b32 v50, v172, v50, vcc
    v_mul_f32 v173, 0x3fb8aa3b, v51
    v_exp_f32 v173, v173
    v_cmp_lt_f32 vcc, 0, v51
    v_add_f32 v51, 1.0, v51
    v_cndmask_b32 v51, v173, v51, vcc
    v_cvt_pk_bf16_f32 v168, v48, v49
    v_lshlrev_b32 v48, 16, v168
    v_and_b32 v49, 0xffff0000, v168
    v_cvt_pk_bf16_f32 v169, v50, v51
    v_lshlrev_b32 v50, 16, v169
    v_and_b32 v51, 0xffff0000, v169
    v_add_f32 v48, 0x358637bd, v48
    v_add_f32 v49, 0x358637bd, v49
    v_add_f32 v50, 0x358637bd, v50
    v_add_f32 v51, 0x358637bd, v51
    v_cvt_pk_bf16_f32 v174, v48, v49
    v_cvt_pk_bf16_f32 v175, v50, v51
    buffer_store_dwordx2 v[174:175], v167, s[56:59], s66 offen offset:48
    s_nop 1
    v_fma_f32 v52, -v164, v144, v52
    v_mul_f32 v52, v52, v165
    v_fma_f32 v53, -v164, v145, v53
    v_mul_f32 v53, v53, v165
    v_fma_f32 v54, -v164, v146, v54
    v_mul_f32 v54, v54, v165
    v_fma_f32 v55, -v164, v147, v55
    v_mul_f32 v55, v55, v165
    v_cvt_pk_bf16_f32 v168, v52, v53
    v_lshlrev_b32 v52, 16, v168
    v_and_b32 v53, 0xffff0000, v168
    v_cvt_pk_bf16_f32 v169, v54, v55
    v_lshlrev_b32 v54, 16, v169
    v_and_b32 v55, 0xffff0000, v169
    v_mul_f32 v170, 0x3fb8aa3b, v52
    v_exp_f32 v170, v170
    v_cmp_lt_f32 vcc, 0, v52
    v_add_f32 v52, 1.0, v52
    v_cndmask_b32 v52, v170, v52, vcc
    v_mul_f32 v171, 0x3fb8aa3b, v53
    v_exp_f32 v171, v171
    v_cmp_lt_f32 vcc, 0, v53
    v_add_f32 v53, 1.0, v53
    v_cndmask_b32 v53, v171, v53, vcc
    v_mul_f32 v172, 0x3fb8aa3b, v54
    v_exp_f32 v172, v172
    v_cmp_lt_f32 vcc, 0, v54
    v_add_f32 v54, 1.0, v54
    v_cndmask_b32 v54, v172, v54, vcc
    v_mul_f32 v173, 0x3fb8aa3b, v55
    v_exp_f32 v173, v173
    v_cmp_lt_f32 vcc, 0, v55
    v_add_f32 v55, 1.0, v55
    v_cndmask_b32 v55, v173, v55, vcc
    v_cvt_pk_bf16_f32 v168, v52, v53
    v_lshlrev_b32 v52, 16, v168
    v_and_b32 v53, 0xffff0000, v168
    v_cvt_pk_bf16_f32 v169, v54, v55
    v_lshlrev_b32 v54, 16, v169
    v_and_b32 v55, 0xffff0000, v169
    v_add_f32 v52, 0x358637bd, v52
    v_add_f32 v53, 0x358637bd, v53
    v_add_f32 v54, 0x358637bd, v54
    v_add_f32 v55, 0x358637bd, v55
    v_cvt_pk_bf16_f32 v174, v52, v53
    v_cvt_pk_bf16_f32 v175, v54, v55
    buffer_store_dwordx2 v[174:175], v167, s[56:59], s66 offen offset:64
    s_nop 1
    v_fma_f32 v56, -v164, v148, v56
    v_mul_f32 v56, v56, v165
    v_fma_f32 v57, -v164, v149, v57
    v_mul_f32 v57, v57, v165
    v_fma_f32 v58, -v164, v150, v58
    v_mul_f32 v58, v58, v165
    v_fma_f32 v59, -v164, v151, v59
    v_mul_f32 v59, v59, v165
    v_cvt_pk_bf16_f32 v168, v56, v57
    v_lshlrev_b32 v56, 16, v168
    v_and_b32 v57, 0xffff0000, v168
    v_cvt_pk_bf16_f32 v169, v58, v59
    v_lshlrev_b32 v58, 16, v169
    v_and_b32 v59, 0xffff0000, v169
    v_mul_f32 v170, 0x3fb8aa3b, v56
    v_exp_f32 v170, v170
    v_cmp_lt_f32 vcc, 0, v56
    v_add_f32 v56, 1.0, v56
    v_cndmask_b32 v56, v170, v56, vcc
    v_mul_f32 v171, 0x3fb8aa3b, v57
    v_exp_f32 v171, v171
    v_cmp_lt_f32 vcc, 0, v57
    v_add_f32 v57, 1.0, v57
    v_cndmask_b32 v57, v171, v57, vcc
    v_mul_f32 v172, 0x3fb8aa3b, v58
    v_exp_f32 v172, v172
    v_cmp_lt_f32 vcc, 0, v58
    v_add_f32 v58, 1.0, v58
    v_cndmask_b32 v58, v172, v58, vcc
    v_mul_f32 v173, 0x3fb8aa3b, v59
    v_exp_f32 v173, v173
    v_cmp_lt_f32 vcc, 0, v59
    v_add_f32 v59, 1.0, v59
    v_cndmask_b32 v59, v173, v59, vcc
    v_cvt_pk_bf16_f32 v168, v56, v57
    v_lshlrev_b32 v56, 16, v168
    v_and_b32 v57, 0xffff0000, v168
    v_cvt_pk_bf16_f32 v169, v58, v59
    v_lshlrev_b32 v58, 16, v169
    v_and_b32 v59, 0xffff0000, v169
    v_add_f32 v56, 0x358637bd, v56
    v_add_f32 v57, 0x358637bd, v57
    v_add_f32 v58, 0x358637bd, v58
    v_add_f32 v59, 0x358637bd, v59
    v_cvt_pk_bf16_f32 v174, v56, v57
    v_cvt_pk_bf16_f32 v175, v58, v59
    buffer_store_dwordx2 v[174:175], v167, s[56:59], s66 offen offset:80
    s_nop 1
    v_fma_f32 v60, -v164, v152, v60
    v_mul_f32 v60, v60, v165
    v_fma_f32 v61, -v164, v153, v61
    v_mul_f32 v61, v61, v165
    v_fma_f32 v62, -v164, v154, v62
    v_mul_f32 v62, v62, v165
    v_fma_f32 v63, -v164, v155, v63
    v_mul_f32 v63, v63, v165
    v_cvt_pk_bf16_f32 v168, v60, v61
    v_lshlrev_b32 v60, 16, v168
    v_and_b32 v61, 0xffff0000, v168
    v_cvt_pk_bf16_f32 v169, v62, v63
    v_lshlrev_b32 v62, 16, v169
    v_and_b32 v63, 0xffff0000, v169
    v_mul_f32 v170, 0x3fb8aa3b, v60
    v_exp_f32 v170, v170
    v_cmp_lt_f32 vcc, 0, v60
    v_add_f32 v60, 1.0, v60
    v_cndmask_b32 v60, v170, v60, vcc
    v_mul_f32 v171, 0x3fb8aa3b, v61
    v_exp_f32 v171, v171
    v_cmp_lt_f32 vcc, 0, v61
    v_add_f32 v61, 1.0, v61
    v_cndmask_b32 v61, v171, v61, vcc
    v_mul_f32 v172, 0x3fb8aa3b, v62
    v_exp_f32 v172, v172
    v_cmp_lt_f32 vcc, 0, v62
    v_add_f32 v62, 1.0, v62
    v_cndmask_b32 v62, v172, v62, vcc
    v_mul_f32 v173, 0x3fb8aa3b, v63
    v_exp_f32 v173, v173
    v_cmp_lt_f32 vcc, 0, v63
    v_add_f32 v63, 1.0, v63
    v_cndmask_b32 v63, v173, v63, vcc
    v_cvt_pk_bf16_f32 v168, v60, v61
    v_lshlrev_b32 v60, 16, v168
    v_and_b32 v61, 0xffff0000, v168
    v_cvt_pk_bf16_f32 v169, v62, v63
    v_lshlrev_b32 v62, 16, v169
    v_and_b32 v63, 0xffff0000, v169
    v_add_f32 v60, 0x358637bd, v60
    v_add_f32 v61, 0x358637bd, v61
    v_add_f32 v62, 0x358637bd, v62
    v_add_f32 v63, 0x358637bd, v63
    v_cvt_pk_bf16_f32 v174, v60, v61
    v_cvt_pk_bf16_f32 v175, v62, v63
    buffer_store_dwordx2 v[174:175], v167, s[56:59], s66 offen offset:96
    s_nop 1
    v_fma_f32 v64, -v164, v156, v64
    v_mul_f32 v64, v64, v165
    v_fma_f32 v65, -v164, v157, v65
    v_mul_f32 v65, v65, v165
    v_fma_f32 v66, -v164, v158, v66
    v_mul_f32 v66, v66, v165
    v_fma_f32 v67, -v164, v159, v67
    v_mul_f32 v67, v67, v165
    v_cvt_pk_bf16_f32 v168, v64, v65
    v_lshlrev_b32 v64, 16, v168
    v_and_b32 v65, 0xffff0000, v168
    v_cvt_pk_bf16_f32 v169, v66, v67
    v_lshlrev_b32 v66, 16, v169
    v_and_b32 v67, 0xffff0000, v169
    v_mul_f32 v170, 0x3fb8aa3b, v64
    v_exp_f32 v170, v170
    v_cmp_lt_f32 vcc, 0, v64
    v_add_f32 v64, 1.0, v64
    v_cndmask_b32 v64, v170, v64, vcc
    v_mul_f32 v171, 0x3fb8aa3b, v65
    v_exp_f32 v171, v171
    v_cmp_lt_f32 vcc, 0, v65
    v_add_f32 v65, 1.0, v65
    v_cndmask_b32 v65, v171, v65, vcc
    v_mul_f32 v172, 0x3fb8aa3b, v66
    v_exp_f32 v172, v172
    v_cmp_lt_f32 vcc, 0, v66
    v_add_f32 v66, 1.0, v66
    v_cndmask_b32 v66, v172, v66, vcc
    v_mul_f32 v173, 0x3fb8aa3b, v67
    v_exp_f32 v173, v173
    v_cmp_lt_f32 vcc, 0, v67
    v_add_f32 v67, 1.0, v67
    v_cndmask_b32 v67, v173, v67, vcc
    v_cvt_pk_bf16_f32 v168, v64, v65
    v_lshlrev_b32 v64, 16, v168
    v_and_b32 v65, 0xffff0000, v168
    v_cvt_pk_bf16_f32 v169, v66, v67
    v_lshlrev_b32 v66, 16, v169
    v_and_b32 v67, 0xffff0000, v169
    v_add_f32 v64, 0x358637bd, v64
    v_add_f32 v65, 0x358637bd, v65
    v_add_f32 v66, 0x358637bd, v66
    v_add_f32 v67, 0x358637bd, v67
    v_cvt_pk_bf16_f32 v174, v64, v65
    v_cvt_pk_bf16_f32 v175, v66, v67
    buffer_store_dwordx2 v[174:175], v167, s[56:59], s66 offen offset:112
    s_nop 1
    s_endpgm
.k1p0_kernel_end:
    s_endpgm

.globl k2p0_kernel
.p2align 8
.type k2p0_kernel,@function
k2p0_kernel:
    s_cmp_ge_u32 s2, 160
    s_cbranch_scc1 .k2p0_kernel_end
    s_load_dwordx16 s[16:31], s[0:1], 0
    s_load_dwordx4 s[32:35], s[0:1], 64
    s_load_dwordx2 s[36:37], s[0:1], 80
    s_waitcnt lgkmcnt(0)
    s_and_b32 s61, s2, 31
    s_lshl_b32 s61, s61, 6
    s_lshr_b32 s62, s2, 5
    s_lshl_b32 s62, s62, 7
    s_add_u32 s44, s36, 2457600
    s_addc_u32 s45, s37, 0
    s_and_b32 s45, s45, 0xffff
    s_mov_b32 s46, 819200
    s_mov_b32 s47, 0x00020000
    v_and_b32 v76, 63, v0
    v_lshrrev_b32 v77, 6, v0
    s_nop 0
    v_readfirstlane_b32 s60, v77
    s_nop 1
    s_mul_i32 s63, s60, 0
    s_mul_i32 s64, s60, 4096
    s_mul_i32 s65, s60, 32
    s_add_u32 s65, s65, 0
    v_lshrrev_b32 v77, 3, v76
    v_add_u32 v77, s65, v77
    v_lshrrev_b32 v78, 1, v77
    v_and_b32 v78, 7, v78
    v_and_b32 v60, 7, v76
    v_xor_b32 v78, v60, v78
    v_lshlrev_b32 v78, 4, v78
    v_add_u32 v77, s62, v77
    s_mov_b32 s66, 1280
    v_mul_lo_u32 v77, v77, s66
    v_add_u32 v60, v77, v78
    s_mul_i32 s65, s60, 32
    s_add_u32 s65, s65, 8
    v_lshrrev_b32 v77, 3, v76
    v_add_u32 v77, s65, v77
    v_lshrrev_b32 v78, 1, v77
    v_and_b32 v78, 7, v78
    v_and_b32 v61, 7, v76
    v_xor_b32 v78, v61, v78
    v_lshlrev_b32 v78, 4, v78
    v_add_u32 v77, s62, v77
    s_mov_b32 s66, 1280
    v_mul_lo_u32 v77, v77, s66
    v_add_u32 v61, v77, v78
    s_mul_i32 s65, s60, 32
    s_add_u32 s65, s65, 16
    v_lshrrev_b32 v77, 3, v76
    v_add_u32 v77, s65, v77
    v_lshrrev_b32 v78, 1, v77
    v_and_b32 v78, 7, v78
    v_and_b32 v62, 7, v76
    v_xor_b32 v78, v62, v78
    v_lshlrev_b32 v78, 4, v78
    v_add_u32 v77, s62, v77
    s_mov_b32 s66, 1280
    v_mul_lo_u32 v77, v77, s66
    v_add_u32 v62, v77, v78
    s_mul_i32 s65, s60, 32
    s_add_u32 s65, s65, 24
    v_lshrrev_b32 v77, 3, v76
    v_add_u32 v77, s65, v77
    v_lshrrev_b32 v78, 1, v77
    v_and_b32 v78, 7, v78
    v_and_b32 v63, 7, v76
    v_xor_b32 v78, v63, v78
    v_lshlrev_b32 v78, 4, v78
    v_add_u32 v77, s62, v77
    s_mov_b32 s66, 1280
    v_mul_lo_u32 v77, v77, s66
    v_add_u32 v63, v77, v78
    s_and_b32 s67, s60, 1
    s_lshr_b32 s68, s60, 1
    v_lshrrev_b32 v77, 5, v76
    v_add_u32 v77, 0, v77
    v_lshrrev_b32 v78, 1, v76
    v_and_b32 v78, 7, v78
    v_xor_b32 v77, v77, v78
    v_lshlrev_b32 v77, 4, v77
    v_and_b32 v78, 31, v76
    v_lshl_add_u32 v77, v78, 7, v77
    s_mul_i32 s65, s68, 8192
    v_add_u32 v68, s65, v77
    v_add_u32 v72, 0x10000, v68
    v_lshrrev_b32 v77, 5, v76
    v_add_u32 v77, 2, v77
    v_lshrrev_b32 v78, 1, v76
    v_and_b32 v78, 7, v78
    v_xor_b32 v77, v77, v78
    v_lshlrev_b32 v77, 4, v77
    v_and_b32 v78, 31, v76
    v_lshl_add_u32 v77, v78, 7, v77
    s_mul_i32 s65, s68, 8192
    v_add_u32 v69, s65, v77
    v_add_u32 v73, 0x10000, v69
    v_lshrrev_b32 v77, 5, v76
    v_add_u32 v77, 4, v77
    v_lshrrev_b32 v78, 1, v76
    v_and_b32 v78, 7, v78
    v_xor_b32 v77, v77, v78
    v_lshlrev_b32 v77, 4, v77
    v_and_b32 v78, 31, v76
    v_lshl_add_u32 v77, v78, 7, v77
    s_mul_i32 s65, s68, 8192
    v_add_u32 v70, s65, v77
    v_add_u32 v74, 0x10000, v70
    v_lshrrev_b32 v77, 5, v76
    v_add_u32 v77, 6, v77
    v_lshrrev_b32 v78, 1, v76
    v_and_b32 v78, 7, v78
    v_xor_b32 v77, v77, v78
    v_lshlrev_b32 v77, 4, v77
    v_and_b32 v78, 31, v76
    v_lshl_add_u32 v77, v78, 7, v77
    s_mul_i32 s65, s68, 8192
    v_add_u32 v71, s65, v77
    v_add_u32 v75, 0x10000, v71
    v_mov_b32 v4, 0
    v_mov_b32 v5, 0
    v_mov_b32 v6, 0
    v_mov_b32 v7, 0
    v_mov_b32 v8, 0
    v_mov_b32 v9, 0
    v_mov_b32 v10, 0
    v_mov_b32 v11, 0
    v_mov_b32 v12, 0
    v_mov_b32 v13, 0
    v_mov_b32 v14, 0
    v_mov_b32 v15, 0
    v_mov_b32 v16, 0
    v_mov_b32 v17, 0
    v_mov_b32 v18, 0
    v_mov_b32 v19, 0
    v_mov_b32 v20, 0
    v_mov_b32 v21, 0
    v_mov_b32 v22, 0
    v_mov_b32 v23, 0
    v_mov_b32 v24, 0
    v_mov_b32 v25, 0
    v_mov_b32 v26, 0
    v_mov_b32 v27, 0
    v_mov_b32 v28, 0
    v_mov_b32 v29, 0
    v_mov_b32 v30, 0
    v_mov_b32 v31, 0
    v_mov_b32 v32, 0
    v_mov_b32 v33, 0
    v_mov_b32 v34, 0
    v_mov_b32 v35, 0
    s_mov_b32 s69, 0
    s_add_u32 m0, s64, 81920
    buffer_load_dwordx4 v60, s[44:47], s69 offen lds
    s_add_u32 m0, s64, 82944
    buffer_load_dwordx4 v61, s[44:47], s69 offen lds
    s_add_u32 m0, s64, 83968
    buffer_load_dwordx4 v62, s[44:47], s69 offen lds
    s_add_u32 m0, s64, 84992
    buffer_load_dwordx4 v63, s[44:47], s69 offen lds
    s_mov_b32 s69, 128
    s_add_u32 m0, s64, 98304
    buffer_load_dwordx4 v60, s[44:47], s69 offen lds
    s_add_u32 m0, s64, 99328
    buffer_load_dwordx4 v61, s[44:47], s69 offen lds
    s_add_u32 m0, s64, 100352
    buffer_load_dwordx4 v62, s[44:47], s69 offen lds
    s_add_u32 m0, s64, 101376
    buffer_load_dwordx4 v63, s[44:47], s69 offen lds
    v_lshrrev_b32 v77, 5, v76
    v_add_u32 v77, 0, v77
    v_and_b32 v78, 15, v76
    v_xor_b32 v77, v77, v78
    v_lshlrev_b32 v77, 4, v77
    v_and_b32 v78, 31, v76
    v_mul_u32_u24 v78, 1280, v78
    v_add_u32 v77, v77, v78
    s_mul_i32 s65, s67, 40960
    v_add_u32 v79, s65, v77
    v_lshrrev_b32 v77, 5, v76
    v_add_u32 v77, 2, v77
    v_and_b32 v78, 15, v76
    v_xor_b32 v77, v77, v78
    v_lshlrev_b32 v77, 4, v77
    v_and_b32 v78, 31, v76
    v_mul_u32_u24 v78, 1280, v78
    v_add_u32 v77, v77, v78
    s_mul_i32 s65, s67, 40960
    v_add_u32 v80, s65, v77
    v_lshrrev_b32 v77, 5, v76
    v_add_u32 v77, 4, v77
    v_and_b32 v78, 15, v76
    v_xor_b32 v77, v77, v78
    v_lshlrev_b32 v77, 4, v77
    v_and_b32 v78, 31, v76
    v_mul_u32_u24 v78, 1280, v78
    v_add_u32 v77, v77, v78
    s_mul_i32 s65, s67, 40960
    v_add_u32 v81, s65, v77
    v_lshrrev_b32 v77, 5, v76
    v_add_u32 v77, 6, v77
    v_and_b32 v78, 15, v76
    v_xor_b32 v77, v77, v78
    v_lshlrev_b32 v77, 4, v77
    v_and_b32 v78, 31, v76
    v_mul_u32_u24 v78, 1280, v78
    v_add_u32 v77, v77, v78
    s_mul_i32 s65, s67, 40960
    v_add_u32 v82, s65, v77
    v_lshrrev_b32 v77, 5, v76
    v_add_u32 v77, 8, v77
    v_and_b32 v78, 15, v76
    v_xor_b32 v77, v77, v78
    v_lshlrev_b32 v77, 4, v77
    v_and_b32 v78, 31, v76
    v_mul_u32_u24 v78, 1280, v78
    v_add_u32 v77, v77, v78
    s_mul_i32 s65, s67, 40960
    v_add_u32 v83, s65, v77
    v_lshrrev_b32 v77, 5, v76
    v_add_u32 v77, 10, v77
    v_and_b32 v78, 15, v76
    v_xor_b32 v77, v77, v78
    v_lshlrev_b32 v77, 4, v77
    v_and_b32 v78, 31, v76
    v_mul_u32_u24 v78, 1280, v78
    v_add_u32 v77, v77, v78
    s_mul_i32 s65, s67, 40960
    v_add_u32 v84, s65, v77
    v_lshrrev_b32 v77, 5, v76
    v_add_u32 v77, 12, v77
    v_and_b32 v78, 15, v76
    v_xor_b32 v77, v77, v78
    v_lshlrev_b32 v77, 4, v77
    v_and_b32 v78, 31, v76
    v_mul_u32_u24 v78, 1280, v78
    v_add_u32 v77, v77, v78
    s_mul_i32 s65, s67, 40960
    v_add_u32 v85, s65, v77
    v_lshrrev_b32 v77, 5, v76
    v_add_u32 v77, 14, v77
    v_and_b32 v78, 15, v76
    v_xor_b32 v77, v77, v78
    v_lshlrev_b32 v77, 4, v77
    v_and_b32 v78, 31, v76
    v_mul_u32_u24 v78, 1280, v78
    v_add_u32 v77, v77, v78
    s_mul_i32 s65, s67, 40960
    v_add_u32 v86, s65, v77
    s_add_u32 s72, s36, 8372224
    s_addc_u32 s73, s37, 0
    s_and_b32 s73, s73, 0xffff
    s_mov_b32 s74, 2621440
    s_mov_b32 s75, 0x00020000
    s_add_u32 s76, s36, 10993664
    s_addc_u32 s77, s37, 0
    s_and_b32 s77, s77, 0xffff
    s_mov_b32 s78, 166400
    s_mov_b32 s79, 0x00020000
    v_and_b32 v168, 31, v76
    v_add_u32 v168, s61, v168
    v_mul_u32_u24 v168, 1280, v168
    v_lshrrev_b32 v77, 5, v76
    v_lshl_add_u32 v168, v77, 4, v168
    s_mul_i32 s84, s60, 320
    buffer_load_dwordx4 v[88:91], v168, s[72:75], s84 offen offset:0
    s_add_u32 s85, s84, 40960
    buffer_load_dwordx4 v[92:95], v168, s[72:75], s85 offen offset:0
    buffer_load_dwordx4 v[96:99], v168, s[72:75], s84 offen offset:32
    s_add_u32 s85, s84, 40960
    buffer_load_dwordx4 v[100:103], v168, s[72:75], s85 offen offset:32
    buffer_load_dwordx4 v[104:107], v168, s[72:75], s84 offen offset:64
    s_add_u32 s85, s84, 40960
    buffer_load_dwordx4 v[108:111], v168, s[72:75], s85 offen offset:64
    buffer_load_dwordx4 v[112:115], v168, s[72:75], s84 offen offset:96
    s_add_u32 s85, s84, 40960
    buffer_load_dwordx4 v[116:119], v168, s[72:75], s85 offen offset:96
    buffer_load_dwordx4 v[120:123], v168, s[72:75], s84 offen offset:128
    s_add_u32 s85, s84, 40960
    buffer_load_dwordx4 v[124:127], v168, s[72:75], s85 offen offset:128
    buffer_load_dwordx4 v[128:131], v168, s[72:75], s84 offen offset:160
    s_add_u32 s85, s84, 40960
    buffer_load_dwordx4 v[132:135], v168, s[72:75], s85 offen offset:160
    buffer_load_dwordx4 v[136:139], v168, s[72:75], s84 offen offset:192
    s_add_u32 s85, s84, 40960
    buffer_load_dwordx4 v[140:143], v168, s[72:75], s85 offen offset:192
    buffer_load_dwordx4 v[144:147], v168, s[72:75], s84 offen offset:224
    s_add_u32 s85, s84, 40960
    buffer_load_dwordx4 v[148:151], v168, s[72:75], s85 offen offset:224
    buffer_load_dwordx4 v[152:155], v168, s[72:75], s84 offen offset:256
    s_add_u32 s85, s84, 40960
    buffer_load_dwordx4 v[156:159], v168, s[72:75], s85 offen offset:256
    buffer_load_dwordx4 v[160:163], v168, s[72:75], s84 offen offset:288
    s_add_u32 s85, s84, 40960
    buffer_load_dwordx4 v[164:167], v168, s[72:75], s85 offen offset:288
    v_and_b32 v169, 31, v76
    v_lshlrev_b32 v169, 8, v169
    v_lshl_add_u32 v169, v77, 5, v169
    s_mul_i32 s86, s60, 40960
    v_mov_b32 v184, 0
    v_mov_b32 v185, 0
    v_mov_b32 v186, 0
    v_mov_b32 v187, 0
    v_mov_b32 v188, 0
    v_mov_b32 v189, 0
    v_mov_b32 v190, 0
    v_mov_b32 v191, 0
    v_mov_b32 v192, 0
    v_mov_b32 v193, 0
    v_mov_b32 v194, 0
    v_mov_b32 v195, 0
    v_mov_b32 v196, 0
    v_mov_b32 v197, 0
    v_mov_b32 v198, 0
    v_mov_b32 v199, 0
    v_mov_b32 v200, 0
    v_mov_b32 v201, 0
    v_mov_b32 v202, 0
    v_mov_b32 v203, 0
    v_mov_b32 v204, 0
    v_mov_b32 v205, 0
    v_mov_b32 v206, 0
    v_mov_b32 v207, 0
    v_mov_b32 v208, 0
    v_mov_b32 v209, 0
    v_mov_b32 v210, 0
    v_mov_b32 v211, 0
    v_mov_b32 v212, 0
    v_mov_b32 v213, 0
    v_mov_b32 v214, 0
    v_mov_b32 v215, 0
    s_mul_i32 s87, s60, 640
    s_add_u32 s87, s87, 163840
    v_lshrrev_b32 v226, 5, v76
    v_lshlrev_b32 v226, 5, v226
    v_mov_b32 v180, 0
    v_mov_b32 v181, 0
    v_mov_b32 v182, 0
    v_mov_b32 v183, 0
    s_mov_b32 exec_lo, 1
    s_mov_b32 exec_hi, 1
    buffer_load_dwordx2 v[224:225], v226, s[76:79], s87 offen offset:0
    s_waitcnt vmcnt(0)
    v_cvt_pk_bf16_f32 v180, v224, v225
    s_mov_b32 exec_lo, 1
    s_mov_b32 exec_hi, 1
    buffer_load_dwordx2 v[224:225], v226, s[76:79], s87 offen offset:8
    s_waitcnt vmcnt(0)
    v_cvt_pk_bf16_f32 v181, v224, v225
    s_mov_b32 exec_lo, 1
    s_mov_b32 exec_hi, 1
    buffer_load_dwordx2 v[224:225], v226, s[76:79], s87 offen offset:16
    s_waitcnt vmcnt(0)
    v_cvt_pk_bf16_f32 v182, v224, v225
    s_mov_b32 exec_lo, 1
    s_mov_b32 exec_hi, 1
    buffer_load_dwordx2 v[224:225], v226, s[76:79], s87 offen offset:24
    s_waitcnt vmcnt(0)
    v_cvt_pk_bf16_f32 v183, v224, v225
    s_mov_b64 exec, -1
    s_nop 1
    v_mfma_f32_32x32x16_bf16 v[184:199], v[180:183], v[88:91], v[184:199]
    v_mfma_f32_32x32x16_bf16 v[200:215], v[180:183], v[92:95], v[200:215]
    s_nop 4
    v_mov_b32 v180, 0
    v_mov_b32 v181, 0
    v_mov_b32 v182, 0
    v_mov_b32 v183, 0
    s_mov_b32 exec_lo, 1
    s_mov_b32 exec_hi, 2
    buffer_load_dwordx2 v[224:225], v226, s[76:79], s87 offen offset:64
    s_waitcnt vmcnt(0)
    v_cvt_pk_bf16_f32 v180, v224, v225
    s_mov_b32 exec_lo, 1
    s_mov_b32 exec_hi, 2
    buffer_load_dwordx2 v[224:225], v226, s[76:79], s87 offen offset:72
    s_waitcnt vmcnt(0)
    v_cvt_pk_bf16_f32 v181, v224, v225
    s_mov_b32 exec_lo, 2
    s_mov_b32 exec_hi, 2
    buffer_load_dwordx2 v[224:225], v226, s[76:79], s87 offen offset:80
    s_waitcnt vmcnt(0)
    v_cvt_pk_bf16_f32 v182, v224, v225
    s_mov_b32 exec_lo, 2
    s_mov_b32 exec_hi, 2
    buffer_load_dwordx2 v[224:225], v226, s[76:79], s87 offen offset:88
    s_waitcnt vmcnt(0)
    v_cvt_pk_bf16_f32 v183, v224, v225
    s_mov_b64 exec, -1
    s_nop 1
    v_mfma_f32_32x32x16_bf16 v[184:199], v[180:183], v[96:99], v[184:199]
    v_mfma_f32_32x32x16_bf16 v[200:215], v[180:183], v[100:103], v[200:215]
    s_nop 4
    v_mov_b32 v180, 0
    v_mov_b32 v181, 0
    v_mov_b32 v182, 0
    v_mov_b32 v183, 0
    s_mov_b32 exec_lo, 2
    s_mov_b32 exec_hi, 4
    buffer_load_dwordx2 v[224:225], v226, s[76:79], s87 offen offset:128
    s_waitcnt vmcnt(0)
    v_cvt_pk_bf16_f32 v180, v224, v225
    s_mov_b32 exec_lo, 2
    s_mov_b32 exec_hi, 4
    buffer_load_dwordx2 v[224:225], v226, s[76:79], s87 offen offset:136
    s_waitcnt vmcnt(0)
    v_cvt_pk_bf16_f32 v181, v224, v225
    s_mov_b32 exec_lo, 2
    s_mov_b32 exec_hi, 4
    buffer_load_dwordx2 v[224:225], v226, s[76:79], s87 offen offset:144
    s_waitcnt vmcnt(0)
    v_cvt_pk_bf16_f32 v182, v224, v225
    s_mov_b32 exec_lo, 2
    s_mov_b32 exec_hi, 4
    buffer_load_dwordx2 v[224:225], v226, s[76:79], s87 offen offset:152
    s_waitcnt vmcnt(0)
    v_cvt_pk_bf16_f32 v183, v224, v225
    s_mov_b64 exec, -1
    s_nop 1
    v_mfma_f32_32x32x16_bf16 v[184:199], v[180:183], v[104:107], v[184:199]
    v_mfma_f32_32x32x16_bf16 v[200:215], v[180:183], v[108:111], v[200:215]
    s_nop 4
    v_mov_b32 v180, 0
    v_mov_b32 v181, 0
    v_mov_b32 v182, 0
    v_mov_b32 v183, 0
    s_mov_b32 exec_lo, 4
    s_mov_b32 exec_hi, 4
    buffer_load_dwordx2 v[224:225], v226, s[76:79], s87 offen offset:192
    s_waitcnt vmcnt(0)
    v_cvt_pk_bf16_f32 v180, v224, v225
    s_mov_b32 exec_lo, 4
    s_mov_b32 exec_hi, 4
    buffer_load_dwordx2 v[224:225], v226, s[76:79], s87 offen offset:200
    s_waitcnt vmcnt(0)
    v_cvt_pk_bf16_f32 v181, v224, v225
    s_mov_b32 exec_lo, 4
    s_mov_b32 exec_hi, 8
    buffer_load_dwordx2 v[224:225], v226, s[76:79], s87 offen offset:208
    s_waitcnt vmcnt(0)
    v_cvt_pk_bf16_f32 v182, v224, v225
    s_mov_b32 exec_lo, 4
    s_mov_b32 exec_hi, 8
    buffer_load_dwordx2 v[224:225], v226, s[76:79], s87 offen offset:216
    s_waitcnt vmcnt(0)
    v_cvt_pk_bf16_f32 v183, v224, v225
    s_mov_b64 exec, -1
    s_nop 1
    v_mfma_f32_32x32x16_bf16 v[184:199], v[180:183], v[112:115], v[184:199]
    v_mfma_f32_32x32x16_bf16 v[200:215], v[180:183], v[116:119], v[200:215]
    s_nop 4
    v_mov_b32 v180, 0
    v_mov_b32 v181, 0
    v_mov_b32 v182, 0
    v_mov_b32 v183, 0
    s_mov_b32 exec_lo, 8
    s_mov_b32 exec_hi, 8
    buffer_load_dwordx2 v[224:225], v226, s[76:79], s87 offen offset:256
    s_waitcnt vmcnt(0)
    v_cvt_pk_bf16_f32 v180, v224, v225
    s_mov_b32 exec_lo, 8
    s_mov_b32 exec_hi, 8
    buffer_load_dwordx2 v[224:225], v226, s[76:79], s87 offen offset:264
    s_waitcnt vmcnt(0)
    v_cvt_pk_bf16_f32 v181, v224, v225
    s_mov_b32 exec_lo, 8
    s_mov_b32 exec_hi, 8
    buffer_load_dwordx2 v[224:225], v226, s[76:79], s87 offen offset:272
    s_waitcnt vmcnt(0)
    v_cvt_pk_bf16_f32 v182, v224, v225
    s_mov_b32 exec_lo, 8
    s_mov_b32 exec_hi, 8
    buffer_load_dwordx2 v[224:225], v226, s[76:79], s87 offen offset:280
    s_waitcnt vmcnt(0)
    v_cvt_pk_bf16_f32 v183, v224, v225
    s_mov_b64 exec, -1
    s_nop 1
    v_mfma_f32_32x32x16_bf16 v[184:199], v[180:183], v[120:123], v[184:199]
    v_mfma_f32_32x32x16_bf16 v[200:215], v[180:183], v[124:127], v[200:215]
    s_nop 4
    v_mov_b32 v180, 0
    v_mov_b32 v181, 0
    v_mov_b32 v182, 0
    v_mov_b32 v183, 0
    s_mov_b32 exec_lo, 16
    s_mov_b32 exec_hi, 16
    buffer_load_dwordx2 v[224:225], v226, s[76:79], s87 offen offset:320
    s_waitcnt vmcnt(0)
    v_cvt_pk_bf16_f32 v180, v224, v225
    s_mov_b32 exec_lo, 16
    s_mov_b32 exec_hi, 16
    buffer_load_dwordx2 v[224:225], v226, s[76:79], s87 offen offset:328
    s_waitcnt vmcnt(0)
    v_cvt_pk_bf16_f32 v181, v224, v225
    s_mov_b32 exec_lo, 16
    s_mov_b32 exec_hi, 16
    buffer_load_dwordx2 v[224:225], v226, s[76:79], s87 offen offset:336
    s_waitcnt vmcnt(0)
    v_cvt_pk_bf16_f32 v182, v224, v225
    s_mov_b32 exec_lo, 16
    s_mov_b32 exec_hi, 16
    buffer_load_dwordx2 v[224:225], v226, s[76:79], s87 offen offset:344
    s_waitcnt vmcnt(0)
    v_cvt_pk_bf16_f32 v183, v224, v225
    s_mov_b64 exec, -1
    s_nop 1
    v_mfma_f32_32x32x16_bf16 v[184:199], v[180:183], v[128:131], v[184:199]
    v_mfma_f32_32x32x16_bf16 v[200:215], v[180:183], v[132:135], v[200:215]
    s_nop 4
    v_mov_b32 v180, 0
    v_mov_b32 v181, 0
    v_mov_b32 v182, 0
    v_mov_b32 v183, 0
    s_mov_b32 exec_lo, 16
    s_mov_b32 exec_hi, 32
    buffer_load_dwordx2 v[224:225], v226, s[76:79], s87 offen offset:384
    s_waitcnt vmcnt(0)
    v_cvt_pk_bf16_f32 v180, v224, v225
    s_mov_b32 exec_lo, 16
    s_mov_b32 exec_hi, 32
    buffer_load_dwordx2 v[224:225], v226, s[76:79], s87 offen offset:392
    s_waitcnt vmcnt(0)
    v_cvt_pk_bf16_f32 v181, v224, v225
    s_mov_b32 exec_lo, 32
    s_mov_b32 exec_hi, 32
    buffer_load_dwordx2 v[224:225], v226, s[76:79], s87 offen offset:400
    s_waitcnt vmcnt(0)
    v_cvt_pk_bf16_f32 v182, v224, v225
    s_mov_b32 exec_lo, 32
    s_mov_b32 exec_hi, 32
    buffer_load_dwordx2 v[224:225], v226, s[76:79], s87 offen offset:408
    s_waitcnt vmcnt(0)
    v_cvt_pk_bf16_f32 v183, v224, v225
    s_mov_b64 exec, -1
    s_nop 1
    v_mfma_f32_32x32x16_bf16 v[184:199], v[180:183], v[136:139], v[184:199]
    v_mfma_f32_32x32x16_bf16 v[200:215], v[180:183], v[140:143], v[200:215]
    s_nop 4
    v_mov_b32 v180, 0
    v_mov_b32 v181, 0
    v_mov_b32 v182, 0
    v_mov_b32 v183, 0
    s_mov_b32 exec_lo, 32
    s_mov_b32 exec_hi, 64
    buffer_load_dwordx2 v[224:225], v226, s[76:79], s87 offen offset:448
    s_waitcnt vmcnt(0)
    v_cvt_pk_bf16_f32 v180, v224, v225
    s_mov_b32 exec_lo, 32
    s_mov_b32 exec_hi, 64
    buffer_load_dwordx2 v[224:225], v226, s[76:79], s87 offen offset:456
    s_waitcnt vmcnt(0)
    v_cvt_pk_bf16_f32 v181, v224, v225
    s_mov_b32 exec_lo, 32
    s_mov_b32 exec_hi, 64
    buffer_load_dwordx2 v[224:225], v226, s[76:79], s87 offen offset:464
    s_waitcnt vmcnt(0)
    v_cvt_pk_bf16_f32 v182, v224, v225
    s_mov_b32 exec_lo, 32
    s_mov_b32 exec_hi, 64
    buffer_load_dwordx2 v[224:225], v226, s[76:79], s87 offen offset:472
    s_waitcnt vmcnt(0)
    v_cvt_pk_bf16_f32 v183, v224, v225
    s_mov_b64 exec, -1
    s_nop 1
    v_mfma_f32_32x32x16_bf16 v[184:199], v[180:183], v[144:147], v[184:199]
    v_mfma_f32_32x32x16_bf16 v[200:215], v[180:183], v[148:151], v[200:215]
    s_nop 4
    v_mov_b32 v180, 0
    v_mov_b32 v181, 0
    v_mov_b32 v182, 0
    v_mov_b32 v183, 0
    s_mov_b32 exec_lo, 64
    s_mov_b32 exec_hi, 64
    buffer_load_dwordx2 v[224:225], v226, s[76:79], s87 offen offset:512
    s_waitcnt vmcnt(0)
    v_cvt_pk_bf16_f32 v180, v224, v225
    s_mov_b32 exec_lo, 64
    s_mov_b32 exec_hi, 64
    buffer_load_dwordx2 v[224:225], v226, s[76:79], s87 offen offset:520
    s_waitcnt vmcnt(0)
    v_cvt_pk_bf16_f32 v181, v224, v225
    s_mov_b32 exec_lo, 64
    s_mov_b32 exec_hi, 128
    buffer_load_dwordx2 v[224:225], v226, s[76:79], s87 offen offset:528
    s_waitcnt vmcnt(0)
    v_cvt_pk_bf16_f32 v182, v224, v225
    s_mov_b32 exec_lo, 64
    s_mov_b32 exec_hi, 128
    buffer_load_dwordx2 v[224:225], v226, s[76:79], s87 offen offset:536
    s_waitcnt vmcnt(0)
    v_cvt_pk_bf16_f32 v183, v224, v225
    s_mov_b64 exec, -1
    s_nop 1
    v_mfma_f32_32x32x16_bf16 v[184:199], v[180:183], v[152:155], v[184:199]
    v_mfma_f32_32x32x16_bf16 v[200:215], v[180:183], v[156:159], v[200:215]
    s_nop 4
    v_mov_b32 v180, 0
    v_mov_b32 v181, 0
    v_mov_b32 v182, 0
    v_mov_b32 v183, 0
    s_mov_b32 exec_lo, 128
    s_mov_b32 exec_hi, 128
    buffer_load_dwordx2 v[224:225], v226, s[76:79], s87 offen offset:576
    s_waitcnt vmcnt(0)
    v_cvt_pk_bf16_f32 v180, v224, v225
    s_mov_b32 exec_lo, 128
    s_mov_b32 exec_hi, 128
    buffer_load_dwordx2 v[224:225], v226, s[76:79], s87 offen offset:584
    s_waitcnt vmcnt(0)
    v_cvt_pk_bf16_f32 v181, v224, v225
    s_mov_b32 exec_lo, 128
    s_mov_b32 exec_hi, 128
    buffer_load_dwordx2 v[224:225], v226, s[76:79], s87 offen offset:592
    s_waitcnt vmcnt(0)
    v_cvt_pk_bf16_f32 v182, v224, v225
    s_mov_b32 exec_lo, 128
    s_mov_b32 exec_hi, 128
    buffer_load_dwordx2 v[224:225], v226, s[76:79], s87 offen offset:600
    s_waitcnt vmcnt(0)
    v_cvt_pk_bf16_f32 v183, v224, v225
    s_mov_b64 exec, -1
    s_nop 1
    v_mfma_f32_32x32x16_bf16 v[184:199], v[180:183], v[160:163], v[184:199]
    v_mfma_f32_32x32x16_bf16 v[200:215], v[180:183], v[164:167], v[200:215]
    s_nop 4
    s_nop 7
    s_nop 7
    v_mov_b32 v227, v184
    v_mov_b32 v231, v184
    s_nop 1
    v_permlane32_swap_b32 v227, v231
    v_mov_b32 v228, v185
    v_mov_b32 v232, v185
    s_nop 1
    v_permlane32_swap_b32 v228, v232
    v_mov_b32 v229, v186
    v_mov_b32 v233, v186
    s_nop 1
    v_permlane32_swap_b32 v229, v233
    v_mov_b32 v230, v187
    v_mov_b32 v234, v187
    s_nop 1
    v_permlane32_swap_b32 v230, v234
    s_nop 1
    v_cvt_pk_bf16_f32 v77, v227, v227
    v_lshlrev_b32 v227, 16, v77
    v_add_f32 v227, 0x358637bd, v227
    v_cvt_pk_bf16_f32 v77, v227, v227
    v_lshlrev_b32 v227, 16, v77
    v_rcp_f32 v227, v227
    v_cvt_pk_bf16_f32 v77, v228, v228
    v_lshlrev_b32 v228, 16, v77
    v_add_f32 v228, 0x358637bd, v228
    v_cvt_pk_bf16_f32 v77, v228, v228
    v_lshlrev_b32 v228, 16, v77
    v_rcp_f32 v228, v228
    v_cvt_pk_bf16_f32 v77, v229, v229
    v_lshlrev_b32 v229, 16, v77
    v_add_f32 v229, 0x358637bd, v229
    v_cvt_pk_bf16_f32 v77, v229, v229
    v_lshlrev_b32 v229, 16, v77
    v_rcp_f32 v229, v229
    v_cvt_pk_bf16_f32 v77, v230, v230
    v_lshlrev_b32 v230, 16, v77
    v_add_f32 v230, 0x358637bd, v230
    v_cvt_pk_bf16_f32 v77, v230, v230
    v_lshlrev_b32 v230, 16, v77
    v_rcp_f32 v230, v230
    v_cvt_pk_bf16_f32 v77, v231, v231
    v_lshlrev_b32 v231, 16, v77
    v_add_f32 v231, 0x358637bd, v231
    v_cvt_pk_bf16_f32 v77, v231, v231
    v_lshlrev_b32 v231, 16, v77
    v_rcp_f32 v231, v231
    v_cvt_pk_bf16_f32 v77, v232, v232
    v_lshlrev_b32 v232, 16, v77
    v_add_f32 v232, 0x358637bd, v232
    v_cvt_pk_bf16_f32 v77, v232, v232
    v_lshlrev_b32 v232, 16, v77
    v_rcp_f32 v232, v232
    v_cvt_pk_bf16_f32 v77, v233, v233
    v_lshlrev_b32 v233, 16, v77
    v_add_f32 v233, 0x358637bd, v233
    v_cvt_pk_bf16_f32 v77, v233, v233
    v_lshlrev_b32 v233, 16, v77
    v_rcp_f32 v233, v233
    v_cvt_pk_bf16_f32 v77, v234, v234
    v_lshlrev_b32 v234, 16, v77
    v_add_f32 v234, 0x358637bd, v234
    v_cvt_pk_bf16_f32 v77, v234, v234
    v_lshlrev_b32 v234, 16, v77
    v_rcp_f32 v234, v234
    v_mov_b32 v216, v200
    v_mov_b32 v220, v200
    s_nop 1
    v_permlane32_swap_b32 v216, v220
    v_mov_b32 v217, v201
    v_mov_b32 v221, v201
    s_nop 1
    v_permlane32_swap_b32 v217, v221
    v_mov_b32 v218, v202
    v_mov_b32 v222, v202
    s_nop 1
    v_permlane32_swap_b32 v218, v222
    v_mov_b32 v219, v203
    v_mov_b32 v223, v203
    s_nop 1
    v_permlane32_swap_b32 v219, v223
    s_nop 1
    v_cvt_pk_bf16_f32 v77, v216, v216
    v_lshlrev_b32 v216, 16, v77
    v_add_f32 v216, 0x358637bd, v216
    v_cvt_pk_bf16_f32 v77, v216, v216
    v_lshlrev_b32 v216, 16, v77
    v_rcp_f32 v216, v216
    v_cvt_pk_bf16_f32 v77, v217, v217
    v_lshlrev_b32 v217, 16, v77
    v_add_f32 v217, 0x358637bd, v217
    v_cvt_pk_bf16_f32 v77, v217, v217
    v_lshlrev_b32 v217, 16, v77
    v_rcp_f32 v217, v217
    v_cvt_pk_bf16_f32 v77, v218, v218
    v_lshlrev_b32 v218, 16, v77
    v_add_f32 v218, 0x358637bd, v218
    v_cvt_pk_bf16_f32 v77, v218, v218
    v_lshlrev_b32 v218, 16, v77
    v_rcp_f32 v218, v218
    v_cvt_pk_bf16_f32 v77, v219, v219
    v_lshlrev_b32 v219, 16, v77
    v_add_f32 v219, 0x358637bd, v219
    v_cvt_pk_bf16_f32 v77, v219, v219
    v_lshlrev_b32 v219, 16, v77
    v_rcp_f32 v219, v219
    v_cvt_pk_bf16_f32 v77, v220, v220
    v_lshlrev_b32 v220, 16, v77
    v_add_f32 v220, 0x358637bd, v220
    v_cvt_pk_bf16_f32 v77, v220, v220
    v_lshlrev_b32 v220, 16, v77
    v_rcp_f32 v220, v220
    v_cvt_pk_bf16_f32 v77, v221, v221
    v_lshlrev_b32 v221, 16, v77
    v_add_f32 v221, 0x358637bd, v221
    v_cvt_pk_bf16_f32 v77, v221, v221
    v_lshlrev_b32 v221, 16, v77
    v_rcp_f32 v221, v221
    v_cvt_pk_bf16_f32 v77, v222, v222
    v_lshlrev_b32 v222, 16, v77
    v_add_f32 v222, 0x358637bd, v222
    v_cvt_pk_bf16_f32 v77, v222, v222
    v_lshlrev_b32 v222, 16, v77
    v_rcp_f32 v222, v222
    v_cvt_pk_bf16_f32 v77, v223, v223
    v_lshlrev_b32 v223, 16, v77
    v_add_f32 v223, 0x358637bd, v223
    v_cvt_pk_bf16_f32 v77, v223, v223
    v_lshlrev_b32 v223, 16, v77
    v_rcp_f32 v223, v223
    s_mov_b32 s88, 0
    s_mov_b32 s89, -1
    v_and_b32 v235, 31, v76
    v_mul_u32_u24 v235, 1280, v235
    v_lshrrev_b32 v78, 5, v76
    v_lshl_add_u32 v235, v78, 3, v235
    v_and_b32 v238, 15, v76
    v_mov_b32 v184, 0
    v_mov_b32 v185, 0
    v_mov_b32 v186, 0
    v_mov_b32 v187, 0
    v_mov_b32 v188, 0
    v_mov_b32 v189, 0
    v_mov_b32 v190, 0
    v_mov_b32 v191, 0
    v_mov_b32 v192, 0
    v_mov_b32 v193, 0
    v_mov_b32 v194, 0
    v_mov_b32 v195, 0
    v_mov_b32 v196, 0
    v_mov_b32 v197, 0
    v_mov_b32 v198, 0
    v_mov_b32 v199, 0
    v_mov_b32 v200, 0
    v_mov_b32 v201, 0
    v_mov_b32 v202, 0
    v_mov_b32 v203, 0
    v_mov_b32 v204, 0
    v_mov_b32 v205, 0
    v_mov_b32 v206, 0
    v_mov_b32 v207, 0
    v_mov_b32 v208, 0
    v_mov_b32 v209, 0
    v_mov_b32 v210, 0
    v_mov_b32 v211, 0
    v_mov_b32 v212, 0
    v_mov_b32 v213, 0
    v_mov_b32 v214, 0
    v_mov_b32 v215, 0
    s_add_u32 s65, s86, 0
    buffer_load_dwordx4 v[172:175], v169, s[76:79], s65 offen offset:0
    buffer_load_dwordx4 v[176:179], v169, s[76:79], s65 offen offset:16
    s_waitcnt vmcnt(0)
    v_cvt_pk_bf16_f32 v180, v172, v173
    v_cvt_pk_bf16_f32 v181, v174, v175
    v_cvt_pk_bf16_f32 v182, v176, v177
    v_cvt_pk_bf16_f32 v183, v178, v179
    s_nop 1
    v_mfma_f32_32x32x16_bf16 v[184:199], v[180:183], v[88:91], v[184:199]
    v_mfma_f32_32x32x16_bf16 v[200:215], v[180:183], v[92:95], v[200:215]
    s_nop 4
    s_add_u32 s65, s86, 0
    buffer_load_dwordx4 v[172:175], v169, s[76:79], s65 offen offset:64
    buffer_load_dwordx4 v[176:179], v169, s[76:79], s65 offen offset:80
    s_waitcnt vmcnt(0)
    v_cvt_pk_bf16_f32 v180, v172, v173
    v_cvt_pk_bf16_f32 v181, v174, v175
    v_cvt_pk_bf16_f32 v182, v176, v177
    v_cvt_pk_bf16_f32 v183, v178, v179
    s_nop 1
    v_mfma_f32_32x32x16_bf16 v[184:199], v[180:183], v[96:99], v[184:199]
    v_mfma_f32_32x32x16_bf16 v[200:215], v[180:183], v[100:103], v[200:215]
    s_nop 4
    s_add_u32 s65, s86, 0
    buffer_load_dwordx4 v[172:175], v169, s[76:79], s65 offen offset:128
    buffer_load_dwordx4 v[176:179], v169, s[76:79], s65 offen offset:144
    s_waitcnt vmcnt(0)
    v_cvt_pk_bf16_f32 v180, v172, v173
    v_cvt_pk_bf16_f32 v181, v174, v175
    v_cvt_pk_bf16_f32 v182, v176, v177
    v_cvt_pk_bf16_f32 v183, v178, v179
    s_nop 1
    v_mfma_f32_32x32x16_bf16 v[184:199], v[180:183], v[104:107], v[184:199]
    v_mfma_f32_32x32x16_bf16 v[200:215], v[180:183], v[108:111], v[200:215]
    s_nop 4
    s_nop 7
    s_nop 7
    v_cvt_pk_bf16_f32 v236, v184, v185
    v_lshlrev_b32 v184, 16, v236
    v_and_b32 v185, 0xffff0000, v236
    v_cvt_pk_bf16_f32 v237, v186, v187
    v_lshlrev_b32 v186, 16, v237
    v_and_b32 v187, 0xffff0000, v237
    v_mul_f32 v184, v184, v227
    v_mul_f32 v185, v185, v227
    v_mul_f32 v186, v186, v227
    v_mul_f32 v187, v187, v227
    v_cvt_pk_bf16_f32 v236, v184, v185
    v_cvt_pk_bf16_f32 v237, v186, v187
    s_mul_i32 s65, s60, 20
    s_add_u32 s65, s65, 0
    v_xor_b32 v77, s65, v238
    v_lshl_add_u32 v77, v77, 4, v235
    ds_write_b64 v77, v[236:237] offset:0
    s_nop 1
    v_cvt_pk_bf16_f32 v236, v188, v189
    v_lshlrev_b32 v188, 16, v236
    v_and_b32 v189, 0xffff0000, v236
    v_cvt_pk_bf16_f32 v237, v190, v191
    v_lshlrev_b32 v190, 16, v237
    v_and_b32 v191, 0xffff0000, v237
    v_mul_f32 v188, v188, v227
    v_mul_f32 v189, v189, v227
    v_mul_f32 v190, v190, v227
    v_mul_f32 v191, v191, v227
    v_cvt_pk_bf16_f32 v236, v188, v189
    v_cvt_pk_bf16_f32 v237, v190, v191
    s_mul_i32 s65, s60, 20
    s_add_u32 s65, s65, 1
    v_xor_b32 v77, s65, v238
    v_lshl_add_u32 v77, v77, 4, v235
    ds_write_b64 v77, v[236:237] offset:0
    s_nop 1
    v_cvt_pk_bf16_f32 v236, v192, v193
    v_lshlrev_b32 v192, 16, v236
    v_and_b32 v193, 0xffff0000, v236
    v_cvt_pk_bf16_f32 v237, v194, v195
    v_lshlrev_b32 v194, 16, v237
    v_and_b32 v195, 0xffff0000, v237
    v_cndmask_b32 v77, v227, v228, s[88:89]
    v_mul_f32 v192, v192, v77
    v_cndmask_b32 v77, v227, v228, s[88:89]
    v_mul_f32 v193, v193, v77
    v_cndmask_b32 v77, v227, v228, s[88:89]
    v_mul_f32 v194, v194, v77
    v_cndmask_b32 v77, v227, v228, s[88:89]
    v_mul_f32 v195, v195, v77
    v_cvt_pk_bf16_f32 v236, v192, v193
    v_cvt_pk_bf16_f32 v237, v194, v195
    s_mul_i32 s65, s60, 20
    s_add_u32 s65, s65, 2
    v_xor_b32 v77, s65, v238
    v_lshl_add_u32 v77, v77, 4, v235
    ds_write_b64 v77, v[236:237] offset:0
    s_nop 1
    v_cvt_pk_bf16_f32 v236, v196, v197
    v_lshlrev_b32 v196, 16, v236
    v_and_b32 v197, 0xffff0000, v236
    v_cvt_pk_bf16_f32 v237, v198, v199
    v_lshlrev_b32 v198, 16, v237
    v_and_b32 v199, 0xffff0000, v237
    v_mul_f32 v196, v196, v228
    v_mul_f32 v197, v197, v228
    v_mul_f32 v198, v198, v228
    v_mul_f32 v199, v199, v228
    v_cvt_pk_bf16_f32 v236, v196, v197
    v_cvt_pk_bf16_f32 v237, v198, v199
    s_mul_i32 s65, s60, 20
    s_add_u32 s65, s65, 3
    v_xor_b32 v77, s65, v238
    v_lshl_add_u32 v77, v77, 4, v235
    ds_write_b64 v77, v[236:237] offset:0
    s_nop 1
    v_cvt_pk_bf16_f32 v236, v200, v201
    v_lshlrev_b32 v200, 16, v236
    v_and_b32 v201, 0xffff0000, v236
    v_cvt_pk_bf16_f32 v237, v202, v203
    v_lshlrev_b32 v202, 16, v237
    v_and_b32 v203, 0xffff0000, v237
    v_mul_f32 v200, v200, v216
    v_mul_f32 v201, v201, v216
    v_mul_f32 v202, v202, v216
    v_mul_f32 v203, v203, v216
    v_cvt_pk_bf16_f32 v236, v200, v201
    v_cvt_pk_bf16_f32 v237, v202, v203
    s_mul_i32 s65, s60, 20
    s_add_u32 s65, s65, 0
    v_xor_b32 v77, s65, v238
    v_lshl_add_u32 v77, v77, 4, v235
    ds_write_b64 v77, v[236:237] offset:40960
    s_nop 1
    v_cvt_pk_bf16_f32 v236, v204, v205
    v_lshlrev_b32 v204, 16, v236
    v_and_b32 v205, 0xffff0000, v236
    v_cvt_pk_bf16_f32 v237, v206, v207
    v_lshlrev_b32 v206, 16, v237
    v_and_b32 v207, 0xffff0000, v237
    v_mul_f32 v204, v204, v216
    v_mul_f32 v205, v205, v216
    v_mul_f32 v206, v206, v216
    v_mul_f32 v207, v207, v216
    v_cvt_pk_bf16_f32 v236, v204, v205
    v_cvt_pk_bf16_f32 v237, v206, v207
    s_mul_i32 s65, s60, 20
    s_add_u32 s65, s65, 1
    v_xor_b32 v77, s65, v238
    v_lshl_add_u32 v77, v77, 4, v235
    ds_write_b64 v77, v[236:237] offset:40960
    s_nop 1
    v_cvt_pk_bf16_f32 v236, v208, v209
    v_lshlrev_b32 v208, 16, v236
    v_and_b32 v209, 0xffff0000, v236
    v_cvt_pk_bf16_f32 v237, v210, v211
    v_lshlrev_b32 v210, 16, v237
    v_and_b32 v211, 0xffff0000, v237
    v_cndmask_b32 v77, v216, v217, s[88:89]
    v_mul_f32 v208, v208, v77
    v_cndmask_b32 v77, v216, v217, s[88:89]
    v_mul_f32 v209, v209, v77
    v_cndmask_b32 v77, v216, v217, s[88:89]
    v_mul_f32 v210, v210, v77
    v_cndmask_b32 v77, v216, v217, s[88:89]
    v_mul_f32 v211, v211, v77
    v_cvt_pk_bf16_f32 v236, v208, v209
    v_cvt_pk_bf16_f32 v237, v210, v211
    s_mul_i32 s65, s60, 20
    s_add_u32 s65, s65, 2
    v_xor_b32 v77, s65, v238
    v_lshl_add_u32 v77, v77, 4, v235
    ds_write_b64 v77, v[236:237] offset:40960
    s_nop 1
    v_cvt_pk_bf16_f32 v236, v212, v213
    v_lshlrev_b32 v212, 16, v236
    v_and_b32 v213, 0xffff0000, v236
    v_cvt_pk_bf16_f32 v237, v214, v215
    v_lshlrev_b32 v214, 16, v237
    v_and_b32 v215, 0xffff0000, v237
    v_mul_f32 v212, v212, v217
    v_mul_f32 v213, v213, v217
    v_mul_f32 v214, v214, v217
    v_mul_f32 v215, v215, v217
    v_cvt_pk_bf16_f32 v236, v212, v213
    v_cvt_pk_bf16_f32 v237, v214, v215
    s_mul_i32 s65, s60, 20
    s_add_u32 s65, s65, 3
    v_xor_b32 v77, s65, v238
    v_lshl_add_u32 v77, v77, 4, v235
    ds_write_b64 v77, v[236:237] offset:40960
    s_nop 1
    v_mov_b32 v184, 0
    v_mov_b32 v185, 0
    v_mov_b32 v186, 0
    v_mov_b32 v187, 0
    v_mov_b32 v188, 0
    v_mov_b32 v189, 0
    v_mov_b32 v190, 0
    v_mov_b32 v191, 0
    v_mov_b32 v192, 0
    v_mov_b32 v193, 0
    v_mov_b32 v194, 0
    v_mov_b32 v195, 0
    v_mov_b32 v196, 0
    v_mov_b32 v197, 0
    v_mov_b32 v198, 0
    v_mov_b32 v199, 0
    v_mov_b32 v200, 0
    v_mov_b32 v201, 0
    v_mov_b32 v202, 0
    v_mov_b32 v203, 0
    v_mov_b32 v204, 0
    v_mov_b32 v205, 0
    v_mov_b32 v206, 0
    v_mov_b32 v207, 0
    v_mov_b32 v208, 0
    v_mov_b32 v209, 0
    v_mov_b32 v210, 0
    v_mov_b32 v211, 0
    v_mov_b32 v212, 0
    v_mov_b32 v213, 0
    v_mov_b32 v214, 0
    v_mov_b32 v215, 0
    s_add_u32 s65, s86, 8192
    buffer_load_dwordx4 v[172:175], v169, s[76:79], s65 offen offset:0
    buffer_load_dwordx4 v[176:179], v169, s[76:79], s65 offen offset:16
    s_waitcnt vmcnt(0)
    v_cvt_pk_bf16_f32 v180, v172, v173
    v_cvt_pk_bf16_f32 v181, v174, v175
    v_cvt_pk_bf16_f32 v182, v176, v177
    v_cvt_pk_bf16_f32 v183, v178, v179
    s_nop 1
    v_mfma_f32_32x32x16_bf16 v[184:199], v[180:183], v[96:99], v[184:199]
    v_mfma_f32_32x32x16_bf16 v[200:215], v[180:183], v[100:103], v[200:215]
    s_nop 4
    s_add_u32 s65, s86, 8192
    buffer_load_dwordx4 v[172:175], v169, s[76:79], s65 offen offset:64
    buffer_load_dwordx4 v[176:179], v169, s[76:79], s65 offen offset:80
    s_waitcnt vmcnt(0)
    v_cvt_pk_bf16_f32 v180, v172, v173
    v_cvt_pk_bf16_f32 v181, v174, v175
    v_cvt_pk_bf16_f32 v182, v176, v177
    v_cvt_pk_bf16_f32 v183, v178, v179
    s_nop 1
    v_mfma_f32_32x32x16_bf16 v[184:199], v[180:183], v[104:107], v[184:199]
    v_mfma_f32_32x32x16_bf16 v[200:215], v[180:183], v[108:111], v[200:215]
    s_nop 4
    s_add_u32 s65, s86, 8192
    buffer_load_dwordx4 v[172:175], v169, s[76:79], s65 offen offset:128
    buffer_load_dwordx4 v[176:179], v169, s[76:79], s65 offen offset:144
    s_waitcnt vmcnt(0)
    v_cvt_pk_bf16_f32 v180, v172, v173
    v_cvt_pk_bf16_f32 v181, v174, v175
    v_cvt_pk_bf16_f32 v182, v176, v177
    v_cvt_pk_bf16_f32 v183, v178, v179
    s_nop 1
    v_mfma_f32_32x32x16_bf16 v[184:199], v[180:183], v[112:115], v[184:199]
    v_mfma_f32_32x32x16_bf16 v[200:215], v[180:183], v[116:119], v[200:215]
    s_nop 4
    s_add_u32 s65, s86, 8192
    buffer_load_dwordx4 v[172:175], v169, s[76:79], s65 offen offset:192
    buffer_load_dwordx4 v[176:179], v169, s[76:79], s65 offen offset:208
    s_waitcnt vmcnt(0)
    v_cvt_pk_bf16_f32 v180, v172, v173
    v_cvt_pk_bf16_f32 v181, v174, v175
    v_cvt_pk_bf16_f32 v182, v176, v177
    v_cvt_pk_bf16_f32 v183, v178, v179
    s_nop 1
    v_mfma_f32_32x32x16_bf16 v[184:199], v[180:183], v[120:123], v[184:199]
    v_mfma_f32_32x32x16_bf16 v[200:215], v[180:183], v[124:127], v[200:215]
    s_nop 4
    s_nop 7
    s_nop 7
    v_cvt_pk_bf16_f32 v236, v184, v185
    v_lshlrev_b32 v184, 16, v236
    v_and_b32 v185, 0xffff0000, v236
    v_cvt_pk_bf16_f32 v237, v186, v187
    v_lshlrev_b32 v186, 16, v237
    v_and_b32 v187, 0xffff0000, v237
    v_mul_f32 v184, v184, v228
    v_mul_f32 v185, v185, v228
    v_mul_f32 v186, v186, v228
    v_mul_f32 v187, v187, v228
    v_cvt_pk_bf16_f32 v236, v184, v185
    v_cvt_pk_bf16_f32 v237, v186, v187
    s_mul_i32 s65, s60, 20
    s_add_u32 s65, s65, 4
    v_xor_b32 v77, s65, v238
    v_lshl_add_u32 v77, v77, 4, v235
    ds_write_b64 v77, v[236:237] offset:0
    s_nop 1
    v_cvt_pk_bf16_f32 v236, v188, v189
    v_lshlrev_b32 v188, 16, v236
    v_and_b32 v189, 0xffff0000, v236
    v_cvt_pk_bf16_f32 v237, v190, v191
    v_lshlrev_b32 v190, 16, v237
    v_and_b32 v191, 0xffff0000, v237
    v_mul_f32 v188, v188, v229
    v_mul_f32 v189, v189, v229
    v_mul_f32 v190, v190, v229
    v_mul_f32 v191, v191, v229
    v_cvt_pk_bf16_f32 v236, v188, v189
    v_cvt_pk_bf16_f32 v237, v190, v191
    s_mul_i32 s65, s60, 20
    s_add_u32 s65, s65, 5
    v_xor_b32 v77, s65, v238
    v_lshl_add_u32 v77, v77, 4, v235
    ds_write_b64 v77, v[236:237] offset:0
    s_nop 1
    v_cvt_pk_bf16_f32 v236, v192, v193
    v_lshlrev_b32 v192, 16, v236
    v_and_b32 v193, 0xffff0000, v236
    v_cvt_pk_bf16_f32 v237, v194, v195
    v_lshlrev_b32 v194, 16, v237
    v_and_b32 v195, 0xffff0000, v237
    v_mul_f32 v192, v192, v229
    v_mul_f32 v193, v193, v229
    v_mul_f32 v194, v194, v229
    v_mul_f32 v195, v195, v229
    v_cvt_pk_bf16_f32 v236, v192, v193
    v_cvt_pk_bf16_f32 v237, v194, v195
    s_mul_i32 s65, s60, 20
    s_add_u32 s65, s65, 6
    v_xor_b32 v77, s65, v238
    v_lshl_add_u32 v77, v77, 4, v235
    ds_write_b64 v77, v[236:237] offset:0
    s_nop 1
    v_cvt_pk_bf16_f32 v236, v196, v197
    v_lshlrev_b32 v196, 16, v236
    v_and_b32 v197, 0xffff0000, v236
    v_cvt_pk_bf16_f32 v237, v198, v199
    v_lshlrev_b32 v198, 16, v237
    v_and_b32 v199, 0xffff0000, v237
    v_cndmask_b32 v77, v229, v230, s[88:89]
    v_mul_f32 v196, v196, v77
    v_cndmask_b32 v77, v229, v230, s[88:89]
    v_mul_f32 v197, v197, v77
    v_cndmask_b32 v77, v229, v230, s[88:89]
    v_mul_f32 v198, v198, v77
    v_cndmask_b32 v77, v229, v230, s[88:89]
    v_mul_f32 v199, v199, v77
    v_cvt_pk_bf16_f32 v236, v196, v197
    v_cvt_pk_bf16_f32 v237, v198, v199
    s_mul_i32 s65, s60, 20
    s_add_u32 s65, s65, 7
    v_xor_b32 v77, s65, v238
    v_lshl_add_u32 v77, v77, 4, v235
    ds_write_b64 v77, v[236:237] offset:0
    s_nop 1
    v_cvt_pk_bf16_f32 v236, v200, v201
    v_lshlrev_b32 v200, 16, v236
    v_and_b32 v201, 0xffff0000, v236
    v_cvt_pk_bf16_f32 v237, v202, v203
    v_lshlrev_b32 v202, 16, v237
    v_and_b32 v203, 0xffff0000, v237
    v_mul_f32 v200, v200, v217
    v_mul_f32 v201, v201, v217
    v_mul_f32 v202, v202, v217
    v_mul_f32 v203, v203, v217
    v_cvt_pk_bf16_f32 v236, v200, v201
    v_cvt_pk_bf16_f32 v237, v202, v203
    s_mul_i32 s65, s60, 20
    s_add_u32 s65, s65, 4
    v_xor_b32 v77, s65, v238
    v_lshl_add_u32 v77, v77, 4, v235
    ds_write_b64 v77, v[236:237] offset:40960
    s_nop 1
    v_cvt_pk_bf16_f32 v236, v204, v205
    v_lshlrev_b32 v204, 16, v236
    v_and_b32 v205, 0xffff0000, v236
    v_cvt_pk_bf16_f32 v237, v206, v207
    v_lshlrev_b32 v206, 16, v237
    v_and_b32 v207, 0xffff0000, v237
    v_mul_f32 v204, v204, v218
    v_mul_f32 v205, v205, v218
    v_mul_f32 v206, v206, v218
    v_mul_f32 v207, v207, v218
    v_cvt_pk_bf16_f32 v236, v204, v205
    v_cvt_pk_bf16_f32 v237, v206, v207
    s_mul_i32 s65, s60, 20
    s_add_u32 s65, s65, 5
    v_xor_b32 v77, s65, v238
    v_lshl_add_u32 v77, v77, 4, v235
    ds_write_b64 v77, v[236:237] offset:40960
    s_nop 1
    v_cvt_pk_bf16_f32 v236, v208, v209
    v_lshlrev_b32 v208, 16, v236
    v_and_b32 v209, 0xffff0000, v236
    v_cvt_pk_bf16_f32 v237, v210, v211
    v_lshlrev_b32 v210, 16, v237
    v_and_b32 v211, 0xffff0000, v237
    v_mul_f32 v208, v208, v218
    v_mul_f32 v209, v209, v218
    v_mul_f32 v210, v210, v218
    v_mul_f32 v211, v211, v218
    v_cvt_pk_bf16_f32 v236, v208, v209
    v_cvt_pk_bf16_f32 v237, v210, v211
    s_mul_i32 s65, s60, 20
    s_add_u32 s65, s65, 6
    v_xor_b32 v77, s65, v238
    v_lshl_add_u32 v77, v77, 4, v235
    ds_write_b64 v77, v[236:237] offset:40960
    s_nop 1
    v_cvt_pk_bf16_f32 v236, v212, v213
    v_lshlrev_b32 v212, 16, v236
    v_and_b32 v213, 0xffff0000, v236
    v_cvt_pk_bf16_f32 v237, v214, v215
    v_lshlrev_b32 v214, 16, v237
    v_and_b32 v215, 0xffff0000, v237
    v_cndmask_b32 v77, v218, v219, s[88:89]
    v_mul_f32 v212, v212, v77
    v_cndmask_b32 v77, v218, v219, s[88:89]
    v_mul_f32 v213, v213, v77
    v_cndmask_b32 v77, v218, v219, s[88:89]
    v_mul_f32 v214, v214, v77
    v_cndmask_b32 v77, v218, v219, s[88:89]
    v_mul_f32 v215, v215, v77
    v_cvt_pk_bf16_f32 v236, v212, v213
    v_cvt_pk_bf16_f32 v237, v214, v215
    s_mul_i32 s65, s60, 20
    s_add_u32 s65, s65, 7
    v_xor_b32 v77, s65, v238
    v_lshl_add_u32 v77, v77, 4, v235
    ds_write_b64 v77, v[236:237] offset:40960
    s_nop 1
    v_mov_b32 v184, 0
    v_mov_b32 v185, 0
    v_mov_b32 v186, 0
    v_mov_b32 v187, 0
    v_mov_b32 v188, 0
    v_mov_b32 v189, 0
    v_mov_b32 v190, 0
    v_mov_b32 v191, 0
    v_mov_b32 v192, 0
    v_mov_b32 v193, 0
    v_mov_b32 v194, 0
    v_mov_b32 v195, 0
    v_mov_b32 v196, 0
    v_mov_b32 v197, 0
    v_mov_b32 v198, 0
    v_mov_b32 v199, 0
    v_mov_b32 v200, 0
    v_mov_b32 v201, 0
    v_mov_b32 v202, 0
    v_mov_b32 v203, 0
    v_mov_b32 v204, 0
    v_mov_b32 v205, 0
    v_mov_b32 v206, 0
    v_mov_b32 v207, 0
    v_mov_b32 v208, 0
    v_mov_b32 v209, 0
    v_mov_b32 v210, 0
    v_mov_b32 v211, 0
    v_mov_b32 v212, 0
    v_mov_b32 v213, 0
    v_mov_b32 v214, 0
    v_mov_b32 v215, 0
    s_add_u32 s65, s86, 16384
    buffer_load_dwordx4 v[172:175], v169, s[76:79], s65 offen offset:0
    buffer_load_dwordx4 v[176:179], v169, s[76:79], s65 offen offset:16
    s_waitcnt vmcnt(0)
    v_cvt_pk_bf16_f32 v180, v172, v173
    v_cvt_pk_bf16_f32 v181, v174, v175
    v_cvt_pk_bf16_f32 v182, v176, v177
    v_cvt_pk_bf16_f32 v183, v178, v179
    s_nop 1
    v_mfma_f32_32x32x16_bf16 v[184:199], v[180:183], v[112:115], v[184:199]
    v_mfma_f32_32x32x16_bf16 v[200:215], v[180:183], v[116:119], v[200:215]
    s_nop 4
    s_add_u32 s65, s86, 16384
    buffer_load_dwordx4 v[172:175], v169, s[76:79], s65 offen offset:64
    buffer_load_dwordx4 v[176:179], v169, s[76:79], s65 offen offset:80
    s_waitcnt vmcnt(0)
    v_cvt_pk_bf16_f32 v180, v172, v173
    v_cvt_pk_bf16_f32 v181, v174, v175
    v_cvt_pk_bf16_f32 v182, v176, v177
    v_cvt_pk_bf16_f32 v183, v178, v179
    s_nop 1
    v_mfma_f32_32x32x16_bf16 v[184:199], v[180:183], v[120:123], v[184:199]
    v_mfma_f32_32x32x16_bf16 v[200:215], v[180:183], v[124:127], v[200:215]
    s_nop 4
    s_add_u32 s65, s86, 16384
    buffer_load_dwordx4 v[172:175], v169, s[76:79], s65 offen offset:128
    buffer_load_dwordx4 v[176:179], v169, s[76:79], s65 offen offset:144
    s_waitcnt vmcnt(0)
    v_cvt_pk_bf16_f32 v180, v172, v173
    v_cvt_pk_bf16_f32 v181, v174, v175
    v_cvt_pk_bf16_f32 v182, v176, v177
    v_cvt_pk_bf16_f32 v183, v178, v179
    s_nop 1
    v_mfma_f32_32x32x16_bf16 v[184:199], v[180:183], v[128:131], v[184:199]
    v_mfma_f32_32x32x16_bf16 v[200:215], v[180:183], v[132:135], v[200:215]
    s_nop 4
    s_add_u32 s65, s86, 16384
    buffer_load_dwordx4 v[172:175], v169, s[76:79], s65 offen offset:192
    buffer_load_dwordx4 v[176:179], v169, s[76:79], s65 offen offset:208
    s_waitcnt vmcnt(0)
    v_cvt_pk_bf16_f32 v180, v172, v173
    v_cvt_pk_bf16_f32 v181, v174, v175
    v_cvt_pk_bf16_f32 v182, v176, v177
    v_cvt_pk_bf16_f32 v183, v178, v179
    s_nop 1
    v_mfma_f32_32x32x16_bf16 v[184:199], v[180:183], v[136:139], v[184:199]
    v_mfma_f32_32x32x16_bf16 v[200:215], v[180:183], v[140:143], v[200:215]
    s_nop 4
    s_nop 7
    s_nop 7
    v_cvt_pk_bf16_f32 v236, v184, v185
    v_lshlrev_b32 v184, 16, v236
    v_and_b32 v185, 0xffff0000, v236
    v_cvt_pk_bf16_f32 v237, v186, v187
    v_lshlrev_b32 v186, 16, v237
    v_and_b32 v187, 0xffff0000, v237
    v_mul_f32 v184, v184, v230
    v_mul_f32 v185, v185, v230
    v_mul_f32 v186, v186, v230
    v_mul_f32 v187, v187, v230
    v_cvt_pk_bf16_f32 v236, v184, v185
    v_cvt_pk_bf16_f32 v237, v186, v187
    s_mul_i32 s65, s60, 20
    s_add_u32 s65, s65, 8
    v_xor_b32 v77, s65, v238
    v_lshl_add_u32 v77, v77, 4, v235
    ds_write_b64 v77, v[236:237] offset:0
    s_nop 1
    v_cvt_pk_bf16_f32 v236, v188, v189
    v_lshlrev_b32 v188, 16, v236
    v_and_b32 v189, 0xffff0000, v236
    v_cvt_pk_bf16_f32 v237, v190, v191
    v_lshlrev_b32 v190, 16, v237
    v_and_b32 v191, 0xffff0000, v237
    v_mul_f32 v188, v188, v230
    v_mul_f32 v189, v189, v230
    v_mul_f32 v190, v190, v230
    v_mul_f32 v191, v191, v230
    v_cvt_pk_bf16_f32 v236, v188, v189
    v_cvt_pk_bf16_f32 v237, v190, v191
    s_mul_i32 s65, s60, 20
    s_add_u32 s65, s65, 9
    v_xor_b32 v77, s65, v238
    v_lshl_add_u32 v77, v77, 4, v235
    ds_write_b64 v77, v[236:237] offset:0
    s_nop 1
    v_cvt_pk_bf16_f32 v236, v192, v193
    v_lshlrev_b32 v192, 16, v236
    v_and_b32 v193, 0xffff0000, v236
    v_cvt_pk_bf16_f32 v237, v194, v195
    v_lshlrev_b32 v194, 16, v237
    v_and_b32 v195, 0xffff0000, v237
    v_mul_f32 v192, v192, v231
    v_mul_f32 v193, v193, v231
    v_mul_f32 v194, v194, v231
    v_mul_f32 v195, v195, v231
    v_cvt_pk_bf16_f32 v236, v192, v193
    v_cvt_pk_bf16_f32 v237, v194, v195
    s_mul_i32 s65, s60, 20
    s_add_u32 s65, s65, 10
    v_xor_b32 v77, s65, v238
    v_lshl_add_u32 v77, v77, 4, v235
    ds_write_b64 v77, v[236:237] offset:0
    s_nop 1
    v_cvt_pk_bf16_f32 v236, v196, v197
    v_lshlrev_b32 v196, 16, v236
    v_and_b32 v197, 0xffff0000, v236
    v_cvt_pk_bf16_f32 v237, v198, v199
    v_lshlrev_b32 v198, 16, v237
    v_and_b32 v199, 0xffff0000, v237
    v_mul_f32 v196, v196, v231
    v_mul_f32 v197, v197, v231
    v_mul_f32 v198, v198, v231
    v_mul_f32 v199, v199, v231
    v_cvt_pk_bf16_f32 v236, v196, v197
    v_cvt_pk_bf16_f32 v237, v198, v199
    s_mul_i32 s65, s60, 20
    s_add_u32 s65, s65, 11
    v_xor_b32 v77, s65, v238
    v_lshl_add_u32 v77, v77, 4, v235
    ds_write_b64 v77, v[236:237] offset:0
    s_nop 1
    v_cvt_pk_bf16_f32 v236, v200, v201
    v_lshlrev_b32 v200, 16, v236
    v_and_b32 v201, 0xffff0000, v236
    v_cvt_pk_bf16_f32 v237, v202, v203
    v_lshlrev_b32 v202, 16, v237
    v_and_b32 v203, 0xffff0000, v237
    v_mul_f32 v200, v200, v219
    v_mul_f32 v201, v201, v219
    v_mul_f32 v202, v202, v219
    v_mul_f32 v203, v203, v219
    v_cvt_pk_bf16_f32 v236, v200, v201
    v_cvt_pk_bf16_f32 v237, v202, v203
    s_mul_i32 s65, s60, 20
    s_add_u32 s65, s65, 8
    v_xor_b32 v77, s65, v238
    v_lshl_add_u32 v77, v77, 4, v235
    ds_write_b64 v77, v[236:237] offset:40960
    s_nop 1
    v_cvt_pk_bf16_f32 v236, v204, v205
    v_lshlrev_b32 v204, 16, v236
    v_and_b32 v205, 0xffff0000, v236
    v_cvt_pk_bf16_f32 v237, v206, v207
    v_lshlrev_b32 v206, 16, v237
    v_and_b32 v207, 0xffff0000, v237
    v_mul_f32 v204, v204, v219
    v_mul_f32 v205, v205, v219
    v_mul_f32 v206, v206, v219
    v_mul_f32 v207, v207, v219
    v_cvt_pk_bf16_f32 v236, v204, v205
    v_cvt_pk_bf16_f32 v237, v206, v207
    s_mul_i32 s65, s60, 20
    s_add_u32 s65, s65, 9
    v_xor_b32 v77, s65, v238
    v_lshl_add_u32 v77, v77, 4, v235
    ds_write_b64 v77, v[236:237] offset:40960
    s_nop 1
    v_cvt_pk_bf16_f32 v236, v208, v209
    v_lshlrev_b32 v208, 16, v236
    v_and_b32 v209, 0xffff0000, v236
    v_cvt_pk_bf16_f32 v237, v210, v211
    v_lshlrev_b32 v210, 16, v237
    v_and_b32 v211, 0xffff0000, v237
    v_mul_f32 v208, v208, v220
    v_mul_f32 v209, v209, v220
    v_mul_f32 v210, v210, v220
    v_mul_f32 v211, v211, v220
    v_cvt_pk_bf16_f32 v236, v208, v209
    v_cvt_pk_bf16_f32 v237, v210, v211
    s_mul_i32 s65, s60, 20
    s_add_u32 s65, s65, 10
    v_xor_b32 v77, s65, v238
    v_lshl_add_u32 v77, v77, 4, v235
    ds_write_b64 v77, v[236:237] offset:40960
    s_nop 1
    v_cvt_pk_bf16_f32 v236, v212, v213
    v_lshlrev_b32 v212, 16, v236
    v_and_b32 v213, 0xffff0000, v236
    v_cvt_pk_bf16_f32 v237, v214, v215
    v_lshlrev_b32 v214, 16, v237
    v_and_b32 v215, 0xffff0000, v237
    v_mul_f32 v212, v212, v220
    v_mul_f32 v213, v213, v220
    v_mul_f32 v214, v214, v220
    v_mul_f32 v215, v215, v220
    v_cvt_pk_bf16_f32 v236, v212, v213
    v_cvt_pk_bf16_f32 v237, v214, v215
    s_mul_i32 s65, s60, 20
    s_add_u32 s65, s65, 11
    v_xor_b32 v77, s65, v238
    v_lshl_add_u32 v77, v77, 4, v235
    ds_write_b64 v77, v[236:237] offset:40960
    s_nop 1
    v_mov_b32 v184, 0
    v_mov_b32 v185, 0
    v_mov_b32 v186, 0
    v_mov_b32 v187, 0
    v_mov_b32 v188, 0
    v_mov_b32 v189, 0
    v_mov_b32 v190, 0
    v_mov_b32 v191, 0
    v_mov_b32 v192, 0
    v_mov_b32 v193, 0
    v_mov_b32 v194, 0
    v_mov_b32 v195, 0
    v_mov_b32 v196, 0
    v_mov_b32 v197, 0
    v_mov_b32 v198, 0
    v_mov_b32 v199, 0
    v_mov_b32 v200, 0
    v_mov_b32 v201, 0
    v_mov_b32 v202, 0
    v_mov_b32 v203, 0
    v_mov_b32 v204, 0
    v_mov_b32 v205, 0
    v_mov_b32 v206, 0
    v_mov_b32 v207, 0
    v_mov_b32 v208, 0
    v_mov_b32 v209, 0
    v_mov_b32 v210, 0
    v_mov_b32 v211, 0
    v_mov_b32 v212, 0
    v_mov_b32 v213, 0
    v_mov_b32 v214, 0
    v_mov_b32 v215, 0
    s_add_u32 s65, s86, 24576
    buffer_load_dwordx4 v[172:175], v169, s[76:79], s65 offen offset:0
    buffer_load_dwordx4 v[176:179], v169, s[76:79], s65 offen offset:16
    s_waitcnt vmcnt(0)
    v_cvt_pk_bf16_f32 v180, v172, v173
    v_cvt_pk_bf16_f32 v181, v174, v175
    v_cvt_pk_bf16_f32 v182, v176, v177
    v_cvt_pk_bf16_f32 v183, v178, v179
    s_nop 1
    v_mfma_f32_32x32x16_bf16 v[184:199], v[180:183], v[128:131], v[184:199]
    v_mfma_f32_32x32x16_bf16 v[200:215], v[180:183], v[132:135], v[200:215]
    s_nop 4
    s_add_u32 s65, s86, 24576
    buffer_load_dwordx4 v[172:175], v169, s[76:79], s65 offen offset:64
    buffer_load_dwordx4 v[176:179], v169, s[76:79], s65 offen offset:80
    s_waitcnt vmcnt(0)
    v_cvt_pk_bf16_f32 v180, v172, v173
    v_cvt_pk_bf16_f32 v181, v174, v175
    v_cvt_pk_bf16_f32 v182, v176, v177
    v_cvt_pk_bf16_f32 v183, v178, v179
    s_nop 1
    v_mfma_f32_32x32x16_bf16 v[184:199], v[180:183], v[136:139], v[184:199]
    v_mfma_f32_32x32x16_bf16 v[200:215], v[180:183], v[140:143], v[200:215]
    s_nop 4
    s_add_u32 s65, s86, 24576
    buffer_load_dwordx4 v[172:175], v169, s[76:79], s65 offen offset:128
    buffer_load_dwordx4 v[176:179], v169, s[76:79], s65 offen offset:144
    s_waitcnt vmcnt(0)
    v_cvt_pk_bf16_f32 v180, v172, v173
    v_cvt_pk_bf16_f32 v181, v174, v175
    v_cvt_pk_bf16_f32 v182, v176, v177
    v_cvt_pk_bf16_f32 v183, v178, v179
    s_nop 1
    v_mfma_f32_32x32x16_bf16 v[184:199], v[180:183], v[144:147], v[184:199]
    v_mfma_f32_32x32x16_bf16 v[200:215], v[180:183], v[148:151], v[200:215]
    s_nop 4
    s_add_u32 s65, s86, 24576
    buffer_load_dwordx4 v[172:175], v169, s[76:79], s65 offen offset:192
    buffer_load_dwordx4 v[176:179], v169, s[76:79], s65 offen offset:208
    s_waitcnt vmcnt(0)
    v_cvt_pk_bf16_f32 v180, v172, v173
    v_cvt_pk_bf16_f32 v181, v174, v175
    v_cvt_pk_bf16_f32 v182, v176, v177
    v_cvt_pk_bf16_f32 v183, v178, v179
    s_nop 1
    v_mfma_f32_32x32x16_bf16 v[184:199], v[180:183], v[152:155], v[184:199]
    v_mfma_f32_32x32x16_bf16 v[200:215], v[180:183], v[156:159], v[200:215]
    s_nop 4
    s_nop 7
    s_nop 7
    v_cvt_pk_bf16_f32 v236, v184, v185
    v_lshlrev_b32 v184, 16, v236
    v_and_b32 v185, 0xffff0000, v236
    v_cvt_pk_bf16_f32 v237, v186, v187
    v_lshlrev_b32 v186, 16, v237
    v_and_b32 v187, 0xffff0000, v237
    v_cndmask_b32 v77, v231, v232, s[88:89]
    v_mul_f32 v184, v184, v77
    v_cndmask_b32 v77, v231, v232, s[88:89]
    v_mul_f32 v185, v185, v77
    v_cndmask_b32 v77, v231, v232, s[88:89]
    v_mul_f32 v186, v186, v77
    v_cndmask_b32 v77, v231, v232, s[88:89]
    v_mul_f32 v187, v187, v77
    v_cvt_pk_bf16_f32 v236, v184, v185
    v_cvt_pk_bf16_f32 v237, v186, v187
    s_mul_i32 s65, s60, 20
    s_add_u32 s65, s65, 12
    v_xor_b32 v77, s65, v238
    v_lshl_add_u32 v77, v77, 4, v235
    ds_write_b64 v77, v[236:237] offset:0
    s_nop 1
    v_cvt_pk_bf16_f32 v236, v188, v189
    v_lshlrev_b32 v188, 16, v236
    v_and_b32 v189, 0xffff0000, v236
    v_cvt_pk_bf16_f32 v237, v190, v191
    v_lshlrev_b32 v190, 16, v237
    v_and_b32 v191, 0xffff0000, v237
    v_mul_f32 v188, v188, v232
    v_mul_f32 v189, v189, v232
    v_mul_f32 v190, v190, v232
    v_mul_f32 v191, v191, v232
    v_cvt_pk_bf16_f32 v236, v188, v189
    v_cvt_pk_bf16_f32 v237, v190, v191
    s_mul_i32 s65, s60, 20
    s_add_u32 s65, s65, 13
    v_xor_b32 v77, s65, v238
    v_lshl_add_u32 v77, v77, 4, v235
    ds_write_b64 v77, v[236:237] offset:0
    s_nop 1
    v_cvt_pk_bf16_f32 v236, v192, v193
    v_lshlrev_b32 v192, 16, v236
    v_and_b32 v193, 0xffff0000, v236
    v_cvt_pk_bf16_f32 v237, v194, v195
    v_lshlrev_b32 v194, 16, v237
    v_and_b32 v195, 0xffff0000, v237
    v_mul_f32 v192, v192, v232
    v_mul_f32 v193, v193, v232
    v_mul_f32 v194, v194, v232
    v_mul_f32 v195, v195, v232
    v_cvt_pk_bf16_f32 v236, v192, v193
    v_cvt_pk_bf16_f32 v237, v194, v195
    s_mul_i32 s65, s60, 20
    s_add_u32 s65, s65, 14
    v_xor_b32 v77, s65, v238
    v_lshl_add_u32 v77, v77, 4, v235
    ds_write_b64 v77, v[236:237] offset:0
    s_nop 1
    v_cvt_pk_bf16_f32 v236, v196, v197
    v_lshlrev_b32 v196, 16, v236
    v_and_b32 v197, 0xffff0000, v236
    v_cvt_pk_bf16_f32 v237, v198, v199
    v_lshlrev_b32 v198, 16, v237
    v_and_b32 v199, 0xffff0000, v237
    v_mul_f32 v196, v196, v233
    v_mul_f32 v197, v197, v233
    v_mul_f32 v198, v198, v233
    v_mul_f32 v199, v199, v233
    v_cvt_pk_bf16_f32 v236, v196, v197
    v_cvt_pk_bf16_f32 v237, v198, v199
    s_mul_i32 s65, s60, 20
    s_add_u32 s65, s65, 15
    v_xor_b32 v77, s65, v238
    v_lshl_add_u32 v77, v77, 4, v235
    ds_write_b64 v77, v[236:237] offset:0
    s_nop 1
    v_cvt_pk_bf16_f32 v236, v200, v201
    v_lshlrev_b32 v200, 16, v236
    v_and_b32 v201, 0xffff0000, v236
    v_cvt_pk_bf16_f32 v237, v202, v203
    v_lshlrev_b32 v202, 16, v237
    v_and_b32 v203, 0xffff0000, v237
    v_cndmask_b32 v77, v220, v221, s[88:89]
    v_mul_f32 v200, v200, v77
    v_cndmask_b32 v77, v220, v221, s[88:89]
    v_mul_f32 v201, v201, v77
    v_cndmask_b32 v77, v220, v221, s[88:89]
    v_mul_f32 v202, v202, v77
    v_cndmask_b32 v77, v220, v221, s[88:89]
    v_mul_f32 v203, v203, v77
    v_cvt_pk_bf16_f32 v236, v200, v201
    v_cvt_pk_bf16_f32 v237, v202, v203
    s_mul_i32 s65, s60, 20
    s_add_u32 s65, s65, 12
    v_xor_b32 v77, s65, v238
    v_lshl_add_u32 v77, v77, 4, v235
    ds_write_b64 v77, v[236:237] offset:40960
    s_nop 1
    v_cvt_pk_bf16_f32 v236, v204, v205
    v_lshlrev_b32 v204, 16, v236
    v_and_b32 v205, 0xffff0000, v236
    v_cvt_pk_bf16_f32 v237, v206, v207
    v_lshlrev_b32 v206, 16, v237
    v_and_b32 v207, 0xffff0000, v237
    v_mul_f32 v204, v204, v221
    v_mul_f32 v205, v205, v221
    v_mul_f32 v206, v206, v221
    v_mul_f32 v207, v207, v221
    v_cvt_pk_bf16_f32 v236, v204, v205
    v_cvt_pk_bf16_f32 v237, v206, v207
    s_mul_i32 s65, s60, 20
    s_add_u32 s65, s65, 13
    v_xor_b32 v77, s65, v238
    v_lshl_add_u32 v77, v77, 4, v235
    ds_write_b64 v77, v[236:237] offset:40960
    s_nop 1
    v_cvt_pk_bf16_f32 v236, v208, v209
    v_lshlrev_b32 v208, 16, v236
    v_and_b32 v209, 0xffff0000, v236
    v_cvt_pk_bf16_f32 v237, v210, v211
    v_lshlrev_b32 v210, 16, v237
    v_and_b32 v211, 0xffff0000, v237
    v_mul_f32 v208, v208, v221
    v_mul_f32 v209, v209, v221
    v_mul_f32 v210, v210, v221
    v_mul_f32 v211, v211, v221
    v_cvt_pk_bf16_f32 v236, v208, v209
    v_cvt_pk_bf16_f32 v237, v210, v211
    s_mul_i32 s65, s60, 20
    s_add_u32 s65, s65, 14
    v_xor_b32 v77, s65, v238
    v_lshl_add_u32 v77, v77, 4, v235
    ds_write_b64 v77, v[236:237] offset:40960
    s_nop 1
    v_cvt_pk_bf16_f32 v236, v212, v213
    v_lshlrev_b32 v212, 16, v236
    v_and_b32 v213, 0xffff0000, v236
    v_cvt_pk_bf16_f32 v237, v214, v215
    v_lshlrev_b32 v214, 16, v237
    v_and_b32 v215, 0xffff0000, v237
    v_mul_f32 v212, v212, v222
    v_mul_f32 v213, v213, v222
    v_mul_f32 v214, v214, v222
    v_mul_f32 v215, v215, v222
    v_cvt_pk_bf16_f32 v236, v212, v213
    v_cvt_pk_bf16_f32 v237, v214, v215
    s_mul_i32 s65, s60, 20
    s_add_u32 s65, s65, 15
    v_xor_b32 v77, s65, v238
    v_lshl_add_u32 v77, v77, 4, v235
    ds_write_b64 v77, v[236:237] offset:40960
    s_nop 1
    v_mov_b32 v184, 0
    v_mov_b32 v185, 0
    v_mov_b32 v186, 0
    v_mov_b32 v187, 0
    v_mov_b32 v188, 0
    v_mov_b32 v189, 0
    v_mov_b32 v190, 0
    v_mov_b32 v191, 0
    v_mov_b32 v192, 0
    v_mov_b32 v193, 0
    v_mov_b32 v194, 0
    v_mov_b32 v195, 0
    v_mov_b32 v196, 0
    v_mov_b32 v197, 0
    v_mov_b32 v198, 0
    v_mov_b32 v199, 0
    v_mov_b32 v200, 0
    v_mov_b32 v201, 0
    v_mov_b32 v202, 0
    v_mov_b32 v203, 0
    v_mov_b32 v204, 0
    v_mov_b32 v205, 0
    v_mov_b32 v206, 0
    v_mov_b32 v207, 0
    v_mov_b32 v208, 0
    v_mov_b32 v209, 0
    v_mov_b32 v210, 0
    v_mov_b32 v211, 0
    v_mov_b32 v212, 0
    v_mov_b32 v213, 0
    v_mov_b32 v214, 0
    v_mov_b32 v215, 0
    s_add_u32 s65, s86, 32768
    buffer_load_dwordx4 v[172:175], v169, s[76:79], s65 offen offset:0
    buffer_load_dwordx4 v[176:179], v169, s[76:79], s65 offen offset:16
    s_waitcnt vmcnt(0)
    v_cvt_pk_bf16_f32 v180, v172, v173
    v_cvt_pk_bf16_f32 v181, v174, v175
    v_cvt_pk_bf16_f32 v182, v176, v177
    v_cvt_pk_bf16_f32 v183, v178, v179
    s_nop 1
    v_mfma_f32_32x32x16_bf16 v[184:199], v[180:183], v[144:147], v[184:199]
    v_mfma_f32_32x32x16_bf16 v[200:215], v[180:183], v[148:151], v[200:215]
    s_nop 4
    s_add_u32 s65, s86, 32768
    buffer_load_dwordx4 v[172:175], v169, s[76:79], s65 offen offset:64
    buffer_load_dwordx4 v[176:179], v169, s[76:79], s65 offen offset:80
    s_waitcnt vmcnt(0)
    v_cvt_pk_bf16_f32 v180, v172, v173
    v_cvt_pk_bf16_f32 v181, v174, v175
    v_cvt_pk_bf16_f32 v182, v176, v177
    v_cvt_pk_bf16_f32 v183, v178, v179
    s_nop 1
    v_mfma_f32_32x32x16_bf16 v[184:199], v[180:183], v[152:155], v[184:199]
    v_mfma_f32_32x32x16_bf16 v[200:215], v[180:183], v[156:159], v[200:215]
    s_nop 4
    s_add_u32 s65, s86, 32768
    buffer_load_dwordx4 v[172:175], v169, s[76:79], s65 offen offset:128
    buffer_load_dwordx4 v[176:179], v169, s[76:79], s65 offen offset:144
    s_waitcnt vmcnt(0)
    v_cvt_pk_bf16_f32 v180, v172, v173
    v_cvt_pk_bf16_f32 v181, v174, v175
    v_cvt_pk_bf16_f32 v182, v176, v177
    v_cvt_pk_bf16_f32 v183, v178, v179
    s_nop 1
    v_mfma_f32_32x32x16_bf16 v[184:199], v[180:183], v[160:163], v[184:199]
    v_mfma_f32_32x32x16_bf16 v[200:215], v[180:183], v[164:167], v[200:215]
    s_nop 4
    s_nop 7
    s_nop 7
    v_cvt_pk_bf16_f32 v236, v184, v185
    v_lshlrev_b32 v184, 16, v236
    v_and_b32 v185, 0xffff0000, v236
    v_cvt_pk_bf16_f32 v237, v186, v187
    v_lshlrev_b32 v186, 16, v237
    v_and_b32 v187, 0xffff0000, v237
    v_mul_f32 v184, v184, v233
    v_mul_f32 v185, v185, v233
    v_mul_f32 v186, v186, v233
    v_mul_f32 v187, v187, v233
    v_cvt_pk_bf16_f32 v236, v184, v185
    v_cvt_pk_bf16_f32 v237, v186, v187
    s_mul_i32 s65, s60, 20
    s_add_u32 s65, s65, 16
    v_xor_b32 v77, s65, v238
    v_lshl_add_u32 v77, v77, 4, v235
    ds_write_b64 v77, v[236:237] offset:0
    s_nop 1
    v_cvt_pk_bf16_f32 v236, v188, v189
    v_lshlrev_b32 v188, 16, v236
    v_and_b32 v189, 0xffff0000, v236
    v_cvt_pk_bf16_f32 v237, v190, v191
    v_lshlrev_b32 v190, 16, v237
    v_and_b32 v191, 0xffff0000, v237
    v_cndmask_b32 v77, v233, v234, s[88:89]
    v_mul_f32 v188, v188, v77
    v_cndmask_b32 v77, v233, v234, s[88:89]
    v_mul_f32 v189, v189, v77
    v_cndmask_b32 v77, v233, v234, s[88:89]
    v_mul_f32 v190, v190, v77
    v_cndmask_b32 v77, v233, v234, s[88:89]
    v_mul_f32 v191, v191, v77
    v_cvt_pk_bf16_f32 v236, v188, v189
    v_cvt_pk_bf16_f32 v237, v190, v191
    s_mul_i32 s65, s60, 20
    s_add_u32 s65, s65, 17
    v_xor_b32 v77, s65, v238
    v_lshl_add_u32 v77, v77, 4, v235
    ds_write_b64 v77, v[236:237] offset:0
    s_nop 1
    v_cvt_pk_bf16_f32 v236, v192, v193
    v_lshlrev_b32 v192, 16, v236
    v_and_b32 v193, 0xffff0000, v236
    v_cvt_pk_bf16_f32 v237, v194, v195
    v_lshlrev_b32 v194, 16, v237
    v_and_b32 v195, 0xffff0000, v237
    v_mul_f32 v192, v192, v234
    v_mul_f32 v193, v193, v234
    v_mul_f32 v194, v194, v234
    v_mul_f32 v195, v195, v234
    v_cvt_pk_bf16_f32 v236, v192, v193
    v_cvt_pk_bf16_f32 v237, v194, v195
    s_mul_i32 s65, s60, 20
    s_add_u32 s65, s65, 18
    v_xor_b32 v77, s65, v238
    v_lshl_add_u32 v77, v77, 4, v235
    ds_write_b64 v77, v[236:237] offset:0
    s_nop 1
    v_cvt_pk_bf16_f32 v236, v196, v197
    v_lshlrev_b32 v196, 16, v236
    v_and_b32 v197, 0xffff0000, v236
    v_cvt_pk_bf16_f32 v237, v198, v199
    v_lshlrev_b32 v198, 16, v237
    v_and_b32 v199, 0xffff0000, v237
    v_mul_f32 v196, v196, v234
    v_mul_f32 v197, v197, v234
    v_mul_f32 v198, v198, v234
    v_mul_f32 v199, v199, v234
    v_cvt_pk_bf16_f32 v236, v196, v197
    v_cvt_pk_bf16_f32 v237, v198, v199
    s_mul_i32 s65, s60, 20
    s_add_u32 s65, s65, 19
    v_xor_b32 v77, s65, v238
    v_lshl_add_u32 v77, v77, 4, v235
    ds_write_b64 v77, v[236:237] offset:0
    s_nop 1
    v_cvt_pk_bf16_f32 v236, v200, v201
    v_lshlrev_b32 v200, 16, v236
    v_and_b32 v201, 0xffff0000, v236
    v_cvt_pk_bf16_f32 v237, v202, v203
    v_lshlrev_b32 v202, 16, v237
    v_and_b32 v203, 0xffff0000, v237
    v_mul_f32 v200, v200, v222
    v_mul_f32 v201, v201, v222
    v_mul_f32 v202, v202, v222
    v_mul_f32 v203, v203, v222
    v_cvt_pk_bf16_f32 v236, v200, v201
    v_cvt_pk_bf16_f32 v237, v202, v203
    s_mul_i32 s65, s60, 20
    s_add_u32 s65, s65, 16
    v_xor_b32 v77, s65, v238
    v_lshl_add_u32 v77, v77, 4, v235
    ds_write_b64 v77, v[236:237] offset:40960
    s_nop 1
    v_cvt_pk_bf16_f32 v236, v204, v205
    v_lshlrev_b32 v204, 16, v236
    v_and_b32 v205, 0xffff0000, v236
    v_cvt_pk_bf16_f32 v237, v206, v207
    v_lshlrev_b32 v206, 16, v237
    v_and_b32 v207, 0xffff0000, v237
    v_cndmask_b32 v77, v222, v223, s[88:89]
    v_mul_f32 v204, v204, v77
    v_cndmask_b32 v77, v222, v223, s[88:89]
    v_mul_f32 v205, v205, v77
    v_cndmask_b32 v77, v222, v223, s[88:89]
    v_mul_f32 v206, v206, v77
    v_cndmask_b32 v77, v222, v223, s[88:89]
    v_mul_f32 v207, v207, v77
    v_cvt_pk_bf16_f32 v236, v204, v205
    v_cvt_pk_bf16_f32 v237, v206, v207
    s_mul_i32 s65, s60, 20
    s_add_u32 s65, s65, 17
    v_xor_b32 v77, s65, v238
    v_lshl_add_u32 v77, v77, 4, v235
    ds_write_b64 v77, v[236:237] offset:40960
    s_nop 1
    v_cvt_pk_bf16_f32 v236, v208, v209
    v_lshlrev_b32 v208, 16, v236
    v_and_b32 v209, 0xffff0000, v236
    v_cvt_pk_bf16_f32 v237, v210, v211
    v_lshlrev_b32 v210, 16, v237
    v_and_b32 v211, 0xffff0000, v237
    v_mul_f32 v208, v208, v223
    v_mul_f32 v209, v209, v223
    v_mul_f32 v210, v210, v223
    v_mul_f32 v211, v211, v223
    v_cvt_pk_bf16_f32 v236, v208, v209
    v_cvt_pk_bf16_f32 v237, v210, v211
    s_mul_i32 s65, s60, 20
    s_add_u32 s65, s65, 18
    v_xor_b32 v77, s65, v238
    v_lshl_add_u32 v77, v77, 4, v235
    ds_write_b64 v77, v[236:237] offset:40960
    s_nop 1
    v_cvt_pk_bf16_f32 v236, v212, v213
    v_lshlrev_b32 v212, 16, v236
    v_and_b32 v213, 0xffff0000, v236
    v_cvt_pk_bf16_f32 v237, v214, v215
    v_lshlrev_b32 v214, 16, v237
    v_and_b32 v215, 0xffff0000, v237
    v_mul_f32 v212, v212, v223
    v_mul_f32 v213, v213, v223
    v_mul_f32 v214, v214, v223
    v_mul_f32 v215, v215, v223
    v_cvt_pk_bf16_f32 v236, v212, v213
    v_cvt_pk_bf16_f32 v237, v214, v215
    s_mul_i32 s65, s60, 20
    s_add_u32 s65, s65, 19
    v_xor_b32 v77, s65, v238
    v_lshl_add_u32 v77, v77, 4, v235
    ds_write_b64 v77, v[236:237] offset:40960
    s_nop 1
    s_waitcnt lgkmcnt(0)
    s_mov_b32 s48, s16
    s_mov_b32 s49, s17
    s_and_b32 s49, s49, 0xffff
    s_mov_b32 s50, 2621440
    s_mov_b32 s51, 0x00020000
    s_add_u32 s56, s36, 11329536
    s_addc_u32 s57, s37, 0
    s_and_b32 s57, s57, 0xffff
    s_mov_b32 s58, 2621440
    s_mov_b32 s59, 0x00020000
    s_add_u32 s80, s36, 7880704
    s_addc_u32 s81, s37, 0
    s_and_b32 s81, s81, 0xffff
    s_mov_b32 s82, 163840
    s_mov_b32 s83, 0x00020000
    v_lshrrev_b32 v104, 5, v76
    v_lshlrev_b32 v104, 2, v104
    s_lshl_b32 s65, s68, 6
    v_add_u32 v104, s65, v104
    v_lshlrev_b32 v105, 1, v104
    s_lshl_b32 s66, s62, 1
    v_and_b32 v106, 31, v76
    s_lshl_b32 s65, s67, 5
    v_add_u32 v106, s65, v106
    v_add_u32 v106, s61, v106
    v_mul_u32_u24 v106, 1280, v106
    v_add_u32 v106, v106, v105
    buffer_load_dwordx2 v[88:89], v106, s[48:51], s66 offen offset:0
    buffer_load_dwordx2 v[90:91], v106, s[48:51], s66 offen offset:16
    buffer_load_dwordx2 v[92:93], v106, s[48:51], s66 offen offset:32
    buffer_load_dwordx2 v[94:95], v106, s[48:51], s66 offen offset:48
    buffer_load_dwordx2 v[96:97], v106, s[48:51], s66 offen offset:64
    buffer_load_dwordx2 v[98:99], v106, s[48:51], s66 offen offset:80
    buffer_load_dwordx2 v[100:101], v106, s[48:51], s66 offen offset:96
    buffer_load_dwordx2 v[102:103], v106, s[48:51], s66 offen offset:112
    s_waitcnt vmcnt(63)
    s_barrier
    s_mov_b32 s69, 256
    s_add_u32 m0, s64, 114688
    buffer_load_dwordx4 v60, s[44:47], s69 offen lds
    s_add_u32 m0, s64, 115712
    buffer_load_dwordx4 v61, s[44:47], s69 offen lds
    s_add_u32 m0, s64, 116736
    buffer_load_dwordx4 v62, s[44:47], s69 offen lds
    s_add_u32 m0, s64, 117760
    buffer_load_dwordx4 v63, s[44:47], s69 offen lds
    ds_read_b128 v[36:39], v79 offset:0
    ds_read_b128 v[44:47], v72 offset:16384
    ds_read_b128 v[48:51], v72 offset:20480
    ds_read_b128 v[40:43], v80 offset:0
    ds_read_b128 v[52:55], v73 offset:16384
    ds_read_b128 v[56:59], v73 offset:20480
    s_waitcnt lgkmcnt(3)
    v_mfma_f32_32x32x16_bf16 v[4:19], v[44:47], v[36:39], v[4:19]
    v_mfma_f32_32x32x16_bf16 v[20:35], v[48:51], v[36:39], v[20:35]
    ds_read_b128 v[36:39], v81 offset:0
    ds_read_b128 v[44:47], v74 offset:16384
    ds_read_b128 v[48:51], v74 offset:20480
    s_waitcnt lgkmcnt(3)
    v_mfma_f32_32x32x16_bf16 v[4:19], v[52:55], v[40:43], v[4:19]
    v_mfma_f32_32x32x16_bf16 v[20:35], v[56:59], v[40:43], v[20:35]
    ds_read_b128 v[40:43], v82 offset:0
    ds_read_b128 v[52:55], v75 offset:16384
    ds_read_b128 v[56:59], v75 offset:20480
    s_waitcnt lgkmcnt(3)
    v_mfma_f32_32x32x16_bf16 v[4:19], v[44:47], v[36:39], v[4:19]
    v_mfma_f32_32x32x16_bf16 v[20:35], v[48:51], v[36:39], v[20:35]
    s_waitcnt vmcnt(63) lgkmcnt(0)
    s_barrier
    s_mov_b32 s69, 384
    s_add_u32 m0, s64, 81920
    buffer_load_dwordx4 v60, s[44:47], s69 offen lds
    s_add_u32 m0, s64, 82944
    buffer_load_dwordx4 v61, s[44:47], s69 offen lds
    s_add_u32 m0, s64, 83968
    buffer_load_dwordx4 v62, s[44:47], s69 offen lds
    s_add_u32 m0, s64, 84992
    buffer_load_dwordx4 v63, s[44:47], s69 offen lds
    ds_read_b128 v[36:39], v83 offset:0
    ds_read_b128 v[44:47], v72 offset:32768
    ds_read_b128 v[48:51], v72 offset:36864
    v_mfma_f32_32x32x16_bf16 v[4:19], v[52:55], v[40:43], v[4:19]
    v_mfma_f32_32x32x16_bf16 v[20:35], v[56:59], v[40:43], v[20:35]
    ds_read_b128 v[40:43], v84 offset:0
    ds_read_b128 v[52:55], v73 offset:32768
    ds_read_b128 v[56:59], v73 offset:36864
    s_waitcnt lgkmcnt(3)
    v_mfma_f32_32x32x16_bf16 v[4:19], v[44:47], v[36:39], v[4:19]
    v_mfma_f32_32x32x16_bf16 v[20:35], v[48:51], v[36:39], v[20:35]
    ds_read_b128 v[36:39], v85 offset:0
    ds_read_b128 v[44:47], v74 offset:32768
    ds_read_b128 v[48:51], v74 offset:36864
    s_waitcnt lgkmcnt(3)
    v_mfma_f32_32x32x16_bf16 v[4:19], v[52:55], v[40:43], v[4:19]
    v_mfma_f32_32x32x16_bf16 v[20:35], v[56:59], v[40:43], v[20:35]
    ds_read_b128 v[40:43], v86 offset:0
    ds_read_b128 v[52:55], v75 offset:32768
    ds_read_b128 v[56:59], v75 offset:36864
    s_waitcnt lgkmcnt(3)
    v_mfma_f32_32x32x16_bf16 v[4:19], v[44:47], v[36:39], v[4:19]
    v_mfma_f32_32x32x16_bf16 v[20:35], v[48:51], v[36:39], v[20:35]
    s_waitcnt vmcnt(4) lgkmcnt(0)
    s_barrier
    s_mov_b32 s69, 512
    s_add_u32 m0, s64, 98304
    buffer_load_dwordx4 v60, s[44:47], s69 offen lds
    s_add_u32 m0, s64, 99328
    buffer_load_dwordx4 v61, s[44:47], s69 offen lds
    s_add_u32 m0, s64, 100352
    buffer_load_dwordx4 v62, s[44:47], s69 offen lds
    s_add_u32 m0, s64, 101376
    buffer_load_dwordx4 v63, s[44:47], s69 offen lds
    ds_read_b128 v[36:39], v79 offset:256
    ds_read_b128 v[44:47], v72 offset:49152
    ds_read_b128 v[48:51], v72 offset:53248
    v_mfma_f32_32x32x16_bf16 v[4:19], v[52:55], v[40:43], v[4:19]
    v_mfma_f32_32x32x16_bf16 v[20:35], v[56:59], v[40:43], v[20:35]
    ds_read_b128 v[40:43], v80 offset:256
    ds_read_b128 v[52:55], v73 offset:49152
    ds_read_b128 v[56:59], v73 offset:53248
    s_waitcnt lgkmcnt(3)
    v_mfma_f32_32x32x16_bf16 v[4:19], v[44:47], v[36:39], v[4:19]
    v_mfma_f32_32x32x16_bf16 v[20:35], v[48:51], v[36:39], v[20:35]
    ds_read_b128 v[36:39], v81 offset:256
    ds_read_b128 v[44:47], v74 offset:49152
    ds_read_b128 v[48:51], v74 offset:53248
    s_waitcnt lgkmcnt(3)
    v_mfma_f32_32x32x16_bf16 v[4:19], v[52:55], v[40:43], v[4:19]
    v_mfma_f32_32x32x16_bf16 v[20:35], v[56:59], v[40:43], v[20:35]
    ds_read_b128 v[40:43], v82 offset:256
    ds_read_b128 v[52:55], v75 offset:49152
    ds_read_b128 v[56:59], v75 offset:53248
    s_waitcnt lgkmcnt(3)
    v_mfma_f32_32x32x16_bf16 v[4:19], v[44:47], v[36:39], v[4:19]
    v_mfma_f32_32x32x16_bf16 v[20:35], v[48:51], v[36:39], v[20:35]
    s_waitcnt vmcnt(4) lgkmcnt(0)
    s_barrier
    s_mov_b32 s69, 640
    s_add_u32 m0, s64, 114688
    buffer_load_dwordx4 v60, s[44:47], s69 offen lds
    s_add_u32 m0, s64, 115712
    buffer_load_dwordx4 v61, s[44:47], s69 offen lds
    s_add_u32 m0, s64, 116736
    buffer_load_dwordx4 v62, s[44:47], s69 offen lds
    s_add_u32 m0, s64, 117760
    buffer_load_dwordx4 v63, s[44:47], s69 offen lds
    ds_read_b128 v[36:39], v83 offset:256
    ds_read_b128 v[44:47], v72 offset:16384
    ds_read_b128 v[48:51], v72 offset:20480
    v_mfma_f32_32x32x16_bf16 v[4:19], v[52:55], v[40:43], v[4:19]
    v_mfma_f32_32x32x16_bf16 v[20:35], v[56:59], v[40:43], v[20:35]
    ds_read_b128 v[40:43], v84 offset:256
    ds_read_b128 v[52:55], v73 offset:16384
    ds_read_b128 v[56:59], v73 offset:20480
    s_waitcnt lgkmcnt(3)
    v_mfma_f32_32x32x16_bf16 v[4:19], v[44:47], v[36:39], v[4:19]
    v_mfma_f32_32x32x16_bf16 v[20:35], v[48:51], v[36:39], v[20:35]
    ds_read_b128 v[36:39], v85 offset:256
    ds_read_b128 v[44:47], v74 offset:16384
    ds_read_b128 v[48:51], v74 offset:20480
    s_waitcnt lgkmcnt(3)
    v_mfma_f32_32x32x16_bf16 v[4:19], v[52:55], v[40:43], v[4:19]
    v_mfma_f32_32x32x16_bf16 v[20:35], v[56:59], v[40:43], v[20:35]
    ds_read_b128 v[40:43], v86 offset:256
    ds_read_b128 v[52:55], v75 offset:16384
    ds_read_b128 v[56:59], v75 offset:20480
    s_waitcnt lgkmcnt(3)
    v_mfma_f32_32x32x16_bf16 v[4:19], v[44:47], v[36:39], v[4:19]
    v_mfma_f32_32x32x16_bf16 v[20:35], v[48:51], v[36:39], v[20:35]
    s_waitcnt vmcnt(4) lgkmcnt(0)
    s_barrier
    s_mov_b32 s69, 768
    s_add_u32 m0, s64, 81920
    buffer_load_dwordx4 v60, s[44:47], s69 offen lds
    s_add_u32 m0, s64, 82944
    buffer_load_dwordx4 v61, s[44:47], s69 offen lds
    s_add_u32 m0, s64, 83968
    buffer_load_dwordx4 v62, s[44:47], s69 offen lds
    s_add_u32 m0, s64, 84992
    buffer_load_dwordx4 v63, s[44:47], s69 offen lds
    ds_read_b128 v[36:39], v79 offset:512
    ds_read_b128 v[44:47], v72 offset:32768
    ds_read_b128 v[48:51], v72 offset:36864
    v_mfma_f32_32x32x16_bf16 v[4:19], v[52:55], v[40:43], v[4:19]
    v_mfma_f32_32x32x16_bf16 v[20:35], v[56:59], v[40:43], v[20:35]
    ds_read_b128 v[40:43], v80 offset:512
    ds_read_b128 v[52:55], v73 offset:32768
    ds_read_b128 v[56:59], v73 offset:36864
    s_waitcnt lgkmcnt(3)
    v_mfma_f32_32x32x16_bf16 v[4:19], v[44:47], v[36:39], v[4:19]
    v_mfma_f32_32x32x16_bf16 v[20:35], v[48:51], v[36:39], v[20:35]
    ds_read_b128 v[36:39], v81 offset:512
    ds_read_b128 v[44:47], v74 offset:32768
    ds_read_b128 v[48:51], v74 offset:36864
    s_waitcnt lgkmcnt(3)
    v_mfma_f32_32x32x16_bf16 v[4:19], v[52:55], v[40:43], v[4:19]
    v_mfma_f32_32x32x16_bf16 v[20:35], v[56:59], v[40:43], v[20:35]
    ds_read_b128 v[40:43], v82 offset:512
    ds_read_b128 v[52:55], v75 offset:32768
    ds_read_b128 v[56:59], v75 offset:36864
    s_waitcnt lgkmcnt(3)
    v_mfma_f32_32x32x16_bf16 v[4:19], v[44:47], v[36:39], v[4:19]
    v_mfma_f32_32x32x16_bf16 v[20:35], v[48:51], v[36:39], v[20:35]
    s_waitcnt vmcnt(4) lgkmcnt(0)
    s_barrier
    s_mov_b32 s69, 896
    s_add_u32 m0, s64, 98304
    buffer_load_dwordx4 v60, s[44:47], s69 offen lds
    s_add_u32 m0, s64, 99328
    buffer_load_dwordx4 v61, s[44:47], s69 offen lds
    s_add_u32 m0, s64, 100352
    buffer_load_dwordx4 v62, s[44:47], s69 offen lds
    s_add_u32 m0, s64, 101376
    buffer_load_dwordx4 v63, s[44:47], s69 offen lds
    ds_read_b128 v[36:39], v83 offset:512
    ds_read_b128 v[44:47], v72 offset:49152
    ds_read_b128 v[48:51], v72 offset:53248
    v_mfma_f32_32x32x16_bf16 v[4:19], v[52:55], v[40:43], v[4:19]
    v_mfma_f32_32x32x16_bf16 v[20:35], v[56:59], v[40:43], v[20:35]
    ds_read_b128 v[40:43], v84 offset:512
    ds_read_b128 v[52:55], v73 offset:49152
    ds_read_b128 v[56:59], v73 offset:53248
    s_waitcnt lgkmcnt(3)
    v_mfma_f32_32x32x16_bf16 v[4:19], v[44:47], v[36:39], v[4:19]
    v_mfma_f32_32x32x16_bf16 v[20:35], v[48:51], v[36:39], v[20:35]
    ds_read_b128 v[36:39], v85 offset:512
    ds_read_b128 v[44:47], v74 offset:49152
    ds_read_b128 v[48:51], v74 offset:53248
    s_waitcnt lgkmcnt(3)
    v_mfma_f32_32x32x16_bf16 v[4:19], v[52:55], v[40:43], v[4:19]
    v_mfma_f32_32x32x16_bf16 v[20:35], v[56:59], v[40:43], v[20:35]
    ds_read_b128 v[40:43], v86 offset:512
    ds_read_b128 v[52:55], v75 offset:49152
    ds_read_b128 v[56:59], v75 offset:53248
    s_waitcnt lgkmcnt(3)
    v_mfma_f32_32x32x16_bf16 v[4:19], v[44:47], v[36:39], v[4:19]
    v_mfma_f32_32x32x16_bf16 v[20:35], v[48:51], v[36:39], v[20:35]
    s_waitcnt vmcnt(4) lgkmcnt(0)
    s_barrier
    s_mov_b32 s69, 1024
    s_add_u32 m0, s64, 114688
    buffer_load_dwordx4 v60, s[44:47], s69 offen lds
    s_add_u32 m0, s64, 115712
    buffer_load_dwordx4 v61, s[44:47], s69 offen lds
    s_add_u32 m0, s64, 116736
    buffer_load_dwordx4 v62, s[44:47], s69 offen lds
    s_add_u32 m0, s64, 117760
    buffer_load_dwordx4 v63, s[44:47], s69 offen lds
    ds_read_b128 v[36:39], v79 offset:768
    ds_read_b128 v[44:47], v72 offset:16384
    ds_read_b128 v[48:51], v72 offset:20480
    v_mfma_f32_32x32x16_bf16 v[4:19], v[52:55], v[40:43], v[4:19]
    v_mfma_f32_32x32x16_bf16 v[20:35], v[56:59], v[40:43], v[20:35]
    ds_read_b128 v[40:43], v80 offset:768
    ds_read_b128 v[52:55], v73 offset:16384
    ds_read_b128 v[56:59], v73 offset:20480
    s_waitcnt lgkmcnt(3)
    v_mfma_f32_32x32x16_bf16 v[4:19], v[44:47], v[36:39], v[4:19]
    v_mfma_f32_32x32x16_bf16 v[20:35], v[48:51], v[36:39], v[20:35]
    ds_read_b128 v[36:39], v81 offset:768
    ds_read_b128 v[44:47], v74 offset:16384
    ds_read_b128 v[48:51], v74 offset:20480
    s_waitcnt lgkmcnt(3)
    v_mfma_f32_32x32x16_bf16 v[4:19], v[52:55], v[40:43], v[4:19]
    v_mfma_f32_32x32x16_bf16 v[20:35], v[56:59], v[40:43], v[20:35]
    ds_read_b128 v[40:43], v82 offset:768
    ds_read_b128 v[52:55], v75 offset:16384
    ds_read_b128 v[56:59], v75 offset:20480
    s_waitcnt lgkmcnt(3)
    v_mfma_f32_32x32x16_bf16 v[4:19], v[44:47], v[36:39], v[4:19]
    v_mfma_f32_32x32x16_bf16 v[20:35], v[48:51], v[36:39], v[20:35]
    s_waitcnt vmcnt(4) lgkmcnt(0)
    s_barrier
    s_mov_b32 s69, 1152
    s_add_u32 m0, s64, 81920
    buffer_load_dwordx4 v60, s[44:47], s69 offen lds
    s_add_u32 m0, s64, 82944
    buffer_load_dwordx4 v61, s[44:47], s69 offen lds
    s_add_u32 m0, s64, 83968
    buffer_load_dwordx4 v62, s[44:47], s69 offen lds
    s_add_u32 m0, s64, 84992
    buffer_load_dwordx4 v63, s[44:47], s69 offen lds
    ds_read_b128 v[36:39], v83 offset:768
    ds_read_b128 v[44:47], v72 offset:32768
    ds_read_b128 v[48:51], v72 offset:36864
    v_mfma_f32_32x32x16_bf16 v[4:19], v[52:55], v[40:43], v[4:19]
    v_mfma_f32_32x32x16_bf16 v[20:35], v[56:59], v[40:43], v[20:35]
    ds_read_b128 v[40:43], v84 offset:768
    ds_read_b128 v[52:55], v73 offset:32768
    ds_read_b128 v[56:59], v73 offset:36864
    s_waitcnt lgkmcnt(3)
    v_mfma_f32_32x32x16_bf16 v[4:19], v[44:47], v[36:39], v[4:19]
    v_mfma_f32_32x32x16_bf16 v[20:35], v[48:51], v[36:39], v[20:35]
    ds_read_b128 v[36:39], v85 offset:768
    ds_read_b128 v[44:47], v74 offset:32768
    ds_read_b128 v[48:51], v74 offset:36864
    s_waitcnt lgkmcnt(3)
    v_mfma_f32_32x32x16_bf16 v[4:19], v[52:55], v[40:43], v[4:19]
    v_mfma_f32_32x32x16_bf16 v[20:35], v[56:59], v[40:43], v[20:35]
    ds_read_b128 v[40:43], v86 offset:768
    ds_read_b128 v[52:55], v75 offset:32768
    ds_read_b128 v[56:59], v75 offset:36864
    s_waitcnt lgkmcnt(3)
    v_mfma_f32_32x32x16_bf16 v[4:19], v[44:47], v[36:39], v[4:19]
    v_mfma_f32_32x32x16_bf16 v[20:35], v[48:51], v[36:39], v[20:35]
    s_waitcnt vmcnt(4) lgkmcnt(0)
    s_barrier
    ds_read_b128 v[36:39], v79 offset:1024
    ds_read_b128 v[44:47], v72 offset:49152
    ds_read_b128 v[48:51], v72 offset:53248
    v_mfma_f32_32x32x16_bf16 v[4:19], v[52:55], v[40:43], v[4:19]
    v_mfma_f32_32x32x16_bf16 v[20:35], v[56:59], v[40:43], v[20:35]
    ds_read_b128 v[40:43], v80 offset:1024
    ds_read_b128 v[52:55], v73 offset:49152
    ds_read_b128 v[56:59], v73 offset:53248
    s_waitcnt lgkmcnt(3)
    v_mfma_f32_32x32x16_bf16 v[4:19], v[44:47], v[36:39], v[4:19]
    v_mfma_f32_32x32x16_bf16 v[20:35], v[48:51], v[36:39], v[20:35]
    ds_read_b128 v[36:39], v81 offset:1024
    ds_read_b128 v[44:47], v74 offset:49152
    ds_read_b128 v[48:51], v74 offset:53248
    s_waitcnt lgkmcnt(3)
    v_mfma_f32_32x32x16_bf16 v[4:19], v[52:55], v[40:43], v[4:19]
    v_mfma_f32_32x32x16_bf16 v[20:35], v[56:59], v[40:43], v[20:35]
    ds_read_b128 v[40:43], v82 offset:1024
    ds_read_b128 v[52:55], v75 offset:49152
    ds_read_b128 v[56:59], v75 offset:53248
    s_waitcnt lgkmcnt(3)
    v_mfma_f32_32x32x16_bf16 v[4:19], v[44:47], v[36:39], v[4:19]
    v_mfma_f32_32x32x16_bf16 v[20:35], v[48:51], v[36:39], v[20:35]
    s_waitcnt vmcnt(0) lgkmcnt(0)
    s_barrier
    ds_read_b128 v[36:39], v83 offset:1024
    ds_read_b128 v[44:47], v72 offset:16384
    ds_read_b128 v[48:51], v72 offset:20480
    v_mfma_f32_32x32x16_bf16 v[4:19], v[52:55], v[40:43], v[4:19]
    v_mfma_f32_32x32x16_bf16 v[20:35], v[56:59], v[40:43], v[20:35]
    ds_read_b128 v[40:43], v84 offset:1024
    ds_read_b128 v[52:55], v73 offset:16384
    ds_read_b128 v[56:59], v73 offset:20480
    s_waitcnt lgkmcnt(3)
    v_mfma_f32_32x32x16_bf16 v[4:19], v[44:47], v[36:39], v[4:19]
    v_mfma_f32_32x32x16_bf16 v[20:35], v[48:51], v[36:39], v[20:35]
    ds_read_b128 v[36:39], v85 offset:1024
    ds_read_b128 v[44:47], v74 offset:16384
    ds_read_b128 v[48:51], v74 offset:20480
    s_waitcnt lgkmcnt(3)
    v_mfma_f32_32x32x16_bf16 v[4:19], v[52:55], v[40:43], v[4:19]
    v_mfma_f32_32x32x16_bf16 v[20:35], v[56:59], v[40:43], v[20:35]
    ds_read_b128 v[40:43], v86 offset:1024
    ds_read_b128 v[52:55], v75 offset:16384
    ds_read_b128 v[56:59], v75 offset:20480
    s_waitcnt lgkmcnt(3)
    v_mfma_f32_32x32x16_bf16 v[4:19], v[44:47], v[36:39], v[4:19]
    v_mfma_f32_32x32x16_bf16 v[20:35], v[48:51], v[36:39], v[20:35]
    s_waitcnt lgkmcnt(0)
    v_mfma_f32_32x32x16_bf16 v[4:19], v[52:55], v[40:43], v[4:19]
    v_mfma_f32_32x32x16_bf16 v[20:35], v[56:59], v[40:43], v[20:35]
    s_nop 7
    s_nop 7
    s_waitcnt vmcnt(0)
    v_and_b32 v107, 31, v76
    s_lshl_b32 s65, s67, 5
    v_add_u32 v107, s65, v107
    v_add_u32 v107, s61, v107
    v_mul_u32_u24 v108, 1280, v107
    v_lshlrev_b32 v109, 1, v104
    v_add_u32 v108, v108, v109
    s_lshl_b32 s66, s62, 1
    v_mov_b32 v118, 0
    v_mov_b32 v119, 0
    v_cvt_pk_bf16_f32 v109, v4, v5
    v_lshlrev_b32 v4, 16, v109
    v_and_b32 v5, 0xffff0000, v109
    v_cvt_pk_bf16_f32 v110, v6, v7
    v_lshlrev_b32 v6, 16, v110
    v_and_b32 v7, 0xffff0000, v110
    v_lshlrev_b32 v112, 16, v88
    v_and_b32 v113, 0xffff0000, v88
    v_lshlrev_b32 v114, 16, v89
    v_and_b32 v115, 0xffff0000, v89
    v_add_f32 v4, v4, v112
    v_add_f32 v5, v5, v113
    v_add_f32 v6, v6, v114
    v_add_f32 v7, v7, v115
    v_cvt_pk_bf16_f32 v116, v4, v5
    v_cvt_pk_bf16_f32 v117, v6, v7
    buffer_store_dwordx2 v[116:117], v108, s[56:59], s66 offen offset:0
    v_lshlrev_b32 v112, 16, v116
    v_and_b32 v113, 0xffff0000, v116
    v_lshlrev_b32 v114, 16, v117
    v_and_b32 v115, 0xffff0000, v117
    v_add_f32 v118, v118, v112
    v_fmac_f32 v119, v112, v112
    v_add_f32 v118, v118, v113
    v_fmac_f32 v119, v113, v113
    v_add_f32 v118, v118, v114
    v_fmac_f32 v119, v114, v114
    v_add_f32 v118, v118, v115
    v_fmac_f32 v119, v115, v115
    s_nop 1
    v_cvt_pk_bf16_f32 v109, v8, v9
    v_lshlrev_b32 v8, 16, v109
    v_and_b32 v9, 0xffff0000, v109
    v_cvt_pk_bf16_f32 v110, v10, v11
    v_lshlrev_b32 v10, 16, v110
    v_and_b32 v11, 0xffff0000, v110
    v_lshlrev_b32 v112, 16, v90
    v_and_b32 v113, 0xffff0000, v90
    v_lshlrev_b32 v114, 16, v91
    v_and_b32 v115, 0xffff0000, v91
    v_add_f32 v8, v8, v112
    v_add_f32 v9, v9, v113
    v_add_f32 v10, v10, v114
    v_add_f32 v11, v11, v115
    v_cvt_pk_bf16_f32 v116, v8, v9
    v_cvt_pk_bf16_f32 v117, v10, v11
    buffer_store_dwordx2 v[116:117], v108, s[56:59], s66 offen offset:16
    v_lshlrev_b32 v112, 16, v116
    v_and_b32 v113, 0xffff0000, v116
    v_lshlrev_b32 v114, 16, v117
    v_and_b32 v115, 0xffff0000, v117
    v_add_f32 v118, v118, v112
    v_fmac_f32 v119, v112, v112
    v_add_f32 v118, v118, v113
    v_fmac_f32 v119, v113, v113
    v_add_f32 v118, v118, v114
    v_fmac_f32 v119, v114, v114
    v_add_f32 v118, v118, v115
    v_fmac_f32 v119, v115, v115
    s_nop 1
    v_cvt_pk_bf16_f32 v109, v12, v13
    v_lshlrev_b32 v12, 16, v109
    v_and_b32 v13, 0xffff0000, v109
    v_cvt_pk_bf16_f32 v110, v14, v15
    v_lshlrev_b32 v14, 16, v110
    v_and_b32 v15, 0xffff0000, v110
    v_lshlrev_b32 v112, 16, v92
    v_and_b32 v113, 0xffff0000, v92
    v_lshlrev_b32 v114, 16, v93
    v_and_b32 v115, 0xffff0000, v93
    v_add_f32 v12, v12, v112
    v_add_f32 v13, v13, v113
    v_add_f32 v14, v14, v114
    v_add_f32 v15, v15, v115
    v_cvt_pk_bf16_f32 v116, v12, v13
    v_cvt_pk_bf16_f32 v117, v14, v15
    buffer_store_dwordx2 v[116:117], v108, s[56:59], s66 offen offset:32
    v_lshlrev_b32 v112, 16, v116
    v_and_b32 v113, 0xffff0000, v116
    v_lshlrev_b32 v114, 16, v117
    v_and_b32 v115, 0xffff0000, v117
    v_add_f32 v118, v118, v112
    v_fmac_f32 v119, v112, v112
    v_add_f32 v118, v118, v113
    v_fmac_f32 v119, v113, v113
    v_add_f32 v118, v118, v114
    v_fmac_f32 v119, v114, v114
    v_add_f32 v118, v118, v115
    v_fmac_f32 v119, v115, v115
    s_nop 1
    v_cvt_pk_bf16_f32 v109, v16, v17
    v_lshlrev_b32 v16, 16, v109
    v_and_b32 v17, 0xffff0000, v109
    v_cvt_pk_bf16_f32 v110, v18, v19
    v_lshlrev_b32 v18, 16, v110
    v_and_b32 v19, 0xffff0000, v110
    v_lshlrev_b32 v112, 16, v94
    v_and_b32 v113, 0xffff0000, v94
    v_lshlrev_b32 v114, 16, v95
    v_and_b32 v115, 0xffff0000, v95
    v_add_f32 v16, v16, v112
    v_add_f32 v17, v17, v113
    v_add_f32 v18, v18, v114
    v_add_f32 v19, v19, v115
    v_cvt_pk_bf16_f32 v116, v16, v17
    v_cvt_pk_bf16_f32 v117, v18, v19
    buffer_store_dwordx2 v[116:117], v108, s[56:59], s66 offen offset:48
    v_lshlrev_b32 v112, 16, v116
    v_and_b32 v113, 0xffff0000, v116
    v_lshlrev_b32 v114, 16, v117
    v_and_b32 v115, 0xffff0000, v117
    v_add_f32 v118, v118, v112
    v_fmac_f32 v119, v112, v112
    v_add_f32 v118, v118, v113
    v_fmac_f32 v119, v113, v113
    v_add_f32 v118, v118, v114
    v_fmac_f32 v119, v114, v114
    v_add_f32 v118, v118, v115
    v_fmac_f32 v119, v115, v115
    s_nop 1
    v_cvt_pk_bf16_f32 v109, v20, v21
    v_lshlrev_b32 v20, 16, v109
    v_and_b32 v21, 0xffff0000, v109
    v_cvt_pk_bf16_f32 v110, v22, v23
    v_lshlrev_b32 v22, 16, v110
    v_and_b32 v23, 0xffff0000, v110
    v_lshlrev_b32 v112, 16, v96
    v_and_b32 v113, 0xffff0000, v96
    v_lshlrev_b32 v114, 16, v97
    v_and_b32 v115, 0xffff0000, v97
    v_add_f32 v20, v20, v112
    v_add_f32 v21, v21, v113
    v_add_f32 v22, v22, v114
    v_add_f32 v23, v23, v115
    v_cvt_pk_bf16_f32 v116, v20, v21
    v_cvt_pk_bf16_f32 v117, v22, v23
    buffer_store_dwordx2 v[116:117], v108, s[56:59], s66 offen offset:64
    v_lshlrev_b32 v112, 16, v116
    v_and_b32 v113, 0xffff0000, v116
    v_lshlrev_b32 v114, 16, v117
    v_and_b32 v115, 0xffff0000, v117
    v_add_f32 v118, v118, v112
    v_fmac_f32 v119, v112, v112
    v_add_f32 v118, v118, v113
    v_fmac_f32 v119, v113, v113
    v_add_f32 v118, v118, v114
    v_fmac_f32 v119, v114, v114
    v_add_f32 v118, v118, v115
    v_fmac_f32 v119, v115, v115
    s_nop 1
    v_cvt_pk_bf16_f32 v109, v24, v25
    v_lshlrev_b32 v24, 16, v109
    v_and_b32 v25, 0xffff0000, v109
    v_cvt_pk_bf16_f32 v110, v26, v27
    v_lshlrev_b32 v26, 16, v110
    v_and_b32 v27, 0xffff0000, v110
    v_lshlrev_b32 v112, 16, v98
    v_and_b32 v113, 0xffff0000, v98
    v_lshlrev_b32 v114, 16, v99
    v_and_b32 v115, 0xffff0000, v99
    v_add_f32 v24, v24, v112
    v_add_f32 v25, v25, v113
    v_add_f32 v26, v26, v114
    v_add_f32 v27, v27, v115
    v_cvt_pk_bf16_f32 v116, v24, v25
    v_cvt_pk_bf16_f32 v117, v26, v27
    buffer_store_dwordx2 v[116:117], v108, s[56:59], s66 offen offset:80
    v_lshlrev_b32 v112, 16, v116
    v_and_b32 v113, 0xffff0000, v116
    v_lshlrev_b32 v114, 16, v117
    v_and_b32 v115, 0xffff0000, v117
    v_add_f32 v118, v118, v112
    v_fmac_f32 v119, v112, v112
    v_add_f32 v118, v118, v113
    v_fmac_f32 v119, v113, v113
    v_add_f32 v118, v118, v114
    v_fmac_f32 v119, v114, v114
    v_add_f32 v118, v118, v115
    v_fmac_f32 v119, v115, v115
    s_nop 1
    v_cvt_pk_bf16_f32 v109, v28, v29
    v_lshlrev_b32 v28, 16, v109
    v_and_b32 v29, 0xffff0000, v109
    v_cvt_pk_bf16_f32 v110, v30, v31
    v_lshlrev_b32 v30, 16, v110
    v_and_b32 v31, 0xffff0000, v110
    v_lshlrev_b32 v112, 16, v100
    v_and_b32 v113, 0xffff0000, v100
    v_lshlrev_b32 v114, 16, v101
    v_and_b32 v115, 0xffff0000, v101
    v_add_f32 v28, v28, v112
    v_add_f32 v29, v29, v113
    v_add_f32 v30, v30, v114
    v_add_f32 v31, v31, v115
    v_cvt_pk_bf16_f32 v116, v28, v29
    v_cvt_pk_bf16_f32 v117, v30, v31
    buffer_store_dwordx2 v[116:117], v108, s[56:59], s66 offen offset:96
    v_lshlrev_b32 v112, 16, v116
    v_and_b32 v113, 0xffff0000, v116
    v_lshlrev_b32 v114, 16, v117
    v_and_b32 v115, 0xffff0000, v117
    v_add_f32 v118, v118, v112
    v_fmac_f32 v119, v112, v112
    v_add_f32 v118, v118, v113
    v_fmac_f32 v119, v113, v113
    v_add_f32 v118, v118, v114
    v_fmac_f32 v119, v114, v114
    v_add_f32 v118, v118, v115
    v_fmac_f32 v119, v115, v115
    s_nop 1
    v_cvt_pk_bf16_f32 v109, v32, v33
    v_lshlrev_b32 v32, 16, v109
    v_and_b32 v33, 0xffff0000, v109
    v_cvt_pk_bf16_f32 v110, v34, v35
    v_lshlrev_b32 v34, 16, v110
    v_and_b32 v35, 0xffff0000, v110
    v_lshlrev_b32 v112, 16, v102
    v_and_b32 v113, 0xffff0000, v102
    v_lshlrev_b32 v114, 16, v103
    v_and_b32 v115, 0xffff0000, v103
    v_add_f32 v32, v32, v112
    v_add_f32 v33, v33, v113
    v_add_f32 v34, v34, v114
    v_add_f32 v35, v35, v115
    v_cvt_pk_bf16_f32 v116, v32, v33
    v_cvt_pk_bf16_f32 v117, v34, v35
    buffer_store_dwordx2 v[116:117], v108, s[56:59], s66 offen offset:112
    v_lshlrev_b32 v112, 16, v116
    v_and_b32 v113, 0xffff0000, v116
    v_lshlrev_b32 v114, 16, v117
    v_and_b32 v115, 0xffff0000, v117
    v_add_f32 v118, v118, v112
    v_fmac_f32 v119, v112, v112
    v_add_f32 v118, v118, v113
    v_fmac_f32 v119, v113, v113
    v_add_f32 v118, v118, v114
    v_fmac_f32 v119, v114, v114
    v_add_f32 v118, v118, v115
    v_fmac_f32 v119, v115, v115
    s_nop 1
    v_mov_b32 v120, v118
    v_mov_b32 v121, v119
    s_nop 1
    v_permlane32_swap_b32 v118, v120
    v_permlane32_swap_b32 v119, v121
    s_nop 1
    v_add_f32 v118, v118, v120
    v_add_f32 v119, v119, v121
    v_mul_u32_u24 v107, 80, v107
    s_lshr_b32 s65, s62, 6
    s_add_u32 s65, s65, s68
    s_lshl_b32 s65, s65, 3
    v_cmp_gt_u32 vcc, 32, v76
    s_and_saveexec_b64 s[76:77], vcc
    buffer_store_dwordx2 v[118:119], v107, s[80:83], s65 offen
    s_or_b64 exec, exec, s[76:77]
.k2p0_kernel_end:
    s_endpgm

.globl k3p0_kernel
.p2align 8
.type k3p0_kernel,@function
k3p0_kernel:
    s_cmp_ge_u32 s2, 224
    s_cbranch_scc1 .k3p0_kernel_end
    s_load_dwordx16 s[16:31], s[0:1], 0
    s_load_dwordx4 s[32:35], s[0:1], 64
    s_load_dwordx2 s[36:37], s[0:1], 80
    s_waitcnt lgkmcnt(0)
    s_and_b32 s61, s2, 15
    s_lshl_b32 s61, s61, 7
    s_lshr_b32 s62, s2, 4
    s_lshl_b32 s62, s62, 7
    s_add_u32 s40, s36, 11329536
    s_addc_u32 s41, s37, 0
    s_and_b32 s41, s41, 0xffff
    s_mov_b32 s42, 2621440
    s_mov_b32 s43, 0x00020000
    s_add_u32 s44, s36, 3276800
    s_addc_u32 s45, s37, 0
    s_and_b32 s45, s45, 0xffff
    s_mov_b32 s46, 2211840
    s_mov_b32 s47, 0x00020000
    v_and_b32 v124, 63, v0
    v_lshrrev_b32 v125, 6, v0
    s_nop 0
    v_readfirstlane_b32 s60, v125
    s_nop 1
    s_mul_i32 s63, s60, 4096
    s_mul_i32 s64, s60, 4096
    s_mul_i32 s65, s60, 32
    s_add_u32 s65, s65, 0
    v_lshrrev_b32 v125, 3, v124
    v_add_u32 v125, s65, v125
    v_lshrrev_b32 v126, 1, v125
    v_and_b32 v126, 7, v126
    v_and_b32 v100, 7, v124
    v_xor_b32 v126, v100, v126
    v_lshlrev_b32 v126, 4, v126
    v_add_u32 v125, s61, v125
    s_mov_b32 s66, 1280
    v_mul_lo_u32 v125, v125, s66
    v_add_u32 v100, v125, v126
    s_mul_i32 s65, s60, 32
    s_add_u32 s65, s65, 8
    v_lshrrev_b32 v125, 3, v124
    v_add_u32 v125, s65, v125
    v_lshrrev_b32 v126, 1, v125
    v_and_b32 v126, 7, v126
    v_and_b32 v101, 7, v124
    v_xor_b32 v126, v101, v126
    v_lshlrev_b32 v126, 4, v126
    v_add_u32 v125, s61, v125
    s_mov_b32 s66, 1280
    v_mul_lo_u32 v125, v125, s66
    v_add_u32 v101, v125, v126
    s_mul_i32 s65, s60, 32
    s_add_u32 s65, s65, 16
    v_lshrrev_b32 v125, 3, v124
    v_add_u32 v125, s65, v125
    v_lshrrev_b32 v126, 1, v125
    v_and_b32 v126, 7, v126
    v_and_b32 v102, 7, v124
    v_xor_b32 v126, v102, v126
    v_lshlrev_b32 v126, 4, v126
    v_add_u32 v125, s61, v125
    s_mov_b32 s66, 1280
    v_mul_lo_u32 v125, v125, s66
    v_add_u32 v102, v125, v126
    s_mul_i32 s65, s60, 32
    s_add_u32 s65, s65, 24
    v_lshrrev_b32 v125, 3, v124
    v_add_u32 v125, s65, v125
    v_lshrrev_b32 v126, 1, v125
    v_and_b32 v126, 7, v126
    v_and_b32 v103, 7, v124
    v_xor_b32 v126, v103, v126
    v_lshlrev_b32 v126, 4, v126
    v_add_u32 v125, s61, v125
    s_mov_b32 s66, 1280
    v_mul_lo_u32 v125, v125, s66
    v_add_u32 v103, v125, v126
    s_mul_i32 s65, s60, 32
    s_add_u32 s65, s65, 0
    v_lshrrev_b32 v125, 3, v124
    v_add_u32 v125, s65, v125
    v_lshrrev_b32 v126, 1, v125
    v_and_b32 v126, 7, v126
    v_and_b32 v104, 7, v124
    v_xor_b32 v126, v104, v126
    v_lshlrev_b32 v126, 4, v126
    v_add_u32 v125, s62, v125
    s_mov_b32 s66, 1280
    v_mul_lo_u32 v125, v125, s66
    v_add_u32 v104, v125, v126
    s_mul_i32 s65, s60, 32
    s_add_u32 s65, s65, 8
    v_lshrrev_b32 v125, 3, v124
    v_add_u32 v125, s65, v125
    v_lshrrev_b32 v126, 1, v125
    v_and_b32 v126, 7, v126
    v_and_b32 v105, 7, v124
    v_xor_b32 v126, v105, v126
    v_lshlrev_b32 v126, 4, v126
    v_add_u32 v125, s62, v125
    s_mov_b32 s66, 1280
    v_mul_lo_u32 v125, v125, s66
    v_add_u32 v105, v125, v126
    s_mul_i32 s65, s60, 32
    s_add_u32 s65, s65, 16
    v_lshrrev_b32 v125, 3, v124
    v_add_u32 v125, s65, v125
    v_lshrrev_b32 v126, 1, v125
    v_and_b32 v126, 7, v126
    v_and_b32 v106, 7, v124
    v_xor_b32 v126, v106, v126
    v_lshlrev_b32 v126, 4, v126
    v_add_u32 v125, s62, v125
    s_mov_b32 s66, 1280
    v_mul_lo_u32 v125, v125, s66
    v_add_u32 v106, v125, v126
    s_mul_i32 s65, s60, 32
    s_add_u32 s65, s65, 24
    v_lshrrev_b32 v125, 3, v124
    v_add_u32 v125, s65, v125
    v_lshrrev_b32 v126, 1, v125
    v_and_b32 v126, 7, v126
    v_and_b32 v107, 7, v124
    v_xor_b32 v126, v107, v126
    v_lshlrev_b32 v126, 4, v126
    v_add_u32 v125, s62, v125
    s_mov_b32 s66, 1280
    v_mul_lo_u32 v125, v125, s66
    v_add_u32 v107, v125, v126
    s_and_b32 s67, s60, 1
    s_lshr_b32 s68, s60, 1
    v_lshrrev_b32 v125, 5, v124
    v_add_u32 v125, 0, v125
    v_lshrrev_b32 v126, 1, v124
    v_and_b32 v126, 7, v126
    v_xor_b32 v125, v125, v126
    v_lshlrev_b32 v125, 4, v125
    v_and_b32 v126, 31, v124
    v_lshl_add_u32 v125, v126, 7, v125
    s_mul_i32 s65, s67, 8192
    v_add_u32 v108, s65, v125
    v_add_u32 v120, 0x10000, v108
    s_mul_i32 s65, s68, 8192
    v_add_u32 v112, s65, v125
    v_add_u32 v116, 0x10000, v112
    v_lshrrev_b32 v125, 5, v124
    v_add_u32 v125, 2, v125
    v_lshrrev_b32 v126, 1, v124
    v_and_b32 v126, 7, v126
    v_xor_b32 v125, v125, v126
    v_lshlrev_b32 v125, 4, v125
    v_and_b32 v126, 31, v124
    v_lshl_add_u32 v125, v126, 7, v125
    s_mul_i32 s65, s67, 8192
    v_add_u32 v109, s65, v125
    v_add_u32 v121, 0x10000, v109
    s_mul_i32 s65, s68, 8192
    v_add_u32 v113, s65, v125
    v_add_u32 v117, 0x10000, v113
    v_lshrrev_b32 v125, 5, v124
    v_add_u32 v125, 4, v125
    v_lshrrev_b32 v126, 1, v124
    v_and_b32 v126, 7, v126
    v_xor_b32 v125, v125, v126
    v_lshlrev_b32 v125, 4, v125
    v_and_b32 v126, 31, v124
    v_lshl_add_u32 v125, v126, 7, v125
    s_mul_i32 s65, s67, 8192
    v_add_u32 v110, s65, v125
    v_add_u32 v122, 0x10000, v110
    s_mul_i32 s65, s68, 8192
    v_add_u32 v114, s65, v125
    v_add_u32 v118, 0x10000, v114
    v_lshrrev_b32 v125, 5, v124
    v_add_u32 v125, 6, v125
    v_lshrrev_b32 v126, 1, v124
    v_and_b32 v126, 7, v126
    v_xor_b32 v125, v125, v126
    v_lshlrev_b32 v125, 4, v125
    v_and_b32 v126, 31, v124
    v_lshl_add_u32 v125, v126, 7, v125
    s_mul_i32 s65, s67, 8192
    v_add_u32 v111, s65, v125
    v_add_u32 v123, 0x10000, v111
    s_mul_i32 s65, s68, 8192
    v_add_u32 v115, s65, v125
    v_add_u32 v119, 0x10000, v115
    v_mov_b32 v4, 0
    v_mov_b32 v5, 0
    v_mov_b32 v6, 0
    v_mov_b32 v7, 0
    v_mov_b32 v8, 0
    v_mov_b32 v9, 0
    v_mov_b32 v10, 0
    v_mov_b32 v11, 0
    v_mov_b32 v12, 0
    v_mov_b32 v13, 0
    v_mov_b32 v14, 0
    v_mov_b32 v15, 0
    v_mov_b32 v16, 0
    v_mov_b32 v17, 0
    v_mov_b32 v18, 0
    v_mov_b32 v19, 0
    v_mov_b32 v20, 0
    v_mov_b32 v21, 0
    v_mov_b32 v22, 0
    v_mov_b32 v23, 0
    v_mov_b32 v24, 0
    v_mov_b32 v25, 0
    v_mov_b32 v26, 0
    v_mov_b32 v27, 0
    v_mov_b32 v28, 0
    v_mov_b32 v29, 0
    v_mov_b32 v30, 0
    v_mov_b32 v31, 0
    v_mov_b32 v32, 0
    v_mov_b32 v33, 0
    v_mov_b32 v34, 0
    v_mov_b32 v35, 0
    v_mov_b32 v36, 0
    v_mov_b32 v37, 0
    v_mov_b32 v38, 0
    v_mov_b32 v39, 0
    v_mov_b32 v40, 0
    v_mov_b32 v41, 0
    v_mov_b32 v42, 0
    v_mov_b32 v43, 0
    v_mov_b32 v44, 0
    v_mov_b32 v45, 0
    v_mov_b32 v46, 0
    v_mov_b32 v47, 0
    v_mov_b32 v48, 0
    v_mov_b32 v49, 0
    v_mov_b32 v50, 0
    v_mov_b32 v51, 0
    v_mov_b32 v52, 0
    v_mov_b32 v53, 0
    v_mov_b32 v54, 0
    v_mov_b32 v55, 0
    v_mov_b32 v56, 0
    v_mov_b32 v57, 0
    v_mov_b32 v58, 0
    v_mov_b32 v59, 0
    v_mov_b32 v60, 0
    v_mov_b32 v61, 0
    v_mov_b32 v62, 0
    v_mov_b32 v63, 0
    v_mov_b32 v64, 0
    v_mov_b32 v65, 0
    v_mov_b32 v66, 0
    v_mov_b32 v67, 0
    s_mov_b32 s69, 0
    s_add_u32 m0, s63, 1024
    buffer_load_dwordx4 v100, s[40:43], s69 offen lds
    s_add_u32 m0, s63, 2048
    buffer_load_dwordx4 v101, s[40:43], s69 offen lds
    s_add_u32 m0, s63, 3072
    buffer_load_dwordx4 v102, s[40:43], s69 offen lds
    s_add_u32 m0, s63, 4096
    buffer_load_dwordx4 v103, s[40:43], s69 offen lds
    s_add_u32 m0, s64, 17408
    buffer_load_dwordx4 v104, s[44:47], s69 offen lds
    s_add_u32 m0, s64, 18432
    buffer_load_dwordx4 v105, s[44:47], s69 offen lds
    s_add_u32 m0, s64, 19456
    buffer_load_dwordx4 v106, s[44:47], s69 offen lds
    s_add_u32 m0, s64, 20480
    buffer_load_dwordx4 v107, s[44:47], s69 offen lds
    s_mov_b32 s69, 128
    s_add_u32 m0, s63, 33792
    buffer_load_dwordx4 v100, s[40:43], s69 offen lds
    s_add_u32 m0, s63, 34816
    buffer_load_dwordx4 v101, s[40:43], s69 offen lds
    s_add_u32 m0, s63, 35840
    buffer_load_dwordx4 v102, s[40:43], s69 offen lds
    s_add_u32 m0, s63, 36864
    buffer_load_dwordx4 v103, s[40:43], s69 offen lds
    s_add_u32 m0, s64, 50176
    buffer_load_dwordx4 v104, s[44:47], s69 offen lds
    s_add_u32 m0, s64, 51200
    buffer_load_dwordx4 v105, s[44:47], s69 offen lds
    s_add_u32 m0, s64, 52224
    buffer_load_dwordx4 v106, s[44:47], s69 offen lds
    s_add_u32 m0, s64, 53248
    buffer_load_dwordx4 v107, s[44:47], s69 offen lds
    s_add_u32 s72, s36, 7880704
    s_addc_u32 s73, s37, 0
    s_and_b32 s73, s73, 0xffff
    s_mov_b32 s74, 163840
    s_mov_b32 s75, 0x00020000
    v_cmp_gt_u32 vcc, 128, v0
    s_and_saveexec_b64 s[76:77], vcc
    s_cbranch_execz .st_10
    v_add_u32 v88, s61, v0
    v_mul_u32_u24 v88, 80, v88
    buffer_load_dwordx4 v[68:71], v88, s[72:75], 0 offen offset:0
    buffer_load_dwordx4 v[72:75], v88, s[72:75], 0 offen offset:16
    buffer_load_dwordx4 v[76:79], v88, s[72:75], 0 offen offset:32
    buffer_load_dwordx4 v[80:83], v88, s[72:75], 0 offen offset:48
    buffer_load_dwordx4 v[84:87], v88, s[72:75], 0 offen offset:64
    s_waitcnt vmcnt(0)
    v_add_f32 v88, v68, v70
    v_add_f32 v89, v69, v71
    v_add_f32 v88, v88, v72
    v_add_f32 v89, v89, v73
    v_add_f32 v88, v88, v74
    v_add_f32 v89, v89, v75
    v_add_f32 v88, v88, v76
    v_add_f32 v89, v89, v77
    v_add_f32 v88, v88, v78
    v_add_f32 v89, v89, v79
    v_add_f32 v88, v88, v80
    v_add_f32 v89, v89, v81
    v_add_f32 v88, v88, v82
    v_add_f32 v89, v89, v83
    v_add_f32 v88, v88, v84
    v_add_f32 v89, v89, v85
    v_add_f32 v88, v88, v86
    v_add_f32 v89, v89, v87
    v_mul_f32 v88, 0x3acccccd, v88
    v_mul_f32 v89, 0x3acccccd, v89
    v_fma_f32 v89, -v88, v88, v89
    v_max_f32 v89, 0, v89
    v_cvt_pk_bf16_f32 v90, v88, v89
    v_lshlrev_b32 v88, 16, v90
    v_and_b32 v89, 0xffff0000, v90
    v_add_f32 v89, 0x3727c5ac, v89
    v_cvt_pk_bf16_f32 v90, v89, v89
    v_lshlrev_b32 v89, 16, v90
    v_sqrt_f32 v89, v89
    s_nop 0
    v_cvt_pk_bf16_f32 v90, v89, v89
    v_lshlrev_b32 v89, 16, v90
    v_rcp_f32 v89, v89
    v_lshlrev_b32 v90, 3, v0
    s_nop 0
    ds_write_b64 v90, v[88:89] offset:0
.st_10:
    s_or_b64 exec, exec, s[76:77]
    s_add_u32 s48, s36, 7708672
    s_addc_u32 s49, s37, 0
    s_and_b32 s49, s49, 0xffff
    s_mov_b32 s50, 6912
    s_mov_b32 s51, 0x00020000
    s_mov_b32 s52, s26
    s_mov_b32 s53, s27
    s_and_b32 s53, s53, 0xffff
    s_mov_b32 s54, 3456
    s_mov_b32 s55, 0x00020000
    s_add_u32 s56, s36, 19193856
    s_addc_u32 s57, s37, 0
    s_and_b32 s57, s57, 0xffff
    s_mov_b32 s58, 7077888
    s_mov_b32 s59, 0x00020000
    v_lshrrev_b32 v176, 5, v124
    v_lshlrev_b32 v176, 2, v176
    s_lshl_b32 s65, s68, 6
    v_add_u32 v176, s65, v176
    v_lshlrev_b32 v177, 2, v176
    s_lshl_b32 s65, s62, 2
    s_lshl_b32 s66, s62, 1
    buffer_load_dwordx4 v[128:131], v177, s[48:51], s65 offen offset:0
    buffer_load_dwordx4 v[132:135], v177, s[48:51], s65 offen offset:32
    buffer_load_dwordx4 v[136:139], v177, s[48:51], s65 offen offset:64
    buffer_load_dwordx4 v[140:143], v177, s[48:51], s65 offen offset:96
    buffer_load_dwordx4 v[144:147], v177, s[48:51], s65 offen offset:128
    buffer_load_dwordx4 v[148:151], v177, s[48:51], s65 offen offset:160
    buffer_load_dwordx4 v[152:155], v177, s[48:51], s65 offen offset:192
    buffer_load_dwordx4 v[156:159], v177, s[48:51], s65 offen offset:224
    v_lshlrev_b32 v177, 1, v176
    buffer_load_dwordx2 v[160:161], v177, s[52:55], s66 offen offset:0
    buffer_load_dwordx2 v[162:163], v177, s[52:55], s66 offen offset:16
    buffer_load_dwordx2 v[164:165], v177, s[52:55], s66 offen offset:32
    buffer_load_dwordx2 v[166:167], v177, s[52:55], s66 offen offset:48
    buffer_load_dwordx2 v[168:169], v177, s[52:55], s66 offen offset:64
    buffer_load_dwordx2 v[170:171], v177, s[52:55], s66 offen offset:80
    buffer_load_dwordx2 v[172:173], v177, s[52:55], s66 offen offset:96
    buffer_load_dwordx2 v[174:175], v177, s[52:55], s66 offen offset:112
    s_waitcnt vmcnt(29)
    s_barrier
    s_mov_b32 s69, 256
    s_add_u32 m0, s63, 66560
    buffer_load_dwordx4 v100, s[40:43], s69 offen lds
    s_add_u32 m0, s63, 67584
    buffer_load_dwordx4 v101, s[40:43], s69 offen lds
    s_add_u32 m0, s63, 68608
    buffer_load_dwordx4 v102, s[40:43], s69 offen lds
    s_add_u32 m0, s63, 69632
    buffer_load_dwordx4 v103, s[40:43], s69 offen lds
    s_add_u32 m0, s64, 82944
    buffer_load_dwordx4 v104, s[44:47], s69 offen lds
    s_add_u32 m0, s64, 83968
    buffer_load_dwordx4 v105, s[44:47], s69 offen lds
    s_add_u32 m0, s64, 84992
    buffer_load_dwordx4 v106, s[44:47], s69 offen lds
    s_add_u32 m0, s64, 86016
    buffer_load_dwordx4 v107, s[44:47], s69 offen lds
    ds_read_b128 v[68:71], v108 offset:1024
    ds_read_b128 v[72:75], v108 offset:5120
    ds_read_b128 v[84:87], v112 offset:17408
    ds_read_b128 v[88:91], v112 offset:21504
    ds_read_b128 v[76:79], v109 offset:1024
    ds_read_b128 v[80:83], v109 offset:5120
    ds_read_b128 v[92:95], v113 offset:17408
    ds_read_b128 v[96:99], v113 offset:21504
    s_waitcnt lgkmcnt(4)
    v_mfma_f32_32x32x16_bf16 v[4:19], v[84:87], v[68:71], v[4:19]
    v_mfma_f32_32x32x16_bf16 v[20:35], v[88:91], v[68:71], v[20:35]
    v_mfma_f32_32x32x16_bf16 v[36:51], v[84:87], v[72:75], v[36:51]
    v_mfma_f32_32x32x16_bf16 v[52:67], v[88:91], v[72:75], v[52:67]
    ds_read_b128 v[68:71], v110 offset:1024
    ds_read_b128 v[72:75], v110 offset:5120
    ds_read_b128 v[84:87], v114 offset:17408
    ds_read_b128 v[88:91], v114 offset:21504
    s_waitcnt lgkmcnt(4)
    v_mfma_f32_32x32x16_bf16 v[4:19], v[92:95], v[76:79], v[4:19]
    v_mfma_f32_32x32x16_bf16 v[20:35], v[96:99], v[76:79], v[20:35]
    v_mfma_f32_32x32x16_bf16 v[36:51], v[92:95], v[80:83], v[36:51]
    v_mfma_f32_32x32x16_bf16 v[52:67], v[96:99], v[80:83], v[52:67]
    ds_read_b128 v[76:79], v111 offset:1024
    ds_read_b128 v[80:83], v111 offset:5120
    ds_read_b128 v[92:95], v115 offset:17408
    ds_read_b128 v[96:99], v115 offset:21504
    s_waitcnt lgkmcnt(4)
    v_mfma_f32_32x32x16_bf16 v[4:19], v[84:87], v[68:71], v[4:19]
    v_mfma_f32_32x32x16_bf16 v[20:35], v[88:91], v[68:71], v[20:35]
    v_mfma_f32_32x32x16_bf16 v[36:51], v[84:87], v[72:75], v[36:51]
    v_mfma_f32_32x32x16_bf16 v[52:67], v[88:91], v[72:75], v[52:67]
    s_waitcnt vmcnt(29) lgkmcnt(0)
    s_barrier
    s_mov_b32 s69, 384
    s_add_u32 m0, s63, 1024
    buffer_load_dwordx4 v100, s[40:43], s69 offen lds
    s_add_u32 m0, s63, 2048
    buffer_load_dwordx4 v101, s[40:43], s69 offen lds
    s_add_u32 m0, s63, 3072
    buffer_load_dwordx4 v102, s[40:43], s69 offen lds
    s_add_u32 m0, s63, 4096
    buffer_load_dwordx4 v103, s[40:43], s69 offen lds
    s_add_u32 m0, s64, 17408
    buffer_load_dwordx4 v104, s[44:47], s69 offen lds
    s_add_u32 m0, s64, 18432
    buffer_load_dwordx4 v105, s[44:47], s69 offen lds
    s_add_u32 m0, s64, 19456
    buffer_load_dwordx4 v106, s[44:47], s69 offen lds
    s_add_u32 m0, s64, 20480
    buffer_load_dwordx4 v107, s[44:47], s69 offen lds
    ds_read_b128 v[68:71], v108 offset:33792
    ds_read_b128 v[72:75], v108 offset:37888
    ds_read_b128 v[84:87], v112 offset:50176
    ds_read_b128 v[88:91], v112 offset:54272
    v_mfma_f32_32x32x16_bf16 v[4:19], v[92:95], v[76:79], v[4:19]
    v_mfma_f32_32x32x16_bf16 v[20:35], v[96:99], v[76:79], v[20:35]
    v_mfma_f32_32x32x16_bf16 v[36:51], v[92:95], v[80:83], v[36:51]
    v_mfma_f32_32x32x16_bf16 v[52:67], v[96:99], v[80:83], v[52:67]
    ds_read_b128 v[76:79], v109 offset:33792
    ds_read_b128 v[80:83], v109 offset:37888
    ds_read_b128 v[92:95], v113 offset:50176
    ds_read_b128 v[96:99], v113 offset:54272
    s_waitcnt lgkmcnt(4)
    v_mfma_f32_32x32x16_bf16 v[4:19], v[84:87], v[68:71], v[4:19]
    v_mfma_f32_32x32x16_bf16 v[20:35], v[88:91], v[68:71], v[20:35]
    v_mfma_f32_32x32x16_bf16 v[36:51], v[84:87], v[72:75], v[36:51]
    v_mfma_f32_32x32x16_bf16 v[52:67], v[88:91], v[72:75], v[52:67]
    ds_read_b128 v[68:71], v110 offset:33792
    ds_read_b128 v[72:75], v110 offset:37888
    ds_read_b128 v[84:87], v114 offset:50176
    ds_read_b128 v[88:91], v114 offset:54272
    s_waitcnt lgkmcnt(4)
    v_mfma_f32_32x32x16_bf16 v[4:19], v[92:95], v[76:79], v[4:19]
    v_mfma_f32_32x32x16_bf16 v[20:35], v[96:99], v[76:79], v[20:35]
    v_mfma_f32_32x32x16_bf16 v[36:51], v[92:95], v[80:83], v[36:51]
    v_mfma_f32_32x32x16_bf16 v[52:67], v[96:99], v[80:83], v[52:67]
    ds_read_b128 v[76:79], v111 offset:33792
    ds_read_b128 v[80:83], v111 offset:37888
    ds_read_b128 v[92:95], v115 offset:50176
    ds_read_b128 v[96:99], v115 offset:54272
    s_waitcnt lgkmcnt(4)
    v_mfma_f32_32x32x16_bf16 v[4:19], v[84:87], v[68:71], v[4:19]
    v_mfma_f32_32x32x16_bf16 v[20:35], v[88:91], v[68:71], v[20:35]
    v_mfma_f32_32x32x16_bf16 v[36:51], v[84:87], v[72:75], v[36:51]
    v_mfma_f32_32x32x16_bf16 v[52:67], v[88:91], v[72:75], v[52:67]
    s_waitcnt vmcnt(8) lgkmcnt(0)
    s_barrier
    s_mov_b32 s69, 512
    s_add_u32 m0, s63, 33792
    buffer_load_dwordx4 v100, s[40:43], s69 offen lds
    s_add_u32 m0, s63, 34816
    buffer_load_dwordx4 v101, s[40:43], s69 offen lds
    s_add_u32 m0, s63, 35840
    buffer_load_dwordx4 v102, s[40:43], s69 offen lds
    s_add_u32 m0, s63, 36864
    buffer_load_dwordx4 v103, s[40:43], s69 offen lds
    s_add_u32 m0, s64, 50176
    buffer_load_dwordx4 v104, s[44:47], s69 offen lds
    s_add_u32 m0, s64, 51200
    buffer_load_dwordx4 v105, s[44:47], s69 offen lds
    s_add_u32 m0, s64, 52224
    buffer_load_dwordx4 v106, s[44:47], s69 offen lds
    s_add_u32 m0, s64, 53248
    buffer_load_dwordx4 v107, s[44:47], s69 offen lds
    ds_read_b128 v[68:71], v120 offset:1024
    ds_read_b128 v[72:75], v120 offset:5120
    ds_read_b128 v[84:87], v116 offset:17408
    ds_read_b128 v[88:91], v116 offset:21504
    v_mfma_f32_32x32x16_bf16 v[4:19], v[92:95], v[76:79], v[4:19]
    v_mfma_f32_32x32x16_bf16 v[20:35], v[96:99], v[76:79], v[20:35]
    v_mfma_f32_32x32x16_bf16 v[36:51], v[92:95], v[80:83], v[36:51]
    v_mfma_f32_32x32x16_bf16 v[52:67], v[96:99], v[80:83], v[52:67]
    ds_read_b128 v[76:79], v121 offset:1024
    ds_read_b128 v[80:83], v121 offset:5120
    ds_read_b128 v[92:95], v117 offset:17408
    ds_read_b128 v[96:99], v117 offset:21504
    s_waitcnt lgkmcnt(4)
    v_mfma_f32_32x32x16_bf16 v[4:19], v[84:87], v[68:71], v[4:19]
    v_mfma_f32_32x32x16_bf16 v[20:35], v[88:91], v[68:71], v[20:35]
    v_mfma_f32_32x32x16_bf16 v[36:51], v[84:87], v[72:75], v[36:51]
    v_mfma_f32_32x32x16_bf16 v[52:67], v[88:91], v[72:75], v[52:67]
    ds_read_b128 v[68:71], v122 offset:1024
    ds_read_b128 v[72:75], v122 offset:5120
    ds_read_b128 v[84:87], v118 offset:17408
    ds_read_b128 v[88:91], v118 offset:21504
    s_waitcnt lgkmcnt(4)
    v_mfma_f32_32x32x16_bf16 v[4:19], v[92:95], v[76:79], v[4:19]
    v_mfma_f32_32x32x16_bf16 v[20:35], v[96:99], v[76:79], v[20:35]
    v_mfma_f32_32x32x16_bf16 v[36:51], v[92:95], v[80:83], v[36:51]
    v_mfma_f32_32x32x16_bf16 v[52:67], v[96:99], v[80:83], v[52:67]
    ds_read_b128 v[76:79], v123 offset:1024
    ds_read_b128 v[80:83], v123 offset:5120
    ds_read_b128 v[92:95], v119 offset:17408
    ds_read_b128 v[96:99], v119 offset:21504
    s_waitcnt lgkmcnt(4)
    v_mfma_f32_32x32x16_bf16 v[4:19], v[84:87], v[68:71], v[4:19]
    v_mfma_f32_32x32x16_bf16 v[20:35], v[88:91], v[68:71], v[20:35]
    v_mfma_f32_32x32x16_bf16 v[36:51], v[84:87], v[72:75], v[36:51]
    v_mfma_f32_32x32x16_bf16 v[52:67], v[88:91], v[72:75], v[52:67]
    s_waitcnt vmcnt(8) lgkmcnt(0)
    s_barrier
    s_mov_b32 s69, 640
    s_add_u32 m0, s63, 66560
    buffer_load_dwordx4 v100, s[40:43], s69 offen lds
    s_add_u32 m0, s63, 67584
    buffer_load_dwordx4 v101, s[40:43], s69 offen lds
    s_add_u32 m0, s63, 68608
    buffer_load_dwordx4 v102, s[40:43], s69 offen lds
    s_add_u32 m0, s63, 69632
    buffer_load_dwordx4 v103, s[40:43], s69 offen lds
    s_add_u32 m0, s64, 82944
    buffer_load_dwordx4 v104, s[44:47], s69 offen lds
    s_add_u32 m0, s64, 83968
    buffer_load_dwordx4 v105, s[44:47], s69 offen lds
    s_add_u32 m0, s64, 84992
    buffer_load_dwordx4 v106, s[44:47], s69 offen lds
    s_add_u32 m0, s64, 86016
    buffer_load_dwordx4 v107, s[44:47], s69 offen lds
    ds_read_b128 v[68:71], v108 offset:1024
    ds_read_b128 v[72:75], v108 offset:5120
    ds_read_b128 v[84:87], v112 offset:17408
    ds_read_b128 v[88:91], v112 offset:21504
    v_mfma_f32_32x32x16_bf16 v[4:19], v[92:95], v[76:79], v[4:19]
    v_mfma_f32_32x32x16_bf16 v[20:35], v[96:99], v[76:79], v[20:35]
    v_mfma_f32_32x32x16_bf16 v[36:51], v[92:95], v[80:83], v[36:51]
    v_mfma_f32_32x32x16_bf16 v[52:67], v[96:99], v[80:83], v[52:67]
    ds_read_b128 v[76:79], v109 offset:1024
    ds_read_b128 v[80:83], v109 offset:5120
    ds_read_b128 v[92:95], v113 offset:17408
    ds_read_b128 v[96:99], v113 offset:21504
    s_waitcnt lgkmcnt(4)
    v_mfma_f32_32x32x16_bf16 v[4:19], v[84:87], v[68:71], v[4:19]
    v_mfma_f32_32x32x16_bf16 v[20:35], v[88:91], v[68:71], v[20:35]
    v_mfma_f32_32x32x16_bf16 v[36:51], v[84:87], v[72:75], v[36:51]
    v_mfma_f32_32x32x16_bf16 v[52:67], v[88:91], v[72:75], v[52:67]
    ds_read_b128 v[68:71], v110 offset:1024
    ds_read_b128 v[72:75], v110 offset:5120
    ds_read_b128 v[84:87], v114 offset:17408
    ds_read_b128 v[88:91], v114 offset:21504
    s_waitcnt lgkmcnt(4)
    v_mfma_f32_32x32x16_bf16 v[4:19], v[92:95], v[76:79], v[4:19]
    v_mfma_f32_32x32x16_bf16 v[20:35], v[96:99], v[76:79], v[20:35]
    v_mfma_f32_32x32x16_bf16 v[36:51], v[92:95], v[80:83], v[36:51]
    v_mfma_f32_32x32x16_bf16 v[52:67], v[96:99], v[80:83], v[52:67]
    ds_read_b128 v[76:79], v111 offset:1024
    ds_read_b128 v[80:83], v111 offset:5120
    ds_read_b128 v[92:95], v115 offset:17408
    ds_read_b128 v[96:99], v115 offset:21504
    s_waitcnt lgkmcnt(4)
    v_mfma_f32_32x32x16_bf16 v[4:19], v[84:87], v[68:71], v[4:19]
    v_mfma_f32_32x32x16_bf16 v[20:35], v[88:91], v[68:71], v[20:35]
    v_mfma_f32_32x32x16_bf16 v[36:51], v[84:87], v[72:75], v[36:51]
    v_mfma_f32_32x32x16_bf16 v[52:67], v[88:91], v[72:75], v[52:67]
    s_waitcnt vmcnt(8) lgkmcnt(0)
    s_barrier
    s_mov_b32 s69, 768
    s_add_u32 m0, s63, 1024
    buffer_load_dwordx4 v100, s[40:43], s69 offen lds
    s_add_u32 m0, s63, 2048
    buffer_load_dwordx4 v101, s[40:43], s69 offen lds
    s_add_u32 m0, s63, 3072
    buffer_load_dwordx4 v102, s[40:43], s69 offen lds
    s_add_u32 m0, s63, 4096
    buffer_load_dwordx4 v103, s[40:43], s69 offen lds
    s_add_u32 m0, s64, 17408
    buffer_load_dwordx4 v104, s[44:47], s69 offen lds
    s_add_u32 m0, s64, 18432
    buffer_load_dwordx4 v105, s[44:47], s69 offen lds
    s_add_u32 m0, s64, 19456
    buffer_load_dwordx4 v106, s[44:47], s69 offen lds
    s_add_u32 m0, s64, 20480
    buffer_load_dwordx4 v107, s[44:47], s69 offen lds
    ds_read_b128 v[68:71], v108 offset:33792
    ds_read_b128 v[72:75], v108 offset:37888
    ds_read_b128 v[84:87], v112 offset:50176
    ds_read_b128 v[88:91], v112 offset:54272
    v_mfma_f32_32x32x16_bf16 v[4:19], v[92:95], v[76:79], v[4:19]
    v_mfma_f32_32x32x16_bf16 v[20:35], v[96:99], v[76:79], v[20:35]
    v_mfma_f32_32x32x16_bf16 v[36:51], v[92:95], v[80:83], v[36:51]
    v_mfma_f32_32x32x16_bf16 v[52:67], v[96:99], v[80:83], v[52:67]
    ds_read_b128 v[76:79], v109 offset:33792
    ds_read_b128 v[80:83], v109 offset:37888
    ds_read_b128 v[92:95], v113 offset:50176
    ds_read_b128 v[96:99], v113 offset:54272
    s_waitcnt lgkmcnt(4)
    v_mfma_f32_32x32x16_bf16 v[4:19], v[84:87], v[68:71], v[4:19]
    v_mfma_f32_32x32x16_bf16 v[20:35], v[88:91], v[68:71], v[20:35]
    v_mfma_f32_32x32x16_bf16 v[36:51], v[84:87], v[72:75], v[36:51]
    v_mfma_f32_32x32x16_bf16 v[52:67], v[88:91], v[72:75], v[52:67]
    ds_read_b128 v[68:71], v110 offset:33792
    ds_read_b128 v[72:75], v110 offset:37888
    ds_read_b128 v[84:87], v114 offset:50176
    ds_read_b128 v[88:91], v114 offset:54272
    s_waitcnt lgkmcnt(4)
    v_mfma_f32_32x32x16_bf16 v[4:19], v[92:95], v[76:79], v[4:19]
    v_mfma_f32_32x32x16_bf16 v[20:35], v[96:99], v[76:79], v[20:35]
    v_mfma_f32_32x32x16_bf16 v[36:51], v[92:95], v[80:83], v[36:51]
    v_mfma_f32_32x32x16_bf16 v[52:67], v[96:99], v[80:83], v[52:67]
    ds_read_b128 v[76:79], v111 offset:33792
    ds_read_b128 v[80:83], v111 offset:37888
    ds_read_b128 v[92:95], v115 offset:50176
    ds_read_b128 v[96:99], v115 offset:54272
    s_waitcnt lgkmcnt(4)
    v_mfma_f32_32x32x16_bf16 v[4:19], v[84:87], v[68:71], v[4:19]
    v_mfma_f32_32x32x16_bf16 v[20:35], v[88:91], v[68:71], v[20:35]
    v_mfma_f32_32x32x16_bf16 v[36:51], v[84:87], v[72:75], v[36:51]
    v_mfma_f32_32x32x16_bf16 v[52:67], v[88:91], v[72:75], v[52:67]
    s_waitcnt vmcnt(8) lgkmcnt(0)
    s_barrier
    s_mov_b32 s69, 896
    s_add_u32 m0, s63, 33792
    buffer_load_dwordx4 v100, s[40:43], s69 offen lds
    s_add_u32 m0, s63, 34816
    buffer_load_dwordx4 v101, s[40:43], s69 offen lds
    s_add_u32 m0, s63, 35840
    buffer_load_dwordx4 v102, s[40:43], s69 offen lds
    s_add_u32 m0, s63, 36864
    buffer_load_dwordx4 v103, s[40:43], s69 offen lds
    s_add_u32 m0, s64, 50176
    buffer_load_dwordx4 v104, s[44:47], s69 offen lds
    s_add_u32 m0, s64, 51200
    buffer_load_dwordx4 v105, s[44:47], s69 offen lds
    s_add_u32 m0, s64, 52224
    buffer_load_dwordx4 v106, s[44:47], s69 offen lds
    s_add_u32 m0, s64, 53248
    buffer_load_dwordx4 v107, s[44:47], s69 offen lds
    ds_read_b128 v[68:71], v120 offset:1024
    ds_read_b128 v[72:75], v120 offset:5120
    ds_read_b128 v[84:87], v116 offset:17408
    ds_read_b128 v[88:91], v116 offset:21504
    v_mfma_f32_32x32x16_bf16 v[4:19], v[92:95], v[76:79], v[4:19]
    v_mfma_f32_32x32x16_bf16 v[20:35], v[96:99], v[76:79], v[20:35]
    v_mfma_f32_32x32x16_bf16 v[36:51], v[92:95], v[80:83], v[36:51]
    v_mfma_f32_32x32x16_bf16 v[52:67], v[96:99], v[80:83], v[52:67]
    ds_read_b128 v[76:79], v121 offset:1024
    ds_read_b128 v[80:83], v121 offset:5120
    ds_read_b128 v[92:95], v117 offset:17408
    ds_read_b128 v[96:99], v117 offset:21504
    s_waitcnt lgkmcnt(4)
    v_mfma_f32_32x32x16_bf16 v[4:19], v[84:87], v[68:71], v[4:19]
    v_mfma_f32_32x32x16_bf16 v[20:35], v[88:91], v[68:71], v[20:35]
    v_mfma_f32_32x32x16_bf16 v[36:51], v[84:87], v[72:75], v[36:51]
    v_mfma_f32_32x32x16_bf16 v[52:67], v[88:91], v[72:75], v[52:67]
    ds_read_b128 v[68:71], v122 offset:1024
    ds_read_b128 v[72:75], v122 offset:5120
    ds_read_b128 v[84:87], v118 offset:17408
    ds_read_b128 v[88:91], v118 offset:21504
    s_waitcnt lgkmcnt(4)
    v_mfma_f32_32x32x16_bf16 v[4:19], v[92:95], v[76:79], v[4:19]
    v_mfma_f32_32x32x16_bf16 v[20:35], v[96:99], v[76:79], v[20:35]
    v_mfma_f32_32x32x16_bf16 v[36:51], v[92:95], v[80:83], v[36:51]
    v_mfma_f32_32x32x16_bf16 v[52:67], v[96:99], v[80:83], v[52:67]
    ds_read_b128 v[76:79], v123 offset:1024
    ds_read_b128 v[80:83], v123 offset:5120
    ds_read_b128 v[92:95], v119 offset:17408
    ds_read_b128 v[96:99], v119 offset:21504
    s_waitcnt lgkmcnt(4)
    v_mfma_f32_32x32x16_bf16 v[4:19], v[84:87], v[68:71], v[4:19]
    v_mfma_f32_32x32x16_bf16 v[20:35], v[88:91], v[68:71], v[20:35]
    v_mfma_f32_32x32x16_bf16 v[36:51], v[84:87], v[72:75], v[36:51]
    v_mfma_f32_32x32x16_bf16 v[52:67], v[88:91], v[72:75], v[52:67]
    s_waitcnt vmcnt(8) lgkmcnt(0)
    s_barrier
    s_mov_b32 s69, 1024
    s_add_u32 m0, s63, 66560
    buffer_load_dwordx4 v100, s[40:43], s69 offen lds
    s_add_u32 m0, s63, 67584
    buffer_load_dwordx4 v101, s[40:43], s69 offen lds
    s_add_u32 m0, s63, 68608
    buffer_load_dwordx4 v102, s[40:43], s69 offen lds
    s_add_u32 m0, s63, 69632
    buffer_load_dwordx4 v103, s[40:43], s69 offen lds
    s_add_u32 m0, s64, 82944
    buffer_load_dwordx4 v104, s[44:47], s69 offen lds
    s_add_u32 m0, s64, 83968
    buffer_load_dwordx4 v105, s[44:47], s69 offen lds
    s_add_u32 m0, s64, 84992
    buffer_load_dwordx4 v106, s[44:47], s69 offen lds
    s_add_u32 m0, s64, 86016
    buffer_load_dwordx4 v107, s[44:47], s69 offen lds
    ds_read_b128 v[68:71], v108 offset:1024
    ds_read_b128 v[72:75], v108 offset:5120
    ds_read_b128 v[84:87], v112 offset:17408
    ds_read_b128 v[88:91], v112 offset:21504
    v_mfma_f32_32x32x16_bf16 v[4:19], v[92:95], v[76:79], v[4:19]
    v_mfma_f32_32x32x16_bf16 v[20:35], v[96:99], v[76:79], v[20:35]
    v_mfma_f32_32x32x16_bf16 v[36:51], v[92:95], v[80:83], v[36:51]
    v_mfma_f32_32x32x16_bf16 v[52:67], v[96:99], v[80:83], v[52:67]
    ds_read_b128 v[76:79], v109 offset:1024
    ds_read_b128 v[80:83], v109 offset:5120
    ds_read_b128 v[92:95], v113 offset:17408
    ds_read_b128 v[96:99], v113 offset:21504
    s_waitcnt lgkmcnt(4)
    v_mfma_f32_32x32x16_bf16 v[4:19], v[84:87], v[68:71], v[4:19]
    v_mfma_f32_32x32x16_bf16 v[20:35], v[88:91], v[68:71], v[20:35]
    v_mfma_f32_32x32x16_bf16 v[36:51], v[84:87], v[72:75], v[36:51]
    v_mfma_f32_32x32x16_bf16 v[52:67], v[88:91], v[72:75], v[52:67]
    ds_read_b128 v[68:71], v110 offset:1024
    ds_read_b128 v[72:75], v110 offset:5120
    ds_read_b128 v[84:87], v114 offset:17408
    ds_read_b128 v[88:91], v114 offset:21504
    s_waitcnt lgkmcnt(4)
    v_mfma_f32_32x32x16_bf16 v[4:19], v[92:95], v[76:79], v[4:19]
    v_mfma_f32_32x32x16_bf16 v[20:35], v[96:99], v[76:79], v[20:35]
    v_mfma_f32_32x32x16_bf16 v[36:51], v[92:95], v[80:83], v[36:51]
    v_mfma_f32_32x32x16_bf16 v[52:67], v[96:99], v[80:83], v[52:67]
    ds_read_b128 v[76:79], v111 offset:1024
    ds_read_b128 v[80:83], v111 offset:5120
    ds_read_b128 v[92:95], v115 offset:17408
    ds_read_b128 v[96:99], v115 offset:21504
    s_waitcnt lgkmcnt(4)
    v_mfma_f32_32x32x16_bf16 v[4:19], v[84:87], v[68:71], v[4:19]
    v_mfma_f32_32x32x16_bf16 v[20:35], v[88:91], v[68:71], v[20:35]
    v_mfma_f32_32x32x16_bf16 v[36:51], v[84:87], v[72:75], v[36:51]
    v_mfma_f32_32x32x16_bf16 v[52:67], v[88:91], v[72:75], v[52:67]
    s_waitcnt vmcnt(8) lgkmcnt(0)
    s_barrier
    s_mov_b32 s69, 1152
    s_add_u32 m0, s63, 1024
    buffer_load_dwordx4 v100, s[40:43], s69 offen lds
    s_add_u32 m0, s63, 2048
    buffer_load_dwordx4 v101, s[40:43], s69 offen lds
    s_add_u32 m0, s63, 3072
    buffer_load_dwordx4 v102, s[40:43], s69 offen lds
    s_add_u32 m0, s63, 4096
    buffer_load_dwordx4 v103, s[40:43], s69 offen lds
    s_add_u32 m0, s64, 17408
    buffer_load_dwordx4 v104, s[44:47], s69 offen lds
    s_add_u32 m0, s64, 18432
    buffer_load_dwordx4 v105, s[44:47], s69 offen lds
    s_add_u32 m0, s64, 19456
    buffer_load_dwordx4 v106, s[44:47], s69 offen lds
    s_add_u32 m0, s64, 20480
    buffer_load_dwordx4 v107, s[44:47], s69 offen lds
    ds_read_b128 v[68:71], v108 offset:33792
    ds_read_b128 v[72:75], v108 offset:37888
    ds_read_b128 v[84:87], v112 offset:50176
    ds_read_b128 v[88:91], v112 offset:54272
    v_mfma_f32_32x32x16_bf16 v[4:19], v[92:95], v[76:79], v[4:19]
    v_mfma_f32_32x32x16_bf16 v[20:35], v[96:99], v[76:79], v[20:35]
    v_mfma_f32_32x32x16_bf16 v[36:51], v[92:95], v[80:83], v[36:51]
    v_mfma_f32_32x32x16_bf16 v[52:67], v[96:99], v[80:83], v[52:67]
    ds_read_b128 v[76:79], v109 offset:33792
    ds_read_b128 v[80:83], v109 offset:37888
    ds_read_b128 v[92:95], v113 offset:50176
    ds_read_b128 v[96:99], v113 offset:54272
    s_waitcnt lgkmcnt(4)
    v_mfma_f32_32x32x16_bf16 v[4:19], v[84:87], v[68:71], v[4:19]
    v_mfma_f32_32x32x16_bf16 v[20:35], v[88:91], v[68:71], v[20:35]
    v_mfma_f32_32x32x16_bf16 v[36:51], v[84:87], v[72:75], v[36:51]
    v_mfma_f32_32x32x16_bf16 v[52:67], v[88:91], v[72:75], v[52:67]
    ds_read_b128 v[68:71], v110 offset:33792
    ds_read_b128 v[72:75], v110 offset:37888
    ds_read_b128 v[84:87], v114 offset:50176
    ds_read_b128 v[88:91], v114 offset:54272
    s_waitcnt lgkmcnt(4)
    v_mfma_f32_32x32x16_bf16 v[4:19], v[92:95], v[76:79], v[4:19]
    v_mfma_f32_32x32x16_bf16 v[20:35], v[96:99], v[76:79], v[20:35]
    v_mfma_f32_32x32x16_bf16 v[36:51], v[92:95], v[80:83], v[36:51]
    v_mfma_f32_32x32x16_bf16 v[52:67], v[96:99], v[80:83], v[52:67]
    ds_read_b128 v[76:79], v111 offset:33792
    ds_read_b128 v[80:83], v111 offset:37888
    ds_read_b128 v[92:95], v115 offset:50176
    ds_read_b128 v[96:99], v115 offset:54272
    s_waitcnt lgkmcnt(4)
    v_mfma_f32_32x32x16_bf16 v[4:19], v[84:87], v[68:71], v[4:19]
    v_mfma_f32_32x32x16_bf16 v[20:35], v[88:91], v[68:71], v[20:35]
    v_mfma_f32_32x32x16_bf16 v[36:51], v[84:87], v[72:75], v[36:51]
    v_mfma_f32_32x32x16_bf16 v[52:67], v[88:91], v[72:75], v[52:67]
    s_waitcnt vmcnt(8) lgkmcnt(0)
    s_barrier
    ds_read_b128 v[68:71], v120 offset:1024
    ds_read_b128 v[72:75], v120 offset:5120
    ds_read_b128 v[84:87], v116 offset:17408
    ds_read_b128 v[88:91], v116 offset:21504
    v_mfma_f32_32x32x16_bf16 v[4:19], v[92:95], v[76:79], v[4:19]
    v_mfma_f32_32x32x16_bf16 v[20:35], v[96:99], v[76:79], v[20:35]
    v_mfma_f32_32x32x16_bf16 v[36:51], v[92:95], v[80:83], v[36:51]
    v_mfma_f32_32x32x16_bf16 v[52:67], v[96:99], v[80:83], v[52:67]
    ds_read_b128 v[76:79], v121 offset:1024
    ds_read_b128 v[80:83], v121 offset:5120
    ds_read_b128 v[92:95], v117 offset:17408
    ds_read_b128 v[96:99], v117 offset:21504
    s_waitcnt lgkmcnt(4)
    v_mfma_f32_32x32x16_bf16 v[4:19], v[84:87], v[68:71], v[4:19]
    v_mfma_f32_32x32x16_bf16 v[20:35], v[88:91], v[68:71], v[20:35]
    v_mfma_f32_32x32x16_bf16 v[36:51], v[84:87], v[72:75], v[36:51]
    v_mfma_f32_32x32x16_bf16 v[52:67], v[88:91], v[72:75], v[52:67]
    ds_read_b128 v[68:71], v122 offset:1024
    ds_read_b128 v[72:75], v122 offset:5120
    ds_read_b128 v[84:87], v118 offset:17408
    ds_read_b128 v[88:91], v118 offset:21504
    s_waitcnt lgkmcnt(4)
    v_mfma_f32_32x32x16_bf16 v[4:19], v[92:95], v[76:79], v[4:19]
    v_mfma_f32_32x32x16_bf16 v[20:35], v[96:99], v[76:79], v[20:35]
    v_mfma_f32_32x32x16_bf16 v[36:51], v[92:95], v[80:83], v[36:51]
    v_mfma_f32_32x32x16_bf16 v[52:67], v[96:99], v[80:83], v[52:67]
    ds_read_b128 v[76:79], v123 offset:1024
    ds_read_b128 v[80:83], v123 offset:5120
    ds_read_b128 v[92:95], v119 offset:17408
    ds_read_b128 v[96:99], v119 offset:21504
    s_waitcnt lgkmcnt(4)
    v_mfma_f32_32x32x16_bf16 v[4:19], v[84:87], v[68:71], v[4:19]
    v_mfma_f32_32x32x16_bf16 v[20:35], v[88:91], v[68:71], v[20:35]
    v_mfma_f32_32x32x16_bf16 v[36:51], v[84:87], v[72:75], v[36:51]
    v_mfma_f32_32x32x16_bf16 v[52:67], v[88:91], v[72:75], v[52:67]
    s_waitcnt vmcnt(0) lgkmcnt(0)
    s_barrier
    ds_read_b128 v[68:71], v108 offset:1024
    ds_read_b128 v[72:75], v108 offset:5120
    ds_read_b128 v[84:87], v112 offset:17408
    ds_read_b128 v[88:91], v112 offset:21504
    v_mfma_f32_32x32x16_bf16 v[4:19], v[92:95], v[76:79], v[4:19]
    v_mfma_f32_32x32x16_bf16 v[20:35], v[96:99], v[76:79], v[20:35]
    v_mfma_f32_32x32x16_bf16 v[36:51], v[92:95], v[80:83], v[36:51]
    v_mfma_f32_32x32x16_bf16 v[52:67], v[96:99], v[80:83], v[52:67]
    ds_read_b128 v[76:79], v109 offset:1024
    ds_read_b128 v[80:83], v109 offset:5120
    ds_read_b128 v[92:95], v113 offset:17408
    ds_read_b128 v[96:99], v113 offset:21504
    s_waitcnt lgkmcnt(4)
    v_mfma_f32_32x32x16_bf16 v[4:19], v[84:87], v[68:71], v[4:19]
    v_mfma_f32_32x32x16_bf16 v[20:35], v[88:91], v[68:71], v[20:35]
    v_mfma_f32_32x32x16_bf16 v[36:51], v[84:87], v[72:75], v[36:51]
    v_mfma_f32_32x32x16_bf16 v[52:67], v[88:91], v[72:75], v[52:67]
    ds_read_b128 v[68:71], v110 offset:1024
    ds_read_b128 v[72:75], v110 offset:5120
    ds_read_b128 v[84:87], v114 offset:17408
    ds_read_b128 v[88:91], v114 offset:21504
    s_waitcnt lgkmcnt(4)
    v_mfma_f32_32x32x16_bf16 v[4:19], v[92:95], v[76:79], v[4:19]
    v_mfma_f32_32x32x16_bf16 v[20:35], v[96:99], v[76:79], v[20:35]
    v_mfma_f32_32x32x16_bf16 v[36:51], v[92:95], v[80:83], v[36:51]
    v_mfma_f32_32x32x16_bf16 v[52:67], v[96:99], v[80:83], v[52:67]
    ds_read_b128 v[76:79], v111 offset:1024
    ds_read_b128 v[80:83], v111 offset:5120
    ds_read_b128 v[92:95], v115 offset:17408
    ds_read_b128 v[96:99], v115 offset:21504
    s_waitcnt lgkmcnt(4)
    v_mfma_f32_32x32x16_bf16 v[4:19], v[84:87], v[68:71], v[4:19]
    v_mfma_f32_32x32x16_bf16 v[20:35], v[88:91], v[68:71], v[20:35]
    v_mfma_f32_32x32x16_bf16 v[36:51], v[84:87], v[72:75], v[36:51]
    v_mfma_f32_32x32x16_bf16 v[52:67], v[88:91], v[72:75], v[52:67]
    s_waitcnt lgkmcnt(0)
    v_mfma_f32_32x32x16_bf16 v[4:19], v[92:95], v[76:79], v[4:19]
    v_mfma_f32_32x32x16_bf16 v[20:35], v[96:99], v[76:79], v[20:35]
    v_mfma_f32_32x32x16_bf16 v[36:51], v[92:95], v[80:83], v[36:51]
    v_mfma_f32_32x32x16_bf16 v[52:67], v[96:99], v[80:83], v[52:67]
    s_nop 7
    s_nop 7
    s_lshl_b32 s65, s68, 6
    s_add_u32 s65, s65, s62
    s_cmp_ge_u32 s65, 1728
    s_cbranch_scc1 .k3p0_kernel_end
    s_waitcnt vmcnt(0)
    v_and_b32 v182, 31, v124
    s_lshl_b32 s65, s67, 6
    v_add_u32 v182, s65, v182
    v_lshlrev_b32 v183, 3, v182
    ds_read_b64 v[178:179], v183 offset:0
    ds_read_b64 v[180:181], v183 offset:256
    v_add_u32 v182, s61, v182
    s_mov_b32 s65, 3456
    v_mul_lo_u32 v182, v182, s65
    v_lshlrev_b32 v183, 1, v176
    v_add_u32 v182, v182, v183
    s_lshl_b32 s66, s62, 1
    v_mov_b32 v184, 0xc0135761
    s_mov_b32 s70, 0xbdd2d3c4
    s_waitcnt lgkmcnt(0)
    v_fma_f32 v4, -v178, v128, v4
    v_mul_f32 v4, v4, v179
    v_fma_f32 v5, -v178, v129, v5
    v_mul_f32 v5, v5, v179
    v_fma_f32 v6, -v178, v130, v6
    v_mul_f32 v6, v6, v179
    v_fma_f32 v7, -v178, v131, v7
    v_mul_f32 v7, v7, v179
    v_cvt_pk_bf16_f32 v185, v4, v5
    v_lshlrev_b32 v4, 16, v185
    v_and_b32 v5, 0xffff0000, v185
    v_cvt_pk_bf16_f32 v186, v6, v7
    v_lshlrev_b32 v6, 16, v186
    v_and_b32 v7, 0xffff0000, v186
    v_lshlrev_b32 v188, 16, v160
    v_and_b32 v189, 0xffff0000, v160
    v_lshlrev_b32 v190, 16, v161
    v_and_b32 v191, 0xffff0000, v161
    v_add_f32 v4, v4, v188
    v_add_f32 v5, v5, v189
    v_add_f32 v6, v6, v190
    v_add_f32 v7, v7, v191
    v_cvt_pk_bf16_f32 v185, v4, v5
    v_lshlrev_b32 v4, 16, v185
    v_and_b32 v5, 0xffff0000, v185
    v_cvt_pk_bf16_f32 v186, v6, v7
    v_lshlrev_b32 v6, 16, v186
    v_and_b32 v7, 0xffff0000, v186
    v_mul_f32 v188, v4, v4
    v_fma_f32 v188, v188, s70, v184
    v_mul_f32 v188, v188, v4
    v_exp_f32 v188, v188
    s_nop 0
    v_add_f32 v188, 1.0, v188
    v_rcp_f32 v188, v188
    s_nop 0
    v_mul_f32 v4, v4, v188
    v_mul_f32 v189, v5, v5
    v_fma_f32 v189, v189, s70, v184
    v_mul_f32 v189, v189, v5
    v_exp_f32 v189, v189
    s_nop 0
    v_add_f32 v189, 1.0, v189
    v_rcp_f32 v189, v189
    s_nop 0
    v_mul_f32 v5, v5, v189
    v_mul_f32 v190, v6, v6
    v_fma_f32 v190, v190, s70, v184
    v_mul_f32 v190, v190, v6
    v_exp_f32 v190, v190
    s_nop 0
    v_add_f32 v190, 1.0, v190
    v_rcp_f32 v190, v190
    s_nop 0
    v_mul_f32 v6, v6, v190
    v_mul_f32 v191, v7, v7
    v_fma_f32 v191, v191, s70, v184
    v_mul_f32 v191, v191, v7
    v_exp_f32 v191, v191
    s_nop 0
    v_add_f32 v191, 1.0, v191
    v_rcp_f32 v191, v191
    s_nop 0
    v_mul_f32 v7, v7, v191
    v_cvt_pk_bf16_f32 v192, v4, v5
    v_cvt_pk_bf16_f32 v193, v6, v7
    buffer_store_dwordx2 v[192:193], v182, s[56:59], s66 offen offset:0
    s_nop 1
    v_fma_f32 v8, -v178, v132, v8
    v_mul_f32 v8, v8, v179
    v_fma_f32 v9, -v178, v133, v9
    v_mul_f32 v9, v9, v179
    v_fma_f32 v10, -v178, v134, v10
    v_mul_f32 v10, v10, v179
    v_fma_f32 v11, -v178, v135, v11
    v_mul_f32 v11, v11, v179
    v_cvt_pk_bf16_f32 v185, v8, v9
    v_lshlrev_b32 v8, 16, v185
    v_and_b32 v9, 0xffff0000, v185
    v_cvt_pk_bf16_f32 v186, v10, v11
    v_lshlrev_b32 v10, 16, v186
    v_and_b32 v11, 0xffff0000, v186
    v_lshlrev_b32 v188, 16, v162
    v_and_b32 v189, 0xffff0000, v162
    v_lshlrev_b32 v190, 16, v163
    v_and_b32 v191, 0xffff0000, v163
    v_add_f32 v8, v8, v188
    v_add_f32 v9, v9, v189
    v_add_f32 v10, v10, v190
    v_add_f32 v11, v11, v191
    v_cvt_pk_bf16_f32 v185, v8, v9
    v_lshlrev_b32 v8, 16, v185
    v_and_b32 v9, 0xffff0000, v185
    v_cvt_pk_bf16_f32 v186, v10, v11
    v_lshlrev_b32 v10, 16, v186
    v_and_b32 v11, 0xffff0000, v186
    v_mul_f32 v188, v8, v8
    v_fma_f32 v188, v188, s70, v184
    v_mul_f32 v188, v188, v8
    v_exp_f32 v188, v188
    s_nop 0
    v_add_f32 v188, 1.0, v188
    v_rcp_f32 v188, v188
    s_nop 0
    v_mul_f32 v8, v8, v188
    v_mul_f32 v189, v9, v9
    v_fma_f32 v189, v189, s70, v184
    v_mul_f32 v189, v189, v9
    v_exp_f32 v189, v189
    s_nop 0
    v_add_f32 v189, 1.0, v189
    v_rcp_f32 v189, v189
    s_nop 0
    v_mul_f32 v9, v9, v189
    v_mul_f32 v190, v10, v10
    v_fma_f32 v190, v190, s70, v184
    v_mul_f32 v190, v190, v10
    v_exp_f32 v190, v190
    s_nop 0
    v_add_f32 v190, 1.0, v190
    v_rcp_f32 v190, v190
    s_nop 0
    v_mul_f32 v10, v10, v190
    v_mul_f32 v191, v11, v11
    v_fma_f32 v191, v191, s70, v184
    v_mul_f32 v191, v191, v11
    v_exp_f32 v191, v191
    s_nop 0
    v_add_f32 v191, 1.0, v191
    v_rcp_f32 v191, v191
    s_nop 0
    v_mul_f32 v11, v11, v191
    v_cvt_pk_bf16_f32 v192, v8, v9
    v_cvt_pk_bf16_f32 v193, v10, v11
    buffer_store_dwordx2 v[192:193], v182, s[56:59], s66 offen offset:16
    s_nop 1
    v_fma_f32 v12, -v178, v136, v12
    v_mul_f32 v12, v12, v179
    v_fma_f32 v13, -v178, v137, v13
    v_mul_f32 v13, v13, v179
    v_fma_f32 v14, -v178, v138, v14
    v_mul_f32 v14, v14, v179
    v_fma_f32 v15, -v178, v139, v15
    v_mul_f32 v15, v15, v179
    v_cvt_pk_bf16_f32 v185, v12, v13
    v_lshlrev_b32 v12, 16, v185
    v_and_b32 v13, 0xffff0000, v185
    v_cvt_pk_bf16_f32 v186, v14, v15
    v_lshlrev_b32 v14, 16, v186
    v_and_b32 v15, 0xffff0000, v186
    v_lshlrev_b32 v188, 16, v164
    v_and_b32 v189, 0xffff0000, v164
    v_lshlrev_b32 v190, 16, v165
    v_and_b32 v191, 0xffff0000, v165
    v_add_f32 v12, v12, v188
    v_add_f32 v13, v13, v189
    v_add_f32 v14, v14, v190
    v_add_f32 v15, v15, v191
    v_cvt_pk_bf16_f32 v185, v12, v13
    v_lshlrev_b32 v12, 16, v185
    v_and_b32 v13, 0xffff0000, v185
    v_cvt_pk_bf16_f32 v186, v14, v15
    v_lshlrev_b32 v14, 16, v186
    v_and_b32 v15, 0xffff0000, v186
    v_mul_f32 v188, v12, v12
    v_fma_f32 v188, v188, s70, v184
    v_mul_f32 v188, v188, v12
    v_exp_f32 v188, v188
    s_nop 0
    v_add_f32 v188, 1.0, v188
    v_rcp_f32 v188, v188
    s_nop 0
    v_mul_f32 v12, v12, v188
    v_mul_f32 v189, v13, v13
    v_fma_f32 v189, v189, s70, v184
    v_mul_f32 v189, v189, v13
    v_exp_f32 v189, v189
    s_nop 0
    v_add_f32 v189, 1.0, v189
    v_rcp_f32 v189, v189
    s_nop 0
    v_mul_f32 v13, v13, v189
    v_mul_f32 v190, v14, v14
    v_fma_f32 v190, v190, s70, v184
    v_mul_f32 v190, v190, v14
    v_exp_f32 v190, v190
    s_nop 0
    v_add_f32 v190, 1.0, v190
    v_rcp_f32 v190, v190
    s_nop 0
    v_mul_f32 v14, v14, v190
    v_mul_f32 v191, v15, v15
    v_fma_f32 v191, v191, s70, v184
    v_mul_f32 v191, v191, v15
    v_exp_f32 v191, v191
    s_nop 0
    v_add_f32 v191, 1.0, v191
    v_rcp_f32 v191, v191
    s_nop 0
    v_mul_f32 v15, v15, v191
    v_cvt_pk_bf16_f32 v192, v12, v13
    v_cvt_pk_bf16_f32 v193, v14, v15
    buffer_store_dwordx2 v[192:193], v182, s[56:59], s66 offen offset:32
    s_nop 1
    v_fma_f32 v16, -v178, v140, v16
    v_mul_f32 v16, v16, v179
    v_fma_f32 v17, -v178, v141, v17
    v_mul_f32 v17, v17, v179
    v_fma_f32 v18, -v178, v142, v18
    v_mul_f32 v18, v18, v179
    v_fma_f32 v19, -v178, v143, v19
    v_mul_f32 v19, v19, v179
    v_cvt_pk_bf16_f32 v185, v16, v17
    v_lshlrev_b32 v16, 16, v185
    v_and_b32 v17, 0xffff0000, v185
    v_cvt_pk_bf16_f32 v186, v18, v19
    v_lshlrev_b32 v18, 16, v186
    v_and_b32 v19, 0xffff0000, v186
    v_lshlrev_b32 v188, 16, v166
    v_and_b32 v189, 0xffff0000, v166
    v_lshlrev_b32 v190, 16, v167
    v_and_b32 v191, 0xffff0000, v167
    v_add_f32 v16, v16, v188
    v_add_f32 v17, v17, v189
    v_add_f32 v18, v18, v190
    v_add_f32 v19, v19, v191
    v_cvt_pk_bf16_f32 v185, v16, v17
    v_lshlrev_b32 v16, 16, v185
    v_and_b32 v17, 0xffff0000, v185
    v_cvt_pk_bf16_f32 v186, v18, v19
    v_lshlrev_b32 v18, 16, v186
    v_and_b32 v19, 0xffff0000, v186
    v_mul_f32 v188, v16, v16
    v_fma_f32 v188, v188, s70, v184
    v_mul_f32 v188, v188, v16
    v_exp_f32 v188, v188
    s_nop 0
    v_add_f32 v188, 1.0, v188
    v_rcp_f32 v188, v188
    s_nop 0
    v_mul_f32 v16, v16, v188
    v_mul_f32 v189, v17, v17
    v_fma_f32 v189, v189, s70, v184
    v_mul_f32 v189, v189, v17
    v_exp_f32 v189, v189
    s_nop 0
    v_add_f32 v189, 1.0, v189
    v_rcp_f32 v189, v189
    s_nop 0
    v_mul_f32 v17, v17, v189
    v_mul_f32 v190, v18, v18
    v_fma_f32 v190, v190, s70, v184
    v_mul_f32 v190, v190, v18
    v_exp_f32 v190, v190
    s_nop 0
    v_add_f32 v190, 1.0, v190
    v_rcp_f32 v190, v190
    s_nop 0
    v_mul_f32 v18, v18, v190
    v_mul_f32 v191, v19, v19
    v_fma_f32 v191, v191, s70, v184
    v_mul_f32 v191, v191, v19
    v_exp_f32 v191, v191
    s_nop 0
    v_add_f32 v191, 1.0, v191
    v_rcp_f32 v191, v191
    s_nop 0
    v_mul_f32 v19, v19, v191
    v_cvt_pk_bf16_f32 v192, v16, v17
    v_cvt_pk_bf16_f32 v193, v18, v19
    buffer_store_dwordx2 v[192:193], v182, s[56:59], s66 offen offset:48
    s_nop 1
    v_fma_f32 v20, -v178, v144, v20
    v_mul_f32 v20, v20, v179
    v_fma_f32 v21, -v178, v145, v21
    v_mul_f32 v21, v21, v179
    v_fma_f32 v22, -v178, v146, v22
    v_mul_f32 v22, v22, v179
    v_fma_f32 v23, -v178, v147, v23
    v_mul_f32 v23, v23, v179
    v_cvt_pk_bf16_f32 v185, v20, v21
    v_lshlrev_b32 v20, 16, v185
    v_and_b32 v21, 0xffff0000, v185
    v_cvt_pk_bf16_f32 v186, v22, v23
    v_lshlrev_b32 v22, 16, v186
    v_and_b32 v23, 0xffff0000, v186
    v_lshlrev_b32 v188, 16, v168
    v_and_b32 v189, 0xffff0000, v168
    v_lshlrev_b32 v190, 16, v169
    v_and_b32 v191, 0xffff0000, v169
    v_add_f32 v20, v20, v188
    v_add_f32 v21, v21, v189
    v_add_f32 v22, v22, v190
    v_add_f32 v23, v23, v191
    v_cvt_pk_bf16_f32 v185, v20, v21
    v_lshlrev_b32 v20, 16, v185
    v_and_b32 v21, 0xffff0000, v185
    v_cvt_pk_bf16_f32 v186, v22, v23
    v_lshlrev_b32 v22, 16, v186
    v_and_b32 v23, 0xffff0000, v186
    v_mul_f32 v188, v20, v20
    v_fma_f32 v188, v188, s70, v184
    v_mul_f32 v188, v188, v20
    v_exp_f32 v188, v188
    s_nop 0
    v_add_f32 v188, 1.0, v188
    v_rcp_f32 v188, v188
    s_nop 0
    v_mul_f32 v20, v20, v188
    v_mul_f32 v189, v21, v21
    v_fma_f32 v189, v189, s70, v184
    v_mul_f32 v189, v189, v21
    v_exp_f32 v189, v189
    s_nop 0
    v_add_f32 v189, 1.0, v189
    v_rcp_f32 v189, v189
    s_nop 0
    v_mul_f32 v21, v21, v189
    v_mul_f32 v190, v22, v22
    v_fma_f32 v190, v190, s70, v184
    v_mul_f32 v190, v190, v22
    v_exp_f32 v190, v190
    s_nop 0
    v_add_f32 v190, 1.0, v190
    v_rcp_f32 v190, v190
    s_nop 0
    v_mul_f32 v22, v22, v190
    v_mul_f32 v191, v23, v23
    v_fma_f32 v191, v191, s70, v184
    v_mul_f32 v191, v191, v23
    v_exp_f32 v191, v191
    s_nop 0
    v_add_f32 v191, 1.0, v191
    v_rcp_f32 v191, v191
    s_nop 0
    v_mul_f32 v23, v23, v191
    v_cvt_pk_bf16_f32 v192, v20, v21
    v_cvt_pk_bf16_f32 v193, v22, v23
    buffer_store_dwordx2 v[192:193], v182, s[56:59], s66 offen offset:64
    s_nop 1
    v_fma_f32 v24, -v178, v148, v24
    v_mul_f32 v24, v24, v179
    v_fma_f32 v25, -v178, v149, v25
    v_mul_f32 v25, v25, v179
    v_fma_f32 v26, -v178, v150, v26
    v_mul_f32 v26, v26, v179
    v_fma_f32 v27, -v178, v151, v27
    v_mul_f32 v27, v27, v179
    v_cvt_pk_bf16_f32 v185, v24, v25
    v_lshlrev_b32 v24, 16, v185
    v_and_b32 v25, 0xffff0000, v185
    v_cvt_pk_bf16_f32 v186, v26, v27
    v_lshlrev_b32 v26, 16, v186
    v_and_b32 v27, 0xffff0000, v186
    v_lshlrev_b32 v188, 16, v170
    v_and_b32 v189, 0xffff0000, v170
    v_lshlrev_b32 v190, 16, v171
    v_and_b32 v191, 0xffff0000, v171
    v_add_f32 v24, v24, v188
    v_add_f32 v25, v25, v189
    v_add_f32 v26, v26, v190
    v_add_f32 v27, v27, v191
    v_cvt_pk_bf16_f32 v185, v24, v25
    v_lshlrev_b32 v24, 16, v185
    v_and_b32 v25, 0xffff0000, v185
    v_cvt_pk_bf16_f32 v186, v26, v27
    v_lshlrev_b32 v26, 16, v186
    v_and_b32 v27, 0xffff0000, v186
    v_mul_f32 v188, v24, v24
    v_fma_f32 v188, v188, s70, v184
    v_mul_f32 v188, v188, v24
    v_exp_f32 v188, v188
    s_nop 0
    v_add_f32 v188, 1.0, v188
    v_rcp_f32 v188, v188
    s_nop 0
    v_mul_f32 v24, v24, v188
    v_mul_f32 v189, v25, v25
    v_fma_f32 v189, v189, s70, v184
    v_mul_f32 v189, v189, v25
    v_exp_f32 v189, v189
    s_nop 0
    v_add_f32 v189, 1.0, v189
    v_rcp_f32 v189, v189
    s_nop 0
    v_mul_f32 v25, v25, v189
    v_mul_f32 v190, v26, v26
    v_fma_f32 v190, v190, s70, v184
    v_mul_f32 v190, v190, v26
    v_exp_f32 v190, v190
    s_nop 0
    v_add_f32 v190, 1.0, v190
    v_rcp_f32 v190, v190
    s_nop 0
    v_mul_f32 v26, v26, v190
    v_mul_f32 v191, v27, v27
    v_fma_f32 v191, v191, s70, v184
    v_mul_f32 v191, v191, v27
    v_exp_f32 v191, v191
    s_nop 0
    v_add_f32 v191, 1.0, v191
    v_rcp_f32 v191, v191
    s_nop 0
    v_mul_f32 v27, v27, v191
    v_cvt_pk_bf16_f32 v192, v24, v25
    v_cvt_pk_bf16_f32 v193, v26, v27
    buffer_store_dwordx2 v[192:193], v182, s[56:59], s66 offen offset:80
    s_nop 1
    v_fma_f32 v28, -v178, v152, v28
    v_mul_f32 v28, v28, v179
    v_fma_f32 v29, -v178, v153, v29
    v_mul_f32 v29, v29, v179
    v_fma_f32 v30, -v178, v154, v30
    v_mul_f32 v30, v30, v179
    v_fma_f32 v31, -v178, v155, v31
    v_mul_f32 v31, v31, v179
    v_cvt_pk_bf16_f32 v185, v28, v29
    v_lshlrev_b32 v28, 16, v185
    v_and_b32 v29, 0xffff0000, v185
    v_cvt_pk_bf16_f32 v186, v30, v31
    v_lshlrev_b32 v30, 16, v186
    v_and_b32 v31, 0xffff0000, v186
    v_lshlrev_b32 v188, 16, v172
    v_and_b32 v189, 0xffff0000, v172
    v_lshlrev_b32 v190, 16, v173
    v_and_b32 v191, 0xffff0000, v173
    v_add_f32 v28, v28, v188
    v_add_f32 v29, v29, v189
    v_add_f32 v30, v30, v190
    v_add_f32 v31, v31, v191
    v_cvt_pk_bf16_f32 v185, v28, v29
    v_lshlrev_b32 v28, 16, v185
    v_and_b32 v29, 0xffff0000, v185
    v_cvt_pk_bf16_f32 v186, v30, v31
    v_lshlrev_b32 v30, 16, v186
    v_and_b32 v31, 0xffff0000, v186
    v_mul_f32 v188, v28, v28
    v_fma_f32 v188, v188, s70, v184
    v_mul_f32 v188, v188, v28
    v_exp_f32 v188, v188
    s_nop 0
    v_add_f32 v188, 1.0, v188
    v_rcp_f32 v188, v188
    s_nop 0
    v_mul_f32 v28, v28, v188
    v_mul_f32 v189, v29, v29
    v_fma_f32 v189, v189, s70, v184
    v_mul_f32 v189, v189, v29
    v_exp_f32 v189, v189
    s_nop 0
    v_add_f32 v189, 1.0, v189
    v_rcp_f32 v189, v189
    s_nop 0
    v_mul_f32 v29, v29, v189
    v_mul_f32 v190, v30, v30
    v_fma_f32 v190, v190, s70, v184
    v_mul_f32 v190, v190, v30
    v_exp_f32 v190, v190
    s_nop 0
    v_add_f32 v190, 1.0, v190
    v_rcp_f32 v190, v190
    s_nop 0
    v_mul_f32 v30, v30, v190
    v_mul_f32 v191, v31, v31
    v_fma_f32 v191, v191, s70, v184
    v_mul_f32 v191, v191, v31
    v_exp_f32 v191, v191
    s_nop 0
    v_add_f32 v191, 1.0, v191
    v_rcp_f32 v191, v191
    s_nop 0
    v_mul_f32 v31, v31, v191
    v_cvt_pk_bf16_f32 v192, v28, v29
    v_cvt_pk_bf16_f32 v193, v30, v31
    buffer_store_dwordx2 v[192:193], v182, s[56:59], s66 offen offset:96
    s_nop 1
    v_fma_f32 v32, -v178, v156, v32
    v_mul_f32 v32, v32, v179
    v_fma_f32 v33, -v178, v157, v33
    v_mul_f32 v33, v33, v179
    v_fma_f32 v34, -v178, v158, v34
    v_mul_f32 v34, v34, v179
    v_fma_f32 v35, -v178, v159, v35
    v_mul_f32 v35, v35, v179
    v_cvt_pk_bf16_f32 v185, v32, v33
    v_lshlrev_b32 v32, 16, v185
    v_and_b32 v33, 0xffff0000, v185
    v_cvt_pk_bf16_f32 v186, v34, v35
    v_lshlrev_b32 v34, 16, v186
    v_and_b32 v35, 0xffff0000, v186
    v_lshlrev_b32 v188, 16, v174
    v_and_b32 v189, 0xffff0000, v174
    v_lshlrev_b32 v190, 16, v175
    v_and_b32 v191, 0xffff0000, v175
    v_add_f32 v32, v32, v188
    v_add_f32 v33, v33, v189
    v_add_f32 v34, v34, v190
    v_add_f32 v35, v35, v191
    v_cvt_pk_bf16_f32 v185, v32, v33
    v_lshlrev_b32 v32, 16, v185
    v_and_b32 v33, 0xffff0000, v185
    v_cvt_pk_bf16_f32 v186, v34, v35
    v_lshlrev_b32 v34, 16, v186
    v_and_b32 v35, 0xffff0000, v186
    v_mul_f32 v188, v32, v32
    v_fma_f32 v188, v188, s70, v184
    v_mul_f32 v188, v188, v32
    v_exp_f32 v188, v188
    s_nop 0
    v_add_f32 v188, 1.0, v188
    v_rcp_f32 v188, v188
    s_nop 0
    v_mul_f32 v32, v32, v188
    v_mul_f32 v189, v33, v33
    v_fma_f32 v189, v189, s70, v184
    v_mul_f32 v189, v189, v33
    v_exp_f32 v189, v189
    s_nop 0
    v_add_f32 v189, 1.0, v189
    v_rcp_f32 v189, v189
    s_nop 0
    v_mul_f32 v33, v33, v189
    v_mul_f32 v190, v34, v34
    v_fma_f32 v190, v190, s70, v184
    v_mul_f32 v190, v190, v34
    v_exp_f32 v190, v190
    s_nop 0
    v_add_f32 v190, 1.0, v190
    v_rcp_f32 v190, v190
    s_nop 0
    v_mul_f32 v34, v34, v190
    v_mul_f32 v191, v35, v35
    v_fma_f32 v191, v191, s70, v184
    v_mul_f32 v191, v191, v35
    v_exp_f32 v191, v191
    s_nop 0
    v_add_f32 v191, 1.0, v191
    v_rcp_f32 v191, v191
    s_nop 0
    v_mul_f32 v35, v35, v191
    v_cvt_pk_bf16_f32 v192, v32, v33
    v_cvt_pk_bf16_f32 v193, v34, v35
    buffer_store_dwordx2 v[192:193], v182, s[56:59], s66 offen offset:112
    s_nop 1
    v_add_u32 v183, 110592, v182
    v_fma_f32 v36, -v180, v128, v36
    v_mul_f32 v36, v36, v181
    v_fma_f32 v37, -v180, v129, v37
    v_mul_f32 v37, v37, v181
    v_fma_f32 v38, -v180, v130, v38
    v_mul_f32 v38, v38, v181
    v_fma_f32 v39, -v180, v131, v39
    v_mul_f32 v39, v39, v181
    v_cvt_pk_bf16_f32 v185, v36, v37
    v_lshlrev_b32 v36, 16, v185
    v_and_b32 v37, 0xffff0000, v185
    v_cvt_pk_bf16_f32 v186, v38, v39
    v_lshlrev_b32 v38, 16, v186
    v_and_b32 v39, 0xffff0000, v186
    v_lshlrev_b32 v188, 16, v160
    v_and_b32 v189, 0xffff0000, v160
    v_lshlrev_b32 v190, 16, v161
    v_and_b32 v191, 0xffff0000, v161
    v_add_f32 v36, v36, v188
    v_add_f32 v37, v37, v189
    v_add_f32 v38, v38, v190
    v_add_f32 v39, v39, v191
    v_cvt_pk_bf16_f32 v185, v36, v37
    v_lshlrev_b32 v36, 16, v185
    v_and_b32 v37, 0xffff0000, v185
    v_cvt_pk_bf16_f32 v186, v38, v39
    v_lshlrev_b32 v38, 16, v186
    v_and_b32 v39, 0xffff0000, v186
    v_mul_f32 v188, v36, v36
    v_fma_f32 v188, v188, s70, v184
    v_mul_f32 v188, v188, v36
    v_exp_f32 v188, v188
    s_nop 0
    v_add_f32 v188, 1.0, v188
    v_rcp_f32 v188, v188
    s_nop 0
    v_mul_f32 v36, v36, v188
    v_mul_f32 v189, v37, v37
    v_fma_f32 v189, v189, s70, v184
    v_mul_f32 v189, v189, v37
    v_exp_f32 v189, v189
    s_nop 0
    v_add_f32 v189, 1.0, v189
    v_rcp_f32 v189, v189
    s_nop 0
    v_mul_f32 v37, v37, v189
    v_mul_f32 v190, v38, v38
    v_fma_f32 v190, v190, s70, v184
    v_mul_f32 v190, v190, v38
    v_exp_f32 v190, v190
    s_nop 0
    v_add_f32 v190, 1.0, v190
    v_rcp_f32 v190, v190
    s_nop 0
    v_mul_f32 v38, v38, v190
    v_mul_f32 v191, v39, v39
    v_fma_f32 v191, v191, s70, v184
    v_mul_f32 v191, v191, v39
    v_exp_f32 v191, v191
    s_nop 0
    v_add_f32 v191, 1.0, v191
    v_rcp_f32 v191, v191
    s_nop 0
    v_mul_f32 v39, v39, v191
    v_cvt_pk_bf16_f32 v192, v36, v37
    v_cvt_pk_bf16_f32 v193, v38, v39
    buffer_store_dwordx2 v[192:193], v183, s[56:59], s66 offen offset:0
    s_nop 1
    v_fma_f32 v40, -v180, v132, v40
    v_mul_f32 v40, v40, v181
    v_fma_f32 v41, -v180, v133, v41
    v_mul_f32 v41, v41, v181
    v_fma_f32 v42, -v180, v134, v42
    v_mul_f32 v42, v42, v181
    v_fma_f32 v43, -v180, v135, v43
    v_mul_f32 v43, v43, v181
    v_cvt_pk_bf16_f32 v185, v40, v41
    v_lshlrev_b32 v40, 16, v185
    v_and_b32 v41, 0xffff0000, v185
    v_cvt_pk_bf16_f32 v186, v42, v43
    v_lshlrev_b32 v42, 16, v186
    v_and_b32 v43, 0xffff0000, v186
    v_lshlrev_b32 v188, 16, v162
    v_and_b32 v189, 0xffff0000, v162
    v_lshlrev_b32 v190, 16, v163
    v_and_b32 v191, 0xffff0000, v163
    v_add_f32 v40, v40, v188
    v_add_f32 v41, v41, v189
    v_add_f32 v42, v42, v190
    v_add_f32 v43, v43, v191
    v_cvt_pk_bf16_f32 v185, v40, v41
    v_lshlrev_b32 v40, 16, v185
    v_and_b32 v41, 0xffff0000, v185
    v_cvt_pk_bf16_f32 v186, v42, v43
    v_lshlrev_b32 v42, 16, v186
    v_and_b32 v43, 0xffff0000, v186
    v_mul_f32 v188, v40, v40
    v_fma_f32 v188, v188, s70, v184
    v_mul_f32 v188, v188, v40
    v_exp_f32 v188, v188
    s_nop 0
    v_add_f32 v188, 1.0, v188
    v_rcp_f32 v188, v188
    s_nop 0
    v_mul_f32 v40, v40, v188
    v_mul_f32 v189, v41, v41
    v_fma_f32 v189, v189, s70, v184
    v_mul_f32 v189, v189, v41
    v_exp_f32 v189, v189
    s_nop 0
    v_add_f32 v189, 1.0, v189
    v_rcp_f32 v189, v189
    s_nop 0
    v_mul_f32 v41, v41, v189
    v_mul_f32 v190, v42, v42
    v_fma_f32 v190, v190, s70, v184
    v_mul_f32 v190, v190, v42
    v_exp_f32 v190, v190
    s_nop 0
    v_add_f32 v190, 1.0, v190
    v_rcp_f32 v190, v190
    s_nop 0
    v_mul_f32 v42, v42, v190
    v_mul_f32 v191, v43, v43
    v_fma_f32 v191, v191, s70, v184
    v_mul_f32 v191, v191, v43
    v_exp_f32 v191, v191
    s_nop 0
    v_add_f32 v191, 1.0, v191
    v_rcp_f32 v191, v191
    s_nop 0
    v_mul_f32 v43, v43, v191
    v_cvt_pk_bf16_f32 v192, v40, v41
    v_cvt_pk_bf16_f32 v193, v42, v43
    buffer_store_dwordx2 v[192:193], v183, s[56:59], s66 offen offset:16
    s_nop 1
    v_fma_f32 v44, -v180, v136, v44
    v_mul_f32 v44, v44, v181
    v_fma_f32 v45, -v180, v137, v45
    v_mul_f32 v45, v45, v181
    v_fma_f32 v46, -v180, v138, v46
    v_mul_f32 v46, v46, v181
    v_fma_f32 v47, -v180, v139, v47
    v_mul_f32 v47, v47, v181
    v_cvt_pk_bf16_f32 v185, v44, v45
    v_lshlrev_b32 v44, 16, v185
    v_and_b32 v45, 0xffff0000, v185
    v_cvt_pk_bf16_f32 v186, v46, v47
    v_lshlrev_b32 v46, 16, v186
    v_and_b32 v47, 0xffff0000, v186
    v_lshlrev_b32 v188, 16, v164
    v_and_b32 v189, 0xffff0000, v164
    v_lshlrev_b32 v190, 16, v165
    v_and_b32 v191, 0xffff0000, v165
    v_add_f32 v44, v44, v188
    v_add_f32 v45, v45, v189
    v_add_f32 v46, v46, v190
    v_add_f32 v47, v47, v191
    v_cvt_pk_bf16_f32 v185, v44, v45
    v_lshlrev_b32 v44, 16, v185
    v_and_b32 v45, 0xffff0000, v185
    v_cvt_pk_bf16_f32 v186, v46, v47
    v_lshlrev_b32 v46, 16, v186
    v_and_b32 v47, 0xffff0000, v186
    v_mul_f32 v188, v44, v44
    v_fma_f32 v188, v188, s70, v184
    v_mul_f32 v188, v188, v44
    v_exp_f32 v188, v188
    s_nop 0
    v_add_f32 v188, 1.0, v188
    v_rcp_f32 v188, v188
    s_nop 0
    v_mul_f32 v44, v44, v188
    v_mul_f32 v189, v45, v45
    v_fma_f32 v189, v189, s70, v184
    v_mul_f32 v189, v189, v45
    v_exp_f32 v189, v189
    s_nop 0
    v_add_f32 v189, 1.0, v189
    v_rcp_f32 v189, v189
    s_nop 0
    v_mul_f32 v45, v45, v189
    v_mul_f32 v190, v46, v46
    v_fma_f32 v190, v190, s70, v184
    v_mul_f32 v190, v190, v46
    v_exp_f32 v190, v190
    s_nop 0
    v_add_f32 v190, 1.0, v190
    v_rcp_f32 v190, v190
    s_nop 0
    v_mul_f32 v46, v46, v190
    v_mul_f32 v191, v47, v47
    v_fma_f32 v191, v191, s70, v184
    v_mul_f32 v191, v191, v47
    v_exp_f32 v191, v191
    s_nop 0
    v_add_f32 v191, 1.0, v191
    v_rcp_f32 v191, v191
    s_nop 0
    v_mul_f32 v47, v47, v191
    v_cvt_pk_bf16_f32 v192, v44, v45
    v_cvt_pk_bf16_f32 v193, v46, v47
    buffer_store_dwordx2 v[192:193], v183, s[56:59], s66 offen offset:32
    s_nop 1
    v_fma_f32 v48, -v180, v140, v48
    v_mul_f32 v48, v48, v181
    v_fma_f32 v49, -v180, v141, v49
    v_mul_f32 v49, v49, v181
    v_fma_f32 v50, -v180, v142, v50
    v_mul_f32 v50, v50, v181
    v_fma_f32 v51, -v180, v143, v51
    v_mul_f32 v51, v51, v181
    v_cvt_pk_bf16_f32 v185, v48, v49
    v_lshlrev_b32 v48, 16, v185
    v_and_b32 v49, 0xffff0000, v185
    v_cvt_pk_bf16_f32 v186, v50, v51
    v_lshlrev_b32 v50, 16, v186
    v_and_b32 v51, 0xffff0000, v186
    v_lshlrev_b32 v188, 16, v166
    v_and_b32 v189, 0xffff0000, v166
    v_lshlrev_b32 v190, 16, v167
    v_and_b32 v191, 0xffff0000, v167
    v_add_f32 v48, v48, v188
    v_add_f32 v49, v49, v189
    v_add_f32 v50, v50, v190
    v_add_f32 v51, v51, v191
    v_cvt_pk_bf16_f32 v185, v48, v49
    v_lshlrev_b32 v48, 16, v185
    v_and_b32 v49, 0xffff0000, v185
    v_cvt_pk_bf16_f32 v186, v50, v51
    v_lshlrev_b32 v50, 16, v186
    v_and_b32 v51, 0xffff0000, v186
    v_mul_f32 v188, v48, v48
    v_fma_f32 v188, v188, s70, v184
    v_mul_f32 v188, v188, v48
    v_exp_f32 v188, v188
    s_nop 0
    v_add_f32 v188, 1.0, v188
    v_rcp_f32 v188, v188
    s_nop 0
    v_mul_f32 v48, v48, v188
    v_mul_f32 v189, v49, v49
    v_fma_f32 v189, v189, s70, v184
    v_mul_f32 v189, v189, v49
    v_exp_f32 v189, v189
    s_nop 0
    v_add_f32 v189, 1.0, v189
    v_rcp_f32 v189, v189
    s_nop 0
    v_mul_f32 v49, v49, v189
    v_mul_f32 v190, v50, v50
    v_fma_f32 v190, v190, s70, v184
    v_mul_f32 v190, v190, v50
    v_exp_f32 v190, v190
    s_nop 0
    v_add_f32 v190, 1.0, v190
    v_rcp_f32 v190, v190
    s_nop 0
    v_mul_f32 v50, v50, v190
    v_mul_f32 v191, v51, v51
    v_fma_f32 v191, v191, s70, v184
    v_mul_f32 v191, v191, v51
    v_exp_f32 v191, v191
    s_nop 0
    v_add_f32 v191, 1.0, v191
    v_rcp_f32 v191, v191
    s_nop 0
    v_mul_f32 v51, v51, v191
    v_cvt_pk_bf16_f32 v192, v48, v49
    v_cvt_pk_bf16_f32 v193, v50, v51
    buffer_store_dwordx2 v[192:193], v183, s[56:59], s66 offen offset:48
    s_nop 1
    v_fma_f32 v52, -v180, v144, v52
    v_mul_f32 v52, v52, v181
    v_fma_f32 v53, -v180, v145, v53
    v_mul_f32 v53, v53, v181
    v_fma_f32 v54, -v180, v146, v54
    v_mul_f32 v54, v54, v181
    v_fma_f32 v55, -v180, v147, v55
    v_mul_f32 v55, v55, v181
    v_cvt_pk_bf16_f32 v185, v52, v53
    v_lshlrev_b32 v52, 16, v185
    v_and_b32 v53, 0xffff0000, v185
    v_cvt_pk_bf16_f32 v186, v54, v55
    v_lshlrev_b32 v54, 16, v186
    v_and_b32 v55, 0xffff0000, v186
    v_lshlrev_b32 v188, 16, v168
    v_and_b32 v189, 0xffff0000, v168
    v_lshlrev_b32 v190, 16, v169
    v_and_b32 v191, 0xffff0000, v169
    v_add_f32 v52, v52, v188
    v_add_f32 v53, v53, v189
    v_add_f32 v54, v54, v190
    v_add_f32 v55, v55, v191
    v_cvt_pk_bf16_f32 v185, v52, v53
    v_lshlrev_b32 v52, 16, v185
    v_and_b32 v53, 0xffff0000, v185
    v_cvt_pk_bf16_f32 v186, v54, v55
    v_lshlrev_b32 v54, 16, v186
    v_and_b32 v55, 0xffff0000, v186
    v_mul_f32 v188, v52, v52
    v_fma_f32 v188, v188, s70, v184
    v_mul_f32 v188, v188, v52
    v_exp_f32 v188, v188
    s_nop 0
    v_add_f32 v188, 1.0, v188
    v_rcp_f32 v188, v188
    s_nop 0
    v_mul_f32 v52, v52, v188
    v_mul_f32 v189, v53, v53
    v_fma_f32 v189, v189, s70, v184
    v_mul_f32 v189, v189, v53
    v_exp_f32 v189, v189
    s_nop 0
    v_add_f32 v189, 1.0, v189
    v_rcp_f32 v189, v189
    s_nop 0
    v_mul_f32 v53, v53, v189
    v_mul_f32 v190, v54, v54
    v_fma_f32 v190, v190, s70, v184
    v_mul_f32 v190, v190, v54
    v_exp_f32 v190, v190
    s_nop 0
    v_add_f32 v190, 1.0, v190
    v_rcp_f32 v190, v190
    s_nop 0
    v_mul_f32 v54, v54, v190
    v_mul_f32 v191, v55, v55
    v_fma_f32 v191, v191, s70, v184
    v_mul_f32 v191, v191, v55
    v_exp_f32 v191, v191
    s_nop 0
    v_add_f32 v191, 1.0, v191
    v_rcp_f32 v191, v191
    s_nop 0
    v_mul_f32 v55, v55, v191
    v_cvt_pk_bf16_f32 v192, v52, v53
    v_cvt_pk_bf16_f32 v193, v54, v55
    buffer_store_dwordx2 v[192:193], v183, s[56:59], s66 offen offset:64
    s_nop 1
    v_fma_f32 v56, -v180, v148, v56
    v_mul_f32 v56, v56, v181
    v_fma_f32 v57, -v180, v149, v57
    v_mul_f32 v57, v57, v181
    v_fma_f32 v58, -v180, v150, v58
    v_mul_f32 v58, v58, v181
    v_fma_f32 v59, -v180, v151, v59
    v_mul_f32 v59, v59, v181
    v_cvt_pk_bf16_f32 v185, v56, v57
    v_lshlrev_b32 v56, 16, v185
    v_and_b32 v57, 0xffff0000, v185
    v_cvt_pk_bf16_f32 v186, v58, v59
    v_lshlrev_b32 v58, 16, v186
    v_and_b32 v59, 0xffff0000, v186
    v_lshlrev_b32 v188, 16, v170
    v_and_b32 v189, 0xffff0000, v170
    v_lshlrev_b32 v190, 16, v171
    v_and_b32 v191, 0xffff0000, v171
    v_add_f32 v56, v56, v188
    v_add_f32 v57, v57, v189
    v_add_f32 v58, v58, v190
    v_add_f32 v59, v59, v191
    v_cvt_pk_bf16_f32 v185, v56, v57
    v_lshlrev_b32 v56, 16, v185
    v_and_b32 v57, 0xffff0000, v185
    v_cvt_pk_bf16_f32 v186, v58, v59
    v_lshlrev_b32 v58, 16, v186
    v_and_b32 v59, 0xffff0000, v186
    v_mul_f32 v188, v56, v56
    v_fma_f32 v188, v188, s70, v184
    v_mul_f32 v188, v188, v56
    v_exp_f32 v188, v188
    s_nop 0
    v_add_f32 v188, 1.0, v188
    v_rcp_f32 v188, v188
    s_nop 0
    v_mul_f32 v56, v56, v188
    v_mul_f32 v189, v57, v57
    v_fma_f32 v189, v189, s70, v184
    v_mul_f32 v189, v189, v57
    v_exp_f32 v189, v189
    s_nop 0
    v_add_f32 v189, 1.0, v189
    v_rcp_f32 v189, v189
    s_nop 0
    v_mul_f32 v57, v57, v189
    v_mul_f32 v190, v58, v58
    v_fma_f32 v190, v190, s70, v184
    v_mul_f32 v190, v190, v58
    v_exp_f32 v190, v190
    s_nop 0
    v_add_f32 v190, 1.0, v190
    v_rcp_f32 v190, v190
    s_nop 0
    v_mul_f32 v58, v58, v190
    v_mul_f32 v191, v59, v59
    v_fma_f32 v191, v191, s70, v184
    v_mul_f32 v191, v191, v59
    v_exp_f32 v191, v191
    s_nop 0
    v_add_f32 v191, 1.0, v191
    v_rcp_f32 v191, v191
    s_nop 0
    v_mul_f32 v59, v59, v191
    v_cvt_pk_bf16_f32 v192, v56, v57
    v_cvt_pk_bf16_f32 v193, v58, v59
    buffer_store_dwordx2 v[192:193], v183, s[56:59], s66 offen offset:80
    s_nop 1
    v_fma_f32 v60, -v180, v152, v60
    v_mul_f32 v60, v60, v181
    v_fma_f32 v61, -v180, v153, v61
    v_mul_f32 v61, v61, v181
    v_fma_f32 v62, -v180, v154, v62
    v_mul_f32 v62, v62, v181
    v_fma_f32 v63, -v180, v155, v63
    v_mul_f32 v63, v63, v181
    v_cvt_pk_bf16_f32 v185, v60, v61
    v_lshlrev_b32 v60, 16, v185
    v_and_b32 v61, 0xffff0000, v185
    v_cvt_pk_bf16_f32 v186, v62, v63
    v_lshlrev_b32 v62, 16, v186
    v_and_b32 v63, 0xffff0000, v186
    v_lshlrev_b32 v188, 16, v172
    v_and_b32 v189, 0xffff0000, v172
    v_lshlrev_b32 v190, 16, v173
    v_and_b32 v191, 0xffff0000, v173
    v_add_f32 v60, v60, v188
    v_add_f32 v61, v61, v189
    v_add_f32 v62, v62, v190
    v_add_f32 v63, v63, v191
    v_cvt_pk_bf16_f32 v185, v60, v61
    v_lshlrev_b32 v60, 16, v185
    v_and_b32 v61, 0xffff0000, v185
    v_cvt_pk_bf16_f32 v186, v62, v63
    v_lshlrev_b32 v62, 16, v186
    v_and_b32 v63, 0xffff0000, v186
    v_mul_f32 v188, v60, v60
    v_fma_f32 v188, v188, s70, v184
    v_mul_f32 v188, v188, v60
    v_exp_f32 v188, v188
    s_nop 0
    v_add_f32 v188, 1.0, v188
    v_rcp_f32 v188, v188
    s_nop 0
    v_mul_f32 v60, v60, v188
    v_mul_f32 v189, v61, v61
    v_fma_f32 v189, v189, s70, v184
    v_mul_f32 v189, v189, v61
    v_exp_f32 v189, v189
    s_nop 0
    v_add_f32 v189, 1.0, v189
    v_rcp_f32 v189, v189
    s_nop 0
    v_mul_f32 v61, v61, v189
    v_mul_f32 v190, v62, v62
    v_fma_f32 v190, v190, s70, v184
    v_mul_f32 v190, v190, v62
    v_exp_f32 v190, v190
    s_nop 0
    v_add_f32 v190, 1.0, v190
    v_rcp_f32 v190, v190
    s_nop 0
    v_mul_f32 v62, v62, v190
    v_mul_f32 v191, v63, v63
    v_fma_f32 v191, v191, s70, v184
    v_mul_f32 v191, v191, v63
    v_exp_f32 v191, v191
    s_nop 0
    v_add_f32 v191, 1.0, v191
    v_rcp_f32 v191, v191
    s_nop 0
    v_mul_f32 v63, v63, v191
    v_cvt_pk_bf16_f32 v192, v60, v61
    v_cvt_pk_bf16_f32 v193, v62, v63
    buffer_store_dwordx2 v[192:193], v183, s[56:59], s66 offen offset:96
    s_nop 1
    v_fma_f32 v64, -v180, v156, v64
    v_mul_f32 v64, v64, v181
    v_fma_f32 v65, -v180, v157, v65
    v_mul_f32 v65, v65, v181
    v_fma_f32 v66, -v180, v158, v66
    v_mul_f32 v66, v66, v181
    v_fma_f32 v67, -v180, v159, v67
    v_mul_f32 v67, v67, v181
    v_cvt_pk_bf16_f32 v185, v64, v65
    v_lshlrev_b32 v64, 16, v185
    v_and_b32 v65, 0xffff0000, v185
    v_cvt_pk_bf16_f32 v186, v66, v67
    v_lshlrev_b32 v66, 16, v186
    v_and_b32 v67, 0xffff0000, v186
    v_lshlrev_b32 v188, 16, v174
    v_and_b32 v189, 0xffff0000, v174
    v_lshlrev_b32 v190, 16, v175
    v_and_b32 v191, 0xffff0000, v175
    v_add_f32 v64, v64, v188
    v_add_f32 v65, v65, v189
    v_add_f32 v66, v66, v190
    v_add_f32 v67, v67, v191
    v_cvt_pk_bf16_f32 v185, v64, v65
    v_lshlrev_b32 v64, 16, v185
    v_and_b32 v65, 0xffff0000, v185
    v_cvt_pk_bf16_f32 v186, v66, v67
    v_lshlrev_b32 v66, 16, v186
    v_and_b32 v67, 0xffff0000, v186
    v_mul_f32 v188, v64, v64
    v_fma_f32 v188, v188, s70, v184
    v_mul_f32 v188, v188, v64
    v_exp_f32 v188, v188
    s_nop 0
    v_add_f32 v188, 1.0, v188
    v_rcp_f32 v188, v188
    s_nop 0
    v_mul_f32 v64, v64, v188
    v_mul_f32 v189, v65, v65
    v_fma_f32 v189, v189, s70, v184
    v_mul_f32 v189, v189, v65
    v_exp_f32 v189, v189
    s_nop 0
    v_add_f32 v189, 1.0, v189
    v_rcp_f32 v189, v189
    s_nop 0
    v_mul_f32 v65, v65, v189
    v_mul_f32 v190, v66, v66
    v_fma_f32 v190, v190, s70, v184
    v_mul_f32 v190, v190, v66
    v_exp_f32 v190, v190
    s_nop 0
    v_add_f32 v190, 1.0, v190
    v_rcp_f32 v190, v190
    s_nop 0
    v_mul_f32 v66, v66, v190
    v_mul_f32 v191, v67, v67
    v_fma_f32 v191, v191, s70, v184
    v_mul_f32 v191, v191, v67
    v_exp_f32 v191, v191
    s_nop 0
    v_add_f32 v191, 1.0, v191
    v_rcp_f32 v191, v191
    s_nop 0
    v_mul_f32 v67, v67, v191
    v_cvt_pk_bf16_f32 v192, v64, v65
    v_cvt_pk_bf16_f32 v193, v66, v67
    buffer_store_dwordx2 v[192:193], v183, s[56:59], s66 offen offset:112
    s_nop 1
.k3p0_kernel_end:
    s_endpgm

.globl k4p0_kernel
.p2align 8
.type k4p0_kernel,@function
k4p0_kernel:
    s_cmp_ge_u32 s2, 160
    s_cbranch_scc1 .k4p0_kernel_end
    s_load_dwordx16 s[16:31], s[0:1], 0
    s_load_dwordx4 s[32:35], s[0:1], 64
    s_load_dwordx2 s[36:37], s[0:1], 80
    s_waitcnt lgkmcnt(0)
    s_and_b32 s61, s2, 31
    s_lshl_b32 s61, s61, 6
    s_lshr_b32 s62, s2, 5
    s_lshl_b32 s62, s62, 7
    s_add_u32 s40, s36, 19193856
    s_addc_u32 s41, s37, 0
    s_and_b32 s41, s41, 0xffff
    s_mov_b32 s42, 7077888
    s_mov_b32 s43, 0x00020000
    s_add_u32 s44, s36, 5488640
    s_addc_u32 s45, s37, 0
    s_and_b32 s45, s45, 0xffff
    s_mov_b32 s46, 2211840
    s_mov_b32 s47, 0x00020000
    v_and_b32 v82, 63, v0
    v_lshrrev_b32 v83, 6, v0
    s_nop 0
    v_readfirstlane_b32 s60, v83
    s_nop 1
    s_mul_i32 s63, s60, 2048
    s_mul_i32 s64, s60, 4096
    s_mul_i32 s65, s60, 16
    s_add_u32 s65, s65, 0
    v_lshrrev_b32 v83, 3, v82
    v_add_u32 v83, s65, v83
    v_lshrrev_b32 v84, 1, v83
    v_and_b32 v84, 7, v84
    v_and_b32 v60, 7, v82
    v_xor_b32 v84, v60, v84
    v_lshlrev_b32 v84, 4, v84
    v_add_u32 v83, s61, v83
    s_mov_b32 s66, 3456
    v_mul_lo_u32 v83, v83, s66
    v_add_u32 v60, v83, v84
    s_mul_i32 s65, s60, 16
    s_add_u32 s65, s65, 8
    v_lshrrev_b32 v83, 3, v82
    v_add_u32 v83, s65, v83
    v_lshrrev_b32 v84, 1, v83
    v_and_b32 v84, 7, v84
    v_and_b32 v61, 7, v82
    v_xor_b32 v84, v61, v84
    v_lshlrev_b32 v84, 4, v84
    v_add_u32 v83, s61, v83
    s_mov_b32 s66, 3456
    v_mul_lo_u32 v83, v83, s66
    v_add_u32 v61, v83, v84
    s_mul_i32 s65, s60, 32
    s_add_u32 s65, s65, 0
    v_lshrrev_b32 v83, 3, v82
    v_add_u32 v83, s65, v83
    v_lshrrev_b32 v84, 1, v83
    v_and_b32 v84, 7, v84
    v_and_b32 v62, 7, v82
    v_xor_b32 v84, v62, v84
    v_lshlrev_b32 v84, 4, v84
    v_add_u32 v83, s62, v83
    s_mov_b32 s66, 3456
    v_mul_lo_u32 v83, v83, s66
    v_add_u32 v62, v83, v84
    s_mul_i32 s65, s60, 32
    s_add_u32 s65, s65, 8
    v_lshrrev_b32 v83, 3, v82
    v_add_u32 v83, s65, v83
    v_lshrrev_b32 v84, 1, v83
    v_and_b32 v84, 7, v84
    v_and_b32 v63, 7, v82
    v_xor_b32 v84, v63, v84
    v_lshlrev_b32 v84, 4, v84
    v_add_u32 v83, s62, v83
    s_mov_b32 s66, 3456
    v_mul_lo_u32 v83, v83, s66
    v_add_u32 v63, v83, v84
    s_mul_i32 s65, s60, 32
    s_add_u32 s65, s65, 16
    v_lshrrev_b32 v83, 3, v82
    v_add_u32 v83, s65, v83
    v_lshrrev_b32 v84, 1, v83
    v_and_b32 v84, 7, v84
    v_and_b32 v64, 7, v82
    v_xor_b32 v84, v64, v84
    v_lshlrev_b32 v84, 4, v84
    v_add_u32 v83, s62, v83
    s_mov_b32 s66, 3456
    v_mul_lo_u32 v83, v83, s66
    v_add_u32 v64, v83, v84
    s_mul_i32 s65, s60, 32
    s_add_u32 s65, s65, 24
    v_lshrrev_b32 v83, 3, v82
    v_add_u32 v83, s65, v83
    v_lshrrev_b32 v84, 1, v83
    v_and_b32 v84, 7, v84
    v_and_b32 v65, 7, v82
    v_xor_b32 v84, v65, v84
    v_lshlrev_b32 v84, 4, v84
    v_add_u32 v83, s62, v83
    s_mov_b32 s66, 3456
    v_mul_lo_u32 v83, v83, s66
    v_add_u32 v65, v83, v84
    s_and_b32 s67, s60, 1
    s_lshr_b32 s68, s60, 1
    v_lshrrev_b32 v83, 5, v82
    v_add_u32 v83, 0, v83
    v_lshrrev_b32 v84, 1, v82
    v_and_b32 v84, 7, v84
    v_xor_b32 v83, v83, v84
    v_lshlrev_b32 v83, 4, v83
    v_and_b32 v84, 31, v82
    v_lshl_add_u32 v83, v84, 7, v83
    s_mul_i32 s65, s67, 4096
    v_add_u32 v66, s65, v83
    v_add_u32 v78, 0x10000, v66
    s_mul_i32 s65, s68, 8192
    v_add_u32 v70, s65, v83
    v_add_u32 v74, 0x10000, v70
    v_lshrrev_b32 v83, 5, v82
    v_add_u32 v83, 2, v83
    v_lshrrev_b32 v84, 1, v82
    v_and_b32 v84, 7, v84
    v_xor_b32 v83, v83, v84
    v_lshlrev_b32 v83, 4, v83
    v_and_b32 v84, 31, v82
    v_lshl_add_u32 v83, v84, 7, v83
    s_mul_i32 s65, s67, 4096
    v_add_u32 v67, s65, v83
    v_add_u32 v79, 0x10000, v67
    s_mul_i32 s65, s68, 8192
    v_add_u32 v71, s65, v83
    v_add_u32 v75, 0x10000, v71
    v_lshrrev_b32 v83, 5, v82
    v_add_u32 v83, 4, v83
    v_lshrrev_b32 v84, 1, v82
    v_and_b32 v84, 7, v84
    v_xor_b32 v83, v83, v84
    v_lshlrev_b32 v83, 4, v83
    v_and_b32 v84, 31, v82
    v_lshl_add_u32 v83, v84, 7, v83
    s_mul_i32 s65, s67, 4096
    v_add_u32 v68, s65, v83
    v_add_u32 v80, 0x10000, v68
    s_mul_i32 s65, s68, 8192
    v_add_u32 v72, s65, v83
    v_add_u32 v76, 0x10000, v72
    v_lshrrev_b32 v83, 5, v82
    v_add_u32 v83, 6, v83
    v_lshrrev_b32 v84, 1, v82
    v_and_b32 v84, 7, v84
    v_xor_b32 v83, v83, v84
    v_lshlrev_b32 v83, 4, v83
    v_and_b32 v84, 31, v82
    v_lshl_add_u32 v83, v84, 7, v83
    s_mul_i32 s65, s67, 4096
    v_add_u32 v69, s65, v83
    v_add_u32 v81, 0x10000, v69
    s_mul_i32 s65, s68, 8192
    v_add_u32 v73, s65, v83
    v_add_u32 v77, 0x10000, v73
    v_mov_b32 v4, 0
    v_mov_b32 v5, 0
    v_mov_b32 v6, 0
    v_mov_b32 v7, 0
    v_mov_b32 v8, 0
    v_mov_b32 v9, 0
    v_mov_b32 v10, 0
    v_mov_b32 v11, 0
    v_mov_b32 v12, 0
    v_mov_b32 v13, 0
    v_mov_b32 v14, 0
    v_mov_b32 v15, 0
    v_mov_b32 v16, 0
    v_mov_b32 v17, 0
    v_mov_b32 v18, 0
    v_mov_b32 v19, 0
    v_mov_b32 v20, 0
    v_mov_b32 v21, 0
    v_mov_b32 v22, 0
    v_mov_b32 v23, 0
    v_mov_b32 v24, 0
    v_mov_b32 v25, 0
    v_mov_b32 v26, 0
    v_mov_b32 v27, 0
    v_mov_b32 v28, 0
    v_mov_b32 v29, 0
    v_mov_b32 v30, 0
    v_mov_b32 v31, 0
    v_mov_b32 v32, 0
    v_mov_b32 v33, 0
    v_mov_b32 v34, 0
    v_mov_b32 v35, 0
    s_mov_b32 s69, 0
    s_add_u32 m0, s63, 0
    buffer_load_dwordx4 v60, s[40:43], s69 offen lds
    s_add_u32 m0, s63, 1024
    buffer_load_dwordx4 v61, s[40:43], s69 offen lds
    s_add_u32 m0, s64, 8192
    buffer_load_dwordx4 v62, s[44:47], s69 offen lds
    s_add_u32 m0, s64, 9216
    buffer_load_dwordx4 v63, s[44:47], s69 offen lds
    s_add_u32 m0, s64, 10240
    buffer_load_dwordx4 v64, s[44:47], s69 offen lds
    s_add_u32 m0, s64, 11264
    buffer_load_dwordx4 v65, s[44:47], s69 offen lds
    s_mov_b32 s69, 128
    s_add_u32 m0, s63, 24576
    buffer_load_dwordx4 v60, s[40:43], s69 offen lds
    s_add_u32 m0, s63, 25600
    buffer_load_dwordx4 v61, s[40:43], s69 offen lds
    s_add_u32 m0, s64, 32768
    buffer_load_dwordx4 v62, s[44:47], s69 offen lds
    s_add_u32 m0, s64, 33792
    buffer_load_dwordx4 v63, s[44:47], s69 offen lds
    s_add_u32 m0, s64, 34816
    buffer_load_dwordx4 v64, s[44:47], s69 offen lds
    s_add_u32 m0, s64, 35840
    buffer_load_dwordx4 v65, s[44:47], s69 offen lds
    s_add_u32 s48, s36, 11329536
    s_addc_u32 s49, s37, 0
    s_and_b32 s49, s49, 0xffff
    s_mov_b32 s50, 2621440
    s_mov_b32 s51, 0x00020000
    s_mov_b32 s52, s30
    s_mov_b32 s53, s31
    s_and_b32 s53, s53, 0xffff
    s_mov_b32 s54, 1280
    s_mov_b32 s55, 0x00020000
    s_add_u32 s56, s36, 13950976
    s_addc_u32 s57, s37, 0
    s_and_b32 s57, s57, 0xffff
    s_mov_b32 s58, 2621440
    s_mov_b32 s59, 0x00020000
    s_add_u32 s80, s36, 8044544
    s_addc_u32 s81, s37, 0
    s_and_b32 s81, s81, 0xffff
    s_mov_b32 s82, 163840
    s_mov_b32 s83, 0x00020000
    v_lshrrev_b32 v118, 5, v82
    v_lshlrev_b32 v118, 2, v118
    s_lshl_b32 s65, s68, 6
    v_add_u32 v118, s65, v118
    v_lshlrev_b32 v119, 1, v118
    s_lshl_b32 s66, s62, 1
    buffer_load_dwordx2 v[86:87], v119, s[52:55], s66 offen offset:0
    buffer_load_dwordx2 v[88:89], v119, s[52:55], s66 offen offset:16
    buffer_load_dwordx2 v[90:91], v119, s[52:55], s66 offen offset:32
    buffer_load_dwordx2 v[92:93], v119, s[52:55], s66 offen offset:48
    buffer_load_dwordx2 v[94:95], v119, s[52:55], s66 offen offset:64
    buffer_load_dwordx2 v[96:97], v119, s[52:55], s66 offen offset:80
    buffer_load_dwordx2 v[98:99], v119, s[52:55], s66 offen offset:96
    buffer_load_dwordx2 v[100:101], v119, s[52:55], s66 offen offset:112
    v_and_b32 v120, 31, v82
    s_lshl_b32 s65, s67, 5
    v_add_u32 v120, s65, v120
    v_add_u32 v120, s61, v120
    v_mul_u32_u24 v120, 1280, v120
    v_add_u32 v120, v120, v119
    buffer_load_dwordx2 v[102:103], v120, s[48:51], s66 offen offset:0
    buffer_load_dwordx2 v[104:105], v120, s[48:51], s66 offen offset:16
    buffer_load_dwordx2 v[106:107], v120, s[48:51], s66 offen offset:32
    buffer_load_dwordx2 v[108:109], v120, s[48:51], s66 offen offset:48
    buffer_load_dwordx2 v[110:111], v120, s[48:51], s66 offen offset:64
    buffer_load_dwordx2 v[112:113], v120, s[48:51], s66 offen offset:80
    buffer_load_dwordx2 v[114:115], v120, s[48:51], s66 offen offset:96
    buffer_load_dwordx2 v[116:117], v120, s[48:51], s66 offen offset:112
    s_waitcnt vmcnt(22)
    s_barrier
    s_mov_b32 s69, 256
    s_add_u32 m0, s63, 49152
    buffer_load_dwordx4 v60, s[40:43], s69 offen lds
    s_add_u32 m0, s63, 50176
    buffer_load_dwordx4 v61, s[40:43], s69 offen lds
    s_add_u32 m0, s64, 57344
    buffer_load_dwordx4 v62, s[44:47], s69 offen lds
    s_add_u32 m0, s64, 58368
    buffer_load_dwordx4 v63, s[44:47], s69 offen lds
    s_add_u32 m0, s64, 59392
    buffer_load_dwordx4 v64, s[44:47], s69 offen lds
    s_add_u32 m0, s64, 60416
    buffer_load_dwordx4 v65, s[44:47], s69 offen lds
    ds_read_b128 v[36:39], v66 offset:0
    ds_read_b128 v[44:47], v70 offset:8192
    ds_read_b128 v[48:51], v70 offset:12288
    ds_read_b128 v[40:43], v67 offset:0
    ds_read_b128 v[52:55], v71 offset:8192
    ds_read_b128 v[56:59], v71 offset:12288
    s_waitcnt lgkmcnt(3)
    v_mfma_f32_32x32x16_bf16 v[4:19], v[44:47], v[36:39], v[4:19]
    v_mfma_f32_32x32x16_bf16 v[20:35], v[48:51], v[36:39], v[20:35]
    ds_read_b128 v[36:39], v68 offset:0
    ds_read_b128 v[44:47], v72 offset:8192
    ds_read_b128 v[48:51], v72 offset:12288
    s_waitcnt lgkmcnt(3)
    v_mfma_f32_32x32x16_bf16 v[4:19], v[52:55], v[40:43], v[4:19]
    v_mfma_f32_32x32x16_bf16 v[20:35], v[56:59], v[40:43], v[20:35]
    ds_read_b128 v[40:43], v69 offset:0
    ds_read_b128 v[52:55], v73 offset:8192
    ds_read_b128 v[56:59], v73 offset:12288
    s_waitcnt lgkmcnt(3)
    v_mfma_f32_32x32x16_bf16 v[4:19], v[44:47], v[36:39], v[4:19]
    v_mfma_f32_32x32x16_bf16 v[20:35], v[48:51], v[36:39], v[20:35]
    s_waitcnt vmcnt(22) lgkmcnt(0)
    s_barrier
    s_mov_b32 s69, 384
    s_add_u32 m0, s63, 0
    buffer_load_dwordx4 v60, s[40:43], s69 offen lds
    s_add_u32 m0, s63, 1024
    buffer_load_dwordx4 v61, s[40:43], s69 offen lds
    s_add_u32 m0, s64, 8192
    buffer_load_dwordx4 v62, s[44:47], s69 offen lds
    s_add_u32 m0, s64, 9216
    buffer_load_dwordx4 v63, s[44:47], s69 offen lds
    s_add_u32 m0, s64, 10240
    buffer_load_dwordx4 v64, s[44:47], s69 offen lds
    s_add_u32 m0, s64, 11264
    buffer_load_dwordx4 v65, s[44:47], s69 offen lds
    ds_read_b128 v[36:39], v66 offset:24576
    ds_read_b128 v[44:47], v70 offset:32768
    ds_read_b128 v[48:51], v70 offset:36864
    v_mfma_f32_32x32x16_bf16 v[4:19], v[52:55], v[40:43], v[4:19]
    v_mfma_f32_32x32x16_bf16 v[20:35], v[56:59], v[40:43], v[20:35]
    ds_read_b128 v[40:43], v67 offset:24576
    ds_read_b128 v[52:55], v71 offset:32768
    ds_read_b128 v[56:59], v71 offset:36864
    s_waitcnt lgkmcnt(3)
    v_mfma_f32_32x32x16_bf16 v[4:19], v[44:47], v[36:39], v[4:19]
    v_mfma_f32_32x32x16_bf16 v[20:35], v[48:51], v[36:39], v[20:35]
    ds_read_b128 v[36:39], v68 offset:24576
    ds_read_b128 v[44:47], v72 offset:32768
    ds_read_b128 v[48:51], v72 offset:36864
    s_waitcnt lgkmcnt(3)
    v_mfma_f32_32x32x16_bf16 v[4:19], v[52:55], v[40:43], v[4:19]
    v_mfma_f32_32x32x16_bf16 v[20:35], v[56:59], v[40:43], v[20:35]
    ds_read_b128 v[40:43], v69 offset:24576
    ds_read_b128 v[52:55], v73 offset:32768
    ds_read_b128 v[56:59], v73 offset:36864
    s_waitcnt lgkmcnt(3)
    v_mfma_f32_32x32x16_bf16 v[4:19], v[44:47], v[36:39], v[4:19]
    v_mfma_f32_32x32x16_bf16 v[20:35], v[48:51], v[36:39], v[20:35]
    s_waitcnt vmcnt(6) lgkmcnt(0)
    s_barrier
    s_mov_b32 s69, 512
    s_add_u32 m0, s63, 24576
    buffer_load_dwordx4 v60, s[40:43], s69 offen lds
    s_add_u32 m0, s63, 25600
    buffer_load_dwordx4 v61, s[40:43], s69 offen lds
    s_add_u32 m0, s64, 32768
    buffer_load_dwordx4 v62, s[44:47], s69 offen lds
    s_add_u32 m0, s64, 33792
    buffer_load_dwordx4 v63, s[44:47], s69 offen lds
    s_add_u32 m0, s64, 34816
    buffer_load_dwordx4 v64, s[44:47], s69 offen lds
    s_add_u32 m0, s64, 35840
    buffer_load_dwordx4 v65, s[44:47], s69 offen lds
    ds_read_b128 v[36:39], v66 offset:49152
    ds_read_b128 v[44:47], v70 offset:57344
    ds_read_b128 v[48:51], v70 offset:61440
    v_mfma_f32_32x32x16_bf16 v[4:19], v[52:55], v[40:43], v[4:19]
    v_mfma_f32_32x32x16_bf16 v[20:35], v[56:59], v[40:43], v[20:35]
    ds_read_b128 v[40:43], v67 offset:49152
    ds_read_b128 v[52:55], v71 offset:57344
    ds_read_b128 v[56:59], v71 offset:61440
    s_waitcnt lgkmcnt(3)
    v_mfma_f32_32x32x16_bf16 v[4:19], v[44:47], v[36:39], v[4:19]
    v_mfma_f32_32x32x16_bf16 v[20:35], v[48:51], v[36:39], v[20:35]
    ds_read_b128 v[36:39], v68 offset:49152
    ds_read_b128 v[44:47], v72 offset:57344
    ds_read_b128 v[48:51], v72 offset:61440
    s_waitcnt lgkmcnt(3)
    v_mfma_f32_32x32x16_bf16 v[4:19], v[52:55], v[40:43], v[4:19]
    v_mfma_f32_32x32x16_bf16 v[20:35], v[56:59], v[40:43], v[20:35]
    ds_read_b128 v[40:43], v69 offset:49152
    ds_read_b128 v[52:55], v73 offset:57344
    ds_read_b128 v[56:59], v73 offset:61440
    s_waitcnt lgkmcnt(3)
    v_mfma_f32_32x32x16_bf16 v[4:19], v[44:47], v[36:39], v[4:19]
    v_mfma_f32_32x32x16_bf16 v[20:35], v[48:51], v[36:39], v[20:35]
    s_waitcnt vmcnt(6) lgkmcnt(0)
    s_barrier
    s_mov_b32 s69, 640
    s_add_u32 m0, s63, 49152
    buffer_load_dwordx4 v60, s[40:43], s69 offen lds
    s_add_u32 m0, s63, 50176
    buffer_load_dwordx4 v61, s[40:43], s69 offen lds
    s_add_u32 m0, s64, 57344
    buffer_load_dwordx4 v62, s[44:47], s69 offen lds
    s_add_u32 m0, s64, 58368
    buffer_load_dwordx4 v63, s[44:47], s69 offen lds
    s_add_u32 m0, s64, 59392
    buffer_load_dwordx4 v64, s[44:47], s69 offen lds
    s_add_u32 m0, s64, 60416
    buffer_load_dwordx4 v65, s[44:47], s69 offen lds
    ds_read_b128 v[36:39], v66 offset:0
    ds_read_b128 v[44:47], v70 offset:8192
    ds_read_b128 v[48:51], v70 offset:12288
    v_mfma_f32_32x32x16_bf16 v[4:19], v[52:55], v[40:43], v[4:19]
    v_mfma_f32_32x32x16_bf16 v[20:35], v[56:59], v[40:43], v[20:35]
    ds_read_b128 v[40:43], v67 offset:0
    ds_read_b128 v[52:55], v71 offset:8192
    ds_read_b128 v[56:59], v71 offset:12288
    s_waitcnt lgkmcnt(3)
    v_mfma_f32_32x32x16_bf16 v[4:19], v[44:47], v[36:39], v[4:19]
    v_mfma_f32_32x32x16_bf16 v[20:35], v[48:51], v[36:39], v[20:35]
    ds_read_b128 v[36:39], v68 offset:0
    ds_read_b128 v[44:47], v72 offset:8192
    ds_read_b128 v[48:51], v72 offset:12288
    s_waitcnt lgkmcnt(3)
    v_mfma_f32_32x32x16_bf16 v[4:19], v[52:55], v[40:43], v[4:19]
    v_mfma_f32_32x32x16_bf16 v[20:35], v[56:59], v[40:43], v[20:35]
    ds_read_b128 v[40:43], v69 offset:0
    ds_read_b128 v[52:55], v73 offset:8192
    ds_read_b128 v[56:59], v73 offset:12288
    s_waitcnt lgkmcnt(3)
    v_mfma_f32_32x32x16_bf16 v[4:19], v[44:47], v[36:39], v[4:19]
    v_mfma_f32_32x32x16_bf16 v[20:35], v[48:51], v[36:39], v[20:35]
    s_waitcnt vmcnt(6) lgkmcnt(0)
    s_barrier
    s_mov_b32 s69, 768
    s_add_u32 m0, s63, 0
    buffer_load_dwordx4 v60, s[40:43], s69 offen lds
    s_add_u32 m0, s63, 1024
    buffer_load_dwordx4 v61, s[40:43], s69 offen lds
    s_add_u32 m0, s64, 8192
    buffer_load_dwordx4 v62, s[44:47], s69 offen lds
    s_add_u32 m0, s64, 9216
    buffer_load_dwordx4 v63, s[44:47], s69 offen lds
    s_add_u32 m0, s64, 10240
    buffer_load_dwordx4 v64, s[44:47], s69 offen lds
    s_add_u32 m0, s64, 11264
    buffer_load_dwordx4 v65, s[44:47], s69 offen lds
    ds_read_b128 v[36:39], v66 offset:24576
    ds_read_b128 v[44:47], v70 offset:32768
    ds_read_b128 v[48:51], v70 offset:36864
    v_mfma_f32_32x32x16_bf16 v[4:19], v[52:55], v[40:43], v[4:19]
    v_mfma_f32_32x32x16_bf16 v[20:35], v[56:59], v[40:43], v[20:35]
    ds_read_b128 v[40:43], v67 offset:24576
    ds_read_b128 v[52:55], v71 offset:32768
    ds_read_b128 v[56:59], v71 offset:36864
    s_waitcnt lgkmcnt(3)
    v_mfma_f32_32x32x16_bf16 v[4:19], v[44:47], v[36:39], v[4:19]
    v_mfma_f32_32x32x16_bf16 v[20:35], v[48:51], v[36:39], v[20:35]
    ds_read_b128 v[36:39], v68 offset:24576
    ds_read_b128 v[44:47], v72 offset:32768
    ds_read_b128 v[48:51], v72 offset:36864
    s_waitcnt lgkmcnt(3)
    v_mfma_f32_32x32x16_bf16 v[4:19], v[52:55], v[40:43], v[4:19]
    v_mfma_f32_32x32x16_bf16 v[20:35], v[56:59], v[40:43], v[20:35]
    ds_read_b128 v[40:43], v69 offset:24576
    ds_read_b128 v[52:55], v73 offset:32768
    ds_read_b128 v[56:59], v73 offset:36864
    s_waitcnt lgkmcnt(3)
    v_mfma_f32_32x32x16_bf16 v[4:19], v[44:47], v[36:39], v[4:19]
    v_mfma_f32_32x32x16_bf16 v[20:35], v[48:51], v[36:39], v[20:35]
    s_waitcnt vmcnt(6) lgkmcnt(0)
    s_barrier
    s_mov_b32 s69, 896
    s_add_u32 m0, s63, 24576
    buffer_load_dwordx4 v60, s[40:43], s69 offen lds
    s_add_u32 m0, s63, 25600
    buffer_load_dwordx4 v61, s[40:43], s69 offen lds
    s_add_u32 m0, s64, 32768
    buffer_load_dwordx4 v62, s[44:47], s69 offen lds
    s_add_u32 m0, s64, 33792
    buffer_load_dwordx4 v63, s[44:47], s69 offen lds
    s_add_u32 m0, s64, 34816
    buffer_load_dwordx4 v64, s[44:47], s69 offen lds
    s_add_u32 m0, s64, 35840
    buffer_load_dwordx4 v65, s[44:47], s69 offen lds
    ds_read_b128 v[36:39], v66 offset:49152
    ds_read_b128 v[44:47], v70 offset:57344
    ds_read_b128 v[48:51], v70 offset:61440
    v_mfma_f32_32x32x16_bf16 v[4:19], v[52:55], v[40:43], v[4:19]
    v_mfma_f32_32x32x16_bf16 v[20:35], v[56:59], v[40:43], v[20:35]
    ds_read_b128 v[40:43], v67 offset:49152
    ds_read_b128 v[52:55], v71 offset:57344
    ds_read_b128 v[56:59], v71 offset:61440
    s_waitcnt lgkmcnt(3)
    v_mfma_f32_32x32x16_bf16 v[4:19], v[44:47], v[36:39], v[4:19]
    v_mfma_f32_32x32x16_bf16 v[20:35], v[48:51], v[36:39], v[20:35]
    ds_read_b128 v[36:39], v68 offset:49152
    ds_read_b128 v[44:47], v72 offset:57344
    ds_read_b128 v[48:51], v72 offset:61440
    s_waitcnt lgkmcnt(3)
    v_mfma_f32_32x32x16_bf16 v[4:19], v[52:55], v[40:43], v[4:19]
    v_mfma_f32_32x32x16_bf16 v[20:35], v[56:59], v[40:43], v[20:35]
    ds_read_b128 v[40:43], v69 offset:49152
    ds_read_b128 v[52:55], v73 offset:57344
    ds_read_b128 v[56:59], v73 offset:61440
    s_waitcnt lgkmcnt(3)
    v_mfma_f32_32x32x16_bf16 v[4:19], v[44:47], v[36:39], v[4:19]
    v_mfma_f32_32x32x16_bf16 v[20:35], v[48:51], v[36:39], v[20:35]
    s_waitcnt vmcnt(6) lgkmcnt(0)
    s_barrier
    s_mov_b32 s69, 1024
    s_add_u32 m0, s63, 49152
    buffer_load_dwordx4 v60, s[40:43], s69 offen lds
    s_add_u32 m0, s63, 50176
    buffer_load_dwordx4 v61, s[40:43], s69 offen lds
    s_add_u32 m0, s64, 57344
    buffer_load_dwordx4 v62, s[44:47], s69 offen lds
    s_add_u32 m0, s64, 58368
    buffer_load_dwordx4 v63, s[44:47], s69 offen lds
    s_add_u32 m0, s64, 59392
    buffer_load_dwordx4 v64, s[44:47], s69 offen lds
    s_add_u32 m0, s64, 60416
    buffer_load_dwordx4 v65, s[44:47], s69 offen lds
    ds_read_b128 v[36:39], v66 offset:0
    ds_read_b128 v[44:47], v70 offset:8192
    ds_read_b128 v[48:51], v70 offset:12288
    v_mfma_f32_32x32x16_bf16 v[4:19], v[52:55], v[40:43], v[4:19]
    v_mfma_f32_32x32x16_bf16 v[20:35], v[56:59], v[40:43], v[20:35]
    ds_read_b128 v[40:43], v67 offset:0
    ds_read_b128 v[52:55], v71 offset:8192
    ds_read_b128 v[56:59], v71 offset:12288
    s_waitcnt lgkmcnt(3)
    v_mfma_f32_32x32x16_bf16 v[4:19], v[44:47], v[36:39], v[4:19]
    v_mfma_f32_32x32x16_bf16 v[20:35], v[48:51], v[36:39], v[20:35]
    ds_read_b128 v[36:39], v68 offset:0
    ds_read_b128 v[44:47], v72 offset:8192
    ds_read_b128 v[48:51], v72 offset:12288
    s_waitcnt lgkmcnt(3)
    v_mfma_f32_32x32x16_bf16 v[4:19], v[52:55], v[40:43], v[4:19]
    v_mfma_f32_32x32x16_bf16 v[20:35], v[56:59], v[40:43], v[20:35]
    ds_read_b128 v[40:43], v69 offset:0
    ds_read_b128 v[52:55], v73 offset:8192
    ds_read_b128 v[56:59], v73 offset:12288
    s_waitcnt lgkmcnt(3)
    v_mfma_f32_32x32x16_bf16 v[4:19], v[44:47], v[36:39], v[4:19]
    v_mfma_f32_32x32x16_bf16 v[20:35], v[48:51], v[36:39], v[20:35]
    s_waitcnt vmcnt(6) lgkmcnt(0)
    s_barrier
    s_mov_b32 s69, 1152
    s_add_u32 m0, s63, 0
    buffer_load_dwordx4 v60, s[40:43], s69 offen lds
    s_add_u32 m0, s63, 1024
    buffer_load_dwordx4 v61, s[40:43], s69 offen lds
    s_add_u32 m0, s64, 8192
    buffer_load_dwordx4 v62, s[44:47], s69 offen lds
    s_add_u32 m0, s64, 9216
    buffer_load_dwordx4 v63, s[44:47], s69 offen lds
    s_add_u32 m0, s64, 10240
    buffer_load_dwordx4 v64, s[44:47], s69 offen lds
    s_add_u32 m0, s64, 11264
    buffer_load_dwordx4 v65, s[44:47], s69 offen lds
    ds_read_b128 v[36:39], v66 offset:24576
    ds_read_b128 v[44:47], v70 offset:32768
    ds_read_b128 v[48:51], v70 offset:36864
    v_mfma_f32_32x32x16_bf16 v[4:19], v[52:55], v[40:43], v[4:19]
    v_mfma_f32_32x32x16_bf16 v[20:35], v[56:59], v[40:43], v[20:35]
    ds_read_b128 v[40:43], v67 offset:24576
    ds_read_b128 v[52:55], v71 offset:32768
    ds_read_b128 v[56:59], v71 offset:36864
    s_waitcnt lgkmcnt(3)
    v_mfma_f32_32x32x16_bf16 v[4:19], v[44:47], v[36:39], v[4:19]
    v_mfma_f32_32x32x16_bf16 v[20:35], v[48:51], v[36:39], v[20:35]
    ds_read_b128 v[36:39], v68 offset:24576
    ds_read_b128 v[44:47], v72 offset:32768
    ds_read_b128 v[48:51], v72 offset:36864
    s_waitcnt lgkmcnt(3)
    v_mfma_f32_32x32x16_bf16 v[4:19], v[52:55], v[40:43], v[4:19]
    v_mfma_f32_32x32x16_bf16 v[20:35], v[56:59], v[40:43], v[20:35]
    ds_read_b128 v[40:43], v69 offset:24576
    ds_read_b128 v[52:55], v73 offset:32768
    ds_read_b128 v[56:59], v73 offset:36864
    s_waitcnt lgkmcnt(3)
    v_mfma_f32_32x32x16_bf16 v[4:19], v[44:47], v[36:39], v[4:19]
    v_mfma_f32_32x32x16_bf16 v[20:35], v[48:51], v[36:39], v[20:35]
    s_waitcnt vmcnt(6) lgkmcnt(0)
    s_barrier
    s_mov_b32 s69, 1280
    s_add_u32 m0, s63, 24576
    buffer_load_dwordx4 v60, s[40:43], s69 offen lds
    s_add_u32 m0, s63, 25600
    buffer_load_dwordx4 v61, s[40:43], s69 offen lds
    s_add_u32 m0, s64, 32768
    buffer_load_dwordx4 v62, s[44:47], s69 offen lds
    s_add_u32 m0, s64, 33792
    buffer_load_dwordx4 v63, s[44:47], s69 offen lds
    s_add_u32 m0, s64, 34816
    buffer_load_dwordx4 v64, s[44:47], s69 offen lds
    s_add_u32 m0, s64, 35840
    buffer_load_dwordx4 v65, s[44:47], s69 offen lds
    ds_read_b128 v[36:39], v66 offset:49152
    ds_read_b128 v[44:47], v70 offset:57344
    ds_read_b128 v[48:51], v70 offset:61440
    v_mfma_f32_32x32x16_bf16 v[4:19], v[52:55], v[40:43], v[4:19]
    v_mfma_f32_32x32x16_bf16 v[20:35], v[56:59], v[40:43], v[20:35]
    ds_read_b128 v[40:43], v67 offset:49152
    ds_read_b128 v[52:55], v71 offset:57344
    ds_read_b128 v[56:59], v71 offset:61440
    s_waitcnt lgkmcnt(3)
    v_mfma_f32_32x32x16_bf16 v[4:19], v[44:47], v[36:39], v[4:19]
    v_mfma_f32_32x32x16_bf16 v[20:35], v[48:51], v[36:39], v[20:35]
    ds_read_b128 v[36:39], v68 offset:49152
    ds_read_b128 v[44:47], v72 offset:57344
    ds_read_b128 v[48:51], v72 offset:61440
    s_waitcnt lgkmcnt(3)
    v_mfma_f32_32x32x16_bf16 v[4:19], v[52:55], v[40:43], v[4:19]
    v_mfma_f32_32x32x16_bf16 v[20:35], v[56:59], v[40:43], v[20:35]
    ds_read_b128 v[40:43], v69 offset:49152
    ds_read_b128 v[52:55], v73 offset:57344
    ds_read_b128 v[56:59], v73 offset:61440
    s_waitcnt lgkmcnt(3)
    v_mfma_f32_32x32x16_bf16 v[4:19], v[44:47], v[36:39], v[4:19]
    v_mfma_f32_32x32x16_bf16 v[20:35], v[48:51], v[36:39], v[20:35]
    s_waitcnt vmcnt(6) lgkmcnt(0)
    s_barrier
    s_mov_b32 s69, 1408
    s_add_u32 m0, s63, 49152
    buffer_load_dwordx4 v60, s[40:43], s69 offen lds
    s_add_u32 m0, s63, 50176
    buffer_load_dwordx4 v61, s[40:43], s69 offen lds
    s_add_u32 m0, s64, 57344
    buffer_load_dwordx4 v62, s[44:47], s69 offen lds
    s_add_u32 m0, s64, 58368
    buffer_load_dwordx4 v63, s[44:47], s69 offen lds
    s_add_u32 m0, s64, 59392
    buffer_load_dwordx4 v64, s[44:47], s69 offen lds
    s_add_u32 m0, s64, 60416
    buffer_load_dwordx4 v65, s[44:47], s69 offen lds
    ds_read_b128 v[36:39], v66 offset:0
    ds_read_b128 v[44:47], v70 offset:8192
    ds_read_b128 v[48:51], v70 offset:12288
    v_mfma_f32_32x32x16_bf16 v[4:19], v[52:55], v[40:43], v[4:19]
    v_mfma_f32_32x32x16_bf16 v[20:35], v[56:59], v[40:43], v[20:35]
    ds_read_b128 v[40:43], v67 offset:0
    ds_read_b128 v[52:55], v71 offset:8192
    ds_read_b128 v[56:59], v71 offset:12288
    s_waitcnt lgkmcnt(3)
    v_mfma_f32_32x32x16_bf16 v[4:19], v[44:47], v[36:39], v[4:19]
    v_mfma_f32_32x32x16_bf16 v[20:35], v[48:51], v[36:39], v[20:35]
    ds_read_b128 v[36:39], v68 offset:0
    ds_read_b128 v[44:47], v72 offset:8192
    ds_read_b128 v[48:51], v72 offset:12288
    s_waitcnt lgkmcnt(3)
    v_mfma_f32_32x32x16_bf16 v[4:19], v[52:55], v[40:43], v[4:19]
    v_mfma_f32_32x32x16_bf16 v[20:35], v[56:59], v[40:43], v[20:35]
    ds_read_b128 v[40:43], v69 offset:0
    ds_read_b128 v[52:55], v73 offset:8192
    ds_read_b128 v[56:59], v73 offset:12288
    s_waitcnt lgkmcnt(3)
    v_mfma_f32_32x32x16_bf16 v[4:19], v[44:47], v[36:39], v[4:19]
    v_mfma_f32_32x32x16_bf16 v[20:35], v[48:51], v[36:39], v[20:35]
    s_waitcnt vmcnt(6) lgkmcnt(0)
    s_barrier
    s_mov_b32 s69, 1536
    s_add_u32 m0, s63, 0
    buffer_load_dwordx4 v60, s[40:43], s69 offen lds
    s_add_u32 m0, s63, 1024
    buffer_load_dwordx4 v61, s[40:43], s69 offen lds
    s_add_u32 m0, s64, 8192
    buffer_load_dwordx4 v62, s[44:47], s69 offen lds
    s_add_u32 m0, s64, 9216
    buffer_load_dwordx4 v63, s[44:47], s69 offen lds
    s_add_u32 m0, s64, 10240
    buffer_load_dwordx4 v64, s[44:47], s69 offen lds
    s_add_u32 m0, s64, 11264
    buffer_load_dwordx4 v65, s[44:47], s69 offen lds
    ds_read_b128 v[36:39], v66 offset:24576
    ds_read_b128 v[44:47], v70 offset:32768
    ds_read_b128 v[48:51], v70 offset:36864
    v_mfma_f32_32x32x16_bf16 v[4:19], v[52:55], v[40:43], v[4:19]
    v_mfma_f32_32x32x16_bf16 v[20:35], v[56:59], v[40:43], v[20:35]
    ds_read_b128 v[40:43], v67 offset:24576
    ds_read_b128 v[52:55], v71 offset:32768
    ds_read_b128 v[56:59], v71 offset:36864
    s_waitcnt lgkmcnt(3)
    v_mfma_f32_32x32x16_bf16 v[4:19], v[44:47], v[36:39], v[4:19]
    v_mfma_f32_32x32x16_bf16 v[20:35], v[48:51], v[36:39], v[20:35]
    ds_read_b128 v[36:39], v68 offset:24576
    ds_read_b128 v[44:47], v72 offset:32768
    ds_read_b128 v[48:51], v72 offset:36864
    s_waitcnt lgkmcnt(3)
    v_mfma_f32_32x32x16_bf16 v[4:19], v[52:55], v[40:43], v[4:19]
    v_mfma_f32_32x32x16_bf16 v[20:35], v[56:59], v[40:43], v[20:35]
    ds_read_b128 v[40:43], v69 offset:24576
    ds_read_b128 v[52:55], v73 offset:32768
    ds_read_b128 v[56:59], v73 offset:36864
    s_waitcnt lgkmcnt(3)
    v_mfma_f32_32x32x16_bf16 v[4:19], v[44:47], v[36:39], v[4:19]
    v_mfma_f32_32x32x16_bf16 v[20:35], v[48:51], v[36:39], v[20:35]
    s_waitcnt vmcnt(6) lgkmcnt(0)
    s_barrier
    s_mov_b32 s69, 1664
    s_add_u32 m0, s63, 24576
    buffer_load_dwordx4 v60, s[40:43], s69 offen lds
    s_add_u32 m0, s63, 25600
    buffer_load_dwordx4 v61, s[40:43], s69 offen lds
    s_add_u32 m0, s64, 32768
    buffer_load_dwordx4 v62, s[44:47], s69 offen lds
    s_add_u32 m0, s64, 33792
    buffer_load_dwordx4 v63, s[44:47], s69 offen lds
    s_add_u32 m0, s64, 34816
    buffer_load_dwordx4 v64, s[44:47], s69 offen lds
    s_add_u32 m0, s64, 35840
    buffer_load_dwordx4 v65, s[44:47], s69 offen lds
    ds_read_b128 v[36:39], v66 offset:49152
    ds_read_b128 v[44:47], v70 offset:57344
    ds_read_b128 v[48:51], v70 offset:61440
    v_mfma_f32_32x32x16_bf16 v[4:19], v[52:55], v[40:43], v[4:19]
    v_mfma_f32_32x32x16_bf16 v[20:35], v[56:59], v[40:43], v[20:35]
    ds_read_b128 v[40:43], v67 offset:49152
    ds_read_b128 v[52:55], v71 offset:57344
    ds_read_b128 v[56:59], v71 offset:61440
    s_waitcnt lgkmcnt(3)
    v_mfma_f32_32x32x16_bf16 v[4:19], v[44:47], v[36:39], v[4:19]
    v_mfma_f32_32x32x16_bf16 v[20:35], v[48:51], v[36:39], v[20:35]
    ds_read_b128 v[36:39], v68 offset:49152
    ds_read_b128 v[44:47], v72 offset:57344
    ds_read_b128 v[48:51], v72 offset:61440
    s_waitcnt lgkmcnt(3)
    v_mfma_f32_32x32x16_bf16 v[4:19], v[52:55], v[40:43], v[4:19]
    v_mfma_f32_32x32x16_bf16 v[20:35], v[56:59], v[40:43], v[20:35]
    ds_read_b128 v[40:43], v69 offset:49152
    ds_read_b128 v[52:55], v73 offset:57344
    ds_read_b128 v[56:59], v73 offset:61440
    s_waitcnt lgkmcnt(3)
    v_mfma_f32_32x32x16_bf16 v[4:19], v[44:47], v[36:39], v[4:19]
    v_mfma_f32_32x32x16_bf16 v[20:35], v[48:51], v[36:39], v[20:35]
    s_waitcnt vmcnt(6) lgkmcnt(0)
    s_barrier
    s_mov_b32 s69, 1792
    s_add_u32 m0, s63, 49152
    buffer_load_dwordx4 v60, s[40:43], s69 offen lds
    s_add_u32 m0, s63, 50176
    buffer_load_dwordx4 v61, s[40:43], s69 offen lds
    s_add_u32 m0, s64, 57344
    buffer_load_dwordx4 v62, s[44:47], s69 offen lds
    s_add_u32 m0, s64, 58368
    buffer_load_dwordx4 v63, s[44:47], s69 offen lds
    s_add_u32 m0, s64, 59392
    buffer_load_dwordx4 v64, s[44:47], s69 offen lds
    s_add_u32 m0, s64, 60416
    buffer_load_dwordx4 v65, s[44:47], s69 offen lds
    ds_read_b128 v[36:39], v66 offset:0
    ds_read_b128 v[44:47], v70 offset:8192
    ds_read_b128 v[48:51], v70 offset:12288
    v_mfma_f32_32x32x16_bf16 v[4:19], v[52:55], v[40:43], v[4:19]
    v_mfma_f32_32x32x16_bf16 v[20:35], v[56:59], v[40:43], v[20:35]
    ds_read_b128 v[40:43], v67 offset:0
    ds_read_b128 v[52:55], v71 offset:8192
    ds_read_b128 v[56:59], v71 offset:12288
    s_waitcnt lgkmcnt(3)
    v_mfma_f32_32x32x16_bf16 v[4:19], v[44:47], v[36:39], v[4:19]
    v_mfma_f32_32x32x16_bf16 v[20:35], v[48:51], v[36:39], v[20:35]
    ds_read_b128 v[36:39], v68 offset:0
    ds_read_b128 v[44:47], v72 offset:8192
    ds_read_b128 v[48:51], v72 offset:12288
    s_waitcnt lgkmcnt(3)
    v_mfma_f32_32x32x16_bf16 v[4:19], v[52:55], v[40:43], v[4:19]
    v_mfma_f32_32x32x16_bf16 v[20:35], v[56:59], v[40:43], v[20:35]
    ds_read_b128 v[40:43], v69 offset:0
    ds_read_b128 v[52:55], v73 offset:8192
    ds_read_b128 v[56:59], v73 offset:12288
    s_waitcnt lgkmcnt(3)
    v_mfma_f32_32x32x16_bf16 v[4:19], v[44:47], v[36:39], v[4:19]
    v_mfma_f32_32x32x16_bf16 v[20:35], v[48:51], v[36:39], v[20:35]
    s_waitcnt vmcnt(6) lgkmcnt(0)
    s_barrier
    s_mov_b32 s69, 1920
    s_add_u32 m0, s63, 0
    buffer_load_dwordx4 v60, s[40:43], s69 offen lds
    s_add_u32 m0, s63, 1024
    buffer_load_dwordx4 v61, s[40:43], s69 offen lds
    s_add_u32 m0, s64, 8192
    buffer_load_dwordx4 v62, s[44:47], s69 offen lds
    s_add_u32 m0, s64, 9216
    buffer_load_dwordx4 v63, s[44:47], s69 offen lds
    s_add_u32 m0, s64, 10240
    buffer_load_dwordx4 v64, s[44:47], s69 offen lds
    s_add_u32 m0, s64, 11264
    buffer_load_dwordx4 v65, s[44:47], s69 offen lds
    ds_read_b128 v[36:39], v66 offset:24576
    ds_read_b128 v[44:47], v70 offset:32768
    ds_read_b128 v[48:51], v70 offset:36864
    v_mfma_f32_32x32x16_bf16 v[4:19], v[52:55], v[40:43], v[4:19]
    v_mfma_f32_32x32x16_bf16 v[20:35], v[56:59], v[40:43], v[20:35]
    ds_read_b128 v[40:43], v67 offset:24576
    ds_read_b128 v[52:55], v71 offset:32768
    ds_read_b128 v[56:59], v71 offset:36864
    s_waitcnt lgkmcnt(3)
    v_mfma_f32_32x32x16_bf16 v[4:19], v[44:47], v[36:39], v[4:19]
    v_mfma_f32_32x32x16_bf16 v[20:35], v[48:51], v[36:39], v[20:35]
    ds_read_b128 v[36:39], v68 offset:24576
    ds_read_b128 v[44:47], v72 offset:32768
    ds_read_b128 v[48:51], v72 offset:36864
    s_waitcnt lgkmcnt(3)
    v_mfma_f32_32x32x16_bf16 v[4:19], v[52:55], v[40:43], v[4:19]
    v_mfma_f32_32x32x16_bf16 v[20:35], v[56:59], v[40:43], v[20:35]
    ds_read_b128 v[40:43], v69 offset:24576
    ds_read_b128 v[52:55], v73 offset:32768
    ds_read_b128 v[56:59], v73 offset:36864
    s_waitcnt lgkmcnt(3)
    v_mfma_f32_32x32x16_bf16 v[4:19], v[44:47], v[36:39], v[4:19]
    v_mfma_f32_32x32x16_bf16 v[20:35], v[48:51], v[36:39], v[20:35]
    s_waitcnt vmcnt(6) lgkmcnt(0)
    s_barrier
    s_mov_b32 s69, 2048
    s_add_u32 m0, s63, 24576
    buffer_load_dwordx4 v60, s[40:43], s69 offen lds
    s_add_u32 m0, s63, 25600
    buffer_load_dwordx4 v61, s[40:43], s69 offen lds
    s_add_u32 m0, s64, 32768
    buffer_load_dwordx4 v62, s[44:47], s69 offen lds
    s_add_u32 m0, s64, 33792
    buffer_load_dwordx4 v63, s[44:47], s69 offen lds
    s_add_u32 m0, s64, 34816
    buffer_load_dwordx4 v64, s[44:47], s69 offen lds
    s_add_u32 m0, s64, 35840
    buffer_load_dwordx4 v65, s[44:47], s69 offen lds
    ds_read_b128 v[36:39], v66 offset:49152
    ds_read_b128 v[44:47], v70 offset:57344
    ds_read_b128 v[48:51], v70 offset:61440
    v_mfma_f32_32x32x16_bf16 v[4:19], v[52:55], v[40:43], v[4:19]
    v_mfma_f32_32x32x16_bf16 v[20:35], v[56:59], v[40:43], v[20:35]
    ds_read_b128 v[40:43], v67 offset:49152
    ds_read_b128 v[52:55], v71 offset:57344
    ds_read_b128 v[56:59], v71 offset:61440
    s_waitcnt lgkmcnt(3)
    v_mfma_f32_32x32x16_bf16 v[4:19], v[44:47], v[36:39], v[4:19]
    v_mfma_f32_32x32x16_bf16 v[20:35], v[48:51], v[36:39], v[20:35]
    ds_read_b128 v[36:39], v68 offset:49152
    ds_read_b128 v[44:47], v72 offset:57344
    ds_read_b128 v[48:51], v72 offset:61440
    s_waitcnt lgkmcnt(3)
    v_mfma_f32_32x32x16_bf16 v[4:19], v[52:55], v[40:43], v[4:19]
    v_mfma_f32_32x32x16_bf16 v[20:35], v[56:59], v[40:43], v[20:35]
    ds_read_b128 v[40:43], v69 offset:49152
    ds_read_b128 v[52:55], v73 offset:57344
    ds_read_b128 v[56:59], v73 offset:61440
    s_waitcnt lgkmcnt(3)
    v_mfma_f32_32x32x16_bf16 v[4:19], v[44:47], v[36:39], v[4:19]
    v_mfma_f32_32x32x16_bf16 v[20:35], v[48:51], v[36:39], v[20:35]
    s_waitcnt vmcnt(6) lgkmcnt(0)
    s_barrier
    s_mov_b32 s69, 2176
    s_add_u32 m0, s63, 49152
    buffer_load_dwordx4 v60, s[40:43], s69 offen lds
    s_add_u32 m0, s63, 50176
    buffer_load_dwordx4 v61, s[40:43], s69 offen lds
    s_add_u32 m0, s64, 57344
    buffer_load_dwordx4 v62, s[44:47], s69 offen lds
    s_add_u32 m0, s64, 58368
    buffer_load_dwordx4 v63, s[44:47], s69 offen lds
    s_add_u32 m0, s64, 59392
    buffer_load_dwordx4 v64, s[44:47], s69 offen lds
    s_add_u32 m0, s64, 60416
    buffer_load_dwordx4 v65, s[44:47], s69 offen lds
    ds_read_b128 v[36:39], v66 offset:0
    ds_read_b128 v[44:47], v70 offset:8192
    ds_read_b128 v[48:51], v70 offset:12288
    v_mfma_f32_32x32x16_bf16 v[4:19], v[52:55], v[40:43], v[4:19]
    v_mfma_f32_32x32x16_bf16 v[20:35], v[56:59], v[40:43], v[20:35]
    ds_read_b128 v[40:43], v67 offset:0
    ds_read_b128 v[52:55], v71 offset:8192
    ds_read_b128 v[56:59], v71 offset:12288
    s_waitcnt lgkmcnt(3)
    v_mfma_f32_32x32x16_bf16 v[4:19], v[44:47], v[36:39], v[4:19]
    v_mfma_f32_32x32x16_bf16 v[20:35], v[48:51], v[36:39], v[20:35]
    ds_read_b128 v[36:39], v68 offset:0
    ds_read_b128 v[44:47], v72 offset:8192
    ds_read_b128 v[48:51], v72 offset:12288
    s_waitcnt lgkmcnt(3)
    v_mfma_f32_32x32x16_bf16 v[4:19], v[52:55], v[40:43], v[4:19]
    v_mfma_f32_32x32x16_bf16 v[20:35], v[56:59], v[40:43], v[20:35]
    ds_read_b128 v[40:43], v69 offset:0
    ds_read_b128 v[52:55], v73 offset:8192
    ds_read_b128 v[56:59], v73 offset:12288
    s_waitcnt lgkmcnt(3)
    v_mfma_f32_32x32x16_bf16 v[4:19], v[44:47], v[36:39], v[4:19]
    v_mfma_f32_32x32x16_bf16 v[20:35], v[48:51], v[36:39], v[20:35]
    s_waitcnt vmcnt(6) lgkmcnt(0)
    s_barrier
    s_mov_b32 s69, 2304
    s_add_u32 m0, s63, 0
    buffer_load_dwordx4 v60, s[40:43], s69 offen lds
    s_add_u32 m0, s63, 1024
    buffer_load_dwordx4 v61, s[40:43], s69 offen lds
    s_add_u32 m0, s64, 8192
    buffer_load_dwordx4 v62, s[44:47], s69 offen lds
    s_add_u32 m0, s64, 9216
    buffer_load_dwordx4 v63, s[44:47], s69 offen lds
    s_add_u32 m0, s64, 10240
    buffer_load_dwordx4 v64, s[44:47], s69 offen lds
    s_add_u32 m0, s64, 11264
    buffer_load_dwordx4 v65, s[44:47], s69 offen lds
    ds_read_b128 v[36:39], v66 offset:24576
    ds_read_b128 v[44:47], v70 offset:32768
    ds_read_b128 v[48:51], v70 offset:36864
    v_mfma_f32_32x32x16_bf16 v[4:19], v[52:55], v[40:43], v[4:19]
    v_mfma_f32_32x32x16_bf16 v[20:35], v[56:59], v[40:43], v[20:35]
    ds_read_b128 v[40:43], v67 offset:24576
    ds_read_b128 v[52:55], v71 offset:32768
    ds_read_b128 v[56:59], v71 offset:36864
    s_waitcnt lgkmcnt(3)
    v_mfma_f32_32x32x16_bf16 v[4:19], v[44:47], v[36:39], v[4:19]
    v_mfma_f32_32x32x16_bf16 v[20:35], v[48:51], v[36:39], v[20:35]
    ds_read_b128 v[36:39], v68 offset:24576
    ds_read_b128 v[44:47], v72 offset:32768
    ds_read_b128 v[48:51], v72 offset:36864
    s_waitcnt lgkmcnt(3)
    v_mfma_f32_32x32x16_bf16 v[4:19], v[52:55], v[40:43], v[4:19]
    v_mfma_f32_32x32x16_bf16 v[20:35], v[56:59], v[40:43], v[20:35]
    ds_read_b128 v[40:43], v69 offset:24576
    ds_read_b128 v[52:55], v73 offset:32768
    ds_read_b128 v[56:59], v73 offset:36864
    s_waitcnt lgkmcnt(3)
    v_mfma_f32_32x32x16_bf16 v[4:19], v[44:47], v[36:39], v[4:19]
    v_mfma_f32_32x32x16_bf16 v[20:35], v[48:51], v[36:39], v[20:35]
    s_waitcnt vmcnt(6) lgkmcnt(0)
    s_barrier
    s_mov_b32 s69, 2432
    s_add_u32 m0, s63, 24576
    buffer_load_dwordx4 v60, s[40:43], s69 offen lds
    s_add_u32 m0, s63, 25600
    buffer_load_dwordx4 v61, s[40:43], s69 offen lds
    s_add_u32 m0, s64, 32768
    buffer_load_dwordx4 v62, s[44:47], s69 offen lds
    s_add_u32 m0, s64, 33792
    buffer_load_dwordx4 v63, s[44:47], s69 offen lds
    s_add_u32 m0, s64, 34816
    buffer_load_dwordx4 v64, s[44:47], s69 offen lds
    s_add_u32 m0, s64, 35840
    buffer_load_dwordx4 v65, s[44:47], s69 offen lds
    ds_read_b128 v[36:39], v66 offset:49152
    ds_read_b128 v[44:47], v70 offset:57344
    ds_read_b128 v[48:51], v70 offset:61440
    v_mfma_f32_32x32x16_bf16 v[4:19], v[52:55], v[40:43], v[4:19]
    v_mfma_f32_32x32x16_bf16 v[20:35], v[56:59], v[40:43], v[20:35]
    ds_read_b128 v[40:43], v67 offset:49152
    ds_read_b128 v[52:55], v71 offset:57344
    ds_read_b128 v[56:59], v71 offset:61440
    s_waitcnt lgkmcnt(3)
    v_mfma_f32_32x32x16_bf16 v[4:19], v[44:47], v[36:39], v[4:19]
    v_mfma_f32_32x32x16_bf16 v[20:35], v[48:51], v[36:39], v[20:35]
    ds_read_b128 v[36:39], v68 offset:49152
    ds_read_b128 v[44:47], v72 offset:57344
    ds_read_b128 v[48:51], v72 offset:61440
    s_waitcnt lgkmcnt(3)
    v_mfma_f32_32x32x16_bf16 v[4:19], v[52:55], v[40:43], v[4:19]
    v_mfma_f32_32x32x16_bf16 v[20:35], v[56:59], v[40:43], v[20:35]
    ds_read_b128 v[40:43], v69 offset:49152
    ds_read_b128 v[52:55], v73 offset:57344
    ds_read_b128 v[56:59], v73 offset:61440
    s_waitcnt lgkmcnt(3)
    v_mfma_f32_32x32x16_bf16 v[4:19], v[44:47], v[36:39], v[4:19]
    v_mfma_f32_32x32x16_bf16 v[20:35], v[48:51], v[36:39], v[20:35]
    s_waitcnt vmcnt(6) lgkmcnt(0)
    s_barrier
    s_mov_b32 s69, 2560
    s_add_u32 m0, s63, 49152
    buffer_load_dwordx4 v60, s[40:43], s69 offen lds
    s_add_u32 m0, s63, 50176
    buffer_load_dwordx4 v61, s[40:43], s69 offen lds
    s_add_u32 m0, s64, 57344
    buffer_load_dwordx4 v62, s[44:47], s69 offen lds
    s_add_u32 m0, s64, 58368
    buffer_load_dwordx4 v63, s[44:47], s69 offen lds
    s_add_u32 m0, s64, 59392
    buffer_load_dwordx4 v64, s[44:47], s69 offen lds
    s_add_u32 m0, s64, 60416
    buffer_load_dwordx4 v65, s[44:47], s69 offen lds
    ds_read_b128 v[36:39], v66 offset:0
    ds_read_b128 v[44:47], v70 offset:8192
    ds_read_b128 v[48:51], v70 offset:12288
    v_mfma_f32_32x32x16_bf16 v[4:19], v[52:55], v[40:43], v[4:19]
    v_mfma_f32_32x32x16_bf16 v[20:35], v[56:59], v[40:43], v[20:35]
    ds_read_b128 v[40:43], v67 offset:0
    ds_read_b128 v[52:55], v71 offset:8192
    ds_read_b128 v[56:59], v71 offset:12288
    s_waitcnt lgkmcnt(3)
    v_mfma_f32_32x32x16_bf16 v[4:19], v[44:47], v[36:39], v[4:19]
    v_mfma_f32_32x32x16_bf16 v[20:35], v[48:51], v[36:39], v[20:35]
    ds_read_b128 v[36:39], v68 offset:0
    ds_read_b128 v[44:47], v72 offset:8192
    ds_read_b128 v[48:51], v72 offset:12288
    s_waitcnt lgkmcnt(3)
    v_mfma_f32_32x32x16_bf16 v[4:19], v[52:55], v[40:43], v[4:19]
    v_mfma_f32_32x32x16_bf16 v[20:35], v[56:59], v[40:43], v[20:35]
    ds_read_b128 v[40:43], v69 offset:0
    ds_read_b128 v[52:55], v73 offset:8192
    ds_read_b128 v[56:59], v73 offset:12288
    s_waitcnt lgkmcnt(3)
    v_mfma_f32_32x32x16_bf16 v[4:19], v[44:47], v[36:39], v[4:19]
    v_mfma_f32_32x32x16_bf16 v[20:35], v[48:51], v[36:39], v[20:35]
    s_waitcnt vmcnt(6) lgkmcnt(0)
    s_barrier
    s_mov_b32 s69, 2688
    s_add_u32 m0, s63, 0
    buffer_load_dwordx4 v60, s[40:43], s69 offen lds
    s_add_u32 m0, s63, 1024
    buffer_load_dwordx4 v61, s[40:43], s69 offen lds
    s_add_u32 m0, s64, 8192
    buffer_load_dwordx4 v62, s[44:47], s69 offen lds
    s_add_u32 m0, s64, 9216
    buffer_load_dwordx4 v63, s[44:47], s69 offen lds
    s_add_u32 m0, s64, 10240
    buffer_load_dwordx4 v64, s[44:47], s69 offen lds
    s_add_u32 m0, s64, 11264
    buffer_load_dwordx4 v65, s[44:47], s69 offen lds
    ds_read_b128 v[36:39], v66 offset:24576
    ds_read_b128 v[44:47], v70 offset:32768
    ds_read_b128 v[48:51], v70 offset:36864
    v_mfma_f32_32x32x16_bf16 v[4:19], v[52:55], v[40:43], v[4:19]
    v_mfma_f32_32x32x16_bf16 v[20:35], v[56:59], v[40:43], v[20:35]
    ds_read_b128 v[40:43], v67 offset:24576
    ds_read_b128 v[52:55], v71 offset:32768
    ds_read_b128 v[56:59], v71 offset:36864
    s_waitcnt lgkmcnt(3)
    v_mfma_f32_32x32x16_bf16 v[4:19], v[44:47], v[36:39], v[4:19]
    v_mfma_f32_32x32x16_bf16 v[20:35], v[48:51], v[36:39], v[20:35]
    ds_read_b128 v[36:39], v68 offset:24576
    ds_read_b128 v[44:47], v72 offset:32768
    ds_read_b128 v[48:51], v72 offset:36864
    s_waitcnt lgkmcnt(3)
    v_mfma_f32_32x32x16_bf16 v[4:19], v[52:55], v[40:43], v[4:19]
    v_mfma_f32_32x32x16_bf16 v[20:35], v[56:59], v[40:43], v[20:35]
    ds_read_b128 v[40:43], v69 offset:24576
    ds_read_b128 v[52:55], v73 offset:32768
    ds_read_b128 v[56:59], v73 offset:36864
    s_waitcnt lgkmcnt(3)
    v_mfma_f32_32x32x16_bf16 v[4:19], v[44:47], v[36:39], v[4:19]
    v_mfma_f32_32x32x16_bf16 v[20:35], v[48:51], v[36:39], v[20:35]
    s_waitcnt vmcnt(6) lgkmcnt(0)
    s_barrier
    s_mov_b32 s69, 2816
    s_add_u32 m0, s63, 24576
    buffer_load_dwordx4 v60, s[40:43], s69 offen lds
    s_add_u32 m0, s63, 25600
    buffer_load_dwordx4 v61, s[40:43], s69 offen lds
    s_add_u32 m0, s64, 32768
    buffer_load_dwordx4 v62, s[44:47], s69 offen lds
    s_add_u32 m0, s64, 33792
    buffer_load_dwordx4 v63, s[44:47], s69 offen lds
    s_add_u32 m0, s64, 34816
    buffer_load_dwordx4 v64, s[44:47], s69 offen lds
    s_add_u32 m0, s64, 35840
    buffer_load_dwordx4 v65, s[44:47], s69 offen lds
    ds_read_b128 v[36:39], v66 offset:49152
    ds_read_b128 v[44:47], v70 offset:57344
    ds_read_b128 v[48:51], v70 offset:61440
    v_mfma_f32_32x32x16_bf16 v[4:19], v[52:55], v[40:43], v[4:19]
    v_mfma_f32_32x32x16_bf16 v[20:35], v[56:59], v[40:43], v[20:35]
    ds_read_b128 v[40:43], v67 offset:49152
    ds_read_b128 v[52:55], v71 offset:57344
    ds_read_b128 v[56:59], v71 offset:61440
    s_waitcnt lgkmcnt(3)
    v_mfma_f32_32x32x16_bf16 v[4:19], v[44:47], v[36:39], v[4:19]
    v_mfma_f32_32x32x16_bf16 v[20:35], v[48:51], v[36:39], v[20:35]
    ds_read_b128 v[36:39], v68 offset:49152
    ds_read_b128 v[44:47], v72 offset:57344
    ds_read_b128 v[48:51], v72 offset:61440
    s_waitcnt lgkmcnt(3)
    v_mfma_f32_32x32x16_bf16 v[4:19], v[52:55], v[40:43], v[4:19]
    v_mfma_f32_32x32x16_bf16 v[20:35], v[56:59], v[40:43], v[20:35]
    ds_read_b128 v[40:43], v69 offset:49152
    ds_read_b128 v[52:55], v73 offset:57344
    ds_read_b128 v[56:59], v73 offset:61440
    s_waitcnt lgkmcnt(3)
    v_mfma_f32_32x32x16_bf16 v[4:19], v[44:47], v[36:39], v[4:19]
    v_mfma_f32_32x32x16_bf16 v[20:35], v[48:51], v[36:39], v[20:35]
    s_waitcnt vmcnt(6) lgkmcnt(0)
    s_barrier
    s_mov_b32 s69, 2944
    s_add_u32 m0, s63, 49152
    buffer_load_dwordx4 v60, s[40:43], s69 offen lds
    s_add_u32 m0, s63, 50176
    buffer_load_dwordx4 v61, s[40:43], s69 offen lds
    s_add_u32 m0, s64, 57344
    buffer_load_dwordx4 v62, s[44:47], s69 offen lds
    s_add_u32 m0, s64, 58368
    buffer_load_dwordx4 v63, s[44:47], s69 offen lds
    s_add_u32 m0, s64, 59392
    buffer_load_dwordx4 v64, s[44:47], s69 offen lds
    s_add_u32 m0, s64, 60416
    buffer_load_dwordx4 v65, s[44:47], s69 offen lds
    ds_read_b128 v[36:39], v66 offset:0
    ds_read_b128 v[44:47], v70 offset:8192
    ds_read_b128 v[48:51], v70 offset:12288
    v_mfma_f32_32x32x16_bf16 v[4:19], v[52:55], v[40:43], v[4:19]
    v_mfma_f32_32x32x16_bf16 v[20:35], v[56:59], v[40:43], v[20:35]
    ds_read_b128 v[40:43], v67 offset:0
    ds_read_b128 v[52:55], v71 offset:8192
    ds_read_b128 v[56:59], v71 offset:12288
    s_waitcnt lgkmcnt(3)
    v_mfma_f32_32x32x16_bf16 v[4:19], v[44:47], v[36:39], v[4:19]
    v_mfma_f32_32x32x16_bf16 v[20:35], v[48:51], v[36:39], v[20:35]
    ds_read_b128 v[36:39], v68 offset:0
    ds_read_b128 v[44:47], v72 offset:8192
    ds_read_b128 v[48:51], v72 offset:12288
    s_waitcnt lgkmcnt(3)
    v_mfma_f32_32x32x16_bf16 v[4:19], v[52:55], v[40:43], v[4:19]
    v_mfma_f32_32x32x16_bf16 v[20:35], v[56:59], v[40:43], v[20:35]
    ds_read_b128 v[40:43], v69 offset:0
    ds_read_b128 v[52:55], v73 offset:8192
    ds_read_b128 v[56:59], v73 offset:12288
    s_waitcnt lgkmcnt(3)
    v_mfma_f32_32x32x16_bf16 v[4:19], v[44:47], v[36:39], v[4:19]
    v_mfma_f32_32x32x16_bf16 v[20:35], v[48:51], v[36:39], v[20:35]
    s_waitcnt vmcnt(6) lgkmcnt(0)
    s_barrier
    s_mov_b32 s69, 3072
    s_add_u32 m0, s63, 0
    buffer_load_dwordx4 v60, s[40:43], s69 offen lds
    s_add_u32 m0, s63, 1024
    buffer_load_dwordx4 v61, s[40:43], s69 offen lds
    s_add_u32 m0, s64, 8192
    buffer_load_dwordx4 v62, s[44:47], s69 offen lds
    s_add_u32 m0, s64, 9216
    buffer_load_dwordx4 v63, s[44:47], s69 offen lds
    s_add_u32 m0, s64, 10240
    buffer_load_dwordx4 v64, s[44:47], s69 offen lds
    s_add_u32 m0, s64, 11264
    buffer_load_dwordx4 v65, s[44:47], s69 offen lds
    ds_read_b128 v[36:39], v66 offset:24576
    ds_read_b128 v[44:47], v70 offset:32768
    ds_read_b128 v[48:51], v70 offset:36864
    v_mfma_f32_32x32x16_bf16 v[4:19], v[52:55], v[40:43], v[4:19]
    v_mfma_f32_32x32x16_bf16 v[20:35], v[56:59], v[40:43], v[20:35]
    ds_read_b128 v[40:43], v67 offset:24576
    ds_read_b128 v[52:55], v71 offset:32768
    ds_read_b128 v[56:59], v71 offset:36864
    s_waitcnt lgkmcnt(3)
    v_mfma_f32_32x32x16_bf16 v[4:19], v[44:47], v[36:39], v[4:19]
    v_mfma_f32_32x32x16_bf16 v[20:35], v[48:51], v[36:39], v[20:35]
    ds_read_b128 v[36:39], v68 offset:24576
    ds_read_b128 v[44:47], v72 offset:32768
    ds_read_b128 v[48:51], v72 offset:36864
    s_waitcnt lgkmcnt(3)
    v_mfma_f32_32x32x16_bf16 v[4:19], v[52:55], v[40:43], v[4:19]
    v_mfma_f32_32x32x16_bf16 v[20:35], v[56:59], v[40:43], v[20:35]
    ds_read_b128 v[40:43], v69 offset:24576
    ds_read_b128 v[52:55], v73 offset:32768
    ds_read_b128 v[56:59], v73 offset:36864
    s_waitcnt lgkmcnt(3)
    v_mfma_f32_32x32x16_bf16 v[4:19], v[44:47], v[36:39], v[4:19]
    v_mfma_f32_32x32x16_bf16 v[20:35], v[48:51], v[36:39], v[20:35]
    s_waitcnt vmcnt(6) lgkmcnt(0)
    s_barrier
    s_mov_b32 s69, 3200
    s_add_u32 m0, s63, 24576
    buffer_load_dwordx4 v60, s[40:43], s69 offen lds
    s_add_u32 m0, s63, 25600
    buffer_load_dwordx4 v61, s[40:43], s69 offen lds
    s_add_u32 m0, s64, 32768
    buffer_load_dwordx4 v62, s[44:47], s69 offen lds
    s_add_u32 m0, s64, 33792
    buffer_load_dwordx4 v63, s[44:47], s69 offen lds
    s_add_u32 m0, s64, 34816
    buffer_load_dwordx4 v64, s[44:47], s69 offen lds
    s_add_u32 m0, s64, 35840
    buffer_load_dwordx4 v65, s[44:47], s69 offen lds
    ds_read_b128 v[36:39], v66 offset:49152
    ds_read_b128 v[44:47], v70 offset:57344
    ds_read_b128 v[48:51], v70 offset:61440
    v_mfma_f32_32x32x16_bf16 v[4:19], v[52:55], v[40:43], v[4:19]
    v_mfma_f32_32x32x16_bf16 v[20:35], v[56:59], v[40:43], v[20:35]
    ds_read_b128 v[40:43], v67 offset:49152
    ds_read_b128 v[52:55], v71 offset:57344
    ds_read_b128 v[56:59], v71 offset:61440
    s_waitcnt lgkmcnt(3)
    v_mfma_f32_32x32x16_bf16 v[4:19], v[44:47], v[36:39], v[4:19]
    v_mfma_f32_32x32x16_bf16 v[20:35], v[48:51], v[36:39], v[20:35]
    ds_read_b128 v[36:39], v68 offset:49152
    ds_read_b128 v[44:47], v72 offset:57344
    ds_read_b128 v[48:51], v72 offset:61440
    s_waitcnt lgkmcnt(3)
    v_mfma_f32_32x32x16_bf16 v[4:19], v[52:55], v[40:43], v[4:19]
    v_mfma_f32_32x32x16_bf16 v[20:35], v[56:59], v[40:43], v[20:35]
    ds_read_b128 v[40:43], v69 offset:49152
    ds_read_b128 v[52:55], v73 offset:57344
    ds_read_b128 v[56:59], v73 offset:61440
    s_waitcnt lgkmcnt(3)
    v_mfma_f32_32x32x16_bf16 v[4:19], v[44:47], v[36:39], v[4:19]
    v_mfma_f32_32x32x16_bf16 v[20:35], v[48:51], v[36:39], v[20:35]
    s_waitcnt vmcnt(6) lgkmcnt(0)
    s_barrier
    s_mov_b32 s69, 3328
    s_add_u32 m0, s63, 49152
    buffer_load_dwordx4 v60, s[40:43], s69 offen lds
    s_add_u32 m0, s63, 50176
    buffer_load_dwordx4 v61, s[40:43], s69 offen lds
    s_add_u32 m0, s64, 57344
    buffer_load_dwordx4 v62, s[44:47], s69 offen lds
    s_add_u32 m0, s64, 58368
    buffer_load_dwordx4 v63, s[44:47], s69 offen lds
    s_add_u32 m0, s64, 59392
    buffer_load_dwordx4 v64, s[44:47], s69 offen lds
    s_add_u32 m0, s64, 60416
    buffer_load_dwordx4 v65, s[44:47], s69 offen lds
    ds_read_b128 v[36:39], v66 offset:0
    ds_read_b128 v[44:47], v70 offset:8192
    ds_read_b128 v[48:51], v70 offset:12288
    v_mfma_f32_32x32x16_bf16 v[4:19], v[52:55], v[40:43], v[4:19]
    v_mfma_f32_32x32x16_bf16 v[20:35], v[56:59], v[40:43], v[20:35]
    ds_read_b128 v[40:43], v67 offset:0
    ds_read_b128 v[52:55], v71 offset:8192
    ds_read_b128 v[56:59], v71 offset:12288
    s_waitcnt lgkmcnt(3)
    v_mfma_f32_32x32x16_bf16 v[4:19], v[44:47], v[36:39], v[4:19]
    v_mfma_f32_32x32x16_bf16 v[20:35], v[48:51], v[36:39], v[20:35]
    ds_read_b128 v[36:39], v68 offset:0
    ds_read_b128 v[44:47], v72 offset:8192
    ds_read_b128 v[48:51], v72 offset:12288
    s_waitcnt lgkmcnt(3)
    v_mfma_f32_32x32x16_bf16 v[4:19], v[52:55], v[40:43], v[4:19]
    v_mfma_f32_32x32x16_bf16 v[20:35], v[56:59], v[40:43], v[20:35]
    ds_read_b128 v[40:43], v69 offset:0
    ds_read_b128 v[52:55], v73 offset:8192
    ds_read_b128 v[56:59], v73 offset:12288
    s_waitcnt lgkmcnt(3)
    v_mfma_f32_32x32x16_bf16 v[4:19], v[44:47], v[36:39], v[4:19]
    v_mfma_f32_32x32x16_bf16 v[20:35], v[48:51], v[36:39], v[20:35]
    s_waitcnt vmcnt(6) lgkmcnt(0)
    s_barrier
    ds_read_b128 v[36:39], v66 offset:24576
    ds_read_b128 v[44:47], v70 offset:32768
    ds_read_b128 v[48:51], v70 offset:36864
    v_mfma_f32_32x32x16_bf16 v[4:19], v[52:55], v[40:43], v[4:19]
    v_mfma_f32_32x32x16_bf16 v[20:35], v[56:59], v[40:43], v[20:35]
    ds_read_b128 v[40:43], v67 offset:24576
    ds_read_b128 v[52:55], v71 offset:32768
    ds_read_b128 v[56:59], v71 offset:36864
    s_waitcnt lgkmcnt(3)
    v_mfma_f32_32x32x16_bf16 v[4:19], v[44:47], v[36:39], v[4:19]
    v_mfma_f32_32x32x16_bf16 v[20:35], v[48:51], v[36:39], v[20:35]
    ds_read_b128 v[36:39], v68 offset:24576
    ds_read_b128 v[44:47], v72 offset:32768
    ds_read_b128 v[48:51], v72 offset:36864
    s_waitcnt lgkmcnt(3)
    v_mfma_f32_32x32x16_bf16 v[4:19], v[52:55], v[40:43], v[4:19]
    v_mfma_f32_32x32x16_bf16 v[20:35], v[56:59], v[40:43], v[20:35]
    ds_read_b128 v[40:43], v69 offset:24576
    ds_read_b128 v[52:55], v73 offset:32768
    ds_read_b128 v[56:59], v73 offset:36864
    s_waitcnt lgkmcnt(3)
    v_mfma_f32_32x32x16_bf16 v[4:19], v[44:47], v[36:39], v[4:19]
    v_mfma_f32_32x32x16_bf16 v[20:35], v[48:51], v[36:39], v[20:35]
    s_waitcnt vmcnt(0) lgkmcnt(0)
    s_barrier
    ds_read_b128 v[36:39], v66 offset:49152
    ds_read_b128 v[44:47], v70 offset:57344
    ds_read_b128 v[48:51], v70 offset:61440
    v_mfma_f32_32x32x16_bf16 v[4:19], v[52:55], v[40:43], v[4:19]
    v_mfma_f32_32x32x16_bf16 v[20:35], v[56:59], v[40:43], v[20:35]
    ds_read_b128 v[40:43], v67 offset:49152
    ds_read_b128 v[52:55], v71 offset:57344
    ds_read_b128 v[56:59], v71 offset:61440
    s_waitcnt lgkmcnt(3)
    v_mfma_f32_32x32x16_bf16 v[4:19], v[44:47], v[36:39], v[4:19]
    v_mfma_f32_32x32x16_bf16 v[20:35], v[48:51], v[36:39], v[20:35]
    ds_read_b128 v[36:39], v68 offset:49152
    ds_read_b128 v[44:47], v72 offset:57344
    ds_read_b128 v[48:51], v72 offset:61440
    s_waitcnt lgkmcnt(3)
    v_mfma_f32_32x32x16_bf16 v[4:19], v[52:55], v[40:43], v[4:19]
    v_mfma_f32_32x32x16_bf16 v[20:35], v[56:59], v[40:43], v[20:35]
    ds_read_b128 v[40:43], v69 offset:49152
    ds_read_b128 v[52:55], v73 offset:57344
    ds_read_b128 v[56:59], v73 offset:61440
    s_waitcnt lgkmcnt(3)
    v_mfma_f32_32x32x16_bf16 v[4:19], v[44:47], v[36:39], v[4:19]
    v_mfma_f32_32x32x16_bf16 v[20:35], v[48:51], v[36:39], v[20:35]
    s_waitcnt lgkmcnt(0)
    v_mfma_f32_32x32x16_bf16 v[4:19], v[52:55], v[40:43], v[4:19]
    v_mfma_f32_32x32x16_bf16 v[20:35], v[56:59], v[40:43], v[20:35]
    s_nop 7
    s_nop 7
    s_waitcnt vmcnt(0)
    v_and_b32 v121, 31, v82
    s_lshl_b32 s65, s67, 5
    v_add_u32 v121, s65, v121
    v_add_u32 v121, s61, v121
    v_mul_u32_u24 v122, 1280, v121
    v_lshlrev_b32 v123, 1, v118
    v_add_u32 v122, v122, v123
    s_lshl_b32 s66, s62, 1
    v_mov_b32 v132, 0
    v_mov_b32 v133, 0
    v_cvt_pk_bf16_f32 v123, v4, v5
    v_lshlrev_b32 v4, 16, v123
    v_and_b32 v5, 0xffff0000, v123
    v_cvt_pk_bf16_f32 v124, v6, v7
    v_lshlrev_b32 v6, 16, v124
    v_and_b32 v7, 0xffff0000, v124
    v_lshlrev_b32 v126, 16, v86
    v_and_b32 v127, 0xffff0000, v86
    v_lshlrev_b32 v128, 16, v87
    v_and_b32 v129, 0xffff0000, v87
    v_add_f32 v4, v4, v126
    v_add_f32 v5, v5, v127
    v_add_f32 v6, v6, v128
    v_add_f32 v7, v7, v129
    v_cvt_pk_bf16_f32 v123, v4, v5
    v_lshlrev_b32 v4, 16, v123
    v_and_b32 v5, 0xffff0000, v123
    v_cvt_pk_bf16_f32 v124, v6, v7
    v_lshlrev_b32 v6, 16, v124
    v_and_b32 v7, 0xffff0000, v124
    v_lshlrev_b32 v126, 16, v102
    v_and_b32 v127, 0xffff0000, v102
    v_lshlrev_b32 v128, 16, v103
    v_and_b32 v129, 0xffff0000, v103
    v_add_f32 v4, v4, v126
    v_add_f32 v5, v5, v127
    v_add_f32 v6, v6, v128
    v_add_f32 v7, v7, v129
    v_cvt_pk_bf16_f32 v130, v4, v5
    v_cvt_pk_bf16_f32 v131, v6, v7
    buffer_store_dwordx2 v[130:131], v122, s[56:59], s66 offen offset:0
    v_lshlrev_b32 v126, 16, v130
    v_and_b32 v127, 0xffff0000, v130
    v_lshlrev_b32 v128, 16, v131
    v_and_b32 v129, 0xffff0000, v131
    v_add_f32 v132, v132, v126
    v_fmac_f32 v133, v126, v126
    v_add_f32 v132, v132, v127
    v_fmac_f32 v133, v127, v127
    v_add_f32 v132, v132, v128
    v_fmac_f32 v133, v128, v128
    v_add_f32 v132, v132, v129
    v_fmac_f32 v133, v129, v129
    s_nop 1
    v_cvt_pk_bf16_f32 v123, v8, v9
    v_lshlrev_b32 v8, 16, v123
    v_and_b32 v9, 0xffff0000, v123
    v_cvt_pk_bf16_f32 v124, v10, v11
    v_lshlrev_b32 v10, 16, v124
    v_and_b32 v11, 0xffff0000, v124
    v_lshlrev_b32 v126, 16, v88
    v_and_b32 v127, 0xffff0000, v88
    v_lshlrev_b32 v128, 16, v89
    v_and_b32 v129, 0xffff0000, v89
    v_add_f32 v8, v8, v126
    v_add_f32 v9, v9, v127
    v_add_f32 v10, v10, v128
    v_add_f32 v11, v11, v129
    v_cvt_pk_bf16_f32 v123, v8, v9
    v_lshlrev_b32 v8, 16, v123
    v_and_b32 v9, 0xffff0000, v123
    v_cvt_pk_bf16_f32 v124, v10, v11
    v_lshlrev_b32 v10, 16, v124
    v_and_b32 v11, 0xffff0000, v124
    v_lshlrev_b32 v126, 16, v104
    v_and_b32 v127, 0xffff0000, v104
    v_lshlrev_b32 v128, 16, v105
    v_and_b32 v129, 0xffff0000, v105
    v_add_f32 v8, v8, v126
    v_add_f32 v9, v9, v127
    v_add_f32 v10, v10, v128
    v_add_f32 v11, v11, v129
    v_cvt_pk_bf16_f32 v130, v8, v9
    v_cvt_pk_bf16_f32 v131, v10, v11
    buffer_store_dwordx2 v[130:131], v122, s[56:59], s66 offen offset:16
    v_lshlrev_b32 v126, 16, v130
    v_and_b32 v127, 0xffff0000, v130
    v_lshlrev_b32 v128, 16, v131
    v_and_b32 v129, 0xffff0000, v131
    v_add_f32 v132, v132, v126
    v_fmac_f32 v133, v126, v126
    v_add_f32 v132, v132, v127
    v_fmac_f32 v133, v127, v127
    v_add_f32 v132, v132, v128
    v_fmac_f32 v133, v128, v128
    v_add_f32 v132, v132, v129
    v_fmac_f32 v133, v129, v129
    s_nop 1
    v_cvt_pk_bf16_f32 v123, v12, v13
    v_lshlrev_b32 v12, 16, v123
    v_and_b32 v13, 0xffff0000, v123
    v_cvt_pk_bf16_f32 v124, v14, v15
    v_lshlrev_b32 v14, 16, v124
    v_and_b32 v15, 0xffff0000, v124
    v_lshlrev_b32 v126, 16, v90
    v_and_b32 v127, 0xffff0000, v90
    v_lshlrev_b32 v128, 16, v91
    v_and_b32 v129, 0xffff0000, v91
    v_add_f32 v12, v12, v126
    v_add_f32 v13, v13, v127
    v_add_f32 v14, v14, v128
    v_add_f32 v15, v15, v129
    v_cvt_pk_bf16_f32 v123, v12, v13
    v_lshlrev_b32 v12, 16, v123
    v_and_b32 v13, 0xffff0000, v123
    v_cvt_pk_bf16_f32 v124, v14, v15
    v_lshlrev_b32 v14, 16, v124
    v_and_b32 v15, 0xffff0000, v124
    v_lshlrev_b32 v126, 16, v106
    v_and_b32 v127, 0xffff0000, v106
    v_lshlrev_b32 v128, 16, v107
    v_and_b32 v129, 0xffff0000, v107
    v_add_f32 v12, v12, v126
    v_add_f32 v13, v13, v127
    v_add_f32 v14, v14, v128
    v_add_f32 v15, v15, v129
    v_cvt_pk_bf16_f32 v130, v12, v13
    v_cvt_pk_bf16_f32 v131, v14, v15
    buffer_store_dwordx2 v[130:131], v122, s[56:59], s66 offen offset:32
    v_lshlrev_b32 v126, 16, v130
    v_and_b32 v127, 0xffff0000, v130
    v_lshlrev_b32 v128, 16, v131
    v_and_b32 v129, 0xffff0000, v131
    v_add_f32 v132, v132, v126
    v_fmac_f32 v133, v126, v126
    v_add_f32 v132, v132, v127
    v_fmac_f32 v133, v127, v127
    v_add_f32 v132, v132, v128
    v_fmac_f32 v133, v128, v128
    v_add_f32 v132, v132, v129
    v_fmac_f32 v133, v129, v129
    s_nop 1
    v_cvt_pk_bf16_f32 v123, v16, v17
    v_lshlrev_b32 v16, 16, v123
    v_and_b32 v17, 0xffff0000, v123
    v_cvt_pk_bf16_f32 v124, v18, v19
    v_lshlrev_b32 v18, 16, v124
    v_and_b32 v19, 0xffff0000, v124
    v_lshlrev_b32 v126, 16, v92
    v_and_b32 v127, 0xffff0000, v92
    v_lshlrev_b32 v128, 16, v93
    v_and_b32 v129, 0xffff0000, v93
    v_add_f32 v16, v16, v126
    v_add_f32 v17, v17, v127
    v_add_f32 v18, v18, v128
    v_add_f32 v19, v19, v129
    v_cvt_pk_bf16_f32 v123, v16, v17
    v_lshlrev_b32 v16, 16, v123
    v_and_b32 v17, 0xffff0000, v123
    v_cvt_pk_bf16_f32 v124, v18, v19
    v_lshlrev_b32 v18, 16, v124
    v_and_b32 v19, 0xffff0000, v124
    v_lshlrev_b32 v126, 16, v108
    v_and_b32 v127, 0xffff0000, v108
    v_lshlrev_b32 v128, 16, v109
    v_and_b32 v129, 0xffff0000, v109
    v_add_f32 v16, v16, v126
    v_add_f32 v17, v17, v127
    v_add_f32 v18, v18, v128
    v_add_f32 v19, v19, v129
    v_cvt_pk_bf16_f32 v130, v16, v17
    v_cvt_pk_bf16_f32 v131, v18, v19
    buffer_store_dwordx2 v[130:131], v122, s[56:59], s66 offen offset:48
    v_lshlrev_b32 v126, 16, v130
    v_and_b32 v127, 0xffff0000, v130
    v_lshlrev_b32 v128, 16, v131
    v_and_b32 v129, 0xffff0000, v131
    v_add_f32 v132, v132, v126
    v_fmac_f32 v133, v126, v126
    v_add_f32 v132, v132, v127
    v_fmac_f32 v133, v127, v127
    v_add_f32 v132, v132, v128
    v_fmac_f32 v133, v128, v128
    v_add_f32 v132, v132, v129
    v_fmac_f32 v133, v129, v129
    s_nop 1
    v_cvt_pk_bf16_f32 v123, v20, v21
    v_lshlrev_b32 v20, 16, v123
    v_and_b32 v21, 0xffff0000, v123
    v_cvt_pk_bf16_f32 v124, v22, v23
    v_lshlrev_b32 v22, 16, v124
    v_and_b32 v23, 0xffff0000, v124
    v_lshlrev_b32 v126, 16, v94
    v_and_b32 v127, 0xffff0000, v94
    v_lshlrev_b32 v128, 16, v95
    v_and_b32 v129, 0xffff0000, v95
    v_add_f32 v20, v20, v126
    v_add_f32 v21, v21, v127
    v_add_f32 v22, v22, v128
    v_add_f32 v23, v23, v129
    v_cvt_pk_bf16_f32 v123, v20, v21
    v_lshlrev_b32 v20, 16, v123
    v_and_b32 v21, 0xffff0000, v123
    v_cvt_pk_bf16_f32 v124, v22, v23
    v_lshlrev_b32 v22, 16, v124
    v_and_b32 v23, 0xffff0000, v124
    v_lshlrev_b32 v126, 16, v110
    v_and_b32 v127, 0xffff0000, v110
    v_lshlrev_b32 v128, 16, v111
    v_and_b32 v129, 0xffff0000, v111
    v_add_f32 v20, v20, v126
    v_add_f32 v21, v21, v127
    v_add_f32 v22, v22, v128
    v_add_f32 v23, v23, v129
    v_cvt_pk_bf16_f32 v130, v20, v21
    v_cvt_pk_bf16_f32 v131, v22, v23
    buffer_store_dwordx2 v[130:131], v122, s[56:59], s66 offen offset:64
    v_lshlrev_b32 v126, 16, v130
    v_and_b32 v127, 0xffff0000, v130
    v_lshlrev_b32 v128, 16, v131
    v_and_b32 v129, 0xffff0000, v131
    v_add_f32 v132, v132, v126
    v_fmac_f32 v133, v126, v126
    v_add_f32 v132, v132, v127
    v_fmac_f32 v133, v127, v127
    v_add_f32 v132, v132, v128
    v_fmac_f32 v133, v128, v128
    v_add_f32 v132, v132, v129
    v_fmac_f32 v133, v129, v129
    s_nop 1
    v_cvt_pk_bf16_f32 v123, v24, v25
    v_lshlrev_b32 v24, 16, v123
    v_and_b32 v25, 0xffff0000, v123
    v_cvt_pk_bf16_f32 v124, v26, v27
    v_lshlrev_b32 v26, 16, v124
    v_and_b32 v27, 0xffff0000, v124
    v_lshlrev_b32 v126, 16, v96
    v_and_b32 v127, 0xffff0000, v96
    v_lshlrev_b32 v128, 16, v97
    v_and_b32 v129, 0xffff0000, v97
    v_add_f32 v24, v24, v126
    v_add_f32 v25, v25, v127
    v_add_f32 v26, v26, v128
    v_add_f32 v27, v27, v129
    v_cvt_pk_bf16_f32 v123, v24, v25
    v_lshlrev_b32 v24, 16, v123
    v_and_b32 v25, 0xffff0000, v123
    v_cvt_pk_bf16_f32 v124, v26, v27
    v_lshlrev_b32 v26, 16, v124
    v_and_b32 v27, 0xffff0000, v124
    v_lshlrev_b32 v126, 16, v112
    v_and_b32 v127, 0xffff0000, v112
    v_lshlrev_b32 v128, 16, v113
    v_and_b32 v129, 0xffff0000, v113
    v_add_f32 v24, v24, v126
    v_add_f32 v25, v25, v127
    v_add_f32 v26, v26, v128
    v_add_f32 v27, v27, v129
    v_cvt_pk_bf16_f32 v130, v24, v25
    v_cvt_pk_bf16_f32 v131, v26, v27
    buffer_store_dwordx2 v[130:131], v122, s[56:59], s66 offen offset:80
    v_lshlrev_b32 v126, 16, v130
    v_and_b32 v127, 0xffff0000, v130
    v_lshlrev_b32 v128, 16, v131
    v_and_b32 v129, 0xffff0000, v131
    v_add_f32 v132, v132, v126
    v_fmac_f32 v133, v126, v126
    v_add_f32 v132, v132, v127
    v_fmac_f32 v133, v127, v127
    v_add_f32 v132, v132, v128
    v_fmac_f32 v133, v128, v128
    v_add_f32 v132, v132, v129
    v_fmac_f32 v133, v129, v129
    s_nop 1
    v_cvt_pk_bf16_f32 v123, v28, v29
    v_lshlrev_b32 v28, 16, v123
    v_and_b32 v29, 0xffff0000, v123
    v_cvt_pk_bf16_f32 v124, v30, v31
    v_lshlrev_b32 v30, 16, v124
    v_and_b32 v31, 0xffff0000, v124
    v_lshlrev_b32 v126, 16, v98
    v_and_b32 v127, 0xffff0000, v98
    v_lshlrev_b32 v128, 16, v99
    v_and_b32 v129, 0xffff0000, v99
    v_add_f32 v28, v28, v126
    v_add_f32 v29, v29, v127
    v_add_f32 v30, v30, v128
    v_add_f32 v31, v31, v129
    v_cvt_pk_bf16_f32 v123, v28, v29
    v_lshlrev_b32 v28, 16, v123
    v_and_b32 v29, 0xffff0000, v123
    v_cvt_pk_bf16_f32 v124, v30, v31
    v_lshlrev_b32 v30, 16, v124
    v_and_b32 v31, 0xffff0000, v124
    v_lshlrev_b32 v126, 16, v114
    v_and_b32 v127, 0xffff0000, v114
    v_lshlrev_b32 v128, 16, v115
    v_and_b32 v129, 0xffff0000, v115
    v_add_f32 v28, v28, v126
    v_add_f32 v29, v29, v127
    v_add_f32 v30, v30, v128
    v_add_f32 v31, v31, v129
    v_cvt_pk_bf16_f32 v130, v28, v29
    v_cvt_pk_bf16_f32 v131, v30, v31
    buffer_store_dwordx2 v[130:131], v122, s[56:59], s66 offen offset:96
    v_lshlrev_b32 v126, 16, v130
    v_and_b32 v127, 0xffff0000, v130
    v_lshlrev_b32 v128, 16, v131
    v_and_b32 v129, 0xffff0000, v131
    v_add_f32 v132, v132, v126
    v_fmac_f32 v133, v126, v126
    v_add_f32 v132, v132, v127
    v_fmac_f32 v133, v127, v127
    v_add_f32 v132, v132, v128
    v_fmac_f32 v133, v128, v128
    v_add_f32 v132, v132, v129
    v_fmac_f32 v133, v129, v129
    s_nop 1
    v_cvt_pk_bf16_f32 v123, v32, v33
    v_lshlrev_b32 v32, 16, v123
    v_and_b32 v33, 0xffff0000, v123
    v_cvt_pk_bf16_f32 v124, v34, v35
    v_lshlrev_b32 v34, 16, v124
    v_and_b32 v35, 0xffff0000, v124
    v_lshlrev_b32 v126, 16, v100
    v_and_b32 v127, 0xffff0000, v100
    v_lshlrev_b32 v128, 16, v101
    v_and_b32 v129, 0xffff0000, v101
    v_add_f32 v32, v32, v126
    v_add_f32 v33, v33, v127
    v_add_f32 v34, v34, v128
    v_add_f32 v35, v35, v129
    v_cvt_pk_bf16_f32 v123, v32, v33
    v_lshlrev_b32 v32, 16, v123
    v_and_b32 v33, 0xffff0000, v123
    v_cvt_pk_bf16_f32 v124, v34, v35
    v_lshlrev_b32 v34, 16, v124
    v_and_b32 v35, 0xffff0000, v124
    v_lshlrev_b32 v126, 16, v116
    v_and_b32 v127, 0xffff0000, v116
    v_lshlrev_b32 v128, 16, v117
    v_and_b32 v129, 0xffff0000, v117
    v_add_f32 v32, v32, v126
    v_add_f32 v33, v33, v127
    v_add_f32 v34, v34, v128
    v_add_f32 v35, v35, v129
    v_cvt_pk_bf16_f32 v130, v32, v33
    v_cvt_pk_bf16_f32 v131, v34, v35
    buffer_store_dwordx2 v[130:131], v122, s[56:59], s66 offen offset:112
    v_lshlrev_b32 v126, 16, v130
    v_and_b32 v127, 0xffff0000, v130
    v_lshlrev_b32 v128, 16, v131
    v_and_b32 v129, 0xffff0000, v131
    v_add_f32 v132, v132, v126
    v_fmac_f32 v133, v126, v126
    v_add_f32 v132, v132, v127
    v_fmac_f32 v133, v127, v127
    v_add_f32 v132, v132, v128
    v_fmac_f32 v133, v128, v128
    v_add_f32 v132, v132, v129
    v_fmac_f32 v133, v129, v129
    s_nop 1
    v_mov_b32 v134, v132
    v_mov_b32 v135, v133
    s_nop 1
    v_permlane32_swap_b32 v132, v134
    v_permlane32_swap_b32 v133, v135
    s_nop 1
    v_add_f32 v132, v132, v134
    v_add_f32 v133, v133, v135
    v_mul_u32_u24 v121, 80, v121
    s_lshr_b32 s65, s62, 6
    s_add_u32 s65, s65, s68
    s_lshl_b32 s65, s65, 3
    v_cmp_gt_u32 vcc, 32, v82
    s_and_saveexec_b64 s[76:77], vcc
    buffer_store_dwordx2 v[132:133], v121, s[80:83], s65 offen
    s_or_b64 exec, exec, s[76:77]
.k4p0_kernel_end:
    s_endpgm

.globl k1p1_kernel
.p2align 8
.type k1p1_kernel,@function
k1p1_kernel:
    s_cmp_ge_u32 s2, 208
    s_cbranch_scc1 .k1p1_kernel_end
    s_load_dwordx16 s[16:31], s[0:1], 0
    s_load_dwordx4 s[32:35], s[0:1], 64
    s_load_dwordx2 s[36:37], s[0:1], 80
    s_waitcnt lgkmcnt(0)
    s_cmp_ge_u32 s2, 128
    s_cbranch_scc1 .k1p1_kernel_q
    s_and_b32 s61, s2, 31
    s_lshl_b32 s61, s61, 6
    s_lshr_b32 s84, s2, 5
    s_add_u32 s40, s36, 13950976
    s_addc_u32 s41, s37, 0
    s_and_b32 s41, s41, 0xffff
    s_mov_b32 s42, 2621440
    s_mov_b32 s43, 0x00020000
    s_mov_b32 s44, s36
    s_mov_b32 s45, s37
    s_and_b32 s45, s45, 0xffff
    s_mov_b32 s46, 2457600
    s_mov_b32 s47, 0x00020000
    s_mul_i32 s62, s84, 160
    s_add_u32 s62, s62, 640
    v_lshrrev_b32 v1, 6, v0
    s_nop 0
    v_readfirstlane_b32 s85, v1
    s_cmp_ge_u32 s85, 2
    s_cselect_b32 s86, 480, 0
    s_add_u32 s86, s86, s62
    v_and_b32 v160, 63, v0
    v_lshrrev_b32 v161, 6, v0
    s_nop 0
    v_readfirstlane_b32 s60, v161
    s_nop 1
    s_mul_i32 s63, s60, 2048
    s_mul_i32 s64, s60, 10240
    s_mul_i32 s65, s60, 16
    s_add_u32 s65, s65, 0
    v_lshrrev_b32 v161, 3, v160
    v_add_u32 v161, s65, v161
    v_lshrrev_b32 v162, 1, v161
    v_and_b32 v162, 7, v162
    v_and_b32 v132, 7, v160
    v_xor_b32 v162, v132, v162
    v_lshlrev_b32 v162, 4, v162
    v_add_u32 v161, s61, v161
    s_mov_b32 s66, 1280
    v_mul_lo_u32 v161, v161, s66
    v_add_u32 v132, v161, v162
    s_mul_i32 s65, s60, 16
    s_add_u32 s65, s65, 8
    v_lshrrev_b32 v161, 3, v160
    v_add_u32 v161, s65, v161
    v_lshrrev_b32 v162, 1, v161
    v_and_b32 v162, 7, v162
    v_and_b32 v133, 7, v160
    v_xor_b32 v162, v133, v162
    v_lshlrev_b32 v162, 4, v162
    v_add_u32 v161, s61, v161
    s_mov_b32 s66, 1280
    v_mul_lo_u32 v161, v161, s66
    v_add_u32 v133, v161, v162
    s_mul_i32 s65, s60, 80
    s_add_u32 s65, s65, 0
    v_lshrrev_b32 v161, 3, v160
    v_add_u32 v161, s65, v161
    v_lshrrev_b32 v162, 1, v161
    v_and_b32 v162, 7, v162
    v_and_b32 v134, 7, v160
    v_xor_b32 v162, v134, v162
    v_lshlrev_b32 v162, 4, v162
    v_add_u32 v161, s86, v161
    s_mov_b32 s66, 1280
    v_mul_lo_u32 v161, v161, s66
    v_add_u32 v134, v161, v162
    s_mul_i32 s65, s60, 80
    s_add_u32 s65, s65, 8
    v_lshrrev_b32 v161, 3, v160
    v_add_u32 v161, s65, v161
    v_lshrrev_b32 v162, 1, v161
    v_and_b32 v162, 7, v162
    v_and_b32 v135, 7, v160
    v_xor_b32 v162, v135, v162
    v_lshlrev_b32 v162, 4, v162
    v_add_u32 v161, s86, v161
    s_mov_b32 s66, 1280
    v_mul_lo_u32 v161, v161, s66
    v_add_u32 v135, v161, v162
    s_mul_i32 s65, s60, 80
    s_add_u32 s65, s65, 16
    v_lshrrev_b32 v161, 3, v160
    v_add_u32 v161, s65, v161
    v_lshrrev_b32 v162, 1, v161
    v_and_b32 v162, 7, v162
    v_and_b32 v136, 7, v160
    v_xor_b32 v162, v136, v162
    v_lshlrev_b32 v162, 4, v162
    v_add_u32 v161, s86, v161
    s_mov_b32 s66, 1280
    v_mul_lo_u32 v161, v161, s66
    v_add_u32 v136, v161, v162
    s_mul_i32 s65, s60, 80
    s_add_u32 s65, s65, 24
    v_lshrrev_b32 v161, 3, v160
    v_add_u32 v161, s65, v161
    v_lshrrev_b32 v162, 1, v161
    v_and_b32 v162, 7, v162
    v_and_b32 v137, 7, v160
    v_xor_b32 v162, v137, v162
    v_lshlrev_b32 v162, 4, v162
    v_add_u32 v161, s86, v161
    s_mov_b32 s66, 1280
    v_mul_lo_u32 v161, v161, s66
    v_add_u32 v137, v161, v162
    s_mul_i32 s65, s60, 80
    s_add_u32 s65, s65, 32
    v_lshrrev_b32 v161, 3, v160
    v_add_u32 v161, s65, v161
    v_lshrrev_b32 v162, 1, v161
    v_and_b32 v162, 7, v162
    v_and_b32 v138, 7, v160
    v_xor_b32 v162, v138, v162
    v_lshlrev_b32 v162, 4, v162
    v_add_u32 v161, s86, v161
    s_mov_b32 s66, 1280
    v_mul_lo_u32 v161, v161, s66
    v_add_u32 v138, v161, v162
    s_mul_i32 s65, s60, 80
    s_add_u32 s65, s65, 40
    v_lshrrev_b32 v161, 3, v160
    v_add_u32 v161, s65, v161
    v_lshrrev_b32 v162, 1, v161
    v_and_b32 v162, 7, v162
    v_and_b32 v139, 7, v160
    v_xor_b32 v162, v139, v162
    v_lshlrev_b32 v162, 4, v162
    v_add_u32 v161, s86, v161
    s_mov_b32 s66, 1280
    v_mul_lo_u32 v161, v161, s66
    v_add_u32 v139, v161, v162
    s_mul_i32 s65, s60, 80
    s_add_u32 s65, s65, 48
    v_lshrrev_b32 v161, 3, v160
    v_add_u32 v161, s65, v161
    v_lshrrev_b32 v162, 1, v161
    v_and_b32 v162, 7, v162
    v_and_b32 v140, 7, v160
    v_xor_b32 v162, v140, v162
    v_lshlrev_b32 v162, 4, v162
    v_add_u32 v161, s86, v161
    s_mov_b32 s66, 1280
    v_mul_lo_u32 v161, v161, s66
    v_add_u32 v140, v161, v162
    s_mul_i32 s65, s60, 80
    s_add_u32 s65, s65, 56
    v_lshrrev_b32 v161, 3, v160
    v_add_u32 v161, s65, v161
    v_lshrrev_b32 v162, 1, v161
    v_and_b32 v162, 7, v162
    v_and_b32 v141, 7, v160
    v_xor_b32 v162, v141, v162
    v_lshlrev_b32 v162, 4, v162
    v_add_u32 v161, s86, v161
    s_mov_b32 s66, 1280
    v_mul_lo_u32 v161, v161, s66
    v_add_u32 v141, v161, v162
    s_mul_i32 s65, s60, 80
    s_add_u32 s65, s65, 64
    v_lshrrev_b32 v161, 3, v160
    v_add_u32 v161, s65, v161
    v_lshrrev_b32 v162, 1, v161
    v_and_b32 v162, 7, v162
    v_and_b32 v142, 7, v160
    v_xor_b32 v162, v142, v162
    v_lshlrev_b32 v162, 4, v162
    v_add_u32 v161, s86, v161
    s_mov_b32 s66, 1280
    v_mul_lo_u32 v161, v161, s66
    v_add_u32 v142, v161, v162
    s_mul_i32 s65, s60, 80
    s_add_u32 s65, s65, 72
    v_lshrrev_b32 v161, 3, v160
    v_add_u32 v161, s65, v161
    v_lshrrev_b32 v162, 1, v161
    v_and_b32 v162, 7, v162
    v_and_b32 v143, 7, v160
    v_xor_b32 v162, v143, v162
    v_lshlrev_b32 v162, 4, v162
    v_add_u32 v161, s86, v161
    s_mov_b32 s66, 1280
    v_mul_lo_u32 v161, v161, s66
    v_add_u32 v143, v161, v162
    s_and_b32 s67, s60, 1
    s_lshr_b32 s68, s60, 1
    v_lshrrev_b32 v161, 5, v160
    v_add_u32 v161, 0, v161
    v_lshrrev_b32 v162, 1, v160
    v_and_b32 v162, 7, v162
    v_xor_b32 v161, v161, v162
    v_lshlrev_b32 v161, 4, v161
    v_and_b32 v162, 31, v160
    v_lshl_add_u32 v161, v162, 7, v161
    s_mul_i32 s65, s67, 4096
    v_add_u32 v144, s65, v161
    v_add_u32 v156, 0x10000, v144
    s_mul_i32 s65, s68, 20480
    v_add_u32 v148, s65, v161
    v_add_u32 v152, 0x10000, v148
    v_lshrrev_b32 v161, 5, v160
    v_add_u32 v161, 2, v161
    v_lshrrev_b32 v162, 1, v160
    v_and_b32 v162, 7, v162
    v_xor_b32 v161, v161, v162
    v_lshlrev_b32 v161, 4, v161
    v_and_b32 v162, 31, v160
    v_lshl_add_u32 v161, v162, 7, v161
    s_mul_i32 s65, s67, 4096
    v_add_u32 v145, s65, v161
    v_add_u32 v157, 0x10000, v145
    s_mul_i32 s65, s68, 20480
    v_add_u32 v149, s65, v161
    v_add_u32 v153, 0x10000, v149
    v_lshrrev_b32 v161, 5, v160
    v_add_u32 v161, 4, v161
    v_lshrrev_b32 v162, 1, v160
    v_and_b32 v162, 7, v162
    v_xor_b32 v161, v161, v162
    v_lshlrev_b32 v161, 4, v161
    v_and_b32 v162, 31, v160
    v_lshl_add_u32 v161, v162, 7, v161
    s_mul_i32 s65, s67, 4096
    v_add_u32 v146, s65, v161
    v_add_u32 v158, 0x10000, v146
    s_mul_i32 s65, s68, 20480
    v_add_u32 v150, s65, v161
    v_add_u32 v154, 0x10000, v150
    v_lshrrev_b32 v161, 5, v160
    v_add_u32 v161, 6, v161
    v_lshrrev_b32 v162, 1, v160
    v_and_b32 v162, 7, v162
    v_xor_b32 v161, v161, v162
    v_lshlrev_b32 v161, 4, v161
    v_and_b32 v162, 31, v160
    v_lshl_add_u32 v161, v162, 7, v161
    s_mul_i32 s65, s67, 4096
    v_add_u32 v147, s65, v161
    v_add_u32 v159, 0x10000, v147
    s_mul_i32 s65, s68, 20480
    v_add_u32 v151, s65, v161
    v_add_u32 v155, 0x10000, v151
    v_mov_b32 v4, 0
    v_mov_b32 v5, 0
    v_mov_b32 v6, 0
    v_mov_b32 v7, 0
    v_mov_b32 v8, 0
    v_mov_b32 v9, 0
    v_mov_b32 v10, 0
    v_mov_b32 v11, 0
    v_mov_b32 v12, 0
    v_mov_b32 v13, 0
    v_mov_b32 v14, 0
    v_mov_b32 v15, 0
    v_mov_b32 v16, 0
    v_mov_b32 v17, 0
    v_mov_b32 v18, 0
    v_mov_b32 v19, 0
    v_mov_b32 v20, 0
    v_mov_b32 v21, 0
    v_mov_b32 v22, 0
    v_mov_b32 v23, 0
    v_mov_b32 v24, 0
    v_mov_b32 v25, 0
    v_mov_b32 v26, 0
    v_mov_b32 v27, 0
    v_mov_b32 v28, 0
    v_mov_b32 v29, 0
    v_mov_b32 v30, 0
    v_mov_b32 v31, 0
    v_mov_b32 v32, 0
    v_mov_b32 v33, 0
    v_mov_b32 v34, 0
    v_mov_b32 v35, 0
    v_mov_b32 v36, 0
    v_mov_b32 v37, 0
    v_mov_b32 v38, 0
    v_mov_b32 v39, 0
    v_mov_b32 v40, 0
    v_mov_b32 v41, 0
    v_mov_b32 v42, 0
    v_mov_b32 v43, 0
    v_mov_b32 v44, 0
    v_mov_b32 v45, 0
    v_mov_b32 v46, 0
    v_mov_b32 v47, 0
    v_mov_b32 v48, 0
    v_mov_b32 v49, 0
    v_mov_b32 v50, 0
    v_mov_b32 v51, 0
    v_mov_b32 v52, 0
    v_mov_b32 v53, 0
    v_mov_b32 v54, 0
    v_mov_b32 v55, 0
    v_mov_b32 v56, 0
    v_mov_b32 v57, 0
    v_mov_b32 v58, 0
    v_mov_b32 v59, 0
    v_mov_b32 v60, 0
    v_mov_b32 v61, 0
    v_mov_b32 v62, 0
    v_mov_b32 v63, 0
    v_mov_b32 v64, 0
    v_mov_b32 v65, 0
    v_mov_b32 v66, 0
    v_mov_b32 v67, 0
    v_mov_b32 v68, 0
    v_mov_b32 v69, 0
    v_mov_b32 v70, 0
    v_mov_b32 v71, 0
    v_mov_b32 v72, 0
    v_mov_b32 v73, 0
    v_mov_b32 v74, 0
    v_mov_b32 v75, 0
    v_mov_b32 v76, 0
    v_mov_b32 v77, 0
    v_mov_b32 v78, 0
    v_mov_b32 v79, 0
    v_mov_b32 v80, 0
    v_mov_b32 v81, 0
    v_mov_b32 v82, 0
    v_mov_b32 v83, 0
    s_mov_b32 s69, 0
    s_add_u32 m0, s63, 1024
    buffer_load_dwordx4 v132, s[40:43], s69 offen lds
    s_add_u32 m0, s63, 2048
    buffer_load_dwordx4 v133, s[40:43], s69 offen lds
    s_add_u32 m0, s64, 9216
    buffer_load_dwordx4 v134, s[44:47], s69 offen lds
    s_add_u32 m0, s64, 10240
    buffer_load_dwordx4 v135, s[44:47], s69 offen lds
    s_add_u32 m0, s64, 11264
    buffer_load_dwordx4 v136, s[44:47], s69 offen lds
    s_add_u32 m0, s64, 12288
    buffer_load_dwordx4 v137, s[44:47], s69 offen lds
    s_add_u32 m0, s64, 13312
    buffer_load_dwordx4 v138, s[44:47], s69 offen lds
    s_add_u32 m0, s64, 14336
    buffer_load_dwordx4 v139, s[44:47], s69 offen lds
    s_add_u32 m0, s64, 15360
    buffer_load_dwordx4 v140, s[44:47], s69 offen lds
    s_add_u32 m0, s64, 16384
    buffer_load_dwordx4 v141, s[44:47], s69 offen lds
    s_add_u32 m0, s64, 17408
    buffer_load_dwordx4 v142, s[44:47], s69 offen lds
    s_add_u32 m0, s64, 18432
    buffer_load_dwordx4 v143, s[44:47], s69 offen lds
    s_mov_b32 s69, 128
    s_add_u32 m0, s63, 50176
    buffer_load_dwordx4 v132, s[40:43], s69 offen lds
    s_add_u32 m0, s63, 51200
    buffer_load_dwordx4 v133, s[40:43], s69 offen lds
    s_add_u32 m0, s64, 58368
    buffer_load_dwordx4 v134, s[44:47], s69 offen lds
    s_add_u32 m0, s64, 59392
    buffer_load_dwordx4 v135, s[44:47], s69 offen lds
    s_add_u32 m0, s64, 60416
    buffer_load_dwordx4 v136, s[44:47], s69 offen lds
    s_add_u32 m0, s64, 61440
    buffer_load_dwordx4 v137, s[44:47], s69 offen lds
    s_add_u32 m0, s64, 62464
    buffer_load_dwordx4 v138, s[44:47], s69 offen lds
    s_add_u32 m0, s64, 63488
    buffer_load_dwordx4 v139, s[44:47], s69 offen lds
    s_add_u32 m0, s64, 64512
    buffer_load_dwordx4 v140, s[44:47], s69 offen lds
    s_add_u32 m0, s64, 65536
    buffer_load_dwordx4 v141, s[44:47], s69 offen lds
    s_add_u32 m0, s64, 66560
    buffer_load_dwordx4 v142, s[44:47], s69 offen lds
    s_add_u32 m0, s64, 67584
    buffer_load_dwordx4 v143, s[44:47], s69 offen lds
    s_add_u32 s72, s36, 8044544
    s_addc_u32 s73, s37, 0
    s_and_b32 s73, s73, 0xffff
    s_mov_b32 s74, 163840
    s_mov_b32 s75, 0x00020000
    v_cmp_gt_u32 vcc, 64, v0
    s_and_saveexec_b64 s[76:77], vcc
    s_cbranch_execz .st_11
    v_add_u32 v104, s61, v0
    v_mul_u32_u24 v104, 80, v104
    buffer_load_dwordx4 v[84:87], v104, s[72:75], 0 offen offset:0
    buffer_load_dwordx4 v[88:91], v104, s[72:75], 0 offen offset:16
    buffer_load_dwordx4 v[92:95], v104, s[72:75], 0 offen offset:32
    buffer_load_dwordx4 v[96:99], v104, s[72:75], 0 offen offset:48
    buffer_load_dwordx4 v[100:103], v104, s[72:75], 0 offen offset:64
    s_waitcnt vmcnt(0)
    v_add_f32 v104, v84, v86
    v_add_f32 v105, v85, v87
    v_add_f32 v104, v104, v88
    v_add_f32 v105, v105, v89
    v_add_f32 v104, v104, v90
    v_add_f32 v105, v105, v91
    v_add_f32 v104, v104, v92
    v_add_f32 v105, v105, v93
    v_add_f32 v104, v104, v94
    v_add_f32 v105, v105, v95
    v_add_f32 v104, v104, v96
    v_add_f32 v105, v105, v97
    v_add_f32 v104, v104, v98
    v_add_f32 v105, v105, v99
    v_add_f32 v104, v104, v100
    v_add_f32 v105, v105, v101
    v_add_f32 v104, v104, v102
    v_add_f32 v105, v105, v103
    v_mul_f32 v104, 0x3acccccd, v104
    v_mul_f32 v105, 0x3acccccd, v105
    v_fma_f32 v105, -v104, v104, v105
    v_max_f32 v105, 0, v105
    v_cvt_pk_bf16_f32 v106, v104, v105
    v_lshlrev_b32 v104, 16, v106
    v_and_b32 v105, 0xffff0000, v106
    v_add_f32 v105, 0x3727c5ac, v105
    v_cvt_pk_bf16_f32 v106, v105, v105
    v_lshlrev_b32 v105, 16, v106
    v_sqrt_f32 v105, v105
    s_nop 0
    v_cvt_pk_bf16_f32 v106, v105, v105
    v_lshlrev_b32 v105, 16, v106
    v_rcp_f32 v105, v105
    v_lshlrev_b32 v106, 3, v0
    s_nop 0
    ds_write_b64 v106, v[104:105] offset:0
.st_11:
    s_or_b64 exec, exec, s[76:77]
    s_add_u32 s48, s36, 7700480
    s_addc_u32 s49, s37, 0
    s_and_b32 s49, s49, 0xffff
    s_mov_b32 s50, 7680
    s_mov_b32 s51, 0x00020000
    s_add_u32 s52, s36, 11161600
    s_addc_u32 s53, s37, 0
    s_and_b32 s53, s53, 0xffff
    s_mov_b32 s54, 166400
    s_mov_b32 s55, 0x00020000
    v_and_b32 v168, 31, v160
    v_lshlrev_b32 v168, 2, v168
    s_mul_i32 s65, s68, 160
    s_add_u32 s65, s65, s86
    s_lshl_b32 s65, s65, 2
    buffer_load_dword v163, v168, s[48:51], s65 offen offset:0
    buffer_load_dword v164, v168, s[48:51], s65 offen offset:128
    buffer_load_dword v165, v168, s[48:51], s65 offen offset:256
    buffer_load_dword v166, v168, s[48:51], s65 offen offset:384
    buffer_load_dword v167, v168, s[48:51], s65 offen offset:512
    s_waitcnt vmcnt(22)
    s_barrier
    s_mov_b32 s69, 256
    s_add_u32 m0, s63, 99328
    buffer_load_dwordx4 v132, s[40:43], s69 offen lds
    s_add_u32 m0, s63, 100352
    buffer_load_dwordx4 v133, s[40:43], s69 offen lds
    s_add_u32 m0, s64, 107520
    buffer_load_dwordx4 v134, s[44:47], s69 offen lds
    s_add_u32 m0, s64, 108544
    buffer_load_dwordx4 v135, s[44:47], s69 offen lds
    s_add_u32 m0, s64, 109568
    buffer_load_dwordx4 v136, s[44:47], s69 offen lds
    s_add_u32 m0, s64, 110592
    buffer_load_dwordx4 v137, s[44:47], s69 offen lds
    s_add_u32 m0, s64, 111616
    buffer_load_dwordx4 v138, s[44:47], s69 offen lds
    s_add_u32 m0, s64, 112640
    buffer_load_dwordx4 v139, s[44:47], s69 offen lds
    s_add_u32 m0, s64, 113664
    buffer_load_dwordx4 v140, s[44:47], s69 offen lds
    s_add_u32 m0, s64, 114688
    buffer_load_dwordx4 v141, s[44:47], s69 offen lds
    s_add_u32 m0, s64, 115712
    buffer_load_dwordx4 v142, s[44:47], s69 offen lds
    s_add_u32 m0, s64, 116736
    buffer_load_dwordx4 v143, s[44:47], s69 offen lds
    ds_read_b128 v[84:87], v144 offset:1024
    ds_read_b128 v[92:95], v148 offset:9216
    ds_read_b128 v[96:99], v148 offset:13312
    ds_read_b128 v[100:103], v148 offset:17408
    ds_read_b128 v[104:107], v148 offset:21504
    ds_read_b128 v[108:111], v148 offset:25600
    ds_read_b128 v[88:91], v145 offset:1024
    ds_read_b128 v[112:115], v149 offset:9216
    ds_read_b128 v[116:119], v149 offset:13312
    ds_read_b128 v[120:123], v149 offset:17408
    ds_read_b128 v[124:127], v149 offset:21504
    ds_read_b128 v[128:131], v149 offset:25600
    s_waitcnt lgkmcnt(6)
    v_mfma_f32_32x32x16_bf16 v[4:19], v[84:87], v[92:95], v[4:19]
    v_mfma_f32_32x32x16_bf16 v[20:35], v[84:87], v[96:99], v[20:35]
    v_mfma_f32_32x32x16_bf16 v[36:51], v[84:87], v[100:103], v[36:51]
    v_mfma_f32_32x32x16_bf16 v[52:67], v[84:87], v[104:107], v[52:67]
    v_mfma_f32_32x32x16_bf16 v[68:83], v[84:87], v[108:111], v[68:83]
    ds_read_b128 v[84:87], v146 offset:1024
    ds_read_b128 v[92:95], v150 offset:9216
    ds_read_b128 v[96:99], v150 offset:13312
    ds_read_b128 v[100:103], v150 offset:17408
    ds_read_b128 v[104:107], v150 offset:21504
    ds_read_b128 v[108:111], v150 offset:25600
    s_waitcnt lgkmcnt(6)
    v_mfma_f32_32x32x16_bf16 v[4:19], v[88:91], v[112:115], v[4:19]
    v_mfma_f32_32x32x16_bf16 v[20:35], v[88:91], v[116:119], v[20:35]
    v_mfma_f32_32x32x16_bf16 v[36:51], v[88:91], v[120:123], v[36:51]
    v_mfma_f32_32x32x16_bf16 v[52:67], v[88:91], v[124:127], v[52:67]
    v_mfma_f32_32x32x16_bf16 v[68:83], v[88:91], v[128:131], v[68:83]
    ds_read_b128 v[88:91], v147 offset:1024
    ds_read_b128 v[112:115], v151 offset:9216
    ds_read_b128 v[116:119], v151 offset:13312
    ds_read_b128 v[120:123], v151 offset:17408
    ds_read_b128 v[124:127], v151 offset:21504
    ds_read_b128 v[128:131], v151 offset:25600
    s_waitcnt lgkmcnt(6)
    v_mfma_f32_32x32x16_bf16 v[4:19], v[84:87], v[92:95], v[4:19]
    v_mfma_f32_32x32x16_bf16 v[20:35], v[84:87], v[96:99], v[20:35]
    v_mfma_f32_32x32x16_bf16 v[36:51], v[84:87], v[100:103], v[36:51]
    v_mfma_f32_32x32x16_bf16 v[52:67], v[84:87], v[104:107], v[52:67]
    v_mfma_f32_32x32x16_bf16 v[68:83], v[84:87], v[108:111], v[68:83]
    s_waitcnt vmcnt(22) lgkmcnt(0)
    s_barrier
    s_mov_b32 s69, 384
    s_add_u32 m0, s63, 1024
    buffer_load_dwordx4 v132, s[40:43], s69 offen lds
    s_add_u32 m0, s63, 2048
    buffer_load_dwordx4 v133, s[40:43], s69 offen lds
    s_add_u32 m0, s64, 9216
    buffer_load_dwordx4 v134, s[44:47], s69 offen lds
    s_add_u32 m0, s64, 10240
    buffer_load_dwordx4 v135, s[44:47], s69 offen lds
    s_add_u32 m0, s64, 11264
    buffer_load_dwordx4 v136, s[44:47], s69 offen lds
    s_add_u32 m0, s64, 12288
    buffer_load_dwordx4 v137, s[44:47], s69 offen lds
    s_add_u32 m0, s64, 13312
    buffer_load_dwordx4 v138, s[44:47], s69 offen lds
    s_add_u32 m0, s64, 14336
    buffer_load_dwordx4 v139, s[44:47], s69 offen lds
    s_add_u32 m0, s64, 15360
    buffer_load_dwordx4 v140, s[44:47], s69 offen lds
    s_add_u32 m0, s64, 16384
    buffer_load_dwordx4 v141, s[44:47], s69 offen lds
    s_add_u32 m0, s64, 17408
    buffer_load_dwordx4 v142, s[44:47], s69 offen lds
    s_add_u32 m0, s64, 18432
    buffer_load_dwordx4 v143, s[44:47], s69 offen lds
    ds_read_b128 v[84:87], v144 offset:50176
    ds_read_b128 v[92:95], v148 offset:58368
    ds_read_b128 v[96:99], v148 offset:62464
    ds_read_b128 v[100:103], v152 offset:1024
    ds_read_b128 v[104:107], v152 offset:5120
    ds_read_b128 v[108:111], v152 offset:9216
    v_mfma_f32_32x32x16_bf16 v[4:19], v[88:91], v[112:115], v[4:19]
    v_mfma_f32_32x32x16_bf16 v[20:35], v[88:91], v[116:119], v[20:35]
    v_mfma_f32_32x32x16_bf16 v[36:51], v[88:91], v[120:123], v[36:51]
    v_mfma_f32_32x32x16_bf16 v[52:67], v[88:91], v[124:127], v[52:67]
    v_mfma_f32_32x32x16_bf16 v[68:83], v[88:91], v[128:131], v[68:83]
    ds_read_b128 v[88:91], v145 offset:50176
    ds_read_b128 v[112:115], v149 offset:58368
    ds_read_b128 v[116:119], v149 offset:62464
    ds_read_b128 v[120:123], v153 offset:1024
    ds_read_b128 v[124:127], v153 offset:5120
    ds_read_b128 v[128:131], v153 offset:9216
    s_waitcnt lgkmcnt(6)
    v_mfma_f32_32x32x16_bf16 v[4:19], v[84:87], v[92:95], v[4:19]
    v_mfma_f32_32x32x16_bf16 v[20:35], v[84:87], v[96:99], v[20:35]
    v_mfma_f32_32x32x16_bf16 v[36:51], v[84:87], v[100:103], v[36:51]
    v_mfma_f32_32x32x16_bf16 v[52:67], v[84:87], v[104:107], v[52:67]
    v_mfma_f32_32x32x16_bf16 v[68:83], v[84:87], v[108:111], v[68:83]
    ds_read_b128 v[84:87], v146 offset:50176
    ds_read_b128 v[92:95], v150 offset:58368
    ds_read_b128 v[96:99], v150 offset:62464
    ds_read_b128 v[100:103], v154 offset:1024
    ds_read_b128 v[104:107], v154 offset:5120
    ds_read_b128 v[108:111], v154 offset:9216
    s_waitcnt lgkmcnt(6)
    v_mfma_f32_32x32x16_bf16 v[4:19], v[88:91], v[112:115], v[4:19]
    v_mfma_f32_32x32x16_bf16 v[20:35], v[88:91], v[116:119], v[20:35]
    v_mfma_f32_32x32x16_bf16 v[36:51], v[88:91], v[120:123], v[36:51]
    v_mfma_f32_32x32x16_bf16 v[52:67], v[88:91], v[124:127], v[52:67]
    v_mfma_f32_32x32x16_bf16 v[68:83], v[88:91], v[128:131], v[68:83]
    ds_read_b128 v[88:91], v147 offset:50176
    ds_read_b128 v[112:115], v151 offset:58368
    ds_read_b128 v[116:119], v151 offset:62464
    ds_read_b128 v[120:123], v155 offset:1024
    ds_read_b128 v[124:127], v155 offset:5120
    ds_read_b128 v[128:131], v155 offset:9216
    s_waitcnt lgkmcnt(6)
    v_mfma_f32_32x32x16_bf16 v[4:19], v[84:87], v[92:95], v[4:19]
    v_mfma_f32_32x32x16_bf16 v[20:35], v[84:87], v[96:99], v[20:35]
    v_mfma_f32_32x32x16_bf16 v[36:51], v[84:87], v[100:103], v[36:51]
    v_mfma_f32_32x32x16_bf16 v[52:67], v[84:87], v[104:107], v[52:67]
    v_mfma_f32_32x32x16_bf16 v[68:83], v[84:87], v[108:111], v[68:83]
    s_waitcnt vmcnt(12) lgkmcnt(0)
    s_barrier
    s_mov_b32 s69, 512
    s_add_u32 m0, s63, 50176
    buffer_load_dwordx4 v132, s[40:43], s69 offen lds
    s_add_u32 m0, s63, 51200
    buffer_load_dwordx4 v133, s[40:43], s69 offen lds
    s_add_u32 m0, s64, 58368
    buffer_load_dwordx4 v134, s[44:47], s69 offen lds
    s_add_u32 m0, s64, 59392
    buffer_load_dwordx4 v135, s[44:47], s69 offen lds
    s_add_u32 m0, s64, 60416
    buffer_load_dwordx4 v136, s[44:47], s69 offen lds
    s_add_u32 m0, s64, 61440
    buffer_load_dwordx4 v137, s[44:47], s69 offen lds
    s_add_u32 m0, s64, 62464
    buffer_load_dwordx4 v138, s[44:47], s69 offen lds
    s_add_u32 m0, s64, 63488
    buffer_load_dwordx4 v139, s[44:47], s69 offen lds
    s_add_u32 m0, s64, 64512
    buffer_load_dwordx4 v140, s[44:47], s69 offen lds
    s_add_u32 m0, s64, 65536
    buffer_load_dwordx4 v141, s[44:47], s69 offen lds
    s_add_u32 m0, s64, 66560
    buffer_load_dwordx4 v142, s[44:47], s69 offen lds
    s_add_u32 m0, s64, 67584
    buffer_load_dwordx4 v143, s[44:47], s69 offen lds
    ds_read_b128 v[84:87], v156 offset:33792
    ds_read_b128 v[92:95], v152 offset:41984
    ds_read_b128 v[96:99], v152 offset:46080
    ds_read_b128 v[100:103], v152 offset:50176
    ds_read_b128 v[104:107], v152 offset:54272
    ds_read_b128 v[108:111], v152 offset:58368
    v_mfma_f32_32x32x16_bf16 v[4:19], v[88:91], v[112:115], v[4:19]
    v_mfma_f32_32x32x16_bf16 v[20:35], v[88:91], v[116:119], v[20:35]
    v_mfma_f32_32x32x16_bf16 v[36:51], v[88:91], v[120:123], v[36:51]
    v_mfma_f32_32x32x16_bf16 v[52:67], v[88:91], v[124:127], v[52:67]
    v_mfma_f32_32x32x16_bf16 v[68:83], v[88:91], v[128:131], v[68:83]
    ds_read_b128 v[88:91], v157 offset:33792
    ds_read_b128 v[112:115], v153 offset:41984
    ds_read_b128 v[116:119], v153 offset:46080
    ds_read_b128 v[120:123], v153 offset:50176
    ds_read_b128 v[124:127], v153 offset:54272
    ds_read_b128 v[128:131], v153 offset:58368
    s_waitcnt lgkmcnt(6)
    v_mfma_f32_32x32x16_bf16 v[4:19], v[84:87], v[92:95], v[4:19]
    v_mfma_f32_32x32x16_bf16 v[20:35], v[84:87], v[96:99], v[20:35]
    v_mfma_f32_32x32x16_bf16 v[36:51], v[84:87], v[100:103], v[36:51]
    v_mfma_f32_32x32x16_bf16 v[52:67], v[84:87], v[104:107], v[52:67]
    v_mfma_f32_32x32x16_bf16 v[68:83], v[84:87], v[108:111], v[68:83]
    ds_read_b128 v[84:87], v158 offset:33792
    ds_read_b128 v[92:95], v154 offset:41984
    ds_read_b128 v[96:99], v154 offset:46080
    ds_read_b128 v[100:103], v154 offset:50176
    ds_read_b128 v[104:107], v154 offset:54272
    ds_read_b128 v[108:111], v154 offset:58368
    s_waitcnt lgkmcnt(6)
    v_mfma_f32_32x32x16_bf16 v[4:19], v[88:91], v[112:115], v[4:19]
    v_mfma_f32_32x32x16_bf16 v[20:35], v[88:91], v[116:119], v[20:35]
    v_mfma_f32_32x32x16_bf16 v[36:51], v[88:91], v[120:123], v[36:51]
    v_mfma_f32_32x32x16_bf16 v[52:67], v[88:91], v[124:127], v[52:67]
    v_mfma_f32_32x32x16_bf16 v[68:83], v[88:91], v[128:131], v[68:83]
    ds_read_b128 v[88:91], v159 offset:33792
    ds_read_b128 v[112:115], v155 offset:41984
    ds_read_b128 v[116:119], v155 offset:46080
    ds_read_b128 v[120:123], v155 offset:50176
    ds_read_b128 v[124:127], v155 offset:54272
    ds_read_b128 v[128:131], v155 offset:58368
    s_waitcnt lgkmcnt(6)
    v_mfma_f32_32x32x16_bf16 v[4:19], v[84:87], v[92:95], v[4:19]
    v_mfma_f32_32x32x16_bf16 v[20:35], v[84:87], v[96:99], v[20:35]
    v_mfma_f32_32x32x16_bf16 v[36:51], v[84:87], v[100:103], v[36:51]
    v_mfma_f32_32x32x16_bf16 v[52:67], v[84:87], v[104:107], v[52:67]
    v_mfma_f32_32x32x16_bf16 v[68:83], v[84:87], v[108:111], v[68:83]
    s_waitcnt vmcnt(12) lgkmcnt(0)
    s_barrier
    s_mov_b32 s69, 640
    s_add_u32 m0, s63, 99328
    buffer_load_dwordx4 v132, s[40:43], s69 offen lds
    s_add_u32 m0, s63, 100352
    buffer_load_dwordx4 v133, s[40:43], s69 offen lds
    s_add_u32 m0, s64, 107520
    buffer_load_dwordx4 v134, s[44:47], s69 offen lds
    s_add_u32 m0, s64, 108544
    buffer_load_dwordx4 v135, s[44:47], s69 offen lds
    s_add_u32 m0, s64, 109568
    buffer_load_dwordx4 v136, s[44:47], s69 offen lds
    s_add_u32 m0, s64, 110592
    buffer_load_dwordx4 v137, s[44:47], s69 offen lds
    s_add_u32 m0, s64, 111616
    buffer_load_dwordx4 v138, s[44:47], s69 offen lds
    s_add_u32 m0, s64, 112640
    buffer_load_dwordx4 v139, s[44:47], s69 offen lds
    s_add_u32 m0, s64, 113664
    buffer_load_dwordx4 v140, s[44:47], s69 offen lds
    s_add_u32 m0, s64, 114688
    buffer_load_dwordx4 v141, s[44:47], s69 offen lds
    s_add_u32 m0, s64, 115712
    buffer_load_dwordx4 v142, s[44:47], s69 offen lds
    s_add_u32 m0, s64, 116736
    buffer_load_dwordx4 v143, s[44:47], s69 offen lds
    ds_read_b128 v[84:87], v144 offset:1024
    ds_read_b128 v[92:95], v148 offset:9216
    ds_read_b128 v[96:99], v148 offset:13312
    ds_read_b128 v[100:103], v148 offset:17408
    ds_read_b128 v[104:107], v148 offset:21504
    ds_read_b128 v[108:111], v148 offset:25600
    v_mfma_f32_32x32x16_bf16 v[4:19], v[88:91], v[112:115], v[4:19]
    v_mfma_f32_32x32x16_bf16 v[20:35], v[88:91], v[116:119], v[20:35]
    v_mfma_f32_32x32x16_bf16 v[36:51], v[88:91], v[120:123], v[36:51]
    v_mfma_f32_32x32x16_bf16 v[52:67], v[88:91], v[124:127], v[52:67]
    v_mfma_f32_32x32x16_bf16 v[68:83], v[88:91], v[128:131], v[68:83]
    ds_read_b128 v[88:91], v145 offset:1024
    ds_read_b128 v[112:115], v149 offset:9216
    ds_read_b128 v[116:119], v149 offset:13312
    ds_read_b128 v[120:123], v149 offset:17408
    ds_read_b128 v[124:127], v149 offset:21504
    ds_read_b128 v[128:131], v149 offset:25600
    s_waitcnt lgkmcnt(6)
    v_mfma_f32_32x32x16_bf16 v[4:19], v[84:87], v[92:95], v[4:19]
    v_mfma_f32_32x32x16_bf16 v[20:35], v[84:87], v[96:99], v[20:35]
    v_mfma_f32_32x32x16_bf16 v[36:51], v[84:87], v[100:103], v[36:51]
    v_mfma_f32_32x32x16_bf16 v[52:67], v[84:87], v[104:107], v[52:67]
    v_mfma_f32_32x32x16_bf16 v[68:83], v[84:87], v[108:111], v[68:83]
    ds_read_b128 v[84:87], v146 offset:1024
    ds_read_b128 v[92:95], v150 offset:9216
    ds_read_b128 v[96:99], v150 offset:13312
    ds_read_b128 v[100:103], v150 offset:17408
    ds_read_b128 v[104:107], v150 offset:21504
    ds_read_b128 v[108:111], v150 offset:25600
    s_waitcnt lgkmcnt(6)
    v_mfma_f32_32x32x16_bf16 v[4:19], v[88:91], v[112:115], v[4:19]
    v_mfma_f32_32x32x16_bf16 v[20:35], v[88:91], v[116:119], v[20:35]
    v_mfma_f32_32x32x16_bf16 v[36:51], v[88:91], v[120:123], v[36:51]
    v_mfma_f32_32x32x16_bf16 v[52:67], v[88:91], v[124:127], v[52:67]
    v_mfma_f32_32x32x16_bf16 v[68:83], v[88:91], v[128:131], v[68:83]
    ds_read_b128 v[88:91], v147 offset:1024
    ds_read_b128 v[112:115], v151 offset:9216
    ds_read_b128 v[116:119], v151 offset:13312
    ds_read_b128 v[120:123], v151 offset:17408
    ds_read_b128 v[124:127], v151 offset:21504
    ds_read_b128 v[128:131], v151 offset:25600
    s_waitcnt lgkmcnt(6)
    v_mfma_f32_32x32x16_bf16 v[4:19], v[84:87], v[92:95], v[4:19]
    v_mfma_f32_32x32x16_bf16 v[20:35], v[84:87], v[96:99], v[20:35]
    v_mfma_f32_32x32x16_bf16 v[36:51], v[84:87], v[100:103], v[36:51]
    v_mfma_f32_32x32x16_bf16 v[52:67], v[84:87], v[104:107], v[52:67]
    v_mfma_f32_32x32x16_bf16 v[68:83], v[84:87], v[108:111], v[68:83]
    s_waitcnt vmcnt(12) lgkmcnt(0)
    s_barrier
    s_mov_b32 s69, 768
    s_add_u32 m0, s63, 1024
    buffer_load_dwordx4 v132, s[40:43], s69 offen lds
    s_add_u32 m0, s63, 2048
    buffer_load_dwordx4 v133, s[40:43], s69 offen lds
    s_add_u32 m0, s64, 9216
    buffer_load_dwordx4 v134, s[44:47], s69 offen lds
    s_add_u32 m0, s64, 10240
    buffer_load_dwordx4 v135, s[44:47], s69 offen lds
    s_add_u32 m0, s64, 11264
    buffer_load_dwordx4 v136, s[44:47], s69 offen lds
    s_add_u32 m0, s64, 12288
    buffer_load_dwordx4 v137, s[44:47], s69 offen lds
    s_add_u32 m0, s64, 13312
    buffer_load_dwordx4 v138, s[44:47], s69 offen lds
    s_add_u32 m0, s64, 14336
    buffer_load_dwordx4 v139, s[44:47], s69 offen lds
    s_add_u32 m0, s64, 15360
    buffer_load_dwordx4 v140, s[44:47], s69 offen lds
    s_add_u32 m0, s64, 16384
    buffer_load_dwordx4 v141, s[44:47], s69 offen lds
    s_add_u32 m0, s64, 17408
    buffer_load_dwordx4 v142, s[44:47], s69 offen lds
    s_add_u32 m0, s64, 18432
    buffer_load_dwordx4 v143, s[44:47], s69 offen lds
    ds_read_b128 v[84:87], v144 offset:50176
    ds_read_b128 v[92:95], v148 offset:58368
    ds_read_b128 v[96:99], v148 offset:62464
    ds_read_b128 v[100:103], v152 offset:1024
    ds_read_b128 v[104:107], v152 offset:5120
    ds_read_b128 v[108:111], v152 offset:9216
    v_mfma_f32_32x32x16_bf16 v[4:19], v[88:91], v[112:115], v[4:19]
    v_mfma_f32_32x32x16_bf16 v[20:35], v[88:91], v[116:119], v[20:35]
    v_mfma_f32_32x32x16_bf16 v[36:51], v[88:91], v[120:123], v[36:51]
    v_mfma_f32_32x32x16_bf16 v[52:67], v[88:91], v[124:127], v[52:67]
    v_mfma_f32_32x32x16_bf16 v[68:83], v[88:91], v[128:131], v[68:83]
    ds_read_b128 v[88:91], v145 offset:50176
    ds_read_b128 v[112:115], v149 offset:58368
    ds_read_b128 v[116:119], v149 offset:62464
    ds_read_b128 v[120:123], v153 offset:1024
    ds_read_b128 v[124:127], v153 offset:5120
    ds_read_b128 v[128:131], v153 offset:9216
    s_waitcnt lgkmcnt(6)
    v_mfma_f32_32x32x16_bf16 v[4:19], v[84:87], v[92:95], v[4:19]
    v_mfma_f32_32x32x16_bf16 v[20:35], v[84:87], v[96:99], v[20:35]
    v_mfma_f32_32x32x16_bf16 v[36:51], v[84:87], v[100:103], v[36:51]
    v_mfma_f32_32x32x16_bf16 v[52:67], v[84:87], v[104:107], v[52:67]
    v_mfma_f32_32x32x16_bf16 v[68:83], v[84:87], v[108:111], v[68:83]
    ds_read_b128 v[84:87], v146 offset:50176
    ds_read_b128 v[92:95], v150 offset:58368
    ds_read_b128 v[96:99], v150 offset:62464
    ds_read_b128 v[100:103], v154 offset:1024
    ds_read_b128 v[104:107], v154 offset:5120
    ds_read_b128 v[108:111], v154 offset:9216
    s_waitcnt lgkmcnt(6)
    v_mfma_f32_32x32x16_bf16 v[4:19], v[88:91], v[112:115], v[4:19]
    v_mfma_f32_32x32x16_bf16 v[20:35], v[88:91], v[116:119], v[20:35]
    v_mfma_f32_32x32x16_bf16 v[36:51], v[88:91], v[120:123], v[36:51]
    v_mfma_f32_32x32x16_bf16 v[52:67], v[88:91], v[124:127], v[52:67]
    v_mfma_f32_32x32x16_bf16 v[68:83], v[88:91], v[128:131], v[68:83]
    ds_read_b128 v[88:91], v147 offset:50176
    ds_read_b128 v[112:115], v151 offset:58368
    ds_read_b128 v[116:119], v151 offset:62464
    ds_read_b128 v[120:123], v155 offset:1024
    ds_read_b128 v[124:127], v155 offset:5120
    ds_read_b128 v[128:131], v155 offset:9216
    s_waitcnt lgkmcnt(6)
    v_mfma_f32_32x32x16_bf16 v[4:19], v[84:87], v[92:95], v[4:19]
    v_mfma_f32_32x32x16_bf16 v[20:35], v[84:87], v[96:99], v[20:35]
    v_mfma_f32_32x32x16_bf16 v[36:51], v[84:87], v[100:103], v[36:51]
    v_mfma_f32_32x32x16_bf16 v[52:67], v[84:87], v[104:107], v[52:67]
    v_mfma_f32_32x32x16_bf16 v[68:83], v[84:87], v[108:111], v[68:83]
    s_waitcnt vmcnt(12) lgkmcnt(0)
    s_barrier
    s_mov_b32 s69, 896
    s_add_u32 m0, s63, 50176
    buffer_load_dwordx4 v132, s[40:43], s69 offen lds
    s_add_u32 m0, s63, 51200
    buffer_load_dwordx4 v133, s[40:43], s69 offen lds
    s_add_u32 m0, s64, 58368
    buffer_load_dwordx4 v134, s[44:47], s69 offen lds
    s_add_u32 m0, s64, 59392
    buffer_load_dwordx4 v135, s[44:47], s69 offen lds
    s_add_u32 m0, s64, 60416
    buffer_load_dwordx4 v136, s[44:47], s69 offen lds
    s_add_u32 m0, s64, 61440
    buffer_load_dwordx4 v137, s[44:47], s69 offen lds
    s_add_u32 m0, s64, 62464
    buffer_load_dwordx4 v138, s[44:47], s69 offen lds
    s_add_u32 m0, s64, 63488
    buffer_load_dwordx4 v139, s[44:47], s69 offen lds
    s_add_u32 m0, s64, 64512
    buffer_load_dwordx4 v140, s[44:47], s69 offen lds
    s_add_u32 m0, s64, 65536
    buffer_load_dwordx4 v141, s[44:47], s69 offen lds
    s_add_u32 m0, s64, 66560
    buffer_load_dwordx4 v142, s[44:47], s69 offen lds
    s_add_u32 m0, s64, 67584
    buffer_load_dwordx4 v143, s[44:47], s69 offen lds
    ds_read_b128 v[84:87], v156 offset:33792
    ds_read_b128 v[92:95], v152 offset:41984
    ds_read_b128 v[96:99], v152 offset:46080
    ds_read_b128 v[100:103], v152 offset:50176
    ds_read_b128 v[104:107], v152 offset:54272
    ds_read_b128 v[108:111], v152 offset:58368
    v_mfma_f32_32x32x16_bf16 v[4:19], v[88:91], v[112:115], v[4:19]
    v_mfma_f32_32x32x16_bf16 v[20:35], v[88:91], v[116:119], v[20:35]
    v_mfma_f32_32x32x16_bf16 v[36:51], v[88:91], v[120:123], v[36:51]
    v_mfma_f32_32x32x16_bf16 v[52:67], v[88:91], v[124:127], v[52:67]
    v_mfma_f32_32x32x16_bf16 v[68:83], v[88:91], v[128:131], v[68:83]
    ds_read_b128 v[88:91], v157 offset:33792
    ds_read_b128 v[112:115], v153 offset:41984
    ds_read_b128 v[116:119], v153 offset:46080
    ds_read_b128 v[120:123], v153 offset:50176
    ds_read_b128 v[124:127], v153 offset:54272
    ds_read_b128 v[128:131], v153 offset:58368
    s_waitcnt lgkmcnt(6)
    v_mfma_f32_32x32x16_bf16 v[4:19], v[84:87], v[92:95], v[4:19]
    v_mfma_f32_32x32x16_bf16 v[20:35], v[84:87], v[96:99], v[20:35]
    v_mfma_f32_32x32x16_bf16 v[36:51], v[84:87], v[100:103], v[36:51]
    v_mfma_f32_32x32x16_bf16 v[52:67], v[84:87], v[104:107], v[52:67]
    v_mfma_f32_32x32x16_bf16 v[68:83], v[84:87], v[108:111], v[68:83]
    ds_read_b128 v[84:87], v158 offset:33792
    ds_read_b128 v[92:95], v154 offset:41984
    ds_read_b128 v[96:99], v154 offset:46080
    ds_read_b128 v[100:103], v154 offset:50176
    ds_read_b128 v[104:107], v154 offset:54272
    ds_read_b128 v[108:111], v154 offset:58368
    s_waitcnt lgkmcnt(6)
    v_mfma_f32_32x32x16_bf16 v[4:19], v[88:91], v[112:115], v[4:19]
    v_mfma_f32_32x32x16_bf16 v[20:35], v[88:91], v[116:119], v[20:35]
    v_mfma_f32_32x32x16_bf16 v[36:51], v[88:91], v[120:123], v[36:51]
    v_mfma_f32_32x32x16_bf16 v[52:67], v[88:91], v[124:127], v[52:67]
    v_mfma_f32_32x32x16_bf16 v[68:83], v[88:91], v[128:131], v[68:83]
    ds_read_b128 v[88:91], v159 offset:33792
    ds_read_b128 v[112:115], v155 offset:41984
    ds_read_b128 v[116:119], v155 offset:46080
    ds_read_b128 v[120:123], v155 offset:50176
    ds_read_b128 v[124:127], v155 offset:54272
    ds_read_b128 v[128:131], v155 offset:58368
    s_waitcnt lgkmcnt(6)
    v_mfma_f32_32x32x16_bf16 v[4:19], v[84:87], v[92:95], v[4:19]
    v_mfma_f32_32x32x16_bf16 v[20:35], v[84:87], v[96:99], v[20:35]
    v_mfma_f32_32x32x16_bf16 v[36:51], v[84:87], v[100:103], v[36:51]
    v_mfma_f32_32x32x16_bf16 v[52:67], v[84:87], v[104:107], v[52:67]
    v_mfma_f32_32x32x16_bf16 v[68:83], v[84:87], v[108:111], v[68:83]
    s_waitcnt vmcnt(12) lgkmcnt(0)
    s_barrier
    s_mov_b32 s69, 1024
    s_add_u32 m0, s63, 99328
    buffer_load_dwordx4 v132, s[40:43], s69 offen lds
    s_add_u32 m0, s63, 100352
    buffer_load_dwordx4 v133, s[40:43], s69 offen lds
    s_add_u32 m0, s64, 107520
    buffer_load_dwordx4 v134, s[44:47], s69 offen lds
    s_add_u32 m0, s64, 108544
    buffer_load_dwordx4 v135, s[44:47], s69 offen lds
    s_add_u32 m0, s64, 109568
    buffer_load_dwordx4 v136, s[44:47], s69 offen lds
    s_add_u32 m0, s64, 110592
    buffer_load_dwordx4 v137, s[44:47], s69 offen lds
    s_add_u32 m0, s64, 111616
    buffer_load_dwordx4 v138, s[44:47], s69 offen lds
    s_add_u32 m0, s64, 112640
    buffer_load_dwordx4 v139, s[44:47], s69 offen lds
    s_add_u32 m0, s64, 113664
    buffer_load_dwordx4 v140, s[44:47], s69 offen lds
    s_add_u32 m0, s64, 114688
    buffer_load_dwordx4 v141, s[44:47], s69 offen lds
    s_add_u32 m0, s64, 115712
    buffer_load_dwordx4 v142, s[44:47], s69 offen lds
    s_add_u32 m0, s64, 116736
    buffer_load_dwordx4 v143, s[44:47], s69 offen lds
    ds_read_b128 v[84:87], v144 offset:1024
    ds_read_b128 v[92:95], v148 offset:9216
    ds_read_b128 v[96:99], v148 offset:13312
    ds_read_b128 v[100:103], v148 offset:17408
    ds_read_b128 v[104:107], v148 offset:21504
    ds_read_b128 v[108:111], v148 offset:25600
    v_mfma_f32_32x32x16_bf16 v[4:19], v[88:91], v[112:115], v[4:19]
    v_mfma_f32_32x32x16_bf16 v[20:35], v[88:91], v[116:119], v[20:35]
    v_mfma_f32_32x32x16_bf16 v[36:51], v[88:91], v[120:123], v[36:51]
    v_mfma_f32_32x32x16_bf16 v[52:67], v[88:91], v[124:127], v[52:67]
    v_mfma_f32_32x32x16_bf16 v[68:83], v[88:91], v[128:131], v[68:83]
    ds_read_b128 v[88:91], v145 offset:1024
    ds_read_b128 v[112:115], v149 offset:9216
    ds_read_b128 v[116:119], v149 offset:13312
    ds_read_b128 v[120:123], v149 offset:17408
    ds_read_b128 v[124:127], v149 offset:21504
    ds_read_b128 v[128:131], v149 offset:25600
    s_waitcnt lgkmcnt(6)
    v_mfma_f32_32x32x16_bf16 v[4:19], v[84:87], v[92:95], v[4:19]
    v_mfma_f32_32x32x16_bf16 v[20:35], v[84:87], v[96:99], v[20:35]
    v_mfma_f32_32x32x16_bf16 v[36:51], v[84:87], v[100:103], v[36:51]
    v_mfma_f32_32x32x16_bf16 v[52:67], v[84:87], v[104:107], v[52:67]
    v_mfma_f32_32x32x16_bf16 v[68:83], v[84:87], v[108:111], v[68:83]
    ds_read_b128 v[84:87], v146 offset:1024
    ds_read_b128 v[92:95], v150 offset:9216
    ds_read_b128 v[96:99], v150 offset:13312
    ds_read_b128 v[100:103], v150 offset:17408
    ds_read_b128 v[104:107], v150 offset:21504
    ds_read_b128 v[108:111], v150 offset:25600
    s_waitcnt lgkmcnt(6)
    v_mfma_f32_32x32x16_bf16 v[4:19], v[88:91], v[112:115], v[4:19]
    v_mfma_f32_32x32x16_bf16 v[20:35], v[88:91], v[116:119], v[20:35]
    v_mfma_f32_32x32x16_bf16 v[36:51], v[88:91], v[120:123], v[36:51]
    v_mfma_f32_32x32x16_bf16 v[52:67], v[88:91], v[124:127], v[52:67]
    v_mfma_f32_32x32x16_bf16 v[68:83], v[88:91], v[128:131], v[68:83]
    ds_read_b128 v[88:91], v147 offset:1024
    ds_read_b128 v[112:115], v151 offset:9216
    ds_read_b128 v[116:119], v151 offset:13312
    ds_read_b128 v[120:123], v151 offset:17408
    ds_read_b128 v[124:127], v151 offset:21504
    ds_read_b128 v[128:131], v151 offset:25600
    s_waitcnt lgkmcnt(6)
    v_mfma_f32_32x32x16_bf16 v[4:19], v[84:87], v[92:95], v[4:19]
    v_mfma_f32_32x32x16_bf16 v[20:35], v[84:87], v[96:99], v[20:35]
    v_mfma_f32_32x32x16_bf16 v[36:51], v[84:87], v[100:103], v[36:51]
    v_mfma_f32_32x32x16_bf16 v[52:67], v[84:87], v[104:107], v[52:67]
    v_mfma_f32_32x32x16_bf16 v[68:83], v[84:87], v[108:111], v[68:83]
    s_waitcnt vmcnt(12) lgkmcnt(0)
    s_barrier
    s_mov_b32 s69, 1152
    s_add_u32 m0, s63, 1024
    buffer_load_dwordx4 v132, s[40:43], s69 offen lds
    s_add_u32 m0, s63, 2048
    buffer_load_dwordx4 v133, s[40:43], s69 offen lds
    s_add_u32 m0, s64, 9216
    buffer_load_dwordx4 v134, s[44:47], s69 offen lds
    s_add_u32 m0, s64, 10240
    buffer_load_dwordx4 v135, s[44:47], s69 offen lds
    s_add_u32 m0, s64, 11264
    buffer_load_dwordx4 v136, s[44:47], s69 offen lds
    s_add_u32 m0, s64, 12288
    buffer_load_dwordx4 v137, s[44:47], s69 offen lds
    s_add_u32 m0, s64, 13312
    buffer_load_dwordx4 v138, s[44:47], s69 offen lds
    s_add_u32 m0, s64, 14336
    buffer_load_dwordx4 v139, s[44:47], s69 offen lds
    s_add_u32 m0, s64, 15360
    buffer_load_dwordx4 v140, s[44:47], s69 offen lds
    s_add_u32 m0, s64, 16384
    buffer_load_dwordx4 v141, s[44:47], s69 offen lds
    s_add_u32 m0, s64, 17408
    buffer_load_dwordx4 v142, s[44:47], s69 offen lds
    s_add_u32 m0, s64, 18432
    buffer_load_dwordx4 v143, s[44:47], s69 offen lds
    ds_read_b128 v[84:87], v144 offset:50176
    ds_read_b128 v[92:95], v148 offset:58368
    ds_read_b128 v[96:99], v148 offset:62464
    ds_read_b128 v[100:103], v152 offset:1024
    ds_read_b128 v[104:107], v152 offset:5120
    ds_read_b128 v[108:111], v152 offset:9216
    v_mfma_f32_32x32x16_bf16 v[4:19], v[88:91], v[112:115], v[4:19]
    v_mfma_f32_32x32x16_bf16 v[20:35], v[88:91], v[116:119], v[20:35]
    v_mfma_f32_32x32x16_bf16 v[36:51], v[88:91], v[120:123], v[36:51]
    v_mfma_f32_32x32x16_bf16 v[52:67], v[88:91], v[124:127], v[52:67]
    v_mfma_f32_32x32x16_bf16 v[68:83], v[88:91], v[128:131], v[68:83]
    ds_read_b128 v[88:91], v145 offset:50176
    ds_read_b128 v[112:115], v149 offset:58368
    ds_read_b128 v[116:119], v149 offset:62464
    ds_read_b128 v[120:123], v153 offset:1024
    ds_read_b128 v[124:127], v153 offset:5120
    ds_read_b128 v[128:131], v153 offset:9216
    s_waitcnt lgkmcnt(6)
    v_mfma_f32_32x32x16_bf16 v[4:19], v[84:87], v[92:95], v[4:19]
    v_mfma_f32_32x32x16_bf16 v[20:35], v[84:87], v[96:99], v[20:35]
    v_mfma_f32_32x32x16_bf16 v[36:51], v[84:87], v[100:103], v[36:51]
    v_mfma_f32_32x32x16_bf16 v[52:67], v[84:87], v[104:107], v[52:67]
    v_mfma_f32_32x32x16_bf16 v[68:83], v[84:87], v[108:111], v[68:83]
    ds_read_b128 v[84:87], v146 offset:50176
    ds_read_b128 v[92:95], v150 offset:58368
    ds_read_b128 v[96:99], v150 offset:62464
    ds_read_b128 v[100:103], v154 offset:1024
    ds_read_b128 v[104:107], v154 offset:5120
    ds_read_b128 v[108:111], v154 offset:9216
    s_waitcnt lgkmcnt(6)
    v_mfma_f32_32x32x16_bf16 v[4:19], v[88:91], v[112:115], v[4:19]
    v_mfma_f32_32x32x16_bf16 v[20:35], v[88:91], v[116:119], v[20:35]
    v_mfma_f32_32x32x16_bf16 v[36:51], v[88:91], v[120:123], v[36:51]
    v_mfma_f32_32x32x16_bf16 v[52:67], v[88:91], v[124:127], v[52:67]
    v_mfma_f32_32x32x16_bf16 v[68:83], v[88:91], v[128:131], v[68:83]
    ds_read_b128 v[88:91], v147 offset:50176
    ds_read_b128 v[112:115], v151 offset:58368
    ds_read_b128 v[116:119], v151 offset:62464
    ds_read_b128 v[120:123], v155 offset:1024
    ds_read_b128 v[124:127], v155 offset:5120
    ds_read_b128 v[128:131], v155 offset:9216
    s_waitcnt lgkmcnt(6)
    v_mfma_f32_32x32x16_bf16 v[4:19], v[84:87], v[92:95], v[4:19]
    v_mfma_f32_32x32x16_bf16 v[20:35], v[84:87], v[96:99], v[20:35]
    v_mfma_f32_32x32x16_bf16 v[36:51], v[84:87], v[100:103], v[36:51]
    v_mfma_f32_32x32x16_bf16 v[52:67], v[84:87], v[104:107], v[52:67]
    v_mfma_f32_32x32x16_bf16 v[68:83], v[84:87], v[108:111], v[68:83]
    s_waitcnt vmcnt(12) lgkmcnt(0)
    s_barrier
    ds_read_b128 v[84:87], v156 offset:33792
    ds_read_b128 v[92:95], v152 offset:41984
    ds_read_b128 v[96:99], v152 offset:46080
    ds_read_b128 v[100:103], v152 offset:50176
    ds_read_b128 v[104:107], v152 offset:54272
    ds_read_b128 v[108:111], v152 offset:58368
    v_mfma_f32_32x32x16_bf16 v[4:19], v[88:91], v[112:115], v[4:19]
    v_mfma_f32_32x32x16_bf16 v[20:35], v[88:91], v[116:119], v[20:35]
    v_mfma_f32_32x32x16_bf16 v[36:51], v[88:91], v[120:123], v[36:51]
    v_mfma_f32_32x32x16_bf16 v[52:67], v[88:91], v[124:127], v[52:67]
    v_mfma_f32_32x32x16_bf16 v[68:83], v[88:91], v[128:131], v[68:83]
    ds_read_b128 v[88:91], v157 offset:33792
    ds_read_b128 v[112:115], v153 offset:41984
    ds_read_b128 v[116:119], v153 offset:46080
    ds_read_b128 v[120:123], v153 offset:50176
    ds_read_b128 v[124:127], v153 offset:54272
    ds_read_b128 v[128:131], v153 offset:58368
    s_waitcnt lgkmcnt(6)
    v_mfma_f32_32x32x16_bf16 v[4:19], v[84:87], v[92:95], v[4:19]
    v_mfma_f32_32x32x16_bf16 v[20:35], v[84:87], v[96:99], v[20:35]
    v_mfma_f32_32x32x16_bf16 v[36:51], v[84:87], v[100:103], v[36:51]
    v_mfma_f32_32x32x16_bf16 v[52:67], v[84:87], v[104:107], v[52:67]
    v_mfma_f32_32x32x16_bf16 v[68:83], v[84:87], v[108:111], v[68:83]
    ds_read_b128 v[84:87], v158 offset:33792
    ds_read_b128 v[92:95], v154 offset:41984
    ds_read_b128 v[96:99], v154 offset:46080
    ds_read_b128 v[100:103], v154 offset:50176
    ds_read_b128 v[104:107], v154 offset:54272
    ds_read_b128 v[108:111], v154 offset:58368
    s_waitcnt lgkmcnt(6)
    v_mfma_f32_32x32x16_bf16 v[4:19], v[88:91], v[112:115], v[4:19]
    v_mfma_f32_32x32x16_bf16 v[20:35], v[88:91], v[116:119], v[20:35]
    v_mfma_f32_32x32x16_bf16 v[36:51], v[88:91], v[120:123], v[36:51]
    v_mfma_f32_32x32x16_bf16 v[52:67], v[88:91], v[124:127], v[52:67]
    v_mfma_f32_32x32x16_bf16 v[68:83], v[88:91], v[128:131], v[68:83]
    ds_read_b128 v[88:91], v159 offset:33792
    ds_read_b128 v[112:115], v155 offset:41984
    ds_read_b128 v[116:119], v155 offset:46080
    ds_read_b128 v[120:123], v155 offset:50176
    ds_read_b128 v[124:127], v155 offset:54272
    ds_read_b128 v[128:131], v155 offset:58368
    s_waitcnt lgkmcnt(6)
    v_mfma_f32_32x32x16_bf16 v[4:19], v[84:87], v[92:95], v[4:19]
    v_mfma_f32_32x32x16_bf16 v[20:35], v[84:87], v[96:99], v[20:35]
    v_mfma_f32_32x32x16_bf16 v[36:51], v[84:87], v[100:103], v[36:51]
    v_mfma_f32_32x32x16_bf16 v[52:67], v[84:87], v[104:107], v[52:67]
    v_mfma_f32_32x32x16_bf16 v[68:83], v[84:87], v[108:111], v[68:83]
    s_waitcnt vmcnt(0) lgkmcnt(0)
    s_barrier
    ds_read_b128 v[84:87], v144 offset:1024
    ds_read_b128 v[92:95], v148 offset:9216
    ds_read_b128 v[96:99], v148 offset:13312
    ds_read_b128 v[100:103], v148 offset:17408
    ds_read_b128 v[104:107], v148 offset:21504
    ds_read_b128 v[108:111], v148 offset:25600
    v_mfma_f32_32x32x16_bf16 v[4:19], v[88:91], v[112:115], v[4:19]
    v_mfma_f32_32x32x16_bf16 v[20:35], v[88:91], v[116:119], v[20:35]
    v_mfma_f32_32x32x16_bf16 v[36:51], v[88:91], v[120:123], v[36:51]
    v_mfma_f32_32x32x16_bf16 v[52:67], v[88:91], v[124:127], v[52:67]
    v_mfma_f32_32x32x16_bf16 v[68:83], v[88:91], v[128:131], v[68:83]
    ds_read_b128 v[88:91], v145 offset:1024
    ds_read_b128 v[112:115], v149 offset:9216
    ds_read_b128 v[116:119], v149 offset:13312
    ds_read_b128 v[120:123], v149 offset:17408
    ds_read_b128 v[124:127], v149 offset:21504
    ds_read_b128 v[128:131], v149 offset:25600
    s_waitcnt lgkmcnt(6)
    v_mfma_f32_32x32x16_bf16 v[4:19], v[84:87], v[92:95], v[4:19]
    v_mfma_f32_32x32x16_bf16 v[20:35], v[84:87], v[96:99], v[20:35]
    v_mfma_f32_32x32x16_bf16 v[36:51], v[84:87], v[100:103], v[36:51]
    v_mfma_f32_32x32x16_bf16 v[52:67], v[84:87], v[104:107], v[52:67]
    v_mfma_f32_32x32x16_bf16 v[68:83], v[84:87], v[108:111], v[68:83]
    ds_read_b128 v[84:87], v146 offset:1024
    ds_read_b128 v[92:95], v150 offset:9216
    ds_read_b128 v[96:99], v150 offset:13312
    ds_read_b128 v[100:103], v150 offset:17408
    ds_read_b128 v[104:107], v150 offset:21504
    ds_read_b128 v[108:111], v150 offset:25600
    s_waitcnt lgkmcnt(6)
    v_mfma_f32_32x32x16_bf16 v[4:19], v[88:91], v[112:115], v[4:19]
    v_mfma_f32_32x32x16_bf16 v[20:35], v[88:91], v[116:119], v[20:35]
    v_mfma_f32_32x32x16_bf16 v[36:51], v[88:91], v[120:123], v[36:51]
    v_mfma_f32_32x32x16_bf16 v[52:67], v[88:91], v[124:127], v[52:67]
    v_mfma_f32_32x32x16_bf16 v[68:83], v[88:91], v[128:131], v[68:83]
    ds_read_b128 v[88:91], v147 offset:1024
    ds_read_b128 v[112:115], v151 offset:9216
    ds_read_b128 v[116:119], v151 offset:13312
    ds_read_b128 v[120:123], v151 offset:17408
    ds_read_b128 v[124:127], v151 offset:21504
    ds_read_b128 v[128:131], v151 offset:25600
    s_waitcnt lgkmcnt(6)
    v_mfma_f32_32x32x16_bf16 v[4:19], v[84:87], v[92:95], v[4:19]
    v_mfma_f32_32x32x16_bf16 v[20:35], v[84:87], v[96:99], v[20:35]
    v_mfma_f32_32x32x16_bf16 v[36:51], v[84:87], v[100:103], v[36:51]
    v_mfma_f32_32x32x16_bf16 v[52:67], v[84:87], v[104:107], v[52:67]
    v_mfma_f32_32x32x16_bf16 v[68:83], v[84:87], v[108:111], v[68:83]
    s_waitcnt lgkmcnt(0)
    v_mfma_f32_32x32x16_bf16 v[4:19], v[88:91], v[112:115], v[4:19]
    v_mfma_f32_32x32x16_bf16 v[20:35], v[88:91], v[116:119], v[20:35]
    v_mfma_f32_32x32x16_bf16 v[36:51], v[88:91], v[120:123], v[36:51]
    v_mfma_f32_32x32x16_bf16 v[52:67], v[88:91], v[124:127], v[52:67]
    v_mfma_f32_32x32x16_bf16 v[68:83], v[88:91], v[128:131], v[68:83]
    s_nop 7
    s_nop 7
    s_waitcnt vmcnt(0)
    v_lshrrev_b32 v168, 5, v160
    v_lshlrev_b32 v168, 5, v168
    s_lshl_b32 s65, s67, 8
    v_add_u32 v168, s65, v168
    ds_read_b128 v[172:175], v168 offset:0
    ds_read_b128 v[176:179], v168 offset:16
    ds_read_b128 v[180:183], v168 offset:64
    ds_read_b128 v[184:187], v168 offset:80
    ds_read_b128 v[188:191], v168 offset:128
    ds_read_b128 v[192:195], v168 offset:144
    ds_read_b128 v[196:199], v168 offset:192
    ds_read_b128 v[200:203], v168 offset:208
    s_waitcnt lgkmcnt(0)
    s_barrier
    v_lshlrev_b32 v228, 4, v160
    s_mul_i32 s87, s60, 10240
    v_add_u32 v228, s87, v228
    s_cmp_ge_u32 s68, 1
    s_cbranch_scc1 .kv_v_12
    v_mov_b32 v212, 0
    v_fma_f32 v4, -v172, v163, v4
    v_mul_f32 v4, v4, v173
    v_fma_f32 v5, -v174, v163, v5
    v_mul_f32 v5, v5, v175
    v_fma_f32 v6, -v176, v163, v6
    v_mul_f32 v6, v6, v177
    v_fma_f32 v7, -v178, v163, v7
    v_mul_f32 v7, v7, v179
    v_cvt_pk_bf16_f32 v204, v4, v5
    v_lshlrev_b32 v4, 16, v204
    v_and_b32 v5, 0xffff0000, v204
    v_cvt_pk_bf16_f32 v205, v6, v7
    v_lshlrev_b32 v6, 16, v205
    v_and_b32 v7, 0xffff0000, v205
    v_mul_f32 v208, 0x3fb8aa3b, v4
    v_exp_f32 v208, v208
    v_cmp_lt_f32 vcc, 0, v4
    v_add_f32 v4, 1.0, v4
    v_cndmask_b32 v4, v208, v4, vcc
    v_mul_f32 v209, 0x3fb8aa3b, v5
    v_exp_f32 v209, v209
    v_cmp_lt_f32 vcc, 0, v5
    v_add_f32 v5, 1.0, v5
    v_cndmask_b32 v5, v209, v5, vcc
    v_mul_f32 v210, 0x3fb8aa3b, v6
    v_exp_f32 v210, v210
    v_cmp_lt_f32 vcc, 0, v6
    v_add_f32 v6, 1.0, v6
    v_cndmask_b32 v6, v210, v6, vcc
    v_mul_f32 v211, 0x3fb8aa3b, v7
    v_exp_f32 v211, v211
    v_cmp_lt_f32 vcc, 0, v7
    v_add_f32 v7, 1.0, v7
    v_cndmask_b32 v7, v211, v7, vcc
    v_cvt_pk_bf16_f32 v204, v4, v5
    v_lshlrev_b32 v4, 16, v204
    v_and_b32 v5, 0xffff0000, v204
    v_cvt_pk_bf16_f32 v205, v6, v7
    v_lshlrev_b32 v6, 16, v205
    v_and_b32 v7, 0xffff0000, v205
    v_add_f32 v4, 0x358637bd, v4
    v_add_f32 v5, 0x358637bd, v5
    v_add_f32 v6, 0x358637bd, v6
    v_add_f32 v7, 0x358637bd, v7
    v_cvt_pk_bf16_f32 v204, v4, v5
    v_lshlrev_b32 v4, 16, v204
    v_and_b32 v5, 0xffff0000, v204
    v_cvt_pk_bf16_f32 v205, v6, v7
    v_lshlrev_b32 v6, 16, v205
    v_and_b32 v7, 0xffff0000, v205
    v_add_f32 v212, v212, v4
    v_add_f32 v212, v212, v5
    v_add_f32 v212, v212, v6
    v_add_f32 v212, v212, v7
    v_cvt_pk_bf16_f32 v220, v4, v5
    v_cvt_pk_bf16_f32 v221, v6, v7
    v_fma_f32 v8, -v180, v163, v8
    v_mul_f32 v8, v8, v181
    v_fma_f32 v9, -v182, v163, v9
    v_mul_f32 v9, v9, v183
    v_fma_f32 v10, -v184, v163, v10
    v_mul_f32 v10, v10, v185
    v_fma_f32 v11, -v186, v163, v11
    v_mul_f32 v11, v11, v187
    v_cvt_pk_bf16_f32 v204, v8, v9
    v_lshlrev_b32 v8, 16, v204
    v_and_b32 v9, 0xffff0000, v204
    v_cvt_pk_bf16_f32 v205, v10, v11
    v_lshlrev_b32 v10, 16, v205
    v_and_b32 v11, 0xffff0000, v205
    v_mul_f32 v208, 0x3fb8aa3b, v8
    v_exp_f32 v208, v208
    v_cmp_lt_f32 vcc, 0, v8
    v_add_f32 v8, 1.0, v8
    v_cndmask_b32 v8, v208, v8, vcc
    v_mul_f32 v209, 0x3fb8aa3b, v9
    v_exp_f32 v209, v209
    v_cmp_lt_f32 vcc, 0, v9
    v_add_f32 v9, 1.0, v9
    v_cndmask_b32 v9, v209, v9, vcc
    v_mul_f32 v210, 0x3fb8aa3b, v10
    v_exp_f32 v210, v210
    v_cmp_lt_f32 vcc, 0, v10
    v_add_f32 v10, 1.0, v10
    v_cndmask_b32 v10, v210, v10, vcc
    v_mul_f32 v211, 0x3fb8aa3b, v11
    v_exp_f32 v211, v211
    v_cmp_lt_f32 vcc, 0, v11
    v_add_f32 v11, 1.0, v11
    v_cndmask_b32 v11, v211, v11, vcc
    v_cvt_pk_bf16_f32 v204, v8, v9
    v_lshlrev_b32 v8, 16, v204
    v_and_b32 v9, 0xffff0000, v204
    v_cvt_pk_bf16_f32 v205, v10, v11
    v_lshlrev_b32 v10, 16, v205
    v_and_b32 v11, 0xffff0000, v205
    v_add_f32 v8, 0x358637bd, v8
    v_add_f32 v9, 0x358637bd, v9
    v_add_f32 v10, 0x358637bd, v10
    v_add_f32 v11, 0x358637bd, v11
    v_cvt_pk_bf16_f32 v204, v8, v9
    v_lshlrev_b32 v8, 16, v204
    v_and_b32 v9, 0xffff0000, v204
    v_cvt_pk_bf16_f32 v205, v10, v11
    v_lshlrev_b32 v10, 16, v205
    v_and_b32 v11, 0xffff0000, v205
    v_add_f32 v212, v212, v8
    v_add_f32 v212, v212, v9
    v_add_f32 v212, v212, v10
    v_add_f32 v212, v212, v11
    v_cvt_pk_bf16_f32 v222, v8, v9
    v_cvt_pk_bf16_f32 v223, v10, v11
    v_fma_f32 v12, -v188, v163, v12
    v_mul_f32 v12, v12, v189
    v_fma_f32 v13, -v190, v163, v13
    v_mul_f32 v13, v13, v191
    v_fma_f32 v14, -v192, v163, v14
    v_mul_f32 v14, v14, v193
    v_fma_f32 v15, -v194, v163, v15
    v_mul_f32 v15, v15, v195
    v_cvt_pk_bf16_f32 v204, v12, v13
    v_lshlrev_b32 v12, 16, v204
    v_and_b32 v13, 0xffff0000, v204
    v_cvt_pk_bf16_f32 v205, v14, v15
    v_lshlrev_b32 v14, 16, v205
    v_and_b32 v15, 0xffff0000, v205
    v_mul_f32 v208, 0x3fb8aa3b, v12
    v_exp_f32 v208, v208
    v_cmp_lt_f32 vcc, 0, v12
    v_add_f32 v12, 1.0, v12
    v_cndmask_b32 v12, v208, v12, vcc
    v_mul_f32 v209, 0x3fb8aa3b, v13
    v_exp_f32 v209, v209
    v_cmp_lt_f32 vcc, 0, v13
    v_add_f32 v13, 1.0, v13
    v_cndmask_b32 v13, v209, v13, vcc
    v_mul_f32 v210, 0x3fb8aa3b, v14
    v_exp_f32 v210, v210
    v_cmp_lt_f32 vcc, 0, v14
    v_add_f32 v14, 1.0, v14
    v_cndmask_b32 v14, v210, v14, vcc
    v_mul_f32 v211, 0x3fb8aa3b, v15
    v_exp_f32 v211, v211
    v_cmp_lt_f32 vcc, 0, v15
    v_add_f32 v15, 1.0, v15
    v_cndmask_b32 v15, v211, v15, vcc
    v_cvt_pk_bf16_f32 v204, v12, v13
    v_lshlrev_b32 v12, 16, v204
    v_and_b32 v13, 0xffff0000, v204
    v_cvt_pk_bf16_f32 v205, v14, v15
    v_lshlrev_b32 v14, 16, v205
    v_and_b32 v15, 0xffff0000, v205
    v_add_f32 v12, 0x358637bd, v12
    v_add_f32 v13, 0x358637bd, v13
    v_add_f32 v14, 0x358637bd, v14
    v_add_f32 v15, 0x358637bd, v15
    v_cvt_pk_bf16_f32 v204, v12, v13
    v_lshlrev_b32 v12, 16, v204
    v_and_b32 v13, 0xffff0000, v204
    v_cvt_pk_bf16_f32 v205, v14, v15
    v_lshlrev_b32 v14, 16, v205
    v_and_b32 v15, 0xffff0000, v205
    v_add_f32 v212, v212, v12
    v_add_f32 v212, v212, v13
    v_add_f32 v212, v212, v14
    v_add_f32 v212, v212, v15
    v_cvt_pk_bf16_f32 v224, v12, v13
    v_cvt_pk_bf16_f32 v225, v14, v15
    v_fma_f32 v16, -v196, v163, v16
    v_mul_f32 v16, v16, v197
    v_fma_f32 v17, -v198, v163, v17
    v_mul_f32 v17, v17, v199
    v_fma_f32 v18, -v200, v163, v18
    v_mul_f32 v18, v18, v201
    v_fma_f32 v19, -v202, v163, v19
    v_mul_f32 v19, v19, v203
    v_cvt_pk_bf16_f32 v204, v16, v17
    v_lshlrev_b32 v16, 16, v204
    v_and_b32 v17, 0xffff0000, v204
    v_cvt_pk_bf16_f32 v205, v18, v19
    v_lshlrev_b32 v18, 16, v205
    v_and_b32 v19, 0xffff0000, v205
    v_mul_f32 v208, 0x3fb8aa3b, v16
    v_exp_f32 v208, v208
    v_cmp_lt_f32 vcc, 0, v16
    v_add_f32 v16, 1.0, v16
    v_cndmask_b32 v16, v208, v16, vcc
    v_mul_f32 v209, 0x3fb8aa3b, v17
    v_exp_f32 v209, v209
    v_cmp_lt_f32 vcc, 0, v17
    v_add_f32 v17, 1.0, v17
    v_cndmask_b32 v17, v209, v17, vcc
    v_mul_f32 v210, 0x3fb8aa3b, v18
    v_exp_f32 v210, v210
    v_cmp_lt_f32 vcc, 0, v18
    v_add_f32 v18, 1.0, v18
    v_cndmask_b32 v18, v210, v18, vcc
    v_mul_f32 v211, 0x3fb8aa3b, v19
    v_exp_f32 v211, v211
    v_cmp_lt_f32 vcc, 0, v19
    v_add_f32 v19, 1.0, v19
    v_cndmask_b32 v19, v211, v19, vcc
    v_cvt_pk_bf16_f32 v204, v16, v17
    v_lshlrev_b32 v16, 16, v204
    v_and_b32 v17, 0xffff0000, v204
    v_cvt_pk_bf16_f32 v205, v18, v19
    v_lshlrev_b32 v18, 16, v205
    v_and_b32 v19, 0xffff0000, v205
    v_add_f32 v16, 0x358637bd, v16
    v_add_f32 v17, 0x358637bd, v17
    v_add_f32 v18, 0x358637bd, v18
    v_add_f32 v19, 0x358637bd, v19
    v_cvt_pk_bf16_f32 v204, v16, v17
    v_lshlrev_b32 v16, 16, v204
    v_and_b32 v17, 0xffff0000, v204
    v_cvt_pk_bf16_f32 v205, v18, v19
    v_lshlrev_b32 v18, 16, v205
    v_and_b32 v19, 0xffff0000, v205
    v_add_f32 v212, v212, v16
    v_add_f32 v212, v212, v17
    v_add_f32 v212, v212, v18
    v_add_f32 v212, v212, v19
    v_cvt_pk_bf16_f32 v226, v16, v17
    v_cvt_pk_bf16_f32 v227, v18, v19
    ds_write_b128 v228, v[220:223] offset:1024
    ds_write_b128 v228, v[224:227] offset:2048
    v_mov_b32 v213, v212
    s_nop 1
    v_permlane32_swap_b32 v212, v213
    s_nop 1
    v_add_f32 v212, v212, v213
    v_lshlrev_b32 v213, 2, v160
    s_mul_i32 s65, s84, 640
    s_add_u32 s65, s65, 163840
    v_cmp_gt_u32 vcc, 32, v160
    s_and_saveexec_b64 s[76:77], vcc
    buffer_atomic_add_f32 v212, v213, s[52:55], s65 offen
    s_or_b64 exec, exec, s[76:77]
    s_nop 1
    v_mov_b32 v212, 0
    v_fma_f32 v20, -v172, v164, v20
    v_mul_f32 v20, v20, v173
    v_fma_f32 v21, -v174, v164, v21
    v_mul_f32 v21, v21, v175
    v_fma_f32 v22, -v176, v164, v22
    v_mul_f32 v22, v22, v177
    v_fma_f32 v23, -v178, v164, v23
    v_mul_f32 v23, v23, v179
    v_cvt_pk_bf16_f32 v204, v20, v21
    v_lshlrev_b32 v20, 16, v204
    v_and_b32 v21, 0xffff0000, v204
    v_cvt_pk_bf16_f32 v205, v22, v23
    v_lshlrev_b32 v22, 16, v205
    v_and_b32 v23, 0xffff0000, v205
    v_mul_f32 v208, 0x3fb8aa3b, v20
    v_exp_f32 v208, v208
    v_cmp_lt_f32 vcc, 0, v20
    v_add_f32 v20, 1.0, v20
    v_cndmask_b32 v20, v208, v20, vcc
    v_mul_f32 v209, 0x3fb8aa3b, v21
    v_exp_f32 v209, v209
    v_cmp_lt_f32 vcc, 0, v21
    v_add_f32 v21, 1.0, v21
    v_cndmask_b32 v21, v209, v21, vcc
    v_mul_f32 v210, 0x3fb8aa3b, v22
    v_exp_f32 v210, v210
    v_cmp_lt_f32 vcc, 0, v22
    v_add_f32 v22, 1.0, v22
    v_cndmask_b32 v22, v210, v22, vcc
    v_mul_f32 v211, 0x3fb8aa3b, v23
    v_exp_f32 v211, v211
    v_cmp_lt_f32 vcc, 0, v23
    v_add_f32 v23, 1.0, v23
    v_cndmask_b32 v23, v211, v23, vcc
    v_cvt_pk_bf16_f32 v204, v20, v21
    v_lshlrev_b32 v20, 16, v204
    v_and_b32 v21, 0xffff0000, v204
    v_cvt_pk_bf16_f32 v205, v22, v23
    v_lshlrev_b32 v22, 16, v205
    v_and_b32 v23, 0xffff0000, v205
    v_add_f32 v20, 0x358637bd, v20
    v_add_f32 v21, 0x358637bd, v21
    v_add_f32 v22, 0x358637bd, v22
    v_add_f32 v23, 0x358637bd, v23
    v_cvt_pk_bf16_f32 v204, v20, v21
    v_lshlrev_b32 v20, 16, v204
    v_and_b32 v21, 0xffff0000, v204
    v_cvt_pk_bf16_f32 v205, v22, v23
    v_lshlrev_b32 v22, 16, v205
    v_and_b32 v23, 0xffff0000, v205
    v_add_f32 v212, v212, v20
    v_add_f32 v212, v212, v21
    v_add_f32 v212, v212, v22
    v_add_f32 v212, v212, v23
    v_cvt_pk_bf16_f32 v220, v20, v21
    v_cvt_pk_bf16_f32 v221, v22, v23
    v_fma_f32 v24, -v180, v164, v24
    v_mul_f32 v24, v24, v181
    v_fma_f32 v25, -v182, v164, v25
    v_mul_f32 v25, v25, v183
    v_fma_f32 v26, -v184, v164, v26
    v_mul_f32 v26, v26, v185
    v_fma_f32 v27, -v186, v164, v27
    v_mul_f32 v27, v27, v187
    v_cvt_pk_bf16_f32 v204, v24, v25
    v_lshlrev_b32 v24, 16, v204
    v_and_b32 v25, 0xffff0000, v204
    v_cvt_pk_bf16_f32 v205, v26, v27
    v_lshlrev_b32 v26, 16, v205
    v_and_b32 v27, 0xffff0000, v205
    v_mul_f32 v208, 0x3fb8aa3b, v24
    v_exp_f32 v208, v208
    v_cmp_lt_f32 vcc, 0, v24
    v_add_f32 v24, 1.0, v24
    v_cndmask_b32 v24, v208, v24, vcc
    v_mul_f32 v209, 0x3fb8aa3b, v25
    v_exp_f32 v209, v209
    v_cmp_lt_f32 vcc, 0, v25
    v_add_f32 v25, 1.0, v25
    v_cndmask_b32 v25, v209, v25, vcc
    v_mul_f32 v210, 0x3fb8aa3b, v26
    v_exp_f32 v210, v210
    v_cmp_lt_f32 vcc, 0, v26
    v_add_f32 v26, 1.0, v26
    v_cndmask_b32 v26, v210, v26, vcc
    v_mul_f32 v211, 0x3fb8aa3b, v27
    v_exp_f32 v211, v211
    v_cmp_lt_f32 vcc, 0, v27
    v_add_f32 v27, 1.0, v27
    v_cndmask_b32 v27, v211, v27, vcc
    v_cvt_pk_bf16_f32 v204, v24, v25
    v_lshlrev_b32 v24, 16, v204
    v_and_b32 v25, 0xffff0000, v204
    v_cvt_pk_bf16_f32 v205, v26, v27
    v_lshlrev_b32 v26, 16, v205
    v_and_b32 v27, 0xffff0000, v205
    v_add_f32 v24, 0x358637bd, v24
    v_add_f32 v25, 0x358637bd, v25
    v_add_f32 v26, 0x358637bd, v26
    v_add_f32 v27, 0x358637bd, v27
    v_cvt_pk_bf16_f32 v204, v24, v25
    v_lshlrev_b32 v24, 16, v204
    v_and_b32 v25, 0xffff0000, v204
    v_cvt_pk_bf16_f32 v205, v26, v27
    v_lshlrev_b32 v26, 16, v205
    v_and_b32 v27, 0xffff0000, v205
    v_add_f32 v212, v212, v24
    v_add_f32 v212, v212, v25
    v_add_f32 v212, v212, v26
    v_add_f32 v212, v212, v27
    v_cvt_pk_bf16_f32 v222, v24, v25
    v_cvt_pk_bf16_f32 v223, v26, v27
    v_fma_f32 v28, -v188, v164, v28
    v_mul_f32 v28, v28, v189
    v_fma_f32 v29, -v190, v164, v29
    v_mul_f32 v29, v29, v191
    v_fma_f32 v30, -v192, v164, v30
    v_mul_f32 v30, v30, v193
    v_fma_f32 v31, -v194, v164, v31
    v_mul_f32 v31, v31, v195
    v_cvt_pk_bf16_f32 v204, v28, v29
    v_lshlrev_b32 v28, 16, v204
    v_and_b32 v29, 0xffff0000, v204
    v_cvt_pk_bf16_f32 v205, v30, v31
    v_lshlrev_b32 v30, 16, v205
    v_and_b32 v31, 0xffff0000, v205
    v_mul_f32 v208, 0x3fb8aa3b, v28
    v_exp_f32 v208, v208
    v_cmp_lt_f32 vcc, 0, v28
    v_add_f32 v28, 1.0, v28
    v_cndmask_b32 v28, v208, v28, vcc
    v_mul_f32 v209, 0x3fb8aa3b, v29
    v_exp_f32 v209, v209
    v_cmp_lt_f32 vcc, 0, v29
    v_add_f32 v29, 1.0, v29
    v_cndmask_b32 v29, v209, v29, vcc
    v_mul_f32 v210, 0x3fb8aa3b, v30
    v_exp_f32 v210, v210
    v_cmp_lt_f32 vcc, 0, v30
    v_add_f32 v30, 1.0, v30
    v_cndmask_b32 v30, v210, v30, vcc
    v_mul_f32 v211, 0x3fb8aa3b, v31
    v_exp_f32 v211, v211
    v_cmp_lt_f32 vcc, 0, v31
    v_add_f32 v31, 1.0, v31
    v_cndmask_b32 v31, v211, v31, vcc
    v_cvt_pk_bf16_f32 v204, v28, v29
    v_lshlrev_b32 v28, 16, v204
    v_and_b32 v29, 0xffff0000, v204
    v_cvt_pk_bf16_f32 v205, v30, v31
    v_lshlrev_b32 v30, 16, v205
    v_and_b32 v31, 0xffff0000, v205
    v_add_f32 v28, 0x358637bd, v28
    v_add_f32 v29, 0x358637bd, v29
    v_add_f32 v30, 0x358637bd, v30
    v_add_f32 v31, 0x358637bd, v31
    v_cvt_pk_bf16_f32 v204, v28, v29
    v_lshlrev_b32 v28, 16, v204
    v_and_b32 v29, 0xffff0000, v204
    v_cvt_pk_bf16_f32 v205, v30, v31
    v_lshlrev_b32 v30, 16, v205
    v_and_b32 v31, 0xffff0000, v205
    v_add_f32 v212, v212, v28
    v_add_f32 v212, v212, v29
    v_add_f32 v212, v212, v30
    v_add_f32 v212, v212, v31
    v_cvt_pk_bf16_f32 v224, v28, v29
    v_cvt_pk_bf16_f32 v225, v30, v31
    v_fma_f32 v32, -v196, v164, v32
    v_mul_f32 v32, v32, v197
    v_fma_f32 v33, -v198, v164, v33
    v_mul_f32 v33, v33, v199
    v_fma_f32 v34, -v200, v164, v34
    v_mul_f32 v34, v34, v201
    v_fma_f32 v35, -v202, v164, v35
    v_mul_f32 v35, v35, v203
    v_cvt_pk_bf16_f32 v204, v32, v33
    v_lshlrev_b32 v32, 16, v204
    v_and_b32 v33, 0xffff0000, v204
    v_cvt_pk_bf16_f32 v205, v34, v35
    v_lshlrev_b32 v34, 16, v205
    v_and_b32 v35, 0xffff0000, v205
    v_mul_f32 v208, 0x3fb8aa3b, v32
    v_exp_f32 v208, v208
    v_cmp_lt_f32 vcc, 0, v32
    v_add_f32 v32, 1.0, v32
    v_cndmask_b32 v32, v208, v32, vcc
    v_mul_f32 v209, 0x3fb8aa3b, v33
    v_exp_f32 v209, v209
    v_cmp_lt_f32 vcc, 0, v33
    v_add_f32 v33, 1.0, v33
    v_cndmask_b32 v33, v209, v33, vcc
    v_mul_f32 v210, 0x3fb8aa3b, v34
    v_exp_f32 v210, v210
    v_cmp_lt_f32 vcc, 0, v34
    v_add_f32 v34, 1.0, v34
    v_cndmask_b32 v34, v210, v34, vcc
    v_mul_f32 v211, 0x3fb8aa3b, v35
    v_exp_f32 v211, v211
    v_cmp_lt_f32 vcc, 0, v35
    v_add_f32 v35, 1.0, v35
    v_cndmask_b32 v35, v211, v35, vcc
    v_cvt_pk_bf16_f32 v204, v32, v33
    v_lshlrev_b32 v32, 16, v204
    v_and_b32 v33, 0xffff0000, v204
    v_cvt_pk_bf16_f32 v205, v34, v35
    v_lshlrev_b32 v34, 16, v205
    v_and_b32 v35, 0xffff0000, v205
    v_add_f32 v32, 0x358637bd, v32
    v_add_f32 v33, 0x358637bd, v33
    v_add_f32 v34, 0x358637bd, v34
    v_add_f32 v35, 0x358637bd, v35
    v_cvt_pk_bf16_f32 v204, v32, v33
    v_lshlrev_b32 v32, 16, v204
    v_and_b32 v33, 0xffff0000, v204
    v_cvt_pk_bf16_f32 v205, v34, v35
    v_lshlrev_b32 v34, 16, v205
    v_and_b32 v35, 0xffff0000, v205
    v_add_f32 v212, v212, v32
    v_add_f32 v212, v212, v33
    v_add_f32 v212, v212, v34
    v_add_f32 v212, v212, v35
    v_cvt_pk_bf16_f32 v226, v32, v33
    v_cvt_pk_bf16_f32 v227, v34, v35
    ds_write_b128 v228, v[220:223] offset:3072
    ds_write_b128 v228, v[224:227] offset:4096
    v_mov_b32 v213, v212
    s_nop 1
    v_permlane32_swap_b32 v212, v213
    s_nop 1
    v_add_f32 v212, v212, v213
    v_lshlrev_b32 v213, 2, v160
    s_mul_i32 s65, s84, 640
    s_add_u32 s65, s65, 163968
    v_cmp_gt_u32 vcc, 32, v160
    s_and_saveexec_b64 s[76:77], vcc
    buffer_atomic_add_f32 v212, v213, s[52:55], s65 offen
    s_or_b64 exec, exec, s[76:77]
    s_nop 1
    v_mov_b32 v212, 0
    v_fma_f32 v36, -v172, v165, v36
    v_mul_f32 v36, v36, v173
    v_fma_f32 v37, -v174, v165, v37
    v_mul_f32 v37, v37, v175
    v_fma_f32 v38, -v176, v165, v38
    v_mul_f32 v38, v38, v177
    v_fma_f32 v39, -v178, v165, v39
    v_mul_f32 v39, v39, v179
    v_cvt_pk_bf16_f32 v204, v36, v37
    v_lshlrev_b32 v36, 16, v204
    v_and_b32 v37, 0xffff0000, v204
    v_cvt_pk_bf16_f32 v205, v38, v39
    v_lshlrev_b32 v38, 16, v205
    v_and_b32 v39, 0xffff0000, v205
    v_mul_f32 v208, 0x3fb8aa3b, v36
    v_exp_f32 v208, v208
    v_cmp_lt_f32 vcc, 0, v36
    v_add_f32 v36, 1.0, v36
    v_cndmask_b32 v36, v208, v36, vcc
    v_mul_f32 v209, 0x3fb8aa3b, v37
    v_exp_f32 v209, v209
    v_cmp_lt_f32 vcc, 0, v37
    v_add_f32 v37, 1.0, v37
    v_cndmask_b32 v37, v209, v37, vcc
    v_mul_f32 v210, 0x3fb8aa3b, v38
    v_exp_f32 v210, v210
    v_cmp_lt_f32 vcc, 0, v38
    v_add_f32 v38, 1.0, v38
    v_cndmask_b32 v38, v210, v38, vcc
    v_mul_f32 v211, 0x3fb8aa3b, v39
    v_exp_f32 v211, v211
    v_cmp_lt_f32 vcc, 0, v39
    v_add_f32 v39, 1.0, v39
    v_cndmask_b32 v39, v211, v39, vcc
    v_cvt_pk_bf16_f32 v204, v36, v37
    v_lshlrev_b32 v36, 16, v204
    v_and_b32 v37, 0xffff0000, v204
    v_cvt_pk_bf16_f32 v205, v38, v39
    v_lshlrev_b32 v38, 16, v205
    v_and_b32 v39, 0xffff0000, v205
    v_add_f32 v36, 0x358637bd, v36
    v_add_f32 v37, 0x358637bd, v37
    v_add_f32 v38, 0x358637bd, v38
    v_add_f32 v39, 0x358637bd, v39
    v_cvt_pk_bf16_f32 v204, v36, v37
    v_lshlrev_b32 v36, 16, v204
    v_and_b32 v37, 0xffff0000, v204
    v_cvt_pk_bf16_f32 v205, v38, v39
    v_lshlrev_b32 v38, 16, v205
    v_and_b32 v39, 0xffff0000, v205
    v_add_f32 v212, v212, v36
    v_add_f32 v212, v212, v37
    v_add_f32 v212, v212, v38
    v_add_f32 v212, v212, v39
    v_cvt_pk_bf16_f32 v220, v36, v37
    v_cvt_pk_bf16_f32 v221, v38, v39
    v_fma_f32 v40, -v180, v165, v40
    v_mul_f32 v40, v40, v181
    v_fma_f32 v41, -v182, v165, v41
    v_mul_f32 v41, v41, v183
    v_fma_f32 v42, -v184, v165, v42
    v_mul_f32 v42, v42, v185
    v_fma_f32 v43, -v186, v165, v43
    v_mul_f32 v43, v43, v187
    v_cvt_pk_bf16_f32 v204, v40, v41
    v_lshlrev_b32 v40, 16, v204
    v_and_b32 v41, 0xffff0000, v204
    v_cvt_pk_bf16_f32 v205, v42, v43
    v_lshlrev_b32 v42, 16, v205
    v_and_b32 v43, 0xffff0000, v205
    v_mul_f32 v208, 0x3fb8aa3b, v40
    v_exp_f32 v208, v208
    v_cmp_lt_f32 vcc, 0, v40
    v_add_f32 v40, 1.0, v40
    v_cndmask_b32 v40, v208, v40, vcc
    v_mul_f32 v209, 0x3fb8aa3b, v41
    v_exp_f32 v209, v209
    v_cmp_lt_f32 vcc, 0, v41
    v_add_f32 v41, 1.0, v41
    v_cndmask_b32 v41, v209, v41, vcc
    v_mul_f32 v210, 0x3fb8aa3b, v42
    v_exp_f32 v210, v210
    v_cmp_lt_f32 vcc, 0, v42
    v_add_f32 v42, 1.0, v42
    v_cndmask_b32 v42, v210, v42, vcc
    v_mul_f32 v211, 0x3fb8aa3b, v43
    v_exp_f32 v211, v211
    v_cmp_lt_f32 vcc, 0, v43
    v_add_f32 v43, 1.0, v43
    v_cndmask_b32 v43, v211, v43, vcc
    v_cvt_pk_bf16_f32 v204, v40, v41
    v_lshlrev_b32 v40, 16, v204
    v_and_b32 v41, 0xffff0000, v204
    v_cvt_pk_bf16_f32 v205, v42, v43
    v_lshlrev_b32 v42, 16, v205
    v_and_b32 v43, 0xffff0000, v205
    v_add_f32 v40, 0x358637bd, v40
    v_add_f32 v41, 0x358637bd, v41
    v_add_f32 v42, 0x358637bd, v42
    v_add_f32 v43, 0x358637bd, v43
    v_cvt_pk_bf16_f32 v204, v40, v41
    v_lshlrev_b32 v40, 16, v204
    v_and_b32 v41, 0xffff0000, v204
    v_cvt_pk_bf16_f32 v205, v42, v43
    v_lshlrev_b32 v42, 16, v205
    v_and_b32 v43, 0xffff0000, v205
    v_add_f32 v212, v212, v40
    v_add_f32 v212, v212, v41
    v_add_f32 v212, v212, v42
    v_add_f32 v212, v212, v43
    v_cvt_pk_bf16_f32 v222, v40, v41
    v_cvt_pk_bf16_f32 v223, v42, v43
    v_fma_f32 v44, -v188, v165, v44
    v_mul_f32 v44, v44, v189
    v_fma_f32 v45, -v190, v165, v45
    v_mul_f32 v45, v45, v191
    v_fma_f32 v46, -v192, v165, v46
    v_mul_f32 v46, v46, v193
    v_fma_f32 v47, -v194, v165, v47
    v_mul_f32 v47, v47, v195
    v_cvt_pk_bf16_f32 v204, v44, v45
    v_lshlrev_b32 v44, 16, v204
    v_and_b32 v45, 0xffff0000, v204
    v_cvt_pk_bf16_f32 v205, v46, v47
    v_lshlrev_b32 v46, 16, v205
    v_and_b32 v47, 0xffff0000, v205
    v_mul_f32 v208, 0x3fb8aa3b, v44
    v_exp_f32 v208, v208
    v_cmp_lt_f32 vcc, 0, v44
    v_add_f32 v44, 1.0, v44
    v_cndmask_b32 v44, v208, v44, vcc
    v_mul_f32 v209, 0x3fb8aa3b, v45
    v_exp_f32 v209, v209
    v_cmp_lt_f32 vcc, 0, v45
    v_add_f32 v45, 1.0, v45
    v_cndmask_b32 v45, v209, v45, vcc
    v_mul_f32 v210, 0x3fb8aa3b, v46
    v_exp_f32 v210, v210
    v_cmp_lt_f32 vcc, 0, v46
    v_add_f32 v46, 1.0, v46
    v_cndmask_b32 v46, v210, v46, vcc
    v_mul_f32 v211, 0x3fb8aa3b, v47
    v_exp_f32 v211, v211
    v_cmp_lt_f32 vcc, 0, v47
    v_add_f32 v47, 1.0, v47
    v_cndmask_b32 v47, v211, v47, vcc
    v_cvt_pk_bf16_f32 v204, v44, v45
    v_lshlrev_b32 v44, 16, v204
    v_and_b32 v45, 0xffff0000, v204
    v_cvt_pk_bf16_f32 v205, v46, v47
    v_lshlrev_b32 v46, 16, v205
    v_and_b32 v47, 0xffff0000, v205
    v_add_f32 v44, 0x358637bd, v44
    v_add_f32 v45, 0x358637bd, v45
    v_add_f32 v46, 0x358637bd, v46
    v_add_f32 v47, 0x358637bd, v47
    v_cvt_pk_bf16_f32 v204, v44, v45
    v_lshlrev_b32 v44, 16, v204
    v_and_b32 v45, 0xffff0000, v204
    v_cvt_pk_bf16_f32 v205, v46, v47
    v_lshlrev_b32 v46, 16, v205
    v_and_b32 v47, 0xffff0000, v205
    v_add_f32 v212, v212, v44
    v_add_f32 v212, v212, v45
    v_add_f32 v212, v212, v46
    v_add_f32 v212, v212, v47
    v_cvt_pk_bf16_f32 v224, v44, v45
    v_cvt_pk_bf16_f32 v225, v46, v47
    v_fma_f32 v48, -v196, v165, v48
    v_mul_f32 v48, v48, v197
    v_fma_f32 v49, -v198, v165, v49
    v_mul_f32 v49, v49, v199
    v_fma_f32 v50, -v200, v165, v50
    v_mul_f32 v50, v50, v201
    v_fma_f32 v51, -v202, v165, v51
    v_mul_f32 v51, v51, v203
    v_cvt_pk_bf16_f32 v204, v48, v49
    v_lshlrev_b32 v48, 16, v204
    v_and_b32 v49, 0xffff0000, v204
    v_cvt_pk_bf16_f32 v205, v50, v51
    v_lshlrev_b32 v50, 16, v205
    v_and_b32 v51, 0xffff0000, v205
    v_mul_f32 v208, 0x3fb8aa3b, v48
    v_exp_f32 v208, v208
    v_cmp_lt_f32 vcc, 0, v48
    v_add_f32 v48, 1.0, v48
    v_cndmask_b32 v48, v208, v48, vcc
    v_mul_f32 v209, 0x3fb8aa3b, v49
    v_exp_f32 v209, v209
    v_cmp_lt_f32 vcc, 0, v49
    v_add_f32 v49, 1.0, v49
    v_cndmask_b32 v49, v209, v49, vcc
    v_mul_f32 v210, 0x3fb8aa3b, v50
    v_exp_f32 v210, v210
    v_cmp_lt_f32 vcc, 0, v50
    v_add_f32 v50, 1.0, v50
    v_cndmask_b32 v50, v210, v50, vcc
    v_mul_f32 v211, 0x3fb8aa3b, v51
    v_exp_f32 v211, v211
    v_cmp_lt_f32 vcc, 0, v51
    v_add_f32 v51, 1.0, v51
    v_cndmask_b32 v51, v211, v51, vcc
    v_cvt_pk_bf16_f32 v204, v48, v49
    v_lshlrev_b32 v48, 16, v204
    v_and_b32 v49, 0xffff0000, v204
    v_cvt_pk_bf16_f32 v205, v50, v51
    v_lshlrev_b32 v50, 16, v205
    v_and_b32 v51, 0xffff0000, v205
    v_add_f32 v48, 0x358637bd, v48
    v_add_f32 v49, 0x358637bd, v49
    v_add_f32 v50, 0x358637bd, v50
    v_add_f32 v51, 0x358637bd, v51
    v_cvt_pk_bf16_f32 v204, v48, v49
    v_lshlrev_b32 v48, 16, v204
    v_and_b32 v49, 0xffff0000, v204
    v_cvt_pk_bf16_f32 v205, v50, v51
    v_lshlrev_b32 v50, 16, v205
    v_and_b32 v51, 0xffff0000, v205
    v_add_f32 v212, v212, v48
    v_add_f32 v212, v212, v49
    v_add_f32 v212, v212, v50
    v_add_f32 v212, v212, v51
    v_cvt_pk_bf16_f32 v226, v48, v49
    v_cvt_pk_bf16_f32 v227, v50, v51
    ds_write_b128 v228, v[220:223] offset:5120
    ds_write_b128 v228, v[224:227] offset:6144
    v_mov_b32 v213, v212
    s_nop 1
    v_permlane32_swap_b32 v212, v213
    s_nop 1
    v_add_f32 v212, v212, v213
    v_lshlrev_b32 v213, 2, v160
    s_mul_i32 s65, s84, 640
    s_add_u32 s65, s65, 164096
    v_cmp_gt_u32 vcc, 32, v160
    s_and_saveexec_b64 s[76:77], vcc
    buffer_atomic_add_f32 v212, v213, s[52:55], s65 offen
    s_or_b64 exec, exec, s[76:77]
    s_nop 1
    v_mov_b32 v212, 0
    v_fma_f32 v52, -v172, v166, v52
    v_mul_f32 v52, v52, v173
    v_fma_f32 v53, -v174, v166, v53
    v_mul_f32 v53, v53, v175
    v_fma_f32 v54, -v176, v166, v54
    v_mul_f32 v54, v54, v177
    v_fma_f32 v55, -v178, v166, v55
    v_mul_f32 v55, v55, v179
    v_cvt_pk_bf16_f32 v204, v52, v53
    v_lshlrev_b32 v52, 16, v204
    v_and_b32 v53, 0xffff0000, v204
    v_cvt_pk_bf16_f32 v205, v54, v55
    v_lshlrev_b32 v54, 16, v205
    v_and_b32 v55, 0xffff0000, v205
    v_mul_f32 v208, 0x3fb8aa3b, v52
    v_exp_f32 v208, v208
    v_cmp_lt_f32 vcc, 0, v52
    v_add_f32 v52, 1.0, v52
    v_cndmask_b32 v52, v208, v52, vcc
    v_mul_f32 v209, 0x3fb8aa3b, v53
    v_exp_f32 v209, v209
    v_cmp_lt_f32 vcc, 0, v53
    v_add_f32 v53, 1.0, v53
    v_cndmask_b32 v53, v209, v53, vcc
    v_mul_f32 v210, 0x3fb8aa3b, v54
    v_exp_f32 v210, v210
    v_cmp_lt_f32 vcc, 0, v54
    v_add_f32 v54, 1.0, v54
    v_cndmask_b32 v54, v210, v54, vcc
    v_mul_f32 v211, 0x3fb8aa3b, v55
    v_exp_f32 v211, v211
    v_cmp_lt_f32 vcc, 0, v55
    v_add_f32 v55, 1.0, v55
    v_cndmask_b32 v55, v211, v55, vcc
    v_cvt_pk_bf16_f32 v204, v52, v53
    v_lshlrev_b32 v52, 16, v204
    v_and_b32 v53, 0xffff0000, v204
    v_cvt_pk_bf16_f32 v205, v54, v55
    v_lshlrev_b32 v54, 16, v205
    v_and_b32 v55, 0xffff0000, v205
    v_add_f32 v52, 0x358637bd, v52
    v_add_f32 v53, 0x358637bd, v53
    v_add_f32 v54, 0x358637bd, v54
    v_add_f32 v55, 0x358637bd, v55
    v_cvt_pk_bf16_f32 v204, v52, v53
    v_lshlrev_b32 v52, 16, v204
    v_and_b32 v53, 0xffff0000, v204
    v_cvt_pk_bf16_f32 v205, v54, v55
    v_lshlrev_b32 v54, 16, v205
    v_and_b32 v55, 0xffff0000, v205
    v_add_f32 v212, v212, v52
    v_add_f32 v212, v212, v53
    v_add_f32 v212, v212, v54
    v_add_f32 v212, v212, v55
    v_cvt_pk_bf16_f32 v220, v52, v53
    v_cvt_pk_bf16_f32 v221, v54, v55
    v_fma_f32 v56, -v180, v166, v56
    v_mul_f32 v56, v56, v181
    v_fma_f32 v57, -v182, v166, v57
    v_mul_f32 v57, v57, v183
    v_fma_f32 v58, -v184, v166, v58
    v_mul_f32 v58, v58, v185
    v_fma_f32 v59, -v186, v166, v59
    v_mul_f32 v59, v59, v187
    v_cvt_pk_bf16_f32 v204, v56, v57
    v_lshlrev_b32 v56, 16, v204
    v_and_b32 v57, 0xffff0000, v204
    v_cvt_pk_bf16_f32 v205, v58, v59
    v_lshlrev_b32 v58, 16, v205
    v_and_b32 v59, 0xffff0000, v205
    v_mul_f32 v208, 0x3fb8aa3b, v56
    v_exp_f32 v208, v208
    v_cmp_lt_f32 vcc, 0, v56
    v_add_f32 v56, 1.0, v56
    v_cndmask_b32 v56, v208, v56, vcc
    v_mul_f32 v209, 0x3fb8aa3b, v57
    v_exp_f32 v209, v209
    v_cmp_lt_f32 vcc, 0, v57
    v_add_f32 v57, 1.0, v57
    v_cndmask_b32 v57, v209, v57, vcc
    v_mul_f32 v210, 0x3fb8aa3b, v58
    v_exp_f32 v210, v210
    v_cmp_lt_f32 vcc, 0, v58
    v_add_f32 v58, 1.0, v58
    v_cndmask_b32 v58, v210, v58, vcc
    v_mul_f32 v211, 0x3fb8aa3b, v59
    v_exp_f32 v211, v211
    v_cmp_lt_f32 vcc, 0, v59
    v_add_f32 v59, 1.0, v59
    v_cndmask_b32 v59, v211, v59, vcc
    v_cvt_pk_bf16_f32 v204, v56, v57
    v_lshlrev_b32 v56, 16, v204
    v_and_b32 v57, 0xffff0000, v204
    v_cvt_pk_bf16_f32 v205, v58, v59
    v_lshlrev_b32 v58, 16, v205
    v_and_b32 v59, 0xffff0000, v205
    v_add_f32 v56, 0x358637bd, v56
    v_add_f32 v57, 0x358637bd, v57
    v_add_f32 v58, 0x358637bd, v58
    v_add_f32 v59, 0x358637bd, v59
    v_cvt_pk_bf16_f32 v204, v56, v57
    v_lshlrev_b32 v56, 16, v204
    v_and_b32 v57, 0xffff0000, v204
    v_cvt_pk_bf16_f32 v205, v58, v59
    v_lshlrev_b32 v58, 16, v205
    v_and_b32 v59, 0xffff0000, v205
    v_add_f32 v212, v212, v56
    v_add_f32 v212, v212, v57
    v_add_f32 v212, v212, v58
    v_add_f32 v212, v212, v59
    v_cvt_pk_bf16_f32 v222, v56, v57
    v_cvt_pk_bf16_f32 v223, v58, v59
    v_fma_f32 v60, -v188, v166, v60
    v_mul_f32 v60, v60, v189
    v_fma_f32 v61, -v190, v166, v61
    v_mul_f32 v61, v61, v191
    v_fma_f32 v62, -v192, v166, v62
    v_mul_f32 v62, v62, v193
    v_fma_f32 v63, -v194, v166, v63
    v_mul_f32 v63, v63, v195
    v_cvt_pk_bf16_f32 v204, v60, v61
    v_lshlrev_b32 v60, 16, v204
    v_and_b32 v61, 0xffff0000, v204
    v_cvt_pk_bf16_f32 v205, v62, v63
    v_lshlrev_b32 v62, 16, v205
    v_and_b32 v63, 0xffff0000, v205
    v_mul_f32 v208, 0x3fb8aa3b, v60
    v_exp_f32 v208, v208
    v_cmp_lt_f32 vcc, 0, v60
    v_add_f32 v60, 1.0, v60
    v_cndmask_b32 v60, v208, v60, vcc
    v_mul_f32 v209, 0x3fb8aa3b, v61
    v_exp_f32 v209, v209
    v_cmp_lt_f32 vcc, 0, v61
    v_add_f32 v61, 1.0, v61
    v_cndmask_b32 v61, v209, v61, vcc
    v_mul_f32 v210, 0x3fb8aa3b, v62
    v_exp_f32 v210, v210
    v_cmp_lt_f32 vcc, 0, v62
    v_add_f32 v62, 1.0, v62
    v_cndmask_b32 v62, v210, v62, vcc
    v_mul_f32 v211, 0x3fb8aa3b, v63
    v_exp_f32 v211, v211
    v_cmp_lt_f32 vcc, 0, v63
    v_add_f32 v63, 1.0, v63
    v_cndmask_b32 v63, v211, v63, vcc
    v_cvt_pk_bf16_f32 v204, v60, v61
    v_lshlrev_b32 v60, 16, v204
    v_and_b32 v61, 0xffff0000, v204
    v_cvt_pk_bf16_f32 v205, v62, v63
    v_lshlrev_b32 v62, 16, v205
    v_and_b32 v63, 0xffff0000, v205
    v_add_f32 v60, 0x358637bd, v60
    v_add_f32 v61, 0x358637bd, v61
    v_add_f32 v62, 0x358637bd, v62
    v_add_f32 v63, 0x358637bd, v63
    v_cvt_pk_bf16_f32 v204, v60, v61
    v_lshlrev_b32 v60, 16, v204
    v_and_b32 v61, 0xffff0000, v204
    v_cvt_pk_bf16_f32 v205, v62, v63
    v_lshlrev_b32 v62, 16, v205
    v_and_b32 v63, 0xffff0000, v205
    v_add_f32 v212, v212, v60
    v_add_f32 v212, v212, v61
    v_add_f32 v212, v212, v62
    v_add_f32 v212, v212, v63
    v_cvt_pk_bf16_f32 v224, v60, v61
    v_cvt_pk_bf16_f32 v225, v62, v63
    v_fma_f32 v64, -v196, v166, v64
    v_mul_f32 v64, v64, v197
    v_fma_f32 v65, -v198, v166, v65
    v_mul_f32 v65, v65, v199
    v_fma_f32 v66, -v200, v166, v66
    v_mul_f32 v66, v66, v201
    v_fma_f32 v67, -v202, v166, v67
    v_mul_f32 v67, v67, v203
    v_cvt_pk_bf16_f32 v204, v64, v65
    v_lshlrev_b32 v64, 16, v204
    v_and_b32 v65, 0xffff0000, v204
    v_cvt_pk_bf16_f32 v205, v66, v67
    v_lshlrev_b32 v66, 16, v205
    v_and_b32 v67, 0xffff0000, v205
    v_mul_f32 v208, 0x3fb8aa3b, v64
    v_exp_f32 v208, v208
    v_cmp_lt_f32 vcc, 0, v64
    v_add_f32 v64, 1.0, v64
    v_cndmask_b32 v64, v208, v64, vcc
    v_mul_f32 v209, 0x3fb8aa3b, v65
    v_exp_f32 v209, v209
    v_cmp_lt_f32 vcc, 0, v65
    v_add_f32 v65, 1.0, v65
    v_cndmask_b32 v65, v209, v65, vcc
    v_mul_f32 v210, 0x3fb8aa3b, v66
    v_exp_f32 v210, v210
    v_cmp_lt_f32 vcc, 0, v66
    v_add_f32 v66, 1.0, v66
    v_cndmask_b32 v66, v210, v66, vcc
    v_mul_f32 v211, 0x3fb8aa3b, v67
    v_exp_f32 v211, v211
    v_cmp_lt_f32 vcc, 0, v67
    v_add_f32 v67, 1.0, v67
    v_cndmask_b32 v67, v211, v67, vcc
    v_cvt_pk_bf16_f32 v204, v64, v65
    v_lshlrev_b32 v64, 16, v204
    v_and_b32 v65, 0xffff0000, v204
    v_cvt_pk_bf16_f32 v205, v66, v67
    v_lshlrev_b32 v66, 16, v205
    v_and_b32 v67, 0xffff0000, v205
    v_add_f32 v64, 0x358637bd, v64
    v_add_f32 v65, 0x358637bd, v65
    v_add_f32 v66, 0x358637bd, v66
    v_add_f32 v67, 0x358637bd, v67
    v_cvt_pk_bf16_f32 v204, v64, v65
    v_lshlrev_b32 v64, 16, v204
    v_and_b32 v65, 0xffff0000, v204
    v_cvt_pk_bf16_f32 v205, v66, v67
    v_lshlrev_b32 v66, 16, v205
    v_and_b32 v67, 0xffff0000, v205
    v_add_f32 v212, v212, v64
    v_add_f32 v212, v212, v65
    v_add_f32 v212, v212, v66
    v_add_f32 v212, v212, v67
    v_cvt_pk_bf16_f32 v226, v64, v65
    v_cvt_pk_bf16_f32 v227, v66, v67
    ds_write_b128 v228, v[220:223] offset:7168
    ds_write_b128 v228, v[224:227] offset:8192
    v_mov_b32 v213, v212
    s_nop 1
    v_permlane32_swap_b32 v212, v213
    s_nop 1
    v_add_f32 v212, v212, v213
    v_lshlrev_b32 v213, 2, v160
    s_mul_i32 s65, s84, 640
    s_add_u32 s65, s65, 164224
    v_cmp_gt_u32 vcc, 32, v160
    s_and_saveexec_b64 s[76:77], vcc
    buffer_atomic_add_f32 v212, v213, s[52:55], s65 offen
    s_or_b64 exec, exec, s[76:77]
    s_nop 1
    v_mov_b32 v212, 0
    v_fma_f32 v68, -v172, v167, v68
    v_mul_f32 v68, v68, v173
    v_fma_f32 v69, -v174, v167, v69
    v_mul_f32 v69, v69, v175
    v_fma_f32 v70, -v176, v167, v70
    v_mul_f32 v70, v70, v177
    v_fma_f32 v71, -v178, v167, v71
    v_mul_f32 v71, v71, v179
    v_cvt_pk_bf16_f32 v204, v68, v69
    v_lshlrev_b32 v68, 16, v204
    v_and_b32 v69, 0xffff0000, v204
    v_cvt_pk_bf16_f32 v205, v70, v71
    v_lshlrev_b32 v70, 16, v205
    v_and_b32 v71, 0xffff0000, v205
    v_mul_f32 v208, 0x3fb8aa3b, v68
    v_exp_f32 v208, v208
    v_cmp_lt_f32 vcc, 0, v68
    v_add_f32 v68, 1.0, v68
    v_cndmask_b32 v68, v208, v68, vcc
    v_mul_f32 v209, 0x3fb8aa3b, v69
    v_exp_f32 v209, v209
    v_cmp_lt_f32 vcc, 0, v69
    v_add_f32 v69, 1.0, v69
    v_cndmask_b32 v69, v209, v69, vcc
    v_mul_f32 v210, 0x3fb8aa3b, v70
    v_exp_f32 v210, v210
    v_cmp_lt_f32 vcc, 0, v70
    v_add_f32 v70, 1.0, v70
    v_cndmask_b32 v70, v210, v70, vcc
    v_mul_f32 v211, 0x3fb8aa3b, v71
    v_exp_f32 v211, v211
    v_cmp_lt_f32 vcc, 0, v71
    v_add_f32 v71, 1.0, v71
    v_cndmask_b32 v71, v211, v71, vcc
    v_cvt_pk_bf16_f32 v204, v68, v69
    v_lshlrev_b32 v68, 16, v204
    v_and_b32 v69, 0xffff0000, v204
    v_cvt_pk_bf16_f32 v205, v70, v71
    v_lshlrev_b32 v70, 16, v205
    v_and_b32 v71, 0xffff0000, v205
    v_add_f32 v68, 0x358637bd, v68
    v_add_f32 v69, 0x358637bd, v69
    v_add_f32 v70, 0x358637bd, v70
    v_add_f32 v71, 0x358637bd, v71
    v_cvt_pk_bf16_f32 v204, v68, v69
    v_lshlrev_b32 v68, 16, v204
    v_and_b32 v69, 0xffff0000, v204
    v_cvt_pk_bf16_f32 v205, v70, v71
    v_lshlrev_b32 v70, 16, v205
    v_and_b32 v71, 0xffff0000, v205
    v_add_f32 v212, v212, v68
    v_add_f32 v212, v212, v69
    v_add_f32 v212, v212, v70
    v_add_f32 v212, v212, v71
    v_cvt_pk_bf16_f32 v220, v68, v69
    v_cvt_pk_bf16_f32 v221, v70, v71
    v_fma_f32 v72, -v180, v167, v72
    v_mul_f32 v72, v72, v181
    v_fma_f32 v73, -v182, v167, v73
    v_mul_f32 v73, v73, v183
    v_fma_f32 v74, -v184, v167, v74
    v_mul_f32 v74, v74, v185
    v_fma_f32 v75, -v186, v167, v75
    v_mul_f32 v75, v75, v187
    v_cvt_pk_bf16_f32 v204, v72, v73
    v_lshlrev_b32 v72, 16, v204
    v_and_b32 v73, 0xffff0000, v204
    v_cvt_pk_bf16_f32 v205, v74, v75
    v_lshlrev_b32 v74, 16, v205
    v_and_b32 v75, 0xffff0000, v205
    v_mul_f32 v208, 0x3fb8aa3b, v72
    v_exp_f32 v208, v208
    v_cmp_lt_f32 vcc, 0, v72
    v_add_f32 v72, 1.0, v72
    v_cndmask_b32 v72, v208, v72, vcc
    v_mul_f32 v209, 0x3fb8aa3b, v73
    v_exp_f32 v209, v209
    v_cmp_lt_f32 vcc, 0, v73
    v_add_f32 v73, 1.0, v73
    v_cndmask_b32 v73, v209, v73, vcc
    v_mul_f32 v210, 0x3fb8aa3b, v74
    v_exp_f32 v210, v210
    v_cmp_lt_f32 vcc, 0, v74
    v_add_f32 v74, 1.0, v74
    v_cndmask_b32 v74, v210, v74, vcc
    v_mul_f32 v211, 0x3fb8aa3b, v75
    v_exp_f32 v211, v211
    v_cmp_lt_f32 vcc, 0, v75
    v_add_f32 v75, 1.0, v75
    v_cndmask_b32 v75, v211, v75, vcc
    v_cvt_pk_bf16_f32 v204, v72, v73
    v_lshlrev_b32 v72, 16, v204
    v_and_b32 v73, 0xffff0000, v204
    v_cvt_pk_bf16_f32 v205, v74, v75
    v_lshlrev_b32 v74, 16, v205
    v_and_b32 v75, 0xffff0000, v205
    v_add_f32 v72, 0x358637bd, v72
    v_add_f32 v73, 0x358637bd, v73
    v_add_f32 v74, 0x358637bd, v74
    v_add_f32 v75, 0x358637bd, v75
    v_cvt_pk_bf16_f32 v204, v72, v73
    v_lshlrev_b32 v72, 16, v204
    v_and_b32 v73, 0xffff0000, v204
    v_cvt_pk_bf16_f32 v205, v74, v75
    v_lshlrev_b32 v74, 16, v205
    v_and_b32 v75, 0xffff0000, v205
    v_add_f32 v212, v212, v72
    v_add_f32 v212, v212, v73
    v_add_f32 v212, v212, v74
    v_add_f32 v212, v212, v75
    v_cvt_pk_bf16_f32 v222, v72, v73
    v_cvt_pk_bf16_f32 v223, v74, v75
    v_fma_f32 v76, -v188, v167, v76
    v_mul_f32 v76, v76, v189
    v_fma_f32 v77, -v190, v167, v77
    v_mul_f32 v77, v77, v191
    v_fma_f32 v78, -v192, v167, v78
    v_mul_f32 v78, v78, v193
    v_fma_f32 v79, -v194, v167, v79
    v_mul_f32 v79, v79, v195
    v_cvt_pk_bf16_f32 v204, v76, v77
    v_lshlrev_b32 v76, 16, v204
    v_and_b32 v77, 0xffff0000, v204
    v_cvt_pk_bf16_f32 v205, v78, v79
    v_lshlrev_b32 v78, 16, v205
    v_and_b32 v79, 0xffff0000, v205
    v_mul_f32 v208, 0x3fb8aa3b, v76
    v_exp_f32 v208, v208
    v_cmp_lt_f32 vcc, 0, v76
    v_add_f32 v76, 1.0, v76
    v_cndmask_b32 v76, v208, v76, vcc
    v_mul_f32 v209, 0x3fb8aa3b, v77
    v_exp_f32 v209, v209
    v_cmp_lt_f32 vcc, 0, v77
    v_add_f32 v77, 1.0, v77
    v_cndmask_b32 v77, v209, v77, vcc
    v_mul_f32 v210, 0x3fb8aa3b, v78
    v_exp_f32 v210, v210
    v_cmp_lt_f32 vcc, 0, v78
    v_add_f32 v78, 1.0, v78
    v_cndmask_b32 v78, v210, v78, vcc
    v_mul_f32 v211, 0x3fb8aa3b, v79
    v_exp_f32 v211, v211
    v_cmp_lt_f32 vcc, 0, v79
    v_add_f32 v79, 1.0, v79
    v_cndmask_b32 v79, v211, v79, vcc
    v_cvt_pk_bf16_f32 v204, v76, v77
    v_lshlrev_b32 v76, 16, v204
    v_and_b32 v77, 0xffff0000, v204
    v_cvt_pk_bf16_f32 v205, v78, v79
    v_lshlrev_b32 v78, 16, v205
    v_and_b32 v79, 0xffff0000, v205
    v_add_f32 v76, 0x358637bd, v76
    v_add_f32 v77, 0x358637bd, v77
    v_add_f32 v78, 0x358637bd, v78
    v_add_f32 v79, 0x358637bd, v79
    v_cvt_pk_bf16_f32 v204, v76, v77
    v_lshlrev_b32 v76, 16, v204
    v_and_b32 v77, 0xffff0000, v204
    v_cvt_pk_bf16_f32 v205, v78, v79
    v_lshlrev_b32 v78, 16, v205
    v_and_b32 v79, 0xffff0000, v205
    v_add_f32 v212, v212, v76
    v_add_f32 v212, v212, v77
    v_add_f32 v212, v212, v78
    v_add_f32 v212, v212, v79
    v_cvt_pk_bf16_f32 v224, v76, v77
    v_cvt_pk_bf16_f32 v225, v78, v79
    v_fma_f32 v80, -v196, v167, v80
    v_mul_f32 v80, v80, v197
    v_fma_f32 v81, -v198, v167, v81
    v_mul_f32 v81, v81, v199
    v_fma_f32 v82, -v200, v167, v82
    v_mul_f32 v82, v82, v201
    v_fma_f32 v83, -v202, v167, v83
    v_mul_f32 v83, v83, v203
    v_cvt_pk_bf16_f32 v204, v80, v81
    v_lshlrev_b32 v80, 16, v204
    v_and_b32 v81, 0xffff0000, v204
    v_cvt_pk_bf16_f32 v205, v82, v83
    v_lshlrev_b32 v82, 16, v205
    v_and_b32 v83, 0xffff0000, v205
    v_mul_f32 v208, 0x3fb8aa3b, v80
    v_exp_f32 v208, v208
    v_cmp_lt_f32 vcc, 0, v80
    v_add_f32 v80, 1.0, v80
    v_cndmask_b32 v80, v208, v80, vcc
    v_mul_f32 v209, 0x3fb8aa3b, v81
    v_exp_f32 v209, v209
    v_cmp_lt_f32 vcc, 0, v81
    v_add_f32 v81, 1.0, v81
    v_cndmask_b32 v81, v209, v81, vcc
    v_mul_f32 v210, 0x3fb8aa3b, v82
    v_exp_f32 v210, v210
    v_cmp_lt_f32 vcc, 0, v82
    v_add_f32 v82, 1.0, v82
    v_cndmask_b32 v82, v210, v82, vcc
    v_mul_f32 v211, 0x3fb8aa3b, v83
    v_exp_f32 v211, v211
    v_cmp_lt_f32 vcc, 0, v83
    v_add_f32 v83, 1.0, v83
    v_cndmask_b32 v83, v211, v83, vcc
    v_cvt_pk_bf16_f32 v204, v80, v81
    v_lshlrev_b32 v80, 16, v204
    v_and_b32 v81, 0xffff0000, v204
    v_cvt_pk_bf16_f32 v205, v82, v83
    v_lshlrev_b32 v82, 16, v205
    v_and_b32 v83, 0xffff0000, v205
    v_add_f32 v80, 0x358637bd, v80
    v_add_f32 v81, 0x358637bd, v81
    v_add_f32 v82, 0x358637bd, v82
    v_add_f32 v83, 0x358637bd, v83
    v_cvt_pk_bf16_f32 v204, v80, v81
    v_lshlrev_b32 v80, 16, v204
    v_and_b32 v81, 0xffff0000, v204
    v_cvt_pk_bf16_f32 v205, v82, v83
    v_lshlrev_b32 v82, 16, v205
    v_and_b32 v83, 0xffff0000, v205
    v_add_f32 v212, v212, v80
    v_add_f32 v212, v212, v81
    v_add_f32 v212, v212, v82
    v_add_f32 v212, v212, v83
    v_cvt_pk_bf16_f32 v226, v80, v81
    v_cvt_pk_bf16_f32 v227, v82, v83
    ds_write_b128 v228, v[220:223] offset:9216
    ds_write_b128 v228, v[224:227] offset:10240
    v_mov_b32 v213, v212
    s_nop 1
    v_permlane32_swap_b32 v212, v213
    s_nop 1
    v_add_f32 v212, v212, v213
    v_lshlrev_b32 v213, 2, v160
    s_mul_i32 s65, s84, 640
    s_add_u32 s65, s65, 164352
    v_cmp_gt_u32 vcc, 32, v160
    s_and_saveexec_b64 s[76:77], vcc
    buffer_atomic_add_f32 v212, v213, s[52:55], s65 offen
    s_or_b64 exec, exec, s[76:77]
    s_nop 1
    s_branch .kv_j_13
.kv_v_12:
    v_fma_f32 v4, -v172, v163, v4
    v_mul_f32 v4, v4, v173
    v_fma_f32 v5, -v174, v163, v5
    v_mul_f32 v5, v5, v175
    v_fma_f32 v6, -v176, v163, v6
    v_mul_f32 v6, v6, v177
    v_fma_f32 v7, -v178, v163, v7
    v_mul_f32 v7, v7, v179
    v_cvt_pk_bf16_f32 v204, v4, v5
    v_lshlrev_b32 v4, 16, v204
    v_and_b32 v5, 0xffff0000, v204
    v_cvt_pk_bf16_f32 v205, v6, v7
    v_lshlrev_b32 v6, 16, v205
    v_and_b32 v7, 0xffff0000, v205
    v_cvt_pk_bf16_f32 v220, v4, v5
    v_cvt_pk_bf16_f32 v221, v6, v7
    v_fma_f32 v8, -v180, v163, v8
    v_mul_f32 v8, v8, v181
    v_fma_f32 v9, -v182, v163, v9
    v_mul_f32 v9, v9, v183
    v_fma_f32 v10, -v184, v163, v10
    v_mul_f32 v10, v10, v185
    v_fma_f32 v11, -v186, v163, v11
    v_mul_f32 v11, v11, v187
    v_cvt_pk_bf16_f32 v204, v8, v9
    v_lshlrev_b32 v8, 16, v204
    v_and_b32 v9, 0xffff0000, v204
    v_cvt_pk_bf16_f32 v205, v10, v11
    v_lshlrev_b32 v10, 16, v205
    v_and_b32 v11, 0xffff0000, v205
    v_cvt_pk_bf16_f32 v222, v8, v9
    v_cvt_pk_bf16_f32 v223, v10, v11
    v_fma_f32 v12, -v188, v163, v12
    v_mul_f32 v12, v12, v189
    v_fma_f32 v13, -v190, v163, v13
    v_mul_f32 v13, v13, v191
    v_fma_f32 v14, -v192, v163, v14
    v_mul_f32 v14, v14, v193
    v_fma_f32 v15, -v194, v163, v15
    v_mul_f32 v15, v15, v195
    v_cvt_pk_bf16_f32 v204, v12, v13
    v_lshlrev_b32 v12, 16, v204
    v_and_b32 v13, 0xffff0000, v204
    v_cvt_pk_bf16_f32 v205, v14, v15
    v_lshlrev_b32 v14, 16, v205
    v_and_b32 v15, 0xffff0000, v205
    v_cvt_pk_bf16_f32 v224, v12, v13
    v_cvt_pk_bf16_f32 v225, v14, v15
    v_fma_f32 v16, -v196, v163, v16
    v_mul_f32 v16, v16, v197
    v_fma_f32 v17, -v198, v163, v17
    v_mul_f32 v17, v17, v199
    v_fma_f32 v18, -v200, v163, v18
    v_mul_f32 v18, v18, v201
    v_fma_f32 v19, -v202, v163, v19
    v_mul_f32 v19, v19, v203
    v_cvt_pk_bf16_f32 v204, v16, v17
    v_lshlrev_b32 v16, 16, v204
    v_and_b32 v17, 0xffff0000, v204
    v_cvt_pk_bf16_f32 v205, v18, v19
    v_lshlrev_b32 v18, 16, v205
    v_and_b32 v19, 0xffff0000, v205
    v_cvt_pk_bf16_f32 v226, v16, v17
    v_cvt_pk_bf16_f32 v227, v18, v19
    ds_write_b128 v228, v[220:223] offset:1024
    ds_write_b128 v228, v[224:227] offset:2048
    s_nop 1
    v_fma_f32 v20, -v172, v164, v20
    v_mul_f32 v20, v20, v173
    v_fma_f32 v21, -v174, v164, v21
    v_mul_f32 v21, v21, v175
    v_fma_f32 v22, -v176, v164, v22
    v_mul_f32 v22, v22, v177
    v_fma_f32 v23, -v178, v164, v23
    v_mul_f32 v23, v23, v179
    v_cvt_pk_bf16_f32 v204, v20, v21
    v_lshlrev_b32 v20, 16, v204
    v_and_b32 v21, 0xffff0000, v204
    v_cvt_pk_bf16_f32 v205, v22, v23
    v_lshlrev_b32 v22, 16, v205
    v_and_b32 v23, 0xffff0000, v205
    v_cvt_pk_bf16_f32 v220, v20, v21
    v_cvt_pk_bf16_f32 v221, v22, v23
    v_fma_f32 v24, -v180, v164, v24
    v_mul_f32 v24, v24, v181
    v_fma_f32 v25, -v182, v164, v25
    v_mul_f32 v25, v25, v183
    v_fma_f32 v26, -v184, v164, v26
    v_mul_f32 v26, v26, v185
    v_fma_f32 v27, -v186, v164, v27
    v_mul_f32 v27, v27, v187
    v_cvt_pk_bf16_f32 v204, v24, v25
    v_lshlrev_b32 v24, 16, v204
    v_and_b32 v25, 0xffff0000, v204
    v_cvt_pk_bf16_f32 v205, v26, v27
    v_lshlrev_b32 v26, 16, v205
    v_and_b32 v27, 0xffff0000, v205
    v_cvt_pk_bf16_f32 v222, v24, v25
    v_cvt_pk_bf16_f32 v223, v26, v27
    v_fma_f32 v28, -v188, v164, v28
    v_mul_f32 v28, v28, v189
    v_fma_f32 v29, -v190, v164, v29
    v_mul_f32 v29, v29, v191
    v_fma_f32 v30, -v192, v164, v30
    v_mul_f32 v30, v30, v193
    v_fma_f32 v31, -v194, v164, v31
    v_mul_f32 v31, v31, v195
    v_cvt_pk_bf16_f32 v204, v28, v29
    v_lshlrev_b32 v28, 16, v204
    v_and_b32 v29, 0xffff0000, v204
    v_cvt_pk_bf16_f32 v205, v30, v31
    v_lshlrev_b32 v30, 16, v205
    v_and_b32 v31, 0xffff0000, v205
    v_cvt_pk_bf16_f32 v224, v28, v29
    v_cvt_pk_bf16_f32 v225, v30, v31
    v_fma_f32 v32, -v196, v164, v32
    v_mul_f32 v32, v32, v197
    v_fma_f32 v33, -v198, v164, v33
    v_mul_f32 v33, v33, v199
    v_fma_f32 v34, -v200, v164, v34
    v_mul_f32 v34, v34, v201
    v_fma_f32 v35, -v202, v164, v35
    v_mul_f32 v35, v35, v203
    v_cvt_pk_bf16_f32 v204, v32, v33
    v_lshlrev_b32 v32, 16, v204
    v_and_b32 v33, 0xffff0000, v204
    v_cvt_pk_bf16_f32 v205, v34, v35
    v_lshlrev_b32 v34, 16, v205
    v_and_b32 v35, 0xffff0000, v205
    v_cvt_pk_bf16_f32 v226, v32, v33
    v_cvt_pk_bf16_f32 v227, v34, v35
    ds_write_b128 v228, v[220:223] offset:3072
    ds_write_b128 v228, v[224:227] offset:4096
    s_nop 1
    v_fma_f32 v36, -v172, v165, v36
    v_mul_f32 v36, v36, v173
    v_fma_f32 v37, -v174, v165, v37
    v_mul_f32 v37, v37, v175
    v_fma_f32 v38, -v176, v165, v38
    v_mul_f32 v38, v38, v177
    v_fma_f32 v39, -v178, v165, v39
    v_mul_f32 v39, v39, v179
    v_cvt_pk_bf16_f32 v204, v36, v37
    v_lshlrev_b32 v36, 16, v204
    v_and_b32 v37, 0xffff0000, v204
    v_cvt_pk_bf16_f32 v205, v38, v39
    v_lshlrev_b32 v38, 16, v205
    v_and_b32 v39, 0xffff0000, v205
    v_cvt_pk_bf16_f32 v220, v36, v37
    v_cvt_pk_bf16_f32 v221, v38, v39
    v_fma_f32 v40, -v180, v165, v40
    v_mul_f32 v40, v40, v181
    v_fma_f32 v41, -v182, v165, v41
    v_mul_f32 v41, v41, v183
    v_fma_f32 v42, -v184, v165, v42
    v_mul_f32 v42, v42, v185
    v_fma_f32 v43, -v186, v165, v43
    v_mul_f32 v43, v43, v187
    v_cvt_pk_bf16_f32 v204, v40, v41
    v_lshlrev_b32 v40, 16, v204
    v_and_b32 v41, 0xffff0000, v204
    v_cvt_pk_bf16_f32 v205, v42, v43
    v_lshlrev_b32 v42, 16, v205
    v_and_b32 v43, 0xffff0000, v205
    v_cvt_pk_bf16_f32 v222, v40, v41
    v_cvt_pk_bf16_f32 v223, v42, v43
    v_fma_f32 v44, -v188, v165, v44
    v_mul_f32 v44, v44, v189
    v_fma_f32 v45, -v190, v165, v45
    v_mul_f32 v45, v45, v191
    v_fma_f32 v46, -v192, v165, v46
    v_mul_f32 v46, v46, v193
    v_fma_f32 v47, -v194, v165, v47
    v_mul_f32 v47, v47, v195
    v_cvt_pk_bf16_f32 v204, v44, v45
    v_lshlrev_b32 v44, 16, v204
    v_and_b32 v45, 0xffff0000, v204
    v_cvt_pk_bf16_f32 v205, v46, v47
    v_lshlrev_b32 v46, 16, v205
    v_and_b32 v47, 0xffff0000, v205
    v_cvt_pk_bf16_f32 v224, v44, v45
    v_cvt_pk_bf16_f32 v225, v46, v47
    v_fma_f32 v48, -v196, v165, v48
    v_mul_f32 v48, v48, v197
    v_fma_f32 v49, -v198, v165, v49
    v_mul_f32 v49, v49, v199
    v_fma_f32 v50, -v200, v165, v50
    v_mul_f32 v50, v50, v201
    v_fma_f32 v51, -v202, v165, v51
    v_mul_f32 v51, v51, v203
    v_cvt_pk_bf16_f32 v204, v48, v49
    v_lshlrev_b32 v48, 16, v204
    v_and_b32 v49, 0xffff0000, v204
    v_cvt_pk_bf16_f32 v205, v50, v51
    v_lshlrev_b32 v50, 16, v205
    v_and_b32 v51, 0xffff0000, v205
    v_cvt_pk_bf16_f32 v226, v48, v49
    v_cvt_pk_bf16_f32 v227, v50, v51
    ds_write_b128 v228, v[220:223] offset:5120
    ds_write_b128 v228, v[224:227] offset:6144
    s_nop 1
    v_fma_f32 v52, -v172, v166, v52
    v_mul_f32 v52, v52, v173
    v_fma_f32 v53, -v174, v166, v53
    v_mul_f32 v53, v53, v175
    v_fma_f32 v54, -v176, v166, v54
    v_mul_f32 v54, v54, v177
    v_fma_f32 v55, -v178, v166, v55
    v_mul_f32 v55, v55, v179
    v_cvt_pk_bf16_f32 v204, v52, v53
    v_lshlrev_b32 v52, 16, v204
    v_and_b32 v53, 0xffff0000, v204
    v_cvt_pk_bf16_f32 v205, v54, v55
    v_lshlrev_b32 v54, 16, v205
    v_and_b32 v55, 0xffff0000, v205
    v_cvt_pk_bf16_f32 v220, v52, v53
    v_cvt_pk_bf16_f32 v221, v54, v55
    v_fma_f32 v56, -v180, v166, v56
    v_mul_f32 v56, v56, v181
    v_fma_f32 v57, -v182, v166, v57
    v_mul_f32 v57, v57, v183
    v_fma_f32 v58, -v184, v166, v58
    v_mul_f32 v58, v58, v185
    v_fma_f32 v59, -v186, v166, v59
    v_mul_f32 v59, v59, v187
    v_cvt_pk_bf16_f32 v204, v56, v57
    v_lshlrev_b32 v56, 16, v204
    v_and_b32 v57, 0xffff0000, v204
    v_cvt_pk_bf16_f32 v205, v58, v59
    v_lshlrev_b32 v58, 16, v205
    v_and_b32 v59, 0xffff0000, v205
    v_cvt_pk_bf16_f32 v222, v56, v57
    v_cvt_pk_bf16_f32 v223, v58, v59
    v_fma_f32 v60, -v188, v166, v60
    v_mul_f32 v60, v60, v189
    v_fma_f32 v61, -v190, v166, v61
    v_mul_f32 v61, v61, v191
    v_fma_f32 v62, -v192, v166, v62
    v_mul_f32 v62, v62, v193
    v_fma_f32 v63, -v194, v166, v63
    v_mul_f32 v63, v63, v195
    v_cvt_pk_bf16_f32 v204, v60, v61
    v_lshlrev_b32 v60, 16, v204
    v_and_b32 v61, 0xffff0000, v204
    v_cvt_pk_bf16_f32 v205, v62, v63
    v_lshlrev_b32 v62, 16, v205
    v_and_b32 v63, 0xffff0000, v205
    v_cvt_pk_bf16_f32 v224, v60, v61
    v_cvt_pk_bf16_f32 v225, v62, v63
    v_fma_f32 v64, -v196, v166, v64
    v_mul_f32 v64, v64, v197
    v_fma_f32 v65, -v198, v166, v65
    v_mul_f32 v65, v65, v199
    v_fma_f32 v66, -v200, v166, v66
    v_mul_f32 v66, v66, v201
    v_fma_f32 v67, -v202, v166, v67
    v_mul_f32 v67, v67, v203
    v_cvt_pk_bf16_f32 v204, v64, v65
    v_lshlrev_b32 v64, 16, v204
    v_and_b32 v65, 0xffff0000, v204
    v_cvt_pk_bf16_f32 v205, v66, v67
    v_lshlrev_b32 v66, 16, v205
    v_and_b32 v67, 0xffff0000, v205
    v_cvt_pk_bf16_f32 v226, v64, v65
    v_cvt_pk_bf16_f32 v227, v66, v67
    ds_write_b128 v228, v[220:223] offset:7168
    ds_write_b128 v228, v[224:227] offset:8192
    s_nop 1
    v_fma_f32 v68, -v172, v167, v68
    v_mul_f32 v68, v68, v173
    v_fma_f32 v69, -v174, v167, v69
    v_mul_f32 v69, v69, v175
    v_fma_f32 v70, -v176, v167, v70
    v_mul_f32 v70, v70, v177
    v_fma_f32 v71, -v178, v167, v71
    v_mul_f32 v71, v71, v179
    v_cvt_pk_bf16_f32 v204, v68, v69
    v_lshlrev_b32 v68, 16, v204
    v_and_b32 v69, 0xffff0000, v204
    v_cvt_pk_bf16_f32 v205, v70, v71
    v_lshlrev_b32 v70, 16, v205
    v_and_b32 v71, 0xffff0000, v205
    v_cvt_pk_bf16_f32 v220, v68, v69
    v_cvt_pk_bf16_f32 v221, v70, v71
    v_fma_f32 v72, -v180, v167, v72
    v_mul_f32 v72, v72, v181
    v_fma_f32 v73, -v182, v167, v73
    v_mul_f32 v73, v73, v183
    v_fma_f32 v74, -v184, v167, v74
    v_mul_f32 v74, v74, v185
    v_fma_f32 v75, -v186, v167, v75
    v_mul_f32 v75, v75, v187
    v_cvt_pk_bf16_f32 v204, v72, v73
    v_lshlrev_b32 v72, 16, v204
    v_and_b32 v73, 0xffff0000, v204
    v_cvt_pk_bf16_f32 v205, v74, v75
    v_lshlrev_b32 v74, 16, v205
    v_and_b32 v75, 0xffff0000, v205
    v_cvt_pk_bf16_f32 v222, v72, v73
    v_cvt_pk_bf16_f32 v223, v74, v75
    v_fma_f32 v76, -v188, v167, v76
    v_mul_f32 v76, v76, v189
    v_fma_f32 v77, -v190, v167, v77
    v_mul_f32 v77, v77, v191
    v_fma_f32 v78, -v192, v167, v78
    v_mul_f32 v78, v78, v193
    v_fma_f32 v79, -v194, v167, v79
    v_mul_f32 v79, v79, v195
    v_cvt_pk_bf16_f32 v204, v76, v77
    v_lshlrev_b32 v76, 16, v204
    v_and_b32 v77, 0xffff0000, v204
    v_cvt_pk_bf16_f32 v205, v78, v79
    v_lshlrev_b32 v78, 16, v205
    v_and_b32 v79, 0xffff0000, v205
    v_cvt_pk_bf16_f32 v224, v76, v77
    v_cvt_pk_bf16_f32 v225, v78, v79
    v_fma_f32 v80, -v196, v167, v80
    v_mul_f32 v80, v80, v197
    v_fma_f32 v81, -v198, v167, v81
    v_mul_f32 v81, v81, v199
    v_fma_f32 v82, -v200, v167, v82
    v_mul_f32 v82, v82, v201
    v_fma_f32 v83, -v202, v167, v83
    v_mul_f32 v83, v83, v203
    v_cvt_pk_bf16_f32 v204, v80, v81
    v_lshlrev_b32 v80, 16, v204
    v_and_b32 v81, 0xffff0000, v204
    v_cvt_pk_bf16_f32 v205, v82, v83
    v_lshlrev_b32 v82, 16, v205
    v_and_b32 v83, 0xffff0000, v205
    v_cvt_pk_bf16_f32 v226, v80, v81
    v_cvt_pk_bf16_f32 v227, v82, v83
    ds_write_b128 v228, v[220:223] offset:9216
    ds_write_b128 v228, v[224:227] offset:10240
    s_nop 1
.kv_j_13:
    s_waitcnt lgkmcnt(0)
    s_barrier
    v_and_b32 v229, 31, v160
    v_lshlrev_b32 v229, 2, v229
    v_lshrrev_b32 v230, 5, v160
    v_lshl_add_u32 v229, v230, 10, v229
    v_lshlrev_b32 v230, 4, v160
    s_mul_i32 s85, s84, 40960
    s_cmp_eq_u32 s60, 1
    s_cbranch_scc1 .kvw_15
    s_cmp_eq_u32 s60, 2
    s_cbranch_scc1 .kvw_16
    s_cmp_eq_u32 s60, 3
    s_cbranch_scc1 .kvw_17
.kvw_14:
    v_mov_b32 v4, 0
    v_mov_b32 v5, 0
    v_mov_b32 v6, 0
    v_mov_b32 v7, 0
    v_mov_b32 v8, 0
    v_mov_b32 v9, 0
    v_mov_b32 v10, 0
    v_mov_b32 v11, 0
    v_mov_b32 v12, 0
    v_mov_b32 v13, 0
    v_mov_b32 v14, 0
    v_mov_b32 v15, 0
    v_mov_b32 v16, 0
    v_mov_b32 v17, 0
    v_mov_b32 v18, 0
    v_mov_b32 v19, 0
    ds_read_b128 v[84:87], v230 offset:21504
    ds_read_b128 v[92:95], v230 offset:1024
    s_waitcnt lgkmcnt(0)
    v_mfma_f32_32x32x16_bf16 v[4:19], v[84:87], v[92:95], v[4:19]
    ds_read_b128 v[84:87], v230 offset:22528
    ds_read_b128 v[92:95], v230 offset:2048
    s_waitcnt lgkmcnt(0)
    v_mfma_f32_32x32x16_bf16 v[4:19], v[84:87], v[92:95], v[4:19]
    ds_read_b128 v[84:87], v230 offset:31744
    ds_read_b128 v[92:95], v230 offset:11264
    s_waitcnt lgkmcnt(0)
    v_mfma_f32_32x32x16_bf16 v[4:19], v[84:87], v[92:95], v[4:19]
    ds_read_b128 v[84:87], v230 offset:32768
    ds_read_b128 v[92:95], v230 offset:12288
    s_waitcnt lgkmcnt(0)
    v_mfma_f32_32x32x16_bf16 v[4:19], v[84:87], v[92:95], v[4:19]
    s_nop 7
    s_nop 7
    s_add_u32 s65, s85, 0
    s_mov_b32 exec_lo, 1048575
    s_mov_b32 exec_hi, 1048575
    buffer_atomic_add_f32 v4, v229, s[52:55], s65 offen
    s_add_u32 s65, s85, 256
    s_mov_b32 exec_lo, 1048575
    s_mov_b32 exec_hi, 1048575
    buffer_atomic_add_f32 v5, v229, s[52:55], s65 offen
    s_add_u32 s65, s85, 512
    s_mov_b32 exec_lo, 1048575
    s_mov_b32 exec_hi, 1048575
    buffer_atomic_add_f32 v6, v229, s[52:55], s65 offen
    s_add_u32 s65, s85, 768
    s_mov_b32 exec_lo, 1048575
    s_mov_b32 exec_hi, 1048575
    buffer_atomic_add_f32 v7, v229, s[52:55], s65 offen
    s_add_u32 s65, s85, 2048
    s_mov_b32 exec_lo, 1048575
    s_mov_b32 exec_hi, 1048575
    buffer_atomic_add_f32 v8, v229, s[52:55], s65 offen
    s_add_u32 s65, s85, 2304
    s_mov_b32 exec_lo, 1048575
    s_mov_b32 exec_hi, 1048575
    buffer_atomic_add_f32 v9, v229, s[52:55], s65 offen
    s_add_u32 s65, s85, 2560
    s_mov_b32 exec_lo, 1048575
    s_mov_b32 exec_hi, 1048575
    buffer_atomic_add_f32 v10, v229, s[52:55], s65 offen
    s_add_u32 s65, s85, 2816
    s_mov_b32 exec_lo, 1048575
    s_mov_b32 exec_hi, 1048575
    buffer_atomic_add_f32 v11, v229, s[52:55], s65 offen
    s_add_u32 s65, s85, 4096
    s_mov_b32 exec_lo, 1048575
    s_mov_b32 exec_hi, 4293918720
    buffer_atomic_add_f32 v12, v229, s[52:55], s65 offen
    s_add_u32 s65, s85, 4352
    s_mov_b32 exec_lo, 1048575
    s_mov_b32 exec_hi, 4293918720
    buffer_atomic_add_f32 v13, v229, s[52:55], s65 offen
    s_add_u32 s65, s85, 4608
    s_mov_b32 exec_lo, 1048575
    s_mov_b32 exec_hi, 4293918720
    buffer_atomic_add_f32 v14, v229, s[52:55], s65 offen
    s_add_u32 s65, s85, 4864
    s_mov_b32 exec_lo, 1048575
    s_mov_b32 exec_hi, 4293918720
    buffer_atomic_add_f32 v15, v229, s[52:55], s65 offen
    s_add_u32 s65, s85, 6144
    s_mov_b32 exec_lo, 4293918720
    s_mov_b32 exec_hi, 4293918720
    buffer_atomic_add_f32 v16, v229, s[52:55], s65 offen
    s_add_u32 s65, s85, 6400
    s_mov_b32 exec_lo, 4293918720
    s_mov_b32 exec_hi, 4293918720
    buffer_atomic_add_f32 v17, v229, s[52:55], s65 offen
    s_add_u32 s65, s85, 6656
    s_mov_b32 exec_lo, 4293918720
    s_mov_b32 exec_hi, 4293918720
    buffer_atomic_add_f32 v18, v229, s[52:55], s65 offen
    s_add_u32 s65, s85, 6912
    s_mov_b32 exec_lo, 4293918720
    s_mov_b32 exec_hi, 4293918720
    buffer_atomic_add_f32 v19, v229, s[52:55], s65 offen
    s_mov_b64 exec, -1
    v_mov_b32 v4, 0
    v_mov_b32 v5, 0
    v_mov_b32 v6, 0
    v_mov_b32 v7, 0
    v_mov_b32 v8, 0
    v_mov_b32 v9, 0
    v_mov_b32 v10, 0
    v_mov_b32 v11, 0
    v_mov_b32 v12, 0
    v_mov_b32 v13, 0
    v_mov_b32 v14, 0
    v_mov_b32 v15, 0
    v_mov_b32 v16, 0
    v_mov_b32 v17, 0
    v_mov_b32 v18, 0
    v_mov_b32 v19, 0
    ds_read_b128 v[84:87], v230 offset:25600
    ds_read_b128 v[92:95], v230 offset:3072
    s_waitcnt lgkmcnt(0)
    v_mfma_f32_32x32x16_bf16 v[4:19], v[84:87], v[92:95], v[4:19]
    ds_read_b128 v[84:87], v230 offset:26624
    ds_read_b128 v[92:95], v230 offset:4096
    s_waitcnt lgkmcnt(0)
    v_mfma_f32_32x32x16_bf16 v[4:19], v[84:87], v[92:95], v[4:19]
    ds_read_b128 v[84:87], v230 offset:35840
    ds_read_b128 v[92:95], v230 offset:13312
    s_waitcnt lgkmcnt(0)
    v_mfma_f32_32x32x16_bf16 v[4:19], v[84:87], v[92:95], v[4:19]
    ds_read_b128 v[84:87], v230 offset:36864
    ds_read_b128 v[92:95], v230 offset:14336
    s_waitcnt lgkmcnt(0)
    v_mfma_f32_32x32x16_bf16 v[4:19], v[84:87], v[92:95], v[4:19]
    s_nop 7
    s_nop 7
    s_add_u32 s65, s85, 16320
    s_mov_b32 exec_lo, 4026531840
    s_mov_b32 exec_hi, 4026531840
    buffer_atomic_add_f32 v4, v229, s[52:55], s65 offen
    s_add_u32 s65, s85, 16576
    s_mov_b32 exec_lo, 4026531840
    s_mov_b32 exec_hi, 4026531840
    buffer_atomic_add_f32 v5, v229, s[52:55], s65 offen
    s_add_u32 s65, s85, 16832
    s_mov_b32 exec_lo, 4026531840
    s_mov_b32 exec_hi, 4026531840
    buffer_atomic_add_f32 v6, v229, s[52:55], s65 offen
    s_add_u32 s65, s85, 17088
    s_mov_b32 exec_lo, 4026531840
    s_mov_b32 exec_hi, 4026531840
    buffer_atomic_add_f32 v7, v229, s[52:55], s65 offen
    s_add_u32 s65, s85, 18368
    s_mov_b32 exec_lo, 4026531840
    s_mov_b32 exec_hi, 4026531840
    buffer_atomic_add_f32 v8, v229, s[52:55], s65 offen
    s_add_u32 s65, s85, 18624
    s_mov_b32 exec_lo, 4026531840
    s_mov_b32 exec_hi, 4026531840
    buffer_atomic_add_f32 v9, v229, s[52:55], s65 offen
    s_add_u32 s65, s85, 18880
    s_mov_b32 exec_lo, 4026531840
    s_mov_b32 exec_hi, 4026531840
    buffer_atomic_add_f32 v10, v229, s[52:55], s65 offen
    s_add_u32 s65, s85, 19136
    s_mov_b32 exec_lo, 4026531840
    s_mov_b32 exec_hi, 4026531840
    buffer_atomic_add_f32 v11, v229, s[52:55], s65 offen
    s_mov_b64 exec, -1
    v_mov_b32 v4, 0
    v_mov_b32 v5, 0
    v_mov_b32 v6, 0
    v_mov_b32 v7, 0
    v_mov_b32 v8, 0
    v_mov_b32 v9, 0
    v_mov_b32 v10, 0
    v_mov_b32 v11, 0
    v_mov_b32 v12, 0
    v_mov_b32 v13, 0
    v_mov_b32 v14, 0
    v_mov_b32 v15, 0
    v_mov_b32 v16, 0
    v_mov_b32 v17, 0
    v_mov_b32 v18, 0
    v_mov_b32 v19, 0
    ds_read_b128 v[84:87], v230 offset:25600
    ds_read_b128 v[92:95], v230 offset:7168
    s_waitcnt lgkmcnt(0)
    v_mfma_f32_32x32x16_bf16 v[4:19], v[84:87], v[92:95], v[4:19]
    ds_read_b128 v[84:87], v230 offset:26624
    ds_read_b128 v[92:95], v230 offset:8192
    s_waitcnt lgkmcnt(0)
    v_mfma_f32_32x32x16_bf16 v[4:19], v[84:87], v[92:95], v[4:19]
    ds_read_b128 v[84:87], v230 offset:35840
    ds_read_b128 v[92:95], v230 offset:17408
    s_waitcnt lgkmcnt(0)
    v_mfma_f32_32x32x16_bf16 v[4:19], v[84:87], v[92:95], v[4:19]
    ds_read_b128 v[84:87], v230 offset:36864
    ds_read_b128 v[92:95], v230 offset:18432
    s_waitcnt lgkmcnt(0)
    v_mfma_f32_32x32x16_bf16 v[4:19], v[84:87], v[92:95], v[4:19]
    s_nop 7
    s_nop 7
    s_add_u32 s65, s85, 20672
    s_mov_b32 exec_lo, 15
    s_mov_b32 exec_hi, 15
    buffer_atomic_add_f32 v12, v229, s[52:55], s65 offen
    s_add_u32 s65, s85, 20928
    s_mov_b32 exec_lo, 15
    s_mov_b32 exec_hi, 15
    buffer_atomic_add_f32 v13, v229, s[52:55], s65 offen
    s_add_u32 s65, s85, 21184
    s_mov_b32 exec_lo, 15
    s_mov_b32 exec_hi, 15
    buffer_atomic_add_f32 v14, v229, s[52:55], s65 offen
    s_add_u32 s65, s85, 21440
    s_mov_b32 exec_lo, 15
    s_mov_b32 exec_hi, 15
    buffer_atomic_add_f32 v15, v229, s[52:55], s65 offen
    s_add_u32 s65, s85, 22720
    s_mov_b32 exec_lo, 15
    s_mov_b32 exec_hi, 15
    buffer_atomic_add_f32 v16, v229, s[52:55], s65 offen
    s_add_u32 s65, s85, 22976
    s_mov_b32 exec_lo, 15
    s_mov_b32 exec_hi, 15
    buffer_atomic_add_f32 v17, v229, s[52:55], s65 offen
    s_add_u32 s65, s85, 23232
    s_mov_b32 exec_lo, 15
    s_mov_b32 exec_hi, 15
    buffer_atomic_add_f32 v18, v229, s[52:55], s65 offen
    s_add_u32 s65, s85, 23488
    s_mov_b32 exec_lo, 15
    s_mov_b32 exec_hi, 15
    buffer_atomic_add_f32 v19, v229, s[52:55], s65 offen
    s_mov_b64 exec, -1
    v_mov_b32 v4, 0
    v_mov_b32 v5, 0
    v_mov_b32 v6, 0
    v_mov_b32 v7, 0
    v_mov_b32 v8, 0
    v_mov_b32 v9, 0
    v_mov_b32 v10, 0
    v_mov_b32 v11, 0
    v_mov_b32 v12, 0
    v_mov_b32 v13, 0
    v_mov_b32 v14, 0
    v_mov_b32 v15, 0
    v_mov_b32 v16, 0
    v_mov_b32 v17, 0
    v_mov_b32 v18, 0
    v_mov_b32 v19, 0
    ds_read_b128 v[84:87], v230 offset:29696
    ds_read_b128 v[92:95], v230 offset:9216
    s_waitcnt lgkmcnt(0)
    v_mfma_f32_32x32x16_bf16 v[4:19], v[84:87], v[92:95], v[4:19]
    ds_read_b128 v[84:87], v230 offset:30720
    ds_read_b128 v[92:95], v230 offset:10240
    s_waitcnt lgkmcnt(0)
    v_mfma_f32_32x32x16_bf16 v[4:19], v[84:87], v[92:95], v[4:19]
    ds_read_b128 v[84:87], v230 offset:39936
    ds_read_b128 v[92:95], v230 offset:19456
    s_waitcnt lgkmcnt(0)
    v_mfma_f32_32x32x16_bf16 v[4:19], v[84:87], v[92:95], v[4:19]
    ds_read_b128 v[84:87], v230 offset:40960
    ds_read_b128 v[92:95], v230 offset:20480
    s_waitcnt lgkmcnt(0)
    v_mfma_f32_32x32x16_bf16 v[4:19], v[84:87], v[92:95], v[4:19]
    s_nop 7
    s_nop 7
    s_add_u32 s65, s85, 32832
    s_mov_b32 exec_lo, 4095
    s_mov_b32 exec_hi, 4095
    buffer_atomic_add_f32 v4, v229, s[52:55], s65 offen
    s_add_u32 s65, s85, 33088
    s_mov_b32 exec_lo, 4095
    s_mov_b32 exec_hi, 4095
    buffer_atomic_add_f32 v5, v229, s[52:55], s65 offen
    s_add_u32 s65, s85, 33344
    s_mov_b32 exec_lo, 4095
    s_mov_b32 exec_hi, 4095
    buffer_atomic_add_f32 v6, v229, s[52:55], s65 offen
    s_add_u32 s65, s85, 33600
    s_mov_b32 exec_lo, 4095
    s_mov_b32 exec_hi, 4095
    buffer_atomic_add_f32 v7, v229, s[52:55], s65 offen
    s_add_u32 s65, s85, 34880
    s_mov_b32 exec_lo, 4095
    s_mov_b32 exec_hi, 4294963200
    buffer_atomic_add_f32 v8, v229, s[52:55], s65 offen
    s_add_u32 s65, s85, 35136
    s_mov_b32 exec_lo, 4095
    s_mov_b32 exec_hi, 4294963200
    buffer_atomic_add_f32 v9, v229, s[52:55], s65 offen
    s_add_u32 s65, s85, 35392
    s_mov_b32 exec_lo, 4095
    s_mov_b32 exec_hi, 4294963200
    buffer_atomic_add_f32 v10, v229, s[52:55], s65 offen
    s_add_u32 s65, s85, 35648
    s_mov_b32 exec_lo, 4095
    s_mov_b32 exec_hi, 4294963200
    buffer_atomic_add_f32 v11, v229, s[52:55], s65 offen
    s_add_u32 s65, s85, 36928
    s_mov_b32 exec_lo, 4294963200
    s_mov_b32 exec_hi, 4294963200
    buffer_atomic_add_f32 v12, v229, s[52:55], s65 offen
    s_add_u32 s65, s85, 37184
    s_mov_b32 exec_lo, 4294963200
    s_mov_b32 exec_hi, 4294963200
    buffer_atomic_add_f32 v13, v229, s[52:55], s65 offen
    s_add_u32 s65, s85, 37440
    s_mov_b32 exec_lo, 4294963200
    s_mov_b32 exec_hi, 4294963200
    buffer_atomic_add_f32 v14, v229, s[52:55], s65 offen
    s_add_u32 s65, s85, 37696
    s_mov_b32 exec_lo, 4294963200
    s_mov_b32 exec_hi, 4294963200
    buffer_atomic_add_f32 v15, v229, s[52:55], s65 offen
    s_add_u32 s65, s85, 38976
    s_mov_b32 exec_lo, 4294963200
    s_mov_b32 exec_hi, 4294963200
    buffer_atomic_add_f32 v16, v229, s[52:55], s65 offen
    s_add_u32 s65, s85, 39232
    s_mov_b32 exec_lo, 4294963200
    s_mov_b32 exec_hi, 4294963200
    buffer_atomic_add_f32 v17, v229, s[52:55], s65 offen
    s_add_u32 s65, s85, 39488
    s_mov_b32 exec_lo, 4294963200
    s_mov_b32 exec_hi, 4294963200
    buffer_atomic_add_f32 v18, v229, s[52:55], s65 offen
    s_add_u32 s65, s85, 39744
    s_mov_b32 exec_lo, 4294963200
    s_mov_b32 exec_hi, 4294963200
    buffer_atomic_add_f32 v19, v229, s[52:55], s65 offen
    s_mov_b64 exec, -1
    s_branch .kvend_18
.kvw_15:
    v_mov_b32 v4, 0
    v_mov_b32 v5, 0
    v_mov_b32 v6, 0
    v_mov_b32 v7, 0
    v_mov_b32 v8, 0
    v_mov_b32 v9, 0
    v_mov_b32 v10, 0
    v_mov_b32 v11, 0
    v_mov_b32 v12, 0
    v_mov_b32 v13, 0
    v_mov_b32 v14, 0
    v_mov_b32 v15, 0
    v_mov_b32 v16, 0
    v_mov_b32 v17, 0
    v_mov_b32 v18, 0
    v_mov_b32 v19, 0
    ds_read_b128 v[84:87], v230 offset:23552
    ds_read_b128 v[92:95], v230 offset:1024
    s_waitcnt lgkmcnt(0)
    v_mfma_f32_32x32x16_bf16 v[4:19], v[84:87], v[92:95], v[4:19]
    ds_read_b128 v[84:87], v230 offset:24576
    ds_read_b128 v[92:95], v230 offset:2048
    s_waitcnt lgkmcnt(0)
    v_mfma_f32_32x32x16_bf16 v[4:19], v[84:87], v[92:95], v[4:19]
    ds_read_b128 v[84:87], v230 offset:33792
    ds_read_b128 v[92:95], v230 offset:11264
    s_waitcnt lgkmcnt(0)
    v_mfma_f32_32x32x16_bf16 v[4:19], v[84:87], v[92:95], v[4:19]
    ds_read_b128 v[84:87], v230 offset:34816
    ds_read_b128 v[92:95], v230 offset:12288
    s_waitcnt lgkmcnt(0)
    v_mfma_f32_32x32x16_bf16 v[4:19], v[84:87], v[92:95], v[4:19]
    s_nop 7
    s_nop 7
    s_add_u32 s65, s85, 8128
    s_mov_b32 exec_lo, 4293918720
    s_mov_b32 exec_hi, 4293918720
    buffer_atomic_add_f32 v4, v229, s[52:55], s65 offen
    s_add_u32 s65, s85, 8384
    s_mov_b32 exec_lo, 4293918720
    s_mov_b32 exec_hi, 4293918720
    buffer_atomic_add_f32 v5, v229, s[52:55], s65 offen
    s_add_u32 s65, s85, 8640
    s_mov_b32 exec_lo, 4293918720
    s_mov_b32 exec_hi, 4293918720
    buffer_atomic_add_f32 v6, v229, s[52:55], s65 offen
    s_add_u32 s65, s85, 8896
    s_mov_b32 exec_lo, 4293918720
    s_mov_b32 exec_hi, 4293918720
    buffer_atomic_add_f32 v7, v229, s[52:55], s65 offen
    s_mov_b64 exec, -1
    v_mov_b32 v4, 0
    v_mov_b32 v5, 0
    v_mov_b32 v6, 0
    v_mov_b32 v7, 0
    v_mov_b32 v8, 0
    v_mov_b32 v9, 0
    v_mov_b32 v10, 0
    v_mov_b32 v11, 0
    v_mov_b32 v12, 0
    v_mov_b32 v13, 0
    v_mov_b32 v14, 0
    v_mov_b32 v15, 0
    v_mov_b32 v16, 0
    v_mov_b32 v17, 0
    v_mov_b32 v18, 0
    v_mov_b32 v19, 0
    ds_read_b128 v[84:87], v230 offset:23552
    ds_read_b128 v[92:95], v230 offset:5120
    s_waitcnt lgkmcnt(0)
    v_mfma_f32_32x32x16_bf16 v[4:19], v[84:87], v[92:95], v[4:19]
    ds_read_b128 v[84:87], v230 offset:24576
    ds_read_b128 v[92:95], v230 offset:6144
    s_waitcnt lgkmcnt(0)
    v_mfma_f32_32x32x16_bf16 v[4:19], v[84:87], v[92:95], v[4:19]
    ds_read_b128 v[84:87], v230 offset:33792
    ds_read_b128 v[92:95], v230 offset:15360
    s_waitcnt lgkmcnt(0)
    v_mfma_f32_32x32x16_bf16 v[4:19], v[84:87], v[92:95], v[4:19]
    ds_read_b128 v[84:87], v230 offset:34816
    ds_read_b128 v[92:95], v230 offset:16384
    s_waitcnt lgkmcnt(0)
    v_mfma_f32_32x32x16_bf16 v[4:19], v[84:87], v[92:95], v[4:19]
    s_nop 7
    s_nop 7
    s_add_u32 s65, s85, 14528
    s_mov_b32 exec_lo, 0
    s_mov_b32 exec_hi, 65535
    buffer_atomic_add_f32 v16, v229, s[52:55], s65 offen
    s_add_u32 s65, s85, 14784
    s_mov_b32 exec_lo, 0
    s_mov_b32 exec_hi, 65535
    buffer_atomic_add_f32 v17, v229, s[52:55], s65 offen
    s_add_u32 s65, s85, 15040
    s_mov_b32 exec_lo, 0
    s_mov_b32 exec_hi, 65535
    buffer_atomic_add_f32 v18, v229, s[52:55], s65 offen
    s_add_u32 s65, s85, 15296
    s_mov_b32 exec_lo, 0
    s_mov_b32 exec_hi, 65535
    buffer_atomic_add_f32 v19, v229, s[52:55], s65 offen
    s_mov_b64 exec, -1
    v_mov_b32 v4, 0
    v_mov_b32 v5, 0
    v_mov_b32 v6, 0
    v_mov_b32 v7, 0
    v_mov_b32 v8, 0
    v_mov_b32 v9, 0
    v_mov_b32 v10, 0
    v_mov_b32 v11, 0
    v_mov_b32 v12, 0
    v_mov_b32 v13, 0
    v_mov_b32 v14, 0
    v_mov_b32 v15, 0
    v_mov_b32 v16, 0
    v_mov_b32 v17, 0
    v_mov_b32 v18, 0
    v_mov_b32 v19, 0
    ds_read_b128 v[84:87], v230 offset:27648
    ds_read_b128 v[92:95], v230 offset:7168
    s_waitcnt lgkmcnt(0)
    v_mfma_f32_32x32x16_bf16 v[4:19], v[84:87], v[92:95], v[4:19]
    ds_read_b128 v[84:87], v230 offset:28672
    ds_read_b128 v[92:95], v230 offset:8192
    s_waitcnt lgkmcnt(0)
    v_mfma_f32_32x32x16_bf16 v[4:19], v[84:87], v[92:95], v[4:19]
    ds_read_b128 v[84:87], v230 offset:37888
    ds_read_b128 v[92:95], v230 offset:17408
    s_waitcnt lgkmcnt(0)
    v_mfma_f32_32x32x16_bf16 v[4:19], v[84:87], v[92:95], v[4:19]
    ds_read_b128 v[84:87], v230 offset:38912
    ds_read_b128 v[92:95], v230 offset:18432
    s_waitcnt lgkmcnt(0)
    v_mfma_f32_32x32x16_bf16 v[4:19], v[84:87], v[92:95], v[4:19]
    s_nop 7
    s_nop 7
    s_add_u32 s65, s85, 24640
    s_mov_b32 exec_lo, 15
    s_mov_b32 exec_hi, 16777200
    buffer_atomic_add_f32 v4, v229, s[52:55], s65 offen
    s_add_u32 s65, s85, 24896
    s_mov_b32 exec_lo, 15
    s_mov_b32 exec_hi, 16777200
    buffer_atomic_add_f32 v5, v229, s[52:55], s65 offen
    s_add_u32 s65, s85, 25152
    s_mov_b32 exec_lo, 15
    s_mov_b32 exec_hi, 16777200
    buffer_atomic_add_f32 v6, v229, s[52:55], s65 offen
    s_add_u32 s65, s85, 25408
    s_mov_b32 exec_lo, 15
    s_mov_b32 exec_hi, 16777200
    buffer_atomic_add_f32 v7, v229, s[52:55], s65 offen
    s_add_u32 s65, s85, 26688
    s_mov_b32 exec_lo, 16777200
    s_mov_b32 exec_hi, 16777200
    buffer_atomic_add_f32 v8, v229, s[52:55], s65 offen
    s_add_u32 s65, s85, 26944
    s_mov_b32 exec_lo, 16777200
    s_mov_b32 exec_hi, 16777200
    buffer_atomic_add_f32 v9, v229, s[52:55], s65 offen
    s_add_u32 s65, s85, 27200
    s_mov_b32 exec_lo, 16777200
    s_mov_b32 exec_hi, 16777200
    buffer_atomic_add_f32 v10, v229, s[52:55], s65 offen
    s_add_u32 s65, s85, 27456
    s_mov_b32 exec_lo, 16777200
    s_mov_b32 exec_hi, 16777200
    buffer_atomic_add_f32 v11, v229, s[52:55], s65 offen
    s_add_u32 s65, s85, 28736
    s_mov_b32 exec_lo, 16777200
    s_mov_b32 exec_hi, 16777200
    buffer_atomic_add_f32 v12, v229, s[52:55], s65 offen
    s_add_u32 s65, s85, 28992
    s_mov_b32 exec_lo, 16777200
    s_mov_b32 exec_hi, 16777200
    buffer_atomic_add_f32 v13, v229, s[52:55], s65 offen
    s_add_u32 s65, s85, 29248
    s_mov_b32 exec_lo, 16777200
    s_mov_b32 exec_hi, 16777200
    buffer_atomic_add_f32 v14, v229, s[52:55], s65 offen
    s_add_u32 s65, s85, 29504
    s_mov_b32 exec_lo, 16777200
    s_mov_b32 exec_hi, 16777200
    buffer_atomic_add_f32 v15, v229, s[52:55], s65 offen
    s_add_u32 s65, s85, 30784
    s_mov_b32 exec_lo, 4278190080
    s_mov_b32 exec_hi, 4278190080
    buffer_atomic_add_f32 v16, v229, s[52:55], s65 offen
    s_add_u32 s65, s85, 31040
    s_mov_b32 exec_lo, 4278190080
    s_mov_b32 exec_hi, 4278190080
    buffer_atomic_add_f32 v17, v229, s[52:55], s65 offen
    s_add_u32 s65, s85, 31296
    s_mov_b32 exec_lo, 4278190080
    s_mov_b32 exec_hi, 4278190080
    buffer_atomic_add_f32 v18, v229, s[52:55], s65 offen
    s_add_u32 s65, s85, 31552
    s_mov_b32 exec_lo, 4278190080
    s_mov_b32 exec_hi, 4278190080
    buffer_atomic_add_f32 v19, v229, s[52:55], s65 offen
    s_mov_b64 exec, -1
    s_branch .kvend_18
.kvw_16:
    v_mov_b32 v4, 0
    v_mov_b32 v5, 0
    v_mov_b32 v6, 0
    v_mov_b32 v7, 0
    v_mov_b32 v8, 0
    v_mov_b32 v9, 0
    v_mov_b32 v10, 0
    v_mov_b32 v11, 0
    v_mov_b32 v12, 0
    v_mov_b32 v13, 0
    v_mov_b32 v14, 0
    v_mov_b32 v15, 0
    v_mov_b32 v16, 0
    v_mov_b32 v17, 0
    v_mov_b32 v18, 0
    v_mov_b32 v19, 0
    ds_read_b128 v[84:87], v230 offset:21504
    ds_read_b128 v[92:95], v230 offset:3072
    s_waitcnt lgkmcnt(0)
    v_mfma_f32_32x32x16_bf16 v[4:19], v[84:87], v[92:95], v[4:19]
    ds_read_b128 v[84:87], v230 offset:22528
    ds_read_b128 v[92:95], v230 offset:4096
    s_waitcnt lgkmcnt(0)
    v_mfma_f32_32x32x16_bf16 v[4:19], v[84:87], v[92:95], v[4:19]
    ds_read_b128 v[84:87], v230 offset:31744
    ds_read_b128 v[92:95], v230 offset:13312
    s_waitcnt lgkmcnt(0)
    v_mfma_f32_32x32x16_bf16 v[4:19], v[84:87], v[92:95], v[4:19]
    ds_read_b128 v[84:87], v230 offset:32768
    ds_read_b128 v[92:95], v230 offset:14336
    s_waitcnt lgkmcnt(0)
    v_mfma_f32_32x32x16_bf16 v[4:19], v[84:87], v[92:95], v[4:19]
    s_nop 7
    s_nop 7
    s_add_u32 s65, s85, 4224
    s_mov_b32 exec_lo, 0
    s_mov_b32 exec_hi, 255
    buffer_atomic_add_f32 v12, v229, s[52:55], s65 offen
    s_add_u32 s65, s85, 4480
    s_mov_b32 exec_lo, 0
    s_mov_b32 exec_hi, 255
    buffer_atomic_add_f32 v13, v229, s[52:55], s65 offen
    s_add_u32 s65, s85, 4736
    s_mov_b32 exec_lo, 0
    s_mov_b32 exec_hi, 255
    buffer_atomic_add_f32 v14, v229, s[52:55], s65 offen
    s_add_u32 s65, s85, 4992
    s_mov_b32 exec_lo, 0
    s_mov_b32 exec_hi, 255
    buffer_atomic_add_f32 v15, v229, s[52:55], s65 offen
    s_add_u32 s65, s85, 6272
    s_mov_b32 exec_lo, 255
    s_mov_b32 exec_hi, 255
    buffer_atomic_add_f32 v16, v229, s[52:55], s65 offen
    s_add_u32 s65, s85, 6528
    s_mov_b32 exec_lo, 255
    s_mov_b32 exec_hi, 255
    buffer_atomic_add_f32 v17, v229, s[52:55], s65 offen
    s_add_u32 s65, s85, 6784
    s_mov_b32 exec_lo, 255
    s_mov_b32 exec_hi, 255
    buffer_atomic_add_f32 v18, v229, s[52:55], s65 offen
    s_add_u32 s65, s85, 7040
    s_mov_b32 exec_lo, 255
    s_mov_b32 exec_hi, 255
    buffer_atomic_add_f32 v19, v229, s[52:55], s65 offen
    s_mov_b64 exec, -1
    v_mov_b32 v4, 0
    v_mov_b32 v5, 0
    v_mov_b32 v6, 0
    v_mov_b32 v7, 0
    v_mov_b32 v8, 0
    v_mov_b32 v9, 0
    v_mov_b32 v10, 0
    v_mov_b32 v11, 0
    v_mov_b32 v12, 0
    v_mov_b32 v13, 0
    v_mov_b32 v14, 0
    v_mov_b32 v15, 0
    v_mov_b32 v16, 0
    v_mov_b32 v17, 0
    v_mov_b32 v18, 0
    v_mov_b32 v19, 0
    ds_read_b128 v[84:87], v230 offset:25600
    ds_read_b128 v[92:95], v230 offset:5120
    s_waitcnt lgkmcnt(0)
    v_mfma_f32_32x32x16_bf16 v[4:19], v[84:87], v[92:95], v[4:19]
    ds_read_b128 v[84:87], v230 offset:26624
    ds_read_b128 v[92:95], v230 offset:6144
    s_waitcnt lgkmcnt(0)
    v_mfma_f32_32x32x16_bf16 v[4:19], v[84:87], v[92:95], v[4:19]
    ds_read_b128 v[84:87], v230 offset:35840
    ds_read_b128 v[92:95], v230 offset:15360
    s_waitcnt lgkmcnt(0)
    v_mfma_f32_32x32x16_bf16 v[4:19], v[84:87], v[92:95], v[4:19]
    ds_read_b128 v[84:87], v230 offset:36864
    ds_read_b128 v[92:95], v230 offset:16384
    s_waitcnt lgkmcnt(0)
    v_mfma_f32_32x32x16_bf16 v[4:19], v[84:87], v[92:95], v[4:19]
    s_nop 7
    s_nop 7
    s_add_u32 s65, s85, 16448
    s_mov_b32 exec_lo, 65535
    s_mov_b32 exec_hi, 65535
    buffer_atomic_add_f32 v4, v229, s[52:55], s65 offen
    s_add_u32 s65, s85, 16704
    s_mov_b32 exec_lo, 65535
    s_mov_b32 exec_hi, 65535
    buffer_atomic_add_f32 v5, v229, s[52:55], s65 offen
    s_add_u32 s65, s85, 16960
    s_mov_b32 exec_lo, 65535
    s_mov_b32 exec_hi, 65535
    buffer_atomic_add_f32 v6, v229, s[52:55], s65 offen
    s_add_u32 s65, s85, 17216
    s_mov_b32 exec_lo, 65535
    s_mov_b32 exec_hi, 65535
    buffer_atomic_add_f32 v7, v229, s[52:55], s65 offen
    s_add_u32 s65, s85, 18496
    s_mov_b32 exec_lo, 65535
    s_mov_b32 exec_hi, 65535
    buffer_atomic_add_f32 v8, v229, s[52:55], s65 offen
    s_add_u32 s65, s85, 18752
    s_mov_b32 exec_lo, 65535
    s_mov_b32 exec_hi, 65535
    buffer_atomic_add_f32 v9, v229, s[52:55], s65 offen
    s_add_u32 s65, s85, 19008
    s_mov_b32 exec_lo, 65535
    s_mov_b32 exec_hi, 65535
    buffer_atomic_add_f32 v10, v229, s[52:55], s65 offen
    s_add_u32 s65, s85, 19264
    s_mov_b32 exec_lo, 65535
    s_mov_b32 exec_hi, 65535
    buffer_atomic_add_f32 v11, v229, s[52:55], s65 offen
    s_add_u32 s65, s85, 20544
    s_mov_b32 exec_lo, 4294901760
    s_mov_b32 exec_hi, 4294901760
    buffer_atomic_add_f32 v12, v229, s[52:55], s65 offen
    s_add_u32 s65, s85, 20800
    s_mov_b32 exec_lo, 4294901760
    s_mov_b32 exec_hi, 4294901760
    buffer_atomic_add_f32 v13, v229, s[52:55], s65 offen
    s_add_u32 s65, s85, 21056
    s_mov_b32 exec_lo, 4294901760
    s_mov_b32 exec_hi, 4294901760
    buffer_atomic_add_f32 v14, v229, s[52:55], s65 offen
    s_add_u32 s65, s85, 21312
    s_mov_b32 exec_lo, 4294901760
    s_mov_b32 exec_hi, 4294901760
    buffer_atomic_add_f32 v15, v229, s[52:55], s65 offen
    s_add_u32 s65, s85, 22592
    s_mov_b32 exec_lo, 4294901760
    s_mov_b32 exec_hi, 4294901760
    buffer_atomic_add_f32 v16, v229, s[52:55], s65 offen
    s_add_u32 s65, s85, 22848
    s_mov_b32 exec_lo, 4294901760
    s_mov_b32 exec_hi, 4294901760
    buffer_atomic_add_f32 v17, v229, s[52:55], s65 offen
    s_add_u32 s65, s85, 23104
    s_mov_b32 exec_lo, 4294901760
    s_mov_b32 exec_hi, 4294901760
    buffer_atomic_add_f32 v18, v229, s[52:55], s65 offen
    s_add_u32 s65, s85, 23360
    s_mov_b32 exec_lo, 4294901760
    s_mov_b32 exec_hi, 4294901760
    buffer_atomic_add_f32 v19, v229, s[52:55], s65 offen
    s_mov_b64 exec, -1
    v_mov_b32 v4, 0
    v_mov_b32 v5, 0
    v_mov_b32 v6, 0
    v_mov_b32 v7, 0
    v_mov_b32 v8, 0
    v_mov_b32 v9, 0
    v_mov_b32 v10, 0
    v_mov_b32 v11, 0
    v_mov_b32 v12, 0
    v_mov_b32 v13, 0
    v_mov_b32 v14, 0
    v_mov_b32 v15, 0
    v_mov_b32 v16, 0
    v_mov_b32 v17, 0
    v_mov_b32 v18, 0
    v_mov_b32 v19, 0
    ds_read_b128 v[84:87], v230 offset:29696
    ds_read_b128 v[92:95], v230 offset:7168
    s_waitcnt lgkmcnt(0)
    v_mfma_f32_32x32x16_bf16 v[4:19], v[84:87], v[92:95], v[4:19]
    ds_read_b128 v[84:87], v230 offset:30720
    ds_read_b128 v[92:95], v230 offset:8192
    s_waitcnt lgkmcnt(0)
    v_mfma_f32_32x32x16_bf16 v[4:19], v[84:87], v[92:95], v[4:19]
    ds_read_b128 v[84:87], v230 offset:39936
    ds_read_b128 v[92:95], v230 offset:17408
    s_waitcnt lgkmcnt(0)
    v_mfma_f32_32x32x16_bf16 v[4:19], v[84:87], v[92:95], v[4:19]
    ds_read_b128 v[84:87], v230 offset:40960
    ds_read_b128 v[92:95], v230 offset:18432
    s_waitcnt lgkmcnt(0)
    v_mfma_f32_32x32x16_bf16 v[4:19], v[84:87], v[92:95], v[4:19]
    s_nop 7
    s_nop 7
    s_add_u32 s65, s85, 32704
    s_mov_b32 exec_lo, 4278190080
    s_mov_b32 exec_hi, 4278190080
    buffer_atomic_add_f32 v4, v229, s[52:55], s65 offen
    s_add_u32 s65, s85, 32960
    s_mov_b32 exec_lo, 4278190080
    s_mov_b32 exec_hi, 4278190080
    buffer_atomic_add_f32 v5, v229, s[52:55], s65 offen
    s_add_u32 s65, s85, 33216
    s_mov_b32 exec_lo, 4278190080
    s_mov_b32 exec_hi, 4278190080
    buffer_atomic_add_f32 v6, v229, s[52:55], s65 offen
    s_add_u32 s65, s85, 33472
    s_mov_b32 exec_lo, 4278190080
    s_mov_b32 exec_hi, 4278190080
    buffer_atomic_add_f32 v7, v229, s[52:55], s65 offen
    s_add_u32 s65, s85, 34752
    s_mov_b32 exec_lo, 4278190080
    s_mov_b32 exec_hi, 0
    buffer_atomic_add_f32 v8, v229, s[52:55], s65 offen
    s_add_u32 s65, s85, 35008
    s_mov_b32 exec_lo, 4278190080
    s_mov_b32 exec_hi, 0
    buffer_atomic_add_f32 v9, v229, s[52:55], s65 offen
    s_add_u32 s65, s85, 35264
    s_mov_b32 exec_lo, 4278190080
    s_mov_b32 exec_hi, 0
    buffer_atomic_add_f32 v10, v229, s[52:55], s65 offen
    s_add_u32 s65, s85, 35520
    s_mov_b32 exec_lo, 4278190080
    s_mov_b32 exec_hi, 0
    buffer_atomic_add_f32 v11, v229, s[52:55], s65 offen
    s_mov_b64 exec, -1
    s_branch .kvend_18
.kvw_17:
    v_mov_b32 v4, 0
    v_mov_b32 v5, 0
    v_mov_b32 v6, 0
    v_mov_b32 v7, 0
    v_mov_b32 v8, 0
    v_mov_b32 v9, 0
    v_mov_b32 v10, 0
    v_mov_b32 v11, 0
    v_mov_b32 v12, 0
    v_mov_b32 v13, 0
    v_mov_b32 v14, 0
    v_mov_b32 v15, 0
    v_mov_b32 v16, 0
    v_mov_b32 v17, 0
    v_mov_b32 v18, 0
    v_mov_b32 v19, 0
    ds_read_b128 v[84:87], v230 offset:23552
    ds_read_b128 v[92:95], v230 offset:3072
    s_waitcnt lgkmcnt(0)
    v_mfma_f32_32x32x16_bf16 v[4:19], v[84:87], v[92:95], v[4:19]
    ds_read_b128 v[84:87], v230 offset:24576
    ds_read_b128 v[92:95], v230 offset:4096
    s_waitcnt lgkmcnt(0)
    v_mfma_f32_32x32x16_bf16 v[4:19], v[84:87], v[92:95], v[4:19]
    ds_read_b128 v[84:87], v230 offset:33792
    ds_read_b128 v[92:95], v230 offset:13312
    s_waitcnt lgkmcnt(0)
    v_mfma_f32_32x32x16_bf16 v[4:19], v[84:87], v[92:95], v[4:19]
    ds_read_b128 v[84:87], v230 offset:34816
    ds_read_b128 v[92:95], v230 offset:14336
    s_waitcnt lgkmcnt(0)
    v_mfma_f32_32x32x16_bf16 v[4:19], v[84:87], v[92:95], v[4:19]
    s_nop 7
    s_nop 7
    s_add_u32 s65, s85, 8256
    s_mov_b32 exec_lo, 255
    s_mov_b32 exec_hi, 255
    buffer_atomic_add_f32 v4, v229, s[52:55], s65 offen
    s_add_u32 s65, s85, 8512
    s_mov_b32 exec_lo, 255
    s_mov_b32 exec_hi, 255
    buffer_atomic_add_f32 v5, v229, s[52:55], s65 offen
    s_add_u32 s65, s85, 8768
    s_mov_b32 exec_lo, 255
    s_mov_b32 exec_hi, 255
    buffer_atomic_add_f32 v6, v229, s[52:55], s65 offen
    s_add_u32 s65, s85, 9024
    s_mov_b32 exec_lo, 255
    s_mov_b32 exec_hi, 255
    buffer_atomic_add_f32 v7, v229, s[52:55], s65 offen
    s_add_u32 s65, s85, 10304
    s_mov_b32 exec_lo, 268435200
    s_mov_b32 exec_hi, 268435200
    buffer_atomic_add_f32 v8, v229, s[52:55], s65 offen
    s_add_u32 s65, s85, 10560
    s_mov_b32 exec_lo, 268435200
    s_mov_b32 exec_hi, 268435200
    buffer_atomic_add_f32 v9, v229, s[52:55], s65 offen
    s_add_u32 s65, s85, 10816
    s_mov_b32 exec_lo, 268435200
    s_mov_b32 exec_hi, 268435200
    buffer_atomic_add_f32 v10, v229, s[52:55], s65 offen
    s_add_u32 s65, s85, 11072
    s_mov_b32 exec_lo, 268435200
    s_mov_b32 exec_hi, 268435200
    buffer_atomic_add_f32 v11, v229, s[52:55], s65 offen
    s_add_u32 s65, s85, 12352
    s_mov_b32 exec_lo, 268435200
    s_mov_b32 exec_hi, 268435200
    buffer_atomic_add_f32 v12, v229, s[52:55], s65 offen
    s_add_u32 s65, s85, 12608
    s_mov_b32 exec_lo, 268435200
    s_mov_b32 exec_hi, 268435200
    buffer_atomic_add_f32 v13, v229, s[52:55], s65 offen
    s_add_u32 s65, s85, 12864
    s_mov_b32 exec_lo, 268435200
    s_mov_b32 exec_hi, 268435200
    buffer_atomic_add_f32 v14, v229, s[52:55], s65 offen
    s_add_u32 s65, s85, 13120
    s_mov_b32 exec_lo, 268435200
    s_mov_b32 exec_hi, 268435200
    buffer_atomic_add_f32 v15, v229, s[52:55], s65 offen
    s_add_u32 s65, s85, 14400
    s_mov_b32 exec_lo, 268435200
    s_mov_b32 exec_hi, 4026531840
    buffer_atomic_add_f32 v16, v229, s[52:55], s65 offen
    s_add_u32 s65, s85, 14656
    s_mov_b32 exec_lo, 268435200
    s_mov_b32 exec_hi, 4026531840
    buffer_atomic_add_f32 v17, v229, s[52:55], s65 offen
    s_add_u32 s65, s85, 14912
    s_mov_b32 exec_lo, 268435200
    s_mov_b32 exec_hi, 4026531840
    buffer_atomic_add_f32 v18, v229, s[52:55], s65 offen
    s_add_u32 s65, s85, 15168
    s_mov_b32 exec_lo, 268435200
    s_mov_b32 exec_hi, 4026531840
    buffer_atomic_add_f32 v19, v229, s[52:55], s65 offen
    s_mov_b64 exec, -1
    v_mov_b32 v4, 0
    v_mov_b32 v5, 0
    v_mov_b32 v6, 0
    v_mov_b32 v7, 0
    v_mov_b32 v8, 0
    v_mov_b32 v9, 0
    v_mov_b32 v10, 0
    v_mov_b32 v11, 0
    v_mov_b32 v12, 0
    v_mov_b32 v13, 0
    v_mov_b32 v14, 0
    v_mov_b32 v15, 0
    v_mov_b32 v16, 0
    v_mov_b32 v17, 0
    v_mov_b32 v18, 0
    v_mov_b32 v19, 0
    ds_read_b128 v[84:87], v230 offset:27648
    ds_read_b128 v[92:95], v230 offset:5120
    s_waitcnt lgkmcnt(0)
    v_mfma_f32_32x32x16_bf16 v[4:19], v[84:87], v[92:95], v[4:19]
    ds_read_b128 v[84:87], v230 offset:28672
    ds_read_b128 v[92:95], v230 offset:6144
    s_waitcnt lgkmcnt(0)
    v_mfma_f32_32x32x16_bf16 v[4:19], v[84:87], v[92:95], v[4:19]
    ds_read_b128 v[84:87], v230 offset:37888
    ds_read_b128 v[92:95], v230 offset:15360
    s_waitcnt lgkmcnt(0)
    v_mfma_f32_32x32x16_bf16 v[4:19], v[84:87], v[92:95], v[4:19]
    ds_read_b128 v[84:87], v230 offset:38912
    ds_read_b128 v[92:95], v230 offset:16384
    s_waitcnt lgkmcnt(0)
    v_mfma_f32_32x32x16_bf16 v[4:19], v[84:87], v[92:95], v[4:19]
    s_nop 7
    s_nop 7
    s_add_u32 s65, s85, 24512
    s_mov_b32 exec_lo, 4294901760
    s_mov_b32 exec_hi, 0
    buffer_atomic_add_f32 v4, v229, s[52:55], s65 offen
    s_add_u32 s65, s85, 24768
    s_mov_b32 exec_lo, 4294901760
    s_mov_b32 exec_hi, 0
    buffer_atomic_add_f32 v5, v229, s[52:55], s65 offen
    s_add_u32 s65, s85, 25024
    s_mov_b32 exec_lo, 4294901760
    s_mov_b32 exec_hi, 0
    buffer_atomic_add_f32 v6, v229, s[52:55], s65 offen
    s_add_u32 s65, s85, 25280
    s_mov_b32 exec_lo, 4294901760
    s_mov_b32 exec_hi, 0
    buffer_atomic_add_f32 v7, v229, s[52:55], s65 offen
    s_mov_b64 exec, -1
    v_mov_b32 v4, 0
    v_mov_b32 v5, 0
    v_mov_b32 v6, 0
    v_mov_b32 v7, 0
    v_mov_b32 v8, 0
    v_mov_b32 v9, 0
    v_mov_b32 v10, 0
    v_mov_b32 v11, 0
    v_mov_b32 v12, 0
    v_mov_b32 v13, 0
    v_mov_b32 v14, 0
    v_mov_b32 v15, 0
    v_mov_b32 v16, 0
    v_mov_b32 v17, 0
    v_mov_b32 v18, 0
    v_mov_b32 v19, 0
    ds_read_b128 v[84:87], v230 offset:27648
    ds_read_b128 v[92:95], v230 offset:9216
    s_waitcnt lgkmcnt(0)
    v_mfma_f32_32x32x16_bf16 v[4:19], v[84:87], v[92:95], v[4:19]
    ds_read_b128 v[84:87], v230 offset:28672
    ds_read_b128 v[92:95], v230 offset:10240
    s_waitcnt lgkmcnt(0)
    v_mfma_f32_32x32x16_bf16 v[4:19], v[84:87], v[92:95], v[4:19]
    ds_read_b128 v[84:87], v230 offset:37888
    ds_read_b128 v[92:95], v230 offset:19456
    s_waitcnt lgkmcnt(0)
    v_mfma_f32_32x32x16_bf16 v[4:19], v[84:87], v[92:95], v[4:19]
    ds_read_b128 v[84:87], v230 offset:38912
    ds_read_b128 v[92:95], v230 offset:20480
    s_waitcnt lgkmcnt(0)
    v_mfma_f32_32x32x16_bf16 v[4:19], v[84:87], v[92:95], v[4:19]
    s_nop 7
    s_nop 7
    s_add_u32 s65, s85, 30912
    s_mov_b32 exec_lo, 4095
    s_mov_b32 exec_hi, 4095
    buffer_atomic_add_f32 v16, v229, s[52:55], s65 offen
    s_add_u32 s65, s85, 31168
    s_mov_b32 exec_lo, 4095
    s_mov_b32 exec_hi, 4095
    buffer_atomic_add_f32 v17, v229, s[52:55], s65 offen
    s_add_u32 s65, s85, 31424
    s_mov_b32 exec_lo, 4095
    s_mov_b32 exec_hi, 4095
    buffer_atomic_add_f32 v18, v229, s[52:55], s65 offen
    s_add_u32 s65, s85, 31680
    s_mov_b32 exec_lo, 4095
    s_mov_b32 exec_hi, 4095
    buffer_atomic_add_f32 v19, v229, s[52:55], s65 offen
    s_mov_b64 exec, -1
.kvend_18:
    s_endpgm
.k1p1_kernel_q:
    s_sub_u32 s65, s2, 128
    s_and_b32 s61, s65, 15
    s_lshl_b32 s61, s61, 7
    s_lshr_b32 s62, s65, 4
    s_lshl_b32 s62, s62, 7
    s_add_u32 s40, s36, 13950976
    s_addc_u32 s41, s37, 0
    s_and_b32 s41, s41, 0xffff
    s_mov_b32 s42, 2621440
    s_mov_b32 s43, 0x00020000
    s_mov_b32 s44, s36
    s_mov_b32 s45, s37
    s_and_b32 s45, s45, 0xffff
    s_mov_b32 s46, 2457600
    s_mov_b32 s47, 0x00020000
    v_and_b32 v124, 63, v0
    v_lshrrev_b32 v125, 6, v0
    s_nop 0
    v_readfirstlane_b32 s60, v125
    s_nop 1
    s_mul_i32 s63, s60, 4096
    s_mul_i32 s64, s60, 4096
    s_mul_i32 s65, s60, 32
    s_add_u32 s65, s65, 0
    v_lshrrev_b32 v125, 3, v124
    v_add_u32 v125, s65, v125
    v_lshrrev_b32 v126, 1, v125
    v_and_b32 v126, 7, v126
    v_and_b32 v100, 7, v124
    v_xor_b32 v126, v100, v126
    v_lshlrev_b32 v126, 4, v126
    v_add_u32 v125, s61, v125
    s_mov_b32 s66, 1280
    v_mul_lo_u32 v125, v125, s66
    v_add_u32 v100, v125, v126
    s_mul_i32 s65, s60, 32
    s_add_u32 s65, s65, 8
    v_lshrrev_b32 v125, 3, v124
    v_add_u32 v125, s65, v125
    v_lshrrev_b32 v126, 1, v125
    v_and_b32 v126, 7, v126
    v_and_b32 v101, 7, v124
    v_xor_b32 v126, v101, v126
    v_lshlrev_b32 v126, 4, v126
    v_add_u32 v125, s61, v125
    s_mov_b32 s66, 1280
    v_mul_lo_u32 v125, v125, s66
    v_add_u32 v101, v125, v126
    s_mul_i32 s65, s60, 32
    s_add_u32 s65, s65, 16
    v_lshrrev_b32 v125, 3, v124
    v_add_u32 v125, s65, v125
    v_lshrrev_b32 v126, 1, v125
    v_and_b32 v126, 7, v126
    v_and_b32 v102, 7, v124
    v_xor_b32 v126, v102, v126
    v_lshlrev_b32 v126, 4, v126
    v_add_u32 v125, s61, v125
    s_mov_b32 s66, 1280
    v_mul_lo_u32 v125, v125, s66
    v_add_u32 v102, v125, v126
    s_mul_i32 s65, s60, 32
    s_add_u32 s65, s65, 24
    v_lshrrev_b32 v125, 3, v124
    v_add_u32 v125, s65, v125
    v_lshrrev_b32 v126, 1, v125
    v_and_b32 v126, 7, v126
    v_and_b32 v103, 7, v124
    v_xor_b32 v126, v103, v126
    v_lshlrev_b32 v126, 4, v126
    v_add_u32 v125, s61, v125
    s_mov_b32 s66, 1280
    v_mul_lo_u32 v125, v125, s66
    v_add_u32 v103, v125, v126
    s_mul_i32 s65, s60, 32
    s_add_u32 s65, s65, 0
    v_lshrrev_b32 v125, 3, v124
    v_add_u32 v125, s65, v125
    v_lshrrev_b32 v126, 1, v125
    v_and_b32 v126, 7, v126
    v_and_b32 v104, 7, v124
    v_xor_b32 v126, v104, v126
    v_lshlrev_b32 v126, 4, v126
    v_add_u32 v125, s62, v125
    s_mov_b32 s66, 1280
    v_mul_lo_u32 v125, v125, s66
    v_add_u32 v104, v125, v126
    s_mul_i32 s65, s60, 32
    s_add_u32 s65, s65, 8
    v_lshrrev_b32 v125, 3, v124
    v_add_u32 v125, s65, v125
    v_lshrrev_b32 v126, 1, v125
    v_and_b32 v126, 7, v126
    v_and_b32 v105, 7, v124
    v_xor_b32 v126, v105, v126
    v_lshlrev_b32 v126, 4, v126
    v_add_u32 v125, s62, v125
    s_mov_b32 s66, 1280
    v_mul_lo_u32 v125, v125, s66
    v_add_u32 v105, v125, v126
    s_mul_i32 s65, s60, 32
    s_add_u32 s65, s65, 16
    v_lshrrev_b32 v125, 3, v124
    v_add_u32 v125, s65, v125
    v_lshrrev_b32 v126, 1, v125
    v_and_b32 v126, 7, v126
    v_and_b32 v106, 7, v124
    v_xor_b32 v126, v106, v126
    v_lshlrev_b32 v126, 4, v126
    v_add_u32 v125, s62, v125
    s_mov_b32 s66, 1280
    v_mul_lo_u32 v125, v125, s66
    v_add_u32 v106, v125, v126
    s_mul_i32 s65, s60, 32
    s_add_u32 s65, s65, 24
    v_lshrrev_b32 v125, 3, v124
    v_add_u32 v125, s65, v125
    v_lshrrev_b32 v126, 1, v125
    v_and_b32 v126, 7, v126
    v_and_b32 v107, 7, v124
    v_xor_b32 v126, v107, v126
    v_lshlrev_b32 v126, 4, v126
    v_add_u32 v125, s62, v125
    s_mov_b32 s66, 1280
    v_mul_lo_u32 v125, v125, s66
    v_add_u32 v107, v125, v126
    s_and_b32 s67, s60, 1
    s_lshr_b32 s68, s60, 1
    v_lshrrev_b32 v125, 5, v124
    v_add_u32 v125, 0, v125
    v_lshrrev_b32 v126, 1, v124
    v_and_b32 v126, 7, v126
    v_xor_b32 v125, v125, v126
    v_lshlrev_b32 v125, 4, v125
    v_and_b32 v126, 31, v124
    v_lshl_add_u32 v125, v126, 7, v125
    s_mul_i32 s65, s67, 8192
    v_add_u32 v108, s65, v125
    v_add_u32 v120, 0x10000, v108
    s_mul_i32 s65, s68, 8192
    v_add_u32 v112, s65, v125
    v_add_u32 v116, 0x10000, v112
    v_lshrrev_b32 v125, 5, v124
    v_add_u32 v125, 2, v125
    v_lshrrev_b32 v126, 1, v124
    v_and_b32 v126, 7, v126
    v_xor_b32 v125, v125, v126
    v_lshlrev_b32 v125, 4, v125
    v_and_b32 v126, 31, v124
    v_lshl_add_u32 v125, v126, 7, v125
    s_mul_i32 s65, s67, 8192
    v_add_u32 v109, s65, v125
    v_add_u32 v121, 0x10000, v109
    s_mul_i32 s65, s68, 8192
    v_add_u32 v113, s65, v125
    v_add_u32 v117, 0x10000, v113
    v_lshrrev_b32 v125, 5, v124
    v_add_u32 v125, 4, v125
    v_lshrrev_b32 v126, 1, v124
    v_and_b32 v126, 7, v126
    v_xor_b32 v125, v125, v126
    v_lshlrev_b32 v125, 4, v125
    v_and_b32 v126, 31, v124
    v_lshl_add_u32 v125, v126, 7, v125
    s_mul_i32 s65, s67, 8192
    v_add_u32 v110, s65, v125
    v_add_u32 v122, 0x10000, v110
    s_mul_i32 s65, s68, 8192
    v_add_u32 v114, s65, v125
    v_add_u32 v118, 0x10000, v114
    v_lshrrev_b32 v125, 5, v124
    v_add_u32 v125, 6, v125
    v_lshrrev_b32 v126, 1, v124
    v_and_b32 v126, 7, v126
    v_xor_b32 v125, v125, v126
    v_lshlrev_b32 v125, 4, v125
    v_and_b32 v126, 31, v124
    v_lshl_add_u32 v125, v126, 7, v125
    s_mul_i32 s65, s67, 8192
    v_add_u32 v111, s65, v125
    v_add_u32 v123, 0x10000, v111
    s_mul_i32 s65, s68, 8192
    v_add_u32 v115, s65, v125
    v_add_u32 v119, 0x10000, v115
    v_mov_b32 v4, 0
    v_mov_b32 v5, 0
    v_mov_b32 v6, 0
    v_mov_b32 v7, 0
    v_mov_b32 v8, 0
    v_mov_b32 v9, 0
    v_mov_b32 v10, 0
    v_mov_b32 v11, 0
    v_mov_b32 v12, 0
    v_mov_b32 v13, 0
    v_mov_b32 v14, 0
    v_mov_b32 v15, 0
    v_mov_b32 v16, 0
    v_mov_b32 v17, 0
    v_mov_b32 v18, 0
    v_mov_b32 v19, 0
    v_mov_b32 v20, 0
    v_mov_b32 v21, 0
    v_mov_b32 v22, 0
    v_mov_b32 v23, 0
    v_mov_b32 v24, 0
    v_mov_b32 v25, 0
    v_mov_b32 v26, 0
    v_mov_b32 v27, 0
    v_mov_b32 v28, 0
    v_mov_b32 v29, 0
    v_mov_b32 v30, 0
    v_mov_b32 v31, 0
    v_mov_b32 v32, 0
    v_mov_b32 v33, 0
    v_mov_b32 v34, 0
    v_mov_b32 v35, 0
    v_mov_b32 v36, 0
    v_mov_b32 v37, 0
    v_mov_b32 v38, 0
    v_mov_b32 v39, 0
    v_mov_b32 v40, 0
    v_mov_b32 v41, 0
    v_mov_b32 v42, 0
    v_mov_b32 v43, 0
    v_mov_b32 v44, 0
    v_mov_b32 v45, 0
    v_mov_b32 v46, 0
    v_mov_b32 v47, 0
    v_mov_b32 v48, 0
    v_mov_b32 v49, 0
    v_mov_b32 v50, 0
    v_mov_b32 v51, 0
    v_mov_b32 v52, 0
    v_mov_b32 v53, 0
    v_mov_b32 v54, 0
    v_mov_b32 v55, 0
    v_mov_b32 v56, 0
    v_mov_b32 v57, 0
    v_mov_b32 v58, 0
    v_mov_b32 v59, 0
    v_mov_b32 v60, 0
    v_mov_b32 v61, 0
    v_mov_b32 v62, 0
    v_mov_b32 v63, 0
    v_mov_b32 v64, 0
    v_mov_b32 v65, 0
    v_mov_b32 v66, 0
    v_mov_b32 v67, 0
    s_mov_b32 s69, 0
    s_add_u32 m0, s63, 1024
    buffer_load_dwordx4 v100, s[40:43], s69 offen lds
    s_add_u32 m0, s63, 2048
    buffer_load_dwordx4 v101, s[40:43], s69 offen lds
    s_add_u32 m0, s63, 3072
    buffer_load_dwordx4 v102, s[40:43], s69 offen lds
    s_add_u32 m0, s63, 4096
    buffer_load_dwordx4 v103, s[40:43], s69 offen lds
    s_add_u32 m0, s64, 17408
    buffer_load_dwordx4 v104, s[44:47], s69 offen lds
    s_add_u32 m0, s64, 18432
    buffer_load_dwordx4 v105, s[44:47], s69 offen lds
    s_add_u32 m0, s64, 19456
    buffer_load_dwordx4 v106, s[44:47], s69 offen lds
    s_add_u32 m0, s64, 20480
    buffer_load_dwordx4 v107, s[44:47], s69 offen lds
    s_mov_b32 s69, 128
    s_add_u32 m0, s63, 33792
    buffer_load_dwordx4 v100, s[40:43], s69 offen lds
    s_add_u32 m0, s63, 34816
    buffer_load_dwordx4 v101, s[40:43], s69 offen lds
    s_add_u32 m0, s63, 35840
    buffer_load_dwordx4 v102, s[40:43], s69 offen lds
    s_add_u32 m0, s63, 36864
    buffer_load_dwordx4 v103, s[40:43], s69 offen lds
    s_add_u32 m0, s64, 50176
    buffer_load_dwordx4 v104, s[44:47], s69 offen lds
    s_add_u32 m0, s64, 51200
    buffer_load_dwordx4 v105, s[44:47], s69 offen lds
    s_add_u32 m0, s64, 52224
    buffer_load_dwordx4 v106, s[44:47], s69 offen lds
    s_add_u32 m0, s64, 53248
    buffer_load_dwordx4 v107, s[44:47], s69 offen lds
    s_add_u32 s72, s36, 8044544
    s_addc_u32 s73, s37, 0
    s_and_b32 s73, s73, 0xffff
    s_mov_b32 s74, 163840
    s_mov_b32 s75, 0x00020000
    v_cmp_gt_u32 vcc, 128, v0
    s_and_saveexec_b64 s[76:77], vcc
    s_cbranch_execz .st_19
    v_add_u32 v88, s61, v0
    v_mul_u32_u24 v88, 80, v88
    buffer_load_dwordx4 v[68:71], v88, s[72:75], 0 offen offset:0
    buffer_load_dwordx4 v[72:75], v88, s[72:75], 0 offen offset:16
    buffer_load_dwordx4 v[76:79], v88, s[72:75], 0 offen offset:32
    buffer_load_dwordx4 v[80:83], v88, s[72:75], 0 offen offset:48
    buffer_load_dwordx4 v[84:87], v88, s[72:75], 0 offen offset:64
    s_waitcnt vmcnt(0)
    v_add_f32 v88, v68, v70
    v_add_f32 v89, v69, v71
    v_add_f32 v88, v88, v72
    v_add_f32 v89, v89, v73
    v_add_f32 v88, v88, v74
    v_add_f32 v89, v89, v75
    v_add_f32 v88, v88, v76
    v_add_f32 v89, v89, v77
    v_add_f32 v88, v88, v78
    v_add_f32 v89, v89, v79
    v_add_f32 v88, v88, v80
    v_add_f32 v89, v89, v81
    v_add_f32 v88, v88, v82
    v_add_f32 v89, v89, v83
    v_add_f32 v88, v88, v84
    v_add_f32 v89, v89, v85
    v_add_f32 v88, v88, v86
    v_add_f32 v89, v89, v87
    v_mul_f32 v88, 0x3acccccd, v88
    v_mul_f32 v89, 0x3acccccd, v89
    v_fma_f32 v89, -v88, v88, v89
    v_max_f32 v89, 0, v89
    v_cvt_pk_bf16_f32 v90, v88, v89
    v_lshlrev_b32 v88, 16, v90
    v_and_b32 v89, 0xffff0000, v90
    v_add_f32 v89, 0x3727c5ac, v89
    v_cvt_pk_bf16_f32 v90, v89, v89
    v_lshlrev_b32 v89, 16, v90
    v_sqrt_f32 v89, v89
    s_nop 0
    v_cvt_pk_bf16_f32 v90, v89, v89
    v_lshlrev_b32 v89, 16, v90
    v_rcp_f32 v89, v89
    v_lshlrev_b32 v90, 3, v0
    s_nop 0
    ds_write_b64 v90, v[88:89] offset:0
.st_19:
    s_or_b64 exec, exec, s[76:77]
    s_add_u32 s48, s36, 7700480
    s_addc_u32 s49, s37, 0
    s_and_b32 s49, s49, 0xffff
    s_mov_b32 s50, 7680
    s_mov_b32 s51, 0x00020000
    s_add_u32 s56, s36, 8372224
    s_addc_u32 s57, s37, 0
    s_and_b32 s57, s57, 0xffff
    s_mov_b32 s58, 2621440
    s_mov_b32 s59, 0x00020000
    v_lshrrev_b32 v160, 5, v124
    v_lshlrev_b32 v160, 2, v160
    s_lshl_b32 s65, s68, 6
    v_add_u32 v160, s65, v160
    v_lshlrev_b32 v161, 2, v160
    s_lshl_b32 s65, s62, 2
    buffer_load_dwordx4 v[128:131], v161, s[48:51], s65 offen offset:0
    buffer_load_dwordx4 v[132:135], v161, s[48:51], s65 offen offset:32
    buffer_load_dwordx4 v[136:139], v161, s[48:51], s65 offen offset:64
    buffer_load_dwordx4 v[140:143], v161, s[48:51], s65 offen offset:96
    buffer_load_dwordx4 v[144:147], v161, s[48:51], s65 offen offset:128
    buffer_load_dwordx4 v[148:151], v161, s[48:51], s65 offen offset:160
    buffer_load_dwordx4 v[152:155], v161, s[48:51], s65 offen offset:192
    buffer_load_dwordx4 v[156:159], v161, s[48:51], s65 offen offset:224
    s_waitcnt vmcnt(21)
    s_barrier
    s_mov_b32 s69, 256
    s_add_u32 m0, s63, 66560
    buffer_load_dwordx4 v100, s[40:43], s69 offen lds
    s_add_u32 m0, s63, 67584
    buffer_load_dwordx4 v101, s[40:43], s69 offen lds
    s_add_u32 m0, s63, 68608
    buffer_load_dwordx4 v102, s[40:43], s69 offen lds
    s_add_u32 m0, s63, 69632
    buffer_load_dwordx4 v103, s[40:43], s69 offen lds
    s_add_u32 m0, s64, 82944
    buffer_load_dwordx4 v104, s[44:47], s69 offen lds
    s_add_u32 m0, s64, 83968
    buffer_load_dwordx4 v105, s[44:47], s69 offen lds
    s_add_u32 m0, s64, 84992
    buffer_load_dwordx4 v106, s[44:47], s69 offen lds
    s_add_u32 m0, s64, 86016
    buffer_load_dwordx4 v107, s[44:47], s69 offen lds
    ds_read_b128 v[68:71], v108 offset:1024
    ds_read_b128 v[72:75], v108 offset:5120
    ds_read_b128 v[84:87], v112 offset:17408
    ds_read_b128 v[88:91], v112 offset:21504
    ds_read_b128 v[76:79], v109 offset:1024
    ds_read_b128 v[80:83], v109 offset:5120
    ds_read_b128 v[92:95], v113 offset:17408
    ds_read_b128 v[96:99], v113 offset:21504
    s_waitcnt lgkmcnt(4)
    v_mfma_f32_32x32x16_bf16 v[4:19], v[84:87], v[68:71], v[4:19]
    v_mfma_f32_32x32x16_bf16 v[20:35], v[88:91], v[68:71], v[20:35]
    v_mfma_f32_32x32x16_bf16 v[36:51], v[84:87], v[72:75], v[36:51]
    v_mfma_f32_32x32x16_bf16 v[52:67], v[88:91], v[72:75], v[52:67]
    ds_read_b128 v[68:71], v110 offset:1024
    ds_read_b128 v[72:75], v110 offset:5120
    ds_read_b128 v[84:87], v114 offset:17408
    ds_read_b128 v[88:91], v114 offset:21504
    s_waitcnt lgkmcnt(4)
    v_mfma_f32_32x32x16_bf16 v[4:19], v[92:95], v[76:79], v[4:19]
    v_mfma_f32_32x32x16_bf16 v[20:35], v[96:99], v[76:79], v[20:35]
    v_mfma_f32_32x32x16_bf16 v[36:51], v[92:95], v[80:83], v[36:51]
    v_mfma_f32_32x32x16_bf16 v[52:67], v[96:99], v[80:83], v[52:67]
    ds_read_b128 v[76:79], v111 offset:1024
    ds_read_b128 v[80:83], v111 offset:5120
    ds_read_b128 v[92:95], v115 offset:17408
    ds_read_b128 v[96:99], v115 offset:21504
    s_waitcnt lgkmcnt(4)
    v_mfma_f32_32x32x16_bf16 v[4:19], v[84:87], v[68:71], v[4:19]
    v_mfma_f32_32x32x16_bf16 v[20:35], v[88:91], v[68:71], v[20:35]
    v_mfma_f32_32x32x16_bf16 v[36:51], v[84:87], v[72:75], v[36:51]
    v_mfma_f32_32x32x16_bf16 v[52:67], v[88:91], v[72:75], v[52:67]
    s_waitcnt vmcnt(21) lgkmcnt(0)
    s_barrier
    s_mov_b32 s69, 384
    s_add_u32 m0, s63, 1024
    buffer_load_dwordx4 v100, s[40:43], s69 offen lds
    s_add_u32 m0, s63, 2048
    buffer_load_dwordx4 v101, s[40:43], s69 offen lds
    s_add_u32 m0, s63, 3072
    buffer_load_dwordx4 v102, s[40:43], s69 offen lds
    s_add_u32 m0, s63, 4096
    buffer_load_dwordx4 v103, s[40:43], s69 offen lds
    s_add_u32 m0, s64, 17408
    buffer_load_dwordx4 v104, s[44:47], s69 offen lds
    s_add_u32 m0, s64, 18432
    buffer_load_dwordx4 v105, s[44:47], s69 offen lds
    s_add_u32 m0, s64, 19456
    buffer_load_dwordx4 v106, s[44:47], s69 offen lds
    s_add_u32 m0, s64, 20480
    buffer_load_dwordx4 v107, s[44:47], s69 offen lds
    ds_read_b128 v[68:71], v108 offset:33792
    ds_read_b128 v[72:75], v108 offset:37888
    ds_read_b128 v[84:87], v112 offset:50176
    ds_read_b128 v[88:91], v112 offset:54272
    v_mfma_f32_32x32x16_bf16 v[4:19], v[92:95], v[76:79], v[4:19]
    v_mfma_f32_32x32x16_bf16 v[20:35], v[96:99], v[76:79], v[20:35]
    v_mfma_f32_32x32x16_bf16 v[36:51], v[92:95], v[80:83], v[36:51]
    v_mfma_f32_32x32x16_bf16 v[52:67], v[96:99], v[80:83], v[52:67]
    ds_read_b128 v[76:79], v109 offset:33792
    ds_read_b128 v[80:83], v109 offset:37888
    ds_read_b128 v[92:95], v113 offset:50176
    ds_read_b128 v[96:99], v113 offset:54272
    s_waitcnt lgkmcnt(4)
    v_mfma_f32_32x32x16_bf16 v[4:19], v[84:87], v[68:71], v[4:19]
    v_mfma_f32_32x32x16_bf16 v[20:35], v[88:91], v[68:71], v[20:35]
    v_mfma_f32_32x32x16_bf16 v[36:51], v[84:87], v[72:75], v[36:51]
    v_mfma_f32_32x32x16_bf16 v[52:67], v[88:91], v[72:75], v[52:67]
    ds_read_b128 v[68:71], v110 offset:33792
    ds_read_b128 v[72:75], v110 offset:37888
    ds_read_b128 v[84:87], v114 offset:50176
    ds_read_b128 v[88:91], v114 offset:54272
    s_waitcnt lgkmcnt(4)
    v_mfma_f32_32x32x16_bf16 v[4:19], v[92:95], v[76:79], v[4:19]
    v_mfma_f32_32x32x16_bf16 v[20:35], v[96:99], v[76:79], v[20:35]
    v_mfma_f32_32x32x16_bf16 v[36:51], v[92:95], v[80:83], v[36:51]
    v_mfma_f32_32x32x16_bf16 v[52:67], v[96:99], v[80:83], v[52:67]
    ds_read_b128 v[76:79], v111 offset:33792
    ds_read_b128 v[80:83], v111 offset:37888
    ds_read_b128 v[92:95], v115 offset:50176
    ds_read_b128 v[96:99], v115 offset:54272
    s_waitcnt lgkmcnt(4)
    v_mfma_f32_32x32x16_bf16 v[4:19], v[84:87], v[68:71], v[4:19]
    v_mfma_f32_32x32x16_bf16 v[20:35], v[88:91], v[68:71], v[20:35]
    v_mfma_f32_32x32x16_bf16 v[36:51], v[84:87], v[72:75], v[36:51]
    v_mfma_f32_32x32x16_bf16 v[52:67], v[88:91], v[72:75], v[52:67]
    s_waitcnt vmcnt(8) lgkmcnt(0)
    s_barrier
    s_mov_b32 s69, 512
    s_add_u32 m0, s63, 33792
    buffer_load_dwordx4 v100, s[40:43], s69 offen lds
    s_add_u32 m0, s63, 34816
    buffer_load_dwordx4 v101, s[40:43], s69 offen lds
    s_add_u32 m0, s63, 35840
    buffer_load_dwordx4 v102, s[40:43], s69 offen lds
    s_add_u32 m0, s63, 36864
    buffer_load_dwordx4 v103, s[40:43], s69 offen lds
    s_add_u32 m0, s64, 50176
    buffer_load_dwordx4 v104, s[44:47], s69 offen lds
    s_add_u32 m0, s64, 51200
    buffer_load_dwordx4 v105, s[44:47], s69 offen lds
    s_add_u32 m0, s64, 52224
    buffer_load_dwordx4 v106, s[44:47], s69 offen lds
    s_add_u32 m0, s64, 53248
    buffer_load_dwordx4 v107, s[44:47], s69 offen lds
    ds_read_b128 v[68:71], v120 offset:1024
    ds_read_b128 v[72:75], v120 offset:5120
    ds_read_b128 v[84:87], v116 offset:17408
    ds_read_b128 v[88:91], v116 offset:21504
    v_mfma_f32_32x32x16_bf16 v[4:19], v[92:95], v[76:79], v[4:19]
    v_mfma_f32_32x32x16_bf16 v[20:35], v[96:99], v[76:79], v[20:35]
    v_mfma_f32_32x32x16_bf16 v[36:51], v[92:95], v[80:83], v[36:51]
    v_mfma_f32_32x32x16_bf16 v[52:67], v[96:99], v[80:83], v[52:67]
    ds_read_b128 v[76:79], v121 offset:1024
    ds_read_b128 v[80:83], v121 offset:5120
    ds_read_b128 v[92:95], v117 offset:17408
    ds_read_b128 v[96:99], v117 offset:21504
    s_waitcnt lgkmcnt(4)
    v_mfma_f32_32x32x16_bf16 v[4:19], v[84:87], v[68:71], v[4:19]
    v_mfma_f32_32x32x16_bf16 v[20:35], v[88:91], v[68:71], v[20:35]
    v_mfma_f32_32x32x16_bf16 v[36:51], v[84:87], v[72:75], v[36:51]
    v_mfma_f32_32x32x16_bf16 v[52:67], v[88:91], v[72:75], v[52:67]
    ds_read_b128 v[68:71], v122 offset:1024
    ds_read_b128 v[72:75], v122 offset:5120
    ds_read_b128 v[84:87], v118 offset:17408
    ds_read_b128 v[88:91], v118 offset:21504
    s_waitcnt lgkmcnt(4)
    v_mfma_f32_32x32x16_bf16 v[4:19], v[92:95], v[76:79], v[4:19]
    v_mfma_f32_32x32x16_bf16 v[20:35], v[96:99], v[76:79], v[20:35]
    v_mfma_f32_32x32x16_bf16 v[36:51], v[92:95], v[80:83], v[36:51]
    v_mfma_f32_32x32x16_bf16 v[52:67], v[96:99], v[80:83], v[52:67]
    ds_read_b128 v[76:79], v123 offset:1024
    ds_read_b128 v[80:83], v123 offset:5120
    ds_read_b128 v[92:95], v119 offset:17408
    ds_read_b128 v[96:99], v119 offset:21504
    s_waitcnt lgkmcnt(4)
    v_mfma_f32_32x32x16_bf16 v[4:19], v[84:87], v[68:71], v[4:19]
    v_mfma_f32_32x32x16_bf16 v[20:35], v[88:91], v[68:71], v[20:35]
    v_mfma_f32_32x32x16_bf16 v[36:51], v[84:87], v[72:75], v[36:51]
    v_mfma_f32_32x32x16_bf16 v[52:67], v[88:91], v[72:75], v[52:67]
    s_waitcnt vmcnt(8) lgkmcnt(0)
    s_barrier
    s_mov_b32 s69, 640
    s_add_u32 m0, s63, 66560
    buffer_load_dwordx4 v100, s[40:43], s69 offen lds
    s_add_u32 m0, s63, 67584
    buffer_load_dwordx4 v101, s[40:43], s69 offen lds
    s_add_u32 m0, s63, 68608
    buffer_load_dwordx4 v102, s[40:43], s69 offen lds
    s_add_u32 m0, s63, 69632
    buffer_load_dwordx4 v103, s[40:43], s69 offen lds
    s_add_u32 m0, s64, 82944
    buffer_load_dwordx4 v104, s[44:47], s69 offen lds
    s_add_u32 m0, s64, 83968
    buffer_load_dwordx4 v105, s[44:47], s69 offen lds
    s_add_u32 m0, s64, 84992
    buffer_load_dwordx4 v106, s[44:47], s69 offen lds
    s_add_u32 m0, s64, 86016
    buffer_load_dwordx4 v107, s[44:47], s69 offen lds
    ds_read_b128 v[68:71], v108 offset:1024
    ds_read_b128 v[72:75], v108 offset:5120
    ds_read_b128 v[84:87], v112 offset:17408
    ds_read_b128 v[88:91], v112 offset:21504
    v_mfma_f32_32x32x16_bf16 v[4:19], v[92:95], v[76:79], v[4:19]
    v_mfma_f32_32x32x16_bf16 v[20:35], v[96:99], v[76:79], v[20:35]
    v_mfma_f32_32x32x16_bf16 v[36:51], v[92:95], v[80:83], v[36:51]
    v_mfma_f32_32x32x16_bf16 v[52:67], v[96:99], v[80:83], v[52:67]
    ds_read_b128 v[76:79], v109 offset:1024
    ds_read_b128 v[80:83], v109 offset:5120
    ds_read_b128 v[92:95], v113 offset:17408
    ds_read_b128 v[96:99], v113 offset:21504
    s_waitcnt lgkmcnt(4)
    v_mfma_f32_32x32x16_bf16 v[4:19], v[84:87], v[68:71], v[4:19]
    v_mfma_f32_32x32x16_bf16 v[20:35], v[88:91], v[68:71], v[20:35]
    v_mfma_f32_32x32x16_bf16 v[36:51], v[84:87], v[72:75], v[36:51]
    v_mfma_f32_32x32x16_bf16 v[52:67], v[88:91], v[72:75], v[52:67]
    ds_read_b128 v[68:71], v110 offset:1024
    ds_read_b128 v[72:75], v110 offset:5120
    ds_read_b128 v[84:87], v114 offset:17408
    ds_read_b128 v[88:91], v114 offset:21504
    s_waitcnt lgkmcnt(4)
    v_mfma_f32_32x32x16_bf16 v[4:19], v[92:95], v[76:79], v[4:19]
    v_mfma_f32_32x32x16_bf16 v[20:35], v[96:99], v[76:79], v[20:35]
    v_mfma_f32_32x32x16_bf16 v[36:51], v[92:95], v[80:83], v[36:51]
    v_mfma_f32_32x32x16_bf16 v[52:67], v[96:99], v[80:83], v[52:67]
    ds_read_b128 v[76:79], v111 offset:1024
    ds_read_b128 v[80:83], v111 offset:5120
    ds_read_b128 v[92:95], v115 offset:17408
    ds_read_b128 v[96:99], v115 offset:21504
    s_waitcnt lgkmcnt(4)
    v_mfma_f32_32x32x16_bf16 v[4:19], v[84:87], v[68:71], v[4:19]
    v_mfma_f32_32x32x16_bf16 v[20:35], v[88:91], v[68:71], v[20:35]
    v_mfma_f32_32x32x16_bf16 v[36:51], v[84:87], v[72:75], v[36:51]
    v_mfma_f32_32x32x16_bf16 v[52:67], v[88:91], v[72:75], v[52:67]
    s_waitcnt vmcnt(8) lgkmcnt(0)
    s_barrier
    s_mov_b32 s69, 768
    s_add_u32 m0, s63, 1024
    buffer_load_dwordx4 v100, s[40:43], s69 offen lds
    s_add_u32 m0, s63, 2048
    buffer_load_dwordx4 v101, s[40:43], s69 offen lds
    s_add_u32 m0, s63, 3072
    buffer_load_dwordx4 v102, s[40:43], s69 offen lds
    s_add_u32 m0, s63, 4096
    buffer_load_dwordx4 v103, s[40:43], s69 offen lds
    s_add_u32 m0, s64, 17408
    buffer_load_dwordx4 v104, s[44:47], s69 offen lds
    s_add_u32 m0, s64, 18432
    buffer_load_dwordx4 v105, s[44:47], s69 offen lds
    s_add_u32 m0, s64, 19456
    buffer_load_dwordx4 v106, s[44:47], s69 offen lds
    s_add_u32 m0, s64, 20480
    buffer_load_dwordx4 v107, s[44:47], s69 offen lds
    ds_read_b128 v[68:71], v108 offset:33792
    ds_read_b128 v[72:75], v108 offset:37888
    ds_read_b128 v[84:87], v112 offset:50176
    ds_read_b128 v[88:91], v112 offset:54272
    v_mfma_f32_32x32x16_bf16 v[4:19], v[92:95], v[76:79], v[4:19]
    v_mfma_f32_32x32x16_bf16 v[20:35], v[96:99], v[76:79], v[20:35]
    v_mfma_f32_32x32x16_bf16 v[36:51], v[92:95], v[80:83], v[36:51]
    v_mfma_f32_32x32x16_bf16 v[52:67], v[96:99], v[80:83], v[52:67]
    ds_read_b128 v[76:79], v109 offset:33792
    ds_read_b128 v[80:83], v109 offset:37888
    ds_read_b128 v[92:95], v113 offset:50176
    ds_read_b128 v[96:99], v113 offset:54272
    s_waitcnt lgkmcnt(4)
    v_mfma_f32_32x32x16_bf16 v[4:19], v[84:87], v[68:71], v[4:19]
    v_mfma_f32_32x32x16_bf16 v[20:35], v[88:91], v[68:71], v[20:35]
    v_mfma_f32_32x32x16_bf16 v[36:51], v[84:87], v[72:75], v[36:51]
    v_mfma_f32_32x32x16_bf16 v[52:67], v[88:91], v[72:75], v[52:67]
    ds_read_b128 v[68:71], v110 offset:33792
    ds_read_b128 v[72:75], v110 offset:37888
    ds_read_b128 v[84:87], v114 offset:50176
    ds_read_b128 v[88:91], v114 offset:54272
    s_waitcnt lgkmcnt(4)
    v_mfma_f32_32x32x16_bf16 v[4:19], v[92:95], v[76:79], v[4:19]
    v_mfma_f32_32x32x16_bf16 v[20:35], v[96:99], v[76:79], v[20:35]
    v_mfma_f32_32x32x16_bf16 v[36:51], v[92:95], v[80:83], v[36:51]
    v_mfma_f32_32x32x16_bf16 v[52:67], v[96:99], v[80:83], v[52:67]
    ds_read_b128 v[76:79], v111 offset:33792
    ds_read_b128 v[80:83], v111 offset:37888
    ds_read_b128 v[92:95], v115 offset:50176
    ds_read_b128 v[96:99], v115 offset:54272
    s_waitcnt lgkmcnt(4)
    v_mfma_f32_32x32x16_bf16 v[4:19], v[84:87], v[68:71], v[4:19]
    v_mfma_f32_32x32x16_bf16 v[20:35], v[88:91], v[68:71], v[20:35]
    v_mfma_f32_32x32x16_bf16 v[36:51], v[84:87], v[72:75], v[36:51]
    v_mfma_f32_32x32x16_bf16 v[52:67], v[88:91], v[72:75], v[52:67]
    s_waitcnt vmcnt(8) lgkmcnt(0)
    s_barrier
    s_mov_b32 s69, 896
    s_add_u32 m0, s63, 33792
    buffer_load_dwordx4 v100, s[40:43], s69 offen lds
    s_add_u32 m0, s63, 34816
    buffer_load_dwordx4 v101, s[40:43], s69 offen lds
    s_add_u32 m0, s63, 35840
    buffer_load_dwordx4 v102, s[40:43], s69 offen lds
    s_add_u32 m0, s63, 36864
    buffer_load_dwordx4 v103, s[40:43], s69 offen lds
    s_add_u32 m0, s64, 50176
    buffer_load_dwordx4 v104, s[44:47], s69 offen lds
    s_add_u32 m0, s64, 51200
    buffer_load_dwordx4 v105, s[44:47], s69 offen lds
    s_add_u32 m0, s64, 52224
    buffer_load_dwordx4 v106, s[44:47], s69 offen lds
    s_add_u32 m0, s64, 53248
    buffer_load_dwordx4 v107, s[44:47], s69 offen lds
    ds_read_b128 v[68:71], v120 offset:1024
    ds_read_b128 v[72:75], v120 offset:5120
    ds_read_b128 v[84:87], v116 offset:17408
    ds_read_b128 v[88:91], v116 offset:21504
    v_mfma_f32_32x32x16_bf16 v[4:19], v[92:95], v[76:79], v[4:19]
    v_mfma_f32_32x32x16_bf16 v[20:35], v[96:99], v[76:79], v[20:35]
    v_mfma_f32_32x32x16_bf16 v[36:51], v[92:95], v[80:83], v[36:51]
    v_mfma_f32_32x32x16_bf16 v[52:67], v[96:99], v[80:83], v[52:67]
    ds_read_b128 v[76:79], v121 offset:1024
    ds_read_b128 v[80:83], v121 offset:5120
    ds_read_b128 v[92:95], v117 offset:17408
    ds_read_b128 v[96:99], v117 offset:21504
    s_waitcnt lgkmcnt(4)
    v_mfma_f32_32x32x16_bf16 v[4:19], v[84:87], v[68:71], v[4:19]
    v_mfma_f32_32x32x16_bf16 v[20:35], v[88:91], v[68:71], v[20:35]
    v_mfma_f32_32x32x16_bf16 v[36:51], v[84:87], v[72:75], v[36:51]
    v_mfma_f32_32x32x16_bf16 v[52:67], v[88:91], v[72:75], v[52:67]
    ds_read_b128 v[68:71], v122 offset:1024
    ds_read_b128 v[72:75], v122 offset:5120
    ds_read_b128 v[84:87], v118 offset:17408
    ds_read_b128 v[88:91], v118 offset:21504
    s_waitcnt lgkmcnt(4)
    v_mfma_f32_32x32x16_bf16 v[4:19], v[92:95], v[76:79], v[4:19]
    v_mfma_f32_32x32x16_bf16 v[20:35], v[96:99], v[76:79], v[20:35]
    v_mfma_f32_32x32x16_bf16 v[36:51], v[92:95], v[80:83], v[36:51]
    v_mfma_f32_32x32x16_bf16 v[52:67], v[96:99], v[80:83], v[52:67]
    ds_read_b128 v[76:79], v123 offset:1024
    ds_read_b128 v[80:83], v123 offset:5120
    ds_read_b128 v[92:95], v119 offset:17408
    ds_read_b128 v[96:99], v119 offset:21504
    s_waitcnt lgkmcnt(4)
    v_mfma_f32_32x32x16_bf16 v[4:19], v[84:87], v[68:71], v[4:19]
    v_mfma_f32_32x32x16_bf16 v[20:35], v[88:91], v[68:71], v[20:35]
    v_mfma_f32_32x32x16_bf16 v[36:51], v[84:87], v[72:75], v[36:51]
    v_mfma_f32_32x32x16_bf16 v[52:67], v[88:91], v[72:75], v[52:67]
    s_waitcnt vmcnt(8) lgkmcnt(0)
    s_barrier
    s_mov_b32 s69, 1024
    s_add_u32 m0, s63, 66560
    buffer_load_dwordx4 v100, s[40:43], s69 offen lds
    s_add_u32 m0, s63, 67584
    buffer_load_dwordx4 v101, s[40:43], s69 offen lds
    s_add_u32 m0, s63, 68608
    buffer_load_dwordx4 v102, s[40:43], s69 offen lds
    s_add_u32 m0, s63, 69632
    buffer_load_dwordx4 v103, s[40:43], s69 offen lds
    s_add_u32 m0, s64, 82944
    buffer_load_dwordx4 v104, s[44:47], s69 offen lds
    s_add_u32 m0, s64, 83968
    buffer_load_dwordx4 v105, s[44:47], s69 offen lds
    s_add_u32 m0, s64, 84992
    buffer_load_dwordx4 v106, s[44:47], s69 offen lds
    s_add_u32 m0, s64, 86016
    buffer_load_dwordx4 v107, s[44:47], s69 offen lds
    ds_read_b128 v[68:71], v108 offset:1024
    ds_read_b128 v[72:75], v108 offset:5120
    ds_read_b128 v[84:87], v112 offset:17408
    ds_read_b128 v[88:91], v112 offset:21504
    v_mfma_f32_32x32x16_bf16 v[4:19], v[92:95], v[76:79], v[4:19]
    v_mfma_f32_32x32x16_bf16 v[20:35], v[96:99], v[76:79], v[20:35]
    v_mfma_f32_32x32x16_bf16 v[36:51], v[92:95], v[80:83], v[36:51]
    v_mfma_f32_32x32x16_bf16 v[52:67], v[96:99], v[80:83], v[52:67]
    ds_read_b128 v[76:79], v109 offset:1024
    ds_read_b128 v[80:83], v109 offset:5120
    ds_read_b128 v[92:95], v113 offset:17408
    ds_read_b128 v[96:99], v113 offset:21504
    s_waitcnt lgkmcnt(4)
    v_mfma_f32_32x32x16_bf16 v[4:19], v[84:87], v[68:71], v[4:19]
    v_mfma_f32_32x32x16_bf16 v[20:35], v[88:91], v[68:71], v[20:35]
    v_mfma_f32_32x32x16_bf16 v[36:51], v[84:87], v[72:75], v[36:51]
    v_mfma_f32_32x32x16_bf16 v[52:67], v[88:91], v[72:75], v[52:67]
    ds_read_b128 v[68:71], v110 offset:1024
    ds_read_b128 v[72:75], v110 offset:5120
    ds_read_b128 v[84:87], v114 offset:17408
    ds_read_b128 v[88:91], v114 offset:21504
    s_waitcnt lgkmcnt(4)
    v_mfma_f32_32x32x16_bf16 v[4:19], v[92:95], v[76:79], v[4:19]
    v_mfma_f32_32x32x16_bf16 v[20:35], v[96:99], v[76:79], v[20:35]
    v_mfma_f32_32x32x16_bf16 v[36:51], v[92:95], v[80:83], v[36:51]
    v_mfma_f32_32x32x16_bf16 v[52:67], v[96:99], v[80:83], v[52:67]
    ds_read_b128 v[76:79], v111 offset:1024
    ds_read_b128 v[80:83], v111 offset:5120
    ds_read_b128 v[92:95], v115 offset:17408
    ds_read_b128 v[96:99], v115 offset:21504
    s_waitcnt lgkmcnt(4)
    v_mfma_f32_32x32x16_bf16 v[4:19], v[84:87], v[68:71], v[4:19]
    v_mfma_f32_32x32x16_bf16 v[20:35], v[88:91], v[68:71], v[20:35]
    v_mfma_f32_32x32x16_bf16 v[36:51], v[84:87], v[72:75], v[36:51]
    v_mfma_f32_32x32x16_bf16 v[52:67], v[88:91], v[72:75], v[52:67]
    s_waitcnt vmcnt(8) lgkmcnt(0)
    s_barrier
    s_mov_b32 s69, 1152
    s_add_u32 m0, s63, 1024
    buffer_load_dwordx4 v100, s[40:43], s69 offen lds
    s_add_u32 m0, s63, 2048
    buffer_load_dwordx4 v101, s[40:43], s69 offen lds
    s_add_u32 m0, s63, 3072
    buffer_load_dwordx4 v102, s[40:43], s69 offen lds
    s_add_u32 m0, s63, 4096
    buffer_load_dwordx4 v103, s[40:43], s69 offen lds
    s_add_u32 m0, s64, 17408
    buffer_load_dwordx4 v104, s[44:47], s69 offen lds
    s_add_u32 m0, s64, 18432
    buffer_load_dwordx4 v105, s[44:47], s69 offen lds
    s_add_u32 m0, s64, 19456
    buffer_load_dwordx4 v106, s[44:47], s69 offen lds
    s_add_u32 m0, s64, 20480
    buffer_load_dwordx4 v107, s[44:47], s69 offen lds
    ds_read_b128 v[68:71], v108 offset:33792
    ds_read_b128 v[72:75], v108 offset:37888
    ds_read_b128 v[84:87], v112 offset:50176
    ds_read_b128 v[88:91], v112 offset:54272
    v_mfma_f32_32x32x16_bf16 v[4:19], v[92:95], v[76:79], v[4:19]
    v_mfma_f32_32x32x16_bf16 v[20:35], v[96:99], v[76:79], v[20:35]
    v_mfma_f32_32x32x16_bf16 v[36:51], v[92:95], v[80:83], v[36:51]
    v_mfma_f32_32x32x16_bf16 v[52:67], v[96:99], v[80:83], v[52:67]
    ds_read_b128 v[76:79], v109 offset:33792
    ds_read_b128 v[80:83], v109 offset:37888
    ds_read_b128 v[92:95], v113 offset:50176
    ds_read_b128 v[96:99], v113 offset:54272
    s_waitcnt lgkmcnt(4)
    v_mfma_f32_32x32x16_bf16 v[4:19], v[84:87], v[68:71], v[4:19]
    v_mfma_f32_32x32x16_bf16 v[20:35], v[88:91], v[68:71], v[20:35]
    v_mfma_f32_32x32x16_bf16 v[36:51], v[84:87], v[72:75], v[36:51]
    v_mfma_f32_32x32x16_bf16 v[52:67], v[88:91], v[72:75], v[52:67]
    ds_read_b128 v[68:71], v110 offset:33792
    ds_read_b128 v[72:75], v110 offset:37888
    ds_read_b128 v[84:87], v114 offset:50176
    ds_read_b128 v[88:91], v114 offset:54272
    s_waitcnt lgkmcnt(4)
    v_mfma_f32_32x32x16_bf16 v[4:19], v[92:95], v[76:79], v[4:19]
    v_mfma_f32_32x32x16_bf16 v[20:35], v[96:99], v[76:79], v[20:35]
    v_mfma_f32_32x32x16_bf16 v[36:51], v[92:95], v[80:83], v[36:51]
    v_mfma_f32_32x32x16_bf16 v[52:67], v[96:99], v[80:83], v[52:67]
    ds_read_b128 v[76:79], v111 offset:33792
    ds_read_b128 v[80:83], v111 offset:37888
    ds_read_b128 v[92:95], v115 offset:50176
    ds_read_b128 v[96:99], v115 offset:54272
    s_waitcnt lgkmcnt(4)
    v_mfma_f32_32x32x16_bf16 v[4:19], v[84:87], v[68:71], v[4:19]
    v_mfma_f32_32x32x16_bf16 v[20:35], v[88:91], v[68:71], v[20:35]
    v_mfma_f32_32x32x16_bf16 v[36:51], v[84:87], v[72:75], v[36:51]
    v_mfma_f32_32x32x16_bf16 v[52:67], v[88:91], v[72:75], v[52:67]
    s_waitcnt vmcnt(8) lgkmcnt(0)
    s_barrier
    ds_read_b128 v[68:71], v120 offset:1024
    ds_read_b128 v[72:75], v120 offset:5120
    ds_read_b128 v[84:87], v116 offset:17408
    ds_read_b128 v[88:91], v116 offset:21504
    v_mfma_f32_32x32x16_bf16 v[4:19], v[92:95], v[76:79], v[4:19]
    v_mfma_f32_32x32x16_bf16 v[20:35], v[96:99], v[76:79], v[20:35]
    v_mfma_f32_32x32x16_bf16 v[36:51], v[92:95], v[80:83], v[36:51]
    v_mfma_f32_32x32x16_bf16 v[52:67], v[96:99], v[80:83], v[52:67]
    ds_read_b128 v[76:79], v121 offset:1024
    ds_read_b128 v[80:83], v121 offset:5120
    ds_read_b128 v[92:95], v117 offset:17408
    ds_read_b128 v[96:99], v117 offset:21504
    s_waitcnt lgkmcnt(4)
    v_mfma_f32_32x32x16_bf16 v[4:19], v[84:87], v[68:71], v[4:19]
    v_mfma_f32_32x32x16_bf16 v[20:35], v[88:91], v[68:71], v[20:35]
    v_mfma_f32_32x32x16_bf16 v[36:51], v[84:87], v[72:75], v[36:51]
    v_mfma_f32_32x32x16_bf16 v[52:67], v[88:91], v[72:75], v[52:67]
    ds_read_b128 v[68:71], v122 offset:1024
    ds_read_b128 v[72:75], v122 offset:5120
    ds_read_b128 v[84:87], v118 offset:17408
    ds_read_b128 v[88:91], v118 offset:21504
    s_waitcnt lgkmcnt(4)
    v_mfma_f32_32x32x16_bf16 v[4:19], v[92:95], v[76:79], v[4:19]
    v_mfma_f32_32x32x16_bf16 v[20:35], v[96:99], v[76:79], v[20:35]
    v_mfma_f32_32x32x16_bf16 v[36:51], v[92:95], v[80:83], v[36:51]
    v_mfma_f32_32x32x16_bf16 v[52:67], v[96:99], v[80:83], v[52:67]
    ds_read_b128 v[76:79], v123 offset:1024
    ds_read_b128 v[80:83], v123 offset:5120
    ds_read_b128 v[92:95], v119 offset:17408
    ds_read_b128 v[96:99], v119 offset:21504
    s_waitcnt lgkmcnt(4)
    v_mfma_f32_32x32x16_bf16 v[4:19], v[84:87], v[68:71], v[4:19]
    v_mfma_f32_32x32x16_bf16 v[20:35], v[88:91], v[68:71], v[20:35]
    v_mfma_f32_32x32x16_bf16 v[36:51], v[84:87], v[72:75], v[36:51]
    v_mfma_f32_32x32x16_bf16 v[52:67], v[88:91], v[72:75], v[52:67]
    s_waitcnt vmcnt(0) lgkmcnt(0)
    s_barrier
    ds_read_b128 v[68:71], v108 offset:1024
    ds_read_b128 v[72:75], v108 offset:5120
    ds_read_b128 v[84:87], v112 offset:17408
    ds_read_b128 v[88:91], v112 offset:21504
    v_mfma_f32_32x32x16_bf16 v[4:19], v[92:95], v[76:79], v[4:19]
    v_mfma_f32_32x32x16_bf16 v[20:35], v[96:99], v[76:79], v[20:35]
    v_mfma_f32_32x32x16_bf16 v[36:51], v[92:95], v[80:83], v[36:51]
    v_mfma_f32_32x32x16_bf16 v[52:67], v[96:99], v[80:83], v[52:67]
    ds_read_b128 v[76:79], v109 offset:1024
    ds_read_b128 v[80:83], v109 offset:5120
    ds_read_b128 v[92:95], v113 offset:17408
    ds_read_b128 v[96:99], v113 offset:21504
    s_waitcnt lgkmcnt(4)
    v_mfma_f32_32x32x16_bf16 v[4:19], v[84:87], v[68:71], v[4:19]
    v_mfma_f32_32x32x16_bf16 v[20:35], v[88:91], v[68:71], v[20:35]
    v_mfma_f32_32x32x16_bf16 v[36:51], v[84:87], v[72:75], v[36:51]
    v_mfma_f32_32x32x16_bf16 v[52:67], v[88:91], v[72:75], v[52:67]
    ds_read_b128 v[68:71], v110 offset:1024
    ds_read_b128 v[72:75], v110 offset:5120
    ds_read_b128 v[84:87], v114 offset:17408
    ds_read_b128 v[88:91], v114 offset:21504
    s_waitcnt lgkmcnt(4)
    v_mfma_f32_32x32x16_bf16 v[4:19], v[92:95], v[76:79], v[4:19]
    v_mfma_f32_32x32x16_bf16 v[20:35], v[96:99], v[76:79], v[20:35]
    v_mfma_f32_32x32x16_bf16 v[36:51], v[92:95], v[80:83], v[36:51]
    v_mfma_f32_32x32x16_bf16 v[52:67], v[96:99], v[80:83], v[52:67]
    ds_read_b128 v[76:79], v111 offset:1024
    ds_read_b128 v[80:83], v111 offset:5120
    ds_read_b128 v[92:95], v115 offset:17408
    ds_read_b128 v[96:99], v115 offset:21504
    s_waitcnt lgkmcnt(4)
    v_mfma_f32_32x32x16_bf16 v[4:19], v[84:87], v[68:71], v[4:19]
    v_mfma_f32_32x32x16_bf16 v[20:35], v[88:91], v[68:71], v[20:35]
    v_mfma_f32_32x32x16_bf16 v[36:51], v[84:87], v[72:75], v[36:51]
    v_mfma_f32_32x32x16_bf16 v[52:67], v[88:91], v[72:75], v[52:67]
    s_waitcnt lgkmcnt(0)
    v_mfma_f32_32x32x16_bf16 v[4:19], v[92:95], v[76:79], v[4:19]
    v_mfma_f32_32x32x16_bf16 v[20:35], v[96:99], v[76:79], v[20:35]
    v_mfma_f32_32x32x16_bf16 v[36:51], v[92:95], v[80:83], v[36:51]
    v_mfma_f32_32x32x16_bf16 v[52:67], v[96:99], v[80:83], v[52:67]
    s_nop 7
    s_nop 7
    s_waitcnt vmcnt(0)
    v_and_b32 v166, 31, v124
    s_lshl_b32 s65, s67, 6
    v_add_u32 v166, s65, v166
    v_lshlrev_b32 v167, 3, v166
    ds_read_b64 v[162:163], v167
    ds_read_b64 v[164:165], v167 offset:256
    v_add_u32 v166, s61, v166
    v_mul_u32_u24 v166, 1280, v166
    v_lshlrev_b32 v167, 1, v160
    v_add_u32 v166, v166, v167
    v_add_u32 v167, 40960, v166
    s_lshl_b32 s66, s62, 1
    s_waitcnt lgkmcnt(0)
    v_fma_f32 v4, -v162, v128, v4
    v_mul_f32 v4, v4, v163
    v_fma_f32 v5, -v162, v129, v5
    v_mul_f32 v5, v5, v163
    v_fma_f32 v6, -v162, v130, v6
    v_mul_f32 v6, v6, v163
    v_fma_f32 v7, -v162, v131, v7
    v_mul_f32 v7, v7, v163
    v_cvt_pk_bf16_f32 v168, v4, v5
    v_lshlrev_b32 v4, 16, v168
    v_and_b32 v5, 0xffff0000, v168
    v_cvt_pk_bf16_f32 v169, v6, v7
    v_lshlrev_b32 v6, 16, v169
    v_and_b32 v7, 0xffff0000, v169
    v_mul_f32 v170, 0x3fb8aa3b, v4
    v_exp_f32 v170, v170
    v_cmp_lt_f32 vcc, 0, v4
    v_add_f32 v4, 1.0, v4
    v_cndmask_b32 v4, v170, v4, vcc
    v_mul_f32 v171, 0x3fb8aa3b, v5
    v_exp_f32 v171, v171
    v_cmp_lt_f32 vcc, 0, v5
    v_add_f32 v5, 1.0, v5
    v_cndmask_b32 v5, v171, v5, vcc
    v_mul_f32 v172, 0x3fb8aa3b, v6
    v_exp_f32 v172, v172
    v_cmp_lt_f32 vcc, 0, v6
    v_add_f32 v6, 1.0, v6
    v_cndmask_b32 v6, v172, v6, vcc
    v_mul_f32 v173, 0x3fb8aa3b, v7
    v_exp_f32 v173, v173
    v_cmp_lt_f32 vcc, 0, v7
    v_add_f32 v7, 1.0, v7
    v_cndmask_b32 v7, v173, v7, vcc
    v_cvt_pk_bf16_f32 v168, v4, v5
    v_lshlrev_b32 v4, 16, v168
    v_and_b32 v5, 0xffff0000, v168
    v_cvt_pk_bf16_f32 v169, v6, v7
    v_lshlrev_b32 v6, 16, v169
    v_and_b32 v7, 0xffff0000, v169
    v_add_f32 v4, 0x358637bd, v4
    v_add_f32 v5, 0x358637bd, v5
    v_add_f32 v6, 0x358637bd, v6
    v_add_f32 v7, 0x358637bd, v7
    v_cvt_pk_bf16_f32 v174, v4, v5
    v_cvt_pk_bf16_f32 v175, v6, v7
    buffer_store_dwordx2 v[174:175], v166, s[56:59], s66 offen offset:0
    s_nop 1
    v_fma_f32 v8, -v162, v132, v8
    v_mul_f32 v8, v8, v163
    v_fma_f32 v9, -v162, v133, v9
    v_mul_f32 v9, v9, v163
    v_fma_f32 v10, -v162, v134, v10
    v_mul_f32 v10, v10, v163
    v_fma_f32 v11, -v162, v135, v11
    v_mul_f32 v11, v11, v163
    v_cvt_pk_bf16_f32 v168, v8, v9
    v_lshlrev_b32 v8, 16, v168
    v_and_b32 v9, 0xffff0000, v168
    v_cvt_pk_bf16_f32 v169, v10, v11
    v_lshlrev_b32 v10, 16, v169
    v_and_b32 v11, 0xffff0000, v169
    v_mul_f32 v170, 0x3fb8aa3b, v8
    v_exp_f32 v170, v170
    v_cmp_lt_f32 vcc, 0, v8
    v_add_f32 v8, 1.0, v8
    v_cndmask_b32 v8, v170, v8, vcc
    v_mul_f32 v171, 0x3fb8aa3b, v9
    v_exp_f32 v171, v171
    v_cmp_lt_f32 vcc, 0, v9
    v_add_f32 v9, 1.0, v9
    v_cndmask_b32 v9, v171, v9, vcc
    v_mul_f32 v172, 0x3fb8aa3b, v10
    v_exp_f32 v172, v172
    v_cmp_lt_f32 vcc, 0, v10
    v_add_f32 v10, 1.0, v10
    v_cndmask_b32 v10, v172, v10, vcc
    v_mul_f32 v173, 0x3fb8aa3b, v11
    v_exp_f32 v173, v173
    v_cmp_lt_f32 vcc, 0, v11
    v_add_f32 v11, 1.0, v11
    v_cndmask_b32 v11, v173, v11, vcc
    v_cvt_pk_bf16_f32 v168, v8, v9
    v_lshlrev_b32 v8, 16, v168
    v_and_b32 v9, 0xffff0000, v168
    v_cvt_pk_bf16_f32 v169, v10, v11
    v_lshlrev_b32 v10, 16, v169
    v_and_b32 v11, 0xffff0000, v169
    v_add_f32 v8, 0x358637bd, v8
    v_add_f32 v9, 0x358637bd, v9
    v_add_f32 v10, 0x358637bd, v10
    v_add_f32 v11, 0x358637bd, v11
    v_cvt_pk_bf16_f32 v174, v8, v9
    v_cvt_pk_bf16_f32 v175, v10, v11
    buffer_store_dwordx2 v[174:175], v166, s[56:59], s66 offen offset:16
    s_nop 1
    v_fma_f32 v12, -v162, v136, v12
    v_mul_f32 v12, v12, v163
    v_fma_f32 v13, -v162, v137, v13
    v_mul_f32 v13, v13, v163
    v_fma_f32 v14, -v162, v138, v14
    v_mul_f32 v14, v14, v163
    v_fma_f32 v15, -v162, v139, v15
    v_mul_f32 v15, v15, v163
    v_cvt_pk_bf16_f32 v168, v12, v13
    v_lshlrev_b32 v12, 16, v168
    v_and_b32 v13, 0xffff0000, v168
    v_cvt_pk_bf16_f32 v169, v14, v15
    v_lshlrev_b32 v14, 16, v169
    v_and_b32 v15, 0xffff0000, v169
    v_mul_f32 v170, 0x3fb8aa3b, v12
    v_exp_f32 v170, v170
    v_cmp_lt_f32 vcc, 0, v12
    v_add_f32 v12, 1.0, v12
    v_cndmask_b32 v12, v170, v12, vcc
    v_mul_f32 v171, 0x3fb8aa3b, v13
    v_exp_f32 v171, v171
    v_cmp_lt_f32 vcc, 0, v13
    v_add_f32 v13, 1.0, v13
    v_cndmask_b32 v13, v171, v13, vcc
    v_mul_f32 v172, 0x3fb8aa3b, v14
    v_exp_f32 v172, v172
    v_cmp_lt_f32 vcc, 0, v14
    v_add_f32 v14, 1.0, v14
    v_cndmask_b32 v14, v172, v14, vcc
    v_mul_f32 v173, 0x3fb8aa3b, v15
    v_exp_f32 v173, v173
    v_cmp_lt_f32 vcc, 0, v15
    v_add_f32 v15, 1.0, v15
    v_cndmask_b32 v15, v173, v15, vcc
    v_cvt_pk_bf16_f32 v168, v12, v13
    v_lshlrev_b32 v12, 16, v168
    v_and_b32 v13, 0xffff0000, v168
    v_cvt_pk_bf16_f32 v169, v14, v15
    v_lshlrev_b32 v14, 16, v169
    v_and_b32 v15, 0xffff0000, v169
    v_add_f32 v12, 0x358637bd, v12
    v_add_f32 v13, 0x358637bd, v13
    v_add_f32 v14, 0x358637bd, v14
    v_add_f32 v15, 0x358637bd, v15
    v_cvt_pk_bf16_f32 v174, v12, v13
    v_cvt_pk_bf16_f32 v175, v14, v15
    buffer_store_dwordx2 v[174:175], v166, s[56:59], s66 offen offset:32
    s_nop 1
    v_fma_f32 v16, -v162, v140, v16
    v_mul_f32 v16, v16, v163
    v_fma_f32 v17, -v162, v141, v17
    v_mul_f32 v17, v17, v163
    v_fma_f32 v18, -v162, v142, v18
    v_mul_f32 v18, v18, v163
    v_fma_f32 v19, -v162, v143, v19
    v_mul_f32 v19, v19, v163
    v_cvt_pk_bf16_f32 v168, v16, v17
    v_lshlrev_b32 v16, 16, v168
    v_and_b32 v17, 0xffff0000, v168
    v_cvt_pk_bf16_f32 v169, v18, v19
    v_lshlrev_b32 v18, 16, v169
    v_and_b32 v19, 0xffff0000, v169
    v_mul_f32 v170, 0x3fb8aa3b, v16
    v_exp_f32 v170, v170
    v_cmp_lt_f32 vcc, 0, v16
    v_add_f32 v16, 1.0, v16
    v_cndmask_b32 v16, v170, v16, vcc
    v_mul_f32 v171, 0x3fb8aa3b, v17
    v_exp_f32 v171, v171
    v_cmp_lt_f32 vcc, 0, v17
    v_add_f32 v17, 1.0, v17
    v_cndmask_b32 v17, v171, v17, vcc
    v_mul_f32 v172, 0x3fb8aa3b, v18
    v_exp_f32 v172, v172
    v_cmp_lt_f32 vcc, 0, v18
    v_add_f32 v18, 1.0, v18
    v_cndmask_b32 v18, v172, v18, vcc
    v_mul_f32 v173, 0x3fb8aa3b, v19
    v_exp_f32 v173, v173
    v_cmp_lt_f32 vcc, 0, v19
    v_add_f32 v19, 1.0, v19
    v_cndmask_b32 v19, v173, v19, vcc
    v_cvt_pk_bf16_f32 v168, v16, v17
    v_lshlrev_b32 v16, 16, v168
    v_and_b32 v17, 0xffff0000, v168
    v_cvt_pk_bf16_f32 v169, v18, v19
    v_lshlrev_b32 v18, 16, v169
    v_and_b32 v19, 0xffff0000, v169
    v_add_f32 v16, 0x358637bd, v16
    v_add_f32 v17, 0x358637bd, v17
    v_add_f32 v18, 0x358637bd, v18
    v_add_f32 v19, 0x358637bd, v19
    v_cvt_pk_bf16_f32 v174, v16, v17
    v_cvt_pk_bf16_f32 v175, v18, v19
    buffer_store_dwordx2 v[174:175], v166, s[56:59], s66 offen offset:48
    s_nop 1
    v_fma_f32 v20, -v162, v144, v20
    v_mul_f32 v20, v20, v163
    v_fma_f32 v21, -v162, v145, v21
    v_mul_f32 v21, v21, v163
    v_fma_f32 v22, -v162, v146, v22
    v_mul_f32 v22, v22, v163
    v_fma_f32 v23, -v162, v147, v23
    v_mul_f32 v23, v23, v163
    v_cvt_pk_bf16_f32 v168, v20, v21
    v_lshlrev_b32 v20, 16, v168
    v_and_b32 v21, 0xffff0000, v168
    v_cvt_pk_bf16_f32 v169, v22, v23
    v_lshlrev_b32 v22, 16, v169
    v_and_b32 v23, 0xffff0000, v169
    v_mul_f32 v170, 0x3fb8aa3b, v20
    v_exp_f32 v170, v170
    v_cmp_lt_f32 vcc, 0, v20
    v_add_f32 v20, 1.0, v20
    v_cndmask_b32 v20, v170, v20, vcc
    v_mul_f32 v171, 0x3fb8aa3b, v21
    v_exp_f32 v171, v171
    v_cmp_lt_f32 vcc, 0, v21
    v_add_f32 v21, 1.0, v21
    v_cndmask_b32 v21, v171, v21, vcc
    v_mul_f32 v172, 0x3fb8aa3b, v22
    v_exp_f32 v172, v172
    v_cmp_lt_f32 vcc, 0, v22
    v_add_f32 v22, 1.0, v22
    v_cndmask_b32 v22, v172, v22, vcc
    v_mul_f32 v173, 0x3fb8aa3b, v23
    v_exp_f32 v173, v173
    v_cmp_lt_f32 vcc, 0, v23
    v_add_f32 v23, 1.0, v23
    v_cndmask_b32 v23, v173, v23, vcc
    v_cvt_pk_bf16_f32 v168, v20, v21
    v_lshlrev_b32 v20, 16, v168
    v_and_b32 v21, 0xffff0000, v168
    v_cvt_pk_bf16_f32 v169, v22, v23
    v_lshlrev_b32 v22, 16, v169
    v_and_b32 v23, 0xffff0000, v169
    v_add_f32 v20, 0x358637bd, v20
    v_add_f32 v21, 0x358637bd, v21
    v_add_f32 v22, 0x358637bd, v22
    v_add_f32 v23, 0x358637bd, v23
    v_cvt_pk_bf16_f32 v174, v20, v21
    v_cvt_pk_bf16_f32 v175, v22, v23
    buffer_store_dwordx2 v[174:175], v166, s[56:59], s66 offen offset:64
    s_nop 1
    v_fma_f32 v24, -v162, v148, v24
    v_mul_f32 v24, v24, v163
    v_fma_f32 v25, -v162, v149, v25
    v_mul_f32 v25, v25, v163
    v_fma_f32 v26, -v162, v150, v26
    v_mul_f32 v26, v26, v163
    v_fma_f32 v27, -v162, v151, v27
    v_mul_f32 v27, v27, v163
    v_cvt_pk_bf16_f32 v168, v24, v25
    v_lshlrev_b32 v24, 16, v168
    v_and_b32 v25, 0xffff0000, v168
    v_cvt_pk_bf16_f32 v169, v26, v27
    v_lshlrev_b32 v26, 16, v169
    v_and_b32 v27, 0xffff0000, v169
    v_mul_f32 v170, 0x3fb8aa3b, v24
    v_exp_f32 v170, v170
    v_cmp_lt_f32 vcc, 0, v24
    v_add_f32 v24, 1.0, v24
    v_cndmask_b32 v24, v170, v24, vcc
    v_mul_f32 v171, 0x3fb8aa3b, v25
    v_exp_f32 v171, v171
    v_cmp_lt_f32 vcc, 0, v25
    v_add_f32 v25, 1.0, v25
    v_cndmask_b32 v25, v171, v25, vcc
    v_mul_f32 v172, 0x3fb8aa3b, v26
    v_exp_f32 v172, v172
    v_cmp_lt_f32 vcc, 0, v26
    v_add_f32 v26, 1.0, v26
    v_cndmask_b32 v26, v172, v26, vcc
    v_mul_f32 v173, 0x3fb8aa3b, v27
    v_exp_f32 v173, v173
    v_cmp_lt_f32 vcc, 0, v27
    v_add_f32 v27, 1.0, v27
    v_cndmask_b32 v27, v173, v27, vcc
    v_cvt_pk_bf16_f32 v168, v24, v25
    v_lshlrev_b32 v24, 16, v168
    v_and_b32 v25, 0xffff0000, v168
    v_cvt_pk_bf16_f32 v169, v26, v27
    v_lshlrev_b32 v26, 16, v169
    v_and_b32 v27, 0xffff0000, v169
    v_add_f32 v24, 0x358637bd, v24
    v_add_f32 v25, 0x358637bd, v25
    v_add_f32 v26, 0x358637bd, v26
    v_add_f32 v27, 0x358637bd, v27
    v_cvt_pk_bf16_f32 v174, v24, v25
    v_cvt_pk_bf16_f32 v175, v26, v27
    buffer_store_dwordx2 v[174:175], v166, s[56:59], s66 offen offset:80
    s_nop 1
    v_fma_f32 v28, -v162, v152, v28
    v_mul_f32 v28, v28, v163
    v_fma_f32 v29, -v162, v153, v29
    v_mul_f32 v29, v29, v163
    v_fma_f32 v30, -v162, v154, v30
    v_mul_f32 v30, v30, v163
    v_fma_f32 v31, -v162, v155, v31
    v_mul_f32 v31, v31, v163
    v_cvt_pk_bf16_f32 v168, v28, v29
    v_lshlrev_b32 v28, 16, v168
    v_and_b32 v29, 0xffff0000, v168
    v_cvt_pk_bf16_f32 v169, v30, v31
    v_lshlrev_b32 v30, 16, v169
    v_and_b32 v31, 0xffff0000, v169
    v_mul_f32 v170, 0x3fb8aa3b, v28
    v_exp_f32 v170, v170
    v_cmp_lt_f32 vcc, 0, v28
    v_add_f32 v28, 1.0, v28
    v_cndmask_b32 v28, v170, v28, vcc
    v_mul_f32 v171, 0x3fb8aa3b, v29
    v_exp_f32 v171, v171
    v_cmp_lt_f32 vcc, 0, v29
    v_add_f32 v29, 1.0, v29
    v_cndmask_b32 v29, v171, v29, vcc
    v_mul_f32 v172, 0x3fb8aa3b, v30
    v_exp_f32 v172, v172
    v_cmp_lt_f32 vcc, 0, v30
    v_add_f32 v30, 1.0, v30
    v_cndmask_b32 v30, v172, v30, vcc
    v_mul_f32 v173, 0x3fb8aa3b, v31
    v_exp_f32 v173, v173
    v_cmp_lt_f32 vcc, 0, v31
    v_add_f32 v31, 1.0, v31
    v_cndmask_b32 v31, v173, v31, vcc
    v_cvt_pk_bf16_f32 v168, v28, v29
    v_lshlrev_b32 v28, 16, v168
    v_and_b32 v29, 0xffff0000, v168
    v_cvt_pk_bf16_f32 v169, v30, v31
    v_lshlrev_b32 v30, 16, v169
    v_and_b32 v31, 0xffff0000, v169
    v_add_f32 v28, 0x358637bd, v28
    v_add_f32 v29, 0x358637bd, v29
    v_add_f32 v30, 0x358637bd, v30
    v_add_f32 v31, 0x358637bd, v31
    v_cvt_pk_bf16_f32 v174, v28, v29
    v_cvt_pk_bf16_f32 v175, v30, v31
    buffer_store_dwordx2 v[174:175], v166, s[56:59], s66 offen offset:96
    s_nop 1
    v_fma_f32 v32, -v162, v156, v32
    v_mul_f32 v32, v32, v163
    v_fma_f32 v33, -v162, v157, v33
    v_mul_f32 v33, v33, v163
    v_fma_f32 v34, -v162, v158, v34
    v_mul_f32 v34, v34, v163
    v_fma_f32 v35, -v162, v159, v35
    v_mul_f32 v35, v35, v163
    v_cvt_pk_bf16_f32 v168, v32, v33
    v_lshlrev_b32 v32, 16, v168
    v_and_b32 v33, 0xffff0000, v168
    v_cvt_pk_bf16_f32 v169, v34, v35
    v_lshlrev_b32 v34, 16, v169
    v_and_b32 v35, 0xffff0000, v169
    v_mul_f32 v170, 0x3fb8aa3b, v32
    v_exp_f32 v170, v170
    v_cmp_lt_f32 vcc, 0, v32
    v_add_f32 v32, 1.0, v32
    v_cndmask_b32 v32, v170, v32, vcc
    v_mul_f32 v171, 0x3fb8aa3b, v33
    v_exp_f32 v171, v171
    v_cmp_lt_f32 vcc, 0, v33
    v_add_f32 v33, 1.0, v33
    v_cndmask_b32 v33, v171, v33, vcc
    v_mul_f32 v172, 0x3fb8aa3b, v34
    v_exp_f32 v172, v172
    v_cmp_lt_f32 vcc, 0, v34
    v_add_f32 v34, 1.0, v34
    v_cndmask_b32 v34, v172, v34, vcc
    v_mul_f32 v173, 0x3fb8aa3b, v35
    v_exp_f32 v173, v173
    v_cmp_lt_f32 vcc, 0, v35
    v_add_f32 v35, 1.0, v35
    v_cndmask_b32 v35, v173, v35, vcc
    v_cvt_pk_bf16_f32 v168, v32, v33
    v_lshlrev_b32 v32, 16, v168
    v_and_b32 v33, 0xffff0000, v168
    v_cvt_pk_bf16_f32 v169, v34, v35
    v_lshlrev_b32 v34, 16, v169
    v_and_b32 v35, 0xffff0000, v169
    v_add_f32 v32, 0x358637bd, v32
    v_add_f32 v33, 0x358637bd, v33
    v_add_f32 v34, 0x358637bd, v34
    v_add_f32 v35, 0x358637bd, v35
    v_cvt_pk_bf16_f32 v174, v32, v33
    v_cvt_pk_bf16_f32 v175, v34, v35
    buffer_store_dwordx2 v[174:175], v166, s[56:59], s66 offen offset:112
    s_nop 1
    v_fma_f32 v36, -v164, v128, v36
    v_mul_f32 v36, v36, v165
    v_fma_f32 v37, -v164, v129, v37
    v_mul_f32 v37, v37, v165
    v_fma_f32 v38, -v164, v130, v38
    v_mul_f32 v38, v38, v165
    v_fma_f32 v39, -v164, v131, v39
    v_mul_f32 v39, v39, v165
    v_cvt_pk_bf16_f32 v168, v36, v37
    v_lshlrev_b32 v36, 16, v168
    v_and_b32 v37, 0xffff0000, v168
    v_cvt_pk_bf16_f32 v169, v38, v39
    v_lshlrev_b32 v38, 16, v169
    v_and_b32 v39, 0xffff0000, v169
    v_mul_f32 v170, 0x3fb8aa3b, v36
    v_exp_f32 v170, v170
    v_cmp_lt_f32 vcc, 0, v36
    v_add_f32 v36, 1.0, v36
    v_cndmask_b32 v36, v170, v36, vcc
    v_mul_f32 v171, 0x3fb8aa3b, v37
    v_exp_f32 v171, v171
    v_cmp_lt_f32 vcc, 0, v37
    v_add_f32 v37, 1.0, v37
    v_cndmask_b32 v37, v171, v37, vcc
    v_mul_f32 v172, 0x3fb8aa3b, v38
    v_exp_f32 v172, v172
    v_cmp_lt_f32 vcc, 0, v38
    v_add_f32 v38, 1.0, v38
    v_cndmask_b32 v38, v172, v38, vcc
    v_mul_f32 v173, 0x3fb8aa3b, v39
    v_exp_f32 v173, v173
    v_cmp_lt_f32 vcc, 0, v39
    v_add_f32 v39, 1.0, v39
    v_cndmask_b32 v39, v173, v39, vcc
    v_cvt_pk_bf16_f32 v168, v36, v37
    v_lshlrev_b32 v36, 16, v168
    v_and_b32 v37, 0xffff0000, v168
    v_cvt_pk_bf16_f32 v169, v38, v39
    v_lshlrev_b32 v38, 16, v169
    v_and_b32 v39, 0xffff0000, v169
    v_add_f32 v36, 0x358637bd, v36
    v_add_f32 v37, 0x358637bd, v37
    v_add_f32 v38, 0x358637bd, v38
    v_add_f32 v39, 0x358637bd, v39
    v_cvt_pk_bf16_f32 v174, v36, v37
    v_cvt_pk_bf16_f32 v175, v38, v39
    buffer_store_dwordx2 v[174:175], v167, s[56:59], s66 offen offset:0
    s_nop 1
    v_fma_f32 v40, -v164, v132, v40
    v_mul_f32 v40, v40, v165
    v_fma_f32 v41, -v164, v133, v41
    v_mul_f32 v41, v41, v165
    v_fma_f32 v42, -v164, v134, v42
    v_mul_f32 v42, v42, v165
    v_fma_f32 v43, -v164, v135, v43
    v_mul_f32 v43, v43, v165
    v_cvt_pk_bf16_f32 v168, v40, v41
    v_lshlrev_b32 v40, 16, v168
    v_and_b32 v41, 0xffff0000, v168
    v_cvt_pk_bf16_f32 v169, v42, v43
    v_lshlrev_b32 v42, 16, v169
    v_and_b32 v43, 0xffff0000, v169
    v_mul_f32 v170, 0x3fb8aa3b, v40
    v_exp_f32 v170, v170
    v_cmp_lt_f32 vcc, 0, v40
    v_add_f32 v40, 1.0, v40
    v_cndmask_b32 v40, v170, v40, vcc
    v_mul_f32 v171, 0x3fb8aa3b, v41
    v_exp_f32 v171, v171
    v_cmp_lt_f32 vcc, 0, v41
    v_add_f32 v41, 1.0, v41
    v_cndmask_b32 v41, v171, v41, vcc
    v_mul_f32 v172, 0x3fb8aa3b, v42
    v_exp_f32 v172, v172
    v_cmp_lt_f32 vcc, 0, v42
    v_add_f32 v42, 1.0, v42
    v_cndmask_b32 v42, v172, v42, vcc
    v_mul_f32 v173, 0x3fb8aa3b, v43
    v_exp_f32 v173, v173
    v_cmp_lt_f32 vcc, 0, v43
    v_add_f32 v43, 1.0, v43
    v_cndmask_b32 v43, v173, v43, vcc
    v_cvt_pk_bf16_f32 v168, v40, v41
    v_lshlrev_b32 v40, 16, v168
    v_and_b32 v41, 0xffff0000, v168
    v_cvt_pk_bf16_f32 v169, v42, v43
    v_lshlrev_b32 v42, 16, v169
    v_and_b32 v43, 0xffff0000, v169
    v_add_f32 v40, 0x358637bd, v40
    v_add_f32 v41, 0x358637bd, v41
    v_add_f32 v42, 0x358637bd, v42
    v_add_f32 v43, 0x358637bd, v43
    v_cvt_pk_bf16_f32 v174, v40, v41
    v_cvt_pk_bf16_f32 v175, v42, v43
    buffer_store_dwordx2 v[174:175], v167, s[56:59], s66 offen offset:16
    s_nop 1
    v_fma_f32 v44, -v164, v136, v44
    v_mul_f32 v44, v44, v165
    v_fma_f32 v45, -v164, v137, v45
    v_mul_f32 v45, v45, v165
    v_fma_f32 v46, -v164, v138, v46
    v_mul_f32 v46, v46, v165
    v_fma_f32 v47, -v164, v139, v47
    v_mul_f32 v47, v47, v165
    v_cvt_pk_bf16_f32 v168, v44, v45
    v_lshlrev_b32 v44, 16, v168
    v_and_b32 v45, 0xffff0000, v168
    v_cvt_pk_bf16_f32 v169, v46, v47
    v_lshlrev_b32 v46, 16, v169
    v_and_b32 v47, 0xffff0000, v169
    v_mul_f32 v170, 0x3fb8aa3b, v44
    v_exp_f32 v170, v170
    v_cmp_lt_f32 vcc, 0, v44
    v_add_f32 v44, 1.0, v44
    v_cndmask_b32 v44, v170, v44, vcc
    v_mul_f32 v171, 0x3fb8aa3b, v45
    v_exp_f32 v171, v171
    v_cmp_lt_f32 vcc, 0, v45
    v_add_f32 v45, 1.0, v45
    v_cndmask_b32 v45, v171, v45, vcc
    v_mul_f32 v172, 0x3fb8aa3b, v46
    v_exp_f32 v172, v172
    v_cmp_lt_f32 vcc, 0, v46
    v_add_f32 v46, 1.0, v46
    v_cndmask_b32 v46, v172, v46, vcc
    v_mul_f32 v173, 0x3fb8aa3b, v47
    v_exp_f32 v173, v173
    v_cmp_lt_f32 vcc, 0, v47
    v_add_f32 v47, 1.0, v47
    v_cndmask_b32 v47, v173, v47, vcc
    v_cvt_pk_bf16_f32 v168, v44, v45
    v_lshlrev_b32 v44, 16, v168
    v_and_b32 v45, 0xffff0000, v168
    v_cvt_pk_bf16_f32 v169, v46, v47
    v_lshlrev_b32 v46, 16, v169
    v_and_b32 v47, 0xffff0000, v169
    v_add_f32 v44, 0x358637bd, v44
    v_add_f32 v45, 0x358637bd, v45
    v_add_f32 v46, 0x358637bd, v46
    v_add_f32 v47, 0x358637bd, v47
    v_cvt_pk_bf16_f32 v174, v44, v45
    v_cvt_pk_bf16_f32 v175, v46, v47
    buffer_store_dwordx2 v[174:175], v167, s[56:59], s66 offen offset:32
    s_nop 1
    v_fma_f32 v48, -v164, v140, v48
    v_mul_f32 v48, v48, v165
    v_fma_f32 v49, -v164, v141, v49
    v_mul_f32 v49, v49, v165
    v_fma_f32 v50, -v164, v142, v50
    v_mul_f32 v50, v50, v165
    v_fma_f32 v51, -v164, v143, v51
    v_mul_f32 v51, v51, v165
    v_cvt_pk_bf16_f32 v168, v48, v49
    v_lshlrev_b32 v48, 16, v168
    v_and_b32 v49, 0xffff0000, v168
    v_cvt_pk_bf16_f32 v169, v50, v51
    v_lshlrev_b32 v50, 16, v169
    v_and_b32 v51, 0xffff0000, v169
    v_mul_f32 v170, 0x3fb8aa3b, v48
    v_exp_f32 v170, v170
    v_cmp_lt_f32 vcc, 0, v48
    v_add_f32 v48, 1.0, v48
    v_cndmask_b32 v48, v170, v48, vcc
    v_mul_f32 v171, 0x3fb8aa3b, v49
    v_exp_f32 v171, v171
    v_cmp_lt_f32 vcc, 0, v49
    v_add_f32 v49, 1.0, v49
    v_cndmask_b32 v49, v171, v49, vcc
    v_mul_f32 v172, 0x3fb8aa3b, v50
    v_exp_f32 v172, v172
    v_cmp_lt_f32 vcc, 0, v50
    v_add_f32 v50, 1.0, v50
    v_cndmask_b32 v50, v172, v50, vcc
    v_mul_f32 v173, 0x3fb8aa3b, v51
    v_exp_f32 v173, v173
    v_cmp_lt_f32 vcc, 0, v51
    v_add_f32 v51, 1.0, v51
    v_cndmask_b32 v51, v173, v51, vcc
    v_cvt_pk_bf16_f32 v168, v48, v49
    v_lshlrev_b32 v48, 16, v168
    v_and_b32 v49, 0xffff0000, v168
    v_cvt_pk_bf16_f32 v169, v50, v51
    v_lshlrev_b32 v50, 16, v169
    v_and_b32 v51, 0xffff0000, v169
    v_add_f32 v48, 0x358637bd, v48
    v_add_f32 v49, 0x358637bd, v49
    v_add_f32 v50, 0x358637bd, v50
    v_add_f32 v51, 0x358637bd, v51
    v_cvt_pk_bf16_f32 v174, v48, v49
    v_cvt_pk_bf16_f32 v175, v50, v51
    buffer_store_dwordx2 v[174:175], v167, s[56:59], s66 offen offset:48
    s_nop 1
    v_fma_f32 v52, -v164, v144, v52
    v_mul_f32 v52, v52, v165
    v_fma_f32 v53, -v164, v145, v53
    v_mul_f32 v53, v53, v165
    v_fma_f32 v54, -v164, v146, v54
    v_mul_f32 v54, v54, v165
    v_fma_f32 v55, -v164, v147, v55
    v_mul_f32 v55, v55, v165
    v_cvt_pk_bf16_f32 v168, v52, v53
    v_lshlrev_b32 v52, 16, v168
    v_and_b32 v53, 0xffff0000, v168
    v_cvt_pk_bf16_f32 v169, v54, v55
    v_lshlrev_b32 v54, 16, v169
    v_and_b32 v55, 0xffff0000, v169
    v_mul_f32 v170, 0x3fb8aa3b, v52
    v_exp_f32 v170, v170
    v_cmp_lt_f32 vcc, 0, v52
    v_add_f32 v52, 1.0, v52
    v_cndmask_b32 v52, v170, v52, vcc
    v_mul_f32 v171, 0x3fb8aa3b, v53
    v_exp_f32 v171, v171
    v_cmp_lt_f32 vcc, 0, v53
    v_add_f32 v53, 1.0, v53
    v_cndmask_b32 v53, v171, v53, vcc
    v_mul_f32 v172, 0x3fb8aa3b, v54
    v_exp_f32 v172, v172
    v_cmp_lt_f32 vcc, 0, v54
    v_add_f32 v54, 1.0, v54
    v_cndmask_b32 v54, v172, v54, vcc
    v_mul_f32 v173, 0x3fb8aa3b, v55
    v_exp_f32 v173, v173
    v_cmp_lt_f32 vcc, 0, v55
    v_add_f32 v55, 1.0, v55
    v_cndmask_b32 v55, v173, v55, vcc
    v_cvt_pk_bf16_f32 v168, v52, v53
    v_lshlrev_b32 v52, 16, v168
    v_and_b32 v53, 0xffff0000, v168
    v_cvt_pk_bf16_f32 v169, v54, v55
    v_lshlrev_b32 v54, 16, v169
    v_and_b32 v55, 0xffff0000, v169
    v_add_f32 v52, 0x358637bd, v52
    v_add_f32 v53, 0x358637bd, v53
    v_add_f32 v54, 0x358637bd, v54
    v_add_f32 v55, 0x358637bd, v55
    v_cvt_pk_bf16_f32 v174, v52, v53
    v_cvt_pk_bf16_f32 v175, v54, v55
    buffer_store_dwordx2 v[174:175], v167, s[56:59], s66 offen offset:64
    s_nop 1
    v_fma_f32 v56, -v164, v148, v56
    v_mul_f32 v56, v56, v165
    v_fma_f32 v57, -v164, v149, v57
    v_mul_f32 v57, v57, v165
    v_fma_f32 v58, -v164, v150, v58
    v_mul_f32 v58, v58, v165
    v_fma_f32 v59, -v164, v151, v59
    v_mul_f32 v59, v59, v165
    v_cvt_pk_bf16_f32 v168, v56, v57
    v_lshlrev_b32 v56, 16, v168
    v_and_b32 v57, 0xffff0000, v168
    v_cvt_pk_bf16_f32 v169, v58, v59
    v_lshlrev_b32 v58, 16, v169
    v_and_b32 v59, 0xffff0000, v169
    v_mul_f32 v170, 0x3fb8aa3b, v56
    v_exp_f32 v170, v170
    v_cmp_lt_f32 vcc, 0, v56
    v_add_f32 v56, 1.0, v56
    v_cndmask_b32 v56, v170, v56, vcc
    v_mul_f32 v171, 0x3fb8aa3b, v57
    v_exp_f32 v171, v171
    v_cmp_lt_f32 vcc, 0, v57
    v_add_f32 v57, 1.0, v57
    v_cndmask_b32 v57, v171, v57, vcc
    v_mul_f32 v172, 0x3fb8aa3b, v58
    v_exp_f32 v172, v172
    v_cmp_lt_f32 vcc, 0, v58
    v_add_f32 v58, 1.0, v58
    v_cndmask_b32 v58, v172, v58, vcc
    v_mul_f32 v173, 0x3fb8aa3b, v59
    v_exp_f32 v173, v173
    v_cmp_lt_f32 vcc, 0, v59
    v_add_f32 v59, 1.0, v59
    v_cndmask_b32 v59, v173, v59, vcc
    v_cvt_pk_bf16_f32 v168, v56, v57
    v_lshlrev_b32 v56, 16, v168
    v_and_b32 v57, 0xffff0000, v168
    v_cvt_pk_bf16_f32 v169, v58, v59
    v_lshlrev_b32 v58, 16, v169
    v_and_b32 v59, 0xffff0000, v169
    v_add_f32 v56, 0x358637bd, v56
    v_add_f32 v57, 0x358637bd, v57
    v_add_f32 v58, 0x358637bd, v58
    v_add_f32 v59, 0x358637bd, v59
    v_cvt_pk_bf16_f32 v174, v56, v57
    v_cvt_pk_bf16_f32 v175, v58, v59
    buffer_store_dwordx2 v[174:175], v167, s[56:59], s66 offen offset:80
    s_nop 1
    v_fma_f32 v60, -v164, v152, v60
    v_mul_f32 v60, v60, v165
    v_fma_f32 v61, -v164, v153, v61
    v_mul_f32 v61, v61, v165
    v_fma_f32 v62, -v164, v154, v62
    v_mul_f32 v62, v62, v165
    v_fma_f32 v63, -v164, v155, v63
    v_mul_f32 v63, v63, v165
    v_cvt_pk_bf16_f32 v168, v60, v61
    v_lshlrev_b32 v60, 16, v168
    v_and_b32 v61, 0xffff0000, v168
    v_cvt_pk_bf16_f32 v169, v62, v63
    v_lshlrev_b32 v62, 16, v169
    v_and_b32 v63, 0xffff0000, v169
    v_mul_f32 v170, 0x3fb8aa3b, v60
    v_exp_f32 v170, v170
    v_cmp_lt_f32 vcc, 0, v60
    v_add_f32 v60, 1.0, v60
    v_cndmask_b32 v60, v170, v60, vcc
    v_mul_f32 v171, 0x3fb8aa3b, v61
    v_exp_f32 v171, v171
    v_cmp_lt_f32 vcc, 0, v61
    v_add_f32 v61, 1.0, v61
    v_cndmask_b32 v61, v171, v61, vcc
    v_mul_f32 v172, 0x3fb8aa3b, v62
    v_exp_f32 v172, v172
    v_cmp_lt_f32 vcc, 0, v62
    v_add_f32 v62, 1.0, v62
    v_cndmask_b32 v62, v172, v62, vcc
    v_mul_f32 v173, 0x3fb8aa3b, v63
    v_exp_f32 v173, v173
    v_cmp_lt_f32 vcc, 0, v63
    v_add_f32 v63, 1.0, v63
    v_cndmask_b32 v63, v173, v63, vcc
    v_cvt_pk_bf16_f32 v168, v60, v61
    v_lshlrev_b32 v60, 16, v168
    v_and_b32 v61, 0xffff0000, v168
    v_cvt_pk_bf16_f32 v169, v62, v63
    v_lshlrev_b32 v62, 16, v169
    v_and_b32 v63, 0xffff0000, v169
    v_add_f32 v60, 0x358637bd, v60
    v_add_f32 v61, 0x358637bd, v61
    v_add_f32 v62, 0x358637bd, v62
    v_add_f32 v63, 0x358637bd, v63
    v_cvt_pk_bf16_f32 v174, v60, v61
    v_cvt_pk_bf16_f32 v175, v62, v63
    buffer_store_dwordx2 v[174:175], v167, s[56:59], s66 offen offset:96
    s_nop 1
    v_fma_f32 v64, -v164, v156, v64
    v_mul_f32 v64, v64, v165
    v_fma_f32 v65, -v164, v157, v65
    v_mul_f32 v65, v65, v165
    v_fma_f32 v66, -v164, v158, v66
    v_mul_f32 v66, v66, v165
    v_fma_f32 v67, -v164, v159, v67
    v_mul_f32 v67, v67, v165
    v_cvt_pk_bf16_f32 v168, v64, v65
    v_lshlrev_b32 v64, 16, v168
    v_and_b32 v65, 0xffff0000, v168
    v_cvt_pk_bf16_f32 v169, v66, v67
    v_lshlrev_b32 v66, 16, v169
    v_and_b32 v67, 0xffff0000, v169
    v_mul_f32 v170, 0x3fb8aa3b, v64
    v_exp_f32 v170, v170
    v_cmp_lt_f32 vcc, 0, v64
    v_add_f32 v64, 1.0, v64
    v_cndmask_b32 v64, v170, v64, vcc
    v_mul_f32 v171, 0x3fb8aa3b, v65
    v_exp_f32 v171, v171
    v_cmp_lt_f32 vcc, 0, v65
    v_add_f32 v65, 1.0, v65
    v_cndmask_b32 v65, v171, v65, vcc
    v_mul_f32 v172, 0x3fb8aa3b, v66
    v_exp_f32 v172, v172
    v_cmp_lt_f32 vcc, 0, v66
    v_add_f32 v66, 1.0, v66
    v_cndmask_b32 v66, v172, v66, vcc
    v_mul_f32 v173, 0x3fb8aa3b, v67
    v_exp_f32 v173, v173
    v_cmp_lt_f32 vcc, 0, v67
    v_add_f32 v67, 1.0, v67
    v_cndmask_b32 v67, v173, v67, vcc
    v_cvt_pk_bf16_f32 v168, v64, v65
    v_lshlrev_b32 v64, 16, v168
    v_and_b32 v65, 0xffff0000, v168
    v_cvt_pk_bf16_f32 v169, v66, v67
    v_lshlrev_b32 v66, 16, v169
    v_and_b32 v67, 0xffff0000, v169
    v_add_f32 v64, 0x358637bd, v64
    v_add_f32 v65, 0x358637bd, v65
    v_add_f32 v66, 0x358637bd, v66
    v_add_f32 v67, 0x358637bd, v67
    v_cvt_pk_bf16_f32 v174, v64, v65
    v_cvt_pk_bf16_f32 v175, v66, v67
    buffer_store_dwordx2 v[174:175], v167, s[56:59], s66 offen offset:112
    s_nop 1
    s_endpgm
.k1p1_kernel_end:
    s_endpgm

.globl k2p1_kernel
.p2align 8
.type k2p1_kernel,@function
k2p1_kernel:
    s_cmp_ge_u32 s2, 160
    s_cbranch_scc1 .k2p1_kernel_end
    s_load_dwordx16 s[16:31], s[0:1], 0
    s_load_dwordx4 s[32:35], s[0:1], 64
    s_load_dwordx2 s[36:37], s[0:1], 80
    s_waitcnt lgkmcnt(0)
    s_and_b32 s61, s2, 31
    s_lshl_b32 s61, s61, 6
    s_lshr_b32 s62, s2, 5
    s_lshl_b32 s62, s62, 7
    s_add_u32 s44, s36, 2457600
    s_addc_u32 s45, s37, 0
    s_and_b32 s45, s45, 0xffff
    s_mov_b32 s46, 819200
    s_mov_b32 s47, 0x00020000
    v_and_b32 v76, 63, v0
    v_lshrrev_b32 v77, 6, v0
    s_nop 0
    v_readfirstlane_b32 s60, v77
    s_nop 1
    s_mul_i32 s63, s60, 0
    s_mul_i32 s64, s60, 4096
    s_mul_i32 s65, s60, 32
    s_add_u32 s65, s65, 0
    v_lshrrev_b32 v77, 3, v76
    v_add_u32 v77, s65, v77
    v_lshrrev_b32 v78, 1, v77
    v_and_b32 v78, 7, v78
    v_and_b32 v60, 7, v76
    v_xor_b32 v78, v60, v78
    v_lshlrev_b32 v78, 4, v78
    v_add_u32 v77, s62, v77
    s_mov_b32 s66, 1280
    v_mul_lo_u32 v77, v77, s66
    v_add_u32 v60, v77, v78
    s_mul_i32 s65, s60, 32
    s_add_u32 s65, s65, 8
    v_lshrrev_b32 v77, 3, v76
    v_add_u32 v77, s65, v77
    v_lshrrev_b32 v78, 1, v77
    v_and_b32 v78, 7, v78
    v_and_b32 v61, 7, v76
    v_xor_b32 v78, v61, v78
    v_lshlrev_b32 v78, 4, v78
    v_add_u32 v77, s62, v77
    s_mov_b32 s66, 1280
    v_mul_lo_u32 v77, v77, s66
    v_add_u32 v61, v77, v78
    s_mul_i32 s65, s60, 32
    s_add_u32 s65, s65, 16
    v_lshrrev_b32 v77, 3, v76
    v_add_u32 v77, s65, v77
    v_lshrrev_b32 v78, 1, v77
    v_and_b32 v78, 7, v78
    v_and_b32 v62, 7, v76
    v_xor_b32 v78, v62, v78
    v_lshlrev_b32 v78, 4, v78
    v_add_u32 v77, s62, v77
    s_mov_b32 s66, 1280
    v_mul_lo_u32 v77, v77, s66
    v_add_u32 v62, v77, v78
    s_mul_i32 s65, s60, 32
    s_add_u32 s65, s65, 24
    v_lshrrev_b32 v77, 3, v76
    v_add_u32 v77, s65, v77
    v_lshrrev_b32 v78, 1, v77
    v_and_b32 v78, 7, v78
    v_and_b32 v63, 7, v76
    v_xor_b32 v78, v63, v78
    v_lshlrev_b32 v78, 4, v78
    v_add_u32 v77, s62, v77
    s_mov_b32 s66, 1280
    v_mul_lo_u32 v77, v77, s66
    v_add_u32 v63, v77, v78
    s_and_b32 s67, s60, 1
    s_lshr_b32 s68, s60, 1
    v_lshrrev_b32 v77, 5, v76
    v_add_u32 v77, 0, v77
    v_lshrrev_b32 v78, 1, v76
    v_and_b32 v78, 7, v78
    v_xor_b32 v77, v77, v78
    v_lshlrev_b32 v77, 4, v77
    v_and_b32 v78, 31, v76
    v_lshl_add_u32 v77, v78, 7, v77
    s_mul_i32 s65, s68, 8192
    v_add_u32 v68, s65, v77
    v_add_u32 v72, 0x10000, v68
    v_lshrrev_b32 v77, 5, v76
    v_add_u32 v77, 2, v77
    v_lshrrev_b32 v78, 1, v76
    v_and_b32 v78, 7, v78
    v_xor_b32 v77, v77, v78
    v_lshlrev_b32 v77, 4, v77
    v_and_b32 v78, 31, v76
    v_lshl_add_u32 v77, v78, 7, v77
    s_mul_i32 s65, s68, 8192
    v_add_u32 v69, s65, v77
    v_add_u32 v73, 0x10000, v69
    v_lshrrev_b32 v77, 5, v76
    v_add_u32 v77, 4, v77
    v_lshrrev_b32 v78, 1, v76
    v_and_b32 v78, 7, v78
    v_xor_b32 v77, v77, v78
    v_lshlrev_b32 v77, 4, v77
    v_and_b32 v78, 31, v76
    v_lshl_add_u32 v77, v78, 7, v77
    s_mul_i32 s65, s68, 8192
    v_add_u32 v70, s65, v77
    v_add_u32 v74, 0x10000, v70
    v_lshrrev_b32 v77, 5, v76
    v_add_u32 v77, 6, v77
    v_lshrrev_b32 v78, 1, v76
    v_and_b32 v78, 7, v78
    v_xor_b32 v77, v77, v78
    v_lshlrev_b32 v77, 4, v77
    v_and_b32 v78, 31, v76
    v_lshl_add_u32 v77, v78, 7, v77
    s_mul_i32 s65, s68, 8192
    v_add_u32 v71, s65, v77
    v_add_u32 v75, 0x10000, v71
    v_mov_b32 v4, 0
    v_mov_b32 v5, 0
    v_mov_b32 v6, 0
    v_mov_b32 v7, 0
    v_mov_b32 v8, 0
    v_mov_b32 v9, 0
    v_mov_b32 v10, 0
    v_mov_b32 v11, 0
    v_mov_b32 v12, 0
    v_mov_b32 v13, 0
    v_mov_b32 v14, 0
    v_mov_b32 v15, 0
    v_mov_b32 v16, 0
    v_mov_b32 v17, 0
    v_mov_b32 v18, 0
    v_mov_b32 v19, 0
    v_mov_b32 v20, 0
    v_mov_b32 v21, 0
    v_mov_b32 v22, 0
    v_mov_b32 v23, 0
    v_mov_b32 v24, 0
    v_mov_b32 v25, 0
    v_mov_b32 v26, 0
    v_mov_b32 v27, 0
    v_mov_b32 v28, 0
    v_mov_b32 v29, 0
    v_mov_b32 v30, 0
    v_mov_b32 v31, 0
    v_mov_b32 v32, 0
    v_mov_b32 v33, 0
    v_mov_b32 v34, 0
    v_mov_b32 v35, 0
    s_mov_b32 s69, 0
    s_add_u32 m0, s64, 81920
    buffer_load_dwordx4 v60, s[44:47], s69 offen lds
    s_add_u32 m0, s64, 82944
    buffer_load_dwordx4 v61, s[44:47], s69 offen lds
    s_add_u32 m0, s64, 83968
    buffer_load_dwordx4 v62, s[44:47], s69 offen lds
    s_add_u32 m0, s64, 84992
    buffer_load_dwordx4 v63, s[44:47], s69 offen lds
    s_mov_b32 s69, 128
    s_add_u32 m0, s64, 98304
    buffer_load_dwordx4 v60, s[44:47], s69 offen lds
    s_add_u32 m0, s64, 99328
    buffer_load_dwordx4 v61, s[44:47], s69 offen lds
    s_add_u32 m0, s64, 100352
    buffer_load_dwordx4 v62, s[44:47], s69 offen lds
    s_add_u32 m0, s64, 101376
    buffer_load_dwordx4 v63, s[44:47], s69 offen lds
    v_lshrrev_b32 v77, 5, v76
    v_add_u32 v77, 0, v77
    v_and_b32 v78, 15, v76
    v_xor_b32 v77, v77, v78
    v_lshlrev_b32 v77, 4, v77
    v_and_b32 v78, 31, v76
    v_mul_u32_u24 v78, 1280, v78
    v_add_u32 v77, v77, v78
    s_mul_i32 s65, s67, 40960
    v_add_u32 v79, s65, v77
    v_lshrrev_b32 v77, 5, v76
    v_add_u32 v77, 2, v77
    v_and_b32 v78, 15, v76
    v_xor_b32 v77, v77, v78
    v_lshlrev_b32 v77, 4, v77
    v_and_b32 v78, 31, v76
    v_mul_u32_u24 v78, 1280, v78
    v_add_u32 v77, v77, v78
    s_mul_i32 s65, s67, 40960
    v_add_u32 v80, s65, v77
    v_lshrrev_b32 v77, 5, v76
    v_add_u32 v77, 4, v77
    v_and_b32 v78, 15, v76
    v_xor_b32 v77, v77, v78
    v_lshlrev_b32 v77, 4, v77
    v_and_b32 v78, 31, v76
    v_mul_u32_u24 v78, 1280, v78
    v_add_u32 v77, v77, v78
    s_mul_i32 s65, s67, 40960
    v_add_u32 v81, s65, v77
    v_lshrrev_b32 v77, 5, v76
    v_add_u32 v77, 6, v77
    v_and_b32 v78, 15, v76
    v_xor_b32 v77, v77, v78
    v_lshlrev_b32 v77, 4, v77
    v_and_b32 v78, 31, v76
    v_mul_u32_u24 v78, 1280, v78
    v_add_u32 v77, v77, v78
    s_mul_i32 s65, s67, 40960
    v_add_u32 v82, s65, v77
    v_lshrrev_b32 v77, 5, v76
    v_add_u32 v77, 8, v77
    v_and_b32 v78, 15, v76
    v_xor_b32 v77, v77, v78
    v_lshlrev_b32 v77, 4, v77
    v_and_b32 v78, 31, v76
    v_mul_u32_u24 v78, 1280, v78
    v_add_u32 v77, v77, v78
    s_mul_i32 s65, s67, 40960
    v_add_u32 v83, s65, v77
    v_lshrrev_b32 v77, 5, v76
    v_add_u32 v77, 10, v77
    v_and_b32 v78, 15, v76
    v_xor_b32 v77, v77, v78
    v_lshlrev_b32 v77, 4, v77
    v_and_b32 v78, 31, v76
    v_mul_u32_u24 v78, 1280, v78
    v_add_u32 v77, v77, v78
    s_mul_i32 s65, s67, 40960
    v_add_u32 v84, s65, v77
    v_lshrrev_b32 v77, 5, v76
    v_add_u32 v77, 12, v77
    v_and_b32 v78, 15, v76
    v_xor_b32 v77, v77, v78
    v_lshlrev_b32 v77, 4, v77
    v_and_b32 v78, 31, v76
    v_mul_u32_u24 v78, 1280, v78
    v_add_u32 v77, v77, v78
    s_mul_i32 s65, s67, 40960
    v_add_u32 v85, s65, v77
    v_lshrrev_b32 v77, 5, v76
    v_add_u32 v77, 14, v77
    v_and_b32 v78, 15, v76
    v_xor_b32 v77, v77, v78
    v_lshlrev_b32 v77, 4, v77
    v_and_b32 v78, 31, v76
    v_mul_u32_u24 v78, 1280, v78
    v_add_u32 v77, v77, v78
    s_mul_i32 s65, s67, 40960
    v_add_u32 v86, s65, v77
    s_add_u32 s72, s36, 8372224
    s_addc_u32 s73, s37, 0
    s_and_b32 s73, s73, 0xffff
    s_mov_b32 s74, 2621440
    s_mov_b32 s75, 0x00020000
    s_add_u32 s76, s36, 11161600
    s_addc_u32 s77, s37, 0
    s_and_b32 s77, s77, 0xffff
    s_mov_b32 s78, 166400
    s_mov_b32 s79, 0x00020000
    v_and_b32 v168, 31, v76
    v_add_u32 v168, s61, v168
    v_mul_u32_u24 v168, 1280, v168
    v_lshrrev_b32 v77, 5, v76
    v_lshl_add_u32 v168, v77, 4, v168
    s_mul_i32 s84, s60, 320
    buffer_load_dwordx4 v[88:91], v168, s[72:75], s84 offen offset:0
    s_add_u32 s85, s84, 40960
    buffer_load_dwordx4 v[92:95], v168, s[72:75], s85 offen offset:0
    buffer_load_dwordx4 v[96:99], v168, s[72:75], s84 offen offset:32
    s_add_u32 s85, s84, 40960
    buffer_load_dwordx4 v[100:103], v168, s[72:75], s85 offen offset:32
    buffer_load_dwordx4 v[104:107], v168, s[72:75], s84 offen offset:64
    s_add_u32 s85, s84, 40960
    buffer_load_dwordx4 v[108:111], v168, s[72:75], s85 offen offset:64
    buffer_load_dwordx4 v[112:115], v168, s[72:75], s84 offen offset:96
    s_add_u32 s85, s84, 40960
    buffer_load_dwordx4 v[116:119], v168, s[72:75], s85 offen offset:96
    buffer_load_dwordx4 v[120:123], v168, s[72:75], s84 offen offset:128
    s_add_u32 s85, s84, 40960
    buffer_load_dwordx4 v[124:127], v168, s[72:75], s85 offen offset:128
    buffer_load_dwordx4 v[128:131], v168, s[72:75], s84 offen offset:160
    s_add_u32 s85, s84, 40960
    buffer_load_dwordx4 v[132:135], v168, s[72:75], s85 offen offset:160
    buffer_load_dwordx4 v[136:139], v168, s[72:75], s84 offen offset:192
    s_add_u32 s85, s84, 40960
    buffer_load_dwordx4 v[140:143], v168, s[72:75], s85 offen offset:192
    buffer_load_dwordx4 v[144:147], v168, s[72:75], s84 offen offset:224
    s_add_u32 s85, s84, 40960
    buffer_load_dwordx4 v[148:151], v168, s[72:75], s85 offen offset:224
    buffer_load_dwordx4 v[152:155], v168, s[72:75], s84 offen offset:256
    s_add_u32 s85, s84, 40960
    buffer_load_dwordx4 v[156:159], v168, s[72:75], s85 offen offset:256
    buffer_load_dwordx4 v[160:163], v168, s[72:75], s84 offen offset:288
    s_add_u32 s85, s84, 40960
    buffer_load_dwordx4 v[164:167], v168, s[72:75], s85 offen offset:288
    v_and_b32 v169, 31, v76
    v_lshlrev_b32 v169, 8, v169
    v_lshl_add_u32 v169, v77, 5, v169
    s_mul_i32 s86, s60, 40960
    v_mov_b32 v184, 0
    v_mov_b32 v185, 0
    v_mov_b32 v186, 0
    v_mov_b32 v187, 0
    v_mov_b32 v188, 0
    v_mov_b32 v189, 0
    v_mov_b32 v190, 0
    v_mov_b32 v191, 0
    v_mov_b32 v192, 0
    v_mov_b32 v193, 0
    v_mov_b32 v194, 0
    v_mov_b32 v195, 0
    v_mov_b32 v196, 0
    v_mov_b32 v197, 0
    v_mov_b32 v198, 0
    v_mov_b32 v199, 0
    v_mov_b32 v200, 0
    v_mov_b32 v201, 0
    v_mov_b32 v202, 0
    v_mov_b32 v203, 0
    v_mov_b32 v204, 0
    v_mov_b32 v205, 0
    v_mov_b32 v206, 0
    v_mov_b32 v207, 0
    v_mov_b32 v208, 0
    v_mov_b32 v209, 0
    v_mov_b32 v210, 0
    v_mov_b32 v211, 0
    v_mov_b32 v212, 0
    v_mov_b32 v213, 0
    v_mov_b32 v214, 0
    v_mov_b32 v215, 0
    s_mul_i32 s87, s60, 640
    s_add_u32 s87, s87, 163840
    v_lshrrev_b32 v226, 5, v76
    v_lshlrev_b32 v226, 5, v226
    v_mov_b32 v180, 0
    v_mov_b32 v181, 0
    v_mov_b32 v182, 0
    v_mov_b32 v183, 0
    s_mov_b32 exec_lo, 1
    s_mov_b32 exec_hi, 1
    buffer_load_dwordx2 v[224:225], v226, s[76:79], s87 offen offset:0
    s_waitcnt vmcnt(0)
    v_cvt_pk_bf16_f32 v180, v224, v225
    s_mov_b32 exec_lo, 1
    s_mov_b32 exec_hi, 1
    buffer_load_dwordx2 v[224:225], v226, s[76:79], s87 offen offset:8
    s_waitcnt vmcnt(0)
    v_cvt_pk_bf16_f32 v181, v224, v225
    s_mov_b32 exec_lo, 1
    s_mov_b32 exec_hi, 1
    buffer_load_dwordx2 v[224:225], v226, s[76:79], s87 offen offset:16
    s_waitcnt vmcnt(0)
    v_cvt_pk_bf16_f32 v182, v224, v225
    s_mov_b32 exec_lo, 1
    s_mov_b32 exec_hi, 1
    buffer_load_dwordx2 v[224:225], v226, s[76:79], s87 offen offset:24
    s_waitcnt vmcnt(0)
    v_cvt_pk_bf16_f32 v183, v224, v225
    s_mov_b64 exec, -1
    s_nop 1
    v_mfma_f32_32x32x16_bf16 v[184:199], v[180:183], v[88:91], v[184:199]
    v_mfma_f32_32x32x16_bf16 v[200:215], v[180:183], v[92:95], v[200:215]
    s_nop 4
    v_mov_b32 v180, 0
    v_mov_b32 v181, 0
    v_mov_b32 v182, 0
    v_mov_b32 v183, 0
    s_mov_b32 exec_lo, 1
    s_mov_b32 exec_hi, 2
    buffer_load_dwordx2 v[224:225], v226, s[76:79], s87 offen offset:64
    s_waitcnt vmcnt(0)
    v_cvt_pk_bf16_f32 v180, v224, v225
    s_mov_b32 exec_lo, 1
    s_mov_b32 exec_hi, 2
    buffer_load_dwordx2 v[224:225], v226, s[76:79], s87 offen offset:72
    s_waitcnt vmcnt(0)
    v_cvt_pk_bf16_f32 v181, v224, v225
    s_mov_b32 exec_lo, 2
    s_mov_b32 exec_hi, 2
    buffer_load_dwordx2 v[224:225], v226, s[76:79], s87 offen offset:80
    s_waitcnt vmcnt(0)
    v_cvt_pk_bf16_f32 v182, v224, v225
    s_mov_b32 exec_lo, 2
    s_mov_b32 exec_hi, 2
    buffer_load_dwordx2 v[224:225], v226, s[76:79], s87 offen offset:88
    s_waitcnt vmcnt(0)
    v_cvt_pk_bf16_f32 v183, v224, v225
    s_mov_b64 exec, -1
    s_nop 1
    v_mfma_f32_32x32x16_bf16 v[184:199], v[180:183], v[96:99], v[184:199]
    v_mfma_f32_32x32x16_bf16 v[200:215], v[180:183], v[100:103], v[200:215]
    s_nop 4
    v_mov_b32 v180, 0
    v_mov_b32 v181, 0
    v_mov_b32 v182, 0
    v_mov_b32 v183, 0
    s_mov_b32 exec_lo, 2
    s_mov_b32 exec_hi, 4
    buffer_load_dwordx2 v[224:225], v226, s[76:79], s87 offen offset:128
    s_waitcnt vmcnt(0)
    v_cvt_pk_bf16_f32 v180, v224, v225
    s_mov_b32 exec_lo, 2
    s_mov_b32 exec_hi, 4
    buffer_load_dwordx2 v[224:225], v226, s[76:79], s87 offen offset:136
    s_waitcnt vmcnt(0)
    v_cvt_pk_bf16_f32 v181, v224, v225
    s_mov_b32 exec_lo, 2
    s_mov_b32 exec_hi, 4
    buffer_load_dwordx2 v[224:225], v226, s[76:79], s87 offen offset:144
    s_waitcnt vmcnt(0)
    v_cvt_pk_bf16_f32 v182, v224, v225
    s_mov_b32 exec_lo, 2
    s_mov_b32 exec_hi, 4
    buffer_load_dwordx2 v[224:225], v226, s[76:79], s87 offen offset:152
    s_waitcnt vmcnt(0)
    v_cvt_pk_bf16_f32 v183, v224, v225
    s_mov_b64 exec, -1
    s_nop 1
    v_mfma_f32_32x32x16_bf16 v[184:199], v[180:183], v[104:107], v[184:199]
    v_mfma_f32_32x32x16_bf16 v[200:215], v[180:183], v[108:111], v[200:215]
    s_nop 4
    v_mov_b32 v180, 0
    v_mov_b32 v181, 0
    v_mov_b32 v182, 0
    v_mov_b32 v183, 0
    s_mov_b32 exec_lo, 4
    s_mov_b32 exec_hi, 4
    buffer_load_dwordx2 v[224:225], v226, s[76:79], s87 offen offset:192
    s_waitcnt vmcnt(0)
    v_cvt_pk_bf16_f32 v180, v224, v225
    s_mov_b32 exec_lo, 4
    s_mov_b32 exec_hi, 4
    buffer_load_dwordx2 v[224:225], v226, s[76:79], s87 offen offset:200
    s_waitcnt vmcnt(0)
    v_cvt_pk_bf16_f32 v181, v224, v225
    s_mov_b32 exec_lo, 4
    s_mov_b32 exec_hi, 8
    buffer_load_dwordx2 v[224:225], v226, s[76:79], s87 offen offset:208
    s_waitcnt vmcnt(0)
    v_cvt_pk_bf16_f32 v182, v224, v225
    s_mov_b32 exec_lo, 4
    s_mov_b32 exec_hi, 8
    buffer_load_dwordx2 v[224:225], v226, s[76:79], s87 offen offset:216
    s_waitcnt vmcnt(0)
    v_cvt_pk_bf16_f32 v183, v224, v225
    s_mov_b64 exec, -1
    s_nop 1
    v_mfma_f32_32x32x16_bf16 v[184:199], v[180:183], v[112:115], v[184:199]
    v_mfma_f32_32x32x16_bf16 v[200:215], v[180:183], v[116:119], v[200:215]
    s_nop 4
    v_mov_b32 v180, 0
    v_mov_b32 v181, 0
    v_mov_b32 v182, 0
    v_mov_b32 v183, 0
    s_mov_b32 exec_lo, 8
    s_mov_b32 exec_hi, 8
    buffer_load_dwordx2 v[224:225], v226, s[76:79], s87 offen offset:256
    s_waitcnt vmcnt(0)
    v_cvt_pk_bf16_f32 v180, v224, v225
    s_mov_b32 exec_lo, 8
    s_mov_b32 exec_hi, 8
    buffer_load_dwordx2 v[224:225], v226, s[76:79], s87 offen offset:264
    s_waitcnt vmcnt(0)
    v_cvt_pk_bf16_f32 v181, v224, v225
    s_mov_b32 exec_lo, 8
    s_mov_b32 exec_hi, 8
    buffer_load_dwordx2 v[224:225], v226, s[76:79], s87 offen offset:272
    s_waitcnt vmcnt(0)
    v_cvt_pk_bf16_f32 v182, v224, v225
    s_mov_b32 exec_lo, 8
    s_mov_b32 exec_hi, 8
    buffer_load_dwordx2 v[224:225], v226, s[76:79], s87 offen offset:280
    s_waitcnt vmcnt(0)
    v_cvt_pk_bf16_f32 v183, v224, v225
    s_mov_b64 exec, -1
    s_nop 1
    v_mfma_f32_32x32x16_bf16 v[184:199], v[180:183], v[120:123], v[184:199]
    v_mfma_f32_32x32x16_bf16 v[200:215], v[180:183], v[124:127], v[200:215]
    s_nop 4
    v_mov_b32 v180, 0
    v_mov_b32 v181, 0
    v_mov_b32 v182, 0
    v_mov_b32 v183, 0
    s_mov_b32 exec_lo, 16
    s_mov_b32 exec_hi, 16
    buffer_load_dwordx2 v[224:225], v226, s[76:79], s87 offen offset:320
    s_waitcnt vmcnt(0)
    v_cvt_pk_bf16_f32 v180, v224, v225
    s_mov_b32 exec_lo, 16
    s_mov_b32 exec_hi, 16
    buffer_load_dwordx2 v[224:225], v226, s[76:79], s87 offen offset:328
    s_waitcnt vmcnt(0)
    v_cvt_pk_bf16_f32 v181, v224, v225
    s_mov_b32 exec_lo, 16
    s_mov_b32 exec_hi, 16
    buffer_load_dwordx2 v[224:225], v226, s[76:79], s87 offen offset:336
    s_waitcnt vmcnt(0)
    v_cvt_pk_bf16_f32 v182, v224, v225
    s_mov_b32 exec_lo, 16
    s_mov_b32 exec_hi, 16
    buffer_load_dwordx2 v[224:225], v226, s[76:79], s87 offen offset:344
    s_waitcnt vmcnt(0)
    v_cvt_pk_bf16_f32 v183, v224, v225
    s_mov_b64 exec, -1
    s_nop 1
    v_mfma_f32_32x32x16_bf16 v[184:199], v[180:183], v[128:131], v[184:199]
    v_mfma_f32_32x32x16_bf16 v[200:215], v[180:183], v[132:135], v[200:215]
    s_nop 4
    v_mov_b32 v180, 0
    v_mov_b32 v181, 0
    v_mov_b32 v182, 0
    v_mov_b32 v183, 0
    s_mov_b32 exec_lo, 16
    s_mov_b32 exec_hi, 32
    buffer_load_dwordx2 v[224:225], v226, s[76:79], s87 offen offset:384
    s_waitcnt vmcnt(0)
    v_cvt_pk_bf16_f32 v180, v224, v225
    s_mov_b32 exec_lo, 16
    s_mov_b32 exec_hi, 32
    buffer_load_dwordx2 v[224:225], v226, s[76:79], s87 offen offset:392
    s_waitcnt vmcnt(0)
    v_cvt_pk_bf16_f32 v181, v224, v225
    s_mov_b32 exec_lo, 32
    s_mov_b32 exec_hi, 32
    buffer_load_dwordx2 v[224:225], v226, s[76:79], s87 offen offset:400
    s_waitcnt vmcnt(0)
    v_cvt_pk_bf16_f32 v182, v224, v225
    s_mov_b32 exec_lo, 32
    s_mov_b32 exec_hi, 32
    buffer_load_dwordx2 v[224:225], v226, s[76:79], s87 offen offset:408
    s_waitcnt vmcnt(0)
    v_cvt_pk_bf16_f32 v183, v224, v225
    s_mov_b64 exec, -1
    s_nop 1
    v_mfma_f32_32x32x16_bf16 v[184:199], v[180:183], v[136:139], v[184:199]
    v_mfma_f32_32x32x16_bf16 v[200:215], v[180:183], v[140:143], v[200:215]
    s_nop 4
    v_mov_b32 v180, 0
    v_mov_b32 v181, 0
    v_mov_b32 v182, 0
    v_mov_b32 v183, 0
    s_mov_b32 exec_lo, 32
    s_mov_b32 exec_hi, 64
    buffer_load_dwordx2 v[224:225], v226, s[76:79], s87 offen offset:448
    s_waitcnt vmcnt(0)
    v_cvt_pk_bf16_f32 v180, v224, v225
    s_mov_b32 exec_lo, 32
    s_mov_b32 exec_hi, 64
    buffer_load_dwordx2 v[224:225], v226, s[76:79], s87 offen offset:456
    s_waitcnt vmcnt(0)
    v_cvt_pk_bf16_f32 v181, v224, v225
    s_mov_b32 exec_lo, 32
    s_mov_b32 exec_hi, 64
    buffer_load_dwordx2 v[224:225], v226, s[76:79], s87 offen offset:464
    s_waitcnt vmcnt(0)
    v_cvt_pk_bf16_f32 v182, v224, v225
    s_mov_b32 exec_lo, 32
    s_mov_b32 exec_hi, 64
    buffer_load_dwordx2 v[224:225], v226, s[76:79], s87 offen offset:472
    s_waitcnt vmcnt(0)
    v_cvt_pk_bf16_f32 v183, v224, v225
    s_mov_b64 exec, -1
    s_nop 1
    v_mfma_f32_32x32x16_bf16 v[184:199], v[180:183], v[144:147], v[184:199]
    v_mfma_f32_32x32x16_bf16 v[200:215], v[180:183], v[148:151], v[200:215]
    s_nop 4
    v_mov_b32 v180, 0
    v_mov_b32 v181, 0
    v_mov_b32 v182, 0
    v_mov_b32 v183, 0
    s_mov_b32 exec_lo, 64
    s_mov_b32 exec_hi, 64
    buffer_load_dwordx2 v[224:225], v226, s[76:79], s87 offen offset:512
    s_waitcnt vmcnt(0)
    v_cvt_pk_bf16_f32 v180, v224, v225
    s_mov_b32 exec_lo, 64
    s_mov_b32 exec_hi, 64
    buffer_load_dwordx2 v[224:225], v226, s[76:79], s87 offen offset:520
    s_waitcnt vmcnt(0)
    v_cvt_pk_bf16_f32 v181, v224, v225
    s_mov_b32 exec_lo, 64
    s_mov_b32 exec_hi, 128
    buffer_load_dwordx2 v[224:225], v226, s[76:79], s87 offen offset:528
    s_waitcnt vmcnt(0)
    v_cvt_pk_bf16_f32 v182, v224, v225
    s_mov_b32 exec_lo, 64
    s_mov_b32 exec_hi, 128
    buffer_load_dwordx2 v[224:225], v226, s[76:79], s87 offen offset:536
    s_waitcnt vmcnt(0)
    v_cvt_pk_bf16_f32 v183, v224, v225
    s_mov_b64 exec, -1
    s_nop 1
    v_mfma_f32_32x32x16_bf16 v[184:199], v[180:183], v[152:155], v[184:199]
    v_mfma_f32_32x32x16_bf16 v[200:215], v[180:183], v[156:159], v[200:215]
    s_nop 4
    v_mov_b32 v180, 0
    v_mov_b32 v181, 0
    v_mov_b32 v182, 0
    v_mov_b32 v183, 0
    s_mov_b32 exec_lo, 128
    s_mov_b32 exec_hi, 128
    buffer_load_dwordx2 v[224:225], v226, s[76:79], s87 offen offset:576
    s_waitcnt vmcnt(0)
    v_cvt_pk_bf16_f32 v180, v224, v225
    s_mov_b32 exec_lo, 128
    s_mov_b32 exec_hi, 128
    buffer_load_dwordx2 v[224:225], v226, s[76:79], s87 offen offset:584
    s_waitcnt vmcnt(0)
    v_cvt_pk_bf16_f32 v181, v224, v225
    s_mov_b32 exec_lo, 128
    s_mov_b32 exec_hi, 128
    buffer_load_dwordx2 v[224:225], v226, s[76:79], s87 offen offset:592
    s_waitcnt vmcnt(0)
    v_cvt_pk_bf16_f32 v182, v224, v225
    s_mov_b32 exec_lo, 128
    s_mov_b32 exec_hi, 128
    buffer_load_dwordx2 v[224:225], v226, s[76:79], s87 offen offset:600
    s_waitcnt vmcnt(0)
    v_cvt_pk_bf16_f32 v183, v224, v225
    s_mov_b64 exec, -1
    s_nop 1
    v_mfma_f32_32x32x16_bf16 v[184:199], v[180:183], v[160:163], v[184:199]
    v_mfma_f32_32x32x16_bf16 v[200:215], v[180:183], v[164:167], v[200:215]
    s_nop 4
    s_nop 7
    s_nop 7
    v_mov_b32 v227, v184
    v_mov_b32 v231, v184
    s_nop 1
    v_permlane32_swap_b32 v227, v231
    v_mov_b32 v228, v185
    v_mov_b32 v232, v185
    s_nop 1
    v_permlane32_swap_b32 v228, v232
    v_mov_b32 v229, v186
    v_mov_b32 v233, v186
    s_nop 1
    v_permlane32_swap_b32 v229, v233
    v_mov_b32 v230, v187
    v_mov_b32 v234, v187
    s_nop 1
    v_permlane32_swap_b32 v230, v234
    s_nop 1
    v_cvt_pk_bf16_f32 v77, v227, v227
    v_lshlrev_b32 v227, 16, v77
    v_add_f32 v227, 0x358637bd, v227
    v_cvt_pk_bf16_f32 v77, v227, v227
    v_lshlrev_b32 v227, 16, v77
    v_rcp_f32 v227, v227
    v_cvt_pk_bf16_f32 v77, v228, v228
    v_lshlrev_b32 v228, 16, v77
    v_add_f32 v228, 0x358637bd, v228
    v_cvt_pk_bf16_f32 v77, v228, v228
    v_lshlrev_b32 v228, 16, v77
    v_rcp_f32 v228, v228
    v_cvt_pk_bf16_f32 v77, v229, v229
    v_lshlrev_b32 v229, 16, v77
    v_add_f32 v229, 0x358637bd, v229
    v_cvt_pk_bf16_f32 v77, v229, v229
    v_lshlrev_b32 v229, 16, v77
    v_rcp_f32 v229, v229
    v_cvt_pk_bf16_f32 v77, v230, v230
    v_lshlrev_b32 v230, 16, v77
    v_add_f32 v230, 0x358637bd, v230
    v_cvt_pk_bf16_f32 v77, v230, v230
    v_lshlrev_b32 v230, 16, v77
    v_rcp_f32 v230, v230
    v_cvt_pk_bf16_f32 v77, v231, v231
    v_lshlrev_b32 v231, 16, v77
    v_add_f32 v231, 0x358637bd, v231
    v_cvt_pk_bf16_f32 v77, v231, v231
    v_lshlrev_b32 v231, 16, v77
    v_rcp_f32 v231, v231
    v_cvt_pk_bf16_f32 v77, v232, v232
    v_lshlrev_b32 v232, 16, v77
    v_add_f32 v232, 0x358637bd, v232
    v_cvt_pk_bf16_f32 v77, v232, v232
    v_lshlrev_b32 v232, 16, v77
    v_rcp_f32 v232, v232
    v_cvt_pk_bf16_f32 v77, v233, v233
    v_lshlrev_b32 v233, 16, v77
    v_add_f32 v233, 0x358637bd, v233
    v_cvt_pk_bf16_f32 v77, v233, v233
    v_lshlrev_b32 v233, 16, v77
    v_rcp_f32 v233, v233
    v_cvt_pk_bf16_f32 v77, v234, v234
    v_lshlrev_b32 v234, 16, v77
    v_add_f32 v234, 0x358637bd, v234
    v_cvt_pk_bf16_f32 v77, v234, v234
    v_lshlrev_b32 v234, 16, v77
    v_rcp_f32 v234, v234
    v_mov_b32 v216, v200
    v_mov_b32 v220, v200
    s_nop 1
    v_permlane32_swap_b32 v216, v220
    v_mov_b32 v217, v201
    v_mov_b32 v221, v201
    s_nop 1
    v_permlane32_swap_b32 v217, v221
    v_mov_b32 v218, v202
    v_mov_b32 v222, v202
    s_nop 1
    v_permlane32_swap_b32 v218, v222
    v_mov_b32 v219, v203
    v_mov_b32 v223, v203
    s_nop 1
    v_permlane32_swap_b32 v219, v223
    s_nop 1
    v_cvt_pk_bf16_f32 v77, v216, v216
    v_lshlrev_b32 v216, 16, v77
    v_add_f32 v216, 0x358637bd, v216
    v_cvt_pk_bf16_f32 v77, v216, v216
    v_lshlrev_b32 v216, 16, v77
    v_rcp_f32 v216, v216
    v_cvt_pk_bf16_f32 v77, v217, v217
    v_lshlrev_b32 v217, 16, v77
    v_add_f32 v217, 0x358637bd, v217
    v_cvt_pk_bf16_f32 v77, v217, v217
    v_lshlrev_b32 v217, 16, v77
    v_rcp_f32 v217, v217
    v_cvt_pk_bf16_f32 v77, v218, v218
    v_lshlrev_b32 v218, 16, v77
    v_add_f32 v218, 0x358637bd, v218
    v_cvt_pk_bf16_f32 v77, v218, v218
    v_lshlrev_b32 v218, 16, v77
    v_rcp_f32 v218, v218
    v_cvt_pk_bf16_f32 v77, v219, v219
    v_lshlrev_b32 v219, 16, v77
    v_add_f32 v219, 0x358637bd, v219
    v_cvt_pk_bf16_f32 v77, v219, v219
    v_lshlrev_b32 v219, 16, v77
    v_rcp_f32 v219, v219
    v_cvt_pk_bf16_f32 v77, v220, v220
    v_lshlrev_b32 v220, 16, v77
    v_add_f32 v220, 0x358637bd, v220
    v_cvt_pk_bf16_f32 v77, v220, v220
    v_lshlrev_b32 v220, 16, v77
    v_rcp_f32 v220, v220
    v_cvt_pk_bf16_f32 v77, v221, v221
    v_lshlrev_b32 v221, 16, v77
    v_add_f32 v221, 0x358637bd, v221
    v_cvt_pk_bf16_f32 v77, v221, v221
    v_lshlrev_b32 v221, 16, v77
    v_rcp_f32 v221, v221
    v_cvt_pk_bf16_f32 v77, v222, v222
    v_lshlrev_b32 v222, 16, v77
    v_add_f32 v222, 0x358637bd, v222
    v_cvt_pk_bf16_f32 v77, v222, v222
    v_lshlrev_b32 v222, 16, v77
    v_rcp_f32 v222, v222
    v_cvt_pk_bf16_f32 v77, v223, v223
    v_lshlrev_b32 v223, 16, v77
    v_add_f32 v223, 0x358637bd, v223
    v_cvt_pk_bf16_f32 v77, v223, v223
    v_lshlrev_b32 v223, 16, v77
    v_rcp_f32 v223, v223
    s_mov_b32 s88, 0
    s_mov_b32 s89, -1
    v_and_b32 v235, 31, v76
    v_mul_u32_u24 v235, 1280, v235
    v_lshrrev_b32 v78, 5, v76
    v_lshl_add_u32 v235, v78, 3, v235
    v_and_b32 v238, 15, v76
    v_mov_b32 v184, 0
    v_mov_b32 v185, 0
    v_mov_b32 v186, 0
    v_mov_b32 v187, 0
    v_mov_b32 v188, 0
    v_mov_b32 v189, 0
    v_mov_b32 v190, 0
    v_mov_b32 v191, 0
    v_mov_b32 v192, 0
    v_mov_b32 v193, 0
    v_mov_b32 v194, 0
    v_mov_b32 v195, 0
    v_mov_b32 v196, 0
    v_mov_b32 v197, 0
    v_mov_b32 v198, 0
    v_mov_b32 v199, 0
    v_mov_b32 v200, 0
    v_mov_b32 v201, 0
    v_mov_b32 v202, 0
    v_mov_b32 v203, 0
    v_mov_b32 v204, 0
    v_mov_b32 v205, 0
    v_mov_b32 v206, 0
    v_mov_b32 v207, 0
    v_mov_b32 v208, 0
    v_mov_b32 v209, 0
    v_mov_b32 v210, 0
    v_mov_b32 v211, 0
    v_mov_b32 v212, 0
    v_mov_b32 v213, 0
    v_mov_b32 v214, 0
    v_mov_b32 v215, 0
    s_add_u32 s65, s86, 0
    buffer_load_dwordx4 v[172:175], v169, s[76:79], s65 offen offset:0
    buffer_load_dwordx4 v[176:179], v169, s[76:79], s65 offen offset:16
    s_waitcnt vmcnt(0)
    v_cvt_pk_bf16_f32 v180, v172, v173
    v_cvt_pk_bf16_f32 v181, v174, v175
    v_cvt_pk_bf16_f32 v182, v176, v177
    v_cvt_pk_bf16_f32 v183, v178, v179
    s_nop 1
    v_mfma_f32_32x32x16_bf16 v[184:199], v[180:183], v[88:91], v[184:199]
    v_mfma_f32_32x32x16_bf16 v[200:215], v[180:183], v[92:95], v[200:215]
    s_nop 4
    s_add_u32 s65, s86, 0
    buffer_load_dwordx4 v[172:175], v169, s[76:79], s65 offen offset:64
    buffer_load_dwordx4 v[176:179], v169, s[76:79], s65 offen offset:80
    s_waitcnt vmcnt(0)
    v_cvt_pk_bf16_f32 v180, v172, v173
    v_cvt_pk_bf16_f32 v181, v174, v175
    v_cvt_pk_bf16_f32 v182, v176, v177
    v_cvt_pk_bf16_f32 v183, v178, v179
    s_nop 1
    v_mfma_f32_32x32x16_bf16 v[184:199], v[180:183], v[96:99], v[184:199]
    v_mfma_f32_32x32x16_bf16 v[200:215], v[180:183], v[100:103], v[200:215]
    s_nop 4
    s_add_u32 s65, s86, 0
    buffer_load_dwordx4 v[172:175], v169, s[76:79], s65 offen offset:128
    buffer_load_dwordx4 v[176:179], v169, s[76:79], s65 offen offset:144
    s_waitcnt vmcnt(0)
    v_cvt_pk_bf16_f32 v180, v172, v173
    v_cvt_pk_bf16_f32 v181, v174, v175
    v_cvt_pk_bf16_f32 v182, v176, v177
    v_cvt_pk_bf16_f32 v183, v178, v179
    s_nop 1
    v_mfma_f32_32x32x16_bf16 v[184:199], v[180:183], v[104:107], v[184:199]
    v_mfma_f32_32x32x16_bf16 v[200:215], v[180:183], v[108:111], v[200:215]
    s_nop 4
    s_nop 7
    s_nop 7
    v_cvt_pk_bf16_f32 v236, v184, v185
    v_lshlrev_b32 v184, 16, v236
    v_and_b32 v185, 0xffff0000, v236
    v_cvt_pk_bf16_f32 v237, v186, v187
    v_lshlrev_b32 v186, 16, v237
    v_and_b32 v187, 0xffff0000, v237
    v_mul_f32 v184, v184, v227
    v_mul_f32 v185, v185, v227
    v_mul_f32 v186, v186, v227
    v_mul_f32 v187, v187, v227
    v_cvt_pk_bf16_f32 v236, v184, v185
    v_cvt_pk_bf16_f32 v237, v186, v187
    s_mul_i32 s65, s60, 20
    s_add_u32 s65, s65, 0
    v_xor_b32 v77, s65, v238
    v_lshl_add_u32 v77, v77, 4, v235
    ds_write_b64 v77, v[236:237] offset:0
    s_nop 1
    v_cvt_pk_bf16_f32 v236, v188, v189
    v_lshlrev_b32 v188, 16, v236
    v_and_b32 v189, 0xffff0000, v236
    v_cvt_pk_bf16_f32 v237, v190, v191
    v_lshlrev_b32 v190, 16, v237
    v_and_b32 v191, 0xffff0000, v237
    v_mul_f32 v188, v188, v227
    v_mul_f32 v189, v189, v227
    v_mul_f32 v190, v190, v227
    v_mul_f32 v191, v191, v227
    v_cvt_pk_bf16_f32 v236, v188, v189
    v_cvt_pk_bf16_f32 v237, v190, v191
    s_mul_i32 s65, s60, 20
    s_add_u32 s65, s65, 1
    v_xor_b32 v77, s65, v238
    v_lshl_add_u32 v77, v77, 4, v235
    ds_write_b64 v77, v[236:237] offset:0
    s_nop 1
    v_cvt_pk_bf16_f32 v236, v192, v193
    v_lshlrev_b32 v192, 16, v236
    v_and_b32 v193, 0xffff0000, v236
    v_cvt_pk_bf16_f32 v237, v194, v195
    v_lshlrev_b32 v194, 16, v237
    v_and_b32 v195, 0xffff0000, v237
    v_cndmask_b32 v77, v227, v228, s[88:89]
    v_mul_f32 v192, v192, v77
    v_cndmask_b32 v77, v227, v228, s[88:89]
    v_mul_f32 v193, v193, v77
    v_cndmask_b32 v77, v227, v228, s[88:89]
    v_mul_f32 v194, v194, v77
    v_cndmask_b32 v77, v227, v228, s[88:89]
    v_mul_f32 v195, v195, v77
    v_cvt_pk_bf16_f32 v236, v192, v193
    v_cvt_pk_bf16_f32 v237, v194, v195
    s_mul_i32 s65, s60, 20
    s_add_u32 s65, s65, 2
    v_xor_b32 v77, s65, v238
    v_lshl_add_u32 v77, v77, 4, v235
    ds_write_b64 v77, v[236:237] offset:0
    s_nop 1
    v_cvt_pk_bf16_f32 v236, v196, v197
    v_lshlrev_b32 v196, 16, v236
    v_and_b32 v197, 0xffff0000, v236
    v_cvt_pk_bf16_f32 v237, v198, v199
    v_lshlrev_b32 v198, 16, v237
    v_and_b32 v199, 0xffff0000, v237
    v_mul_f32 v196, v196, v228
    v_mul_f32 v197, v197, v228
    v_mul_f32 v198, v198, v228
    v_mul_f32 v199, v199, v228
    v_cvt_pk_bf16_f32 v236, v196, v197
    v_cvt_pk_bf16_f32 v237, v198, v199
    s_mul_i32 s65, s60, 20
    s_add_u32 s65, s65, 3
    v_xor_b32 v77, s65, v238
    v_lshl_add_u32 v77, v77, 4, v235
    ds_write_b64 v77, v[236:237] offset:0
    s_nop 1
    v_cvt_pk_bf16_f32 v236, v200, v201
    v_lshlrev_b32 v200, 16, v236
    v_and_b32 v201, 0xffff0000, v236
    v_cvt_pk_bf16_f32 v237, v202, v203
    v_lshlrev_b32 v202, 16, v237
    v_and_b32 v203, 0xffff0000, v237
    v_mul_f32 v200, v200, v216
    v_mul_f32 v201, v201, v216
    v_mul_f32 v202, v202, v216
    v_mul_f32 v203, v203, v216
    v_cvt_pk_bf16_f32 v236, v200, v201
    v_cvt_pk_bf16_f32 v237, v202, v203
    s_mul_i32 s65, s60, 20
    s_add_u32 s65, s65, 0
    v_xor_b32 v77, s65, v238
    v_lshl_add_u32 v77, v77, 4, v235
    ds_write_b64 v77, v[236:237] offset:40960
    s_nop 1
    v_cvt_pk_bf16_f32 v236, v204, v205
    v_lshlrev_b32 v204, 16, v236
    v_and_b32 v205, 0xffff0000, v236
    v_cvt_pk_bf16_f32 v237, v206, v207
    v_lshlrev_b32 v206, 16, v237
    v_and_b32 v207, 0xffff0000, v237
    v_mul_f32 v204, v204, v216
    v_mul_f32 v205, v205, v216
    v_mul_f32 v206, v206, v216
    v_mul_f32 v207, v207, v216
    v_cvt_pk_bf16_f32 v236, v204, v205
    v_cvt_pk_bf16_f32 v237, v206, v207
    s_mul_i32 s65, s60, 20
    s_add_u32 s65, s65, 1
    v_xor_b32 v77, s65, v238
    v_lshl_add_u32 v77, v77, 4, v235
    ds_write_b64 v77, v[236:237] offset:40960
    s_nop 1
    v_cvt_pk_bf16_f32 v236, v208, v209
    v_lshlrev_b32 v208, 16, v236
    v_and_b32 v209, 0xffff0000, v236
    v_cvt_pk_bf16_f32 v237, v210, v211
    v_lshlrev_b32 v210, 16, v237
    v_and_b32 v211, 0xffff0000, v237
    v_cndmask_b32 v77, v216, v217, s[88:89]
    v_mul_f32 v208, v208, v77
    v_cndmask_b32 v77, v216, v217, s[88:89]
    v_mul_f32 v209, v209, v77
    v_cndmask_b32 v77, v216, v217, s[88:89]
    v_mul_f32 v210, v210, v77
    v_cndmask_b32 v77, v216, v217, s[88:89]
    v_mul_f32 v211, v211, v77
    v_cvt_pk_bf16_f32 v236, v208, v209
    v_cvt_pk_bf16_f32 v237, v210, v211
    s_mul_i32 s65, s60, 20
    s_add_u32 s65, s65, 2
    v_xor_b32 v77, s65, v238
    v_lshl_add_u32 v77, v77, 4, v235
    ds_write_b64 v77, v[236:237] offset:40960
    s_nop 1
    v_cvt_pk_bf16_f32 v236, v212, v213
    v_lshlrev_b32 v212, 16, v236
    v_and_b32 v213, 0xffff0000, v236
    v_cvt_pk_bf16_f32 v237, v214, v215
    v_lshlrev_b32 v214, 16, v237
    v_and_b32 v215, 0xffff0000, v237
    v_mul_f32 v212, v212, v217
    v_mul_f32 v213, v213, v217
    v_mul_f32 v214, v214, v217
    v_mul_f32 v215, v215, v217
    v_cvt_pk_bf16_f32 v236, v212, v213
    v_cvt_pk_bf16_f32 v237, v214, v215
    s_mul_i32 s65, s60, 20
    s_add_u32 s65, s65, 3
    v_xor_b32 v77, s65, v238
    v_lshl_add_u32 v77, v77, 4, v235
    ds_write_b64 v77, v[236:237] offset:40960
    s_nop 1
    v_mov_b32 v184, 0
    v_mov_b32 v185, 0
    v_mov_b32 v186, 0
    v_mov_b32 v187, 0
    v_mov_b32 v188, 0
    v_mov_b32 v189, 0
    v_mov_b32 v190, 0
    v_mov_b32 v191, 0
    v_mov_b32 v192, 0
    v_mov_b32 v193, 0
    v_mov_b32 v194, 0
    v_mov_b32 v195, 0
    v_mov_b32 v196, 0
    v_mov_b32 v197, 0
    v_mov_b32 v198, 0
    v_mov_b32 v199, 0
    v_mov_b32 v200, 0
    v_mov_b32 v201, 0
    v_mov_b32 v202, 0
    v_mov_b32 v203, 0
    v_mov_b32 v204, 0
    v_mov_b32 v205, 0
    v_mov_b32 v206, 0
    v_mov_b32 v207, 0
    v_mov_b32 v208, 0
    v_mov_b32 v209, 0
    v_mov_b32 v210, 0
    v_mov_b32 v211, 0
    v_mov_b32 v212, 0
    v_mov_b32 v213, 0
    v_mov_b32 v214, 0
    v_mov_b32 v215, 0
    s_add_u32 s65, s86, 8192
    buffer_load_dwordx4 v[172:175], v169, s[76:79], s65 offen offset:0
    buffer_load_dwordx4 v[176:179], v169, s[76:79], s65 offen offset:16
    s_waitcnt vmcnt(0)
    v_cvt_pk_bf16_f32 v180, v172, v173
    v_cvt_pk_bf16_f32 v181, v174, v175
    v_cvt_pk_bf16_f32 v182, v176, v177
    v_cvt_pk_bf16_f32 v183, v178, v179
    s_nop 1
    v_mfma_f32_32x32x16_bf16 v[184:199], v[180:183], v[96:99], v[184:199]
    v_mfma_f32_32x32x16_bf16 v[200:215], v[180:183], v[100:103], v[200:215]
    s_nop 4
    s_add_u32 s65, s86, 8192
    buffer_load_dwordx4 v[172:175], v169, s[76:79], s65 offen offset:64
    buffer_load_dwordx4 v[176:179], v169, s[76:79], s65 offen offset:80
    s_waitcnt vmcnt(0)
    v_cvt_pk_bf16_f32 v180, v172, v173
    v_cvt_pk_bf16_f32 v181, v174, v175
    v_cvt_pk_bf16_f32 v182, v176, v177
    v_cvt_pk_bf16_f32 v183, v178, v179
    s_nop 1
    v_mfma_f32_32x32x16_bf16 v[184:199], v[180:183], v[104:107], v[184:199]
    v_mfma_f32_32x32x16_bf16 v[200:215], v[180:183], v[108:111], v[200:215]
    s_nop 4
    s_add_u32 s65, s86, 8192
    buffer_load_dwordx4 v[172:175], v169, s[76:79], s65 offen offset:128
    buffer_load_dwordx4 v[176:179], v169, s[76:79], s65 offen offset:144
    s_waitcnt vmcnt(0)
    v_cvt_pk_bf16_f32 v180, v172, v173
    v_cvt_pk_bf16_f32 v181, v174, v175
    v_cvt_pk_bf16_f32 v182, v176, v177
    v_cvt_pk_bf16_f32 v183, v178, v179
    s_nop 1
    v_mfma_f32_32x32x16_bf16 v[184:199], v[180:183], v[112:115], v[184:199]
    v_mfma_f32_32x32x16_bf16 v[200:215], v[180:183], v[116:119], v[200:215]
    s_nop 4
    s_add_u32 s65, s86, 8192
    buffer_load_dwordx4 v[172:175], v169, s[76:79], s65 offen offset:192
    buffer_load_dwordx4 v[176:179], v169, s[76:79], s65 offen offset:208
    s_waitcnt vmcnt(0)
    v_cvt_pk_bf16_f32 v180, v172, v173
    v_cvt_pk_bf16_f32 v181, v174, v175
    v_cvt_pk_bf16_f32 v182, v176, v177
    v_cvt_pk_bf16_f32 v183, v178, v179
    s_nop 1
    v_mfma_f32_32x32x16_bf16 v[184:199], v[180:183], v[120:123], v[184:199]
    v_mfma_f32_32x32x16_bf16 v[200:215], v[180:183], v[124:127], v[200:215]
    s_nop 4
    s_nop 7
    s_nop 7
    v_cvt_pk_bf16_f32 v236, v184, v185
    v_lshlrev_b32 v184, 16, v236
    v_and_b32 v185, 0xffff0000, v236
    v_cvt_pk_bf16_f32 v237, v186, v187
    v_lshlrev_b32 v186, 16, v237
    v_and_b32 v187, 0xffff0000, v237
    v_mul_f32 v184, v184, v228
    v_mul_f32 v185, v185, v228
    v_mul_f32 v186, v186, v228
    v_mul_f32 v187, v187, v228
    v_cvt_pk_bf16_f32 v236, v184, v185
    v_cvt_pk_bf16_f32 v237, v186, v187
    s_mul_i32 s65, s60, 20
    s_add_u32 s65, s65, 4
    v_xor_b32 v77, s65, v238
    v_lshl_add_u32 v77, v77, 4, v235
    ds_write_b64 v77, v[236:237] offset:0
    s_nop 1
    v_cvt_pk_bf16_f32 v236, v188, v189
    v_lshlrev_b32 v188, 16, v236
    v_and_b32 v189, 0xffff0000, v236
    v_cvt_pk_bf16_f32 v237, v190, v191
    v_lshlrev_b32 v190, 16, v237
    v_and_b32 v191, 0xffff0000, v237
    v_mul_f32 v188, v188, v229
    v_mul_f32 v189, v189, v229
    v_mul_f32 v190, v190, v229
    v_mul_f32 v191, v191, v229
    v_cvt_pk_bf16_f32 v236, v188, v189
    v_cvt_pk_bf16_f32 v237, v190, v191
    s_mul_i32 s65, s60, 20
    s_add_u32 s65, s65, 5
    v_xor_b32 v77, s65, v238
    v_lshl_add_u32 v77, v77, 4, v235
    ds_write_b64 v77, v[236:237] offset:0
    s_nop 1
    v_cvt_pk_bf16_f32 v236, v192, v193
    v_lshlrev_b32 v192, 16, v236
    v_and_b32 v193, 0xffff0000, v236
    v_cvt_pk_bf16_f32 v237, v194, v195
    v_lshlrev_b32 v194, 16, v237
    v_and_b32 v195, 0xffff0000, v237
    v_mul_f32 v192, v192, v229
    v_mul_f32 v193, v193, v229
    v_mul_f32 v194, v194, v229
    v_mul_f32 v195, v195, v229
    v_cvt_pk_bf16_f32 v236, v192, v193
    v_cvt_pk_bf16_f32 v237, v194, v195
    s_mul_i32 s65, s60, 20
    s_add_u32 s65, s65, 6
    v_xor_b32 v77, s65, v238
    v_lshl_add_u32 v77, v77, 4, v235
    ds_write_b64 v77, v[236:237] offset:0
    s_nop 1
    v_cvt_pk_bf16_f32 v236, v196, v197
    v_lshlrev_b32 v196, 16, v236
    v_and_b32 v197, 0xffff0000, v236
    v_cvt_pk_bf16_f32 v237, v198, v199
    v_lshlrev_b32 v198, 16, v237
    v_and_b32 v199, 0xffff0000, v237
    v_cndmask_b32 v77, v229, v230, s[88:89]
    v_mul_f32 v196, v196, v77
    v_cndmask_b32 v77, v229, v230, s[88:89]
    v_mul_f32 v197, v197, v77
    v_cndmask_b32 v77, v229, v230, s[88:89]
    v_mul_f32 v198, v198, v77
    v_cndmask_b32 v77, v229, v230, s[88:89]
    v_mul_f32 v199, v199, v77
    v_cvt_pk_bf16_f32 v236, v196, v197
    v_cvt_pk_bf16_f32 v237, v198, v199
    s_mul_i32 s65, s60, 20
    s_add_u32 s65, s65, 7
    v_xor_b32 v77, s65, v238
    v_lshl_add_u32 v77, v77, 4, v235
    ds_write_b64 v77, v[236:237] offset:0
    s_nop 1
    v_cvt_pk_bf16_f32 v236, v200, v201
    v_lshlrev_b32 v200, 16, v236
    v_and_b32 v201, 0xffff0000, v236
    v_cvt_pk_bf16_f32 v237, v202, v203
    v_lshlrev_b32 v202, 16, v237
    v_and_b32 v203, 0xffff0000, v237
    v_mul_f32 v200, v200, v217
    v_mul_f32 v201, v201, v217
    v_mul_f32 v202, v202, v217
    v_mul_f32 v203, v203, v217
    v_cvt_pk_bf16_f32 v236, v200, v201
    v_cvt_pk_bf16_f32 v237, v202, v203
    s_mul_i32 s65, s60, 20
    s_add_u32 s65, s65, 4
    v_xor_b32 v77, s65, v238
    v_lshl_add_u32 v77, v77, 4, v235
    ds_write_b64 v77, v[236:237] offset:40960
    s_nop 1
    v_cvt_pk_bf16_f32 v236, v204, v205
    v_lshlrev_b32 v204, 16, v236
    v_and_b32 v205, 0xffff0000, v236
    v_cvt_pk_bf16_f32 v237, v206, v207
    v_lshlrev_b32 v206, 16, v237
    v_and_b32 v207, 0xffff0000, v237
    v_mul_f32 v204, v204, v218
    v_mul_f32 v205, v205, v218
    v_mul_f32 v206, v206, v218
    v_mul_f32 v207, v207, v218
    v_cvt_pk_bf16_f32 v236, v204, v205
    v_cvt_pk_bf16_f32 v237, v206, v207
    s_mul_i32 s65, s60, 20
    s_add_u32 s65, s65, 5
    v_xor_b32 v77, s65, v238
    v_lshl_add_u32 v77, v77, 4, v235
    ds_write_b64 v77, v[236:237] offset:40960
    s_nop 1
    v_cvt_pk_bf16_f32 v236, v208, v209
    v_lshlrev_b32 v208, 16, v236
    v_and_b32 v209, 0xffff0000, v236
    v_cvt_pk_bf16_f32 v237, v210, v211
    v_lshlrev_b32 v210, 16, v237
    v_and_b32 v211, 0xffff0000, v237
    v_mul_f32 v208, v208, v218
    v_mul_f32 v209, v209, v218
    v_mul_f32 v210, v210, v218
    v_mul_f32 v211, v211, v218
    v_cvt_pk_bf16_f32 v236, v208, v209
    v_cvt_pk_bf16_f32 v237, v210, v211
    s_mul_i32 s65, s60, 20
    s_add_u32 s65, s65, 6
    v_xor_b32 v77, s65, v238
    v_lshl_add_u32 v77, v77, 4, v235
    ds_write_b64 v77, v[236:237] offset:40960
    s_nop 1
    v_cvt_pk_bf16_f32 v236, v212, v213
    v_lshlrev_b32 v212, 16, v236
    v_and_b32 v213, 0xffff0000, v236
    v_cvt_pk_bf16_f32 v237, v214, v215
    v_lshlrev_b32 v214, 16, v237
    v_and_b32 v215, 0xffff0000, v237
    v_cndmask_b32 v77, v218, v219, s[88:89]
    v_mul_f32 v212, v212, v77
    v_cndmask_b32 v77, v218, v219, s[88:89]
    v_mul_f32 v213, v213, v77
    v_cndmask_b32 v77, v218, v219, s[88:89]
    v_mul_f32 v214, v214, v77
    v_cndmask_b32 v77, v218, v219, s[88:89]
    v_mul_f32 v215, v215, v77
    v_cvt_pk_bf16_f32 v236, v212, v213
    v_cvt_pk_bf16_f32 v237, v214, v215
    s_mul_i32 s65, s60, 20
    s_add_u32 s65, s65, 7
    v_xor_b32 v77, s65, v238
    v_lshl_add_u32 v77, v77, 4, v235
    ds_write_b64 v77, v[236:237] offset:40960
    s_nop 1
    v_mov_b32 v184, 0
    v_mov_b32 v185, 0
    v_mov_b32 v186, 0
    v_mov_b32 v187, 0
    v_mov_b32 v188, 0
    v_mov_b32 v189, 0
    v_mov_b32 v190, 0
    v_mov_b32 v191, 0
    v_mov_b32 v192, 0
    v_mov_b32 v193, 0
    v_mov_b32 v194, 0
    v_mov_b32 v195, 0
    v_mov_b32 v196, 0
    v_mov_b32 v197, 0
    v_mov_b32 v198, 0
    v_mov_b32 v199, 0
    v_mov_b32 v200, 0
    v_mov_b32 v201, 0
    v_mov_b32 v202, 0
    v_mov_b32 v203, 0
    v_mov_b32 v204, 0
    v_mov_b32 v205, 0
    v_mov_b32 v206, 0
    v_mov_b32 v207, 0
    v_mov_b32 v208, 0
    v_mov_b32 v209, 0
    v_mov_b32 v210, 0
    v_mov_b32 v211, 0
    v_mov_b32 v212, 0
    v_mov_b32 v213, 0
    v_mov_b32 v214, 0
    v_mov_b32 v215, 0
    s_add_u32 s65, s86, 16384
    buffer_load_dwordx4 v[172:175], v169, s[76:79], s65 offen offset:0
    buffer_load_dwordx4 v[176:179], v169, s[76:79], s65 offen offset:16
    s_waitcnt vmcnt(0)
    v_cvt_pk_bf16_f32 v180, v172, v173
    v_cvt_pk_bf16_f32 v181, v174, v175
    v_cvt_pk_bf16_f32 v182, v176, v177
    v_cvt_pk_bf16_f32 v183, v178, v179
    s_nop 1
    v_mfma_f32_32x32x16_bf16 v[184:199], v[180:183], v[112:115], v[184:199]
    v_mfma_f32_32x32x16_bf16 v[200:215], v[180:183], v[116:119], v[200:215]
    s_nop 4
    s_add_u32 s65, s86, 16384
    buffer_load_dwordx4 v[172:175], v169, s[76:79], s65 offen offset:64
    buffer_load_dwordx4 v[176:179], v169, s[76:79], s65 offen offset:80
    s_waitcnt vmcnt(0)
    v_cvt_pk_bf16_f32 v180, v172, v173
    v_cvt_pk_bf16_f32 v181, v174, v175
    v_cvt_pk_bf16_f32 v182, v176, v177
    v_cvt_pk_bf16_f32 v183, v178, v179
    s_nop 1
    v_mfma_f32_32x32x16_bf16 v[184:199], v[180:183], v[120:123], v[184:199]
    v_mfma_f32_32x32x16_bf16 v[200:215], v[180:183], v[124:127], v[200:215]
    s_nop 4
    s_add_u32 s65, s86, 16384
    buffer_load_dwordx4 v[172:175], v169, s[76:79], s65 offen offset:128
    buffer_load_dwordx4 v[176:179], v169, s[76:79], s65 offen offset:144
    s_waitcnt vmcnt(0)
    v_cvt_pk_bf16_f32 v180, v172, v173
    v_cvt_pk_bf16_f32 v181, v174, v175
    v_cvt_pk_bf16_f32 v182, v176, v177
    v_cvt_pk_bf16_f32 v183, v178, v179
    s_nop 1
    v_mfma_f32_32x32x16_bf16 v[184:199], v[180:183], v[128:131], v[184:199]
    v_mfma_f32_32x32x16_bf16 v[200:215], v[180:183], v[132:135], v[200:215]
    s_nop 4
    s_add_u32 s65, s86, 16384
    buffer_load_dwordx4 v[172:175], v169, s[76:79], s65 offen offset:192
    buffer_load_dwordx4 v[176:179], v169, s[76:79], s65 offen offset:208
    s_waitcnt vmcnt(0)
    v_cvt_pk_bf16_f32 v180, v172, v173
    v_cvt_pk_bf16_f32 v181, v174, v175
    v_cvt_pk_bf16_f32 v182, v176, v177
    v_cvt_pk_bf16_f32 v183, v178, v179
    s_nop 1
    v_mfma_f32_32x32x16_bf16 v[184:199], v[180:183], v[136:139], v[184:199]
    v_mfma_f32_32x32x16_bf16 v[200:215], v[180:183], v[140:143], v[200:215]
    s_nop 4
    s_nop 7
    s_nop 7
    v_cvt_pk_bf16_f32 v236, v184, v185
    v_lshlrev_b32 v184, 16, v236
    v_and_b32 v185, 0xffff0000, v236
    v_cvt_pk_bf16_f32 v237, v186, v187
    v_lshlrev_b32 v186, 16, v237
    v_and_b32 v187, 0xffff0000, v237
    v_mul_f32 v184, v184, v230
    v_mul_f32 v185, v185, v230
    v_mul_f32 v186, v186, v230
    v_mul_f32 v187, v187, v230
    v_cvt_pk_bf16_f32 v236, v184, v185
    v_cvt_pk_bf16_f32 v237, v186, v187
    s_mul_i32 s65, s60, 20
    s_add_u32 s65, s65, 8
    v_xor_b32 v77, s65, v238
    v_lshl_add_u32 v77, v77, 4, v235
    ds_write_b64 v77, v[236:237] offset:0
    s_nop 1
    v_cvt_pk_bf16_f32 v236, v188, v189
    v_lshlrev_b32 v188, 16, v236
    v_and_b32 v189, 0xffff0000, v236
    v_cvt_pk_bf16_f32 v237, v190, v191
    v_lshlrev_b32 v190, 16, v237
    v_and_b32 v191, 0xffff0000, v237
    v_mul_f32 v188, v188, v230
    v_mul_f32 v189, v189, v230
    v_mul_f32 v190, v190, v230
    v_mul_f32 v191, v191, v230
    v_cvt_pk_bf16_f32 v236, v188, v189
    v_cvt_pk_bf16_f32 v237, v190, v191
    s_mul_i32 s65, s60, 20
    s_add_u32 s65, s65, 9
    v_xor_b32 v77, s65, v238
    v_lshl_add_u32 v77, v77, 4, v235
    ds_write_b64 v77, v[236:237] offset:0
    s_nop 1
    v_cvt_pk_bf16_f32 v236, v192, v193
    v_lshlrev_b32 v192, 16, v236
    v_and_b32 v193, 0xffff0000, v236
    v_cvt_pk_bf16_f32 v237, v194, v195
    v_lshlrev_b32 v194, 16, v237
    v_and_b32 v195, 0xffff0000, v237
    v_mul_f32 v192, v192, v231
    v_mul_f32 v193, v193, v231
    v_mul_f32 v194, v194, v231
    v_mul_f32 v195, v195, v231
    v_cvt_pk_bf16_f32 v236, v192, v193
    v_cvt_pk_bf16_f32 v237, v194, v195
    s_mul_i32 s65, s60, 20
    s_add_u32 s65, s65, 10
    v_xor_b32 v77, s65, v238
    v_lshl_add_u32 v77, v77, 4, v235
    ds_write_b64 v77, v[236:237] offset:0
    s_nop 1
    v_cvt_pk_bf16_f32 v236, v196, v197
    v_lshlrev_b32 v196, 16, v236
    v_and_b32 v197, 0xffff0000, v236
    v_cvt_pk_bf16_f32 v237, v198, v199
    v_lshlrev_b32 v198, 16, v237
    v_and_b32 v199, 0xffff0000, v237
    v_mul_f32 v196, v196, v231
    v_mul_f32 v197, v197, v231
    v_mul_f32 v198, v198, v231
    v_mul_f32 v199, v199, v231
    v_cvt_pk_bf16_f32 v236, v196, v197
    v_cvt_pk_bf16_f32 v237, v198, v199
    s_mul_i32 s65, s60, 20
    s_add_u32 s65, s65, 11
    v_xor_b32 v77, s65, v238
    v_lshl_add_u32 v77, v77, 4, v235
    ds_write_b64 v77, v[236:237] offset:0
    s_nop 1
    v_cvt_pk_bf16_f32 v236, v200, v201
    v_lshlrev_b32 v200, 16, v236
    v_and_b32 v201, 0xffff0000, v236
    v_cvt_pk_bf16_f32 v237, v202, v203
    v_lshlrev_b32 v202, 16, v237
    v_and_b32 v203, 0xffff0000, v237
    v_mul_f32 v200, v200, v219
    v_mul_f32 v201, v201, v219
    v_mul_f32 v202, v202, v219
    v_mul_f32 v203, v203, v219
    v_cvt_pk_bf16_f32 v236, v200, v201
    v_cvt_pk_bf16_f32 v237, v202, v203
    s_mul_i32 s65, s60, 20
    s_add_u32 s65, s65, 8
    v_xor_b32 v77, s65, v238
    v_lshl_add_u32 v77, v77, 4, v235
    ds_write_b64 v77, v[236:237] offset:40960
    s_nop 1
    v_cvt_pk_bf16_f32 v236, v204, v205
    v_lshlrev_b32 v204, 16, v236
    v_and_b32 v205, 0xffff0000, v236
    v_cvt_pk_bf16_f32 v237, v206, v207
    v_lshlrev_b32 v206, 16, v237
    v_and_b32 v207, 0xffff0000, v237
    v_mul_f32 v204, v204, v219
    v_mul_f32 v205, v205, v219
    v_mul_f32 v206, v206, v219
    v_mul_f32 v207, v207, v219
    v_cvt_pk_bf16_f32 v236, v204, v205
    v_cvt_pk_bf16_f32 v237, v206, v207
    s_mul_i32 s65, s60, 20
    s_add_u32 s65, s65, 9
    v_xor_b32 v77, s65, v238
    v_lshl_add_u32 v77, v77, 4, v235
    ds_write_b64 v77, v[236:237] offset:40960
    s_nop 1
    v_cvt_pk_bf16_f32 v236, v208, v209
    v_lshlrev_b32 v208, 16, v236
    v_and_b32 v209, 0xffff0000, v236
    v_cvt_pk_bf16_f32 v237, v210, v211
    v_lshlrev_b32 v210, 16, v237
    v_and_b32 v211, 0xffff0000, v237
    v_mul_f32 v208, v208, v220
    v_mul_f32 v209, v209, v220
    v_mul_f32 v210, v210, v220
    v_mul_f32 v211, v211, v220
    v_cvt_pk_bf16_f32 v236, v208, v209
    v_cvt_pk_bf16_f32 v237, v210, v211
    s_mul_i32 s65, s60, 20
    s_add_u32 s65, s65, 10
    v_xor_b32 v77, s65, v238
    v_lshl_add_u32 v77, v77, 4, v235
    ds_write_b64 v77, v[236:237] offset:40960
    s_nop 1
    v_cvt_pk_bf16_f32 v236, v212, v213
    v_lshlrev_b32 v212, 16, v236
    v_and_b32 v213, 0xffff0000, v236
    v_cvt_pk_bf16_f32 v237, v214, v215
    v_lshlrev_b32 v214, 16, v237
    v_and_b32 v215, 0xffff0000, v237
    v_mul_f32 v212, v212, v220
    v_mul_f32 v213, v213, v220
    v_mul_f32 v214, v214, v220
    v_mul_f32 v215, v215, v220
    v_cvt_pk_bf16_f32 v236, v212, v213
    v_cvt_pk_bf16_f32 v237, v214, v215
    s_mul_i32 s65, s60, 20
    s_add_u32 s65, s65, 11
    v_xor_b32 v77, s65, v238
    v_lshl_add_u32 v77, v77, 4, v235
    ds_write_b64 v77, v[236:237] offset:40960
    s_nop 1
    v_mov_b32 v184, 0
    v_mov_b32 v185, 0
    v_mov_b32 v186, 0
    v_mov_b32 v187, 0
    v_mov_b32 v188, 0
    v_mov_b32 v189, 0
    v_mov_b32 v190, 0
    v_mov_b32 v191, 0
    v_mov_b32 v192, 0
    v_mov_b32 v193, 0
    v_mov_b32 v194, 0
    v_mov_b32 v195, 0
    v_mov_b32 v196, 0
    v_mov_b32 v197, 0
    v_mov_b32 v198, 0
    v_mov_b32 v199, 0
    v_mov_b32 v200, 0
    v_mov_b32 v201, 0
    v_mov_b32 v202, 0
    v_mov_b32 v203, 0
    v_mov_b32 v204, 0
    v_mov_b32 v205, 0
    v_mov_b32 v206, 0
    v_mov_b32 v207, 0
    v_mov_b32 v208, 0
    v_mov_b32 v209, 0
    v_mov_b32 v210, 0
    v_mov_b32 v211, 0
    v_mov_b32 v212, 0
    v_mov_b32 v213, 0
    v_mov_b32 v214, 0
    v_mov_b32 v215, 0
    s_add_u32 s65, s86, 24576
    buffer_load_dwordx4 v[172:175], v169, s[76:79], s65 offen offset:0
    buffer_load_dwordx4 v[176:179], v169, s[76:79], s65 offen offset:16
    s_waitcnt vmcnt(0)
    v_cvt_pk_bf16_f32 v180, v172, v173
    v_cvt_pk_bf16_f32 v181, v174, v175
    v_cvt_pk_bf16_f32 v182, v176, v177
    v_cvt_pk_bf16_f32 v183, v178, v179
    s_nop 1
    v_mfma_f32_32x32x16_bf16 v[184:199], v[180:183], v[128:131], v[184:199]
    v_mfma_f32_32x32x16_bf16 v[200:215], v[180:183], v[132:135], v[200:215]
    s_nop 4
    s_add_u32 s65, s86, 24576
    buffer_load_dwordx4 v[172:175], v169, s[76:79], s65 offen offset:64
    buffer_load_dwordx4 v[176:179], v169, s[76:79], s65 offen offset:80
    s_waitcnt vmcnt(0)
    v_cvt_pk_bf16_f32 v180, v172, v173
    v_cvt_pk_bf16_f32 v181, v174, v175
    v_cvt_pk_bf16_f32 v182, v176, v177
    v_cvt_pk_bf16_f32 v183, v178, v179
    s_nop 1
    v_mfma_f32_32x32x16_bf16 v[184:199], v[180:183], v[136:139], v[184:199]
    v_mfma_f32_32x32x16_bf16 v[200:215], v[180:183], v[140:143], v[200:215]
    s_nop 4
    s_add_u32 s65, s86, 24576
    buffer_load_dwordx4 v[172:175], v169, s[76:79], s65 offen offset:128
    buffer_load_dwordx4 v[176:179], v169, s[76:79], s65 offen offset:144
    s_waitcnt vmcnt(0)
    v_cvt_pk_bf16_f32 v180, v172, v173
    v_cvt_pk_bf16_f32 v181, v174, v175
    v_cvt_pk_bf16_f32 v182, v176, v177
    v_cvt_pk_bf16_f32 v183, v178, v179
    s_nop 1
    v_mfma_f32_32x32x16_bf16 v[184:199], v[180:183], v[144:147], v[184:199]
    v_mfma_f32_32x32x16_bf16 v[200:215], v[180:183], v[148:151], v[200:215]
    s_nop 4
    s_add_u32 s65, s86, 24576
    buffer_load_dwordx4 v[172:175], v169, s[76:79], s65 offen offset:192
    buffer_load_dwordx4 v[176:179], v169, s[76:79], s65 offen offset:208
    s_waitcnt vmcnt(0)
    v_cvt_pk_bf16_f32 v180, v172, v173
    v_cvt_pk_bf16_f32 v181, v174, v175
    v_cvt_pk_bf16_f32 v182, v176, v177
    v_cvt_pk_bf16_f32 v183, v178, v179
    s_nop 1
    v_mfma_f32_32x32x16_bf16 v[184:199], v[180:183], v[152:155], v[184:199]
    v_mfma_f32_32x32x16_bf16 v[200:215], v[180:183], v[156:159], v[200:215]
    s_nop 4
    s_nop 7
    s_nop 7
    v_cvt_pk_bf16_f32 v236, v184, v185
    v_lshlrev_b32 v184, 16, v236
    v_and_b32 v185, 0xffff0000, v236
    v_cvt_pk_bf16_f32 v237, v186, v187
    v_lshlrev_b32 v186, 16, v237
    v_and_b32 v187, 0xffff0000, v237
    v_cndmask_b32 v77, v231, v232, s[88:89]
    v_mul_f32 v184, v184, v77
    v_cndmask_b32 v77, v231, v232, s[88:89]
    v_mul_f32 v185, v185, v77
    v_cndmask_b32 v77, v231, v232, s[88:89]
    v_mul_f32 v186, v186, v77
    v_cndmask_b32 v77, v231, v232, s[88:89]
    v_mul_f32 v187, v187, v77
    v_cvt_pk_bf16_f32 v236, v184, v185
    v_cvt_pk_bf16_f32 v237, v186, v187
    s_mul_i32 s65, s60, 20
    s_add_u32 s65, s65, 12
    v_xor_b32 v77, s65, v238
    v_lshl_add_u32 v77, v77, 4, v235
    ds_write_b64 v77, v[236:237] offset:0
    s_nop 1
    v_cvt_pk_bf16_f32 v236, v188, v189
    v_lshlrev_b32 v188, 16, v236
    v_and_b32 v189, 0xffff0000, v236
    v_cvt_pk_bf16_f32 v237, v190, v191
    v_lshlrev_b32 v190, 16, v237
    v_and_b32 v191, 0xffff0000, v237
    v_mul_f32 v188, v188, v232
    v_mul_f32 v189, v189, v232
    v_mul_f32 v190, v190, v232
    v_mul_f32 v191, v191, v232
    v_cvt_pk_bf16_f32 v236, v188, v189
    v_cvt_pk_bf16_f32 v237, v190, v191
    s_mul_i32 s65, s60, 20
    s_add_u32 s65, s65, 13
    v_xor_b32 v77, s65, v238
    v_lshl_add_u32 v77, v77, 4, v235
    ds_write_b64 v77, v[236:237] offset:0
    s_nop 1
    v_cvt_pk_bf16_f32 v236, v192, v193
    v_lshlrev_b32 v192, 16, v236
    v_and_b32 v193, 0xffff0000, v236
    v_cvt_pk_bf16_f32 v237, v194, v195
    v_lshlrev_b32 v194, 16, v237
    v_and_b32 v195, 0xffff0000, v237
    v_mul_f32 v192, v192, v232
    v_mul_f32 v193, v193, v232
    v_mul_f32 v194, v194, v232
    v_mul_f32 v195, v195, v232
    v_cvt_pk_bf16_f32 v236, v192, v193
    v_cvt_pk_bf16_f32 v237, v194, v195
    s_mul_i32 s65, s60, 20
    s_add_u32 s65, s65, 14
    v_xor_b32 v77, s65, v238
    v_lshl_add_u32 v77, v77, 4, v235
    ds_write_b64 v77, v[236:237] offset:0
    s_nop 1
    v_cvt_pk_bf16_f32 v236, v196, v197
    v_lshlrev_b32 v196, 16, v236
    v_and_b32 v197, 0xffff0000, v236
    v_cvt_pk_bf16_f32 v237, v198, v199
    v_lshlrev_b32 v198, 16, v237
    v_and_b32 v199, 0xffff0000, v237
    v_mul_f32 v196, v196, v233
    v_mul_f32 v197, v197, v233
    v_mul_f32 v198, v198, v233
    v_mul_f32 v199, v199, v233
    v_cvt_pk_bf16_f32 v236, v196, v197
    v_cvt_pk_bf16_f32 v237, v198, v199
    s_mul_i32 s65, s60, 20
    s_add_u32 s65, s65, 15
    v_xor_b32 v77, s65, v238
    v_lshl_add_u32 v77, v77, 4, v235
    ds_write_b64 v77, v[236:237] offset:0
    s_nop 1
    v_cvt_pk_bf16_f32 v236, v200, v201
    v_lshlrev_b32 v200, 16, v236
    v_and_b32 v201, 0xffff0000, v236
    v_cvt_pk_bf16_f32 v237, v202, v203
    v_lshlrev_b32 v202, 16, v237
    v_and_b32 v203, 0xffff0000, v237
    v_cndmask_b32 v77, v220, v221, s[88:89]
    v_mul_f32 v200, v200, v77
    v_cndmask_b32 v77, v220, v221, s[88:89]
    v_mul_f32 v201, v201, v77
    v_cndmask_b32 v77, v220, v221, s[88:89]
    v_mul_f32 v202, v202, v77
    v_cndmask_b32 v77, v220, v221, s[88:89]
    v_mul_f32 v203, v203, v77
    v_cvt_pk_bf16_f32 v236, v200, v201
    v_cvt_pk_bf16_f32 v237, v202, v203
    s_mul_i32 s65, s60, 20
    s_add_u32 s65, s65, 12
    v_xor_b32 v77, s65, v238
    v_lshl_add_u32 v77, v77, 4, v235
    ds_write_b64 v77, v[236:237] offset:40960
    s_nop 1
    v_cvt_pk_bf16_f32 v236, v204, v205
    v_lshlrev_b32 v204, 16, v236
    v_and_b32 v205, 0xffff0000, v236
    v_cvt_pk_bf16_f32 v237, v206, v207
    v_lshlrev_b32 v206, 16, v237
    v_and_b32 v207, 0xffff0000, v237
    v_mul_f32 v204, v204, v221
    v_mul_f32 v205, v205, v221
    v_mul_f32 v206, v206, v221
    v_mul_f32 v207, v207, v221
    v_cvt_pk_bf16_f32 v236, v204, v205
    v_cvt_pk_bf16_f32 v237, v206, v207
    s_mul_i32 s65, s60, 20
    s_add_u32 s65, s65, 13
    v_xor_b32 v77, s65, v238
    v_lshl_add_u32 v77, v77, 4, v235
    ds_write_b64 v77, v[236:237] offset:40960
    s_nop 1
    v_cvt_pk_bf16_f32 v236, v208, v209
    v_lshlrev_b32 v208, 16, v236
    v_and_b32 v209, 0xffff0000, v236
    v_cvt_pk_bf16_f32 v237, v210, v211
    v_lshlrev_b32 v210, 16, v237
    v_and_b32 v211, 0xffff0000, v237
    v_mul_f32 v208, v208, v221
    v_mul_f32 v209, v209, v221
    v_mul_f32 v210, v210, v221
    v_mul_f32 v211, v211, v221
    v_cvt_pk_bf16_f32 v236, v208, v209
    v_cvt_pk_bf16_f32 v237, v210, v211
    s_mul_i32 s65, s60, 20
    s_add_u32 s65, s65, 14
    v_xor_b32 v77, s65, v238
    v_lshl_add_u32 v77, v77, 4, v235
    ds_write_b64 v77, v[236:237] offset:40960
    s_nop 1
    v_cvt_pk_bf16_f32 v236, v212, v213
    v_lshlrev_b32 v212, 16, v236
    v_and_b32 v213, 0xffff0000, v236
    v_cvt_pk_bf16_f32 v237, v214, v215
    v_lshlrev_b32 v214, 16, v237
    v_and_b32 v215, 0xffff0000, v237
    v_mul_f32 v212, v212, v222
    v_mul_f32 v213, v213, v222
    v_mul_f32 v214, v214, v222
    v_mul_f32 v215, v215, v222
    v_cvt_pk_bf16_f32 v236, v212, v213
    v_cvt_pk_bf16_f32 v237, v214, v215
    s_mul_i32 s65, s60, 20
    s_add_u32 s65, s65, 15
    v_xor_b32 v77, s65, v238
    v_lshl_add_u32 v77, v77, 4, v235
    ds_write_b64 v77, v[236:237] offset:40960
    s_nop 1
    v_mov_b32 v184, 0
    v_mov_b32 v185, 0
    v_mov_b32 v186, 0
    v_mov_b32 v187, 0
    v_mov_b32 v188, 0
    v_mov_b32 v189, 0
    v_mov_b32 v190, 0
    v_mov_b32 v191, 0
    v_mov_b32 v192, 0
    v_mov_b32 v193, 0
    v_mov_b32 v194, 0
    v_mov_b32 v195, 0
    v_mov_b32 v196, 0
    v_mov_b32 v197, 0
    v_mov_b32 v198, 0
    v_mov_b32 v199, 0
    v_mov_b32 v200, 0
    v_mov_b32 v201, 0
    v_mov_b32 v202, 0
    v_mov_b32 v203, 0
    v_mov_b32 v204, 0
    v_mov_b32 v205, 0
    v_mov_b32 v206, 0
    v_mov_b32 v207, 0
    v_mov_b32 v208, 0
    v_mov_b32 v209, 0
    v_mov_b32 v210, 0
    v_mov_b32 v211, 0
    v_mov_b32 v212, 0
    v_mov_b32 v213, 0
    v_mov_b32 v214, 0
    v_mov_b32 v215, 0
    s_add_u32 s65, s86, 32768
    buffer_load_dwordx4 v[172:175], v169, s[76:79], s65 offen offset:0
    buffer_load_dwordx4 v[176:179], v169, s[76:79], s65 offen offset:16
    s_waitcnt vmcnt(0)
    v_cvt_pk_bf16_f32 v180, v172, v173
    v_cvt_pk_bf16_f32 v181, v174, v175
    v_cvt_pk_bf16_f32 v182, v176, v177
    v_cvt_pk_bf16_f32 v183, v178, v179
    s_nop 1
    v_mfma_f32_32x32x16_bf16 v[184:199], v[180:183], v[144:147], v[184:199]
    v_mfma_f32_32x32x16_bf16 v[200:215], v[180:183], v[148:151], v[200:215]
    s_nop 4
    s_add_u32 s65, s86, 32768
    buffer_load_dwordx4 v[172:175], v169, s[76:79], s65 offen offset:64
    buffer_load_dwordx4 v[176:179], v169, s[76:79], s65 offen offset:80
    s_waitcnt vmcnt(0)
    v_cvt_pk_bf16_f32 v180, v172, v173
    v_cvt_pk_bf16_f32 v181, v174, v175
    v_cvt_pk_bf16_f32 v182, v176, v177
    v_cvt_pk_bf16_f32 v183, v178, v179
    s_nop 1
    v_mfma_f32_32x32x16_bf16 v[184:199], v[180:183], v[152:155], v[184:199]
    v_mfma_f32_32x32x16_bf16 v[200:215], v[180:183], v[156:159], v[200:215]
    s_nop 4
    s_add_u32 s65, s86, 32768
    buffer_load_dwordx4 v[172:175], v169, s[76:79], s65 offen offset:128
    buffer_load_dwordx4 v[176:179], v169, s[76:79], s65 offen offset:144
    s_waitcnt vmcnt(0)
    v_cvt_pk_bf16_f32 v180, v172, v173
    v_cvt_pk_bf16_f32 v181, v174, v175
    v_cvt_pk_bf16_f32 v182, v176, v177
    v_cvt_pk_bf16_f32 v183, v178, v179
    s_nop 1
    v_mfma_f32_32x32x16_bf16 v[184:199], v[180:183], v[160:163], v[184:199]
    v_mfma_f32_32x32x16_bf16 v[200:215], v[180:183], v[164:167], v[200:215]
    s_nop 4
    s_nop 7
    s_nop 7
    v_cvt_pk_bf16_f32 v236, v184, v185
    v_lshlrev_b32 v184, 16, v236
    v_and_b32 v185, 0xffff0000, v236
    v_cvt_pk_bf16_f32 v237, v186, v187
    v_lshlrev_b32 v186, 16, v237
    v_and_b32 v187, 0xffff0000, v237
    v_mul_f32 v184, v184, v233
    v_mul_f32 v185, v185, v233
    v_mul_f32 v186, v186, v233
    v_mul_f32 v187, v187, v233
    v_cvt_pk_bf16_f32 v236, v184, v185
    v_cvt_pk_bf16_f32 v237, v186, v187
    s_mul_i32 s65, s60, 20
    s_add_u32 s65, s65, 16
    v_xor_b32 v77, s65, v238
    v_lshl_add_u32 v77, v77, 4, v235
    ds_write_b64 v77, v[236:237] offset:0
    s_nop 1
    v_cvt_pk_bf16_f32 v236, v188, v189
    v_lshlrev_b32 v188, 16, v236
    v_and_b32 v189, 0xffff0000, v236
    v_cvt_pk_bf16_f32 v237, v190, v191
    v_lshlrev_b32 v190, 16, v237
    v_and_b32 v191, 0xffff0000, v237
    v_cndmask_b32 v77, v233, v234, s[88:89]
    v_mul_f32 v188, v188, v77
    v_cndmask_b32 v77, v233, v234, s[88:89]
    v_mul_f32 v189, v189, v77
    v_cndmask_b32 v77, v233, v234, s[88:89]
    v_mul_f32 v190, v190, v77
    v_cndmask_b32 v77, v233, v234, s[88:89]
    v_mul_f32 v191, v191, v77
    v_cvt_pk_bf16_f32 v236, v188, v189
    v_cvt_pk_bf16_f32 v237, v190, v191
    s_mul_i32 s65, s60, 20
    s_add_u32 s65, s65, 17
    v_xor_b32 v77, s65, v238
    v_lshl_add_u32 v77, v77, 4, v235
    ds_write_b64 v77, v[236:237] offset:0
    s_nop 1
    v_cvt_pk_bf16_f32 v236, v192, v193
    v_lshlrev_b32 v192, 16, v236
    v_and_b32 v193, 0xffff0000, v236
    v_cvt_pk_bf16_f32 v237, v194, v195
    v_lshlrev_b32 v194, 16, v237
    v_and_b32 v195, 0xffff0000, v237
    v_mul_f32 v192, v192, v234
    v_mul_f32 v193, v193, v234
    v_mul_f32 v194, v194, v234
    v_mul_f32 v195, v195, v234
    v_cvt_pk_bf16_f32 v236, v192, v193
    v_cvt_pk_bf16_f32 v237, v194, v195
    s_mul_i32 s65, s60, 20
    s_add_u32 s65, s65, 18
    v_xor_b32 v77, s65, v238
    v_lshl_add_u32 v77, v77, 4, v235
    ds_write_b64 v77, v[236:237] offset:0
    s_nop 1
    v_cvt_pk_bf16_f32 v236, v196, v197
    v_lshlrev_b32 v196, 16, v236
    v_and_b32 v197, 0xffff0000, v236
    v_cvt_pk_bf16_f32 v237, v198, v199
    v_lshlrev_b32 v198, 16, v237
    v_and_b32 v199, 0xffff0000, v237
    v_mul_f32 v196, v196, v234
    v_mul_f32 v197, v197, v234
    v_mul_f32 v198, v198, v234
    v_mul_f32 v199, v199, v234
    v_cvt_pk_bf16_f32 v236, v196, v197
    v_cvt_pk_bf16_f32 v237, v198, v199
    s_mul_i32 s65, s60, 20
    s_add_u32 s65, s65, 19
    v_xor_b32 v77, s65, v238
    v_lshl_add_u32 v77, v77, 4, v235
    ds_write_b64 v77, v[236:237] offset:0
    s_nop 1
    v_cvt_pk_bf16_f32 v236, v200, v201
    v_lshlrev_b32 v200, 16, v236
    v_and_b32 v201, 0xffff0000, v236
    v_cvt_pk_bf16_f32 v237, v202, v203
    v_lshlrev_b32 v202, 16, v237
    v_and_b32 v203, 0xffff0000, v237
    v_mul_f32 v200, v200, v222
    v_mul_f32 v201, v201, v222
    v_mul_f32 v202, v202, v222
    v_mul_f32 v203, v203, v222
    v_cvt_pk_bf16_f32 v236, v200, v201
    v_cvt_pk_bf16_f32 v237, v202, v203
    s_mul_i32 s65, s60, 20
    s_add_u32 s65, s65, 16
    v_xor_b32 v77, s65, v238
    v_lshl_add_u32 v77, v77, 4, v235
    ds_write_b64 v77, v[236:237] offset:40960
    s_nop 1
    v_cvt_pk_bf16_f32 v236, v204, v205
    v_lshlrev_b32 v204, 16, v236
    v_and_b32 v205, 0xffff0000, v236
    v_cvt_pk_bf16_f32 v237, v206, v207
    v_lshlrev_b32 v206, 16, v237
    v_and_b32 v207, 0xffff0000, v237
    v_cndmask_b32 v77, v222, v223, s[88:89]
    v_mul_f32 v204, v204, v77
    v_cndmask_b32 v77, v222, v223, s[88:89]
    v_mul_f32 v205, v205, v77
    v_cndmask_b32 v77, v222, v223, s[88:89]
    v_mul_f32 v206, v206, v77
    v_cndmask_b32 v77, v222, v223, s[88:89]
    v_mul_f32 v207, v207, v77
    v_cvt_pk_bf16_f32 v236, v204, v205
    v_cvt_pk_bf16_f32 v237, v206, v207
    s_mul_i32 s65, s60, 20
    s_add_u32 s65, s65, 17
    v_xor_b32 v77, s65, v238
    v_lshl_add_u32 v77, v77, 4, v235
    ds_write_b64 v77, v[236:237] offset:40960
    s_nop 1
    v_cvt_pk_bf16_f32 v236, v208, v209
    v_lshlrev_b32 v208, 16, v236
    v_and_b32 v209, 0xffff0000, v236
    v_cvt_pk_bf16_f32 v237, v210, v211
    v_lshlrev_b32 v210, 16, v237
    v_and_b32 v211, 0xffff0000, v237
    v_mul_f32 v208, v208, v223
    v_mul_f32 v209, v209, v223
    v_mul_f32 v210, v210, v223
    v_mul_f32 v211, v211, v223
    v_cvt_pk_bf16_f32 v236, v208, v209
    v_cvt_pk_bf16_f32 v237, v210, v211
    s_mul_i32 s65, s60, 20
    s_add_u32 s65, s65, 18
    v_xor_b32 v77, s65, v238
    v_lshl_add_u32 v77, v77, 4, v235
    ds_write_b64 v77, v[236:237] offset:40960
    s_nop 1
    v_cvt_pk_bf16_f32 v236, v212, v213
    v_lshlrev_b32 v212, 16, v236
    v_and_b32 v213, 0xffff0000, v236
    v_cvt_pk_bf16_f32 v237, v214, v215
    v_lshlrev_b32 v214, 16, v237
    v_and_b32 v215, 0xffff0000, v237
    v_mul_f32 v212, v212, v223
    v_mul_f32 v213, v213, v223
    v_mul_f32 v214, v214, v223
    v_mul_f32 v215, v215, v223
    v_cvt_pk_bf16_f32 v236, v212, v213
    v_cvt_pk_bf16_f32 v237, v214, v215
    s_mul_i32 s65, s60, 20
    s_add_u32 s65, s65, 19
    v_xor_b32 v77, s65, v238
    v_lshl_add_u32 v77, v77, 4, v235
    ds_write_b64 v77, v[236:237] offset:40960
    s_nop 1
    s_waitcnt lgkmcnt(0)
    s_add_u32 s48, s36, 13950976
    s_addc_u32 s49, s37, 0
    s_and_b32 s49, s49, 0xffff
    s_mov_b32 s50, 2621440
    s_mov_b32 s51, 0x00020000
    s_add_u32 s56, s36, 16572416
    s_addc_u32 s57, s37, 0
    s_and_b32 s57, s57, 0xffff
    s_mov_b32 s58, 2621440
    s_mov_b32 s59, 0x00020000
    s_add_u32 s80, s36, 8208384
    s_addc_u32 s81, s37, 0
    s_and_b32 s81, s81, 0xffff
    s_mov_b32 s82, 163840
    s_mov_b32 s83, 0x00020000
    v_lshrrev_b32 v104, 5, v76
    v_lshlrev_b32 v104, 2, v104
    s_lshl_b32 s65, s68, 6
    v_add_u32 v104, s65, v104
    v_lshlrev_b32 v105, 1, v104
    s_lshl_b32 s66, s62, 1
    v_and_b32 v106, 31, v76
    s_lshl_b32 s65, s67, 5
    v_add_u32 v106, s65, v106
    v_add_u32 v106, s61, v106
    v_mul_u32_u24 v106, 1280, v106
    v_add_u32 v106, v106, v105
    buffer_load_dwordx2 v[88:89], v106, s[48:51], s66 offen offset:0
    buffer_load_dwordx2 v[90:91], v106, s[48:51], s66 offen offset:16
    buffer_load_dwordx2 v[92:93], v106, s[48:51], s66 offen offset:32
    buffer_load_dwordx2 v[94:95], v106, s[48:51], s66 offen offset:48
    buffer_load_dwordx2 v[96:97], v106, s[48:51], s66 offen offset:64
    buffer_load_dwordx2 v[98:99], v106, s[48:51], s66 offen offset:80
    buffer_load_dwordx2 v[100:101], v106, s[48:51], s66 offen offset:96
    buffer_load_dwordx2 v[102:103], v106, s[48:51], s66 offen offset:112
    s_waitcnt vmcnt(63)
    s_barrier
    s_mov_b32 s69, 256
    s_add_u32 m0, s64, 114688
    buffer_load_dwordx4 v60, s[44:47], s69 offen lds
    s_add_u32 m0, s64, 115712
    buffer_load_dwordx4 v61, s[44:47], s69 offen lds
    s_add_u32 m0, s64, 116736
    buffer_load_dwordx4 v62, s[44:47], s69 offen lds
    s_add_u32 m0, s64, 117760
    buffer_load_dwordx4 v63, s[44:47], s69 offen lds
    ds_read_b128 v[36:39], v79 offset:0
    ds_read_b128 v[44:47], v72 offset:16384
    ds_read_b128 v[48:51], v72 offset:20480
    ds_read_b128 v[40:43], v80 offset:0
    ds_read_b128 v[52:55], v73 offset:16384
    ds_read_b128 v[56:59], v73 offset:20480
    s_waitcnt lgkmcnt(3)
    v_mfma_f32_32x32x16_bf16 v[4:19], v[44:47], v[36:39], v[4:19]
    v_mfma_f32_32x32x16_bf16 v[20:35], v[48:51], v[36:39], v[20:35]
    ds_read_b128 v[36:39], v81 offset:0
    ds_read_b128 v[44:47], v74 offset:16384
    ds_read_b128 v[48:51], v74 offset:20480
    s_waitcnt lgkmcnt(3)
    v_mfma_f32_32x32x16_bf16 v[4:19], v[52:55], v[40:43], v[4:19]
    v_mfma_f32_32x32x16_bf16 v[20:35], v[56:59], v[40:43], v[20:35]
    ds_read_b128 v[40:43], v82 offset:0
    ds_read_b128 v[52:55], v75 offset:16384
    ds_read_b128 v[56:59], v75 offset:20480
    s_waitcnt lgkmcnt(3)
    v_mfma_f32_32x32x16_bf16 v[4:19], v[44:47], v[36:39], v[4:19]
    v_mfma_f32_32x32x16_bf16 v[20:35], v[48:51], v[36:39], v[20:35]
    s_waitcnt vmcnt(63) lgkmcnt(0)
    s_barrier
    s_mov_b32 s69, 384
    s_add_u32 m0, s64, 81920
    buffer_load_dwordx4 v60, s[44:47], s69 offen lds
    s_add_u32 m0, s64, 82944
    buffer_load_dwordx4 v61, s[44:47], s69 offen lds
    s_add_u32 m0, s64, 83968
    buffer_load_dwordx4 v62, s[44:47], s69 offen lds
    s_add_u32 m0, s64, 84992
    buffer_load_dwordx4 v63, s[44:47], s69 offen lds
    ds_read_b128 v[36:39], v83 offset:0
    ds_read_b128 v[44:47], v72 offset:32768
    ds_read_b128 v[48:51], v72 offset:36864
    v_mfma_f32_32x32x16_bf16 v[4:19], v[52:55], v[40:43], v[4:19]
    v_mfma_f32_32x32x16_bf16 v[20:35], v[56:59], v[40:43], v[20:35]
    ds_read_b128 v[40:43], v84 offset:0
    ds_read_b128 v[52:55], v73 offset:32768
    ds_read_b128 v[56:59], v73 offset:36864
    s_waitcnt lgkmcnt(3)
    v_mfma_f32_32x32x16_bf16 v[4:19], v[44:47], v[36:39], v[4:19]
    v_mfma_f32_32x32x16_bf16 v[20:35], v[48:51], v[36:39], v[20:35]
    ds_read_b128 v[36:39], v85 offset:0
    ds_read_b128 v[44:47], v74 offset:32768
    ds_read_b128 v[48:51], v74 offset:36864
    s_waitcnt lgkmcnt(3)
    v_mfma_f32_32x32x16_bf16 v[4:19], v[52:55], v[40:43], v[4:19]
    v_mfma_f32_32x32x16_bf16 v[20:35], v[56:59], v[40:43], v[20:35]
    ds_read_b128 v[40:43], v86 offset:0
    ds_read_b128 v[52:55], v75 offset:32768
    ds_read_b128 v[56:59], v75 offset:36864
    s_waitcnt lgkmcnt(3)
    v_mfma_f32_32x32x16_bf16 v[4:19], v[44:47], v[36:39], v[4:19]
    v_mfma_f32_32x32x16_bf16 v[20:35], v[48:51], v[36:39], v[20:35]
    s_waitcnt vmcnt(4) lgkmcnt(0)
    s_barrier
    s_mov_b32 s69, 512
    s_add_u32 m0, s64, 98304
    buffer_load_dwordx4 v60, s[44:47], s69 offen lds
    s_add_u32 m0, s64, 99328
    buffer_load_dwordx4 v61, s[44:47], s69 offen lds
    s_add_u32 m0, s64, 100352
    buffer_load_dwordx4 v62, s[44:47], s69 offen lds
    s_add_u32 m0, s64, 101376
    buffer_load_dwordx4 v63, s[44:47], s69 offen lds
    ds_read_b128 v[36:39], v79 offset:256
    ds_read_b128 v[44:47], v72 offset:49152
    ds_read_b128 v[48:51], v72 offset:53248
    v_mfma_f32_32x32x16_bf16 v[4:19], v[52:55], v[40:43], v[4:19]
    v_mfma_f32_32x32x16_bf16 v[20:35], v[56:59], v[40:43], v[20:35]
    ds_read_b128 v[40:43], v80 offset:256
    ds_read_b128 v[52:55], v73 offset:49152
    ds_read_b128 v[56:59], v73 offset:53248
    s_waitcnt lgkmcnt(3)
    v_mfma_f32_32x32x16_bf16 v[4:19], v[44:47], v[36:39], v[4:19]
    v_mfma_f32_32x32x16_bf16 v[20:35], v[48:51], v[36:39], v[20:35]
    ds_read_b128 v[36:39], v81 offset:256
    ds_read_b128 v[44:47], v74 offset:49152
    ds_read_b128 v[48:51], v74 offset:53248
    s_waitcnt lgkmcnt(3)
    v_mfma_f32_32x32x16_bf16 v[4:19], v[52:55], v[40:43], v[4:19]
    v_mfma_f32_32x32x16_bf16 v[20:35], v[56:59], v[40:43], v[20:35]
    ds_read_b128 v[40:43], v82 offset:256
    ds_read_b128 v[52:55], v75 offset:49152
    ds_read_b128 v[56:59], v75 offset:53248
    s_waitcnt lgkmcnt(3)
    v_mfma_f32_32x32x16_bf16 v[4:19], v[44:47], v[36:39], v[4:19]
    v_mfma_f32_32x32x16_bf16 v[20:35], v[48:51], v[36:39], v[20:35]
    s_waitcnt vmcnt(4) lgkmcnt(0)
    s_barrier
    s_mov_b32 s69, 640
    s_add_u32 m0, s64, 114688
    buffer_load_dwordx4 v60, s[44:47], s69 offen lds
    s_add_u32 m0, s64, 115712
    buffer_load_dwordx4 v61, s[44:47], s69 offen lds
    s_add_u32 m0, s64, 116736
    buffer_load_dwordx4 v62, s[44:47], s69 offen lds
    s_add_u32 m0, s64, 117760
    buffer_load_dwordx4 v63, s[44:47], s69 offen lds
    ds_read_b128 v[36:39], v83 offset:256
    ds_read_b128 v[44:47], v72 offset:16384
    ds_read_b128 v[48:51], v72 offset:20480
    v_mfma_f32_32x32x16_bf16 v[4:19], v[52:55], v[40:43], v[4:19]
    v_mfma_f32_32x32x16_bf16 v[20:35], v[56:59], v[40:43], v[20:35]
    ds_read_b128 v[40:43], v84 offset:256
    ds_read_b128 v[52:55], v73 offset:16384
    ds_read_b128 v[56:59], v73 offset:20480
    s_waitcnt lgkmcnt(3)
    v_mfma_f32_32x32x16_bf16 v[4:19], v[44:47], v[36:39], v[4:19]
    v_mfma_f32_32x32x16_bf16 v[20:35], v[48:51], v[36:39], v[20:35]
    ds_read_b128 v[36:39], v85 offset:256
    ds_read_b128 v[44:47], v74 offset:16384
    ds_read_b128 v[48:51], v74 offset:20480
    s_waitcnt lgkmcnt(3)
    v_mfma_f32_32x32x16_bf16 v[4:19], v[52:55], v[40:43], v[4:19]
    v_mfma_f32_32x32x16_bf16 v[20:35], v[56:59], v[40:43], v[20:35]
    ds_read_b128 v[40:43], v86 offset:256
    ds_read_b128 v[52:55], v75 offset:16384
    ds_read_b128 v[56:59], v75 offset:20480
    s_waitcnt lgkmcnt(3)
    v_mfma_f32_32x32x16_bf16 v[4:19], v[44:47], v[36:39], v[4:19]
    v_mfma_f32_32x32x16_bf16 v[20:35], v[48:51], v[36:39], v[20:35]
    s_waitcnt vmcnt(4) lgkmcnt(0)
    s_barrier
    s_mov_b32 s69, 768
    s_add_u32 m0, s64, 81920
    buffer_load_dwordx4 v60, s[44:47], s69 offen lds
    s_add_u32 m0, s64, 82944
    buffer_load_dwordx4 v61, s[44:47], s69 offen lds
    s_add_u32 m0, s64, 83968
    buffer_load_dwordx4 v62, s[44:47], s69 offen lds
    s_add_u32 m0, s64, 84992
    buffer_load_dwordx4 v63, s[44:47], s69 offen lds
    ds_read_b128 v[36:39], v79 offset:512
    ds_read_b128 v[44:47], v72 offset:32768
    ds_read_b128 v[48:51], v72 offset:36864
    v_mfma_f32_32x32x16_bf16 v[4:19], v[52:55], v[40:43], v[4:19]
    v_mfma_f32_32x32x16_bf16 v[20:35], v[56:59], v[40:43], v[20:35]
    ds_read_b128 v[40:43], v80 offset:512
    ds_read_b128 v[52:55], v73 offset:32768
    ds_read_b128 v[56:59], v73 offset:36864
    s_waitcnt lgkmcnt(3)
    v_mfma_f32_32x32x16_bf16 v[4:19], v[44:47], v[36:39], v[4:19]
    v_mfma_f32_32x32x16_bf16 v[20:35], v[48:51], v[36:39], v[20:35]
    ds_read_b128 v[36:39], v81 offset:512
    ds_read_b128 v[44:47], v74 offset:32768
    ds_read_b128 v[48:51], v74 offset:36864
    s_waitcnt lgkmcnt(3)
    v_mfma_f32_32x32x16_bf16 v[4:19], v[52:55], v[40:43], v[4:19]
    v_mfma_f32_32x32x16_bf16 v[20:35], v[56:59], v[40:43], v[20:35]
    ds_read_b128 v[40:43], v82 offset:512
    ds_read_b128 v[52:55], v75 offset:32768
    ds_read_b128 v[56:59], v75 offset:36864
    s_waitcnt lgkmcnt(3)
    v_mfma_f32_32x32x16_bf16 v[4:19], v[44:47], v[36:39], v[4:19]
    v_mfma_f32_32x32x16_bf16 v[20:35], v[48:51], v[36:39], v[20:35]
    s_waitcnt vmcnt(4) lgkmcnt(0)
    s_barrier
    s_mov_b32 s69, 896
    s_add_u32 m0, s64, 98304
    buffer_load_dwordx4 v60, s[44:47], s69 offen lds
    s_add_u32 m0, s64, 99328
    buffer_load_dwordx4 v61, s[44:47], s69 offen lds
    s_add_u32 m0, s64, 100352
    buffer_load_dwordx4 v62, s[44:47], s69 offen lds
    s_add_u32 m0, s64, 101376
    buffer_load_dwordx4 v63, s[44:47], s69 offen lds
    ds_read_b128 v[36:39], v83 offset:512
    ds_read_b128 v[44:47], v72 offset:49152
    ds_read_b128 v[48:51], v72 offset:53248
    v_mfma_f32_32x32x16_bf16 v[4:19], v[52:55], v[40:43], v[4:19]
    v_mfma_f32_32x32x16_bf16 v[20:35], v[56:59], v[40:43], v[20:35]
    ds_read_b128 v[40:43], v84 offset:512
    ds_read_b128 v[52:55], v73 offset:49152
    ds_read_b128 v[56:59], v73 offset:53248
    s_waitcnt lgkmcnt(3)
    v_mfma_f32_32x32x16_bf16 v[4:19], v[44:47], v[36:39], v[4:19]
    v_mfma_f32_32x32x16_bf16 v[20:35], v[48:51], v[36:39], v[20:35]
    ds_read_b128 v[36:39], v85 offset:512
    ds_read_b128 v[44:47], v74 offset:49152
    ds_read_b128 v[48:51], v74 offset:53248
    s_waitcnt lgkmcnt(3)
    v_mfma_f32_32x32x16_bf16 v[4:19], v[52:55], v[40:43], v[4:19]
    v_mfma_f32_32x32x16_bf16 v[20:35], v[56:59], v[40:43], v[20:35]
    ds_read_b128 v[40:43], v86 offset:512
    ds_read_b128 v[52:55], v75 offset:49152
    ds_read_b128 v[56:59], v75 offset:53248
    s_waitcnt lgkmcnt(3)
    v_mfma_f32_32x32x16_bf16 v[4:19], v[44:47], v[36:39], v[4:19]
    v_mfma_f32_32x32x16_bf16 v[20:35], v[48:51], v[36:39], v[20:35]
    s_waitcnt vmcnt(4) lgkmcnt(0)
    s_barrier
    s_mov_b32 s69, 1024
    s_add_u32 m0, s64, 114688
    buffer_load_dwordx4 v60, s[44:47], s69 offen lds
    s_add_u32 m0, s64, 115712
    buffer_load_dwordx4 v61, s[44:47], s69 offen lds
    s_add_u32 m0, s64, 116736
    buffer_load_dwordx4 v62, s[44:47], s69 offen lds
    s_add_u32 m0, s64, 117760
    buffer_load_dwordx4 v63, s[44:47], s69 offen lds
    ds_read_b128 v[36:39], v79 offset:768
    ds_read_b128 v[44:47], v72 offset:16384
    ds_read_b128 v[48:51], v72 offset:20480
    v_mfma_f32_32x32x16_bf16 v[4:19], v[52:55], v[40:43], v[4:19]
    v_mfma_f32_32x32x16_bf16 v[20:35], v[56:59], v[40:43], v[20:35]
    ds_read_b128 v[40:43], v80 offset:768
    ds_read_b128 v[52:55], v73 offset:16384
    ds_read_b128 v[56:59], v73 offset:20480
    s_waitcnt lgkmcnt(3)
    v_mfma_f32_32x32x16_bf16 v[4:19], v[44:47], v[36:39], v[4:19]
    v_mfma_f32_32x32x16_bf16 v[20:35], v[48:51], v[36:39], v[20:35]
    ds_read_b128 v[36:39], v81 offset:768
    ds_read_b128 v[44:47], v74 offset:16384
    ds_read_b128 v[48:51], v74 offset:20480
    s_waitcnt lgkmcnt(3)
    v_mfma_f32_32x32x16_bf16 v[4:19], v[52:55], v[40:43], v[4:19]
    v_mfma_f32_32x32x16_bf16 v[20:35], v[56:59], v[40:43], v[20:35]
    ds_read_b128 v[40:43], v82 offset:768
    ds_read_b128 v[52:55], v75 offset:16384
    ds_read_b128 v[56:59], v75 offset:20480
    s_waitcnt lgkmcnt(3)
    v_mfma_f32_32x32x16_bf16 v[4:19], v[44:47], v[36:39], v[4:19]
    v_mfma_f32_32x32x16_bf16 v[20:35], v[48:51], v[36:39], v[20:35]
    s_waitcnt vmcnt(4) lgkmcnt(0)
    s_barrier
    s_mov_b32 s69, 1152
    s_add_u32 m0, s64, 81920
    buffer_load_dwordx4 v60, s[44:47], s69 offen lds
    s_add_u32 m0, s64, 82944
    buffer_load_dwordx4 v61, s[44:47], s69 offen lds
    s_add_u32 m0, s64, 83968
    buffer_load_dwordx4 v62, s[44:47], s69 offen lds
    s_add_u32 m0, s64, 84992
    buffer_load_dwordx4 v63, s[44:47], s69 offen lds
    ds_read_b128 v[36:39], v83 offset:768
    ds_read_b128 v[44:47], v72 offset:32768
    ds_read_b128 v[48:51], v72 offset:36864
    v_mfma_f32_32x32x16_bf16 v[4:19], v[52:55], v[40:43], v[4:19]
    v_mfma_f32_32x32x16_bf16 v[20:35], v[56:59], v[40:43], v[20:35]
    ds_read_b128 v[40:43], v84 offset:768
    ds_read_b128 v[52:55], v73 offset:32768
    ds_read_b128 v[56:59], v73 offset:36864
    s_waitcnt lgkmcnt(3)
    v_mfma_f32_32x32x16_bf16 v[4:19], v[44:47], v[36:39], v[4:19]
    v_mfma_f32_32x32x16_bf16 v[20:35], v[48:51], v[36:39], v[20:35]
    ds_read_b128 v[36:39], v85 offset:768
    ds_read_b128 v[44:47], v74 offset:32768
    ds_read_b128 v[48:51], v74 offset:36864
    s_waitcnt lgkmcnt(3)
    v_mfma_f32_32x32x16_bf16 v[4:19], v[52:55], v[40:43], v[4:19]
    v_mfma_f32_32x32x16_bf16 v[20:35], v[56:59], v[40:43], v[20:35]
    ds_read_b128 v[40:43], v86 offset:768
    ds_read_b128 v[52:55], v75 offset:32768
    ds_read_b128 v[56:59], v75 offset:36864
    s_waitcnt lgkmcnt(3)
    v_mfma_f32_32x32x16_bf16 v[4:19], v[44:47], v[36:39], v[4:19]
    v_mfma_f32_32x32x16_bf16 v[20:35], v[48:51], v[36:39], v[20:35]
    s_waitcnt vmcnt(4) lgkmcnt(0)
    s_barrier
    ds_read_b128 v[36:39], v79 offset:1024
    ds_read_b128 v[44:47], v72 offset:49152
    ds_read_b128 v[48:51], v72 offset:53248
    v_mfma_f32_32x32x16_bf16 v[4:19], v[52:55], v[40:43], v[4:19]
    v_mfma_f32_32x32x16_bf16 v[20:35], v[56:59], v[40:43], v[20:35]
    ds_read_b128 v[40:43], v80 offset:1024
    ds_read_b128 v[52:55], v73 offset:49152
    ds_read_b128 v[56:59], v73 offset:53248
    s_waitcnt lgkmcnt(3)
    v_mfma_f32_32x32x16_bf16 v[4:19], v[44:47], v[36:39], v[4:19]
    v_mfma_f32_32x32x16_bf16 v[20:35], v[48:51], v[36:39], v[20:35]
    ds_read_b128 v[36:39], v81 offset:1024
    ds_read_b128 v[44:47], v74 offset:49152
    ds_read_b128 v[48:51], v74 offset:53248
    s_waitcnt lgkmcnt(3)
    v_mfma_f32_32x32x16_bf16 v[4:19], v[52:55], v[40:43], v[4:19]
    v_mfma_f32_32x32x16_bf16 v[20:35], v[56:59], v[40:43], v[20:35]
    ds_read_b128 v[40:43], v82 offset:1024
    ds_read_b128 v[52:55], v75 offset:49152
    ds_read_b128 v[56:59], v75 offset:53248
    s_waitcnt lgkmcnt(3)
    v_mfma_f32_32x32x16_bf16 v[4:19], v[44:47], v[36:39], v[4:19]
    v_mfma_f32_32x32x16_bf16 v[20:35], v[48:51], v[36:39], v[20:35]
    s_waitcnt vmcnt(0) lgkmcnt(0)
    s_barrier
    ds_read_b128 v[36:39], v83 offset:1024
    ds_read_b128 v[44:47], v72 offset:16384
    ds_read_b128 v[48:51], v72 offset:20480
    v_mfma_f32_32x32x16_bf16 v[4:19], v[52:55], v[40:43], v[4:19]
    v_mfma_f32_32x32x16_bf16 v[20:35], v[56:59], v[40:43], v[20:35]
    ds_read_b128 v[40:43], v84 offset:1024
    ds_read_b128 v[52:55], v73 offset:16384
    ds_read_b128 v[56:59], v73 offset:20480
    s_waitcnt lgkmcnt(3)
    v_mfma_f32_32x32x16_bf16 v[4:19], v[44:47], v[36:39], v[4:19]
    v_mfma_f32_32x32x16_bf16 v[20:35], v[48:51], v[36:39], v[20:35]
    ds_read_b128 v[36:39], v85 offset:1024
    ds_read_b128 v[44:47], v74 offset:16384
    ds_read_b128 v[48:51], v74 offset:20480
    s_waitcnt lgkmcnt(3)
    v_mfma_f32_32x32x16_bf16 v[4:19], v[52:55], v[40:43], v[4:19]
    v_mfma_f32_32x32x16_bf16 v[20:35], v[56:59], v[40:43], v[20:35]
    ds_read_b128 v[40:43], v86 offset:1024
    ds_read_b128 v[52:55], v75 offset:16384
    ds_read_b128 v[56:59], v75 offset:20480
    s_waitcnt lgkmcnt(3)
    v_mfma_f32_32x32x16_bf16 v[4:19], v[44:47], v[36:39], v[4:19]
    v_mfma_f32_32x32x16_bf16 v[20:35], v[48:51], v[36:39], v[20:35]
    s_waitcnt lgkmcnt(0)
    v_mfma_f32_32x32x16_bf16 v[4:19], v[52:55], v[40:43], v[4:19]
    v_mfma_f32_32x32x16_bf16 v[20:35], v[56:59], v[40:43], v[20:35]
    s_nop 7
    s_nop 7
    s_waitcnt vmcnt(0)
    v_and_b32 v107, 31, v76
    s_lshl_b32 s65, s67, 5
    v_add_u32 v107, s65, v107
    v_add_u32 v107, s61, v107
    v_mul_u32_u24 v108, 1280, v107
    v_lshlrev_b32 v109, 1, v104
    v_add_u32 v108, v108, v109
    s_lshl_b32 s66, s62, 1
    v_mov_b32 v118, 0
    v_mov_b32 v119, 0
    v_cvt_pk_bf16_f32 v109, v4, v5
    v_lshlrev_b32 v4, 16, v109
    v_and_b32 v5, 0xffff0000, v109
    v_cvt_pk_bf16_f32 v110, v6, v7
    v_lshlrev_b32 v6, 16, v110
    v_and_b32 v7, 0xffff0000, v110
    v_lshlrev_b32 v112, 16, v88
    v_and_b32 v113, 0xffff0000, v88
    v_lshlrev_b32 v114, 16, v89
    v_and_b32 v115, 0xffff0000, v89
    v_add_f32 v4, v4, v112
    v_add_f32 v5, v5, v113
    v_add_f32 v6, v6, v114
    v_add_f32 v7, v7, v115
    v_cvt_pk_bf16_f32 v116, v4, v5
    v_cvt_pk_bf16_f32 v117, v6, v7
    buffer_store_dwordx2 v[116:117], v108, s[56:59], s66 offen offset:0
    v_lshlrev_b32 v112, 16, v116
    v_and_b32 v113, 0xffff0000, v116
    v_lshlrev_b32 v114, 16, v117
    v_and_b32 v115, 0xffff0000, v117
    v_add_f32 v118, v118, v112
    v_fmac_f32 v119, v112, v112
    v_add_f32 v118, v118, v113
    v_fmac_f32 v119, v113, v113
    v_add_f32 v118, v118, v114
    v_fmac_f32 v119, v114, v114
    v_add_f32 v118, v118, v115
    v_fmac_f32 v119, v115, v115
    s_nop 1
    v_cvt_pk_bf16_f32 v109, v8, v9
    v_lshlrev_b32 v8, 16, v109
    v_and_b32 v9, 0xffff0000, v109
    v_cvt_pk_bf16_f32 v110, v10, v11
    v_lshlrev_b32 v10, 16, v110
    v_and_b32 v11, 0xffff0000, v110
    v_lshlrev_b32 v112, 16, v90
    v_and_b32 v113, 0xffff0000, v90
    v_lshlrev_b32 v114, 16, v91
    v_and_b32 v115, 0xffff0000, v91
    v_add_f32 v8, v8, v112
    v_add_f32 v9, v9, v113
    v_add_f32 v10, v10, v114
    v_add_f32 v11, v11, v115
    v_cvt_pk_bf16_f32 v116, v8, v9
    v_cvt_pk_bf16_f32 v117, v10, v11
    buffer_store_dwordx2 v[116:117], v108, s[56:59], s66 offen offset:16
    v_lshlrev_b32 v112, 16, v116
    v_and_b32 v113, 0xffff0000, v116
    v_lshlrev_b32 v114, 16, v117
    v_and_b32 v115, 0xffff0000, v117
    v_add_f32 v118, v118, v112
    v_fmac_f32 v119, v112, v112
    v_add_f32 v118, v118, v113
    v_fmac_f32 v119, v113, v113
    v_add_f32 v118, v118, v114
    v_fmac_f32 v119, v114, v114
    v_add_f32 v118, v118, v115
    v_fmac_f32 v119, v115, v115
    s_nop 1
    v_cvt_pk_bf16_f32 v109, v12, v13
    v_lshlrev_b32 v12, 16, v109
    v_and_b32 v13, 0xffff0000, v109
    v_cvt_pk_bf16_f32 v110, v14, v15
    v_lshlrev_b32 v14, 16, v110
    v_and_b32 v15, 0xffff0000, v110
    v_lshlrev_b32 v112, 16, v92
    v_and_b32 v113, 0xffff0000, v92
    v_lshlrev_b32 v114, 16, v93
    v_and_b32 v115, 0xffff0000, v93
    v_add_f32 v12, v12, v112
    v_add_f32 v13, v13, v113
    v_add_f32 v14, v14, v114
    v_add_f32 v15, v15, v115
    v_cvt_pk_bf16_f32 v116, v12, v13
    v_cvt_pk_bf16_f32 v117, v14, v15
    buffer_store_dwordx2 v[116:117], v108, s[56:59], s66 offen offset:32
    v_lshlrev_b32 v112, 16, v116
    v_and_b32 v113, 0xffff0000, v116
    v_lshlrev_b32 v114, 16, v117
    v_and_b32 v115, 0xffff0000, v117
    v_add_f32 v118, v118, v112
    v_fmac_f32 v119, v112, v112
    v_add_f32 v118, v118, v113
    v_fmac_f32 v119, v113, v113
    v_add_f32 v118, v118, v114
    v_fmac_f32 v119, v114, v114
    v_add_f32 v118, v118, v115
    v_fmac_f32 v119, v115, v115
    s_nop 1
    v_cvt_pk_bf16_f32 v109, v16, v17
    v_lshlrev_b32 v16, 16, v109
    v_and_b32 v17, 0xffff0000, v109
    v_cvt_pk_bf16_f32 v110, v18, v19
    v_lshlrev_b32 v18, 16, v110
    v_and_b32 v19, 0xffff0000, v110
    v_lshlrev_b32 v112, 16, v94
    v_and_b32 v113, 0xffff0000, v94
    v_lshlrev_b32 v114, 16, v95
    v_and_b32 v115, 0xffff0000, v95
    v_add_f32 v16, v16, v112
    v_add_f32 v17, v17, v113
    v_add_f32 v18, v18, v114
    v_add_f32 v19, v19, v115
    v_cvt_pk_bf16_f32 v116, v16, v17
    v_cvt_pk_bf16_f32 v117, v18, v19
    buffer_store_dwordx2 v[116:117], v108, s[56:59], s66 offen offset:48
    v_lshlrev_b32 v112, 16, v116
    v_and_b32 v113, 0xffff0000, v116
    v_lshlrev_b32 v114, 16, v117
    v_and_b32 v115, 0xffff0000, v117
    v_add_f32 v118, v118, v112
    v_fmac_f32 v119, v112, v112
    v_add_f32 v118, v118, v113
    v_fmac_f32 v119, v113, v113
    v_add_f32 v118, v118, v114
    v_fmac_f32 v119, v114, v114
    v_add_f32 v118, v118, v115
    v_fmac_f32 v119, v115, v115
    s_nop 1
    v_cvt_pk_bf16_f32 v109, v20, v21
    v_lshlrev_b32 v20, 16, v109
    v_and_b32 v21, 0xffff0000, v109
    v_cvt_pk_bf16_f32 v110, v22, v23
    v_lshlrev_b32 v22, 16, v110
    v_and_b32 v23, 0xffff0000, v110
    v_lshlrev_b32 v112, 16, v96
    v_and_b32 v113, 0xffff0000, v96
    v_lshlrev_b32 v114, 16, v97
    v_and_b32 v115, 0xffff0000, v97
    v_add_f32 v20, v20, v112
    v_add_f32 v21, v21, v113
    v_add_f32 v22, v22, v114
    v_add_f32 v23, v23, v115
    v_cvt_pk_bf16_f32 v116, v20, v21
    v_cvt_pk_bf16_f32 v117, v22, v23
    buffer_store_dwordx2 v[116:117], v108, s[56:59], s66 offen offset:64
    v_lshlrev_b32 v112, 16, v116
    v_and_b32 v113, 0xffff0000, v116
    v_lshlrev_b32 v114, 16, v117
    v_and_b32 v115, 0xffff0000, v117
    v_add_f32 v118, v118, v112
    v_fmac_f32 v119, v112, v112
    v_add_f32 v118, v118, v113
    v_fmac_f32 v119, v113, v113
    v_add_f32 v118, v118, v114
    v_fmac_f32 v119, v114, v114
    v_add_f32 v118, v118, v115
    v_fmac_f32 v119, v115, v115
    s_nop 1
    v_cvt_pk_bf16_f32 v109, v24, v25
    v_lshlrev_b32 v24, 16, v109
    v_and_b32 v25, 0xffff0000, v109
    v_cvt_pk_bf16_f32 v110, v26, v27
    v_lshlrev_b32 v26, 16, v110
    v_and_b32 v27, 0xffff0000, v110
    v_lshlrev_b32 v112, 16, v98
    v_and_b32 v113, 0xffff0000, v98
    v_lshlrev_b32 v114, 16, v99
    v_and_b32 v115, 0xffff0000, v99
    v_add_f32 v24, v24, v112
    v_add_f32 v25, v25, v113
    v_add_f32 v26, v26, v114
    v_add_f32 v27, v27, v115
    v_cvt_pk_bf16_f32 v116, v24, v25
    v_cvt_pk_bf16_f32 v117, v26, v27
    buffer_store_dwordx2 v[116:117], v108, s[56:59], s66 offen offset:80
    v_lshlrev_b32 v112, 16, v116
    v_and_b32 v113, 0xffff0000, v116
    v_lshlrev_b32 v114, 16, v117
    v_and_b32 v115, 0xffff0000, v117
    v_add_f32 v118, v118, v112
    v_fmac_f32 v119, v112, v112
    v_add_f32 v118, v118, v113
    v_fmac_f32 v119, v113, v113
    v_add_f32 v118, v118, v114
    v_fmac_f32 v119, v114, v114
    v_add_f32 v118, v118, v115
    v_fmac_f32 v119, v115, v115
    s_nop 1
    v_cvt_pk_bf16_f32 v109, v28, v29
    v_lshlrev_b32 v28, 16, v109
    v_and_b32 v29, 0xffff0000, v109
    v_cvt_pk_bf16_f32 v110, v30, v31
    v_lshlrev_b32 v30, 16, v110
    v_and_b32 v31, 0xffff0000, v110
    v_lshlrev_b32 v112, 16, v100
    v_and_b32 v113, 0xffff0000, v100
    v_lshlrev_b32 v114, 16, v101
    v_and_b32 v115, 0xffff0000, v101
    v_add_f32 v28, v28, v112
    v_add_f32 v29, v29, v113
    v_add_f32 v30, v30, v114
    v_add_f32 v31, v31, v115
    v_cvt_pk_bf16_f32 v116, v28, v29
    v_cvt_pk_bf16_f32 v117, v30, v31
    buffer_store_dwordx2 v[116:117], v108, s[56:59], s66 offen offset:96
    v_lshlrev_b32 v112, 16, v116
    v_and_b32 v113, 0xffff0000, v116
    v_lshlrev_b32 v114, 16, v117
    v_and_b32 v115, 0xffff0000, v117
    v_add_f32 v118, v118, v112
    v_fmac_f32 v119, v112, v112
    v_add_f32 v118, v118, v113
    v_fmac_f32 v119, v113, v113
    v_add_f32 v118, v118, v114
    v_fmac_f32 v119, v114, v114
    v_add_f32 v118, v118, v115
    v_fmac_f32 v119, v115, v115
    s_nop 1
    v_cvt_pk_bf16_f32 v109, v32, v33
    v_lshlrev_b32 v32, 16, v109
    v_and_b32 v33, 0xffff0000, v109
    v_cvt_pk_bf16_f32 v110, v34, v35
    v_lshlrev_b32 v34, 16, v110
    v_and_b32 v35, 0xffff0000, v110
    v_lshlrev_b32 v112, 16, v102
    v_and_b32 v113, 0xffff0000, v102
    v_lshlrev_b32 v114, 16, v103
    v_and_b32 v115, 0xffff0000, v103
    v_add_f32 v32, v32, v112
    v_add_f32 v33, v33, v113
    v_add_f32 v34, v34, v114
    v_add_f32 v35, v35, v115
    v_cvt_pk_bf16_f32 v116, v32, v33
    v_cvt_pk_bf16_f32 v117, v34, v35
    buffer_store_dwordx2 v[116:117], v108, s[56:59], s66 offen offset:112
    v_lshlrev_b32 v112, 16, v116
    v_and_b32 v113, 0xffff0000, v116
    v_lshlrev_b32 v114, 16, v117
    v_and_b32 v115, 0xffff0000, v117
    v_add_f32 v118, v118, v112
    v_fmac_f32 v119, v112, v112
    v_add_f32 v118, v118, v113
    v_fmac_f32 v119, v113, v113
    v_add_f32 v118, v118, v114
    v_fmac_f32 v119, v114, v114
    v_add_f32 v118, v118, v115
    v_fmac_f32 v119, v115, v115
    s_nop 1
    v_mov_b32 v120, v118
    v_mov_b32 v121, v119
    s_nop 1
    v_permlane32_swap_b32 v118, v120
    v_permlane32_swap_b32 v119, v121
    s_nop 1
    v_add_f32 v118, v118, v120
    v_add_f32 v119, v119, v121
    v_mul_u32_u24 v107, 80, v107
    s_lshr_b32 s65, s62, 6
    s_add_u32 s65, s65, s68
    s_lshl_b32 s65, s65, 3
    v_cmp_gt_u32 vcc, 32, v76
    s_and_saveexec_b64 s[76:77], vcc
    buffer_store_dwordx2 v[118:119], v107, s[80:83], s65 offen
    s_or_b64 exec, exec, s[76:77]
.k2p1_kernel_end:
    s_endpgm

.globl k3p1_kernel
.p2align 8
.type k3p1_kernel,@function
k3p1_kernel:
    s_cmp_ge_u32 s2, 224
    s_cbranch_scc1 .k3p1_kernel_end
    s_load_dwordx16 s[16:31], s[0:1], 0
    s_load_dwordx4 s[32:35], s[0:1], 64
    s_load_dwordx2 s[36:37], s[0:1], 80
    s_waitcnt lgkmcnt(0)
    s_and_b32 s61, s2, 15
    s_lshl_b32 s61, s61, 7
    s_lshr_b32 s62, s2, 4
    s_lshl_b32 s62, s62, 7
    s_add_u32 s40, s36, 16572416
    s_addc_u32 s41, s37, 0
    s_and_b32 s41, s41, 0xffff
    s_mov_b32 s42, 2621440
    s_mov_b32 s43, 0x00020000
    s_add_u32 s44, s36, 3276800
    s_addc_u32 s45, s37, 0
    s_and_b32 s45, s45, 0xffff
    s_mov_b32 s46, 2211840
    s_mov_b32 s47, 0x00020000
    v_and_b32 v124, 63, v0
    v_lshrrev_b32 v125, 6, v0
    s_nop 0
    v_readfirstlane_b32 s60, v125
    s_nop 1
    s_mul_i32 s63, s60, 4096
    s_mul_i32 s64, s60, 4096
    s_mul_i32 s65, s60, 32
    s_add_u32 s65, s65, 0
    v_lshrrev_b32 v125, 3, v124
    v_add_u32 v125, s65, v125
    v_lshrrev_b32 v126, 1, v125
    v_and_b32 v126, 7, v126
    v_and_b32 v100, 7, v124
    v_xor_b32 v126, v100, v126
    v_lshlrev_b32 v126, 4, v126
    v_add_u32 v125, s61, v125
    s_mov_b32 s66, 1280
    v_mul_lo_u32 v125, v125, s66
    v_add_u32 v100, v125, v126
    s_mul_i32 s65, s60, 32
    s_add_u32 s65, s65, 8
    v_lshrrev_b32 v125, 3, v124
    v_add_u32 v125, s65, v125
    v_lshrrev_b32 v126, 1, v125
    v_and_b32 v126, 7, v126
    v_and_b32 v101, 7, v124
    v_xor_b32 v126, v101, v126
    v_lshlrev_b32 v126, 4, v126
    v_add_u32 v125, s61, v125
    s_mov_b32 s66, 1280
    v_mul_lo_u32 v125, v125, s66
    v_add_u32 v101, v125, v126
    s_mul_i32 s65, s60, 32
    s_add_u32 s65, s65, 16
    v_lshrrev_b32 v125, 3, v124
    v_add_u32 v125, s65, v125
    v_lshrrev_b32 v126, 1, v125
    v_and_b32 v126, 7, v126
    v_and_b32 v102, 7, v124
    v_xor_b32 v126, v102, v126
    v_lshlrev_b32 v126, 4, v126
    v_add_u32 v125, s61, v125
    s_mov_b32 s66, 1280
    v_mul_lo_u32 v125, v125, s66
    v_add_u32 v102, v125, v126
    s_mul_i32 s65, s60, 32
    s_add_u32 s65, s65, 24
    v_lshrrev_b32 v125, 3, v124
    v_add_u32 v125, s65, v125
    v_lshrrev_b32 v126, 1, v125
    v_and_b32 v126, 7, v126
    v_and_b32 v103, 7, v124
    v_xor_b32 v126, v103, v126
    v_lshlrev_b32 v126, 4, v126
    v_add_u32 v125, s61, v125
    s_mov_b32 s66, 1280
    v_mul_lo_u32 v125, v125, s66
    v_add_u32 v103, v125, v126
    s_mul_i32 s65, s60, 32
    s_add_u32 s65, s65, 0
    v_lshrrev_b32 v125, 3, v124
    v_add_u32 v125, s65, v125
    v_lshrrev_b32 v126, 1, v125
    v_and_b32 v126, 7, v126
    v_and_b32 v104, 7, v124
    v_xor_b32 v126, v104, v126
    v_lshlrev_b32 v126, 4, v126
    v_add_u32 v125, s62, v125
    s_mov_b32 s66, 1280
    v_mul_lo_u32 v125, v125, s66
    v_add_u32 v104, v125, v126
    s_mul_i32 s65, s60, 32
    s_add_u32 s65, s65, 8
    v_lshrrev_b32 v125, 3, v124
    v_add_u32 v125, s65, v125
    v_lshrrev_b32 v126, 1, v125
    v_and_b32 v126, 7, v126
    v_and_b32 v105, 7, v124
    v_xor_b32 v126, v105, v126
    v_lshlrev_b32 v126, 4, v126
    v_add_u32 v125, s62, v125
    s_mov_b32 s66, 1280
    v_mul_lo_u32 v125, v125, s66
    v_add_u32 v105, v125, v126
    s_mul_i32 s65, s60, 32
    s_add_u32 s65, s65, 16
    v_lshrrev_b32 v125, 3, v124
    v_add_u32 v125, s65, v125
    v_lshrrev_b32 v126, 1, v125
    v_and_b32 v126, 7, v126
    v_and_b32 v106, 7, v124
    v_xor_b32 v126, v106, v126
    v_lshlrev_b32 v126, 4, v126
    v_add_u32 v125, s62, v125
    s_mov_b32 s66, 1280
    v_mul_lo_u32 v125, v125, s66
    v_add_u32 v106, v125, v126
    s_mul_i32 s65, s60, 32
    s_add_u32 s65, s65, 24
    v_lshrrev_b32 v125, 3, v124
    v_add_u32 v125, s65, v125
    v_lshrrev_b32 v126, 1, v125
    v_and_b32 v126, 7, v126
    v_and_b32 v107, 7, v124
    v_xor_b32 v126, v107, v126
    v_lshlrev_b32 v126, 4, v126
    v_add_u32 v125, s62, v125
    s_mov_b32 s66, 1280
    v_mul_lo_u32 v125, v125, s66
    v_add_u32 v107, v125, v126
    s_and_b32 s67, s60, 1
    s_lshr_b32 s68, s60, 1
    v_lshrrev_b32 v125, 5, v124
    v_add_u32 v125, 0, v125
    v_lshrrev_b32 v126, 1, v124
    v_and_b32 v126, 7, v126
    v_xor_b32 v125, v125, v126
    v_lshlrev_b32 v125, 4, v125
    v_and_b32 v126, 31, v124
    v_lshl_add_u32 v125, v126, 7, v125
    s_mul_i32 s65, s67, 8192
    v_add_u32 v108, s65, v125
    v_add_u32 v120, 0x10000, v108
    s_mul_i32 s65, s68, 8192
    v_add_u32 v112, s65, v125
    v_add_u32 v116, 0x10000, v112
    v_lshrrev_b32 v125, 5, v124
    v_add_u32 v125, 2, v125
    v_lshrrev_b32 v126, 1, v124
    v_and_b32 v126, 7, v126
    v_xor_b32 v125, v125, v126
    v_lshlrev_b32 v125, 4, v125
    v_and_b32 v126, 31, v124
    v_lshl_add_u32 v125, v126, 7, v125
    s_mul_i32 s65, s67, 8192
    v_add_u32 v109, s65, v125
    v_add_u32 v121, 0x10000, v109
    s_mul_i32 s65, s68, 8192
    v_add_u32 v113, s65, v125
    v_add_u32 v117, 0x10000, v113
    v_lshrrev_b32 v125, 5, v124
    v_add_u32 v125, 4, v125
    v_lshrrev_b32 v126, 1, v124
    v_and_b32 v126, 7, v126
    v_xor_b32 v125, v125, v126
    v_lshlrev_b32 v125, 4, v125
    v_and_b32 v126, 31, v124
    v_lshl_add_u32 v125, v126, 7, v125
    s_mul_i32 s65, s67, 8192
    v_add_u32 v110, s65, v125
    v_add_u32 v122, 0x10000, v110
    s_mul_i32 s65, s68, 8192
    v_add_u32 v114, s65, v125
    v_add_u32 v118, 0x10000, v114
    v_lshrrev_b32 v125, 5, v124
    v_add_u32 v125, 6, v125
    v_lshrrev_b32 v126, 1, v124
    v_and_b32 v126, 7, v126
    v_xor_b32 v125, v125, v126
    v_lshlrev_b32 v125, 4, v125
    v_and_b32 v126, 31, v124
    v_lshl_add_u32 v125, v126, 7, v125
    s_mul_i32 s65, s67, 8192
    v_add_u32 v111, s65, v125
    v_add_u32 v123, 0x10000, v111
    s_mul_i32 s65, s68, 8192
    v_add_u32 v115, s65, v125
    v_add_u32 v119, 0x10000, v115
    v_mov_b32 v4, 0
    v_mov_b32 v5, 0
    v_mov_b32 v6, 0
    v_mov_b32 v7, 0
    v_mov_b32 v8, 0
    v_mov_b32 v9, 0
    v_mov_b32 v10, 0
    v_mov_b32 v11, 0
    v_mov_b32 v12, 0
    v_mov_b32 v13, 0
    v_mov_b32 v14, 0
    v_mov_b32 v15, 0
    v_mov_b32 v16, 0
    v_mov_b32 v17, 0
    v_mov_b32 v18, 0
    v_mov_b32 v19, 0
    v_mov_b32 v20, 0
    v_mov_b32 v21, 0
    v_mov_b32 v22, 0
    v_mov_b32 v23, 0
    v_mov_b32 v24, 0
    v_mov_b32 v25, 0
    v_mov_b32 v26, 0
    v_mov_b32 v27, 0
    v_mov_b32 v28, 0
    v_mov_b32 v29, 0
    v_mov_b32 v30, 0
    v_mov_b32 v31, 0
    v_mov_b32 v32, 0
    v_mov_b32 v33, 0
    v_mov_b32 v34, 0
    v_mov_b32 v35, 0
    v_mov_b32 v36, 0
    v_mov_b32 v37, 0
    v_mov_b32 v38, 0
    v_mov_b32 v39, 0
    v_mov_b32 v40, 0
    v_mov_b32 v41, 0
    v_mov_b32 v42, 0
    v_mov_b32 v43, 0
    v_mov_b32 v44, 0
    v_mov_b32 v45, 0
    v_mov_b32 v46, 0
    v_mov_b32 v47, 0
    v_mov_b32 v48, 0
    v_mov_b32 v49, 0
    v_mov_b32 v50, 0
    v_mov_b32 v51, 0
    v_mov_b32 v52, 0
    v_mov_b32 v53, 0
    v_mov_b32 v54, 0
    v_mov_b32 v55, 0
    v_mov_b32 v56, 0
    v_mov_b32 v57, 0
    v_mov_b32 v58, 0
    v_mov_b32 v59, 0
    v_mov_b32 v60, 0
    v_mov_b32 v61, 0
    v_mov_b32 v62, 0
    v_mov_b32 v63, 0
    v_mov_b32 v64, 0
    v_mov_b32 v65, 0
    v_mov_b32 v66, 0
    v_mov_b32 v67, 0
    s_mov_b32 s69, 0
    s_add_u32 m0, s63, 1024
    buffer_load_dwordx4 v100, s[40:43], s69 offen lds
    s_add_u32 m0, s63, 2048
    buffer_load_dwordx4 v101, s[40:43], s69 offen lds
    s_add_u32 m0, s63, 3072
    buffer_load_dwordx4 v102, s[40:43], s69 offen lds
    s_add_u32 m0, s63, 4096
    buffer_load_dwordx4 v103, s[40:43], s69 offen lds
    s_add_u32 m0, s64, 17408
    buffer_load_dwordx4 v104, s[44:47], s69 offen lds
    s_add_u32 m0, s64, 18432
    buffer_load_dwordx4 v105, s[44:47], s69 offen lds
    s_add_u32 m0, s64, 19456
    buffer_load_dwordx4 v106, s[44:47], s69 offen lds
    s_add_u32 m0, s64, 20480
    buffer_load_dwordx4 v107, s[44:47], s69 offen lds
    s_mov_b32 s69, 128
    s_add_u32 m0, s63, 33792
    buffer_load_dwordx4 v100, s[40:43], s69 offen lds
    s_add_u32 m0, s63, 34816
    buffer_load_dwordx4 v101, s[40:43], s69 offen lds
    s_add_u32 m0, s63, 35840
    buffer_load_dwordx4 v102, s[40:43], s69 offen lds
    s_add_u32 m0, s63, 36864
    buffer_load_dwordx4 v103, s[40:43], s69 offen lds
    s_add_u32 m0, s64, 50176
    buffer_load_dwordx4 v104, s[44:47], s69 offen lds
    s_add_u32 m0, s64, 51200
    buffer_load_dwordx4 v105, s[44:47], s69 offen lds
    s_add_u32 m0, s64, 52224
    buffer_load_dwordx4 v106, s[44:47], s69 offen lds
    s_add_u32 m0, s64, 53248
    buffer_load_dwordx4 v107, s[44:47], s69 offen lds
    s_add_u32 s72, s36, 8208384
    s_addc_u32 s73, s37, 0
    s_and_b32 s73, s73, 0xffff
    s_mov_b32 s74, 163840
    s_mov_b32 s75, 0x00020000
    v_cmp_gt_u32 vcc, 128, v0
    s_and_saveexec_b64 s[76:77], vcc
    s_cbranch_execz .st_20
    v_add_u32 v88, s61, v0
    v_mul_u32_u24 v88, 80, v88
    buffer_load_dwordx4 v[68:71], v88, s[72:75], 0 offen offset:0
    buffer_load_dwordx4 v[72:75], v88, s[72:75], 0 offen offset:16
    buffer_load_dwordx4 v[76:79], v88, s[72:75], 0 offen offset:32
    buffer_load_dwordx4 v[80:83], v88, s[72:75], 0 offen offset:48
    buffer_load_dwordx4 v[84:87], v88, s[72:75], 0 offen offset:64
    s_waitcnt vmcnt(0)
    v_add_f32 v88, v68, v70
    v_add_f32 v89, v69, v71
    v_add_f32 v88, v88, v72
    v_add_f32 v89, v89, v73
    v_add_f32 v88, v88, v74
    v_add_f32 v89, v89, v75
    v_add_f32 v88, v88, v76
    v_add_f32 v89, v89, v77
    v_add_f32 v88, v88, v78
    v_add_f32 v89, v89, v79
    v_add_f32 v88, v88, v80
    v_add_f32 v89, v89, v81
    v_add_f32 v88, v88, v82
    v_add_f32 v89, v89, v83
    v_add_f32 v88, v88, v84
    v_add_f32 v89, v89, v85
    v_add_f32 v88, v88, v86
    v_add_f32 v89, v89, v87
    v_mul_f32 v88, 0x3acccccd, v88
    v_mul_f32 v89, 0x3acccccd, v89
    v_fma_f32 v89, -v88, v88, v89
    v_max_f32 v89, 0, v89
    v_cvt_pk_bf16_f32 v90, v88, v89
    v_lshlrev_b32 v88, 16, v90
    v_and_b32 v89, 0xffff0000, v90
    v_add_f32 v89, 0x3727c5ac, v89
    v_cvt_pk_bf16_f32 v90, v89, v89
    v_lshlrev_b32 v89, 16, v90
    v_sqrt_f32 v89, v89
    s_nop 0
    v_cvt_pk_bf16_f32 v90, v89, v89
    v_lshlrev_b32 v89, 16, v90
    v_rcp_f32 v89, v89
    v_lshlrev_b32 v90, 3, v0
    s_nop 0
    ds_write_b64 v90, v[88:89] offset:0
.st_20:
    s_or_b64 exec, exec, s[76:77]
    s_add_u32 s48, s36, 7708672
    s_addc_u32 s49, s37, 0
    s_and_b32 s49, s49, 0xffff
    s_mov_b32 s50, 6912
    s_mov_b32 s51, 0x00020000
    s_mov_b32 s52, s26
    s_mov_b32 s53, s27
    s_and_b32 s53, s53, 0xffff
    s_mov_b32 s54, 3456
    s_mov_b32 s55, 0x00020000
    s_add_u32 s56, s36, 19193856
    s_addc_u32 s57, s37, 0
    s_and_b32 s57, s57, 0xffff
    s_mov_b32 s58, 7077888
    s_mov_b32 s59, 0x00020000
    v_lshrrev_b32 v176, 5, v124
    v_lshlrev_b32 v176, 2, v176
    s_lshl_b32 s65, s68, 6
    v_add_u32 v176, s65, v176
    v_lshlrev_b32 v177, 2, v176
    s_lshl_b32 s65, s62, 2
    s_lshl_b32 s66, s62, 1
    buffer_load_dwordx4 v[128:131], v177, s[48:51], s65 offen offset:0
    buffer_load_dwordx4 v[132:135], v177, s[48:51], s65 offen offset:32
    buffer_load_dwordx4 v[136:139], v177, s[48:51], s65 offen offset:64
    buffer_load_dwordx4 v[140:143], v177, s[48:51], s65 offen offset:96
    buffer_load_dwordx4 v[144:147], v177, s[48:51], s65 offen offset:128
    buffer_load_dwordx4 v[148:151], v177, s[48:51], s65 offen offset:160
    buffer_load_dwordx4 v[152:155], v177, s[48:51], s65 offen offset:192
    buffer_load_dwordx4 v[156:159], v177, s[48:51], s65 offen offset:224
    v_lshlrev_b32 v177, 1, v176
    buffer_load_dwordx2 v[160:161], v177, s[52:55], s66 offen offset:0
    buffer_load_dwordx2 v[162:163], v177, s[52:55], s66 offen offset:16
    buffer_load_dwordx2 v[164:165], v177, s[52:55], s66 offen offset:32
    buffer_load_dwordx2 v[166:167], v177, s[52:55], s66 offen offset:48
    buffer_load_dwordx2 v[168:169], v177, s[52:55], s66 offen offset:64
    buffer_load_dwordx2 v[170:171], v177, s[52:55], s66 offen offset:80
    buffer_load_dwordx2 v[172:173], v177, s[52:55], s66 offen offset:96
    buffer_load_dwordx2 v[174:175], v177, s[52:55], s66 offen offset:112
    s_waitcnt vmcnt(29)
    s_barrier
    s_mov_b32 s69, 256
    s_add_u32 m0, s63, 66560
    buffer_load_dwordx4 v100, s[40:43], s69 offen lds
    s_add_u32 m0, s63, 67584
    buffer_load_dwordx4 v101, s[40:43], s69 offen lds
    s_add_u32 m0, s63, 68608
    buffer_load_dwordx4 v102, s[40:43], s69 offen lds
    s_add_u32 m0, s63, 69632
    buffer_load_dwordx4 v103, s[40:43], s69 offen lds
    s_add_u32 m0, s64, 82944
    buffer_load_dwordx4 v104, s[44:47], s69 offen lds
    s_add_u32 m0, s64, 83968
    buffer_load_dwordx4 v105, s[44:47], s69 offen lds
    s_add_u32 m0, s64, 84992
    buffer_load_dwordx4 v106, s[44:47], s69 offen lds
    s_add_u32 m0, s64, 86016
    buffer_load_dwordx4 v107, s[44:47], s69 offen lds
    ds_read_b128 v[68:71], v108 offset:1024
    ds_read_b128 v[72:75], v108 offset:5120
    ds_read_b128 v[84:87], v112 offset:17408
    ds_read_b128 v[88:91], v112 offset:21504
    ds_read_b128 v[76:79], v109 offset:1024
    ds_read_b128 v[80:83], v109 offset:5120
    ds_read_b128 v[92:95], v113 offset:17408
    ds_read_b128 v[96:99], v113 offset:21504
    s_waitcnt lgkmcnt(4)
    v_mfma_f32_32x32x16_bf16 v[4:19], v[84:87], v[68:71], v[4:19]
    v_mfma_f32_32x32x16_bf16 v[20:35], v[88:91], v[68:71], v[20:35]
    v_mfma_f32_32x32x16_bf16 v[36:51], v[84:87], v[72:75], v[36:51]
    v_mfma_f32_32x32x16_bf16 v[52:67], v[88:91], v[72:75], v[52:67]
    ds_read_b128 v[68:71], v110 offset:1024
    ds_read_b128 v[72:75], v110 offset:5120
    ds_read_b128 v[84:87], v114 offset:17408
    ds_read_b128 v[88:91], v114 offset:21504
    s_waitcnt lgkmcnt(4)
    v_mfma_f32_32x32x16_bf16 v[4:19], v[92:95], v[76:79], v[4:19]
    v_mfma_f32_32x32x16_bf16 v[20:35], v[96:99], v[76:79], v[20:35]
    v_mfma_f32_32x32x16_bf16 v[36:51], v[92:95], v[80:83], v[36:51]
    v_mfma_f32_32x32x16_bf16 v[52:67], v[96:99], v[80:83], v[52:67]
    ds_read_b128 v[76:79], v111 offset:1024
    ds_read_b128 v[80:83], v111 offset:5120
    ds_read_b128 v[92:95], v115 offset:17408
    ds_read_b128 v[96:99], v115 offset:21504
    s_waitcnt lgkmcnt(4)
    v_mfma_f32_32x32x16_bf16 v[4:19], v[84:87], v[68:71], v[4:19]
    v_mfma_f32_32x32x16_bf16 v[20:35], v[88:91], v[68:71], v[20:35]
    v_mfma_f32_32x32x16_bf16 v[36:51], v[84:87], v[72:75], v[36:51]
    v_mfma_f32_32x32x16_bf16 v[52:67], v[88:91], v[72:75], v[52:67]
    s_waitcnt vmcnt(29) lgkmcnt(0)
    s_barrier
    s_mov_b32 s69, 384
    s_add_u32 m0, s63, 1024
    buffer_load_dwordx4 v100, s[40:43], s69 offen lds
    s_add_u32 m0, s63, 2048
    buffer_load_dwordx4 v101, s[40:43], s69 offen lds
    s_add_u32 m0, s63, 3072
    buffer_load_dwordx4 v102, s[40:43], s69 offen lds
    s_add_u32 m0, s63, 4096
    buffer_load_dwordx4 v103, s[40:43], s69 offen lds
    s_add_u32 m0, s64, 17408
    buffer_load_dwordx4 v104, s[44:47], s69 offen lds
    s_add_u32 m0, s64, 18432
    buffer_load_dwordx4 v105, s[44:47], s69 offen lds
    s_add_u32 m0, s64, 19456
    buffer_load_dwordx4 v106, s[44:47], s69 offen lds
    s_add_u32 m0, s64, 20480
    buffer_load_dwordx4 v107, s[44:47], s69 offen lds
    ds_read_b128 v[68:71], v108 offset:33792
    ds_read_b128 v[72:75], v108 offset:37888
    ds_read_b128 v[84:87], v112 offset:50176
    ds_read_b128 v[88:91], v112 offset:54272
    v_mfma_f32_32x32x16_bf16 v[4:19], v[92:95], v[76:79], v[4:19]
    v_mfma_f32_32x32x16_bf16 v[20:35], v[96:99], v[76:79], v[20:35]
    v_mfma_f32_32x32x16_bf16 v[36:51], v[92:95], v[80:83], v[36:51]
    v_mfma_f32_32x32x16_bf16 v[52:67], v[96:99], v[80:83], v[52:67]
    ds_read_b128 v[76:79], v109 offset:33792
    ds_read_b128 v[80:83], v109 offset:37888
    ds_read_b128 v[92:95], v113 offset:50176
    ds_read_b128 v[96:99], v113 offset:54272
    s_waitcnt lgkmcnt(4)
    v_mfma_f32_32x32x16_bf16 v[4:19], v[84:87], v[68:71], v[4:19]
    v_mfma_f32_32x32x16_bf16 v[20:35], v[88:91], v[68:71], v[20:35]
    v_mfma_f32_32x32x16_bf16 v[36:51], v[84:87], v[72:75], v[36:51]
    v_mfma_f32_32x32x16_bf16 v[52:67], v[88:91], v[72:75], v[52:67]
    ds_read_b128 v[68:71], v110 offset:33792
    ds_read_b128 v[72:75], v110 offset:37888
    ds_read_b128 v[84:87], v114 offset:50176
    ds_read_b128 v[88:91], v114 offset:54272
    s_waitcnt lgkmcnt(4)
    v_mfma_f32_32x32x16_bf16 v[4:19], v[92:95], v[76:79], v[4:19]
    v_mfma_f32_32x32x16_bf16 v[20:35], v[96:99], v[76:79], v[20:35]
    v_mfma_f32_32x32x16_bf16 v[36:51], v[92:95], v[80:83], v[36:51]
    v_mfma_f32_32x32x16_bf16 v[52:67], v[96:99], v[80:83], v[52:67]
    ds_read_b128 v[76:79], v111 offset:33792
    ds_read_b128 v[80:83], v111 offset:37888
    ds_read_b128 v[92:95], v115 offset:50176
    ds_read_b128 v[96:99], v115 offset:54272
    s_waitcnt lgkmcnt(4)
    v_mfma_f32_32x32x16_bf16 v[4:19], v[84:87], v[68:71], v[4:19]
    v_mfma_f32_32x32x16_bf16 v[20:35], v[88:91], v[68:71], v[20:35]
    v_mfma_f32_32x32x16_bf16 v[36:51], v[84:87], v[72:75], v[36:51]
    v_mfma_f32_32x32x16_bf16 v[52:67], v[88:91], v[72:75], v[52:67]
    s_waitcnt vmcnt(8) lgkmcnt(0)
    s_barrier
    s_mov_b32 s69, 512
    s_add_u32 m0, s63, 33792
    buffer_load_dwordx4 v100, s[40:43], s69 offen lds
    s_add_u32 m0, s63, 34816
    buffer_load_dwordx4 v101, s[40:43], s69 offen lds
    s_add_u32 m0, s63, 35840
    buffer_load_dwordx4 v102, s[40:43], s69 offen lds
    s_add_u32 m0, s63, 36864
    buffer_load_dwordx4 v103, s[40:43], s69 offen lds
    s_add_u32 m0, s64, 50176
    buffer_load_dwordx4 v104, s[44:47], s69 offen lds
    s_add_u32 m0, s64, 51200
    buffer_load_dwordx4 v105, s[44:47], s69 offen lds
    s_add_u32 m0, s64, 52224
    buffer_load_dwordx4 v106, s[44:47], s69 offen lds
    s_add_u32 m0, s64, 53248
    buffer_load_dwordx4 v107, s[44:47], s69 offen lds
    ds_read_b128 v[68:71], v120 offset:1024
    ds_read_b128 v[72:75], v120 offset:5120
    ds_read_b128 v[84:87], v116 offset:17408
    ds_read_b128 v[88:91], v116 offset:21504
    v_mfma_f32_32x32x16_bf16 v[4:19], v[92:95], v[76:79], v[4:19]
    v_mfma_f32_32x32x16_bf16 v[20:35], v[96:99], v[76:79], v[20:35]
    v_mfma_f32_32x32x16_bf16 v[36:51], v[92:95], v[80:83], v[36:51]
    v_mfma_f32_32x32x16_bf16 v[52:67], v[96:99], v[80:83], v[52:67]
    ds_read_b128 v[76:79], v121 offset:1024
    ds_read_b128 v[80:83], v121 offset:5120
    ds_read_b128 v[92:95], v117 offset:17408
    ds_read_b128 v[96:99], v117 offset:21504
    s_waitcnt lgkmcnt(4)
    v_mfma_f32_32x32x16_bf16 v[4:19], v[84:87], v[68:71], v[4:19]
    v_mfma_f32_32x32x16_bf16 v[20:35], v[88:91], v[68:71], v[20:35]
    v_mfma_f32_32x32x16_bf16 v[36:51], v[84:87], v[72:75], v[36:51]
    v_mfma_f32_32x32x16_bf16 v[52:67], v[88:91], v[72:75], v[52:67]
    ds_read_b128 v[68:71], v122 offset:1024
    ds_read_b128 v[72:75], v122 offset:5120
    ds_read_b128 v[84:87], v118 offset:17408
    ds_read_b128 v[88:91], v118 offset:21504
    s_waitcnt lgkmcnt(4)
    v_mfma_f32_32x32x16_bf16 v[4:19], v[92:95], v[76:79], v[4:19]
    v_mfma_f32_32x32x16_bf16 v[20:35], v[96:99], v[76:79], v[20:35]
    v_mfma_f32_32x32x16_bf16 v[36:51], v[92:95], v[80:83], v[36:51]
    v_mfma_f32_32x32x16_bf16 v[52:67], v[96:99], v[80:83], v[52:67]
    ds_read_b128 v[76:79], v123 offset:1024
    ds_read_b128 v[80:83], v123 offset:5120
    ds_read_b128 v[92:95], v119 offset:17408
    ds_read_b128 v[96:99], v119 offset:21504
    s_waitcnt lgkmcnt(4)
    v_mfma_f32_32x32x16_bf16 v[4:19], v[84:87], v[68:71], v[4:19]
    v_mfma_f32_32x32x16_bf16 v[20:35], v[88:91], v[68:71], v[20:35]
    v_mfma_f32_32x32x16_bf16 v[36:51], v[84:87], v[72:75], v[36:51]
    v_mfma_f32_32x32x16_bf16 v[52:67], v[88:91], v[72:75], v[52:67]
    s_waitcnt vmcnt(8) lgkmcnt(0)
    s_barrier
    s_mov_b32 s69, 640
    s_add_u32 m0, s63, 66560
    buffer_load_dwordx4 v100, s[40:43], s69 offen lds
    s_add_u32 m0, s63, 67584
    buffer_load_dwordx4 v101, s[40:43], s69 offen lds
    s_add_u32 m0, s63, 68608
    buffer_load_dwordx4 v102, s[40:43], s69 offen lds
    s_add_u32 m0, s63, 69632
    buffer_load_dwordx4 v103, s[40:43], s69 offen lds
    s_add_u32 m0, s64, 82944
    buffer_load_dwordx4 v104, s[44:47], s69 offen lds
    s_add_u32 m0, s64, 83968
    buffer_load_dwordx4 v105, s[44:47], s69 offen lds
    s_add_u32 m0, s64, 84992
    buffer_load_dwordx4 v106, s[44:47], s69 offen lds
    s_add_u32 m0, s64, 86016
    buffer_load_dwordx4 v107, s[44:47], s69 offen lds
    ds_read_b128 v[68:71], v108 offset:1024
    ds_read_b128 v[72:75], v108 offset:5120
    ds_read_b128 v[84:87], v112 offset:17408
    ds_read_b128 v[88:91], v112 offset:21504
    v_mfma_f32_32x32x16_bf16 v[4:19], v[92:95], v[76:79], v[4:19]
    v_mfma_f32_32x32x16_bf16 v[20:35], v[96:99], v[76:79], v[20:35]
    v_mfma_f32_32x32x16_bf16 v[36:51], v[92:95], v[80:83], v[36:51]
    v_mfma_f32_32x32x16_bf16 v[52:67], v[96:99], v[80:83], v[52:67]
    ds_read_b128 v[76:79], v109 offset:1024
    ds_read_b128 v[80:83], v109 offset:5120
    ds_read_b128 v[92:95], v113 offset:17408
    ds_read_b128 v[96:99], v113 offset:21504
    s_waitcnt lgkmcnt(4)
    v_mfma_f32_32x32x16_bf16 v[4:19], v[84:87], v[68:71], v[4:19]
    v_mfma_f32_32x32x16_bf16 v[20:35], v[88:91], v[68:71], v[20:35]
    v_mfma_f32_32x32x16_bf16 v[36:51], v[84:87], v[72:75], v[36:51]
    v_mfma_f32_32x32x16_bf16 v[52:67], v[88:91], v[72:75], v[52:67]
    ds_read_b128 v[68:71], v110 offset:1024
    ds_read_b128 v[72:75], v110 offset:5120
    ds_read_b128 v[84:87], v114 offset:17408
    ds_read_b128 v[88:91], v114 offset:21504
    s_waitcnt lgkmcnt(4)
    v_mfma_f32_32x32x16_bf16 v[4:19], v[92:95], v[76:79], v[4:19]
    v_mfma_f32_32x32x16_bf16 v[20:35], v[96:99], v[76:79], v[20:35]
    v_mfma_f32_32x32x16_bf16 v[36:51], v[92:95], v[80:83], v[36:51]
    v_mfma_f32_32x32x16_bf16 v[52:67], v[96:99], v[80:83], v[52:67]
    ds_read_b128 v[76:79], v111 offset:1024
    ds_read_b128 v[80:83], v111 offset:5120
    ds_read_b128 v[92:95], v115 offset:17408
    ds_read_b128 v[96:99], v115 offset:21504
    s_waitcnt lgkmcnt(4)
    v_mfma_f32_32x32x16_bf16 v[4:19], v[84:87], v[68:71], v[4:19]
    v_mfma_f32_32x32x16_bf16 v[20:35], v[88:91], v[68:71], v[20:35]
    v_mfma_f32_32x32x16_bf16 v[36:51], v[84:87], v[72:75], v[36:51]
    v_mfma_f32_32x32x16_bf16 v[52:67], v[88:91], v[72:75], v[52:67]
    s_waitcnt vmcnt(8) lgkmcnt(0)
    s_barrier
    s_mov_b32 s69, 768
    s_add_u32 m0, s63, 1024
    buffer_load_dwordx4 v100, s[40:43], s69 offen lds
    s_add_u32 m0, s63, 2048
    buffer_load_dwordx4 v101, s[40:43], s69 offen lds
    s_add_u32 m0, s63, 3072
    buffer_load_dwordx4 v102, s[40:43], s69 offen lds
    s_add_u32 m0, s63, 4096
    buffer_load_dwordx4 v103, s[40:43], s69 offen lds
    s_add_u32 m0, s64, 17408
    buffer_load_dwordx4 v104, s[44:47], s69 offen lds
    s_add_u32 m0, s64, 18432
    buffer_load_dwordx4 v105, s[44:47], s69 offen lds
    s_add_u32 m0, s64, 19456
    buffer_load_dwordx4 v106, s[44:47], s69 offen lds
    s_add_u32 m0, s64, 20480
    buffer_load_dwordx4 v107, s[44:47], s69 offen lds
    ds_read_b128 v[68:71], v108 offset:33792
    ds_read_b128 v[72:75], v108 offset:37888
    ds_read_b128 v[84:87], v112 offset:50176
    ds_read_b128 v[88:91], v112 offset:54272
    v_mfma_f32_32x32x16_bf16 v[4:19], v[92:95], v[76:79], v[4:19]
    v_mfma_f32_32x32x16_bf16 v[20:35], v[96:99], v[76:79], v[20:35]
    v_mfma_f32_32x32x16_bf16 v[36:51], v[92:95], v[80:83], v[36:51]
    v_mfma_f32_32x32x16_bf16 v[52:67], v[96:99], v[80:83], v[52:67]
    ds_read_b128 v[76:79], v109 offset:33792
    ds_read_b128 v[80:83], v109 offset:37888
    ds_read_b128 v[92:95], v113 offset:50176
    ds_read_b128 v[96:99], v113 offset:54272
    s_waitcnt lgkmcnt(4)
    v_mfma_f32_32x32x16_bf16 v[4:19], v[84:87], v[68:71], v[4:19]
    v_mfma_f32_32x32x16_bf16 v[20:35], v[88:91], v[68:71], v[20:35]
    v_mfma_f32_32x32x16_bf16 v[36:51], v[84:87], v[72:75], v[36:51]
    v_mfma_f32_32x32x16_bf16 v[52:67], v[88:91], v[72:75], v[52:67]
    ds_read_b128 v[68:71], v110 offset:33792
    ds_read_b128 v[72:75], v110 offset:37888
    ds_read_b128 v[84:87], v114 offset:50176
    ds_read_b128 v[88:91], v114 offset:54272
    s_waitcnt lgkmcnt(4)
    v_mfma_f32_32x32x16_bf16 v[4:19], v[92:95], v[76:79], v[4:19]
    v_mfma_f32_32x32x16_bf16 v[20:35], v[96:99], v[76:79], v[20:35]
    v_mfma_f32_32x32x16_bf16 v[36:51], v[92:95], v[80:83], v[36:51]
    v_mfma_f32_32x32x16_bf16 v[52:67], v[96:99], v[80:83], v[52:67]
    ds_read_b128 v[76:79], v111 offset:33792
    ds_read_b128 v[80:83], v111 offset:37888
    ds_read_b128 v[92:95], v115 offset:50176
    ds_read_b128 v[96:99], v115 offset:54272
    s_waitcnt lgkmcnt(4)
    v_mfma_f32_32x32x16_bf16 v[4:19], v[84:87], v[68:71], v[4:19]
    v_mfma_f32_32x32x16_bf16 v[20:35], v[88:91], v[68:71], v[20:35]
    v_mfma_f32_32x32x16_bf16 v[36:51], v[84:87], v[72:75], v[36:51]
    v_mfma_f32_32x32x16_bf16 v[52:67], v[88:91], v[72:75], v[52:67]
    s_waitcnt vmcnt(8) lgkmcnt(0)
    s_barrier
    s_mov_b32 s69, 896
    s_add_u32 m0, s63, 33792
    buffer_load_dwordx4 v100, s[40:43], s69 offen lds
    s_add_u32 m0, s63, 34816
    buffer_load_dwordx4 v101, s[40:43], s69 offen lds
    s_add_u32 m0, s63, 35840
    buffer_load_dwordx4 v102, s[40:43], s69 offen lds
    s_add_u32 m0, s63, 36864
    buffer_load_dwordx4 v103, s[40:43], s69 offen lds
    s_add_u32 m0, s64, 50176
    buffer_load_dwordx4 v104, s[44:47], s69 offen lds
    s_add_u32 m0, s64, 51200
    buffer_load_dwordx4 v105, s[44:47], s69 offen lds
    s_add_u32 m0, s64, 52224
    buffer_load_dwordx4 v106, s[44:47], s69 offen lds
    s_add_u32 m0, s64, 53248
    buffer_load_dwordx4 v107, s[44:47], s69 offen lds
    ds_read_b128 v[68:71], v120 offset:1024
    ds_read_b128 v[72:75], v120 offset:5120
    ds_read_b128 v[84:87], v116 offset:17408
    ds_read_b128 v[88:91], v116 offset:21504
    v_mfma_f32_32x32x16_bf16 v[4:19], v[92:95], v[76:79], v[4:19]
    v_mfma_f32_32x32x16_bf16 v[20:35], v[96:99], v[76:79], v[20:35]
    v_mfma_f32_32x32x16_bf16 v[36:51], v[92:95], v[80:83], v[36:51]
    v_mfma_f32_32x32x16_bf16 v[52:67], v[96:99], v[80:83], v[52:67]
    ds_read_b128 v[76:79], v121 offset:1024
    ds_read_b128 v[80:83], v121 offset:5120
    ds_read_b128 v[92:95], v117 offset:17408
    ds_read_b128 v[96:99], v117 offset:21504
    s_waitcnt lgkmcnt(4)
    v_mfma_f32_32x32x16_bf16 v[4:19], v[84:87], v[68:71], v[4:19]
    v_mfma_f32_32x32x16_bf16 v[20:35], v[88:91], v[68:71], v[20:35]
    v_mfma_f32_32x32x16_bf16 v[36:51], v[84:87], v[72:75], v[36:51]
    v_mfma_f32_32x32x16_bf16 v[52:67], v[88:91], v[72:75], v[52:67]
    ds_read_b128 v[68:71], v122 offset:1024
    ds_read_b128 v[72:75], v122 offset:5120
    ds_read_b128 v[84:87], v118 offset:17408
    ds_read_b128 v[88:91], v118 offset:21504
    s_waitcnt lgkmcnt(4)
    v_mfma_f32_32x32x16_bf16 v[4:19], v[92:95], v[76:79], v[4:19]
    v_mfma_f32_32x32x16_bf16 v[20:35], v[96:99], v[76:79], v[20:35]
    v_mfma_f32_32x32x16_bf16 v[36:51], v[92:95], v[80:83], v[36:51]
    v_mfma_f32_32x32x16_bf16 v[52:67], v[96:99], v[80:83], v[52:67]
    ds_read_b128 v[76:79], v123 offset:1024
    ds_read_b128 v[80:83], v123 offset:5120
    ds_read_b128 v[92:95], v119 offset:17408
    ds_read_b128 v[96:99], v119 offset:21504
    s_waitcnt lgkmcnt(4)
    v_mfma_f32_32x32x16_bf16 v[4:19], v[84:87], v[68:71], v[4:19]
    v_mfma_f32_32x32x16_bf16 v[20:35], v[88:91], v[68:71], v[20:35]
    v_mfma_f32_32x32x16_bf16 v[36:51], v[84:87], v[72:75], v[36:51]
    v_mfma_f32_32x32x16_bf16 v[52:67], v[88:91], v[72:75], v[52:67]
    s_waitcnt vmcnt(8) lgkmcnt(0)
    s_barrier
    s_mov_b32 s69, 1024
    s_add_u32 m0, s63, 66560
    buffer_load_dwordx4 v100, s[40:43], s69 offen lds
    s_add_u32 m0, s63, 67584
    buffer_load_dwordx4 v101, s[40:43], s69 offen lds
    s_add_u32 m0, s63, 68608
    buffer_load_dwordx4 v102, s[40:43], s69 offen lds
    s_add_u32 m0, s63, 69632
    buffer_load_dwordx4 v103, s[40:43], s69 offen lds
    s_add_u32 m0, s64, 82944
    buffer_load_dwordx4 v104, s[44:47], s69 offen lds
    s_add_u32 m0, s64, 83968
    buffer_load_dwordx4 v105, s[44:47], s69 offen lds
    s_add_u32 m0, s64, 84992
    buffer_load_dwordx4 v106, s[44:47], s69 offen lds
    s_add_u32 m0, s64, 86016
    buffer_load_dwordx4 v107, s[44:47], s69 offen lds
    ds_read_b128 v[68:71], v108 offset:1024
    ds_read_b128 v[72:75], v108 offset:5120
    ds_read_b128 v[84:87], v112 offset:17408
    ds_read_b128 v[88:91], v112 offset:21504
    v_mfma_f32_32x32x16_bf16 v[4:19], v[92:95], v[76:79], v[4:19]
    v_mfma_f32_32x32x16_bf16 v[20:35], v[96:99], v[76:79], v[20:35]
    v_mfma_f32_32x32x16_bf16 v[36:51], v[92:95], v[80:83], v[36:51]
    v_mfma_f32_32x32x16_bf16 v[52:67], v[96:99], v[80:83], v[52:67]
    ds_read_b128 v[76:79], v109 offset:1024
    ds_read_b128 v[80:83], v109 offset:5120
    ds_read_b128 v[92:95], v113 offset:17408
    ds_read_b128 v[96:99], v113 offset:21504
    s_waitcnt lgkmcnt(4)
    v_mfma_f32_32x32x16_bf16 v[4:19], v[84:87], v[68:71], v[4:19]
    v_mfma_f32_32x32x16_bf16 v[20:35], v[88:91], v[68:71], v[20:35]
    v_mfma_f32_32x32x16_bf16 v[36:51], v[84:87], v[72:75], v[36:51]
    v_mfma_f32_32x32x16_bf16 v[52:67], v[88:91], v[72:75], v[52:67]
    ds_read_b128 v[68:71], v110 offset:1024
    ds_read_b128 v[72:75], v110 offset:5120
    ds_read_b128 v[84:87], v114 offset:17408
    ds_read_b128 v[88:91], v114 offset:21504
    s_waitcnt lgkmcnt(4)
    v_mfma_f32_32x32x16_bf16 v[4:19], v[92:95], v[76:79], v[4:19]
    v_mfma_f32_32x32x16_bf16 v[20:35], v[96:99], v[76:79], v[20:35]
    v_mfma_f32_32x32x16_bf16 v[36:51], v[92:95], v[80:83], v[36:51]
    v_mfma_f32_32x32x16_bf16 v[52:67], v[96:99], v[80:83], v[52:67]
    ds_read_b128 v[76:79], v111 offset:1024
    ds_read_b128 v[80:83], v111 offset:5120
    ds_read_b128 v[92:95], v115 offset:17408
    ds_read_b128 v[96:99], v115 offset:21504
    s_waitcnt lgkmcnt(4)
    v_mfma_f32_32x32x16_bf16 v[4:19], v[84:87], v[68:71], v[4:19]
    v_mfma_f32_32x32x16_bf16 v[20:35], v[88:91], v[68:71], v[20:35]
    v_mfma_f32_32x32x16_bf16 v[36:51], v[84:87], v[72:75], v[36:51]
    v_mfma_f32_32x32x16_bf16 v[52:67], v[88:91], v[72:75], v[52:67]
    s_waitcnt vmcnt(8) lgkmcnt(0)
    s_barrier
    s_mov_b32 s69, 1152
    s_add_u32 m0, s63, 1024
    buffer_load_dwordx4 v100, s[40:43], s69 offen lds
    s_add_u32 m0, s63, 2048
    buffer_load_dwordx4 v101, s[40:43], s69 offen lds
    s_add_u32 m0, s63, 3072
    buffer_load_dwordx4 v102, s[40:43], s69 offen lds
    s_add_u32 m0, s63, 4096
    buffer_load_dwordx4 v103, s[40:43], s69 offen lds
    s_add_u32 m0, s64, 17408
    buffer_load_dwordx4 v104, s[44:47], s69 offen lds
    s_add_u32 m0, s64, 18432
    buffer_load_dwordx4 v105, s[44:47], s69 offen lds
    s_add_u32 m0, s64, 19456
    buffer_load_dwordx4 v106, s[44:47], s69 offen lds
    s_add_u32 m0, s64, 20480
    buffer_load_dwordx4 v107, s[44:47], s69 offen lds
    ds_read_b128 v[68:71], v108 offset:33792
    ds_read_b128 v[72:75], v108 offset:37888
    ds_read_b128 v[84:87], v112 offset:50176
    ds_read_b128 v[88:91], v112 offset:54272
    v_mfma_f32_32x32x16_bf16 v[4:19], v[92:95], v[76:79], v[4:19]
    v_mfma_f32_32x32x16_bf16 v[20:35], v[96:99], v[76:79], v[20:35]
    v_mfma_f32_32x32x16_bf16 v[36:51], v[92:95], v[80:83], v[36:51]
    v_mfma_f32_32x32x16_bf16 v[52:67], v[96:99], v[80:83], v[52:67]
    ds_read_b128 v[76:79], v109 offset:33792
    ds_read_b128 v[80:83], v109 offset:37888
    ds_read_b128 v[92:95], v113 offset:50176
    ds_read_b128 v[96:99], v113 offset:54272
    s_waitcnt lgkmcnt(4)
    v_mfma_f32_32x32x16_bf16 v[4:19], v[84:87], v[68:71], v[4:19]
    v_mfma_f32_32x32x16_bf16 v[20:35], v[88:91], v[68:71], v[20:35]
    v_mfma_f32_32x32x16_bf16 v[36:51], v[84:87], v[72:75], v[36:51]
    v_mfma_f32_32x32x16_bf16 v[52:67], v[88:91], v[72:75], v[52:67]
    ds_read_b128 v[68:71], v110 offset:33792
    ds_read_b128 v[72:75], v110 offset:37888
    ds_read_b128 v[84:87], v114 offset:50176
    ds_read_b128 v[88:91], v114 offset:54272
    s_waitcnt lgkmcnt(4)
    v_mfma_f32_32x32x16_bf16 v[4:19], v[92:95], v[76:79], v[4:19]
    v_mfma_f32_32x32x16_bf16 v[20:35], v[96:99], v[76:79], v[20:35]
    v_mfma_f32_32x32x16_bf16 v[36:51], v[92:95], v[80:83], v[36:51]
    v_mfma_f32_32x32x16_bf16 v[52:67], v[96:99], v[80:83], v[52:67]
    ds_read_b128 v[76:79], v111 offset:33792
    ds_read_b128 v[80:83], v111 offset:37888
    ds_read_b128 v[92:95], v115 offset:50176
    ds_read_b128 v[96:99], v115 offset:54272
    s_waitcnt lgkmcnt(4)
    v_mfma_f32_32x32x16_bf16 v[4:19], v[84:87], v[68:71], v[4:19]
    v_mfma_f32_32x32x16_bf16 v[20:35], v[88:91], v[68:71], v[20:35]
    v_mfma_f32_32x32x16_bf16 v[36:51], v[84:87], v[72:75], v[36:51]
    v_mfma_f32_32x32x16_bf16 v[52:67], v[88:91], v[72:75], v[52:67]
    s_waitcnt vmcnt(8) lgkmcnt(0)
    s_barrier
    ds_read_b128 v[68:71], v120 offset:1024
    ds_read_b128 v[72:75], v120 offset:5120
    ds_read_b128 v[84:87], v116 offset:17408
    ds_read_b128 v[88:91], v116 offset:21504
    v_mfma_f32_32x32x16_bf16 v[4:19], v[92:95], v[76:79], v[4:19]
    v_mfma_f32_32x32x16_bf16 v[20:35], v[96:99], v[76:79], v[20:35]
    v_mfma_f32_32x32x16_bf16 v[36:51], v[92:95], v[80:83], v[36:51]
    v_mfma_f32_32x32x16_bf16 v[52:67], v[96:99], v[80:83], v[52:67]
    ds_read_b128 v[76:79], v121 offset:1024
    ds_read_b128 v[80:83], v121 offset:5120
    ds_read_b128 v[92:95], v117 offset:17408
    ds_read_b128 v[96:99], v117 offset:21504
    s_waitcnt lgkmcnt(4)
    v_mfma_f32_32x32x16_bf16 v[4:19], v[84:87], v[68:71], v[4:19]
    v_mfma_f32_32x32x16_bf16 v[20:35], v[88:91], v[68:71], v[20:35]
    v_mfma_f32_32x32x16_bf16 v[36:51], v[84:87], v[72:75], v[36:51]
    v_mfma_f32_32x32x16_bf16 v[52:67], v[88:91], v[72:75], v[52:67]
    ds_read_b128 v[68:71], v122 offset:1024
    ds_read_b128 v[72:75], v122 offset:5120
    ds_read_b128 v[84:87], v118 offset:17408
    ds_read_b128 v[88:91], v118 offset:21504
    s_waitcnt lgkmcnt(4)
    v_mfma_f32_32x32x16_bf16 v[4:19], v[92:95], v[76:79], v[4:19]
    v_mfma_f32_32x32x16_bf16 v[20:35], v[96:99], v[76:79], v[20:35]
    v_mfma_f32_32x32x16_bf16 v[36:51], v[92:95], v[80:83], v[36:51]
    v_mfma_f32_32x32x16_bf16 v[52:67], v[96:99], v[80:83], v[52:67]
    ds_read_b128 v[76:79], v123 offset:1024
    ds_read_b128 v[80:83], v123 offset:5120
    ds_read_b128 v[92:95], v119 offset:17408
    ds_read_b128 v[96:99], v119 offset:21504
    s_waitcnt lgkmcnt(4)
    v_mfma_f32_32x32x16_bf16 v[4:19], v[84:87], v[68:71], v[4:19]
    v_mfma_f32_32x32x16_bf16 v[20:35], v[88:91], v[68:71], v[20:35]
    v_mfma_f32_32x32x16_bf16 v[36:51], v[84:87], v[72:75], v[36:51]
    v_mfma_f32_32x32x16_bf16 v[52:67], v[88:91], v[72:75], v[52:67]
    s_waitcnt vmcnt(0) lgkmcnt(0)
    s_barrier
    ds_read_b128 v[68:71], v108 offset:1024
    ds_read_b128 v[72:75], v108 offset:5120
    ds_read_b128 v[84:87], v112 offset:17408
    ds_read_b128 v[88:91], v112 offset:21504
    v_mfma_f32_32x32x16_bf16 v[4:19], v[92:95], v[76:79], v[4:19]
    v_mfma_f32_32x32x16_bf16 v[20:35], v[96:99], v[76:79], v[20:35]
    v_mfma_f32_32x32x16_bf16 v[36:51], v[92:95], v[80:83], v[36:51]
    v_mfma_f32_32x32x16_bf16 v[52:67], v[96:99], v[80:83], v[52:67]
    ds_read_b128 v[76:79], v109 offset:1024
    ds_read_b128 v[80:83], v109 offset:5120
    ds_read_b128 v[92:95], v113 offset:17408
    ds_read_b128 v[96:99], v113 offset:21504
    s_waitcnt lgkmcnt(4)
    v_mfma_f32_32x32x16_bf16 v[4:19], v[84:87], v[68:71], v[4:19]
    v_mfma_f32_32x32x16_bf16 v[20:35], v[88:91], v[68:71], v[20:35]
    v_mfma_f32_32x32x16_bf16 v[36:51], v[84:87], v[72:75], v[36:51]
    v_mfma_f32_32x32x16_bf16 v[52:67], v[88:91], v[72:75], v[52:67]
    ds_read_b128 v[68:71], v110 offset:1024
    ds_read_b128 v[72:75], v110 offset:5120
    ds_read_b128 v[84:87], v114 offset:17408
    ds_read_b128 v[88:91], v114 offset:21504
    s_waitcnt lgkmcnt(4)
    v_mfma_f32_32x32x16_bf16 v[4:19], v[92:95], v[76:79], v[4:19]
    v_mfma_f32_32x32x16_bf16 v[20:35], v[96:99], v[76:79], v[20:35]
    v_mfma_f32_32x32x16_bf16 v[36:51], v[92:95], v[80:83], v[36:51]
    v_mfma_f32_32x32x16_bf16 v[52:67], v[96:99], v[80:83], v[52:67]
    ds_read_b128 v[76:79], v111 offset:1024
    ds_read_b128 v[80:83], v111 offset:5120
    ds_read_b128 v[92:95], v115 offset:17408
    ds_read_b128 v[96:99], v115 offset:21504
    s_waitcnt lgkmcnt(4)
    v_mfma_f32_32x32x16_bf16 v[4:19], v[84:87], v[68:71], v[4:19]
    v_mfma_f32_32x32x16_bf16 v[20:35], v[88:91], v[68:71], v[20:35]
    v_mfma_f32_32x32x16_bf16 v[36:51], v[84:87], v[72:75], v[36:51]
    v_mfma_f32_32x32x16_bf16 v[52:67], v[88:91], v[72:75], v[52:67]
    s_waitcnt lgkmcnt(0)
    v_mfma_f32_32x32x16_bf16 v[4:19], v[92:95], v[76:79], v[4:19]
    v_mfma_f32_32x32x16_bf16 v[20:35], v[96:99], v[76:79], v[20:35]
    v_mfma_f32_32x32x16_bf16 v[36:51], v[92:95], v[80:83], v[36:51]
    v_mfma_f32_32x32x16_bf16 v[52:67], v[96:99], v[80:83], v[52:67]
    s_nop 7
    s_nop 7
    s_lshl_b32 s65, s68, 6
    s_add_u32 s65, s65, s62
    s_cmp_ge_u32 s65, 1728
    s_cbranch_scc1 .k3p1_kernel_end
    s_waitcnt vmcnt(0)
    v_and_b32 v182, 31, v124
    s_lshl_b32 s65, s67, 6
    v_add_u32 v182, s65, v182
    v_lshlrev_b32 v183, 3, v182
    ds_read_b64 v[178:179], v183 offset:0
    ds_read_b64 v[180:181], v183 offset:256
    v_add_u32 v182, s61, v182
    s_mov_b32 s65, 3456
    v_mul_lo_u32 v182, v182, s65
    v_lshlrev_b32 v183, 1, v176
    v_add_u32 v182, v182, v183
    s_lshl_b32 s66, s62, 1
    v_mov_b32 v184, 0xc0135761
    s_mov_b32 s70, 0xbdd2d3c4
    s_waitcnt lgkmcnt(0)
    v_fma_f32 v4, -v178, v128, v4
    v_mul_f32 v4, v4, v179
    v_fma_f32 v5, -v178, v129, v5
    v_mul_f32 v5, v5, v179
    v_fma_f32 v6, -v178, v130, v6
    v_mul_f32 v6, v6, v179
    v_fma_f32 v7, -v178, v131, v7
    v_mul_f32 v7, v7, v179
    v_cvt_pk_bf16_f32 v185, v4, v5
    v_lshlrev_b32 v4, 16, v185
    v_and_b32 v5, 0xffff0000, v185
    v_cvt_pk_bf16_f32 v186, v6, v7
    v_lshlrev_b32 v6, 16, v186
    v_and_b32 v7, 0xffff0000, v186
    v_lshlrev_b32 v188, 16, v160
    v_and_b32 v189, 0xffff0000, v160
    v_lshlrev_b32 v190, 16, v161
    v_and_b32 v191, 0xffff0000, v161
    v_add_f32 v4, v4, v188
    v_add_f32 v5, v5, v189
    v_add_f32 v6, v6, v190
    v_add_f32 v7, v7, v191
    v_cvt_pk_bf16_f32 v185, v4, v5
    v_lshlrev_b32 v4, 16, v185
    v_and_b32 v5, 0xffff0000, v185
    v_cvt_pk_bf16_f32 v186, v6, v7
    v_lshlrev_b32 v6, 16, v186
    v_and_b32 v7, 0xffff0000, v186
    v_mul_f32 v188, v4, v4
    v_fma_f32 v188, v188, s70, v184
    v_mul_f32 v188, v188, v4
    v_exp_f32 v188, v188
    s_nop 0
    v_add_f32 v188, 1.0, v188
    v_rcp_f32 v188, v188
    s_nop 0
    v_mul_f32 v4, v4, v188
    v_mul_f32 v189, v5, v5
    v_fma_f32 v189, v189, s70, v184
    v_mul_f32 v189, v189, v5
    v_exp_f32 v189, v189
    s_nop 0
    v_add_f32 v189, 1.0, v189
    v_rcp_f32 v189, v189
    s_nop 0
    v_mul_f32 v5, v5, v189
    v_mul_f32 v190, v6, v6
    v_fma_f32 v190, v190, s70, v184
    v_mul_f32 v190, v190, v6
    v_exp_f32 v190, v190
    s_nop 0
    v_add_f32 v190, 1.0, v190
    v_rcp_f32 v190, v190
    s_nop 0
    v_mul_f32 v6, v6, v190
    v_mul_f32 v191, v7, v7
    v_fma_f32 v191, v191, s70, v184
    v_mul_f32 v191, v191, v7
    v_exp_f32 v191, v191
    s_nop 0
    v_add_f32 v191, 1.0, v191
    v_rcp_f32 v191, v191
    s_nop 0
    v_mul_f32 v7, v7, v191
    v_cvt_pk_bf16_f32 v192, v4, v5
    v_cvt_pk_bf16_f32 v193, v6, v7
    buffer_store_dwordx2 v[192:193], v182, s[56:59], s66 offen offset:0
    s_nop 1
    v_fma_f32 v8, -v178, v132, v8
    v_mul_f32 v8, v8, v179
    v_fma_f32 v9, -v178, v133, v9
    v_mul_f32 v9, v9, v179
    v_fma_f32 v10, -v178, v134, v10
    v_mul_f32 v10, v10, v179
    v_fma_f32 v11, -v178, v135, v11
    v_mul_f32 v11, v11, v179
    v_cvt_pk_bf16_f32 v185, v8, v9
    v_lshlrev_b32 v8, 16, v185
    v_and_b32 v9, 0xffff0000, v185
    v_cvt_pk_bf16_f32 v186, v10, v11
    v_lshlrev_b32 v10, 16, v186
    v_and_b32 v11, 0xffff0000, v186
    v_lshlrev_b32 v188, 16, v162
    v_and_b32 v189, 0xffff0000, v162
    v_lshlrev_b32 v190, 16, v163
    v_and_b32 v191, 0xffff0000, v163
    v_add_f32 v8, v8, v188
    v_add_f32 v9, v9, v189
    v_add_f32 v10, v10, v190
    v_add_f32 v11, v11, v191
    v_cvt_pk_bf16_f32 v185, v8, v9
    v_lshlrev_b32 v8, 16, v185
    v_and_b32 v9, 0xffff0000, v185
    v_cvt_pk_bf16_f32 v186, v10, v11
    v_lshlrev_b32 v10, 16, v186
    v_and_b32 v11, 0xffff0000, v186
    v_mul_f32 v188, v8, v8
    v_fma_f32 v188, v188, s70, v184
    v_mul_f32 v188, v188, v8
    v_exp_f32 v188, v188
    s_nop 0
    v_add_f32 v188, 1.0, v188
    v_rcp_f32 v188, v188
    s_nop 0
    v_mul_f32 v8, v8, v188
    v_mul_f32 v189, v9, v9
    v_fma_f32 v189, v189, s70, v184
    v_mul_f32 v189, v189, v9
    v_exp_f32 v189, v189
    s_nop 0
    v_add_f32 v189, 1.0, v189
    v_rcp_f32 v189, v189
    s_nop 0
    v_mul_f32 v9, v9, v189
    v_mul_f32 v190, v10, v10
    v_fma_f32 v190, v190, s70, v184
    v_mul_f32 v190, v190, v10
    v_exp_f32 v190, v190
    s_nop 0
    v_add_f32 v190, 1.0, v190
    v_rcp_f32 v190, v190
    s_nop 0
    v_mul_f32 v10, v10, v190
    v_mul_f32 v191, v11, v11
    v_fma_f32 v191, v191, s70, v184
    v_mul_f32 v191, v191, v11
    v_exp_f32 v191, v191
    s_nop 0
    v_add_f32 v191, 1.0, v191
    v_rcp_f32 v191, v191
    s_nop 0
    v_mul_f32 v11, v11, v191
    v_cvt_pk_bf16_f32 v192, v8, v9
    v_cvt_pk_bf16_f32 v193, v10, v11
    buffer_store_dwordx2 v[192:193], v182, s[56:59], s66 offen offset:16
    s_nop 1
    v_fma_f32 v12, -v178, v136, v12
    v_mul_f32 v12, v12, v179
    v_fma_f32 v13, -v178, v137, v13
    v_mul_f32 v13, v13, v179
    v_fma_f32 v14, -v178, v138, v14
    v_mul_f32 v14, v14, v179
    v_fma_f32 v15, -v178, v139, v15
    v_mul_f32 v15, v15, v179
    v_cvt_pk_bf16_f32 v185, v12, v13
    v_lshlrev_b32 v12, 16, v185
    v_and_b32 v13, 0xffff0000, v185
    v_cvt_pk_bf16_f32 v186, v14, v15
    v_lshlrev_b32 v14, 16, v186
    v_and_b32 v15, 0xffff0000, v186
    v_lshlrev_b32 v188, 16, v164
    v_and_b32 v189, 0xffff0000, v164
    v_lshlrev_b32 v190, 16, v165
    v_and_b32 v191, 0xffff0000, v165
    v_add_f32 v12, v12, v188
    v_add_f32 v13, v13, v189
    v_add_f32 v14, v14, v190
    v_add_f32 v15, v15, v191
    v_cvt_pk_bf16_f32 v185, v12, v13
    v_lshlrev_b32 v12, 16, v185
    v_and_b32 v13, 0xffff0000, v185
    v_cvt_pk_bf16_f32 v186, v14, v15
    v_lshlrev_b32 v14, 16, v186
    v_and_b32 v15, 0xffff0000, v186
    v_mul_f32 v188, v12, v12
    v_fma_f32 v188, v188, s70, v184
    v_mul_f32 v188, v188, v12
    v_exp_f32 v188, v188
    s_nop 0
    v_add_f32 v188, 1.0, v188
    v_rcp_f32 v188, v188
    s_nop 0
    v_mul_f32 v12, v12, v188
    v_mul_f32 v189, v13, v13
    v_fma_f32 v189, v189, s70, v184
    v_mul_f32 v189, v189, v13
    v_exp_f32 v189, v189
    s_nop 0
    v_add_f32 v189, 1.0, v189
    v_rcp_f32 v189, v189
    s_nop 0
    v_mul_f32 v13, v13, v189
    v_mul_f32 v190, v14, v14
    v_fma_f32 v190, v190, s70, v184
    v_mul_f32 v190, v190, v14
    v_exp_f32 v190, v190
    s_nop 0
    v_add_f32 v190, 1.0, v190
    v_rcp_f32 v190, v190
    s_nop 0
    v_mul_f32 v14, v14, v190
    v_mul_f32 v191, v15, v15
    v_fma_f32 v191, v191, s70, v184
    v_mul_f32 v191, v191, v15
    v_exp_f32 v191, v191
    s_nop 0
    v_add_f32 v191, 1.0, v191
    v_rcp_f32 v191, v191
    s_nop 0
    v_mul_f32 v15, v15, v191
    v_cvt_pk_bf16_f32 v192, v12, v13
    v_cvt_pk_bf16_f32 v193, v14, v15
    buffer_store_dwordx2 v[192:193], v182, s[56:59], s66 offen offset:32
    s_nop 1
    v_fma_f32 v16, -v178, v140, v16
    v_mul_f32 v16, v16, v179
    v_fma_f32 v17, -v178, v141, v17
    v_mul_f32 v17, v17, v179
    v_fma_f32 v18, -v178, v142, v18
    v_mul_f32 v18, v18, v179
    v_fma_f32 v19, -v178, v143, v19
    v_mul_f32 v19, v19, v179
    v_cvt_pk_bf16_f32 v185, v16, v17
    v_lshlrev_b32 v16, 16, v185
    v_and_b32 v17, 0xffff0000, v185
    v_cvt_pk_bf16_f32 v186, v18, v19
    v_lshlrev_b32 v18, 16, v186
    v_and_b32 v19, 0xffff0000, v186
    v_lshlrev_b32 v188, 16, v166
    v_and_b32 v189, 0xffff0000, v166
    v_lshlrev_b32 v190, 16, v167
    v_and_b32 v191, 0xffff0000, v167
    v_add_f32 v16, v16, v188
    v_add_f32 v17, v17, v189
    v_add_f32 v18, v18, v190
    v_add_f32 v19, v19, v191
    v_cvt_pk_bf16_f32 v185, v16, v17
    v_lshlrev_b32 v16, 16, v185
    v_and_b32 v17, 0xffff0000, v185
    v_cvt_pk_bf16_f32 v186, v18, v19
    v_lshlrev_b32 v18, 16, v186
    v_and_b32 v19, 0xffff0000, v186
    v_mul_f32 v188, v16, v16
    v_fma_f32 v188, v188, s70, v184
    v_mul_f32 v188, v188, v16
    v_exp_f32 v188, v188
    s_nop 0
    v_add_f32 v188, 1.0, v188
    v_rcp_f32 v188, v188
    s_nop 0
    v_mul_f32 v16, v16, v188
    v_mul_f32 v189, v17, v17
    v_fma_f32 v189, v189, s70, v184
    v_mul_f32 v189, v189, v17
    v_exp_f32 v189, v189
    s_nop 0
    v_add_f32 v189, 1.0, v189
    v_rcp_f32 v189, v189
    s_nop 0
    v_mul_f32 v17, v17, v189
    v_mul_f32 v190, v18, v18
    v_fma_f32 v190, v190, s70, v184
    v_mul_f32 v190, v190, v18
    v_exp_f32 v190, v190
    s_nop 0
    v_add_f32 v190, 1.0, v190
    v_rcp_f32 v190, v190
    s_nop 0
    v_mul_f32 v18, v18, v190
    v_mul_f32 v191, v19, v19
    v_fma_f32 v191, v191, s70, v184
    v_mul_f32 v191, v191, v19
    v_exp_f32 v191, v191
    s_nop 0
    v_add_f32 v191, 1.0, v191
    v_rcp_f32 v191, v191
    s_nop 0
    v_mul_f32 v19, v19, v191
    v_cvt_pk_bf16_f32 v192, v16, v17
    v_cvt_pk_bf16_f32 v193, v18, v19
    buffer_store_dwordx2 v[192:193], v182, s[56:59], s66 offen offset:48
    s_nop 1
    v_fma_f32 v20, -v178, v144, v20
    v_mul_f32 v20, v20, v179
    v_fma_f32 v21, -v178, v145, v21
    v_mul_f32 v21, v21, v179
    v_fma_f32 v22, -v178, v146, v22
    v_mul_f32 v22, v22, v179
    v_fma_f32 v23, -v178, v147, v23
    v_mul_f32 v23, v23, v179
    v_cvt_pk_bf16_f32 v185, v20, v21
    v_lshlrev_b32 v20, 16, v185
    v_and_b32 v21, 0xffff0000, v185
    v_cvt_pk_bf16_f32 v186, v22, v23
    v_lshlrev_b32 v22, 16, v186
    v_and_b32 v23, 0xffff0000, v186
    v_lshlrev_b32 v188, 16, v168
    v_and_b32 v189, 0xffff0000, v168
    v_lshlrev_b32 v190, 16, v169
    v_and_b32 v191, 0xffff0000, v169
    v_add_f32 v20, v20, v188
    v_add_f32 v21, v21, v189
    v_add_f32 v22, v22, v190
    v_add_f32 v23, v23, v191
    v_cvt_pk_bf16_f32 v185, v20, v21
    v_lshlrev_b32 v20, 16, v185
    v_and_b32 v21, 0xffff0000, v185
    v_cvt_pk_bf16_f32 v186, v22, v23
    v_lshlrev_b32 v22, 16, v186
    v_and_b32 v23, 0xffff0000, v186
    v_mul_f32 v188, v20, v20
    v_fma_f32 v188, v188, s70, v184
    v_mul_f32 v188, v188, v20
    v_exp_f32 v188, v188
    s_nop 0
    v_add_f32 v188, 1.0, v188
    v_rcp_f32 v188, v188
    s_nop 0
    v_mul_f32 v20, v20, v188
    v_mul_f32 v189, v21, v21
    v_fma_f32 v189, v189, s70, v184
    v_mul_f32 v189, v189, v21
    v_exp_f32 v189, v189
    s_nop 0
    v_add_f32 v189, 1.0, v189
    v_rcp_f32 v189, v189
    s_nop 0
    v_mul_f32 v21, v21, v189
    v_mul_f32 v190, v22, v22
    v_fma_f32 v190, v190, s70, v184
    v_mul_f32 v190, v190, v22
    v_exp_f32 v190, v190
    s_nop 0
    v_add_f32 v190, 1.0, v190
    v_rcp_f32 v190, v190
    s_nop 0
    v_mul_f32 v22, v22, v190
    v_mul_f32 v191, v23, v23
    v_fma_f32 v191, v191, s70, v184
    v_mul_f32 v191, v191, v23
    v_exp_f32 v191, v191
    s_nop 0
    v_add_f32 v191, 1.0, v191
    v_rcp_f32 v191, v191
    s_nop 0
    v_mul_f32 v23, v23, v191
    v_cvt_pk_bf16_f32 v192, v20, v21
    v_cvt_pk_bf16_f32 v193, v22, v23
    buffer_store_dwordx2 v[192:193], v182, s[56:59], s66 offen offset:64
    s_nop 1
    v_fma_f32 v24, -v178, v148, v24
    v_mul_f32 v24, v24, v179
    v_fma_f32 v25, -v178, v149, v25
    v_mul_f32 v25, v25, v179
    v_fma_f32 v26, -v178, v150, v26
    v_mul_f32 v26, v26, v179
    v_fma_f32 v27, -v178, v151, v27
    v_mul_f32 v27, v27, v179
    v_cvt_pk_bf16_f32 v185, v24, v25
    v_lshlrev_b32 v24, 16, v185
    v_and_b32 v25, 0xffff0000, v185
    v_cvt_pk_bf16_f32 v186, v26, v27
    v_lshlrev_b32 v26, 16, v186
    v_and_b32 v27, 0xffff0000, v186
    v_lshlrev_b32 v188, 16, v170
    v_and_b32 v189, 0xffff0000, v170
    v_lshlrev_b32 v190, 16, v171
    v_and_b32 v191, 0xffff0000, v171
    v_add_f32 v24, v24, v188
    v_add_f32 v25, v25, v189
    v_add_f32 v26, v26, v190
    v_add_f32 v27, v27, v191
    v_cvt_pk_bf16_f32 v185, v24, v25
    v_lshlrev_b32 v24, 16, v185
    v_and_b32 v25, 0xffff0000, v185
    v_cvt_pk_bf16_f32 v186, v26, v27
    v_lshlrev_b32 v26, 16, v186
    v_and_b32 v27, 0xffff0000, v186
    v_mul_f32 v188, v24, v24
    v_fma_f32 v188, v188, s70, v184
    v_mul_f32 v188, v188, v24
    v_exp_f32 v188, v188
    s_nop 0
    v_add_f32 v188, 1.0, v188
    v_rcp_f32 v188, v188
    s_nop 0
    v_mul_f32 v24, v24, v188
    v_mul_f32 v189, v25, v25
    v_fma_f32 v189, v189, s70, v184
    v_mul_f32 v189, v189, v25
    v_exp_f32 v189, v189
    s_nop 0
    v_add_f32 v189, 1.0, v189
    v_rcp_f32 v189, v189
    s_nop 0
    v_mul_f32 v25, v25, v189
    v_mul_f32 v190, v26, v26
    v_fma_f32 v190, v190, s70, v184
    v_mul_f32 v190, v190, v26
    v_exp_f32 v190, v190
    s_nop 0
    v_add_f32 v190, 1.0, v190
    v_rcp_f32 v190, v190
    s_nop 0
    v_mul_f32 v26, v26, v190
    v_mul_f32 v191, v27, v27
    v_fma_f32 v191, v191, s70, v184
    v_mul_f32 v191, v191, v27
    v_exp_f32 v191, v191
    s_nop 0
    v_add_f32 v191, 1.0, v191
    v_rcp_f32 v191, v191
    s_nop 0
    v_mul_f32 v27, v27, v191
    v_cvt_pk_bf16_f32 v192, v24, v25
    v_cvt_pk_bf16_f32 v193, v26, v27
    buffer_store_dwordx2 v[192:193], v182, s[56:59], s66 offen offset:80
    s_nop 1
    v_fma_f32 v28, -v178, v152, v28
    v_mul_f32 v28, v28, v179
    v_fma_f32 v29, -v178, v153, v29
    v_mul_f32 v29, v29, v179
    v_fma_f32 v30, -v178, v154, v30
    v_mul_f32 v30, v30, v179
    v_fma_f32 v31, -v178, v155, v31
    v_mul_f32 v31, v31, v179
    v_cvt_pk_bf16_f32 v185, v28, v29
    v_lshlrev_b32 v28, 16, v185
    v_and_b32 v29, 0xffff0000, v185
    v_cvt_pk_bf16_f32 v186, v30, v31
    v_lshlrev_b32 v30, 16, v186
    v_and_b32 v31, 0xffff0000, v186
    v_lshlrev_b32 v188, 16, v172
    v_and_b32 v189, 0xffff0000, v172
    v_lshlrev_b32 v190, 16, v173
    v_and_b32 v191, 0xffff0000, v173
    v_add_f32 v28, v28, v188
    v_add_f32 v29, v29, v189
    v_add_f32 v30, v30, v190
    v_add_f32 v31, v31, v191
    v_cvt_pk_bf16_f32 v185, v28, v29
    v_lshlrev_b32 v28, 16, v185
    v_and_b32 v29, 0xffff0000, v185
    v_cvt_pk_bf16_f32 v186, v30, v31
    v_lshlrev_b32 v30, 16, v186
    v_and_b32 v31, 0xffff0000, v186
    v_mul_f32 v188, v28, v28
    v_fma_f32 v188, v188, s70, v184
    v_mul_f32 v188, v188, v28
    v_exp_f32 v188, v188
    s_nop 0
    v_add_f32 v188, 1.0, v188
    v_rcp_f32 v188, v188
    s_nop 0
    v_mul_f32 v28, v28, v188
    v_mul_f32 v189, v29, v29
    v_fma_f32 v189, v189, s70, v184
    v_mul_f32 v189, v189, v29
    v_exp_f32 v189, v189
    s_nop 0
    v_add_f32 v189, 1.0, v189
    v_rcp_f32 v189, v189
    s_nop 0
    v_mul_f32 v29, v29, v189
    v_mul_f32 v190, v30, v30
    v_fma_f32 v190, v190, s70, v184
    v_mul_f32 v190, v190, v30
    v_exp_f32 v190, v190
    s_nop 0
    v_add_f32 v190, 1.0, v190
    v_rcp_f32 v190, v190
    s_nop 0
    v_mul_f32 v30, v30, v190
    v_mul_f32 v191, v31, v31
    v_fma_f32 v191, v191, s70, v184
    v_mul_f32 v191, v191, v31
    v_exp_f32 v191, v191
    s_nop 0
    v_add_f32 v191, 1.0, v191
    v_rcp_f32 v191, v191
    s_nop 0
    v_mul_f32 v31, v31, v191
    v_cvt_pk_bf16_f32 v192, v28, v29
    v_cvt_pk_bf16_f32 v193, v30, v31
    buffer_store_dwordx2 v[192:193], v182, s[56:59], s66 offen offset:96
    s_nop 1
    v_fma_f32 v32, -v178, v156, v32
    v_mul_f32 v32, v32, v179
    v_fma_f32 v33, -v178, v157, v33
    v_mul_f32 v33, v33, v179
    v_fma_f32 v34, -v178, v158, v34
    v_mul_f32 v34, v34, v179
    v_fma_f32 v35, -v178, v159, v35
    v_mul_f32 v35, v35, v179
    v_cvt_pk_bf16_f32 v185, v32, v33
    v_lshlrev_b32 v32, 16, v185
    v_and_b32 v33, 0xffff0000, v185
    v_cvt_pk_bf16_f32 v186, v34, v35
    v_lshlrev_b32 v34, 16, v186
    v_and_b32 v35, 0xffff0000, v186
    v_lshlrev_b32 v188, 16, v174
    v_and_b32 v189, 0xffff0000, v174
    v_lshlrev_b32 v190, 16, v175
    v_and_b32 v191, 0xffff0000, v175
    v_add_f32 v32, v32, v188
    v_add_f32 v33, v33, v189
    v_add_f32 v34, v34, v190
    v_add_f32 v35, v35, v191
    v_cvt_pk_bf16_f32 v185, v32, v33
    v_lshlrev_b32 v32, 16, v185
    v_and_b32 v33, 0xffff0000, v185
    v_cvt_pk_bf16_f32 v186, v34, v35
    v_lshlrev_b32 v34, 16, v186
    v_and_b32 v35, 0xffff0000, v186
    v_mul_f32 v188, v32, v32
    v_fma_f32 v188, v188, s70, v184
    v_mul_f32 v188, v188, v32
    v_exp_f32 v188, v188
    s_nop 0
    v_add_f32 v188, 1.0, v188
    v_rcp_f32 v188, v188
    s_nop 0
    v_mul_f32 v32, v32, v188
    v_mul_f32 v189, v33, v33
    v_fma_f32 v189, v189, s70, v184
    v_mul_f32 v189, v189, v33
    v_exp_f32 v189, v189
    s_nop 0
    v_add_f32 v189, 1.0, v189
    v_rcp_f32 v189, v189
    s_nop 0
    v_mul_f32 v33, v33, v189
    v_mul_f32 v190, v34, v34
    v_fma_f32 v190, v190, s70, v184
    v_mul_f32 v190, v190, v34
    v_exp_f32 v190, v190
    s_nop 0
    v_add_f32 v190, 1.0, v190
    v_rcp_f32 v190, v190
    s_nop 0
    v_mul_f32 v34, v34, v190
    v_mul_f32 v191, v35, v35
    v_fma_f32 v191, v191, s70, v184
    v_mul_f32 v191, v191, v35
    v_exp_f32 v191, v191
    s_nop 0
    v_add_f32 v191, 1.0, v191
    v_rcp_f32 v191, v191
    s_nop 0
    v_mul_f32 v35, v35, v191
    v_cvt_pk_bf16_f32 v192, v32, v33
    v_cvt_pk_bf16_f32 v193, v34, v35
    buffer_store_dwordx2 v[192:193], v182, s[56:59], s66 offen offset:112
    s_nop 1
    v_add_u32 v183, 110592, v182
    v_fma_f32 v36, -v180, v128, v36
    v_mul_f32 v36, v36, v181
    v_fma_f32 v37, -v180, v129, v37
    v_mul_f32 v37, v37, v181
    v_fma_f32 v38, -v180, v130, v38
    v_mul_f32 v38, v38, v181
    v_fma_f32 v39, -v180, v131, v39
    v_mul_f32 v39, v39, v181
    v_cvt_pk_bf16_f32 v185, v36, v37
    v_lshlrev_b32 v36, 16, v185
    v_and_b32 v37, 0xffff0000, v185
    v_cvt_pk_bf16_f32 v186, v38, v39
    v_lshlrev_b32 v38, 16, v186
    v_and_b32 v39, 0xffff0000, v186
    v_lshlrev_b32 v188, 16, v160
    v_and_b32 v189, 0xffff0000, v160
    v_lshlrev_b32 v190, 16, v161
    v_and_b32 v191, 0xffff0000, v161
    v_add_f32 v36, v36, v188
    v_add_f32 v37, v37, v189
    v_add_f32 v38, v38, v190
    v_add_f32 v39, v39, v191
    v_cvt_pk_bf16_f32 v185, v36, v37
    v_lshlrev_b32 v36, 16, v185
    v_and_b32 v37, 0xffff0000, v185
    v_cvt_pk_bf16_f32 v186, v38, v39
    v_lshlrev_b32 v38, 16, v186
    v_and_b32 v39, 0xffff0000, v186
    v_mul_f32 v188, v36, v36
    v_fma_f32 v188, v188, s70, v184
    v_mul_f32 v188, v188, v36
    v_exp_f32 v188, v188
    s_nop 0
    v_add_f32 v188, 1.0, v188
    v_rcp_f32 v188, v188
    s_nop 0
    v_mul_f32 v36, v36, v188
    v_mul_f32 v189, v37, v37
    v_fma_f32 v189, v189, s70, v184
    v_mul_f32 v189, v189, v37
    v_exp_f32 v189, v189
    s_nop 0
    v_add_f32 v189, 1.0, v189
    v_rcp_f32 v189, v189
    s_nop 0
    v_mul_f32 v37, v37, v189
    v_mul_f32 v190, v38, v38
    v_fma_f32 v190, v190, s70, v184
    v_mul_f32 v190, v190, v38
    v_exp_f32 v190, v190
    s_nop 0
    v_add_f32 v190, 1.0, v190
    v_rcp_f32 v190, v190
    s_nop 0
    v_mul_f32 v38, v38, v190
    v_mul_f32 v191, v39, v39
    v_fma_f32 v191, v191, s70, v184
    v_mul_f32 v191, v191, v39
    v_exp_f32 v191, v191
    s_nop 0
    v_add_f32 v191, 1.0, v191
    v_rcp_f32 v191, v191
    s_nop 0
    v_mul_f32 v39, v39, v191
    v_cvt_pk_bf16_f32 v192, v36, v37
    v_cvt_pk_bf16_f32 v193, v38, v39
    buffer_store_dwordx2 v[192:193], v183, s[56:59], s66 offen offset:0
    s_nop 1
    v_fma_f32 v40, -v180, v132, v40
    v_mul_f32 v40, v40, v181
    v_fma_f32 v41, -v180, v133, v41
    v_mul_f32 v41, v41, v181
    v_fma_f32 v42, -v180, v134, v42
    v_mul_f32 v42, v42, v181
    v_fma_f32 v43, -v180, v135, v43
    v_mul_f32 v43, v43, v181
    v_cvt_pk_bf16_f32 v185, v40, v41
    v_lshlrev_b32 v40, 16, v185
    v_and_b32 v41, 0xffff0000, v185
    v_cvt_pk_bf16_f32 v186, v42, v43
    v_lshlrev_b32 v42, 16, v186
    v_and_b32 v43, 0xffff0000, v186
    v_lshlrev_b32 v188, 16, v162
    v_and_b32 v189, 0xffff0000, v162
    v_lshlrev_b32 v190, 16, v163
    v_and_b32 v191, 0xffff0000, v163
    v_add_f32 v40, v40, v188
    v_add_f32 v41, v41, v189
    v_add_f32 v42, v42, v190
    v_add_f32 v43, v43, v191
    v_cvt_pk_bf16_f32 v185, v40, v41
    v_lshlrev_b32 v40, 16, v185
    v_and_b32 v41, 0xffff0000, v185
    v_cvt_pk_bf16_f32 v186, v42, v43
    v_lshlrev_b32 v42, 16, v186
    v_and_b32 v43, 0xffff0000, v186
    v_mul_f32 v188, v40, v40
    v_fma_f32 v188, v188, s70, v184
    v_mul_f32 v188, v188, v40
    v_exp_f32 v188, v188
    s_nop 0
    v_add_f32 v188, 1.0, v188
    v_rcp_f32 v188, v188
    s_nop 0
    v_mul_f32 v40, v40, v188
    v_mul_f32 v189, v41, v41
    v_fma_f32 v189, v189, s70, v184
    v_mul_f32 v189, v189, v41
    v_exp_f32 v189, v189
    s_nop 0
    v_add_f32 v189, 1.0, v189
    v_rcp_f32 v189, v189
    s_nop 0
    v_mul_f32 v41, v41, v189
    v_mul_f32 v190, v42, v42
    v_fma_f32 v190, v190, s70, v184
    v_mul_f32 v190, v190, v42
    v_exp_f32 v190, v190
    s_nop 0
    v_add_f32 v190, 1.0, v190
    v_rcp_f32 v190, v190
    s_nop 0
    v_mul_f32 v42, v42, v190
    v_mul_f32 v191, v43, v43
    v_fma_f32 v191, v191, s70, v184
    v_mul_f32 v191, v191, v43
    v_exp_f32 v191, v191
    s_nop 0
    v_add_f32 v191, 1.0, v191
    v_rcp_f32 v191, v191
    s_nop 0
    v_mul_f32 v43, v43, v191
    v_cvt_pk_bf16_f32 v192, v40, v41
    v_cvt_pk_bf16_f32 v193, v42, v43
    buffer_store_dwordx2 v[192:193], v183, s[56:59], s66 offen offset:16
    s_nop 1
    v_fma_f32 v44, -v180, v136, v44
    v_mul_f32 v44, v44, v181
    v_fma_f32 v45, -v180, v137, v45
    v_mul_f32 v45, v45, v181
    v_fma_f32 v46, -v180, v138, v46
    v_mul_f32 v46, v46, v181
    v_fma_f32 v47, -v180, v139, v47
    v_mul_f32 v47, v47, v181
    v_cvt_pk_bf16_f32 v185, v44, v45
    v_lshlrev_b32 v44, 16, v185
    v_and_b32 v45, 0xffff0000, v185
    v_cvt_pk_bf16_f32 v186, v46, v47
    v_lshlrev_b32 v46, 16, v186
    v_and_b32 v47, 0xffff0000, v186
    v_lshlrev_b32 v188, 16, v164
    v_and_b32 v189, 0xffff0000, v164
    v_lshlrev_b32 v190, 16, v165
    v_and_b32 v191, 0xffff0000, v165
    v_add_f32 v44, v44, v188
    v_add_f32 v45, v45, v189
    v_add_f32 v46, v46, v190
    v_add_f32 v47, v47, v191
    v_cvt_pk_bf16_f32 v185, v44, v45
    v_lshlrev_b32 v44, 16, v185
    v_and_b32 v45, 0xffff0000, v185
    v_cvt_pk_bf16_f32 v186, v46, v47
    v_lshlrev_b32 v46, 16, v186
    v_and_b32 v47, 0xffff0000, v186
    v_mul_f32 v188, v44, v44
    v_fma_f32 v188, v188, s70, v184
    v_mul_f32 v188, v188, v44
    v_exp_f32 v188, v188
    s_nop 0
    v_add_f32 v188, 1.0, v188
    v_rcp_f32 v188, v188
    s_nop 0
    v_mul_f32 v44, v44, v188
    v_mul_f32 v189, v45, v45
    v_fma_f32 v189, v189, s70, v184
    v_mul_f32 v189, v189, v45
    v_exp_f32 v189, v189
    s_nop 0
    v_add_f32 v189, 1.0, v189
    v_rcp_f32 v189, v189
    s_nop 0
    v_mul_f32 v45, v45, v189
    v_mul_f32 v190, v46, v46
    v_fma_f32 v190, v190, s70, v184
    v_mul_f32 v190, v190, v46
    v_exp_f32 v190, v190
    s_nop 0
    v_add_f32 v190, 1.0, v190
    v_rcp_f32 v190, v190
    s_nop 0
    v_mul_f32 v46, v46, v190
    v_mul_f32 v191, v47, v47
    v_fma_f32 v191, v191, s70, v184
    v_mul_f32 v191, v191, v47
    v_exp_f32 v191, v191
    s_nop 0
    v_add_f32 v191, 1.0, v191
    v_rcp_f32 v191, v191
    s_nop 0
    v_mul_f32 v47, v47, v191
    v_cvt_pk_bf16_f32 v192, v44, v45
    v_cvt_pk_bf16_f32 v193, v46, v47
    buffer_store_dwordx2 v[192:193], v183, s[56:59], s66 offen offset:32
    s_nop 1
    v_fma_f32 v48, -v180, v140, v48
    v_mul_f32 v48, v48, v181
    v_fma_f32 v49, -v180, v141, v49
    v_mul_f32 v49, v49, v181
    v_fma_f32 v50, -v180, v142, v50
    v_mul_f32 v50, v50, v181
    v_fma_f32 v51, -v180, v143, v51
    v_mul_f32 v51, v51, v181
    v_cvt_pk_bf16_f32 v185, v48, v49
    v_lshlrev_b32 v48, 16, v185
    v_and_b32 v49, 0xffff0000, v185
    v_cvt_pk_bf16_f32 v186, v50, v51
    v_lshlrev_b32 v50, 16, v186
    v_and_b32 v51, 0xffff0000, v186
    v_lshlrev_b32 v188, 16, v166
    v_and_b32 v189, 0xffff0000, v166
    v_lshlrev_b32 v190, 16, v167
    v_and_b32 v191, 0xffff0000, v167
    v_add_f32 v48, v48, v188
    v_add_f32 v49, v49, v189
    v_add_f32 v50, v50, v190
    v_add_f32 v51, v51, v191
    v_cvt_pk_bf16_f32 v185, v48, v49
    v_lshlrev_b32 v48, 16, v185
    v_and_b32 v49, 0xffff0000, v185
    v_cvt_pk_bf16_f32 v186, v50, v51
    v_lshlrev_b32 v50, 16, v186
    v_and_b32 v51, 0xffff0000, v186
    v_mul_f32 v188, v48, v48
    v_fma_f32 v188, v188, s70, v184
    v_mul_f32 v188, v188, v48
    v_exp_f32 v188, v188
    s_nop 0
    v_add_f32 v188, 1.0, v188
    v_rcp_f32 v188, v188
    s_nop 0
    v_mul_f32 v48, v48, v188
    v_mul_f32 v189, v49, v49
    v_fma_f32 v189, v189, s70, v184
    v_mul_f32 v189, v189, v49
    v_exp_f32 v189, v189
    s_nop 0
    v_add_f32 v189, 1.0, v189
    v_rcp_f32 v189, v189
    s_nop 0
    v_mul_f32 v49, v49, v189
    v_mul_f32 v190, v50, v50
    v_fma_f32 v190, v190, s70, v184
    v_mul_f32 v190, v190, v50
    v_exp_f32 v190, v190
    s_nop 0
    v_add_f32 v190, 1.0, v190
    v_rcp_f32 v190, v190
    s_nop 0
    v_mul_f32 v50, v50, v190
    v_mul_f32 v191, v51, v51
    v_fma_f32 v191, v191, s70, v184
    v_mul_f32 v191, v191, v51
    v_exp_f32 v191, v191
    s_nop 0
    v_add_f32 v191, 1.0, v191
    v_rcp_f32 v191, v191
    s_nop 0
    v_mul_f32 v51, v51, v191
    v_cvt_pk_bf16_f32 v192, v48, v49
    v_cvt_pk_bf16_f32 v193, v50, v51
    buffer_store_dwordx2 v[192:193], v183, s[56:59], s66 offen offset:48
    s_nop 1
    v_fma_f32 v52, -v180, v144, v52
    v_mul_f32 v52, v52, v181
    v_fma_f32 v53, -v180, v145, v53
    v_mul_f32 v53, v53, v181
    v_fma_f32 v54, -v180, v146, v54
    v_mul_f32 v54, v54, v181
    v_fma_f32 v55, -v180, v147, v55
    v_mul_f32 v55, v55, v181
    v_cvt_pk_bf16_f32 v185, v52, v53
    v_lshlrev_b32 v52, 16, v185
    v_and_b32 v53, 0xffff0000, v185
    v_cvt_pk_bf16_f32 v186, v54, v55
    v_lshlrev_b32 v54, 16, v186
    v_and_b32 v55, 0xffff0000, v186
    v_lshlrev_b32 v188, 16, v168
    v_and_b32 v189, 0xffff0000, v168
    v_lshlrev_b32 v190, 16, v169
    v_and_b32 v191, 0xffff0000, v169
    v_add_f32 v52, v52, v188
    v_add_f32 v53, v53, v189
    v_add_f32 v54, v54, v190
    v_add_f32 v55, v55, v191
    v_cvt_pk_bf16_f32 v185, v52, v53
    v_lshlrev_b32 v52, 16, v185
    v_and_b32 v53, 0xffff0000, v185
    v_cvt_pk_bf16_f32 v186, v54, v55
    v_lshlrev_b32 v54, 16, v186
    v_and_b32 v55, 0xffff0000, v186
    v_mul_f32 v188, v52, v52
    v_fma_f32 v188, v188, s70, v184
    v_mul_f32 v188, v188, v52
    v_exp_f32 v188, v188
    s_nop 0
    v_add_f32 v188, 1.0, v188
    v_rcp_f32 v188, v188
    s_nop 0
    v_mul_f32 v52, v52, v188
    v_mul_f32 v189, v53, v53
    v_fma_f32 v189, v189, s70, v184
    v_mul_f32 v189, v189, v53
    v_exp_f32 v189, v189
    s_nop 0
    v_add_f32 v189, 1.0, v189
    v_rcp_f32 v189, v189
    s_nop 0
    v_mul_f32 v53, v53, v189
    v_mul_f32 v190, v54, v54
    v_fma_f32 v190, v190, s70, v184
    v_mul_f32 v190, v190, v54
    v_exp_f32 v190, v190
    s_nop 0
    v_add_f32 v190, 1.0, v190
    v_rcp_f32 v190, v190
    s_nop 0
    v_mul_f32 v54, v54, v190
    v_mul_f32 v191, v55, v55
    v_fma_f32 v191, v191, s70, v184
    v_mul_f32 v191, v191, v55
    v_exp_f32 v191, v191
    s_nop 0
    v_add_f32 v191, 1.0, v191
    v_rcp_f32 v191, v191
    s_nop 0
    v_mul_f32 v55, v55, v191
    v_cvt_pk_bf16_f32 v192, v52, v53
    v_cvt_pk_bf16_f32 v193, v54, v55
    buffer_store_dwordx2 v[192:193], v183, s[56:59], s66 offen offset:64
    s_nop 1
    v_fma_f32 v56, -v180, v148, v56
    v_mul_f32 v56, v56, v181
    v_fma_f32 v57, -v180, v149, v57
    v_mul_f32 v57, v57, v181
    v_fma_f32 v58, -v180, v150, v58
    v_mul_f32 v58, v58, v181
    v_fma_f32 v59, -v180, v151, v59
    v_mul_f32 v59, v59, v181
    v_cvt_pk_bf16_f32 v185, v56, v57
    v_lshlrev_b32 v56, 16, v185
    v_and_b32 v57, 0xffff0000, v185
    v_cvt_pk_bf16_f32 v186, v58, v59
    v_lshlrev_b32 v58, 16, v186
    v_and_b32 v59, 0xffff0000, v186
    v_lshlrev_b32 v188, 16, v170
    v_and_b32 v189, 0xffff0000, v170
    v_lshlrev_b32 v190, 16, v171
    v_and_b32 v191, 0xffff0000, v171
    v_add_f32 v56, v56, v188
    v_add_f32 v57, v57, v189
    v_add_f32 v58, v58, v190
    v_add_f32 v59, v59, v191
    v_cvt_pk_bf16_f32 v185, v56, v57
    v_lshlrev_b32 v56, 16, v185
    v_and_b32 v57, 0xffff0000, v185
    v_cvt_pk_bf16_f32 v186, v58, v59
    v_lshlrev_b32 v58, 16, v186
    v_and_b32 v59, 0xffff0000, v186
    v_mul_f32 v188, v56, v56
    v_fma_f32 v188, v188, s70, v184
    v_mul_f32 v188, v188, v56
    v_exp_f32 v188, v188
    s_nop 0
    v_add_f32 v188, 1.0, v188
    v_rcp_f32 v188, v188
    s_nop 0
    v_mul_f32 v56, v56, v188
    v_mul_f32 v189, v57, v57
    v_fma_f32 v189, v189, s70, v184
    v_mul_f32 v189, v189, v57
    v_exp_f32 v189, v189
    s_nop 0
    v_add_f32 v189, 1.0, v189
    v_rcp_f32 v189, v189
    s_nop 0
    v_mul_f32 v57, v57, v189
    v_mul_f32 v190, v58, v58
    v_fma_f32 v190, v190, s70, v184
    v_mul_f32 v190, v190, v58
    v_exp_f32 v190, v190
    s_nop 0
    v_add_f32 v190, 1.0, v190
    v_rcp_f32 v190, v190
    s_nop 0
    v_mul_f32 v58, v58, v190
    v_mul_f32 v191, v59, v59
    v_fma_f32 v191, v191, s70, v184
    v_mul_f32 v191, v191, v59
    v_exp_f32 v191, v191
    s_nop 0
    v_add_f32 v191, 1.0, v191
    v_rcp_f32 v191, v191
    s_nop 0
    v_mul_f32 v59, v59, v191
    v_cvt_pk_bf16_f32 v192, v56, v57
    v_cvt_pk_bf16_f32 v193, v58, v59
    buffer_store_dwordx2 v[192:193], v183, s[56:59], s66 offen offset:80
    s_nop 1
    v_fma_f32 v60, -v180, v152, v60
    v_mul_f32 v60, v60, v181
    v_fma_f32 v61, -v180, v153, v61
    v_mul_f32 v61, v61, v181
    v_fma_f32 v62, -v180, v154, v62
    v_mul_f32 v62, v62, v181
    v_fma_f32 v63, -v180, v155, v63
    v_mul_f32 v63, v63, v181
    v_cvt_pk_bf16_f32 v185, v60, v61
    v_lshlrev_b32 v60, 16, v185
    v_and_b32 v61, 0xffff0000, v185
    v_cvt_pk_bf16_f32 v186, v62, v63
    v_lshlrev_b32 v62, 16, v186
    v_and_b32 v63, 0xffff0000, v186
    v_lshlrev_b32 v188, 16, v172
    v_and_b32 v189, 0xffff0000, v172
    v_lshlrev_b32 v190, 16, v173
    v_and_b32 v191, 0xffff0000, v173
    v_add_f32 v60, v60, v188
    v_add_f32 v61, v61, v189
    v_add_f32 v62, v62, v190
    v_add_f32 v63, v63, v191
    v_cvt_pk_bf16_f32 v185, v60, v61
    v_lshlrev_b32 v60, 16, v185
    v_and_b32 v61, 0xffff0000, v185
    v_cvt_pk_bf16_f32 v186, v62, v63
    v_lshlrev_b32 v62, 16, v186
    v_and_b32 v63, 0xffff0000, v186
    v_mul_f32 v188, v60, v60
    v_fma_f32 v188, v188, s70, v184
    v_mul_f32 v188, v188, v60
    v_exp_f32 v188, v188
    s_nop 0
    v_add_f32 v188, 1.0, v188
    v_rcp_f32 v188, v188
    s_nop 0
    v_mul_f32 v60, v60, v188
    v_mul_f32 v189, v61, v61
    v_fma_f32 v189, v189, s70, v184
    v_mul_f32 v189, v189, v61
    v_exp_f32 v189, v189
    s_nop 0
    v_add_f32 v189, 1.0, v189
    v_rcp_f32 v189, v189
    s_nop 0
    v_mul_f32 v61, v61, v189
    v_mul_f32 v190, v62, v62
    v_fma_f32 v190, v190, s70, v184
    v_mul_f32 v190, v190, v62
    v_exp_f32 v190, v190
    s_nop 0
    v_add_f32 v190, 1.0, v190
    v_rcp_f32 v190, v190
    s_nop 0
    v_mul_f32 v62, v62, v190
    v_mul_f32 v191, v63, v63
    v_fma_f32 v191, v191, s70, v184
    v_mul_f32 v191, v191, v63
    v_exp_f32 v191, v191
    s_nop 0
    v_add_f32 v191, 1.0, v191
    v_rcp_f32 v191, v191
    s_nop 0
    v_mul_f32 v63, v63, v191
    v_cvt_pk_bf16_f32 v192, v60, v61
    v_cvt_pk_bf16_f32 v193, v62, v63
    buffer_store_dwordx2 v[192:193], v183, s[56:59], s66 offen offset:96
    s_nop 1
    v_fma_f32 v64, -v180, v156, v64
    v_mul_f32 v64, v64, v181
    v_fma_f32 v65, -v180, v157, v65
    v_mul_f32 v65, v65, v181
    v_fma_f32 v66, -v180, v158, v66
    v_mul_f32 v66, v66, v181
    v_fma_f32 v67, -v180, v159, v67
    v_mul_f32 v67, v67, v181
    v_cvt_pk_bf16_f32 v185, v64, v65
    v_lshlrev_b32 v64, 16, v185
    v_and_b32 v65, 0xffff0000, v185
    v_cvt_pk_bf16_f32 v186, v66, v67
    v_lshlrev_b32 v66, 16, v186
    v_and_b32 v67, 0xffff0000, v186
    v_lshlrev_b32 v188, 16, v174
    v_and_b32 v189, 0xffff0000, v174
    v_lshlrev_b32 v190, 16, v175
    v_and_b32 v191, 0xffff0000, v175
    v_add_f32 v64, v64, v188
    v_add_f32 v65, v65, v189
    v_add_f32 v66, v66, v190
    v_add_f32 v67, v67, v191
    v_cvt_pk_bf16_f32 v185, v64, v65
    v_lshlrev_b32 v64, 16, v185
    v_and_b32 v65, 0xffff0000, v185
    v_cvt_pk_bf16_f32 v186, v66, v67
    v_lshlrev_b32 v66, 16, v186
    v_and_b32 v67, 0xffff0000, v186
    v_mul_f32 v188, v64, v64
    v_fma_f32 v188, v188, s70, v184
    v_mul_f32 v188, v188, v64
    v_exp_f32 v188, v188
    s_nop 0
    v_add_f32 v188, 1.0, v188
    v_rcp_f32 v188, v188
    s_nop 0
    v_mul_f32 v64, v64, v188
    v_mul_f32 v189, v65, v65
    v_fma_f32 v189, v189, s70, v184
    v_mul_f32 v189, v189, v65
    v_exp_f32 v189, v189
    s_nop 0
    v_add_f32 v189, 1.0, v189
    v_rcp_f32 v189, v189
    s_nop 0
    v_mul_f32 v65, v65, v189
    v_mul_f32 v190, v66, v66
    v_fma_f32 v190, v190, s70, v184
    v_mul_f32 v190, v190, v66
    v_exp_f32 v190, v190
    s_nop 0
    v_add_f32 v190, 1.0, v190
    v_rcp_f32 v190, v190
    s_nop 0
    v_mul_f32 v66, v66, v190
    v_mul_f32 v191, v67, v67
    v_fma_f32 v191, v191, s70, v184
    v_mul_f32 v191, v191, v67
    v_exp_f32 v191, v191
    s_nop 0
    v_add_f32 v191, 1.0, v191
    v_rcp_f32 v191, v191
    s_nop 0
    v_mul_f32 v67, v67, v191
    v_cvt_pk_bf16_f32 v192, v64, v65
    v_cvt_pk_bf16_f32 v193, v66, v67
    buffer_store_dwordx2 v[192:193], v183, s[56:59], s66 offen offset:112
    s_nop 1
.k3p1_kernel_end:
    s_endpgm

.globl k4p1_kernel
.p2align 8
.type k4p1_kernel,@function
k4p1_kernel:
    s_cmp_ge_u32 s2, 160
    s_cbranch_scc1 .k4p1_kernel_end
    s_load_dwordx16 s[16:31], s[0:1], 0
    s_load_dwordx4 s[32:35], s[0:1], 64
    s_load_dwordx2 s[36:37], s[0:1], 80
    s_waitcnt lgkmcnt(0)
    s_and_b32 s61, s2, 31
    s_lshl_b32 s61, s61, 6
    s_lshr_b32 s62, s2, 5
    s_lshl_b32 s62, s62, 7
    s_add_u32 s40, s36, 19193856
    s_addc_u32 s41, s37, 0
    s_and_b32 s41, s41, 0xffff
    s_mov_b32 s42, 7077888
    s_mov_b32 s43, 0x00020000
    s_add_u32 s44, s36, 5488640
    s_addc_u32 s45, s37, 0
    s_and_b32 s45, s45, 0xffff
    s_mov_b32 s46, 2211840
    s_mov_b32 s47, 0x00020000
    v_and_b32 v82, 63, v0
    v_lshrrev_b32 v83, 6, v0
    s_nop 0
    v_readfirstlane_b32 s60, v83
    s_nop 1
    s_mul_i32 s63, s60, 2048
    s_mul_i32 s64, s60, 4096
    s_mul_i32 s65, s60, 16
    s_add_u32 s65, s65, 0
    v_lshrrev_b32 v83, 3, v82
    v_add_u32 v83, s65, v83
    v_lshrrev_b32 v84, 1, v83
    v_and_b32 v84, 7, v84
    v_and_b32 v60, 7, v82
    v_xor_b32 v84, v60, v84
    v_lshlrev_b32 v84, 4, v84
    v_add_u32 v83, s61, v83
    s_mov_b32 s66, 3456
    v_mul_lo_u32 v83, v83, s66
    v_add_u32 v60, v83, v84
    s_mul_i32 s65, s60, 16
    s_add_u32 s65, s65, 8
    v_lshrrev_b32 v83, 3, v82
    v_add_u32 v83, s65, v83
    v_lshrrev_b32 v84, 1, v83
    v_and_b32 v84, 7, v84
    v_and_b32 v61, 7, v82
    v_xor_b32 v84, v61, v84
    v_lshlrev_b32 v84, 4, v84
    v_add_u32 v83, s61, v83
    s_mov_b32 s66, 3456
    v_mul_lo_u32 v83, v83, s66
    v_add_u32 v61, v83, v84
    s_mul_i32 s65, s60, 32
    s_add_u32 s65, s65, 0
    v_lshrrev_b32 v83, 3, v82
    v_add_u32 v83, s65, v83
    v_lshrrev_b32 v84, 1, v83
    v_and_b32 v84, 7, v84
    v_and_b32 v62, 7, v82
    v_xor_b32 v84, v62, v84
    v_lshlrev_b32 v84, 4, v84
    v_add_u32 v83, s62, v83
    s_mov_b32 s66, 3456
    v_mul_lo_u32 v83, v83, s66
    v_add_u32 v62, v83, v84
    s_mul_i32 s65, s60, 32
    s_add_u32 s65, s65, 8
    v_lshrrev_b32 v83, 3, v82
    v_add_u32 v83, s65, v83
    v_lshrrev_b32 v84, 1, v83
    v_and_b32 v84, 7, v84
    v_and_b32 v63, 7, v82
    v_xor_b32 v84, v63, v84
    v_lshlrev_b32 v84, 4, v84
    v_add_u32 v83, s62, v83
    s_mov_b32 s66, 3456
    v_mul_lo_u32 v83, v83, s66
    v_add_u32 v63, v83, v84
    s_mul_i32 s65, s60, 32
    s_add_u32 s65, s65, 16
    v_lshrrev_b32 v83, 3, v82
    v_add_u32 v83, s65, v83
    v_lshrrev_b32 v84, 1, v83
    v_and_b32 v84, 7, v84
    v_and_b32 v64, 7, v82
    v_xor_b32 v84, v64, v84
    v_lshlrev_b32 v84, 4, v84
    v_add_u32 v83, s62, v83
    s_mov_b32 s66, 3456
    v_mul_lo_u32 v83, v83, s66
    v_add_u32 v64, v83, v84
    s_mul_i32 s65, s60, 32
    s_add_u32 s65, s65, 24
    v_lshrrev_b32 v83, 3, v82
    v_add_u32 v83, s65, v83
    v_lshrrev_b32 v84, 1, v83
    v_and_b32 v84, 7, v84
    v_and_b32 v65, 7, v82
    v_xor_b32 v84, v65, v84
    v_lshlrev_b32 v84, 4, v84
    v_add_u32 v83, s62, v83
    s_mov_b32 s66, 3456
    v_mul_lo_u32 v83, v83, s66
    v_add_u32 v65, v83, v84
    s_and_b32 s67, s60, 1
    s_lshr_b32 s68, s60, 1
    v_lshrrev_b32 v83, 5, v82
    v_add_u32 v83, 0, v83
    v_lshrrev_b32 v84, 1, v82
    v_and_b32 v84, 7, v84
    v_xor_b32 v83, v83, v84
    v_lshlrev_b32 v83, 4, v83
    v_and_b32 v84, 31, v82
    v_lshl_add_u32 v83, v84, 7, v83
    s_mul_i32 s65, s67, 4096
    v_add_u32 v66, s65, v83
    v_add_u32 v78, 0x10000, v66
    s_mul_i32 s65, s68, 8192
    v_add_u32 v70, s65, v83
    v_add_u32 v74, 0x10000, v70
    v_lshrrev_b32 v83, 5, v82
    v_add_u32 v83, 2, v83
    v_lshrrev_b32 v84, 1, v82
    v_and_b32 v84, 7, v84
    v_xor_b32 v83, v83, v84
    v_lshlrev_b32 v83, 4, v83
    v_and_b32 v84, 31, v82
    v_lshl_add_u32 v83, v84, 7, v83
    s_mul_i32 s65, s67, 4096
    v_add_u32 v67, s65, v83
    v_add_u32 v79, 0x10000, v67
    s_mul_i32 s65, s68, 8192
    v_add_u32 v71, s65, v83
    v_add_u32 v75, 0x10000, v71
    v_lshrrev_b32 v83, 5, v82
    v_add_u32 v83, 4, v83
    v_lshrrev_b32 v84, 1, v82
    v_and_b32 v84, 7, v84
    v_xor_b32 v83, v83, v84
    v_lshlrev_b32 v83, 4, v83
    v_and_b32 v84, 31, v82
    v_lshl_add_u32 v83, v84, 7, v83
    s_mul_i32 s65, s67, 4096
    v_add_u32 v68, s65, v83
    v_add_u32 v80, 0x10000, v68
    s_mul_i32 s65, s68, 8192
    v_add_u32 v72, s65, v83
    v_add_u32 v76, 0x10000, v72
    v_lshrrev_b32 v83, 5, v82
    v_add_u32 v83, 6, v83
    v_lshrrev_b32 v84, 1, v82
    v_and_b32 v84, 7, v84
    v_xor_b32 v83, v83, v84
    v_lshlrev_b32 v83, 4, v83
    v_and_b32 v84, 31, v82
    v_lshl_add_u32 v83, v84, 7, v83
    s_mul_i32 s65, s67, 4096
    v_add_u32 v69, s65, v83
    v_add_u32 v81, 0x10000, v69
    s_mul_i32 s65, s68, 8192
    v_add_u32 v73, s65, v83
    v_add_u32 v77, 0x10000, v73
    v_mov_b32 v4, 0
    v_mov_b32 v5, 0
    v_mov_b32 v6, 0
    v_mov_b32 v7, 0
    v_mov_b32 v8, 0
    v_mov_b32 v9, 0
    v_mov_b32 v10, 0
    v_mov_b32 v11, 0
    v_mov_b32 v12, 0
    v_mov_b32 v13, 0
    v_mov_b32 v14, 0
    v_mov_b32 v15, 0
    v_mov_b32 v16, 0
    v_mov_b32 v17, 0
    v_mov_b32 v18, 0
    v_mov_b32 v19, 0
    v_mov_b32 v20, 0
    v_mov_b32 v21, 0
    v_mov_b32 v22, 0
    v_mov_b32 v23, 0
    v_mov_b32 v24, 0
    v_mov_b32 v25, 0
    v_mov_b32 v26, 0
    v_mov_b32 v27, 0
    v_mov_b32 v28, 0
    v_mov_b32 v29, 0
    v_mov_b32 v30, 0
    v_mov_b32 v31, 0
    v_mov_b32 v32, 0
    v_mov_b32 v33, 0
    v_mov_b32 v34, 0
    v_mov_b32 v35, 0
    s_mov_b32 s69, 0
    s_add_u32 m0, s63, 0
    buffer_load_dwordx4 v60, s[40:43], s69 offen lds
    s_add_u32 m0, s63, 1024
    buffer_load_dwordx4 v61, s[40:43], s69 offen lds
    s_add_u32 m0, s64, 8192
    buffer_load_dwordx4 v62, s[44:47], s69 offen lds
    s_add_u32 m0, s64, 9216
    buffer_load_dwordx4 v63, s[44:47], s69 offen lds
    s_add_u32 m0, s64, 10240
    buffer_load_dwordx4 v64, s[44:47], s69 offen lds
    s_add_u32 m0, s64, 11264
    buffer_load_dwordx4 v65, s[44:47], s69 offen lds
    s_mov_b32 s69, 128
    s_add_u32 m0, s63, 24576
    buffer_load_dwordx4 v60, s[40:43], s69 offen lds
    s_add_u32 m0, s63, 25600
    buffer_load_dwordx4 v61, s[40:43], s69 offen lds
    s_add_u32 m0, s64, 32768
    buffer_load_dwordx4 v62, s[44:47], s69 offen lds
    s_add_u32 m0, s64, 33792
    buffer_load_dwordx4 v63, s[44:47], s69 offen lds
    s_add_u32 m0, s64, 34816
    buffer_load_dwordx4 v64, s[44:47], s69 offen lds
    s_add_u32 m0, s64, 35840
    buffer_load_dwordx4 v65, s[44:47], s69 offen lds
    s_add_u32 s48, s36, 16572416
    s_addc_u32 s49, s37, 0
    s_and_b32 s49, s49, 0xffff
    s_mov_b32 s50, 2621440
    s_mov_b32 s51, 0x00020000
    s_mov_b32 s52, s30
    s_mov_b32 s53, s31
    s_and_b32 s53, s53, 0xffff
    s_mov_b32 s54, 1280
    s_mov_b32 s55, 0x00020000
    s_mov_b32 s56, s32
    s_mov_b32 s57, s33
    s_and_b32 s57, s57, 0xffff
    s_mov_b32 s58, 2621440
    s_mov_b32 s59, 0x00020000
    v_lshrrev_b32 v118, 5, v82
    v_lshlrev_b32 v118, 2, v118
    s_lshl_b32 s65, s68, 6
    v_add_u32 v118, s65, v118
    v_lshlrev_b32 v119, 1, v118
    s_lshl_b32 s66, s62, 1
    buffer_load_dwordx2 v[86:87], v119, s[52:55], s66 offen offset:0
    buffer_load_dwordx2 v[88:89], v119, s[52:55], s66 offen offset:16
    buffer_load_dwordx2 v[90:91], v119, s[52:55], s66 offen offset:32
    buffer_load_dwordx2 v[92:93], v119, s[52:55], s66 offen offset:48
    buffer_load_dwordx2 v[94:95], v119, s[52:55], s66 offen offset:64
    buffer_load_dwordx2 v[96:97], v119, s[52:55], s66 offen offset:80
    buffer_load_dwordx2 v[98:99], v119, s[52:55], s66 offen offset:96
    buffer_load_dwordx2 v[100:101], v119, s[52:55], s66 offen offset:112
    v_and_b32 v120, 31, v82
    s_lshl_b32 s65, s67, 5
    v_add_u32 v120, s65, v120
    v_add_u32 v120, s61, v120
    v_mul_u32_u24 v120, 1280, v120
    v_add_u32 v120, v120, v119
    buffer_load_dwordx2 v[102:103], v120, s[48:51], s66 offen offset:0
    buffer_load_dwordx2 v[104:105], v120, s[48:51], s66 offen offset:16
    buffer_load_dwordx2 v[106:107], v120, s[48:51], s66 offen offset:32
    buffer_load_dwordx2 v[108:109], v120, s[48:51], s66 offen offset:48
    buffer_load_dwordx2 v[110:111], v120, s[48:51], s66 offen offset:64
    buffer_load_dwordx2 v[112:113], v120, s[48:51], s66 offen offset:80
    buffer_load_dwordx2 v[114:115], v120, s[48:51], s66 offen offset:96
    buffer_load_dwordx2 v[116:117], v120, s[48:51], s66 offen offset:112
    s_waitcnt vmcnt(22)
    s_barrier
    s_mov_b32 s69, 256
    s_add_u32 m0, s63, 49152
    buffer_load_dwordx4 v60, s[40:43], s69 offen lds
    s_add_u32 m0, s63, 50176
    buffer_load_dwordx4 v61, s[40:43], s69 offen lds
    s_add_u32 m0, s64, 57344
    buffer_load_dwordx4 v62, s[44:47], s69 offen lds
    s_add_u32 m0, s64, 58368
    buffer_load_dwordx4 v63, s[44:47], s69 offen lds
    s_add_u32 m0, s64, 59392
    buffer_load_dwordx4 v64, s[44:47], s69 offen lds
    s_add_u32 m0, s64, 60416
    buffer_load_dwordx4 v65, s[44:47], s69 offen lds
    ds_read_b128 v[36:39], v66 offset:0
    ds_read_b128 v[44:47], v70 offset:8192
    ds_read_b128 v[48:51], v70 offset:12288
    ds_read_b128 v[40:43], v67 offset:0
    ds_read_b128 v[52:55], v71 offset:8192
    ds_read_b128 v[56:59], v71 offset:12288
    s_waitcnt lgkmcnt(3)
    v_mfma_f32_32x32x16_bf16 v[4:19], v[44:47], v[36:39], v[4:19]
    v_mfma_f32_32x32x16_bf16 v[20:35], v[48:51], v[36:39], v[20:35]
    ds_read_b128 v[36:39], v68 offset:0
    ds_read_b128 v[44:47], v72 offset:8192
    ds_read_b128 v[48:51], v72 offset:12288
    s_waitcnt lgkmcnt(3)
    v_mfma_f32_32x32x16_bf16 v[4:19], v[52:55], v[40:43], v[4:19]
    v_mfma_f32_32x32x16_bf16 v[20:35], v[56:59], v[40:43], v[20:35]
    ds_read_b128 v[40:43], v69 offset:0
    ds_read_b128 v[52:55], v73 offset:8192
    ds_read_b128 v[56:59], v73 offset:12288
    s_waitcnt lgkmcnt(3)
    v_mfma_f32_32x32x16_bf16 v[4:19], v[44:47], v[36:39], v[4:19]
    v_mfma_f32_32x32x16_bf16 v[20:35], v[48:51], v[36:39], v[20:35]
    s_waitcnt vmcnt(22) lgkmcnt(0)
    s_barrier
    s_mov_b32 s69, 384
    s_add_u32 m0, s63, 0
    buffer_load_dwordx4 v60, s[40:43], s69 offen lds
    s_add_u32 m0, s63, 1024
    buffer_load_dwordx4 v61, s[40:43], s69 offen lds
    s_add_u32 m0, s64, 8192
    buffer_load_dwordx4 v62, s[44:47], s69 offen lds
    s_add_u32 m0, s64, 9216
    buffer_load_dwordx4 v63, s[44:47], s69 offen lds
    s_add_u32 m0, s64, 10240
    buffer_load_dwordx4 v64, s[44:47], s69 offen lds
    s_add_u32 m0, s64, 11264
    buffer_load_dwordx4 v65, s[44:47], s69 offen lds
    ds_read_b128 v[36:39], v66 offset:24576
    ds_read_b128 v[44:47], v70 offset:32768
    ds_read_b128 v[48:51], v70 offset:36864
    v_mfma_f32_32x32x16_bf16 v[4:19], v[52:55], v[40:43], v[4:19]
    v_mfma_f32_32x32x16_bf16 v[20:35], v[56:59], v[40:43], v[20:35]
    ds_read_b128 v[40:43], v67 offset:24576
    ds_read_b128 v[52:55], v71 offset:32768
    ds_read_b128 v[56:59], v71 offset:36864
    s_waitcnt lgkmcnt(3)
    v_mfma_f32_32x32x16_bf16 v[4:19], v[44:47], v[36:39], v[4:19]
    v_mfma_f32_32x32x16_bf16 v[20:35], v[48:51], v[36:39], v[20:35]
    ds_read_b128 v[36:39], v68 offset:24576
    ds_read_b128 v[44:47], v72 offset:32768
    ds_read_b128 v[48:51], v72 offset:36864
    s_waitcnt lgkmcnt(3)
    v_mfma_f32_32x32x16_bf16 v[4:19], v[52:55], v[40:43], v[4:19]
    v_mfma_f32_32x32x16_bf16 v[20:35], v[56:59], v[40:43], v[20:35]
    ds_read_b128 v[40:43], v69 offset:24576
    ds_read_b128 v[52:55], v73 offset:32768
    ds_read_b128 v[56:59], v73 offset:36864
    s_waitcnt lgkmcnt(3)
    v_mfma_f32_32x32x16_bf16 v[4:19], v[44:47], v[36:39], v[4:19]
    v_mfma_f32_32x32x16_bf16 v[20:35], v[48:51], v[36:39], v[20:35]
    s_waitcnt vmcnt(6) lgkmcnt(0)
    s_barrier
    s_mov_b32 s69, 512
    s_add_u32 m0, s63, 24576
    buffer_load_dwordx4 v60, s[40:43], s69 offen lds
    s_add_u32 m0, s63, 25600
    buffer_load_dwordx4 v61, s[40:43], s69 offen lds
    s_add_u32 m0, s64, 32768
    buffer_load_dwordx4 v62, s[44:47], s69 offen lds
    s_add_u32 m0, s64, 33792
    buffer_load_dwordx4 v63, s[44:47], s69 offen lds
    s_add_u32 m0, s64, 34816
    buffer_load_dwordx4 v64, s[44:47], s69 offen lds
    s_add_u32 m0, s64, 35840
    buffer_load_dwordx4 v65, s[44:47], s69 offen lds
    ds_read_b128 v[36:39], v66 offset:49152
    ds_read_b128 v[44:47], v70 offset:57344
    ds_read_b128 v[48:51], v70 offset:61440
    v_mfma_f32_32x32x16_bf16 v[4:19], v[52:55], v[40:43], v[4:19]
    v_mfma_f32_32x32x16_bf16 v[20:35], v[56:59], v[40:43], v[20:35]
    ds_read_b128 v[40:43], v67 offset:49152
    ds_read_b128 v[52:55], v71 offset:57344
    ds_read_b128 v[56:59], v71 offset:61440
    s_waitcnt lgkmcnt(3)
    v_mfma_f32_32x32x16_bf16 v[4:19], v[44:47], v[36:39], v[4:19]
    v_mfma_f32_32x32x16_bf16 v[20:35], v[48:51], v[36:39], v[20:35]
    ds_read_b128 v[36:39], v68 offset:49152
    ds_read_b128 v[44:47], v72 offset:57344
    ds_read_b128 v[48:51], v72 offset:61440
    s_waitcnt lgkmcnt(3)
    v_mfma_f32_32x32x16_bf16 v[4:19], v[52:55], v[40:43], v[4:19]
    v_mfma_f32_32x32x16_bf16 v[20:35], v[56:59], v[40:43], v[20:35]
    ds_read_b128 v[40:43], v69 offset:49152
    ds_read_b128 v[52:55], v73 offset:57344
    ds_read_b128 v[56:59], v73 offset:61440
    s_waitcnt lgkmcnt(3)
    v_mfma_f32_32x32x16_bf16 v[4:19], v[44:47], v[36:39], v[4:19]
    v_mfma_f32_32x32x16_bf16 v[20:35], v[48:51], v[36:39], v[20:35]
    s_waitcnt vmcnt(6) lgkmcnt(0)
    s_barrier
    s_mov_b32 s69, 640
    s_add_u32 m0, s63, 49152
    buffer_load_dwordx4 v60, s[40:43], s69 offen lds
    s_add_u32 m0, s63, 50176
    buffer_load_dwordx4 v61, s[40:43], s69 offen lds
    s_add_u32 m0, s64, 57344
    buffer_load_dwordx4 v62, s[44:47], s69 offen lds
    s_add_u32 m0, s64, 58368
    buffer_load_dwordx4 v63, s[44:47], s69 offen lds
    s_add_u32 m0, s64, 59392
    buffer_load_dwordx4 v64, s[44:47], s69 offen lds
    s_add_u32 m0, s64, 60416
    buffer_load_dwordx4 v65, s[44:47], s69 offen lds
    ds_read_b128 v[36:39], v66 offset:0
    ds_read_b128 v[44:47], v70 offset:8192
    ds_read_b128 v[48:51], v70 offset:12288
    v_mfma_f32_32x32x16_bf16 v[4:19], v[52:55], v[40:43], v[4:19]
    v_mfma_f32_32x32x16_bf16 v[20:35], v[56:59], v[40:43], v[20:35]
    ds_read_b128 v[40:43], v67 offset:0
    ds_read_b128 v[52:55], v71 offset:8192
    ds_read_b128 v[56:59], v71 offset:12288
    s_waitcnt lgkmcnt(3)
    v_mfma_f32_32x32x16_bf16 v[4:19], v[44:47], v[36:39], v[4:19]
    v_mfma_f32_32x32x16_bf16 v[20:35], v[48:51], v[36:39], v[20:35]
    ds_read_b128 v[36:39], v68 offset:0
    ds_read_b128 v[44:47], v72 offset:8192
    ds_read_b128 v[48:51], v72 offset:12288
    s_waitcnt lgkmcnt(3)
    v_mfma_f32_32x32x16_bf16 v[4:19], v[52:55], v[40:43], v[4:19]
    v_mfma_f32_32x32x16_bf16 v[20:35], v[56:59], v[40:43], v[20:35]
    ds_read_b128 v[40:43], v69 offset:0
    ds_read_b128 v[52:55], v73 offset:8192
    ds_read_b128 v[56:59], v73 offset:12288
    s_waitcnt lgkmcnt(3)
    v_mfma_f32_32x32x16_bf16 v[4:19], v[44:47], v[36:39], v[4:19]
    v_mfma_f32_32x32x16_bf16 v[20:35], v[48:51], v[36:39], v[20:35]
    s_waitcnt vmcnt(6) lgkmcnt(0)
    s_barrier
    s_mov_b32 s69, 768
    s_add_u32 m0, s63, 0
    buffer_load_dwordx4 v60, s[40:43], s69 offen lds
    s_add_u32 m0, s63, 1024
    buffer_load_dwordx4 v61, s[40:43], s69 offen lds
    s_add_u32 m0, s64, 8192
    buffer_load_dwordx4 v62, s[44:47], s69 offen lds
    s_add_u32 m0, s64, 9216
    buffer_load_dwordx4 v63, s[44:47], s69 offen lds
    s_add_u32 m0, s64, 10240
    buffer_load_dwordx4 v64, s[44:47], s69 offen lds
    s_add_u32 m0, s64, 11264
    buffer_load_dwordx4 v65, s[44:47], s69 offen lds
    ds_read_b128 v[36:39], v66 offset:24576
    ds_read_b128 v[44:47], v70 offset:32768
    ds_read_b128 v[48:51], v70 offset:36864
    v_mfma_f32_32x32x16_bf16 v[4:19], v[52:55], v[40:43], v[4:19]
    v_mfma_f32_32x32x16_bf16 v[20:35], v[56:59], v[40:43], v[20:35]
    ds_read_b128 v[40:43], v67 offset:24576
    ds_read_b128 v[52:55], v71 offset:32768
    ds_read_b128 v[56:59], v71 offset:36864
    s_waitcnt lgkmcnt(3)
    v_mfma_f32_32x32x16_bf16 v[4:19], v[44:47], v[36:39], v[4:19]
    v_mfma_f32_32x32x16_bf16 v[20:35], v[48:51], v[36:39], v[20:35]
    ds_read_b128 v[36:39], v68 offset:24576
    ds_read_b128 v[44:47], v72 offset:32768
    ds_read_b128 v[48:51], v72 offset:36864
    s_waitcnt lgkmcnt(3)
    v_mfma_f32_32x32x16_bf16 v[4:19], v[52:55], v[40:43], v[4:19]
    v_mfma_f32_32x32x16_bf16 v[20:35], v[56:59], v[40:43], v[20:35]
    ds_read_b128 v[40:43], v69 offset:24576
    ds_read_b128 v[52:55], v73 offset:32768
    ds_read_b128 v[56:59], v73 offset:36864
    s_waitcnt lgkmcnt(3)
    v_mfma_f32_32x32x16_bf16 v[4:19], v[44:47], v[36:39], v[4:19]
    v_mfma_f32_32x32x16_bf16 v[20:35], v[48:51], v[36:39], v[20:35]
    s_waitcnt vmcnt(6) lgkmcnt(0)
    s_barrier
    s_mov_b32 s69, 896
    s_add_u32 m0, s63, 24576
    buffer_load_dwordx4 v60, s[40:43], s69 offen lds
    s_add_u32 m0, s63, 25600
    buffer_load_dwordx4 v61, s[40:43], s69 offen lds
    s_add_u32 m0, s64, 32768
    buffer_load_dwordx4 v62, s[44:47], s69 offen lds
    s_add_u32 m0, s64, 33792
    buffer_load_dwordx4 v63, s[44:47], s69 offen lds
    s_add_u32 m0, s64, 34816
    buffer_load_dwordx4 v64, s[44:47], s69 offen lds
    s_add_u32 m0, s64, 35840
    buffer_load_dwordx4 v65, s[44:47], s69 offen lds
    ds_read_b128 v[36:39], v66 offset:49152
    ds_read_b128 v[44:47], v70 offset:57344
    ds_read_b128 v[48:51], v70 offset:61440
    v_mfma_f32_32x32x16_bf16 v[4:19], v[52:55], v[40:43], v[4:19]
    v_mfma_f32_32x32x16_bf16 v[20:35], v[56:59], v[40:43], v[20:35]
    ds_read_b128 v[40:43], v67 offset:49152
    ds_read_b128 v[52:55], v71 offset:57344
    ds_read_b128 v[56:59], v71 offset:61440
    s_waitcnt lgkmcnt(3)
    v_mfma_f32_32x32x16_bf16 v[4:19], v[44:47], v[36:39], v[4:19]
    v_mfma_f32_32x32x16_bf16 v[20:35], v[48:51], v[36:39], v[20:35]
    ds_read_b128 v[36:39], v68 offset:49152
    ds_read_b128 v[44:47], v72 offset:57344
    ds_read_b128 v[48:51], v72 offset:61440
    s_waitcnt lgkmcnt(3)
    v_mfma_f32_32x32x16_bf16 v[4:19], v[52:55], v[40:43], v[4:19]
    v_mfma_f32_32x32x16_bf16 v[20:35], v[56:59], v[40:43], v[20:35]
    ds_read_b128 v[40:43], v69 offset:49152
    ds_read_b128 v[52:55], v73 offset:57344
    ds_read_b128 v[56:59], v73 offset:61440
    s_waitcnt lgkmcnt(3)
    v_mfma_f32_32x32x16_bf16 v[4:19], v[44:47], v[36:39], v[4:19]
    v_mfma_f32_32x32x16_bf16 v[20:35], v[48:51], v[36:39], v[20:35]
    s_waitcnt vmcnt(6) lgkmcnt(0)
    s_barrier
    s_mov_b32 s69, 1024
    s_add_u32 m0, s63, 49152
    buffer_load_dwordx4 v60, s[40:43], s69 offen lds
    s_add_u32 m0, s63, 50176
    buffer_load_dwordx4 v61, s[40:43], s69 offen lds
    s_add_u32 m0, s64, 57344
    buffer_load_dwordx4 v62, s[44:47], s69 offen lds
    s_add_u32 m0, s64, 58368
    buffer_load_dwordx4 v63, s[44:47], s69 offen lds
    s_add_u32 m0, s64, 59392
    buffer_load_dwordx4 v64, s[44:47], s69 offen lds
    s_add_u32 m0, s64, 60416
    buffer_load_dwordx4 v65, s[44:47], s69 offen lds
    ds_read_b128 v[36:39], v66 offset:0
    ds_read_b128 v[44:47], v70 offset:8192
    ds_read_b128 v[48:51], v70 offset:12288
    v_mfma_f32_32x32x16_bf16 v[4:19], v[52:55], v[40:43], v[4:19]
    v_mfma_f32_32x32x16_bf16 v[20:35], v[56:59], v[40:43], v[20:35]
    ds_read_b128 v[40:43], v67 offset:0
    ds_read_b128 v[52:55], v71 offset:8192
    ds_read_b128 v[56:59], v71 offset:12288
    s_waitcnt lgkmcnt(3)
    v_mfma_f32_32x32x16_bf16 v[4:19], v[44:47], v[36:39], v[4:19]
    v_mfma_f32_32x32x16_bf16 v[20:35], v[48:51], v[36:39], v[20:35]
    ds_read_b128 v[36:39], v68 offset:0
    ds_read_b128 v[44:47], v72 offset:8192
    ds_read_b128 v[48:51], v72 offset:12288
    s_waitcnt lgkmcnt(3)
    v_mfma_f32_32x32x16_bf16 v[4:19], v[52:55], v[40:43], v[4:19]
    v_mfma_f32_32x32x16_bf16 v[20:35], v[56:59], v[40:43], v[20:35]
    ds_read_b128 v[40:43], v69 offset:0
    ds_read_b128 v[52:55], v73 offset:8192
    ds_read_b128 v[56:59], v73 offset:12288
    s_waitcnt lgkmcnt(3)
    v_mfma_f32_32x32x16_bf16 v[4:19], v[44:47], v[36:39], v[4:19]
    v_mfma_f32_32x32x16_bf16 v[20:35], v[48:51], v[36:39], v[20:35]
    s_waitcnt vmcnt(6) lgkmcnt(0)
    s_barrier
    s_mov_b32 s69, 1152
    s_add_u32 m0, s63, 0
    buffer_load_dwordx4 v60, s[40:43], s69 offen lds
    s_add_u32 m0, s63, 1024
    buffer_load_dwordx4 v61, s[40:43], s69 offen lds
    s_add_u32 m0, s64, 8192
    buffer_load_dwordx4 v62, s[44:47], s69 offen lds
    s_add_u32 m0, s64, 9216
    buffer_load_dwordx4 v63, s[44:47], s69 offen lds
    s_add_u32 m0, s64, 10240
    buffer_load_dwordx4 v64, s[44:47], s69 offen lds
    s_add_u32 m0, s64, 11264
    buffer_load_dwordx4 v65, s[44:47], s69 offen lds
    ds_read_b128 v[36:39], v66 offset:24576
    ds_read_b128 v[44:47], v70 offset:32768
    ds_read_b128 v[48:51], v70 offset:36864
    v_mfma_f32_32x32x16_bf16 v[4:19], v[52:55], v[40:43], v[4:19]
    v_mfma_f32_32x32x16_bf16 v[20:35], v[56:59], v[40:43], v[20:35]
    ds_read_b128 v[40:43], v67 offset:24576
    ds_read_b128 v[52:55], v71 offset:32768
    ds_read_b128 v[56:59], v71 offset:36864
    s_waitcnt lgkmcnt(3)
    v_mfma_f32_32x32x16_bf16 v[4:19], v[44:47], v[36:39], v[4:19]
    v_mfma_f32_32x32x16_bf16 v[20:35], v[48:51], v[36:39], v[20:35]
    ds_read_b128 v[36:39], v68 offset:24576
    ds_read_b128 v[44:47], v72 offset:32768
    ds_read_b128 v[48:51], v72 offset:36864
    s_waitcnt lgkmcnt(3)
    v_mfma_f32_32x32x16_bf16 v[4:19], v[52:55], v[40:43], v[4:19]
    v_mfma_f32_32x32x16_bf16 v[20:35], v[56:59], v[40:43], v[20:35]
    ds_read_b128 v[40:43], v69 offset:24576
    ds_read_b128 v[52:55], v73 offset:32768
    ds_read_b128 v[56:59], v73 offset:36864
    s_waitcnt lgkmcnt(3)
    v_mfma_f32_32x32x16_bf16 v[4:19], v[44:47], v[36:39], v[4:19]
    v_mfma_f32_32x32x16_bf16 v[20:35], v[48:51], v[36:39], v[20:35]
    s_waitcnt vmcnt(6) lgkmcnt(0)
    s_barrier
    s_mov_b32 s69, 1280
    s_add_u32 m0, s63, 24576
    buffer_load_dwordx4 v60, s[40:43], s69 offen lds
    s_add_u32 m0, s63, 25600
    buffer_load_dwordx4 v61, s[40:43], s69 offen lds
    s_add_u32 m0, s64, 32768
    buffer_load_dwordx4 v62, s[44:47], s69 offen lds
    s_add_u32 m0, s64, 33792
    buffer_load_dwordx4 v63, s[44:47], s69 offen lds
    s_add_u32 m0, s64, 34816
    buffer_load_dwordx4 v64, s[44:47], s69 offen lds
    s_add_u32 m0, s64, 35840
    buffer_load_dwordx4 v65, s[44:47], s69 offen lds
    ds_read_b128 v[36:39], v66 offset:49152
    ds_read_b128 v[44:47], v70 offset:57344
    ds_read_b128 v[48:51], v70 offset:61440
    v_mfma_f32_32x32x16_bf16 v[4:19], v[52:55], v[40:43], v[4:19]
    v_mfma_f32_32x32x16_bf16 v[20:35], v[56:59], v[40:43], v[20:35]
    ds_read_b128 v[40:43], v67 offset:49152
    ds_read_b128 v[52:55], v71 offset:57344
    ds_read_b128 v[56:59], v71 offset:61440
    s_waitcnt lgkmcnt(3)
    v_mfma_f32_32x32x16_bf16 v[4:19], v[44:47], v[36:39], v[4:19]
    v_mfma_f32_32x32x16_bf16 v[20:35], v[48:51], v[36:39], v[20:35]
    ds_read_b128 v[36:39], v68 offset:49152
    ds_read_b128 v[44:47], v72 offset:57344
    ds_read_b128 v[48:51], v72 offset:61440
    s_waitcnt lgkmcnt(3)
    v_mfma_f32_32x32x16_bf16 v[4:19], v[52:55], v[40:43], v[4:19]
    v_mfma_f32_32x32x16_bf16 v[20:35], v[56:59], v[40:43], v[20:35]
    ds_read_b128 v[40:43], v69 offset:49152
    ds_read_b128 v[52:55], v73 offset:57344
    ds_read_b128 v[56:59], v73 offset:61440
    s_waitcnt lgkmcnt(3)
    v_mfma_f32_32x32x16_bf16 v[4:19], v[44:47], v[36:39], v[4:19]
    v_mfma_f32_32x32x16_bf16 v[20:35], v[48:51], v[36:39], v[20:35]
    s_waitcnt vmcnt(6) lgkmcnt(0)
    s_barrier
    s_mov_b32 s69, 1408
    s_add_u32 m0, s63, 49152
    buffer_load_dwordx4 v60, s[40:43], s69 offen lds
    s_add_u32 m0, s63, 50176
    buffer_load_dwordx4 v61, s[40:43], s69 offen lds
    s_add_u32 m0, s64, 57344
    buffer_load_dwordx4 v62, s[44:47], s69 offen lds
    s_add_u32 m0, s64, 58368
    buffer_load_dwordx4 v63, s[44:47], s69 offen lds
    s_add_u32 m0, s64, 59392
    buffer_load_dwordx4 v64, s[44:47], s69 offen lds
    s_add_u32 m0, s64, 60416
    buffer_load_dwordx4 v65, s[44:47], s69 offen lds
    ds_read_b128 v[36:39], v66 offset:0
    ds_read_b128 v[44:47], v70 offset:8192
    ds_read_b128 v[48:51], v70 offset:12288
    v_mfma_f32_32x32x16_bf16 v[4:19], v[52:55], v[40:43], v[4:19]
    v_mfma_f32_32x32x16_bf16 v[20:35], v[56:59], v[40:43], v[20:35]
    ds_read_b128 v[40:43], v67 offset:0
    ds_read_b128 v[52:55], v71 offset:8192
    ds_read_b128 v[56:59], v71 offset:12288
    s_waitcnt lgkmcnt(3)
    v_mfma_f32_32x32x16_bf16 v[4:19], v[44:47], v[36:39], v[4:19]
    v_mfma_f32_32x32x16_bf16 v[20:35], v[48:51], v[36:39], v[20:35]
    ds_read_b128 v[36:39], v68 offset:0
    ds_read_b128 v[44:47], v72 offset:8192
    ds_read_b128 v[48:51], v72 offset:12288
    s_waitcnt lgkmcnt(3)
    v_mfma_f32_32x32x16_bf16 v[4:19], v[52:55], v[40:43], v[4:19]
    v_mfma_f32_32x32x16_bf16 v[20:35], v[56:59], v[40:43], v[20:35]
    ds_read_b128 v[40:43], v69 offset:0
    ds_read_b128 v[52:55], v73 offset:8192
    ds_read_b128 v[56:59], v73 offset:12288
    s_waitcnt lgkmcnt(3)
    v_mfma_f32_32x32x16_bf16 v[4:19], v[44:47], v[36:39], v[4:19]
    v_mfma_f32_32x32x16_bf16 v[20:35], v[48:51], v[36:39], v[20:35]
    s_waitcnt vmcnt(6) lgkmcnt(0)
    s_barrier
    s_mov_b32 s69, 1536
    s_add_u32 m0, s63, 0
    buffer_load_dwordx4 v60, s[40:43], s69 offen lds
    s_add_u32 m0, s63, 1024
    buffer_load_dwordx4 v61, s[40:43], s69 offen lds
    s_add_u32 m0, s64, 8192
    buffer_load_dwordx4 v62, s[44:47], s69 offen lds
    s_add_u32 m0, s64, 9216
    buffer_load_dwordx4 v63, s[44:47], s69 offen lds
    s_add_u32 m0, s64, 10240
    buffer_load_dwordx4 v64, s[44:47], s69 offen lds
    s_add_u32 m0, s64, 11264
    buffer_load_dwordx4 v65, s[44:47], s69 offen lds
    ds_read_b128 v[36:39], v66 offset:24576
    ds_read_b128 v[44:47], v70 offset:32768
    ds_read_b128 v[48:51], v70 offset:36864
    v_mfma_f32_32x32x16_bf16 v[4:19], v[52:55], v[40:43], v[4:19]
    v_mfma_f32_32x32x16_bf16 v[20:35], v[56:59], v[40:43], v[20:35]
    ds_read_b128 v[40:43], v67 offset:24576
    ds_read_b128 v[52:55], v71 offset:32768
    ds_read_b128 v[56:59], v71 offset:36864
    s_waitcnt lgkmcnt(3)
    v_mfma_f32_32x32x16_bf16 v[4:19], v[44:47], v[36:39], v[4:19]
    v_mfma_f32_32x32x16_bf16 v[20:35], v[48:51], v[36:39], v[20:35]
    ds_read_b128 v[36:39], v68 offset:24576
    ds_read_b128 v[44:47], v72 offset:32768
    ds_read_b128 v[48:51], v72 offset:36864
    s_waitcnt lgkmcnt(3)
    v_mfma_f32_32x32x16_bf16 v[4:19], v[52:55], v[40:43], v[4:19]
    v_mfma_f32_32x32x16_bf16 v[20:35], v[56:59], v[40:43], v[20:35]
    ds_read_b128 v[40:43], v69 offset:24576
    ds_read_b128 v[52:55], v73 offset:32768
    ds_read_b128 v[56:59], v73 offset:36864
    s_waitcnt lgkmcnt(3)
    v_mfma_f32_32x32x16_bf16 v[4:19], v[44:47], v[36:39], v[4:19]
    v_mfma_f32_32x32x16_bf16 v[20:35], v[48:51], v[36:39], v[20:35]
    s_waitcnt vmcnt(6) lgkmcnt(0)
    s_barrier
    s_mov_b32 s69, 1664
    s_add_u32 m0, s63, 24576
    buffer_load_dwordx4 v60, s[40:43], s69 offen lds
    s_add_u32 m0, s63, 25600
    buffer_load_dwordx4 v61, s[40:43], s69 offen lds
    s_add_u32 m0, s64, 32768
    buffer_load_dwordx4 v62, s[44:47], s69 offen lds
    s_add_u32 m0, s64, 33792
    buffer_load_dwordx4 v63, s[44:47], s69 offen lds
    s_add_u32 m0, s64, 34816
    buffer_load_dwordx4 v64, s[44:47], s69 offen lds
    s_add_u32 m0, s64, 35840
    buffer_load_dwordx4 v65, s[44:47], s69 offen lds
    ds_read_b128 v[36:39], v66 offset:49152
    ds_read_b128 v[44:47], v70 offset:57344
    ds_read_b128 v[48:51], v70 offset:61440
    v_mfma_f32_32x32x16_bf16 v[4:19], v[52:55], v[40:43], v[4:19]
    v_mfma_f32_32x32x16_bf16 v[20:35], v[56:59], v[40:43], v[20:35]
    ds_read_b128 v[40:43], v67 offset:49152
    ds_read_b128 v[52:55], v71 offset:57344
    ds_read_b128 v[56:59], v71 offset:61440
    s_waitcnt lgkmcnt(3)
    v_mfma_f32_32x32x16_bf16 v[4:19], v[44:47], v[36:39], v[4:19]
    v_mfma_f32_32x32x16_bf16 v[20:35], v[48:51], v[36:39], v[20:35]
    ds_read_b128 v[36:39], v68 offset:49152
    ds_read_b128 v[44:47], v72 offset:57344
    ds_read_b128 v[48:51], v72 offset:61440
    s_waitcnt lgkmcnt(3)
    v_mfma_f32_32x32x16_bf16 v[4:19], v[52:55], v[40:43], v[4:19]
    v_mfma_f32_32x32x16_bf16 v[20:35], v[56:59], v[40:43], v[20:35]
    ds_read_b128 v[40:43], v69 offset:49152
    ds_read_b128 v[52:55], v73 offset:57344
    ds_read_b128 v[56:59], v73 offset:61440
    s_waitcnt lgkmcnt(3)
    v_mfma_f32_32x32x16_bf16 v[4:19], v[44:47], v[36:39], v[4:19]
    v_mfma_f32_32x32x16_bf16 v[20:35], v[48:51], v[36:39], v[20:35]
    s_waitcnt vmcnt(6) lgkmcnt(0)
    s_barrier
    s_mov_b32 s69, 1792
    s_add_u32 m0, s63, 49152
    buffer_load_dwordx4 v60, s[40:43], s69 offen lds
    s_add_u32 m0, s63, 50176
    buffer_load_dwordx4 v61, s[40:43], s69 offen lds
    s_add_u32 m0, s64, 57344
    buffer_load_dwordx4 v62, s[44:47], s69 offen lds
    s_add_u32 m0, s64, 58368
    buffer_load_dwordx4 v63, s[44:47], s69 offen lds
    s_add_u32 m0, s64, 59392
    buffer_load_dwordx4 v64, s[44:47], s69 offen lds
    s_add_u32 m0, s64, 60416
    buffer_load_dwordx4 v65, s[44:47], s69 offen lds
    ds_read_b128 v[36:39], v66 offset:0
    ds_read_b128 v[44:47], v70 offset:8192
    ds_read_b128 v[48:51], v70 offset:12288
    v_mfma_f32_32x32x16_bf16 v[4:19], v[52:55], v[40:43], v[4:19]
    v_mfma_f32_32x32x16_bf16 v[20:35], v[56:59], v[40:43], v[20:35]
    ds_read_b128 v[40:43], v67 offset:0
    ds_read_b128 v[52:55], v71 offset:8192
    ds_read_b128 v[56:59], v71 offset:12288
    s_waitcnt lgkmcnt(3)
    v_mfma_f32_32x32x16_bf16 v[4:19], v[44:47], v[36:39], v[4:19]
    v_mfma_f32_32x32x16_bf16 v[20:35], v[48:51], v[36:39], v[20:35]
    ds_read_b128 v[36:39], v68 offset:0
    ds_read_b128 v[44:47], v72 offset:8192
    ds_read_b128 v[48:51], v72 offset:12288
    s_waitcnt lgkmcnt(3)
    v_mfma_f32_32x32x16_bf16 v[4:19], v[52:55], v[40:43], v[4:19]
    v_mfma_f32_32x32x16_bf16 v[20:35], v[56:59], v[40:43], v[20:35]
    ds_read_b128 v[40:43], v69 offset:0
    ds_read_b128 v[52:55], v73 offset:8192
    ds_read_b128 v[56:59], v73 offset:12288
    s_waitcnt lgkmcnt(3)
    v_mfma_f32_32x32x16_bf16 v[4:19], v[44:47], v[36:39], v[4:19]
    v_mfma_f32_32x32x16_bf16 v[20:35], v[48:51], v[36:39], v[20:35]
    s_waitcnt vmcnt(6) lgkmcnt(0)
    s_barrier
    s_mov_b32 s69, 1920
    s_add_u32 m0, s63, 0
    buffer_load_dwordx4 v60, s[40:43], s69 offen lds
    s_add_u32 m0, s63, 1024
    buffer_load_dwordx4 v61, s[40:43], s69 offen lds
    s_add_u32 m0, s64, 8192
    buffer_load_dwordx4 v62, s[44:47], s69 offen lds
    s_add_u32 m0, s64, 9216
    buffer_load_dwordx4 v63, s[44:47], s69 offen lds
    s_add_u32 m0, s64, 10240
    buffer_load_dwordx4 v64, s[44:47], s69 offen lds
    s_add_u32 m0, s64, 11264
    buffer_load_dwordx4 v65, s[44:47], s69 offen lds
    ds_read_b128 v[36:39], v66 offset:24576
    ds_read_b128 v[44:47], v70 offset:32768
    ds_read_b128 v[48:51], v70 offset:36864
    v_mfma_f32_32x32x16_bf16 v[4:19], v[52:55], v[40:43], v[4:19]
    v_mfma_f32_32x32x16_bf16 v[20:35], v[56:59], v[40:43], v[20:35]
    ds_read_b128 v[40:43], v67 offset:24576
    ds_read_b128 v[52:55], v71 offset:32768
    ds_read_b128 v[56:59], v71 offset:36864
    s_waitcnt lgkmcnt(3)
    v_mfma_f32_32x32x16_bf16 v[4:19], v[44:47], v[36:39], v[4:19]
    v_mfma_f32_32x32x16_bf16 v[20:35], v[48:51], v[36:39], v[20:35]
    ds_read_b128 v[36:39], v68 offset:24576
    ds_read_b128 v[44:47], v72 offset:32768
    ds_read_b128 v[48:51], v72 offset:36864
    s_waitcnt lgkmcnt(3)
    v_mfma_f32_32x32x16_bf16 v[4:19], v[52:55], v[40:43], v[4:19]
    v_mfma_f32_32x32x16_bf16 v[20:35], v[56:59], v[40:43], v[20:35]
    ds_read_b128 v[40:43], v69 offset:24576
    ds_read_b128 v[52:55], v73 offset:32768
    ds_read_b128 v[56:59], v73 offset:36864
    s_waitcnt lgkmcnt(3)
    v_mfma_f32_32x32x16_bf16 v[4:19], v[44:47], v[36:39], v[4:19]
    v_mfma_f32_32x32x16_bf16 v[20:35], v[48:51], v[36:39], v[20:35]
    s_waitcnt vmcnt(6) lgkmcnt(0)
    s_barrier
    s_mov_b32 s69, 2048
    s_add_u32 m0, s63, 24576
    buffer_load_dwordx4 v60, s[40:43], s69 offen lds
    s_add_u32 m0, s63, 25600
    buffer_load_dwordx4 v61, s[40:43], s69 offen lds
    s_add_u32 m0, s64, 32768
    buffer_load_dwordx4 v62, s[44:47], s69 offen lds
    s_add_u32 m0, s64, 33792
    buffer_load_dwordx4 v63, s[44:47], s69 offen lds
    s_add_u32 m0, s64, 34816
    buffer_load_dwordx4 v64, s[44:47], s69 offen lds
    s_add_u32 m0, s64, 35840
    buffer_load_dwordx4 v65, s[44:47], s69 offen lds
    ds_read_b128 v[36:39], v66 offset:49152
    ds_read_b128 v[44:47], v70 offset:57344
    ds_read_b128 v[48:51], v70 offset:61440
    v_mfma_f32_32x32x16_bf16 v[4:19], v[52:55], v[40:43], v[4:19]
    v_mfma_f32_32x32x16_bf16 v[20:35], v[56:59], v[40:43], v[20:35]
    ds_read_b128 v[40:43], v67 offset:49152
    ds_read_b128 v[52:55], v71 offset:57344
    ds_read_b128 v[56:59], v71 offset:61440
    s_waitcnt lgkmcnt(3)
    v_mfma_f32_32x32x16_bf16 v[4:19], v[44:47], v[36:39], v[4:19]
    v_mfma_f32_32x32x16_bf16 v[20:35], v[48:51], v[36:39], v[20:35]
    ds_read_b128 v[36:39], v68 offset:49152
    ds_read_b128 v[44:47], v72 offset:57344
    ds_read_b128 v[48:51], v72 offset:61440
    s_waitcnt lgkmcnt(3)
    v_mfma_f32_32x32x16_bf16 v[4:19], v[52:55], v[40:43], v[4:19]
    v_mfma_f32_32x32x16_bf16 v[20:35], v[56:59], v[40:43], v[20:35]
    ds_read_b128 v[40:43], v69 offset:49152
    ds_read_b128 v[52:55], v73 offset:57344
    ds_read_b128 v[56:59], v73 offset:61440
    s_waitcnt lgkmcnt(3)
    v_mfma_f32_32x32x16_bf16 v[4:19], v[44:47], v[36:39], v[4:19]
    v_mfma_f32_32x32x16_bf16 v[20:35], v[48:51], v[36:39], v[20:35]
    s_waitcnt vmcnt(6) lgkmcnt(0)
    s_barrier
    s_mov_b32 s69, 2176
    s_add_u32 m0, s63, 49152
    buffer_load_dwordx4 v60, s[40:43], s69 offen lds
    s_add_u32 m0, s63, 50176
    buffer_load_dwordx4 v61, s[40:43], s69 offen lds
    s_add_u32 m0, s64, 57344
    buffer_load_dwordx4 v62, s[44:47], s69 offen lds
    s_add_u32 m0, s64, 58368
    buffer_load_dwordx4 v63, s[44:47], s69 offen lds
    s_add_u32 m0, s64, 59392
    buffer_load_dwordx4 v64, s[44:47], s69 offen lds
    s_add_u32 m0, s64, 60416
    buffer_load_dwordx4 v65, s[44:47], s69 offen lds
    ds_read_b128 v[36:39], v66 offset:0
    ds_read_b128 v[44:47], v70 offset:8192
    ds_read_b128 v[48:51], v70 offset:12288
    v_mfma_f32_32x32x16_bf16 v[4:19], v[52:55], v[40:43], v[4:19]
    v_mfma_f32_32x32x16_bf16 v[20:35], v[56:59], v[40:43], v[20:35]
    ds_read_b128 v[40:43], v67 offset:0
    ds_read_b128 v[52:55], v71 offset:8192
    ds_read_b128 v[56:59], v71 offset:12288
    s_waitcnt lgkmcnt(3)
    v_mfma_f32_32x32x16_bf16 v[4:19], v[44:47], v[36:39], v[4:19]
    v_mfma_f32_32x32x16_bf16 v[20:35], v[48:51], v[36:39], v[20:35]
    ds_read_b128 v[36:39], v68 offset:0
    ds_read_b128 v[44:47], v72 offset:8192
    ds_read_b128 v[48:51], v72 offset:12288
    s_waitcnt lgkmcnt(3)
    v_mfma_f32_32x32x16_bf16 v[4:19], v[52:55], v[40:43], v[4:19]
    v_mfma_f32_32x32x16_bf16 v[20:35], v[56:59], v[40:43], v[20:35]
    ds_read_b128 v[40:43], v69 offset:0
    ds_read_b128 v[52:55], v73 offset:8192
    ds_read_b128 v[56:59], v73 offset:12288
    s_waitcnt lgkmcnt(3)
    v_mfma_f32_32x32x16_bf16 v[4:19], v[44:47], v[36:39], v[4:19]
    v_mfma_f32_32x32x16_bf16 v[20:35], v[48:51], v[36:39], v[20:35]
    s_waitcnt vmcnt(6) lgkmcnt(0)
    s_barrier
    s_mov_b32 s69, 2304
    s_add_u32 m0, s63, 0
    buffer_load_dwordx4 v60, s[40:43], s69 offen lds
    s_add_u32 m0, s63, 1024
    buffer_load_dwordx4 v61, s[40:43], s69 offen lds
    s_add_u32 m0, s64, 8192
    buffer_load_dwordx4 v62, s[44:47], s69 offen lds
    s_add_u32 m0, s64, 9216
    buffer_load_dwordx4 v63, s[44:47], s69 offen lds
    s_add_u32 m0, s64, 10240
    buffer_load_dwordx4 v64, s[44:47], s69 offen lds
    s_add_u32 m0, s64, 11264
    buffer_load_dwordx4 v65, s[44:47], s69 offen lds
    ds_read_b128 v[36:39], v66 offset:24576
    ds_read_b128 v[44:47], v70 offset:32768
    ds_read_b128 v[48:51], v70 offset:36864
    v_mfma_f32_32x32x16_bf16 v[4:19], v[52:55], v[40:43], v[4:19]
    v_mfma_f32_32x32x16_bf16 v[20:35], v[56:59], v[40:43], v[20:35]
    ds_read_b128 v[40:43], v67 offset:24576
    ds_read_b128 v[52:55], v71 offset:32768
    ds_read_b128 v[56:59], v71 offset:36864
    s_waitcnt lgkmcnt(3)
    v_mfma_f32_32x32x16_bf16 v[4:19], v[44:47], v[36:39], v[4:19]
    v_mfma_f32_32x32x16_bf16 v[20:35], v[48:51], v[36:39], v[20:35]
    ds_read_b128 v[36:39], v68 offset:24576
    ds_read_b128 v[44:47], v72 offset:32768
    ds_read_b128 v[48:51], v72 offset:36864
    s_waitcnt lgkmcnt(3)
    v_mfma_f32_32x32x16_bf16 v[4:19], v[52:55], v[40:43], v[4:19]
    v_mfma_f32_32x32x16_bf16 v[20:35], v[56:59], v[40:43], v[20:35]
    ds_read_b128 v[40:43], v69 offset:24576
    ds_read_b128 v[52:55], v73 offset:32768
    ds_read_b128 v[56:59], v73 offset:36864
    s_waitcnt lgkmcnt(3)
    v_mfma_f32_32x32x16_bf16 v[4:19], v[44:47], v[36:39], v[4:19]
    v_mfma_f32_32x32x16_bf16 v[20:35], v[48:51], v[36:39], v[20:35]
    s_waitcnt vmcnt(6) lgkmcnt(0)
    s_barrier
    s_mov_b32 s69, 2432
    s_add_u32 m0, s63, 24576
    buffer_load_dwordx4 v60, s[40:43], s69 offen lds
    s_add_u32 m0, s63, 25600
    buffer_load_dwordx4 v61, s[40:43], s69 offen lds
    s_add_u32 m0, s64, 32768
    buffer_load_dwordx4 v62, s[44:47], s69 offen lds
    s_add_u32 m0, s64, 33792
    buffer_load_dwordx4 v63, s[44:47], s69 offen lds
    s_add_u32 m0, s64, 34816
    buffer_load_dwordx4 v64, s[44:47], s69 offen lds
    s_add_u32 m0, s64, 35840
    buffer_load_dwordx4 v65, s[44:47], s69 offen lds
    ds_read_b128 v[36:39], v66 offset:49152
    ds_read_b128 v[44:47], v70 offset:57344
    ds_read_b128 v[48:51], v70 offset:61440
    v_mfma_f32_32x32x16_bf16 v[4:19], v[52:55], v[40:43], v[4:19]
    v_mfma_f32_32x32x16_bf16 v[20:35], v[56:59], v[40:43], v[20:35]
    ds_read_b128 v[40:43], v67 offset:49152
    ds_read_b128 v[52:55], v71 offset:57344
    ds_read_b128 v[56:59], v71 offset:61440
    s_waitcnt lgkmcnt(3)
    v_mfma_f32_32x32x16_bf16 v[4:19], v[44:47], v[36:39], v[4:19]
    v_mfma_f32_32x32x16_bf16 v[20:35], v[48:51], v[36:39], v[20:35]
    ds_read_b128 v[36:39], v68 offset:49152
    ds_read_b128 v[44:47], v72 offset:57344
    ds_read_b128 v[48:51], v72 offset:61440
    s_waitcnt lgkmcnt(3)
    v_mfma_f32_32x32x16_bf16 v[4:19], v[52:55], v[40:43], v[4:19]
    v_mfma_f32_32x32x16_bf16 v[20:35], v[56:59], v[40:43], v[20:35]
    ds_read_b128 v[40:43], v69 offset:49152
    ds_read_b128 v[52:55], v73 offset:57344
    ds_read_b128 v[56:59], v73 offset:61440
    s_waitcnt lgkmcnt(3)
    v_mfma_f32_32x32x16_bf16 v[4:19], v[44:47], v[36:39], v[4:19]
    v_mfma_f32_32x32x16_bf16 v[20:35], v[48:51], v[36:39], v[20:35]
    s_waitcnt vmcnt(6) lgkmcnt(0)
    s_barrier
    s_mov_b32 s69, 2560
    s_add_u32 m0, s63, 49152
    buffer_load_dwordx4 v60, s[40:43], s69 offen lds
    s_add_u32 m0, s63, 50176
    buffer_load_dwordx4 v61, s[40:43], s69 offen lds
    s_add_u32 m0, s64, 57344
    buffer_load_dwordx4 v62, s[44:47], s69 offen lds
    s_add_u32 m0, s64, 58368
    buffer_load_dwordx4 v63, s[44:47], s69 offen lds
    s_add_u32 m0, s64, 59392
    buffer_load_dwordx4 v64, s[44:47], s69 offen lds
    s_add_u32 m0, s64, 60416
    buffer_load_dwordx4 v65, s[44:47], s69 offen lds
    ds_read_b128 v[36:39], v66 offset:0
    ds_read_b128 v[44:47], v70 offset:8192
    ds_read_b128 v[48:51], v70 offset:12288
    v_mfma_f32_32x32x16_bf16 v[4:19], v[52:55], v[40:43], v[4:19]
    v_mfma_f32_32x32x16_bf16 v[20:35], v[56:59], v[40:43], v[20:35]
    ds_read_b128 v[40:43], v67 offset:0
    ds_read_b128 v[52:55], v71 offset:8192
    ds_read_b128 v[56:59], v71 offset:12288
    s_waitcnt lgkmcnt(3)
    v_mfma_f32_32x32x16_bf16 v[4:19], v[44:47], v[36:39], v[4:19]
    v_mfma_f32_32x32x16_bf16 v[20:35], v[48:51], v[36:39], v[20:35]
    ds_read_b128 v[36:39], v68 offset:0
    ds_read_b128 v[44:47], v72 offset:8192
    ds_read_b128 v[48:51], v72 offset:12288
    s_waitcnt lgkmcnt(3)
    v_mfma_f32_32x32x16_bf16 v[4:19], v[52:55], v[40:43], v[4:19]
    v_mfma_f32_32x32x16_bf16 v[20:35], v[56:59], v[40:43], v[20:35]
    ds_read_b128 v[40:43], v69 offset:0
    ds_read_b128 v[52:55], v73 offset:8192
    ds_read_b128 v[56:59], v73 offset:12288
    s_waitcnt lgkmcnt(3)
    v_mfma_f32_32x32x16_bf16 v[4:19], v[44:47], v[36:39], v[4:19]
    v_mfma_f32_32x32x16_bf16 v[20:35], v[48:51], v[36:39], v[20:35]
    s_waitcnt vmcnt(6) lgkmcnt(0)
    s_barrier
    s_mov_b32 s69, 2688
    s_add_u32 m0, s63, 0
    buffer_load_dwordx4 v60, s[40:43], s69 offen lds
    s_add_u32 m0, s63, 1024
    buffer_load_dwordx4 v61, s[40:43], s69 offen lds
    s_add_u32 m0, s64, 8192
    buffer_load_dwordx4 v62, s[44:47], s69 offen lds
    s_add_u32 m0, s64, 9216
    buffer_load_dwordx4 v63, s[44:47], s69 offen lds
    s_add_u32 m0, s64, 10240
    buffer_load_dwordx4 v64, s[44:47], s69 offen lds
    s_add_u32 m0, s64, 11264
    buffer_load_dwordx4 v65, s[44:47], s69 offen lds
    ds_read_b128 v[36:39], v66 offset:24576
    ds_read_b128 v[44:47], v70 offset:32768
    ds_read_b128 v[48:51], v70 offset:36864
    v_mfma_f32_32x32x16_bf16 v[4:19], v[52:55], v[40:43], v[4:19]
    v_mfma_f32_32x32x16_bf16 v[20:35], v[56:59], v[40:43], v[20:35]
    ds_read_b128 v[40:43], v67 offset:24576
    ds_read_b128 v[52:55], v71 offset:32768
    ds_read_b128 v[56:59], v71 offset:36864
    s_waitcnt lgkmcnt(3)
    v_mfma_f32_32x32x16_bf16 v[4:19], v[44:47], v[36:39], v[4:19]
    v_mfma_f32_32x32x16_bf16 v[20:35], v[48:51], v[36:39], v[20:35]
    ds_read_b128 v[36:39], v68 offset:24576
    ds_read_b128 v[44:47], v72 offset:32768
    ds_read_b128 v[48:51], v72 offset:36864
    s_waitcnt lgkmcnt(3)
    v_mfma_f32_32x32x16_bf16 v[4:19], v[52:55], v[40:43], v[4:19]
    v_mfma_f32_32x32x16_bf16 v[20:35], v[56:59], v[40:43], v[20:35]
    ds_read_b128 v[40:43], v69 offset:24576
    ds_read_b128 v[52:55], v73 offset:32768
    ds_read_b128 v[56:59], v73 offset:36864
    s_waitcnt lgkmcnt(3)
    v_mfma_f32_32x32x16_bf16 v[4:19], v[44:47], v[36:39], v[4:19]
    v_mfma_f32_32x32x16_bf16 v[20:35], v[48:51], v[36:39], v[20:35]
    s_waitcnt vmcnt(6) lgkmcnt(0)
    s_barrier
    s_mov_b32 s69, 2816
    s_add_u32 m0, s63, 24576
    buffer_load_dwordx4 v60, s[40:43], s69 offen lds
    s_add_u32 m0, s63, 25600
    buffer_load_dwordx4 v61, s[40:43], s69 offen lds
    s_add_u32 m0, s64, 32768
    buffer_load_dwordx4 v62, s[44:47], s69 offen lds
    s_add_u32 m0, s64, 33792
    buffer_load_dwordx4 v63, s[44:47], s69 offen lds
    s_add_u32 m0, s64, 34816
    buffer_load_dwordx4 v64, s[44:47], s69 offen lds
    s_add_u32 m0, s64, 35840
    buffer_load_dwordx4 v65, s[44:47], s69 offen lds
    ds_read_b128 v[36:39], v66 offset:49152
    ds_read_b128 v[44:47], v70 offset:57344
    ds_read_b128 v[48:51], v70 offset:61440
    v_mfma_f32_32x32x16_bf16 v[4:19], v[52:55], v[40:43], v[4:19]
    v_mfma_f32_32x32x16_bf16 v[20:35], v[56:59], v[40:43], v[20:35]
    ds_read_b128 v[40:43], v67 offset:49152
    ds_read_b128 v[52:55], v71 offset:57344
    ds_read_b128 v[56:59], v71 offset:61440
    s_waitcnt lgkmcnt(3)
    v_mfma_f32_32x32x16_bf16 v[4:19], v[44:47], v[36:39], v[4:19]
    v_mfma_f32_32x32x16_bf16 v[20:35], v[48:51], v[36:39], v[20:35]
    ds_read_b128 v[36:39], v68 offset:49152
    ds_read_b128 v[44:47], v72 offset:57344
    ds_read_b128 v[48:51], v72 offset:61440
    s_waitcnt lgkmcnt(3)
    v_mfma_f32_32x32x16_bf16 v[4:19], v[52:55], v[40:43], v[4:19]
    v_mfma_f32_32x32x16_bf16 v[20:35], v[56:59], v[40:43], v[20:35]
    ds_read_b128 v[40:43], v69 offset:49152
    ds_read_b128 v[52:55], v73 offset:57344
    ds_read_b128 v[56:59], v73 offset:61440
    s_waitcnt lgkmcnt(3)
    v_mfma_f32_32x32x16_bf16 v[4:19], v[44:47], v[36:39], v[4:19]
    v_mfma_f32_32x32x16_bf16 v[20:35], v[48:51], v[36:39], v[20:35]
    s_waitcnt vmcnt(6) lgkmcnt(0)
    s_barrier
    s_mov_b32 s69, 2944
    s_add_u32 m0, s63, 49152
    buffer_load_dwordx4 v60, s[40:43], s69 offen lds
    s_add_u32 m0, s63, 50176
    buffer_load_dwordx4 v61, s[40:43], s69 offen lds
    s_add_u32 m0, s64, 57344
    buffer_load_dwordx4 v62, s[44:47], s69 offen lds
    s_add_u32 m0, s64, 58368
    buffer_load_dwordx4 v63, s[44:47], s69 offen lds
    s_add_u32 m0, s64, 59392
    buffer_load_dwordx4 v64, s[44:47], s69 offen lds
    s_add_u32 m0, s64, 60416
    buffer_load_dwordx4 v65, s[44:47], s69 offen lds
    ds_read_b128 v[36:39], v66 offset:0
    ds_read_b128 v[44:47], v70 offset:8192
    ds_read_b128 v[48:51], v70 offset:12288
    v_mfma_f32_32x32x16_bf16 v[4:19], v[52:55], v[40:43], v[4:19]
    v_mfma_f32_32x32x16_bf16 v[20:35], v[56:59], v[40:43], v[20:35]
    ds_read_b128 v[40:43], v67 offset:0
    ds_read_b128 v[52:55], v71 offset:8192
    ds_read_b128 v[56:59], v71 offset:12288
    s_waitcnt lgkmcnt(3)
    v_mfma_f32_32x32x16_bf16 v[4:19], v[44:47], v[36:39], v[4:19]
    v_mfma_f32_32x32x16_bf16 v[20:35], v[48:51], v[36:39], v[20:35]
    ds_read_b128 v[36:39], v68 offset:0
    ds_read_b128 v[44:47], v72 offset:8192
    ds_read_b128 v[48:51], v72 offset:12288
    s_waitcnt lgkmcnt(3)
    v_mfma_f32_32x32x16_bf16 v[4:19], v[52:55], v[40:43], v[4:19]
    v_mfma_f32_32x32x16_bf16 v[20:35], v[56:59], v[40:43], v[20:35]
    ds_read_b128 v[40:43], v69 offset:0
    ds_read_b128 v[52:55], v73 offset:8192
    ds_read_b128 v[56:59], v73 offset:12288
    s_waitcnt lgkmcnt(3)
    v_mfma_f32_32x32x16_bf16 v[4:19], v[44:47], v[36:39], v[4:19]
    v_mfma_f32_32x32x16_bf16 v[20:35], v[48:51], v[36:39], v[20:35]
    s_waitcnt vmcnt(6) lgkmcnt(0)
    s_barrier
    s_mov_b32 s69, 3072
    s_add_u32 m0, s63, 0
    buffer_load_dwordx4 v60, s[40:43], s69 offen lds
    s_add_u32 m0, s63, 1024
    buffer_load_dwordx4 v61, s[40:43], s69 offen lds
    s_add_u32 m0, s64, 8192
    buffer_load_dwordx4 v62, s[44:47], s69 offen lds
    s_add_u32 m0, s64, 9216
    buffer_load_dwordx4 v63, s[44:47], s69 offen lds
    s_add_u32 m0, s64, 10240
    buffer_load_dwordx4 v64, s[44:47], s69 offen lds
    s_add_u32 m0, s64, 11264
    buffer_load_dwordx4 v65, s[44:47], s69 offen lds
    ds_read_b128 v[36:39], v66 offset:24576
    ds_read_b128 v[44:47], v70 offset:32768
    ds_read_b128 v[48:51], v70 offset:36864
    v_mfma_f32_32x32x16_bf16 v[4:19], v[52:55], v[40:43], v[4:19]
    v_mfma_f32_32x32x16_bf16 v[20:35], v[56:59], v[40:43], v[20:35]
    ds_read_b128 v[40:43], v67 offset:24576
    ds_read_b128 v[52:55], v71 offset:32768
    ds_read_b128 v[56:59], v71 offset:36864
    s_waitcnt lgkmcnt(3)
    v_mfma_f32_32x32x16_bf16 v[4:19], v[44:47], v[36:39], v[4:19]
    v_mfma_f32_32x32x16_bf16 v[20:35], v[48:51], v[36:39], v[20:35]
    ds_read_b128 v[36:39], v68 offset:24576
    ds_read_b128 v[44:47], v72 offset:32768
    ds_read_b128 v[48:51], v72 offset:36864
    s_waitcnt lgkmcnt(3)
    v_mfma_f32_32x32x16_bf16 v[4:19], v[52:55], v[40:43], v[4:19]
    v_mfma_f32_32x32x16_bf16 v[20:35], v[56:59], v[40:43], v[20:35]
    ds_read_b128 v[40:43], v69 offset:24576
    ds_read_b128 v[52:55], v73 offset:32768
    ds_read_b128 v[56:59], v73 offset:36864
    s_waitcnt lgkmcnt(3)
    v_mfma_f32_32x32x16_bf16 v[4:19], v[44:47], v[36:39], v[4:19]
    v_mfma_f32_32x32x16_bf16 v[20:35], v[48:51], v[36:39], v[20:35]
    s_waitcnt vmcnt(6) lgkmcnt(0)
    s_barrier
    s_mov_b32 s69, 3200
    s_add_u32 m0, s63, 24576
    buffer_load_dwordx4 v60, s[40:43], s69 offen lds
    s_add_u32 m0, s63, 25600
    buffer_load_dwordx4 v61, s[40:43], s69 offen lds
    s_add_u32 m0, s64, 32768
    buffer_load_dwordx4 v62, s[44:47], s69 offen lds
    s_add_u32 m0, s64, 33792
    buffer_load_dwordx4 v63, s[44:47], s69 offen lds
    s_add_u32 m0, s64, 34816
    buffer_load_dwordx4 v64, s[44:47], s69 offen lds
    s_add_u32 m0, s64, 35840
    buffer_load_dwordx4 v65, s[44:47], s69 offen lds
    ds_read_b128 v[36:39], v66 offset:49152
    ds_read_b128 v[44:47], v70 offset:57344
    ds_read_b128 v[48:51], v70 offset:61440
    v_mfma_f32_32x32x16_bf16 v[4:19], v[52:55], v[40:43], v[4:19]
    v_mfma_f32_32x32x16_bf16 v[20:35], v[56:59], v[40:43], v[20:35]
    ds_read_b128 v[40:43], v67 offset:49152
    ds_read_b128 v[52:55], v71 offset:57344
    ds_read_b128 v[56:59], v71 offset:61440
    s_waitcnt lgkmcnt(3)
    v_mfma_f32_32x32x16_bf16 v[4:19], v[44:47], v[36:39], v[4:19]
    v_mfma_f32_32x32x16_bf16 v[20:35], v[48:51], v[36:39], v[20:35]
    ds_read_b128 v[36:39], v68 offset:49152
    ds_read_b128 v[44:47], v72 offset:57344
    ds_read_b128 v[48:51], v72 offset:61440
    s_waitcnt lgkmcnt(3)
    v_mfma_f32_32x32x16_bf16 v[4:19], v[52:55], v[40:43], v[4:19]
    v_mfma_f32_32x32x16_bf16 v[20:35], v[56:59], v[40:43], v[20:35]
    ds_read_b128 v[40:43], v69 offset:49152
    ds_read_b128 v[52:55], v73 offset:57344
    ds_read_b128 v[56:59], v73 offset:61440
    s_waitcnt lgkmcnt(3)
    v_mfma_f32_32x32x16_bf16 v[4:19], v[44:47], v[36:39], v[4:19]
    v_mfma_f32_32x32x16_bf16 v[20:35], v[48:51], v[36:39], v[20:35]
    s_waitcnt vmcnt(6) lgkmcnt(0)
    s_barrier
    s_mov_b32 s69, 3328
    s_add_u32 m0, s63, 49152
    buffer_load_dwordx4 v60, s[40:43], s69 offen lds
    s_add_u32 m0, s63, 50176
    buffer_load_dwordx4 v61, s[40:43], s69 offen lds
    s_add_u32 m0, s64, 57344
    buffer_load_dwordx4 v62, s[44:47], s69 offen lds
    s_add_u32 m0, s64, 58368
    buffer_load_dwordx4 v63, s[44:47], s69 offen lds
    s_add_u32 m0, s64, 59392
    buffer_load_dwordx4 v64, s[44:47], s69 offen lds
    s_add_u32 m0, s64, 60416
    buffer_load_dwordx4 v65, s[44:47], s69 offen lds
    ds_read_b128 v[36:39], v66 offset:0
    ds_read_b128 v[44:47], v70 offset:8192
    ds_read_b128 v[48:51], v70 offset:12288
    v_mfma_f32_32x32x16_bf16 v[4:19], v[52:55], v[40:43], v[4:19]
    v_mfma_f32_32x32x16_bf16 v[20:35], v[56:59], v[40:43], v[20:35]
    ds_read_b128 v[40:43], v67 offset:0
    ds_read_b128 v[52:55], v71 offset:8192
    ds_read_b128 v[56:59], v71 offset:12288
    s_waitcnt lgkmcnt(3)
    v_mfma_f32_32x32x16_bf16 v[4:19], v[44:47], v[36:39], v[4:19]
    v_mfma_f32_32x32x16_bf16 v[20:35], v[48:51], v[36:39], v[20:35]
    ds_read_b128 v[36:39], v68 offset:0
    ds_read_b128 v[44:47], v72 offset:8192
    ds_read_b128 v[48:51], v72 offset:12288
    s_waitcnt lgkmcnt(3)
    v_mfma_f32_32x32x16_bf16 v[4:19], v[52:55], v[40:43], v[4:19]
    v_mfma_f32_32x32x16_bf16 v[20:35], v[56:59], v[40:43], v[20:35]
    ds_read_b128 v[40:43], v69 offset:0
    ds_read_b128 v[52:55], v73 offset:8192
    ds_read_b128 v[56:59], v73 offset:12288
    s_waitcnt lgkmcnt(3)
    v_mfma_f32_32x32x16_bf16 v[4:19], v[44:47], v[36:39], v[4:19]
    v_mfma_f32_32x32x16_bf16 v[20:35], v[48:51], v[36:39], v[20:35]
    s_waitcnt vmcnt(6) lgkmcnt(0)
    s_barrier
    ds_read_b128 v[36:39], v66 offset:24576
    ds_read_b128 v[44:47], v70 offset:32768
    ds_read_b128 v[48:51], v70 offset:36864
    v_mfma_f32_32x32x16_bf16 v[4:19], v[52:55], v[40:43], v[4:19]
    v_mfma_f32_32x32x16_bf16 v[20:35], v[56:59], v[40:43], v[20:35]
    ds_read_b128 v[40:43], v67 offset:24576
    ds_read_b128 v[52:55], v71 offset:32768
    ds_read_b128 v[56:59], v71 offset:36864
    s_waitcnt lgkmcnt(3)
    v_mfma_f32_32x32x16_bf16 v[4:19], v[44:47], v[36:39], v[4:19]
    v_mfma_f32_32x32x16_bf16 v[20:35], v[48:51], v[36:39], v[20:35]
    ds_read_b128 v[36:39], v68 offset:24576
    ds_read_b128 v[44:47], v72 offset:32768
    ds_read_b128 v[48:51], v72 offset:36864
    s_waitcnt lgkmcnt(3)
    v_mfma_f32_32x32x16_bf16 v[4:19], v[52:55], v[40:43], v[4:19]
    v_mfma_f32_32x32x16_bf16 v[20:35], v[56:59], v[40:43], v[20:35]
    ds_read_b128 v[40:43], v69 offset:24576
    ds_read_b128 v[52:55], v73 offset:32768
    ds_read_b128 v[56:59], v73 offset:36864
    s_waitcnt lgkmcnt(3)
    v_mfma_f32_32x32x16_bf16 v[4:19], v[44:47], v[36:39], v[4:19]
    v_mfma_f32_32x32x16_bf16 v[20:35], v[48:51], v[36:39], v[20:35]
    s_waitcnt vmcnt(0) lgkmcnt(0)
    s_barrier
    ds_read_b128 v[36:39], v66 offset:49152
    ds_read_b128 v[44:47], v70 offset:57344
    ds_read_b128 v[48:51], v70 offset:61440
    v_mfma_f32_32x32x16_bf16 v[4:19], v[52:55], v[40:43], v[4:19]
    v_mfma_f32_32x32x16_bf16 v[20:35], v[56:59], v[40:43], v[20:35]
    ds_read_b128 v[40:43], v67 offset:49152
    ds_read_b128 v[52:55], v71 offset:57344
    ds_read_b128 v[56:59], v71 offset:61440
    s_waitcnt lgkmcnt(3)
    v_mfma_f32_32x32x16_bf16 v[4:19], v[44:47], v[36:39], v[4:19]
    v_mfma_f32_32x32x16_bf16 v[20:35], v[48:51], v[36:39], v[20:35]
    ds_read_b128 v[36:39], v68 offset:49152
    ds_read_b128 v[44:47], v72 offset:57344
    ds_read_b128 v[48:51], v72 offset:61440
    s_waitcnt lgkmcnt(3)
    v_mfma_f32_32x32x16_bf16 v[4:19], v[52:55], v[40:43], v[4:19]
    v_mfma_f32_32x32x16_bf16 v[20:35], v[56:59], v[40:43], v[20:35]
    ds_read_b128 v[40:43], v69 offset:49152
    ds_read_b128 v[52:55], v73 offset:57344
    ds_read_b128 v[56:59], v73 offset:61440
    s_waitcnt lgkmcnt(3)
    v_mfma_f32_32x32x16_bf16 v[4:19], v[44:47], v[36:39], v[4:19]
    v_mfma_f32_32x32x16_bf16 v[20:35], v[48:51], v[36:39], v[20:35]
    s_waitcnt lgkmcnt(0)
    v_mfma_f32_32x32x16_bf16 v[4:19], v[52:55], v[40:43], v[4:19]
    v_mfma_f32_32x32x16_bf16 v[20:35], v[56:59], v[40:43], v[20:35]
    s_nop 7
    s_nop 7
    s_waitcnt vmcnt(0)
    v_and_b32 v121, 31, v82
    s_lshl_b32 s65, s67, 5
    v_add_u32 v121, s65, v121
    v_add_u32 v121, s61, v121
    v_mul_u32_u24 v122, 1280, v121
    v_lshlrev_b32 v123, 1, v118
    v_add_u32 v122, v122, v123
    s_lshl_b32 s66, s62, 1
    v_mov_b32 v132, 0
    v_mov_b32 v133, 0
    v_cvt_pk_bf16_f32 v123, v4, v5
    v_lshlrev_b32 v4, 16, v123
    v_and_b32 v5, 0xffff0000, v123
    v_cvt_pk_bf16_f32 v124, v6, v7
    v_lshlrev_b32 v6, 16, v124
    v_and_b32 v7, 0xffff0000, v124
    v_lshlrev_b32 v126, 16, v86
    v_and_b32 v127, 0xffff0000, v86
    v_lshlrev_b32 v128, 16, v87
    v_and_b32 v129, 0xffff0000, v87
    v_add_f32 v4, v4, v126
    v_add_f32 v5, v5, v127
    v_add_f32 v6, v6, v128
    v_add_f32 v7, v7, v129
    v_cvt_pk_bf16_f32 v123, v4, v5
    v_lshlrev_b32 v4, 16, v123
    v_and_b32 v5, 0xffff0000, v123
    v_cvt_pk_bf16_f32 v124, v6, v7
    v_lshlrev_b32 v6, 16, v124
    v_and_b32 v7, 0xffff0000, v124
    v_lshlrev_b32 v126, 16, v102
    v_and_b32 v127, 0xffff0000, v102
    v_lshlrev_b32 v128, 16, v103
    v_and_b32 v129, 0xffff0000, v103
    v_add_f32 v4, v4, v126
    v_add_f32 v5, v5, v127
    v_add_f32 v6, v6, v128
    v_add_f32 v7, v7, v129
    v_cvt_pk_bf16_f32 v130, v4, v5
    v_cvt_pk_bf16_f32 v131, v6, v7
    buffer_store_dwordx2 v[130:131], v122, s[56:59], s66 offen offset:0
    s_nop 1
    v_cvt_pk_bf16_f32 v123, v8, v9
    v_lshlrev_b32 v8, 16, v123
    v_and_b32 v9, 0xffff0000, v123
    v_cvt_pk_bf16_f32 v124, v10, v11
    v_lshlrev_b32 v10, 16, v124
    v_and_b32 v11, 0xffff0000, v124
    v_lshlrev_b32 v126, 16, v88
    v_and_b32 v127, 0xffff0000, v88
    v_lshlrev_b32 v128, 16, v89
    v_and_b32 v129, 0xffff0000, v89
    v_add_f32 v8, v8, v126
    v_add_f32 v9, v9, v127
    v_add_f32 v10, v10, v128
    v_add_f32 v11, v11, v129
    v_cvt_pk_bf16_f32 v123, v8, v9
    v_lshlrev_b32 v8, 16, v123
    v_and_b32 v9, 0xffff0000, v123
    v_cvt_pk_bf16_f32 v124, v10, v11
    v_lshlrev_b32 v10, 16, v124
    v_and_b32 v11, 0xffff0000, v124
    v_lshlrev_b32 v126, 16, v104
    v_and_b32 v127, 0xffff0000, v104
    v_lshlrev_b32 v128, 16, v105
    v_and_b32 v129, 0xffff0000, v105
    v_add_f32 v8, v8, v126
    v_add_f32 v9, v9, v127
    v_add_f32 v10, v10, v128
    v_add_f32 v11, v11, v129
    v_cvt_pk_bf16_f32 v130, v8, v9
    v_cvt_pk_bf16_f32 v131, v10, v11
    buffer_store_dwordx2 v[130:131], v122, s[56:59], s66 offen offset:16
    s_nop 1
    v_cvt_pk_bf16_f32 v123, v12, v13
    v_lshlrev_b32 v12, 16, v123
    v_and_b32 v13, 0xffff0000, v123
    v_cvt_pk_bf16_f32 v124, v14, v15
    v_lshlrev_b32 v14, 16, v124
    v_and_b32 v15, 0xffff0000, v124
    v_lshlrev_b32 v126, 16, v90
    v_and_b32 v127, 0xffff0000, v90
    v_lshlrev_b32 v128, 16, v91
    v_and_b32 v129, 0xffff0000, v91
    v_add_f32 v12, v12, v126
    v_add_f32 v13, v13, v127
    v_add_f32 v14, v14, v128
    v_add_f32 v15, v15, v129
    v_cvt_pk_bf16_f32 v123, v12, v13
    v_lshlrev_b32 v12, 16, v123
    v_and_b32 v13, 0xffff0000, v123
    v_cvt_pk_bf16_f32 v124, v14, v15
    v_lshlrev_b32 v14, 16, v124
    v_and_b32 v15, 0xffff0000, v124
    v_lshlrev_b32 v126, 16, v106
    v_and_b32 v127, 0xffff0000, v106
    v_lshlrev_b32 v128, 16, v107
    v_and_b32 v129, 0xffff0000, v107
    v_add_f32 v12, v12, v126
    v_add_f32 v13, v13, v127
    v_add_f32 v14, v14, v128
    v_add_f32 v15, v15, v129
    v_cvt_pk_bf16_f32 v130, v12, v13
    v_cvt_pk_bf16_f32 v131, v14, v15
    buffer_store_dwordx2 v[130:131], v122, s[56:59], s66 offen offset:32
    s_nop 1
    v_cvt_pk_bf16_f32 v123, v16, v17
    v_lshlrev_b32 v16, 16, v123
    v_and_b32 v17, 0xffff0000, v123
    v_cvt_pk_bf16_f32 v124, v18, v19
    v_lshlrev_b32 v18, 16, v124
    v_and_b32 v19, 0xffff0000, v124
    v_lshlrev_b32 v126, 16, v92
    v_and_b32 v127, 0xffff0000, v92
    v_lshlrev_b32 v128, 16, v93
    v_and_b32 v129, 0xffff0000, v93
    v_add_f32 v16, v16, v126
    v_add_f32 v17, v17, v127
    v_add_f32 v18, v18, v128
    v_add_f32 v19, v19, v129
    v_cvt_pk_bf16_f32 v123, v16, v17
    v_lshlrev_b32 v16, 16, v123
    v_and_b32 v17, 0xffff0000, v123
    v_cvt_pk_bf16_f32 v124, v18, v19
    v_lshlrev_b32 v18, 16, v124
    v_and_b32 v19, 0xffff0000, v124
    v_lshlrev_b32 v126, 16, v108
    v_and_b32 v127, 0xffff0000, v108
    v_lshlrev_b32 v128, 16, v109
    v_and_b32 v129, 0xffff0000, v109
    v_add_f32 v16, v16, v126
    v_add_f32 v17, v17, v127
    v_add_f32 v18, v18, v128
    v_add_f32 v19, v19, v129
    v_cvt_pk_bf16_f32 v130, v16, v17
    v_cvt_pk_bf16_f32 v131, v18, v19
    buffer_store_dwordx2 v[130:131], v122, s[56:59], s66 offen offset:48
    s_nop 1
    v_cvt_pk_bf16_f32 v123, v20, v21
    v_lshlrev_b32 v20, 16, v123
    v_and_b32 v21, 0xffff0000, v123
    v_cvt_pk_bf16_f32 v124, v22, v23
    v_lshlrev_b32 v22, 16, v124
    v_and_b32 v23, 0xffff0000, v124
    v_lshlrev_b32 v126, 16, v94
    v_and_b32 v127, 0xffff0000, v94
    v_lshlrev_b32 v128, 16, v95
    v_and_b32 v129, 0xffff0000, v95
    v_add_f32 v20, v20, v126
    v_add_f32 v21, v21, v127
    v_add_f32 v22, v22, v128
    v_add_f32 v23, v23, v129
    v_cvt_pk_bf16_f32 v123, v20, v21
    v_lshlrev_b32 v20, 16, v123
    v_and_b32 v21, 0xffff0000, v123
    v_cvt_pk_bf16_f32 v124, v22, v23
    v_lshlrev_b32 v22, 16, v124
    v_and_b32 v23, 0xffff0000, v124
    v_lshlrev_b32 v126, 16, v110
    v_and_b32 v127, 0xffff0000, v110
    v_lshlrev_b32 v128, 16, v111
    v_and_b32 v129, 0xffff0000, v111
    v_add_f32 v20, v20, v126
    v_add_f32 v21, v21, v127
    v_add_f32 v22, v22, v128
    v_add_f32 v23, v23, v129
    v_cvt_pk_bf16_f32 v130, v20, v21
    v_cvt_pk_bf16_f32 v131, v22, v23
    buffer_store_dwordx2 v[130:131], v122, s[56:59], s66 offen offset:64
    s_nop 1
    v_cvt_pk_bf16_f32 v123, v24, v25
    v_lshlrev_b32 v24, 16, v123
    v_and_b32 v25, 0xffff0000, v123
    v_cvt_pk_bf16_f32 v124, v26, v27
    v_lshlrev_b32 v26, 16, v124
    v_and_b32 v27, 0xffff0000, v124
    v_lshlrev_b32 v126, 16, v96
    v_and_b32 v127, 0xffff0000, v96
    v_lshlrev_b32 v128, 16, v97
    v_and_b32 v129, 0xffff0000, v97
    v_add_f32 v24, v24, v126
    v_add_f32 v25, v25, v127
    v_add_f32 v26, v26, v128
    v_add_f32 v27, v27, v129
    v_cvt_pk_bf16_f32 v123, v24, v25
    v_lshlrev_b32 v24, 16, v123
    v_and_b32 v25, 0xffff0000, v123
    v_cvt_pk_bf16_f32 v124, v26, v27
    v_lshlrev_b32 v26, 16, v124
    v_and_b32 v27, 0xffff0000, v124
    v_lshlrev_b32 v126, 16, v112
    v_and_b32 v127, 0xffff0000, v112
    v_lshlrev_b32 v128, 16, v113
    v_and_b32 v129, 0xffff0000, v113
    v_add_f32 v24, v24, v126
    v_add_f32 v25, v25, v127
    v_add_f32 v26, v26, v128
    v_add_f32 v27, v27, v129
    v_cvt_pk_bf16_f32 v130, v24, v25
    v_cvt_pk_bf16_f32 v131, v26, v27
    buffer_store_dwordx2 v[130:131], v122, s[56:59], s66 offen offset:80
    s_nop 1
    v_cvt_pk_bf16_f32 v123, v28, v29
    v_lshlrev_b32 v28, 16, v123
    v_and_b32 v29, 0xffff0000, v123
    v_cvt_pk_bf16_f32 v124, v30, v31
    v_lshlrev_b32 v30, 16, v124
    v_and_b32 v31, 0xffff0000, v124
    v_lshlrev_b32 v126, 16, v98
    v_and_b32 v127, 0xffff0000, v98
    v_lshlrev_b32 v128, 16, v99
    v_and_b32 v129, 0xffff0000, v99
    v_add_f32 v28, v28, v126
    v_add_f32 v29, v29, v127
    v_add_f32 v30, v30, v128
    v_add_f32 v31, v31, v129
    v_cvt_pk_bf16_f32 v123, v28, v29
    v_lshlrev_b32 v28, 16, v123
    v_and_b32 v29, 0xffff0000, v123
    v_cvt_pk_bf16_f32 v124, v30, v31
    v_lshlrev_b32 v30, 16, v124
    v_and_b32 v31, 0xffff0000, v124
    v_lshlrev_b32 v126, 16, v114
    v_and_b32 v127, 0xffff0000, v114
    v_lshlrev_b32 v128, 16, v115
    v_and_b32 v129, 0xffff0000, v115
    v_add_f32 v28, v28, v126
    v_add_f32 v29, v29, v127
    v_add_f32 v30, v30, v128
    v_add_f32 v31, v31, v129
    v_cvt_pk_bf16_f32 v130, v28, v29
    v_cvt_pk_bf16_f32 v131, v30, v31
    buffer_store_dwordx2 v[130:131], v122, s[56:59], s66 offen offset:96
    s_nop 1
    v_cvt_pk_bf16_f32 v123, v32, v33
    v_lshlrev_b32 v32, 16, v123
    v_and_b32 v33, 0xffff0000, v123
    v_cvt_pk_bf16_f32 v124, v34, v35
    v_lshlrev_b32 v34, 16, v124
    v_and_b32 v35, 0xffff0000, v124
    v_lshlrev_b32 v126, 16, v100
    v_and_b32 v127, 0xffff0000, v100
    v_lshlrev_b32 v128, 16, v101
    v_and_b32 v129, 0xffff0000, v101
    v_add_f32 v32, v32, v126
    v_add_f32 v33, v33, v127
    v_add_f32 v34, v34, v128
    v_add_f32 v35, v35, v129
    v_cvt_pk_bf16_f32 v123, v32, v33
    v_lshlrev_b32 v32, 16, v123
    v_and_b32 v33, 0xffff0000, v123
    v_cvt_pk_bf16_f32 v124, v34, v35
    v_lshlrev_b32 v34, 16, v124
    v_and_b32 v35, 0xffff0000, v124
    v_lshlrev_b32 v126, 16, v116
    v_and_b32 v127, 0xffff0000, v116
    v_lshlrev_b32 v128, 16, v117
    v_and_b32 v129, 0xffff0000, v117
    v_add_f32 v32, v32, v126
    v_add_f32 v33, v33, v127
    v_add_f32 v34, v34, v128
    v_add_f32 v35, v35, v129
    v_cvt_pk_bf16_f32 v130, v32, v33
    v_cvt_pk_bf16_f32 v131, v34, v35
    buffer_store_dwordx2 v[130:131], v122, s[56:59], s66 offen offset:112
    s_nop 1
.k4p1_kernel_end:
    s_endpgm

.section .rodata,"a"
.p2align 6
.amdhsa_kernel prep_kernel
  .amdhsa_next_free_vgpr 64
  .amdhsa_next_free_sgpr 102
  .amdhsa_accum_offset 64
  .amdhsa_group_segment_fixed_size 0
  .amdhsa_kernarg_size 88
  .amdhsa_user_sgpr_count 2
  .amdhsa_user_sgpr_kernarg_segment_ptr 1
  .amdhsa_system_sgpr_workgroup_id_x 1
.end_amdhsa_kernel

.p2align 6
.amdhsa_kernel k1p0_kernel
  .amdhsa_next_free_vgpr 232
  .amdhsa_next_free_sgpr 102
  .amdhsa_accum_offset 232
  .amdhsa_group_segment_fixed_size 0
  .amdhsa_kernarg_size 88
  .amdhsa_user_sgpr_count 2
  .amdhsa_user_sgpr_kernarg_segment_ptr 1
  .amdhsa_system_sgpr_workgroup_id_x 1
.end_amdhsa_kernel

.p2align 6
.amdhsa_kernel k2p0_kernel
  .amdhsa_next_free_vgpr 240
  .amdhsa_next_free_sgpr 102
  .amdhsa_accum_offset 240
  .amdhsa_group_segment_fixed_size 0
  .amdhsa_kernarg_size 88
  .amdhsa_user_sgpr_count 2
  .amdhsa_user_sgpr_kernarg_segment_ptr 1
  .amdhsa_system_sgpr_workgroup_id_x 1
.end_amdhsa_kernel

.p2align 6
.amdhsa_kernel k3p0_kernel
  .amdhsa_next_free_vgpr 200
  .amdhsa_next_free_sgpr 102
  .amdhsa_accum_offset 200
  .amdhsa_group_segment_fixed_size 0
  .amdhsa_kernarg_size 88
  .amdhsa_user_sgpr_count 2
  .amdhsa_user_sgpr_kernarg_segment_ptr 1
  .amdhsa_system_sgpr_workgroup_id_x 1
.end_amdhsa_kernel

.p2align 6
.amdhsa_kernel k4p0_kernel
  .amdhsa_next_free_vgpr 136
  .amdhsa_next_free_sgpr 102
  .amdhsa_accum_offset 136
  .amdhsa_group_segment_fixed_size 0
  .amdhsa_kernarg_size 88
  .amdhsa_user_sgpr_count 2
  .amdhsa_user_sgpr_kernarg_segment_ptr 1
  .amdhsa_system_sgpr_workgroup_id_x 1
.end_amdhsa_kernel

.p2align 6
.amdhsa_kernel k1p1_kernel
  .amdhsa_next_free_vgpr 232
  .amdhsa_next_free_sgpr 102
  .amdhsa_accum_offset 232
  .amdhsa_group_segment_fixed_size 0
  .amdhsa_kernarg_size 88
  .amdhsa_user_sgpr_count 2
  .amdhsa_user_sgpr_kernarg_segment_ptr 1
  .amdhsa_system_sgpr_workgroup_id_x 1
.end_amdhsa_kernel

.p2align 6
.amdhsa_kernel k2p1_kernel
  .amdhsa_next_free_vgpr 240
  .amdhsa_next_free_sgpr 102
  .amdhsa_accum_offset 240
  .amdhsa_group_segment_fixed_size 0
  .amdhsa_kernarg_size 88
  .amdhsa_user_sgpr_count 2
  .amdhsa_user_sgpr_kernarg_segment_ptr 1
  .amdhsa_system_sgpr_workgroup_id_x 1
.end_amdhsa_kernel

.p2align 6
.amdhsa_kernel k3p1_kernel
  .amdhsa_next_free_vgpr 200
  .amdhsa_next_free_sgpr 102
  .amdhsa_accum_offset 200
  .amdhsa_group_segment_fixed_size 0
  .amdhsa_kernarg_size 88
  .amdhsa_user_sgpr_count 2
  .amdhsa_user_sgpr_kernarg_segment_ptr 1
  .amdhsa_system_sgpr_workgroup_id_x 1
.end_amdhsa_kernel

.p2align 6
.amdhsa_kernel k4p1_kernel
  .amdhsa_next_free_vgpr 136
  .amdhsa_next_free_sgpr 102
  .amdhsa_accum_offset 136
  .amdhsa_group_segment_fixed_size 0
  .amdhsa_kernarg_size 88
  .amdhsa_user_sgpr_count 2
  .amdhsa_user_sgpr_kernarg_segment_ptr 1
  .amdhsa_system_sgpr_workgroup_id_x 1
.end_amdhsa_kernel
```
